```python
import torch

def _softmax(x, axis=-1):
    return torch.softmax(x, dim=axis)
def _gelu(x):
    return torch.nn.functional.gelu(x, approximate="tanh")
def _silu(x):
    return torch.nn.functional.silu(x)
def _sigmoid(x):
    return torch.sigmoid(x)
def _layernorm(x, axis=-1, eps=1e-5):
    m = x.mean(dim=axis, keepdim=True)
    v = x.var(dim=axis, keepdim=True, unbiased=False)
    return (x - m) / torch.sqrt(v + eps)
def _scatter_add(tgt, idx, src, axis=0):
    return tgt.clone().index_add_(axis, idx, src)
def _segment_sum(src, seg, n):
    out = torch.zeros((n,) + src.shape[1:], dtype=src.dtype)
    return out.index_add_(0, seg, src)
def _pad(x, pw):
    flat = tuple(v for pair in reversed(pw) for v in pair)
    return torch.nn.functional.pad(x, flat)

kernel_name = 'standalone__detection_seg_dino__vision'

def setup_inputs():

    _w = (lambda a: (lambda t: t.to(torch.bfloat16) if t.is_floating_point() else t)(torch.as_tensor(a)))
    H = W = (512 // 2) * 2
    C = 192
    Nq = 16
    sc = C ** -0.5
    return {
        "q": _w((lambda *s: torch.randn(*s, dtype=torch.bfloat16) * 0.2)(1, Nq, C)),
        "f0": _w((lambda *s: torch.randn(*s, dtype=torch.bfloat16) * 3.2)(1, H, W, C)),
        "f1": _w((lambda *s: torch.randn(*s, dtype=torch.bfloat16) * 3.2)(1, H // 2, W // 2, C)),
        "wq": _w((lambda *s: torch.randn(*s, dtype=torch.bfloat16) * 1.6)(C, C) * sc),
        "wk": _w((lambda *s: torch.randn(*s, dtype=torch.bfloat16) * 1.6)(C, C) * sc),
        "wv": _w((lambda *s: torch.randn(*s, dtype=torch.bfloat16) * 3.2)(C, C) * sc),
        "wo": _w((lambda *s: torch.randn(*s, dtype=torch.bfloat16) * 3.2)(C, C) * sc),
    }

def reference(q, f0, f1, wq, wk, wv, wo):
    B, H, W, C = f0.shape
    f1u = (lambda x, n, axis: torch.repeat_interleave(x, n, dim=axis))((lambda x, n, axis: torch.repeat_interleave(x, n, dim=axis))(f1, 2, axis=1), 2, axis=2)
    fused = f0 + f1u
    feats = _layernorm(fused.reshape(B, H * W, C), axis=-1)
    qn = _layernorm(q, axis=-1)
    Q = torch.einsum("bnc,cd->bnd", qn, wq)
    K = torch.einsum("bmc,cd->bmd", feats, wk)
    V = torch.einsum("bmc,cd->bmd", feats, wv)
    scale = C ** -0.5
    logits = torch.einsum("bnd,bmd->bnm", Q, K) * scale
    attn = _softmax(logits, axis=-1)
    ctx = torch.einsum("bnm,bmd->bnd", attn, V)
    return q + torch.einsum("bnd,dc->bnc", ctx, wo)
```

```asm
; @launch kernel=prep_kernel grid=(25,1,1) block=(256,1,1) lds=163840
; @launch kernel=main_kernel grid=(256,1,1) block=(256,1,1) lds=163840
; @launch kernel=comb_kernel grid=(64,1,1) block=(256,1,1) lds=1024
.amdgcn_target "amdgcn-amd-amdhsa--gfx950"
.text
.p2align 8
prep_kernel:
    s_cmp_ge_u32 s2, 25
    s_cbranch_scc1 L_prep_end
    s_load_dwordx16 s[4:19], s[0:1], 0
    s_load_dwordx4 s[20:23], s[0:1], 64
    v_lshrrev_b32 v1, 6, v0
    v_and_b32 v0, 63, v0
    v_readfirstlane_b32 s3, v1
    v_lshlrev_b32 v65, 4, v0
    s_waitcnt lgkmcnt(0)
    s_mov_b32 s32, s22
    s_mov_b32 s33, s23
    s_mov_b32 s34, 8388608
    s_mov_b32 s35, 0x20000
    s_cmp_eq_u32 s2, 24
    s_cbranch_scc1 L_prep_qk
    s_cmp_lg_u32 s3, 0
    s_cbranch_scc1 L_prep_end
    s_mul_i32 s62, s2, 43
    s_lshr_b32 s62, s62, 8
    s_mul_i32 s56, s62, 6
    s_sub_u32 s63, s2, s56
    s_mov_b32 s64, s14
    s_mov_b32 s65, s15
    s_mov_b32 s66, 73728
    s_mov_b32 s67, 0x20000
    s_mov_b32 s68, s16
    s_mov_b32 s69, s17
    s_mov_b32 s70, 73728
    s_mov_b32 s71, 0x20000
    v_add_u32 v1, 0, v0
    v_mul_u32_u24 v1, 10923, v1
    v_lshrrev_b32 v1, 16, v1
    v_mul_u32_u24 v1, 288, v1
    v_add_u32 v16, v1, v65
    v_add_u32 v1, 64, v0
    v_mul_u32_u24 v1, 10923, v1
    v_lshrrev_b32 v1, 16, v1
    v_mul_u32_u24 v1, 288, v1
    v_add_u32 v17, v1, v65
    v_add_u32 v1, 128, v0
    v_mul_u32_u24 v1, 10923, v1
    v_lshrrev_b32 v1, 16, v1
    v_mul_u32_u24 v1, 288, v1
    v_add_u32 v18, v1, v65
    s_mul_i32 s57, s62, 96
    s_mov_b32 m0, 122880
    s_nop 0
    buffer_load_dwordx4 v16, s[68:71], s57 offen offset:0 lds
    buffer_load_dwordx4 v17, s[68:71], s57 offen offset:1024 lds
    buffer_load_dwordx4 v18, s[68:71], s57 offen offset:2048 lds
    s_mov_b32 m0, 125952
    s_add_u32 s57, s57, 12288
    buffer_load_dwordx4 v16, s[68:71], s57 offen offset:0 lds
    buffer_load_dwordx4 v17, s[68:71], s57 offen offset:1024 lds
    buffer_load_dwordx4 v18, s[68:71], s57 offen offset:2048 lds
    s_mov_b32 m0, 129024
    s_add_u32 s57, s57, 12288
    buffer_load_dwordx4 v16, s[68:71], s57 offen offset:0 lds
    buffer_load_dwordx4 v17, s[68:71], s57 offen offset:1024 lds
    buffer_load_dwordx4 v18, s[68:71], s57 offen offset:2048 lds
    s_mov_b32 m0, 132096
    s_add_u32 s57, s57, 12288
    buffer_load_dwordx4 v16, s[68:71], s57 offen offset:0 lds
    buffer_load_dwordx4 v17, s[68:71], s57 offen offset:1024 lds
    buffer_load_dwordx4 v18, s[68:71], s57 offen offset:2048 lds
    s_mov_b32 m0, 135168
    s_add_u32 s57, s57, 12288
    buffer_load_dwordx4 v16, s[68:71], s57 offen offset:0 lds
    buffer_load_dwordx4 v17, s[68:71], s57 offen offset:1024 lds
    buffer_load_dwordx4 v18, s[68:71], s57 offen offset:2048 lds
    s_mov_b32 m0, 138240
    s_add_u32 s57, s57, 12288
    buffer_load_dwordx4 v16, s[68:71], s57 offen offset:0 lds
    buffer_load_dwordx4 v17, s[68:71], s57 offen offset:1024 lds
    buffer_load_dwordx4 v18, s[68:71], s57 offen offset:2048 lds
    v_bfe_u32 v1, v0, 2, 2
    v_and_b32 v2, 3, v0
    v_lshl_add_u32 v1, v1, 3, v2
    v_mul_u32_u24 v1, 384, v1
    v_and_b32 v2, 48, v0
    v_add_u32 v20, v1, v2
    s_mul_i32 s58, s63, 12288
    buffer_load_dwordx4 v[184:187], v20, s[64:67], s58 offen offset:0
    buffer_load_dwordx4 v[188:191], v20, s[64:67], s58 offen offset:64
    buffer_load_dwordx4 v[192:195], v20, s[64:67], s58 offen offset:128
    buffer_load_dwordx4 v[196:199], v20, s[64:67], s58 offen offset:192
    buffer_load_dwordx4 v[200:203], v20, s[64:67], s58 offen offset:256
    buffer_load_dwordx4 v[204:207], v20, s[64:67], s58 offen offset:320
    buffer_load_dwordx4 v[208:211], v20, s[64:67], s58 offen offset:1536
    buffer_load_dwordx4 v[212:215], v20, s[64:67], s58 offen offset:1600
    buffer_load_dwordx4 v[216:219], v20, s[64:67], s58 offen offset:1664
    buffer_load_dwordx4 v[220:223], v20, s[64:67], s58 offen offset:1728
    buffer_load_dwordx4 v[224:227], v20, s[64:67], s58 offen offset:1792
    buffer_load_dwordx4 v[228:231], v20, s[64:67], s58 offen offset:1856
    v_lshrrev_b32 v1, 4, v0
    v_bfe_u32 v2, v0, 2, 2
    v_lshl_add_u32 v1, v1, 3, v2
    v_mul_u32_u24 v1, 96, v1
    v_and_b32 v2, 3, v0
    v_mul_u32_u24 v2, 24, v2
    v_add_u32 v1, v1, v2
    v_add_u32 v21, 122880, v1
    s_waitcnt vmcnt(12)
    ds_read_b64_tr_b16 v[76:77], v21 offset:0
    ds_read_b64_tr_b16 v[78:79], v21 offset:384
    ds_read_b64_tr_b16 v[80:81], v21 offset:3072
    ds_read_b64_tr_b16 v[82:83], v21 offset:3456
    ds_read_b64_tr_b16 v[84:85], v21 offset:6144
    ds_read_b64_tr_b16 v[86:87], v21 offset:6528
    ds_read_b64_tr_b16 v[88:89], v21 offset:9216
    ds_read_b64_tr_b16 v[90:91], v21 offset:9600
    ds_read_b64_tr_b16 v[92:93], v21 offset:12288
    ds_read_b64_tr_b16 v[94:95], v21 offset:12672
    ds_read_b64_tr_b16 v[96:97], v21 offset:15360
    ds_read_b64_tr_b16 v[98:99], v21 offset:15744
    ds_read_b64_tr_b16 v[100:101], v21 offset:8
    ds_read_b64_tr_b16 v[102:103], v21 offset:392
    ds_read_b64_tr_b16 v[104:105], v21 offset:3080
    ds_read_b64_tr_b16 v[106:107], v21 offset:3464
    ds_read_b64_tr_b16 v[108:109], v21 offset:6152
    ds_read_b64_tr_b16 v[110:111], v21 offset:6536
    ds_read_b64_tr_b16 v[112:113], v21 offset:9224
    ds_read_b64_tr_b16 v[114:115], v21 offset:9608
    ds_read_b64_tr_b16 v[116:117], v21 offset:12296
    ds_read_b64_tr_b16 v[118:119], v21 offset:12680
    ds_read_b64_tr_b16 v[120:121], v21 offset:15368
    ds_read_b64_tr_b16 v[122:123], v21 offset:15752
    ds_read_b64_tr_b16 v[124:125], v21 offset:16
    ds_read_b64_tr_b16 v[126:127], v21 offset:400
    ds_read_b64_tr_b16 v[128:129], v21 offset:3088
    ds_read_b64_tr_b16 v[130:131], v21 offset:3472
    ds_read_b64_tr_b16 v[132:133], v21 offset:6160
    ds_read_b64_tr_b16 v[134:135], v21 offset:6544
    ds_read_b64_tr_b16 v[136:137], v21 offset:9232
    ds_read_b64_tr_b16 v[138:139], v21 offset:9616
    ds_read_b64_tr_b16 v[140:141], v21 offset:12304
    ds_read_b64_tr_b16 v[142:143], v21 offset:12688
    ds_read_b64_tr_b16 v[144:145], v21 offset:15376
    ds_read_b64_tr_b16 v[146:147], v21 offset:15760
    s_waitcnt vmcnt(0)
    s_waitcnt lgkmcnt(15)
    v_mfma_f32_16x16x32_bf16 v[160:163], v[184:187], v[76:79], 0
    v_mfma_f32_16x16x32_bf16 v[164:167], v[208:211], v[76:79], 0
    v_mfma_f32_16x16x32_bf16 v[160:163], v[188:191], v[80:83], v[160:163]
    v_mfma_f32_16x16x32_bf16 v[164:167], v[212:215], v[80:83], v[164:167]
    v_mfma_f32_16x16x32_bf16 v[160:163], v[192:195], v[84:87], v[160:163]
    v_mfma_f32_16x16x32_bf16 v[164:167], v[216:219], v[84:87], v[164:167]
    v_mfma_f32_16x16x32_bf16 v[160:163], v[196:199], v[88:91], v[160:163]
    v_mfma_f32_16x16x32_bf16 v[164:167], v[220:223], v[88:91], v[164:167]
    v_mfma_f32_16x16x32_bf16 v[160:163], v[200:203], v[92:95], v[160:163]
    v_mfma_f32_16x16x32_bf16 v[164:167], v[224:227], v[92:95], v[164:167]
    v_mfma_f32_16x16x32_bf16 v[160:163], v[204:207], v[96:99], v[160:163]
    v_mfma_f32_16x16x32_bf16 v[164:167], v[228:231], v[96:99], v[164:167]
    v_mfma_f32_16x16x32_bf16 v[168:171], v[184:187], v[100:103], 0
    v_mfma_f32_16x16x32_bf16 v[172:175], v[208:211], v[100:103], 0
    v_mfma_f32_16x16x32_bf16 v[168:171], v[188:191], v[104:107], v[168:171]
    v_mfma_f32_16x16x32_bf16 v[172:175], v[212:215], v[104:107], v[172:175]
    v_mfma_f32_16x16x32_bf16 v[168:171], v[192:195], v[108:111], v[168:171]
    v_mfma_f32_16x16x32_bf16 v[172:175], v[216:219], v[108:111], v[172:175]
    v_mfma_f32_16x16x32_bf16 v[168:171], v[196:199], v[112:115], v[168:171]
    v_mfma_f32_16x16x32_bf16 v[172:175], v[220:223], v[112:115], v[172:175]
    s_waitcnt lgkmcnt(14)
    v_mfma_f32_16x16x32_bf16 v[168:171], v[200:203], v[116:119], v[168:171]
    v_mfma_f32_16x16x32_bf16 v[172:175], v[224:227], v[116:119], v[172:175]
    s_waitcnt lgkmcnt(12)
    v_mfma_f32_16x16x32_bf16 v[168:171], v[204:207], v[120:123], v[168:171]
    v_mfma_f32_16x16x32_bf16 v[172:175], v[228:231], v[120:123], v[172:175]
    s_waitcnt lgkmcnt(10)
    v_mfma_f32_16x16x32_bf16 v[176:179], v[184:187], v[124:127], 0
    v_mfma_f32_16x16x32_bf16 v[180:183], v[208:211], v[124:127], 0
    s_waitcnt lgkmcnt(8)
    v_mfma_f32_16x16x32_bf16 v[176:179], v[188:191], v[128:131], v[176:179]
    v_mfma_f32_16x16x32_bf16 v[180:183], v[212:215], v[128:131], v[180:183]
    s_waitcnt lgkmcnt(6)
    v_mfma_f32_16x16x32_bf16 v[176:179], v[192:195], v[132:135], v[176:179]
    v_mfma_f32_16x16x32_bf16 v[180:183], v[216:219], v[132:135], v[180:183]
    s_waitcnt lgkmcnt(4)
    v_mfma_f32_16x16x32_bf16 v[176:179], v[196:199], v[136:139], v[176:179]
    v_mfma_f32_16x16x32_bf16 v[180:183], v[220:223], v[136:139], v[180:183]
    s_waitcnt lgkmcnt(2)
    v_mfma_f32_16x16x32_bf16 v[176:179], v[200:203], v[140:143], v[176:179]
    v_mfma_f32_16x16x32_bf16 v[180:183], v[224:227], v[140:143], v[180:183]
    s_waitcnt lgkmcnt(0)
    v_mfma_f32_16x16x32_bf16 v[176:179], v[204:207], v[144:147], v[176:179]
    v_mfma_f32_16x16x32_bf16 v[180:183], v[228:231], v[144:147], v[180:183]
    s_mul_i32 s56, s62, 18432
    s_lshl_b32 s57, s63, 10
    s_add_u32 s56, s56, s57
    s_add_u32 s56, s56, 8192
    v_cvt_pk_bf16_f32 v184, v160, v161
    v_cvt_pk_bf16_f32 v185, v162, v163
    v_cvt_pk_bf16_f32 v186, v164, v165
    v_cvt_pk_bf16_f32 v187, v166, v167
    buffer_store_dwordx4 v[184:187], v65, s[32:35], s56 offen
    s_add_u32 s56, s56, 6144
    v_cvt_pk_bf16_f32 v188, v168, v169
    v_cvt_pk_bf16_f32 v189, v170, v171
    v_cvt_pk_bf16_f32 v190, v172, v173
    v_cvt_pk_bf16_f32 v191, v174, v175
    buffer_store_dwordx4 v[188:191], v65, s[32:35], s56 offen
    s_add_u32 s56, s56, 6144
    v_cvt_pk_bf16_f32 v192, v176, v177
    v_cvt_pk_bf16_f32 v193, v178, v179
    v_cvt_pk_bf16_f32 v194, v180, v181
    v_cvt_pk_bf16_f32 v195, v182, v183
    buffer_store_dwordx4 v[192:195], v65, s[32:35], s56 offen
    s_endpgm
L_prep_qk:
    s_mov_b32 s64, s10
    s_mov_b32 s65, s11
    s_mov_b32 s66, 73728
    s_mov_b32 s67, 0x20000
    s_mov_b32 s68, s12
    s_mov_b32 s69, s13
    s_mov_b32 s70, 73728
    s_mov_b32 s71, 0x20000
    s_mov_b32 s72, s4
    s_mov_b32 s73, s5
    s_mov_b32 s74, 6144
    s_mov_b32 s75, 0x20000
    v_lshrrev_b32 v1, 2, v0
    v_and_b32 v1, 14, v1
    s_mov_b32 s56, 0x5000
    v_bfe_u32 v2, s56, v1, 2
    v_lshlrev_b32 v2, 5, v2
    v_xor_b32 v16, v65, v2
    s_mov_b32 s56, 0xaa55
    v_bfe_u32 v2, s56, v1, 2
    v_lshlrev_b32 v2, 5, v2
    v_xor_b32 v17, v65, v2
    s_mov_b32 s56, 0xfffa
    v_bfe_u32 v2, s56, v1, 2
    v_lshlrev_b32 v2, 5, v2
    v_xor_b32 v18, v65, v2
    v_xor_b32 v19, 16, v16
    v_xor_b32 v20, 0x1010, v17
    v_xor_b32 v21, 0x1010, v18
    s_mul_i32 s57, s3, 18432
    s_add_u32 m0, s57, 73728
    s_nop 0
    buffer_load_dwordx4 v16, s[64:67], s57 offen offset:0 lds
    buffer_load_dwordx4 v17, s[64:67], s57 offen offset:1024 lds
    buffer_load_dwordx4 v18, s[64:67], s57 offen offset:2048 lds
    buffer_load_dwordx4 v19, s[64:67], s57 offen offset:3072 lds
    s_add_u32 m0, s57, 77824
    s_nop 0
    buffer_load_dwordx4 v20, s[64:67], s57 offen offset:0 lds
    buffer_load_dwordx4 v21, s[64:67], s57 offen offset:1024 lds
    s_add_u32 s57, s57, 6144
    s_add_u32 m0, s57, 73728
    s_nop 0
    buffer_load_dwordx4 v16, s[64:67], s57 offen offset:0 lds
    buffer_load_dwordx4 v17, s[64:67], s57 offen offset:1024 lds
    buffer_load_dwordx4 v18, s[64:67], s57 offen offset:2048 lds
    buffer_load_dwordx4 v19, s[64:67], s57 offen offset:3072 lds
    s_add_u32 m0, s57, 77824
    s_nop 0
    buffer_load_dwordx4 v20, s[64:67], s57 offen offset:0 lds
    buffer_load_dwordx4 v21, s[64:67], s57 offen offset:1024 lds
    s_add_u32 s57, s57, 6144
    s_add_u32 m0, s57, 73728
    s_nop 0
    buffer_load_dwordx4 v16, s[64:67], s57 offen offset:0 lds
    buffer_load_dwordx4 v17, s[64:67], s57 offen offset:1024 lds
    buffer_load_dwordx4 v18, s[64:67], s57 offen offset:2048 lds
    buffer_load_dwordx4 v19, s[64:67], s57 offen offset:3072 lds
    s_add_u32 m0, s57, 77824
    s_nop 0
    buffer_load_dwordx4 v20, s[64:67], s57 offen offset:0 lds
    buffer_load_dwordx4 v21, s[64:67], s57 offen offset:1024 lds
    v_and_b32 v1, 15, v0
    v_mul_u32_u24 v1, 384, v1
    v_and_b32 v2, 48, v0
    v_add_u32 v44, v1, v2
    buffer_load_dwordx4 v[136:139], v44, s[72:75], 0 offen offset:0
    buffer_load_dwordx4 v[140:143], v44, s[72:75], 0 offen offset:64
    buffer_load_dwordx4 v[144:147], v44, s[72:75], 0 offen offset:128
    buffer_load_dwordx4 v[148:151], v44, s[72:75], 0 offen offset:192
    buffer_load_dwordx4 v[152:155], v44, s[72:75], 0 offen offset:256
    buffer_load_dwordx4 v[156:159], v44, s[72:75], 0 offen offset:320
    s_mul_i32 s57, s3, 18432
    buffer_load_dwordx4 a[76:79], v44, s[68:71], s57 offen offset:0
    buffer_load_dwordx4 a[80:83], v44, s[68:71], s57 offen offset:64
    buffer_load_dwordx4 a[84:87], v44, s[68:71], s57 offen offset:128
    buffer_load_dwordx4 a[88:91], v44, s[68:71], s57 offen offset:192
    buffer_load_dwordx4 a[92:95], v44, s[68:71], s57 offen offset:256
    buffer_load_dwordx4 a[96:99], v44, s[68:71], s57 offen offset:320
    s_add_u32 s57, s57, 6144
    buffer_load_dwordx4 a[100:103], v44, s[68:71], s57 offen offset:0
    buffer_load_dwordx4 a[104:107], v44, s[68:71], s57 offen offset:64
    buffer_load_dwordx4 a[108:111], v44, s[68:71], s57 offen offset:128
    buffer_load_dwordx4 a[112:115], v44, s[68:71], s57 offen offset:192
    buffer_load_dwordx4 a[116:119], v44, s[68:71], s57 offen offset:256
    buffer_load_dwordx4 a[120:123], v44, s[68:71], s57 offen offset:320
    s_add_u32 s57, s57, 6144
    buffer_load_dwordx4 a[124:127], v44, s[68:71], s57 offen offset:0
    buffer_load_dwordx4 a[128:131], v44, s[68:71], s57 offen offset:64
    buffer_load_dwordx4 a[132:135], v44, s[68:71], s57 offen offset:128
    buffer_load_dwordx4 a[136:139], v44, s[68:71], s57 offen offset:192
    buffer_load_dwordx4 a[140:143], v44, s[68:71], s57 offen offset:256
    buffer_load_dwordx4 a[144:147], v44, s[68:71], s57 offen offset:320
    v_mov_b32 v52, 0x3f803f80
    v_mov_b32 v56, 0x3ebcbe62
    s_mov_b32 s44, 0x100001
    s_mov_b32 s45, 0x10000100
    v_mov_b32 v53, 0x3f803f80
    v_mov_b32 v57, 0x3ebcbe62
    s_mov_b32 s46, 0x200002
    s_mov_b32 s47, 0x20000200
    v_mov_b32 v54, 0x3f803f80
    v_mov_b32 v58, 0x3ebcbe62
    s_mov_b32 s48, 0x400004
    s_mov_b32 s49, 0x40000400
    v_mov_b32 v55, 0x3f803f80
    v_mov_b32 v59, 0x3ebcbe62
    s_mov_b32 s50, 0x800008
    s_mov_b32 s51, 0x80000800
    v_mov_b32 v60, 0x43400000
    v_lshrrev_b32 v1, 5, v0
    v_lshlrev_b32 v1, 8, v1
    v_and_b32 v2, 15, v0
    v_lshl_add_u32 v1, v2, 4, v1
    v_bfe_u32 v2, v0, 4, 1
    v_lshl_add_u32 v1, v2, 3, v1
    s_mul_i32 s56, s3, 1536
    s_add_u32 s56, s56, 147456
    v_add_u32 v40, s56, v1
    v_lshrrev_b32 v1, 4, v0
    v_bfe_u32 v2, v0, 2, 2
    v_lshl_add_u32 v3, v1, 3, v2
    v_mul_u32_u24 v3, 384, v3
    v_and_b32 v4, 1, v0
    v_lshl_add_u32 v3, v4, 3, v3
    v_add_u32 v3, 73728, v3
    v_and_b32 v2, 2, v2
    v_and_or_b32 v2, v1, 1, v2
    v_bfe_u32 v4, v0, 1, 1
    v_xor_b32 v2, v2, v4
    s_mul_i32 s56, s3, 6
    s_add_u32 s57, s56, 0
    v_xor_b32 v4, s57, v2
    v_lshl_add_u32 v46, v4, 4, v3
    v_xor_b32 v47, 64, v46
    s_add_u32 s57, s56, 2
    v_xor_b32 v4, s57, v2
    v_lshl_add_u32 v48, v4, 4, v3
    v_xor_b32 v49, 64, v48
    s_add_u32 s57, s56, 4
    v_xor_b32 v4, s57, v2
    v_lshl_add_u32 v50, v4, 4, v3
    v_xor_b32 v51, 64, v50
    s_waitcnt vmcnt(18)
    v_mfma_f32_16x16x32_bf16 v[88:91], v[136:139], v[136:139], 0
    v_mfma_f32_16x16x32_bf16 v[92:95], v[52:55], v[136:139], 0
    v_mfma_f32_16x16x32_bf16 v[88:91], v[140:143], v[140:143], v[88:91]
    v_mfma_f32_16x16x32_bf16 v[92:95], v[52:55], v[140:143], v[92:95]
    v_mfma_f32_16x16x32_bf16 v[88:91], v[144:147], v[144:147], v[88:91]
    v_mfma_f32_16x16x32_bf16 v[92:95], v[52:55], v[144:147], v[92:95]
    v_mfma_f32_16x16x32_bf16 v[88:91], v[148:151], v[148:151], v[88:91]
    v_mfma_f32_16x16x32_bf16 v[92:95], v[52:55], v[148:151], v[92:95]
    v_mfma_f32_16x16x32_bf16 v[88:91], v[152:155], v[152:155], v[88:91]
    v_mfma_f32_16x16x32_bf16 v[92:95], v[52:55], v[152:155], v[92:95]
    v_mfma_f32_16x16x32_bf16 v[88:91], v[156:159], v[156:159], v[88:91]
    v_mfma_f32_16x16x32_bf16 v[92:95], v[52:55], v[156:159], v[92:95]
    s_barrier
    ds_read_b64_tr_b16 v[160:161], v46 offset:0
    ds_read_b64_tr_b16 v[162:163], v47 offset:1536
    ds_read_b64_tr_b16 v[164:165], v46 offset:12288
    ds_read_b64_tr_b16 v[166:167], v47 offset:13824
    ds_read_b64_tr_b16 v[168:169], v46 offset:24576
    ds_read_b64_tr_b16 v[170:171], v47 offset:26112
    ds_read_b64_tr_b16 v[172:173], v46 offset:36864
    ds_read_b64_tr_b16 v[174:175], v47 offset:38400
    ds_read_b64_tr_b16 v[176:177], v46 offset:49152
    ds_read_b64_tr_b16 v[178:179], v47 offset:50688
    ds_read_b64_tr_b16 v[180:181], v46 offset:61440
    ds_read_b64_tr_b16 v[182:183], v47 offset:62976
    ds_read_b64_tr_b16 v[184:185], v48 offset:0
    ds_read_b64_tr_b16 v[186:187], v49 offset:1536
    ds_read_b64_tr_b16 v[188:189], v48 offset:12288
    ds_read_b64_tr_b16 v[190:191], v49 offset:13824
    ds_read_b64_tr_b16 v[192:193], v48 offset:24576
    ds_read_b64_tr_b16 v[194:195], v49 offset:26112
    ds_read_b64_tr_b16 v[196:197], v48 offset:36864
    ds_read_b64_tr_b16 v[198:199], v49 offset:38400
    ds_read_b64_tr_b16 v[200:201], v48 offset:49152
    ds_read_b64_tr_b16 v[202:203], v49 offset:50688
    ds_read_b64_tr_b16 v[204:205], v48 offset:61440
    ds_read_b64_tr_b16 v[206:207], v49 offset:62976
    ds_read_b64_tr_b16 v[208:209], v50 offset:0
    ds_read_b64_tr_b16 v[210:211], v51 offset:1536
    ds_read_b64_tr_b16 v[212:213], v50 offset:12288
    ds_read_b64_tr_b16 v[214:215], v51 offset:13824
    ds_read_b64_tr_b16 v[216:217], v50 offset:24576
    ds_read_b64_tr_b16 v[218:219], v51 offset:26112
    ds_read_b64_tr_b16 v[220:221], v50 offset:36864
    ds_read_b64_tr_b16 v[222:223], v51 offset:38400
    ds_read_b64_tr_b16 v[224:225], v50 offset:49152
    ds_read_b64_tr_b16 v[226:227], v51 offset:50688
    ds_read_b64_tr_b16 v[228:229], v50 offset:61440
    ds_read_b64_tr_b16 v[230:231], v51 offset:62976
    v_cndmask_b32 v3, 0, v88, s[44:45]
    v_cndmask_b32 v3, v3, v89, s[46:47]
    v_cndmask_b32 v3, v3, v90, s[48:49]
    v_cndmask_b32 v3, v3, v91, s[50:51]
    s_nop 1
    v_mfma_f32_16x16x4_f32 v[96:99], v60, v3, v[56:59]
    s_waitcnt lgkmcnt(15)
    v_mfma_f32_16x16x32_bf16 v[16:19], v[160:163], v[136:139], 0
    v_mfma_f32_16x16x32_bf16 v[28:31], v[160:163], v[52:55], 0
    v_mfma_f32_16x16x32_bf16 v[16:19], v[164:167], v[140:143], v[16:19]
    v_mfma_f32_16x16x32_bf16 v[28:31], v[164:167], v[52:55], v[28:31]
    v_mfma_f32_16x16x32_bf16 v[16:19], v[168:171], v[144:147], v[16:19]
    v_mfma_f32_16x16x32_bf16 v[28:31], v[168:171], v[52:55], v[28:31]
    v_mfma_f32_16x16x32_bf16 v[16:19], v[172:175], v[148:151], v[16:19]
    v_mfma_f32_16x16x32_bf16 v[28:31], v[172:175], v[52:55], v[28:31]
    v_mfma_f32_16x16x32_bf16 v[16:19], v[176:179], v[152:155], v[16:19]
    v_mfma_f32_16x16x32_bf16 v[28:31], v[176:179], v[52:55], v[28:31]
    v_mfma_f32_16x16x32_bf16 v[16:19], v[180:183], v[156:159], v[16:19]
    v_mfma_f32_16x16x32_bf16 v[28:31], v[180:183], v[52:55], v[28:31]
    v_mfma_f32_16x16x32_bf16 v[20:23], v[184:187], v[136:139], 0
    v_mfma_f32_16x16x32_bf16 v[32:35], v[184:187], v[52:55], 0
    v_mfma_f32_16x16x32_bf16 v[20:23], v[188:191], v[140:143], v[20:23]
    v_mfma_f32_16x16x32_bf16 v[32:35], v[188:191], v[52:55], v[32:35]
    v_mfma_f32_16x16x32_bf16 v[20:23], v[192:195], v[144:147], v[20:23]
    v_mfma_f32_16x16x32_bf16 v[32:35], v[192:195], v[52:55], v[32:35]
    v_mfma_f32_16x16x32_bf16 v[20:23], v[196:199], v[148:151], v[20:23]
    v_mfma_f32_16x16x32_bf16 v[32:35], v[196:199], v[52:55], v[32:35]
    s_waitcnt lgkmcnt(14)
    v_mfma_f32_16x16x32_bf16 v[20:23], v[200:203], v[152:155], v[20:23]
    v_mfma_f32_16x16x32_bf16 v[32:35], v[200:203], v[52:55], v[32:35]
    s_waitcnt lgkmcnt(12)
    v_mfma_f32_16x16x32_bf16 v[20:23], v[204:207], v[156:159], v[20:23]
    v_mfma_f32_16x16x32_bf16 v[32:35], v[204:207], v[52:55], v[32:35]
    s_waitcnt lgkmcnt(10)
    v_mfma_f32_16x16x32_bf16 v[24:27], v[208:211], v[136:139], 0
    v_mfma_f32_16x16x32_bf16 v[36:39], v[208:211], v[52:55], 0
    s_waitcnt lgkmcnt(8)
    v_mfma_f32_16x16x32_bf16 v[24:27], v[212:215], v[140:143], v[24:27]
    v_mfma_f32_16x16x32_bf16 v[36:39], v[212:215], v[52:55], v[36:39]
    s_waitcnt lgkmcnt(6)
    v_mfma_f32_16x16x32_bf16 v[24:27], v[216:219], v[144:147], v[24:27]
    v_mfma_f32_16x16x32_bf16 v[36:39], v[216:219], v[52:55], v[36:39]
    s_waitcnt lgkmcnt(4)
    v_mfma_f32_16x16x32_bf16 v[24:27], v[220:223], v[148:151], v[24:27]
    v_mfma_f32_16x16x32_bf16 v[36:39], v[220:223], v[52:55], v[36:39]
    s_waitcnt lgkmcnt(2)
    v_mfma_f32_16x16x32_bf16 v[24:27], v[224:227], v[152:155], v[24:27]
    v_mfma_f32_16x16x32_bf16 v[36:39], v[224:227], v[52:55], v[36:39]
    s_waitcnt lgkmcnt(0)
    v_mfma_f32_16x16x32_bf16 v[24:27], v[228:231], v[156:159], v[24:27]
    v_mfma_f32_16x16x32_bf16 v[36:39], v[228:231], v[52:55], v[36:39]
    v_fma_f32 v5, -v92, v92, v96
    v_max_f32 v5, v5, v56
    v_rsq_f32 v5, v5
    v_mul_f32 v6, 0x3baaaaab, v92
    v_mul_f32 v5, v60, v5
    v_fma_f32 v16, -v6, v28, v16
    v_fma_f32 v17, -v6, v29, v17
    v_fma_f32 v18, -v6, v30, v18
    v_fma_f32 v19, -v6, v31, v19
    v_fma_f32 v20, -v6, v32, v20
    v_fma_f32 v21, -v6, v33, v21
    v_fma_f32 v22, -v6, v34, v22
    v_fma_f32 v23, -v6, v35, v23
    v_fma_f32 v24, -v6, v36, v24
    v_fma_f32 v25, -v6, v37, v25
    v_fma_f32 v26, -v6, v38, v26
    v_fma_f32 v27, -v6, v39, v27
    v_mul_f32 v16, v16, v5
    v_mul_f32 v17, v17, v5
    v_mul_f32 v18, v18, v5
    v_mul_f32 v19, v19, v5
    v_mul_f32 v20, v20, v5
    v_mul_f32 v21, v21, v5
    v_mul_f32 v22, v22, v5
    v_mul_f32 v23, v23, v5
    v_mul_f32 v24, v24, v5
    v_mul_f32 v25, v25, v5
    v_mul_f32 v26, v26, v5
    v_mul_f32 v27, v27, v5
    v_cvt_pk_bf16_f32 v28, v16, v17
    v_cvt_pk_bf16_f32 v29, v18, v19
    ds_write_b64 v40, v[28:29] offset:0
    v_cvt_pk_bf16_f32 v30, v20, v21
    v_cvt_pk_bf16_f32 v31, v22, v23
    ds_write_b64 v40, v[30:31] offset:512
    v_cvt_pk_bf16_f32 v32, v24, v25
    v_cvt_pk_bf16_f32 v33, v26, v27
    ds_write_b64 v40, v[32:33] offset:1024
    v_add_u32 v7, 147456, v65
    s_waitcnt lgkmcnt(0)
    s_barrier
    ds_read_b128 v[136:139], v7 offset:0
    ds_read_b128 v[140:143], v7 offset:1024
    ds_read_b128 v[144:147], v7 offset:2048
    ds_read_b128 v[148:151], v7 offset:3072
    ds_read_b128 v[152:155], v7 offset:4096
    ds_read_b128 v[156:159], v7 offset:5120
    s_waitcnt vmcnt(0)
    s_waitcnt lgkmcnt(5)
    v_mfma_f32_16x16x32_bf16 v[16:19], a[76:79], v[136:139], 0
    v_mfma_f32_16x16x32_bf16 v[20:23], a[100:103], v[136:139], 0
    v_mfma_f32_16x16x32_bf16 v[24:27], a[124:127], v[136:139], 0
    s_waitcnt lgkmcnt(4)
    v_mfma_f32_16x16x32_bf16 v[16:19], a[80:83], v[140:143], v[16:19]
    v_mfma_f32_16x16x32_bf16 v[20:23], a[104:107], v[140:143], v[20:23]
    v_mfma_f32_16x16x32_bf16 v[24:27], a[128:131], v[140:143], v[24:27]
    s_waitcnt lgkmcnt(3)
    v_mfma_f32_16x16x32_bf16 v[16:19], a[84:87], v[144:147], v[16:19]
    v_mfma_f32_16x16x32_bf16 v[20:23], a[108:111], v[144:147], v[20:23]
    v_mfma_f32_16x16x32_bf16 v[24:27], a[132:135], v[144:147], v[24:27]
    s_waitcnt lgkmcnt(2)
    v_mfma_f32_16x16x32_bf16 v[16:19], a[88:91], v[148:151], v[16:19]
    v_mfma_f32_16x16x32_bf16 v[20:23], a[112:115], v[148:151], v[20:23]
    v_mfma_f32_16x16x32_bf16 v[24:27], a[136:139], v[148:151], v[24:27]
    s_waitcnt lgkmcnt(1)
    v_mfma_f32_16x16x32_bf16 v[16:19], a[92:95], v[152:155], v[16:19]
    v_mfma_f32_16x16x32_bf16 v[20:23], a[116:119], v[152:155], v[20:23]
    v_mfma_f32_16x16x32_bf16 v[24:27], a[140:143], v[152:155], v[24:27]
    s_waitcnt lgkmcnt(0)
    v_mfma_f32_16x16x32_bf16 v[16:19], a[96:99], v[156:159], v[16:19]
    v_mfma_f32_16x16x32_bf16 v[20:23], a[120:123], v[156:159], v[20:23]
    v_mfma_f32_16x16x32_bf16 v[24:27], a[144:147], v[156:159], v[24:27]
    s_nop 5
    v_mul_f32 v16, 0x419fecaf, v16
    v_mul_f32 v17, 0x419fecaf, v17
    v_mul_f32 v18, 0x419fecaf, v18
    v_mul_f32 v19, 0x419fecaf, v19
    v_mul_f32 v20, 0x419fecaf, v20
    v_mul_f32 v21, 0x419fecaf, v21
    v_mul_f32 v22, 0x419fecaf, v22
    v_mul_f32 v23, 0x419fecaf, v23
    v_mul_f32 v24, 0x419fecaf, v24
    v_mul_f32 v25, 0x419fecaf, v25
    v_mul_f32 v26, 0x419fecaf, v26
    v_mul_f32 v27, 0x419fecaf, v27
    v_cvt_pk_bf16_f32 v28, v16, v17
    v_cvt_pk_bf16_f32 v29, v18, v19
    ds_write_b64 v40, v[28:29] offset:6144
    v_cvt_pk_bf16_f32 v30, v20, v21
    v_cvt_pk_bf16_f32 v31, v22, v23
    ds_write_b64 v40, v[30:31] offset:6656
    v_cvt_pk_bf16_f32 v32, v24, v25
    v_cvt_pk_bf16_f32 v33, v26, v27
    ds_write_b64 v40, v[32:33] offset:7168
    v_lshrrev_b32 v1, 5, v0
    v_bfe_u32 v2, v0, 4, 1
    v_lshl_or_b32 v1, v2, 1, v1
    v_and_b32 v2, 15, v0
    v_lshlrev_b32 v2, 4, v2
    v_lshl_add_u32 v1, v1, 8, v2
    v_add_u32 v1, 153600, v1
    s_waitcnt lgkmcnt(0)
    s_barrier
    s_cmp_lg_u32 s3, 0
    s_cbranch_scc1 L_prep_end
    ds_read_b128 v[136:139], v1 offset:0
    ds_read_b128 v[140:143], v1 offset:1024
    ds_read_b128 v[144:147], v1 offset:2048
    ds_read_b128 v[148:151], v1 offset:3072
    ds_read_b128 v[152:155], v1 offset:4096
    ds_read_b128 v[156:159], v1 offset:5120
    s_waitcnt lgkmcnt(0)
    s_movk_i32 s56, 0x1000
    buffer_store_dwordx4 v[136:139], v65, s[32:35], 0 offen offset:0
    buffer_store_dwordx4 v[140:143], v65, s[32:35], 0 offen offset:1024
    buffer_store_dwordx4 v[144:147], v65, s[32:35], 0 offen offset:2048
    buffer_store_dwordx4 v[148:151], v65, s[32:35], 0 offen offset:3072
    buffer_store_dwordx4 v[152:155], v65, s[32:35], s56 offen offset:0
    buffer_store_dwordx4 v[156:159], v65, s[32:35], s56 offen offset:1024
L_prep_end:
    s_endpgm
.p2align 8
main_kernel:
    s_cmp_ge_u32 s2, 256
    s_cbranch_scc1 L_main_end
    s_load_dwordx16 s[4:19], s[0:1], 0
    s_load_dwordx4 s[20:23], s[0:1], 64
    s_getpc_b64 s[54:55]
L_pc_main:
    v_lshlrev_b32 v233, 7, v0
    v_min_u32 v233, L_main_codeend - L_pc_main - 4, v233
    global_load_dword v232, v233, s[54:55]
    v_lshrrev_b32 v1, 6, v0
    v_and_b32 v0, 63, v0
    v_readfirstlane_b32 s3, v1
    v_lshlrev_b32 v65, 4, v0
    v_lshrrev_b32 v1, 2, v0
    v_and_b32 v1, 14, v1
    s_mov_b32 s56, 0x5000
    v_bfe_u32 v2, s56, v1, 2
    v_lshlrev_b32 v2, 5, v2
    v_xor_b32 v16, v65, v2
    s_mov_b32 s56, 0xaa55
    v_bfe_u32 v2, s56, v1, 2
    v_lshlrev_b32 v2, 5, v2
    v_xor_b32 v17, v65, v2
    s_mov_b32 s56, 0xfffa
    v_bfe_u32 v2, s56, v1, 2
    v_lshlrev_b32 v2, 5, v2
    v_xor_b32 v18, v65, v2
    v_xor_b32 v19, 16, v16
    v_xor_b32 v20, 0x1010, v17
    v_xor_b32 v21, 0x1010, v18
    v_lshrrev_b32 v1, 3, v0
    v_and_b32 v1, 6, v1
    s_mov_b32 s56, 0x40
    v_bfe_u32 v2, s56, v1, 2
    v_lshlrev_b32 v2, 5, v2
    v_xor_b32 v22, v65, v2
    s_mov_b32 s56, 0xa5
    v_bfe_u32 v2, s56, v1, 2
    v_lshlrev_b32 v2, 5, v2
    v_xor_b32 v23, v65, v2
    s_mov_b32 s56, 0xfe
    v_bfe_u32 v2, s56, v1, 2
    v_lshlrev_b32 v2, 5, v2
    v_xor_b32 v24, v65, v2
    v_xor_b32 v25, 0x80, v22
    v_xor_b32 v26, 0x1080, v23
    v_xor_b32 v27, 0x1080, v24
    v_xor_b32 v28, 0x1010, v22
    v_xor_b32 v29, 0x1010, v23
    v_xor_b32 v30, 0x2010, v24
    v_xor_b32 v31, 0x2090, v22
    v_xor_b32 v32, 0x2090, v23
    v_xor_b32 v33, 0x2090, v24
    s_mul_i32 s36, s3, 6144
    s_mul_i32 s37, s3, 12288
    s_add_u32 s40, s36, 0
    s_add_u32 s41, s37, 24576
    s_add_u32 s42, s37, 73728
    s_mul_i32 s56, s2, 393216
    s_mul_i32 s57, s2, 98304
    s_waitcnt lgkmcnt(0)
    s_add_u32 s28, s8, s57
    s_addc_u32 s29, s9, 0
    s_mov_b32 s30, 98304
    s_mov_b32 s31, 0x20000
    s_add_u32 s24, s6, s56
    s_addc_u32 s25, s7, 0
    s_mov_b32 s26, 393216
    s_mov_b32 s27, 0x20000
    s_mov_b32 s32, s22
    s_mov_b32 s33, s23
    s_mov_b32 s34, 8388608
    s_mov_b32 s35, 0x20000
    s_add_u32 m0, s40, 0
    s_add_u32 s57, s36, 0
    buffer_load_dwordx4 v16, s[28:31], s57 offen offset:0 nt lds
    buffer_load_dwordx4 v17, s[28:31], s57 offen offset:1024 nt lds
    buffer_load_dwordx4 v18, s[28:31], s57 offen offset:2048 nt lds
    buffer_load_dwordx4 v19, s[28:31], s57 offen offset:3072 nt lds
    s_add_u32 m0, s40, 4096
    s_nop 0
    buffer_load_dwordx4 v20, s[28:31], s57 offen offset:0 nt lds
    buffer_load_dwordx4 v21, s[28:31], s57 offen offset:1024 nt lds
    s_movk_i32 s56, 0x1000
    buffer_load_dwordx4 v[136:139], v65, s[32:35], 0 offen offset:0
    buffer_load_dwordx4 v[140:143], v65, s[32:35], 0 offen offset:1024
    buffer_load_dwordx4 v[144:147], v65, s[32:35], 0 offen offset:2048
    buffer_load_dwordx4 v[148:151], v65, s[32:35], 0 offen offset:3072
    buffer_load_dwordx4 v[152:155], v65, s[32:35], s56 offen offset:0
    buffer_load_dwordx4 v[156:159], v65, s[32:35], s56 offen offset:1024
    s_add_u32 m0, s41, 0
    s_add_u32 s58, s37, 0
    buffer_load_dwordx4 v22, s[24:27], s58 offen offset:0 nt lds
    buffer_load_dwordx4 v23, s[24:27], s58 offen offset:1024 nt lds
    buffer_load_dwordx4 v24, s[24:27], s58 offen offset:2048 nt lds
    buffer_load_dwordx4 v25, s[24:27], s58 offen offset:3072 nt lds
    s_add_u32 m0, s41, 4096
    s_nop 0
    buffer_load_dwordx4 v26, s[24:27], s58 offen offset:0 nt lds
    buffer_load_dwordx4 v27, s[24:27], s58 offen offset:1024 nt lds
    buffer_load_dwordx4 v28, s[24:27], s58 offen offset:2048 nt lds
    buffer_load_dwordx4 v29, s[24:27], s58 offen offset:3072 nt lds
    s_add_u32 m0, s41, 8192
    s_nop 0
    buffer_load_dwordx4 v30, s[24:27], s58 offen offset:0 nt lds
    buffer_load_dwordx4 v31, s[24:27], s58 offen offset:1024 nt lds
    buffer_load_dwordx4 v32, s[24:27], s58 offen offset:2048 nt lds
    buffer_load_dwordx4 v33, s[24:27], s58 offen offset:3072 nt lds
    v_and_b32 v1, 15, v0
    v_lshrrev_b32 v2, 4, v0
    v_lshrrev_b32 v6, 1, v2
    v_and_b32 v3, 1, v2
    v_lshl_or_b32 v3, v3, 1, v6
    v_lshrrev_b32 v4, 2, v0
    v_bfe_u32 v5, v0, 1, 1
    v_lshrrev_b32 v6, 3, v1
    v_and_or_b32 v6, v1, 6, v6
    v_xor_b32 v6, v6, v3
    v_mul_u32_u24 v7, 384, v1
    v_lshl_add_u32 v6, v6, 4, v7
    v_add_u32 v34, s40, v6
    v_xor_b32 v35, 64, v34
    v_lshrrev_b32 v6, 3, v1
    v_and_b32 v7, 7, v1
    v_lshl_or_b32 v6, v7, 1, v6
    v_xor_b32 v6, v6, v3
    v_mul_u32_u24 v7, 768, v1
    v_lshl_add_u32 v6, v6, 4, v7
    v_add_u32 v40, s41, v6
    v_xor_b32 v41, 0x40, v40
    v_xor_b32 v42, 0x80, v40
    v_xor_b32 v43, 0xc0, v40
    v_and_b32 v2, 1, v0
    v_lshlrev_b32 v2, 3, v2
    v_lshrrev_b32 v6, 3, v4
    v_and_or_b32 v6, v4, 6, v6
    v_xor_b32 v6, v6, v5
    v_mul_u32_u24 v7, 384, v4
    v_lshl_add_u32 v6, v6, 4, v7
    v_add3_u32 v36, s40, v6, v2
    v_xor_b32 v37, 0x20, v36
    v_xor_b32 v38, 0x40, v36
    v_xor_b32 v39, 0x60, v36
    v_lshrrev_b32 v6, 3, v4
    v_and_b32 v7, 7, v4
    v_lshl_or_b32 v6, v7, 1, v6
    v_xor_b32 v6, v6, v5
    v_mul_u32_u24 v7, 768, v4
    v_lshl_add_u32 v6, v6, 4, v7
    v_add3_u32 v44, s41, v6, v2
    v_xor_b32 v45, 0x20, v44
    v_xor_b32 v46, 0x40, v44
    v_xor_b32 v47, 0x60, v44
    v_xor_b32 v48, 0x80, v44
    v_xor_b32 v49, 0xa0, v44
    v_xor_b32 v50, 0xc0, v44
    v_xor_b32 v51, 0xe0, v44
    v_mov_b32 v52, 0x3f803f80
    v_mov_b32 v56, 0x3ebcbe62
    s_mov_b32 s44, 0x100001
    s_mov_b32 s45, 0x10000100
    v_mov_b32 v53, 0x3f803f80
    v_mov_b32 v57, 0x3ebcbe62
    s_mov_b32 s46, 0x200002
    s_mov_b32 s47, 0x20000200
    v_mov_b32 v54, 0x3f803f80
    v_mov_b32 v58, 0x3ebcbe62
    s_mov_b32 s48, 0x400004
    s_mov_b32 s49, 0x40000400
    v_mov_b32 v55, 0x3f803f80
    v_mov_b32 v59, 0x3ebcbe62
    s_mov_b32 s50, 0x800008
    s_mov_b32 s51, 0x80000800
    v_mov_b32 v60, 0x43400000
    v_lshrrev_b32 v1, 5, v0
    v_lshlrev_b32 v1, 8, v1
    v_and_b32 v2, 15, v0
    v_lshl_add_u32 v1, v2, 4, v1
    v_bfe_u32 v2, v0, 4, 1
    v_lshl_add_u32 v1, v2, 3, v1
    s_mul_i32 s56, s3, 1536
    s_add_u32 s56, s56, 147456
    v_add_u32 v236, s56, v1
    s_mul_i32 s56, s3, 3072
    s_add_u32 s56, s56, 24576
    v_add_u32 v237, s56, v65
    v_add_u32 v238, s41, v65
    s_lshl_b32 s56, s3, 10
    v_add_u32 v240, 159744, v65
    v_add_u32 v239, s56, v240
    v_add_u32 v241, 147456, v65
    v_and_b32 v1, 15, v0
    v_lshlrev_b32 v1, 17, v1
    v_and_b32 v2, 48, v0
    v_add_u32 v242, v1, v2
    s_mov_b32 s52, 0x41c00000
    s_add_u32 m0, s42, 0
    s_add_u32 s59, s37, 196608
    buffer_load_dwordx4 v22, s[24:27], s59 offen offset:0 nt lds
    buffer_load_dwordx4 v23, s[24:27], s59 offen offset:1024 nt lds
    buffer_load_dwordx4 v24, s[24:27], s59 offen offset:2048 nt lds
    buffer_load_dwordx4 v25, s[24:27], s59 offen offset:3072 nt lds
    s_add_u32 m0, s42, 4096
    s_nop 0
    buffer_load_dwordx4 v26, s[24:27], s59 offen offset:0 nt lds
    buffer_load_dwordx4 v27, s[24:27], s59 offen offset:1024 nt lds
    buffer_load_dwordx4 v28, s[24:27], s59 offen offset:2048 nt lds
    buffer_load_dwordx4 v29, s[24:27], s59 offen offset:3072 nt lds
    s_add_u32 m0, s42, 8192
    s_nop 0
    buffer_load_dwordx4 v30, s[24:27], s59 offen offset:0 nt lds
    buffer_load_dwordx4 v31, s[24:27], s59 offen offset:1024 nt lds
    buffer_load_dwordx4 v32, s[24:27], s59 offen offset:2048 nt lds
    buffer_load_dwordx4 v33, s[24:27], s59 offen offset:3072 nt lds
    s_mul_i32 s60, s3, 18432
    s_waitcnt vmcnt(30)
    ds_read_b128 a[48:51], v34 offset:0
    ds_read_b128 a[52:55], v35 offset:0
    ds_read_b128 a[56:59], v34 offset:128
    ds_read_b128 a[60:63], v35 offset:128
    ds_read_b128 a[64:67], v34 offset:256
    ds_read_b128 a[68:71], v35 offset:256
    s_waitcnt lgkmcnt(5)
    v_mfma_f32_16x16x32_bf16 v[84:87], a[48:51], a[48:51], 0
    ds_read_b64_tr_b16 a[72:73], v36 offset:0
    ds_read_b64_tr_b16 a[74:75], v37 offset:0
    v_mfma_f32_16x16x32_bf16 v[80:83], a[48:51], v[52:55], 0
    ds_read_b64_tr_b16 a[76:77], v38 offset:0
    ds_read_b64_tr_b16 a[78:79], v39 offset:0
    s_waitcnt lgkmcnt(8)
    v_mfma_f32_16x16x32_bf16 v[84:87], a[52:55], a[52:55], v[84:87]
    ds_read_b64_tr_b16 a[80:81], v36 offset:128
    ds_read_b64_tr_b16 a[82:83], v37 offset:128
    v_mfma_f32_16x16x32_bf16 v[80:83], a[52:55], v[52:55], v[80:83]
    ds_read_b64_tr_b16 a[84:85], v38 offset:128
    ds_read_b64_tr_b16 a[86:87], v39 offset:128
    s_waitcnt lgkmcnt(11)
    v_mfma_f32_16x16x32_bf16 v[84:87], a[56:59], a[56:59], v[84:87]
    ds_read_b64_tr_b16 a[88:89], v36 offset:256
    ds_read_b64_tr_b16 a[90:91], v37 offset:256
    v_mfma_f32_16x16x32_bf16 v[80:83], a[56:59], v[52:55], v[80:83]
    ds_read_b64_tr_b16 a[92:93], v38 offset:256
    ds_read_b64_tr_b16 a[94:95], v39 offset:256
    s_waitcnt lgkmcnt(14)
    v_mfma_f32_16x16x32_bf16 v[84:87], a[60:63], a[60:63], v[84:87]
    v_mfma_f32_16x16x32_bf16 v[80:83], a[60:63], v[52:55], v[80:83]
    s_waitcnt lgkmcnt(13)
    v_mfma_f32_16x16x32_bf16 v[84:87], a[64:67], a[64:67], v[84:87]
    v_mfma_f32_16x16x32_bf16 v[80:83], a[64:67], v[52:55], v[80:83]
    s_waitcnt lgkmcnt(12)
    v_mfma_f32_16x16x32_bf16 v[84:87], a[68:71], a[68:71], v[84:87]
    v_mfma_f32_16x16x32_bf16 v[80:83], a[68:71], v[52:55], v[80:83]
    s_waitcnt lgkmcnt(0)
    s_add_u32 m0, s40, 0
    s_add_u32 s57, s36, 24576
    buffer_load_dwordx4 v16, s[28:31], s57 offen offset:0 nt lds
    buffer_load_dwordx4 v17, s[28:31], s57 offen offset:1024 nt lds
    buffer_load_dwordx4 v18, s[28:31], s57 offen offset:2048 nt lds
    buffer_load_dwordx4 v19, s[28:31], s57 offen offset:3072 nt lds
    s_add_u32 m0, s40, 4096
    s_nop 0
    buffer_load_dwordx4 v20, s[28:31], s57 offen offset:0 nt lds
    buffer_load_dwordx4 v21, s[28:31], s57 offen offset:1024 nt lds
    s_waitcnt vmcnt(30)
    v_mfma_f32_16x16x32_bf16 v[120:123], v[52:55], v[136:139], 0
    v_mfma_f32_16x16x32_bf16 v[120:123], v[52:55], v[140:143], v[120:123]
    v_mfma_f32_16x16x32_bf16 v[120:123], v[52:55], v[144:147], v[120:123]
    v_mfma_f32_16x16x32_bf16 v[120:123], v[52:55], v[148:151], v[120:123]
    v_mfma_f32_16x16x32_bf16 v[120:123], v[52:55], v[152:155], v[120:123]
    v_mfma_f32_16x16x32_bf16 v[120:123], v[52:55], v[156:159], v[120:123]
    s_nop 7
    v_mul_f32 v61, 0x3baaaaab, v120
    v_mfma_f32_16x16x32_bf16 v[76:79], a[48:51], v[136:139], 0
    v_mfma_f32_16x16x32_bf16 v[76:79], a[52:55], v[140:143], v[76:79]
    v_mfma_f32_16x16x32_bf16 v[76:79], a[56:59], v[144:147], v[76:79]
    v_mfma_f32_16x16x32_bf16 v[76:79], a[60:63], v[148:151], v[76:79]
    v_mfma_f32_16x16x32_bf16 v[76:79], a[64:67], v[152:155], v[76:79]
    v_mfma_f32_16x16x32_bf16 v[76:79], a[68:71], v[156:159], v[76:79]
    s_waitcnt vmcnt(18)
    ds_read_b128 a[96:99], v40 offset:0
    ds_read_b128 a[100:103], v41 offset:0
    ds_read_b128 a[104:107], v42 offset:0
    ds_read_b128 a[108:111], v43 offset:0
    ds_read_b128 a[112:115], v40 offset:256
    ds_read_b128 a[116:119], v41 offset:256
    ds_read_b128 a[120:123], v42 offset:256
    ds_read_b128 a[124:127], v43 offset:256
    ds_read_b128 a[128:131], v40 offset:512
    ds_read_b128 a[132:135], v41 offset:512
    ds_read_b128 a[136:139], v42 offset:512
    ds_read_b128 a[140:143], v43 offset:512
    s_waitcnt lgkmcnt(11)
    v_mfma_f32_16x16x32_bf16 v[96:99], a[96:99], a[96:99], v[84:87]
    ds_read_b64_tr_b16 a[144:145], v44 offset:0
    ds_read_b64_tr_b16 a[146:147], v48 offset:256
    v_mfma_f32_16x16x32_bf16 v[100:103], a[96:99], a[48:51], 0
    ds_read_b64_tr_b16 a[148:149], v45 offset:0
    ds_read_b64_tr_b16 a[150:151], v49 offset:256
    s_waitcnt lgkmcnt(14)
    v_mfma_f32_16x16x32_bf16 v[96:99], a[100:103], a[100:103], v[96:99]
    ds_read_b64_tr_b16 a[152:153], v46 offset:0
    ds_read_b64_tr_b16 a[154:155], v50 offset:256
    v_mfma_f32_16x16x32_bf16 v[100:103], a[100:103], a[52:55], v[100:103]
    ds_read_b64_tr_b16 a[156:157], v47 offset:0
    ds_read_b64_tr_b16 a[158:159], v51 offset:256
    s_waitcnt lgkmcnt(15)
    v_mfma_f32_16x16x32_bf16 v[96:99], a[104:107], a[104:107], v[96:99]
    ds_read_b64_tr_b16 a[160:161], v48 offset:0
    ds_read_b64_tr_b16 a[162:163], v44 offset:512
    v_mfma_f32_16x16x32_bf16 v[100:103], a[104:107], a[56:59], v[100:103]
    ds_read_b64_tr_b16 a[164:165], v49 offset:0
    ds_read_b64_tr_b16 a[166:167], v45 offset:512
    v_mfma_f32_16x16x32_bf16 v[96:99], a[108:111], a[108:111], v[96:99]
    ds_read_b64_tr_b16 a[168:169], v50 offset:0
    ds_read_b64_tr_b16 a[170:171], v46 offset:512
    v_mfma_f32_16x16x32_bf16 v[100:103], a[108:111], a[60:63], v[100:103]
    ds_read_b64_tr_b16 a[172:173], v51 offset:0
    ds_read_b64_tr_b16 a[174:175], v47 offset:512
    v_mfma_f32_16x16x32_bf16 v[96:99], a[112:115], a[112:115], v[96:99]
    ds_read_b64_tr_b16 a[176:177], v44 offset:256
    ds_read_b64_tr_b16 a[178:179], v48 offset:512
    v_mfma_f32_16x16x32_bf16 v[100:103], a[112:115], a[64:67], v[100:103]
    ds_read_b64_tr_b16 a[180:181], v45 offset:256
    ds_read_b64_tr_b16 a[182:183], v49 offset:512
    s_waitcnt lgkmcnt(15)
    v_mfma_f32_16x16x32_bf16 v[96:99], a[116:119], a[116:119], v[96:99]
    ds_read_b64_tr_b16 a[184:185], v46 offset:256
    ds_read_b64_tr_b16 a[186:187], v50 offset:512
    v_mfma_f32_16x16x32_bf16 v[100:103], a[116:119], a[68:71], v[100:103]
    ds_read_b64_tr_b16 a[188:189], v47 offset:256
    ds_read_b64_tr_b16 a[190:191], v51 offset:512
    v_mfma_f32_16x16x32_bf16 v[92:95], a[96:99], v[52:55], v[80:83]
    v_mfma_f32_16x16x32_bf16 v[92:95], a[100:103], v[52:55], v[92:95]
    v_mfma_f32_16x16x32_bf16 v[92:95], a[104:107], v[52:55], v[92:95]
    v_mfma_f32_16x16x32_bf16 v[92:95], a[108:111], v[52:55], v[92:95]
    s_nop 1
    v_fma_f32 v96, v100, 2.0, v96
    v_fma_f32 v97, v101, 2.0, v97
    v_mfma_f32_16x16x32_bf16 v[92:95], a[112:115], v[52:55], v[92:95]
    v_fma_f32 v98, v102, 2.0, v98
    v_fma_f32 v99, v103, 2.0, v99
    v_mfma_f32_16x16x32_bf16 v[92:95], a[116:119], v[52:55], v[92:95]
    v_cndmask_b32 v3, 0, v96, s[44:45]
    v_cndmask_b32 v3, v3, v97, s[46:47]
    v_mfma_f32_16x16x32_bf16 v[88:91], a[96:99], v[136:139], v[76:79]
    v_cndmask_b32 v3, v3, v98, s[48:49]
    v_cndmask_b32 v3, v3, v99, s[50:51]
    v_mfma_f32_16x16x32_bf16 v[88:91], a[100:103], v[140:143], v[88:91]
    s_nop 0
    s_nop 0
    v_mfma_f32_16x16x32_bf16 v[88:91], a[104:107], v[144:147], v[88:91]
    v_mfma_f32_16x16x4_f32 v[120:123], v3, v60, v[56:59]
    v_mfma_f32_16x16x32_bf16 v[88:91], a[108:111], v[148:151], v[88:91]
    v_mfma_f32_16x16x32_bf16 v[88:91], a[112:115], v[152:155], v[88:91]
    v_mfma_f32_16x16x32_bf16 v[88:91], a[116:119], v[156:159], v[88:91]
    s_waitcnt lgkmcnt(0)
    s_add_u32 m0, s41, 0
    s_add_u32 s58, s37, 49152
    buffer_load_dwordx4 v22, s[24:27], s58 offen offset:0 nt lds
    buffer_load_dwordx4 v23, s[24:27], s58 offen offset:1024 nt lds
    s_add_u32 s61, s60, 8192
    buffer_load_dwordx4 v[160:163], v65, s[32:35], s61 offen offset:0
    buffer_load_dwordx4 v24, s[24:27], s58 offen offset:2048 nt lds
    buffer_load_dwordx4 v25, s[24:27], s58 offen offset:3072 nt lds
    buffer_load_dwordx4 v[164:167], v65, s[32:35], s61 offen offset:1024
    s_add_u32 m0, s41, 4096
    s_nop 0
    buffer_load_dwordx4 v26, s[24:27], s58 offen offset:0 nt lds
    buffer_load_dwordx4 v27, s[24:27], s58 offen offset:1024 nt lds
    buffer_load_dwordx4 v[168:171], v65, s[32:35], s61 offen offset:2048
    buffer_load_dwordx4 v28, s[24:27], s58 offen offset:2048 nt lds
    buffer_load_dwordx4 v29, s[24:27], s58 offen offset:3072 nt lds
    buffer_load_dwordx4 v[172:175], v65, s[32:35], s61 offen offset:3072
    s_add_u32 m0, s41, 8192
    s_nop 0
    buffer_load_dwordx4 v30, s[24:27], s58 offen offset:0 nt lds
    buffer_load_dwordx4 v31, s[24:27], s58 offen offset:1024 nt lds
    s_add_u32 s61, s60, 12288
    buffer_load_dwordx4 v[176:179], v65, s[32:35], s61 offen offset:0
    buffer_load_dwordx4 v32, s[24:27], s58 offen offset:2048 nt lds
    buffer_load_dwordx4 v33, s[24:27], s58 offen offset:3072 nt lds
    buffer_load_dwordx4 v[180:183], v65, s[32:35], s61 offen offset:1024
    v_mfma_f32_16x16x32_bf16 v[112:115], a[120:123], a[120:123], v[84:87]
    v_mfma_f32_16x16x32_bf16 v[116:119], a[120:123], a[48:51], 0
    v_mfma_f32_16x16x32_bf16 v[112:115], a[124:127], a[124:127], v[112:115]
    v_mfma_f32_16x16x32_bf16 v[116:119], a[124:127], a[52:55], v[116:119]
    v_fma_f32 v128, -v92, v92, v120
    v_fma_f32 v129, -v93, v93, v121
    v_mfma_f32_16x16x32_bf16 v[112:115], a[128:131], a[128:131], v[112:115]
    v_fma_f32 v130, -v94, v94, v122
    v_fma_f32 v131, -v95, v95, v123
    v_mfma_f32_16x16x32_bf16 v[116:119], a[128:131], a[56:59], v[116:119]
    v_max_f32 v128, v128, v56
    v_max_f32 v129, v129, v56
    v_mfma_f32_16x16x32_bf16 v[112:115], a[132:135], a[132:135], v[112:115]
    v_max_f32 v130, v130, v56
    v_max_f32 v131, v131, v56
    v_mfma_f32_16x16x32_bf16 v[116:119], a[132:135], a[60:63], v[116:119]
    v_rsq_f32 v128, v128
    v_mfma_f32_16x16x32_bf16 v[112:115], a[136:139], a[136:139], v[112:115]
    v_rsq_f32 v129, v129
    v_mfma_f32_16x16x32_bf16 v[116:119], a[136:139], a[64:67], v[116:119]
    v_rsq_f32 v130, v130
    v_mfma_f32_16x16x32_bf16 v[112:115], a[140:143], a[140:143], v[112:115]
    v_rsq_f32 v131, v131
    v_mfma_f32_16x16x32_bf16 v[116:119], a[140:143], a[68:71], v[116:119]
    v_fma_f32 v88, -v92, v61, v88
    v_fma_f32 v89, -v93, v61, v89
    v_mfma_f32_16x16x32_bf16 v[108:111], a[120:123], v[52:55], v[80:83]
    v_fma_f32 v90, -v94, v61, v90
    v_fma_f32 v91, -v95, v61, v91
    v_mfma_f32_16x16x32_bf16 v[108:111], a[124:127], v[52:55], v[108:111]
    v_mul_f32 v88, v88, v128
    v_mul_f32 v89, v89, v129
    v_mfma_f32_16x16x32_bf16 v[108:111], a[128:131], v[52:55], v[108:111]
    v_mul_f32 v90, v90, v130
    v_mul_f32 v91, v91, v131
    v_mfma_f32_16x16x32_bf16 v[108:111], a[132:135], v[52:55], v[108:111]
    v_max3_f32 v1, v88, v89, v90
    v_max_f32 v1, v1, v91
    v_mfma_f32_16x16x32_bf16 v[108:111], a[136:139], v[52:55], v[108:111]
    v_mov_b32 v2, v1
    s_nop 1
    v_permlane32_swap_b32 v1, v2
    v_mfma_f32_16x16x32_bf16 v[108:111], a[140:143], v[52:55], v[108:111]
    v_max_f32 v1, v1, v2
    v_mov_b32 v2, v1
    v_mfma_f32_16x16x32_bf16 v[104:107], a[120:123], v[136:139], v[76:79]
    s_nop 0
    v_permlane16_swap_b32 v1, v2
    v_max_f32 v1, v1, v2
    v_mfma_f32_16x16x32_bf16 v[104:107], a[124:127], v[140:143], v[104:107]
    v_sub_f32 v62, 0, v1
    v_sub_f32 v88, v88, v1
    v_mfma_f32_16x16x32_bf16 v[104:107], a[128:131], v[144:147], v[104:107]
    v_sub_f32 v89, v89, v1
    v_sub_f32 v90, v90, v1
    v_mfma_f32_16x16x32_bf16 v[104:107], a[132:135], v[148:151], v[104:107]
    v_sub_f32 v91, v91, v1
    v_mfma_f32_16x16x32_bf16 v[104:107], a[136:139], v[152:155], v[104:107]
    v_exp_f32 v96, v88
    v_mfma_f32_16x16x32_bf16 v[104:107], a[140:143], v[156:159], v[104:107]
    v_exp_f32 v97, v89
    v_exp_f32 v98, v90
    v_exp_f32 v99, v91
    v_mul_f32 v88, v96, v128
    v_mul_f32 v89, v97, v129
    v_mul_f32 v90, v98, v130
    v_mul_f32 v91, v99, v131
    v_fma_f32 v112, v116, 2.0, v112
    v_fma_f32 v113, v117, 2.0, v113
    v_fma_f32 v114, v118, 2.0, v114
    v_fma_f32 v115, v119, 2.0, v115
    v_cndmask_b32 v4, 0, v112, s[44:45]
    v_cndmask_b32 v4, v4, v113, s[46:47]
    v_cndmask_b32 v4, v4, v114, s[48:49]
    v_cndmask_b32 v4, v4, v115, s[50:51]
    v_mov_b32 v63, v96
    v_mul_f32 v64, v88, v92
    v_mfma_f32_16x16x4_f32 v[124:127], v4, v60, v[56:59]
    v_add_f32 v63, v63, v97
    v_fmac_f32 v64, v89, v93
    v_add_f32 v63, v63, v98
    v_fmac_f32 v64, v90, v94
    v_add_f32 v63, v63, v99
    v_fmac_f32 v64, v91, v95
    v_mov_b32 v68, v88
    v_mov_b32 v69, v89
    v_mov_b32 v70, v90
    v_mov_b32 v71, v91
    v_fma_f32 v132, -v108, v108, v124
    v_fma_f32 v133, -v109, v109, v125
    v_fma_f32 v134, -v110, v110, v126
    v_fma_f32 v135, -v111, v111, v127
    v_max_f32 v132, v132, v56
    v_max_f32 v133, v133, v56
    v_max_f32 v134, v134, v56
    v_max_f32 v135, v135, v56
    v_rsq_f32 v132, v132
    v_rsq_f32 v133, v133
    v_rsq_f32 v134, v134
    v_rsq_f32 v135, v135
    v_fma_f32 v104, -v108, v61, v104
    v_fma_f32 v105, -v109, v61, v105
    v_fma_f32 v106, -v110, v61, v106
    v_fma_f32 v107, -v111, v61, v107
    v_fma_f32 v104, v104, v132, v62
    v_fma_f32 v105, v105, v133, v62
    v_fma_f32 v106, v106, v134, v62
    v_fma_f32 v107, v107, v135, v62
    v_max3_f32 v1, v104, v105, v106
    v_max_f32 v1, v1, v107
    v_cmp_lt_f32 vcc, s52, v1
    s_cbranch_vccnz L_site0
L_back0:
    v_exp_f32 v112, v104
    v_exp_f32 v113, v105
    v_exp_f32 v114, v106
    v_exp_f32 v115, v107
    v_mul_f32 v104, v112, v132
    v_mul_f32 v105, v113, v133
    v_mul_f32 v106, v114, v134
    v_mul_f32 v107, v115, v135
    v_cvt_pk_bf16_f32 v72, v88, v89
    v_cvt_pk_bf16_f32 v73, v90, v91
    v_cvt_pk_bf16_f32 v74, v104, v105
    v_cvt_pk_bf16_f32 v75, v106, v107
    s_nop 1
    v_mfma_f32_16x16x32_bf16 a[0:3], a[144:147], v[72:75], 0
    v_add_f32 v63, v63, v112
    v_fmac_f32 v64, v104, v108
    v_mfma_f32_16x16x32_bf16 a[4:7], a[148:151], v[72:75], 0
    v_add_f32 v63, v63, v113
    v_fmac_f32 v64, v105, v109
    v_mfma_f32_16x16x32_bf16 a[8:11], a[152:155], v[72:75], 0
    v_add_f32 v63, v63, v114
    v_fmac_f32 v64, v106, v110
    v_mfma_f32_16x16x32_bf16 a[12:15], a[156:159], v[72:75], 0
    v_add_f32 v63, v63, v115
    v_fmac_f32 v64, v107, v111
    v_mfma_f32_16x16x32_bf16 a[16:19], a[160:163], v[72:75], 0
    v_add_f32 v68, v68, v104
    v_add_f32 v69, v69, v105
    v_mfma_f32_16x16x32_bf16 a[20:23], a[164:167], v[72:75], 0
    v_add_f32 v70, v70, v106
    v_add_f32 v71, v71, v107
    v_mfma_f32_16x16x32_bf16 a[24:27], a[168:171], v[72:75], 0
    v_mfma_f32_16x16x32_bf16 a[28:31], a[172:175], v[72:75], 0
    v_mfma_f32_16x16x32_bf16 a[32:35], a[176:179], v[72:75], 0
    v_mfma_f32_16x16x32_bf16 a[36:39], a[180:183], v[72:75], 0
    v_mfma_f32_16x16x32_bf16 a[40:43], a[184:187], v[72:75], 0
    v_mfma_f32_16x16x32_bf16 a[44:47], a[188:191], v[72:75], 0
    s_waitcnt vmcnt(24)
    ds_read_b128 a[96:99], v40 offset:49152
    ds_read_b128 a[100:103], v41 offset:49152
    ds_read_b128 a[104:107], v42 offset:49152
    ds_read_b128 a[108:111], v43 offset:49152
    ds_read_b128 a[112:115], v40 offset:49408
    ds_read_b128 a[116:119], v41 offset:49408
    ds_read_b128 a[120:123], v42 offset:49408
    ds_read_b128 a[124:127], v43 offset:49408
    ds_read_b128 a[128:131], v40 offset:49664
    ds_read_b128 a[132:135], v41 offset:49664
    ds_read_b128 a[136:139], v42 offset:49664
    ds_read_b128 a[140:143], v43 offset:49664
    s_waitcnt lgkmcnt(11)
    v_mfma_f32_16x16x32_bf16 v[96:99], a[96:99], a[96:99], v[84:87]
    ds_read_b64_tr_b16 a[144:145], v44 offset:49152
    ds_read_b64_tr_b16 a[146:147], v48 offset:49408
    v_mfma_f32_16x16x32_bf16 v[100:103], a[96:99], a[48:51], 0
    ds_read_b64_tr_b16 a[148:149], v45 offset:49152
    ds_read_b64_tr_b16 a[150:151], v49 offset:49408
    s_waitcnt lgkmcnt(14)
    v_mfma_f32_16x16x32_bf16 v[96:99], a[100:103], a[100:103], v[96:99]
    ds_read_b64_tr_b16 a[152:153], v46 offset:49152
    ds_read_b64_tr_b16 a[154:155], v50 offset:49408
    v_mfma_f32_16x16x32_bf16 v[100:103], a[100:103], a[52:55], v[100:103]
    ds_read_b64_tr_b16 a[156:157], v47 offset:49152
    ds_read_b64_tr_b16 a[158:159], v51 offset:49408
    s_waitcnt lgkmcnt(15)
    v_mfma_f32_16x16x32_bf16 v[96:99], a[104:107], a[104:107], v[96:99]
    ds_read_b64_tr_b16 a[160:161], v48 offset:49152
    ds_read_b64_tr_b16 a[162:163], v44 offset:49664
    v_mfma_f32_16x16x32_bf16 v[100:103], a[104:107], a[56:59], v[100:103]
    ds_read_b64_tr_b16 a[164:165], v49 offset:49152
    ds_read_b64_tr_b16 a[166:167], v45 offset:49664
    v_mfma_f32_16x16x32_bf16 v[96:99], a[108:111], a[108:111], v[96:99]
    ds_read_b64_tr_b16 a[168:169], v50 offset:49152
    ds_read_b64_tr_b16 a[170:171], v46 offset:49664
    v_mfma_f32_16x16x32_bf16 v[100:103], a[108:111], a[60:63], v[100:103]
    ds_read_b64_tr_b16 a[172:173], v51 offset:49152
    ds_read_b64_tr_b16 a[174:175], v47 offset:49664
    v_mfma_f32_16x16x32_bf16 v[96:99], a[112:115], a[112:115], v[96:99]
    ds_read_b64_tr_b16 a[176:177], v44 offset:49408
    ds_read_b64_tr_b16 a[178:179], v48 offset:49664
    v_mfma_f32_16x16x32_bf16 v[100:103], a[112:115], a[64:67], v[100:103]
    ds_read_b64_tr_b16 a[180:181], v45 offset:49408
    ds_read_b64_tr_b16 a[182:183], v49 offset:49664
    s_waitcnt lgkmcnt(15)
    v_mfma_f32_16x16x32_bf16 v[96:99], a[116:119], a[116:119], v[96:99]
    ds_read_b64_tr_b16 a[184:185], v46 offset:49408
    ds_read_b64_tr_b16 a[186:187], v50 offset:49664
    v_mfma_f32_16x16x32_bf16 v[100:103], a[116:119], a[68:71], v[100:103]
    ds_read_b64_tr_b16 a[188:189], v47 offset:49408
    ds_read_b64_tr_b16 a[190:191], v51 offset:49664
    v_mfma_f32_16x16x32_bf16 v[92:95], a[96:99], v[52:55], v[80:83]
    v_mfma_f32_16x16x32_bf16 v[92:95], a[100:103], v[52:55], v[92:95]
    v_mfma_f32_16x16x32_bf16 v[92:95], a[104:107], v[52:55], v[92:95]
    v_mfma_f32_16x16x32_bf16 v[92:95], a[108:111], v[52:55], v[92:95]
    s_nop 1
    v_fma_f32 v96, v100, 2.0, v96
    v_fma_f32 v97, v101, 2.0, v97
    v_mfma_f32_16x16x32_bf16 v[92:95], a[112:115], v[52:55], v[92:95]
    v_fma_f32 v98, v102, 2.0, v98
    v_fma_f32 v99, v103, 2.0, v99
    v_mfma_f32_16x16x32_bf16 v[92:95], a[116:119], v[52:55], v[92:95]
    v_cndmask_b32 v3, 0, v96, s[44:45]
    v_cndmask_b32 v3, v3, v97, s[46:47]
    v_mfma_f32_16x16x32_bf16 v[88:91], a[96:99], v[136:139], v[76:79]
    v_cndmask_b32 v3, v3, v98, s[48:49]
    v_cndmask_b32 v3, v3, v99, s[50:51]
    v_mfma_f32_16x16x32_bf16 v[88:91], a[100:103], v[140:143], v[88:91]
    s_nop 0
    s_nop 0
    v_mfma_f32_16x16x32_bf16 v[88:91], a[104:107], v[144:147], v[88:91]
    v_mfma_f32_16x16x4_f32 v[120:123], v3, v60, v[56:59]
    v_mfma_f32_16x16x32_bf16 v[88:91], a[108:111], v[148:151], v[88:91]
    v_mfma_f32_16x16x32_bf16 v[88:91], a[112:115], v[152:155], v[88:91]
    v_mfma_f32_16x16x32_bf16 v[88:91], a[116:119], v[156:159], v[88:91]
    s_waitcnt lgkmcnt(0)
    s_add_u32 m0, s42, 0
    s_add_u32 s59, s37, 245760
    buffer_load_dwordx4 v22, s[24:27], s59 offen offset:0 nt lds
    buffer_load_dwordx4 v23, s[24:27], s59 offen offset:1024 nt lds
    buffer_load_dwordx4 v[184:187], v65, s[32:35], s61 offen offset:2048
    buffer_load_dwordx4 v24, s[24:27], s59 offen offset:2048 nt lds
    buffer_load_dwordx4 v25, s[24:27], s59 offen offset:3072 nt lds
    buffer_load_dwordx4 v[188:191], v65, s[32:35], s61 offen offset:3072
    s_add_u32 m0, s42, 4096
    s_nop 0
    buffer_load_dwordx4 v26, s[24:27], s59 offen offset:0 nt lds
    buffer_load_dwordx4 v27, s[24:27], s59 offen offset:1024 nt lds
    s_add_u32 s61, s60, 16384
    buffer_load_dwordx4 v[192:195], v65, s[32:35], s61 offen offset:0
    buffer_load_dwordx4 v28, s[24:27], s59 offen offset:2048 nt lds
    buffer_load_dwordx4 v29, s[24:27], s59 offen offset:3072 nt lds
    buffer_load_dwordx4 v[196:199], v65, s[32:35], s61 offen offset:1024
    s_add_u32 m0, s42, 8192
    s_nop 0
    buffer_load_dwordx4 v30, s[24:27], s59 offen offset:0 nt lds
    buffer_load_dwordx4 v31, s[24:27], s59 offen offset:1024 nt lds
    buffer_load_dwordx4 v[200:203], v65, s[32:35], s61 offen offset:2048
    buffer_load_dwordx4 v32, s[24:27], s59 offen offset:2048 nt lds
    buffer_load_dwordx4 v33, s[24:27], s59 offen offset:3072 nt lds
    buffer_load_dwordx4 v[204:207], v65, s[32:35], s61 offen offset:3072
    v_mfma_f32_16x16x32_bf16 v[112:115], a[120:123], a[120:123], v[84:87]
    v_mfma_f32_16x16x32_bf16 v[116:119], a[120:123], a[48:51], 0
    v_mfma_f32_16x16x32_bf16 v[112:115], a[124:127], a[124:127], v[112:115]
    v_mfma_f32_16x16x32_bf16 v[116:119], a[124:127], a[52:55], v[116:119]
    v_fma_f32 v128, -v92, v92, v120
    v_fma_f32 v129, -v93, v93, v121
    v_mfma_f32_16x16x32_bf16 v[112:115], a[128:131], a[128:131], v[112:115]
    v_fma_f32 v130, -v94, v94, v122
    v_fma_f32 v131, -v95, v95, v123
    v_mfma_f32_16x16x32_bf16 v[116:119], a[128:131], a[56:59], v[116:119]
    v_max_f32 v128, v128, v56
    v_max_f32 v129, v129, v56
    v_mfma_f32_16x16x32_bf16 v[112:115], a[132:135], a[132:135], v[112:115]
    v_max_f32 v130, v130, v56
    v_max_f32 v131, v131, v56
    v_mfma_f32_16x16x32_bf16 v[116:119], a[132:135], a[60:63], v[116:119]
    v_rsq_f32 v128, v128
    v_mfma_f32_16x16x32_bf16 v[112:115], a[136:139], a[136:139], v[112:115]
    v_rsq_f32 v129, v129
    v_mfma_f32_16x16x32_bf16 v[116:119], a[136:139], a[64:67], v[116:119]
    v_rsq_f32 v130, v130
    v_mfma_f32_16x16x32_bf16 v[112:115], a[140:143], a[140:143], v[112:115]
    v_rsq_f32 v131, v131
    v_mfma_f32_16x16x32_bf16 v[116:119], a[140:143], a[68:71], v[116:119]
    v_fma_f32 v88, -v92, v61, v88
    v_fma_f32 v89, -v93, v61, v89
    v_mfma_f32_16x16x32_bf16 v[108:111], a[120:123], v[52:55], v[80:83]
    v_fma_f32 v90, -v94, v61, v90
    v_fma_f32 v91, -v95, v61, v91
    v_mfma_f32_16x16x32_bf16 v[108:111], a[124:127], v[52:55], v[108:111]
    v_fma_f32 v88, v88, v128, v62
    v_fma_f32 v89, v89, v129, v62
    v_mfma_f32_16x16x32_bf16 v[108:111], a[128:131], v[52:55], v[108:111]
    v_fma_f32 v90, v90, v130, v62
    v_fma_f32 v91, v91, v131, v62
    v_mfma_f32_16x16x32_bf16 v[108:111], a[132:135], v[52:55], v[108:111]
    v_max3_f32 v1, v88, v89, v90
    v_max_f32 v1, v1, v91
    v_mfma_f32_16x16x32_bf16 v[108:111], a[136:139], v[52:55], v[108:111]
    v_cmp_lt_f32 vcc, s52, v1
    s_cbranch_vccnz L_site1
L_back1:
    v_mfma_f32_16x16x32_bf16 v[108:111], a[140:143], v[52:55], v[108:111]
    v_exp_f32 v96, v88
    v_mfma_f32_16x16x32_bf16 v[104:107], a[120:123], v[136:139], v[76:79]
    v_exp_f32 v97, v89
    v_mfma_f32_16x16x32_bf16 v[104:107], a[124:127], v[140:143], v[104:107]
    v_exp_f32 v98, v90
    v_mfma_f32_16x16x32_bf16 v[104:107], a[128:131], v[144:147], v[104:107]
    v_exp_f32 v99, v91
    v_mfma_f32_16x16x32_bf16 v[104:107], a[132:135], v[148:151], v[104:107]
    v_mul_f32 v88, v96, v128
    v_mul_f32 v89, v97, v129
    v_mfma_f32_16x16x32_bf16 v[104:107], a[136:139], v[152:155], v[104:107]
    v_mul_f32 v90, v98, v130
    v_mul_f32 v91, v99, v131
    v_mfma_f32_16x16x32_bf16 v[104:107], a[140:143], v[156:159], v[104:107]
    v_fma_f32 v112, v116, 2.0, v112
    v_fma_f32 v113, v117, 2.0, v113
    v_fma_f32 v114, v118, 2.0, v114
    v_fma_f32 v115, v119, 2.0, v115
    v_cndmask_b32 v4, 0, v112, s[44:45]
    v_cndmask_b32 v4, v4, v113, s[46:47]
    v_cndmask_b32 v4, v4, v114, s[48:49]
    v_cndmask_b32 v4, v4, v115, s[50:51]
    v_add_f32 v63, v63, v96
    v_fmac_f32 v64, v88, v92
    v_mfma_f32_16x16x4_f32 v[124:127], v4, v60, v[56:59]
    v_add_f32 v63, v63, v97
    v_fmac_f32 v64, v89, v93
    v_add_f32 v63, v63, v98
    v_fmac_f32 v64, v90, v94
    v_add_f32 v63, v63, v99
    v_fmac_f32 v64, v91, v95
    v_add_f32 v68, v68, v88
    v_add_f32 v69, v69, v89
    v_add_f32 v70, v70, v90
    v_add_f32 v71, v71, v91
    v_fma_f32 v132, -v108, v108, v124
    v_fma_f32 v133, -v109, v109, v125
    v_fma_f32 v134, -v110, v110, v126
    v_fma_f32 v135, -v111, v111, v127
    v_max_f32 v132, v132, v56
    v_max_f32 v133, v133, v56
    v_max_f32 v134, v134, v56
    v_max_f32 v135, v135, v56
    v_rsq_f32 v132, v132
    v_rsq_f32 v133, v133
    v_rsq_f32 v134, v134
    v_rsq_f32 v135, v135
    v_fma_f32 v104, -v108, v61, v104
    v_fma_f32 v105, -v109, v61, v105
    v_fma_f32 v106, -v110, v61, v106
    v_fma_f32 v107, -v111, v61, v107
    v_fma_f32 v104, v104, v132, v62
    v_fma_f32 v105, v105, v133, v62
    v_fma_f32 v106, v106, v134, v62
    v_fma_f32 v107, v107, v135, v62
    v_max3_f32 v1, v104, v105, v106
    v_max_f32 v1, v1, v107
    v_cmp_lt_f32 vcc, s52, v1
    s_cbranch_vccnz L_site2
L_back2:
    v_exp_f32 v112, v104
    v_exp_f32 v113, v105
    v_exp_f32 v114, v106
    v_exp_f32 v115, v107
    v_mul_f32 v104, v112, v132
    v_mul_f32 v105, v113, v133
    v_mul_f32 v106, v114, v134
    v_mul_f32 v107, v115, v135
    v_cvt_pk_bf16_f32 v72, v88, v89
    v_cvt_pk_bf16_f32 v73, v90, v91
    v_cvt_pk_bf16_f32 v74, v104, v105
    v_cvt_pk_bf16_f32 v75, v106, v107
    s_nop 1
    v_mfma_f32_16x16x32_bf16 a[0:3], a[144:147], v[72:75], a[0:3]
    v_add_f32 v68, v68, v104
    v_add_f32 v69, v69, v105
    v_mfma_f32_16x16x32_bf16 a[4:7], a[148:151], v[72:75], a[4:7]
    v_add_f32 v70, v70, v106
    v_add_f32 v71, v71, v107
    v_mfma_f32_16x16x32_bf16 a[8:11], a[152:155], v[72:75], a[8:11]
    v_cvt_pk_bf16_f32 v66, v68, v69
    v_cvt_pk_bf16_f32 v67, v70, v71
    v_mfma_f32_16x16x32_bf16 a[12:15], a[156:159], v[72:75], a[12:15]
    v_add_f32 v63, v63, v112
    v_fmac_f32 v64, v104, v108
    v_mfma_f32_16x16x32_bf16 a[16:19], a[160:163], v[72:75], a[16:19]
    v_add_f32 v63, v63, v113
    v_fmac_f32 v64, v105, v109
    v_mfma_f32_16x16x32_bf16 a[20:23], a[164:167], v[72:75], a[20:23]
    v_add_f32 v63, v63, v114
    v_fmac_f32 v64, v106, v110
    v_mfma_f32_16x16x32_bf16 a[24:27], a[168:171], v[72:75], a[24:27]
    v_add_f32 v63, v63, v115
    v_fmac_f32 v64, v107, v111
    v_mfma_f32_16x16x32_bf16 a[28:31], a[172:175], v[72:75], a[28:31]
    v_mfma_f32_16x16x32_bf16 a[32:35], a[176:179], v[72:75], a[32:35]
    v_mfma_f32_16x16x32_bf16 a[36:39], a[180:183], v[72:75], a[36:39]
    v_mfma_f32_16x16x32_bf16 a[40:43], a[184:187], v[72:75], a[40:43]
    v_mfma_f32_16x16x32_bf16 a[44:47], a[188:191], v[72:75], a[44:47]
    v_mfma_f32_16x16x16_bf16 a[0:3], a[72:73], v[66:67], a[0:3]
    v_mfma_f32_16x16x16_bf16 a[4:7], a[74:75], v[66:67], a[4:7]
    v_mfma_f32_16x16x16_bf16 a[8:11], a[76:77], v[66:67], a[8:11]
    v_mfma_f32_16x16x16_bf16 a[12:15], a[78:79], v[66:67], a[12:15]
    v_mfma_f32_16x16x16_bf16 a[16:19], a[80:81], v[66:67], a[16:19]
    v_mfma_f32_16x16x16_bf16 a[20:23], a[82:83], v[66:67], a[20:23]
    v_mfma_f32_16x16x16_bf16 a[24:27], a[84:85], v[66:67], a[24:27]
    v_mfma_f32_16x16x16_bf16 a[28:31], a[86:87], v[66:67], a[28:31]
    v_mfma_f32_16x16x16_bf16 a[32:35], a[88:89], v[66:67], a[32:35]
    v_mfma_f32_16x16x16_bf16 a[36:39], a[90:91], v[66:67], a[36:39]
    v_mfma_f32_16x16x16_bf16 a[40:43], a[92:93], v[66:67], a[40:43]
    v_mfma_f32_16x16x16_bf16 a[44:47], a[94:95], v[66:67], a[44:47]
    s_waitcnt vmcnt(36)
    ds_read_b128 a[48:51], v34 offset:0
    ds_read_b128 a[52:55], v35 offset:0
    ds_read_b128 a[56:59], v34 offset:128
    ds_read_b128 a[60:63], v35 offset:128
    ds_read_b128 a[64:67], v34 offset:256
    ds_read_b128 a[68:71], v35 offset:256
    s_waitcnt lgkmcnt(5)
    v_mfma_f32_16x16x32_bf16 v[84:87], a[48:51], a[48:51], 0
    ds_read_b64_tr_b16 a[72:73], v36 offset:0
    ds_read_b64_tr_b16 a[74:75], v37 offset:0
    v_mfma_f32_16x16x32_bf16 v[80:83], a[48:51], v[52:55], 0
    ds_read_b64_tr_b16 a[76:77], v38 offset:0
    ds_read_b64_tr_b16 a[78:79], v39 offset:0
    s_waitcnt lgkmcnt(8)
    v_mfma_f32_16x16x32_bf16 v[84:87], a[52:55], a[52:55], v[84:87]
    ds_read_b64_tr_b16 a[80:81], v36 offset:128
    ds_read_b64_tr_b16 a[82:83], v37 offset:128
    v_mfma_f32_16x16x32_bf16 v[80:83], a[52:55], v[52:55], v[80:83]
    ds_read_b64_tr_b16 a[84:85], v38 offset:128
    ds_read_b64_tr_b16 a[86:87], v39 offset:128
    s_waitcnt lgkmcnt(11)
    v_mfma_f32_16x16x32_bf16 v[84:87], a[56:59], a[56:59], v[84:87]
    ds_read_b64_tr_b16 a[88:89], v36 offset:256
    ds_read_b64_tr_b16 a[90:91], v37 offset:256
    v_mfma_f32_16x16x32_bf16 v[80:83], a[56:59], v[52:55], v[80:83]
    ds_read_b64_tr_b16 a[92:93], v38 offset:256
    ds_read_b64_tr_b16 a[94:95], v39 offset:256
    s_waitcnt lgkmcnt(14)
    v_mfma_f32_16x16x32_bf16 v[84:87], a[60:63], a[60:63], v[84:87]
    v_mfma_f32_16x16x32_bf16 v[80:83], a[60:63], v[52:55], v[80:83]
    s_waitcnt lgkmcnt(13)
    v_mfma_f32_16x16x32_bf16 v[84:87], a[64:67], a[64:67], v[84:87]
    v_mfma_f32_16x16x32_bf16 v[80:83], a[64:67], v[52:55], v[80:83]
    s_waitcnt lgkmcnt(12)
    v_mfma_f32_16x16x32_bf16 v[84:87], a[68:71], a[68:71], v[84:87]
    v_mfma_f32_16x16x32_bf16 v[80:83], a[68:71], v[52:55], v[80:83]
    s_waitcnt lgkmcnt(0)
    s_add_u32 m0, s40, 0
    s_add_u32 s57, s36, 49152
    buffer_load_dwordx4 v16, s[28:31], s57 offen offset:0 nt lds
    buffer_load_dwordx4 v17, s[28:31], s57 offen offset:1024 nt lds
    s_add_u32 s61, s60, 20480
    buffer_load_dwordx4 v[208:211], v65, s[32:35], s61 offen offset:0
    buffer_load_dwordx4 v18, s[28:31], s57 offen offset:2048 nt lds
    buffer_load_dwordx4 v19, s[28:31], s57 offen offset:3072 nt lds
    buffer_load_dwordx4 v[212:215], v65, s[32:35], s61 offen offset:1024
    s_add_u32 m0, s40, 4096
    s_nop 0
    buffer_load_dwordx4 v20, s[28:31], s57 offen offset:0 nt lds
    buffer_load_dwordx4 v21, s[28:31], s57 offen offset:1024 nt lds
    buffer_load_dwordx4 v[216:219], v65, s[32:35], s61 offen offset:2048
    v_mfma_f32_16x16x32_bf16 v[76:79], a[48:51], v[136:139], 0
    v_mfma_f32_16x16x32_bf16 v[76:79], a[52:55], v[140:143], v[76:79]
    v_mfma_f32_16x16x32_bf16 v[76:79], a[56:59], v[144:147], v[76:79]
    v_mfma_f32_16x16x32_bf16 v[76:79], a[60:63], v[148:151], v[76:79]
    v_mfma_f32_16x16x32_bf16 v[76:79], a[64:67], v[152:155], v[76:79]
    v_mfma_f32_16x16x32_bf16 v[76:79], a[68:71], v[156:159], v[76:79]
    s_waitcnt vmcnt(28)
    ds_read_b128 a[96:99], v40 offset:0
    ds_read_b128 a[100:103], v41 offset:0
    ds_read_b128 a[104:107], v42 offset:0
    ds_read_b128 a[108:111], v43 offset:0
    ds_read_b128 a[112:115], v40 offset:256
    ds_read_b128 a[116:119], v41 offset:256
    ds_read_b128 a[120:123], v42 offset:256
    ds_read_b128 a[124:127], v43 offset:256
    ds_read_b128 a[128:131], v40 offset:512
    ds_read_b128 a[132:135], v41 offset:512
    ds_read_b128 a[136:139], v42 offset:512
    ds_read_b128 a[140:143], v43 offset:512
    s_waitcnt lgkmcnt(11)
    v_mfma_f32_16x16x32_bf16 v[96:99], a[96:99], a[96:99], v[84:87]
    ds_read_b64_tr_b16 a[144:145], v44 offset:0
    ds_read_b64_tr_b16 a[146:147], v48 offset:256
    v_mfma_f32_16x16x32_bf16 v[100:103], a[96:99], a[48:51], 0
    ds_read_b64_tr_b16 a[148:149], v45 offset:0
    ds_read_b64_tr_b16 a[150:151], v49 offset:256
    s_waitcnt lgkmcnt(14)
    v_mfma_f32_16x16x32_bf16 v[96:99], a[100:103], a[100:103], v[96:99]
    ds_read_b64_tr_b16 a[152:153], v46 offset:0
    ds_read_b64_tr_b16 a[154:155], v50 offset:256
    v_mfma_f32_16x16x32_bf16 v[100:103], a[100:103], a[52:55], v[100:103]
    ds_read_b64_tr_b16 a[156:157], v47 offset:0
    ds_read_b64_tr_b16 a[158:159], v51 offset:256
    s_waitcnt lgkmcnt(15)
    v_mfma_f32_16x16x32_bf16 v[96:99], a[104:107], a[104:107], v[96:99]
    ds_read_b64_tr_b16 a[160:161], v48 offset:0
    ds_read_b64_tr_b16 a[162:163], v44 offset:512
    v_mfma_f32_16x16x32_bf16 v[100:103], a[104:107], a[56:59], v[100:103]
    ds_read_b64_tr_b16 a[164:165], v49 offset:0
    ds_read_b64_tr_b16 a[166:167], v45 offset:512
    v_mfma_f32_16x16x32_bf16 v[96:99], a[108:111], a[108:111], v[96:99]
    ds_read_b64_tr_b16 a[168:169], v50 offset:0
    ds_read_b64_tr_b16 a[170:171], v46 offset:512
    v_mfma_f32_16x16x32_bf16 v[100:103], a[108:111], a[60:63], v[100:103]
    ds_read_b64_tr_b16 a[172:173], v51 offset:0
    ds_read_b64_tr_b16 a[174:175], v47 offset:512
    v_mfma_f32_16x16x32_bf16 v[96:99], a[112:115], a[112:115], v[96:99]
    ds_read_b64_tr_b16 a[176:177], v44 offset:256
    ds_read_b64_tr_b16 a[178:179], v48 offset:512
    v_mfma_f32_16x16x32_bf16 v[100:103], a[112:115], a[64:67], v[100:103]
    ds_read_b64_tr_b16 a[180:181], v45 offset:256
    ds_read_b64_tr_b16 a[182:183], v49 offset:512
    s_waitcnt lgkmcnt(15)
    v_mfma_f32_16x16x32_bf16 v[96:99], a[116:119], a[116:119], v[96:99]
    ds_read_b64_tr_b16 a[184:185], v46 offset:256
    ds_read_b64_tr_b16 a[186:187], v50 offset:512
    v_mfma_f32_16x16x32_bf16 v[100:103], a[116:119], a[68:71], v[100:103]
    ds_read_b64_tr_b16 a[188:189], v47 offset:256
    ds_read_b64_tr_b16 a[190:191], v51 offset:512
    v_mfma_f32_16x16x32_bf16 v[92:95], a[96:99], v[52:55], v[80:83]
    v_mfma_f32_16x16x32_bf16 v[92:95], a[100:103], v[52:55], v[92:95]
    v_mfma_f32_16x16x32_bf16 v[92:95], a[104:107], v[52:55], v[92:95]
    v_mfma_f32_16x16x32_bf16 v[92:95], a[108:111], v[52:55], v[92:95]
    s_nop 1
    v_fma_f32 v96, v100, 2.0, v96
    v_fma_f32 v97, v101, 2.0, v97
    v_mfma_f32_16x16x32_bf16 v[92:95], a[112:115], v[52:55], v[92:95]
    v_fma_f32 v98, v102, 2.0, v98
    v_fma_f32 v99, v103, 2.0, v99
    v_mfma_f32_16x16x32_bf16 v[92:95], a[116:119], v[52:55], v[92:95]
    v_cndmask_b32 v3, 0, v96, s[44:45]
    v_cndmask_b32 v3, v3, v97, s[46:47]
    v_mfma_f32_16x16x32_bf16 v[88:91], a[96:99], v[136:139], v[76:79]
    v_cndmask_b32 v3, v3, v98, s[48:49]
    v_cndmask_b32 v3, v3, v99, s[50:51]
    v_mfma_f32_16x16x32_bf16 v[88:91], a[100:103], v[140:143], v[88:91]
    s_nop 0
    s_nop 0
    v_mfma_f32_16x16x32_bf16 v[88:91], a[104:107], v[144:147], v[88:91]
    v_mfma_f32_16x16x4_f32 v[120:123], v3, v60, v[56:59]
    v_mfma_f32_16x16x32_bf16 v[88:91], a[108:111], v[148:151], v[88:91]
    v_mfma_f32_16x16x32_bf16 v[88:91], a[112:115], v[152:155], v[88:91]
    v_mfma_f32_16x16x32_bf16 v[88:91], a[116:119], v[156:159], v[88:91]
    s_waitcnt lgkmcnt(0)
    s_add_u32 m0, s41, 0
    s_add_u32 s58, s37, 98304
    buffer_load_dwordx4 v22, s[24:27], s58 offen offset:0 nt lds
    buffer_load_dwordx4 v23, s[24:27], s58 offen offset:1024 nt lds
    buffer_load_dwordx4 v[220:223], v65, s[32:35], s61 offen offset:3072
    buffer_load_dwordx4 v24, s[24:27], s58 offen offset:2048 nt lds
    buffer_load_dwordx4 v25, s[24:27], s58 offen offset:3072 nt lds
    s_add_u32 s61, s60, 24576
    buffer_load_dwordx4 v[224:227], v65, s[32:35], s61 offen offset:0
    s_add_u32 m0, s41, 4096
    s_nop 0
    buffer_load_dwordx4 v26, s[24:27], s58 offen offset:0 nt lds
    buffer_load_dwordx4 v27, s[24:27], s58 offen offset:1024 nt lds
    buffer_load_dwordx4 v[228:231], v65, s[32:35], s61 offen offset:1024
    buffer_load_dwordx4 v28, s[24:27], s58 offen offset:2048 nt lds
    buffer_load_dwordx4 v29, s[24:27], s58 offen offset:3072 nt lds
    s_add_u32 m0, s41, 8192
    s_nop 0
    buffer_load_dwordx4 v30, s[24:27], s58 offen offset:0 nt lds
    buffer_load_dwordx4 v31, s[24:27], s58 offen offset:1024 nt lds
    buffer_load_dwordx4 v32, s[24:27], s58 offen offset:2048 nt lds
    buffer_load_dwordx4 v33, s[24:27], s58 offen offset:3072 nt lds
    v_mfma_f32_16x16x32_bf16 v[112:115], a[120:123], a[120:123], v[84:87]
    v_mfma_f32_16x16x32_bf16 v[116:119], a[120:123], a[48:51], 0
    v_mfma_f32_16x16x32_bf16 v[112:115], a[124:127], a[124:127], v[112:115]
    v_mfma_f32_16x16x32_bf16 v[116:119], a[124:127], a[52:55], v[116:119]
    v_fma_f32 v128, -v92, v92, v120
    v_fma_f32 v129, -v93, v93, v121
    v_mfma_f32_16x16x32_bf16 v[112:115], a[128:131], a[128:131], v[112:115]
    v_fma_f32 v130, -v94, v94, v122
    v_fma_f32 v131, -v95, v95, v123
    v_mfma_f32_16x16x32_bf16 v[116:119], a[128:131], a[56:59], v[116:119]
    v_max_f32 v128, v128, v56
    v_max_f32 v129, v129, v56
    v_mfma_f32_16x16x32_bf16 v[112:115], a[132:135], a[132:135], v[112:115]
    v_max_f32 v130, v130, v56
    v_max_f32 v131, v131, v56
    v_mfma_f32_16x16x32_bf16 v[116:119], a[132:135], a[60:63], v[116:119]
    v_rsq_f32 v128, v128
    v_mfma_f32_16x16x32_bf16 v[112:115], a[136:139], a[136:139], v[112:115]
    v_rsq_f32 v129, v129
    v_mfma_f32_16x16x32_bf16 v[116:119], a[136:139], a[64:67], v[116:119]
    v_rsq_f32 v130, v130
    v_mfma_f32_16x16x32_bf16 v[112:115], a[140:143], a[140:143], v[112:115]
    v_rsq_f32 v131, v131
    v_mfma_f32_16x16x32_bf16 v[116:119], a[140:143], a[68:71], v[116:119]
    v_fma_f32 v88, -v92, v61, v88
    v_fma_f32 v89, -v93, v61, v89
    v_mfma_f32_16x16x32_bf16 v[108:111], a[120:123], v[52:55], v[80:83]
    v_fma_f32 v90, -v94, v61, v90
    v_fma_f32 v91, -v95, v61, v91
    v_mfma_f32_16x16x32_bf16 v[108:111], a[124:127], v[52:55], v[108:111]
    v_fma_f32 v88, v88, v128, v62
    v_fma_f32 v89, v89, v129, v62
    v_mfma_f32_16x16x32_bf16 v[108:111], a[128:131], v[52:55], v[108:111]
    v_fma_f32 v90, v90, v130, v62
    v_fma_f32 v91, v91, v131, v62
    v_mfma_f32_16x16x32_bf16 v[108:111], a[132:135], v[52:55], v[108:111]
    v_max3_f32 v1, v88, v89, v90
    v_max_f32 v1, v1, v91
    v_mfma_f32_16x16x32_bf16 v[108:111], a[136:139], v[52:55], v[108:111]
    v_cmp_lt_f32 vcc, s52, v1
    s_cbranch_vccnz L_site3
L_back3:
    v_mfma_f32_16x16x32_bf16 v[108:111], a[140:143], v[52:55], v[108:111]
    v_exp_f32 v96, v88
    v_mfma_f32_16x16x32_bf16 v[104:107], a[120:123], v[136:139], v[76:79]
    v_exp_f32 v97, v89
    v_mfma_f32_16x16x32_bf16 v[104:107], a[124:127], v[140:143], v[104:107]
    v_exp_f32 v98, v90
    v_mfma_f32_16x16x32_bf16 v[104:107], a[128:131], v[144:147], v[104:107]
    v_exp_f32 v99, v91
    v_mfma_f32_16x16x32_bf16 v[104:107], a[132:135], v[148:151], v[104:107]
    v_mul_f32 v88, v96, v128
    v_mul_f32 v89, v97, v129
    v_mfma_f32_16x16x32_bf16 v[104:107], a[136:139], v[152:155], v[104:107]
    v_mul_f32 v90, v98, v130
    v_mul_f32 v91, v99, v131
    v_mfma_f32_16x16x32_bf16 v[104:107], a[140:143], v[156:159], v[104:107]
    v_fma_f32 v112, v116, 2.0, v112
    v_fma_f32 v113, v117, 2.0, v113
    v_fma_f32 v114, v118, 2.0, v114
    v_fma_f32 v115, v119, 2.0, v115
    v_cndmask_b32 v4, 0, v112, s[44:45]
    v_cndmask_b32 v4, v4, v113, s[46:47]
    v_cndmask_b32 v4, v4, v114, s[48:49]
    v_cndmask_b32 v4, v4, v115, s[50:51]
    v_add_f32 v63, v63, v96
    v_fmac_f32 v64, v88, v92
    v_mfma_f32_16x16x4_f32 v[124:127], v4, v60, v[56:59]
    v_add_f32 v63, v63, v97
    v_fmac_f32 v64, v89, v93
    v_add_f32 v63, v63, v98
    v_fmac_f32 v64, v90, v94
    v_add_f32 v63, v63, v99
    v_fmac_f32 v64, v91, v95
    v_mov_b32 v68, v88
    v_mov_b32 v69, v89
    v_mov_b32 v70, v90
    v_mov_b32 v71, v91
    v_fma_f32 v132, -v108, v108, v124
    v_fma_f32 v133, -v109, v109, v125
    v_fma_f32 v134, -v110, v110, v126
    v_fma_f32 v135, -v111, v111, v127
    v_max_f32 v132, v132, v56
    v_max_f32 v133, v133, v56
    v_max_f32 v134, v134, v56
    v_max_f32 v135, v135, v56
    v_rsq_f32 v132, v132
    v_rsq_f32 v133, v133
    v_rsq_f32 v134, v134
    v_rsq_f32 v135, v135
    v_fma_f32 v104, -v108, v61, v104
    v_fma_f32 v105, -v109, v61, v105
    v_fma_f32 v106, -v110, v61, v106
    v_fma_f32 v107, -v111, v61, v107
    v_fma_f32 v104, v104, v132, v62
    v_fma_f32 v105, v105, v133, v62
    v_fma_f32 v106, v106, v134, v62
    v_fma_f32 v107, v107, v135, v62
    v_max3_f32 v1, v104, v105, v106
    v_max_f32 v1, v1, v107
    v_cmp_lt_f32 vcc, s52, v1
    s_cbranch_vccnz L_site4
L_back4:
    v_exp_f32 v112, v104
    v_exp_f32 v113, v105
    v_exp_f32 v114, v106
    v_exp_f32 v115, v107
    v_mul_f32 v104, v112, v132
    v_mul_f32 v105, v113, v133
    v_mul_f32 v106, v114, v134
    v_mul_f32 v107, v115, v135
    v_cvt_pk_bf16_f32 v72, v88, v89
    v_cvt_pk_bf16_f32 v73, v90, v91
    v_cvt_pk_bf16_f32 v74, v104, v105
    v_cvt_pk_bf16_f32 v75, v106, v107
    s_nop 1
    v_mfma_f32_16x16x32_bf16 a[0:3], a[144:147], v[72:75], a[0:3]
    v_add_f32 v63, v63, v112
    v_fmac_f32 v64, v104, v108
    v_mfma_f32_16x16x32_bf16 a[4:7], a[148:151], v[72:75], a[4:7]
    v_add_f32 v63, v63, v113
    v_fmac_f32 v64, v105, v109
    v_mfma_f32_16x16x32_bf16 a[8:11], a[152:155], v[72:75], a[8:11]
    v_add_f32 v63, v63, v114
    v_fmac_f32 v64, v106, v110
    v_mfma_f32_16x16x32_bf16 a[12:15], a[156:159], v[72:75], a[12:15]
    v_add_f32 v63, v63, v115
    v_fmac_f32 v64, v107, v111
    v_mfma_f32_16x16x32_bf16 a[16:19], a[160:163], v[72:75], a[16:19]
    v_add_f32 v68, v68, v104
    v_add_f32 v69, v69, v105
    v_mfma_f32_16x16x32_bf16 a[20:23], a[164:167], v[72:75], a[20:23]
    v_add_f32 v70, v70, v106
    v_add_f32 v71, v71, v107
    v_mfma_f32_16x16x32_bf16 a[24:27], a[168:171], v[72:75], a[24:27]
    v_mfma_f32_16x16x32_bf16 a[28:31], a[172:175], v[72:75], a[28:31]
    v_mfma_f32_16x16x32_bf16 a[32:35], a[176:179], v[72:75], a[32:35]
    v_mfma_f32_16x16x32_bf16 a[36:39], a[180:183], v[72:75], a[36:39]
    v_mfma_f32_16x16x32_bf16 a[40:43], a[184:187], v[72:75], a[40:43]
    v_mfma_f32_16x16x32_bf16 a[44:47], a[188:191], v[72:75], a[44:47]
    s_waitcnt vmcnt(25)
    ds_read_b128 a[96:99], v40 offset:49152
    ds_read_b128 a[100:103], v41 offset:49152
    ds_read_b128 a[104:107], v42 offset:49152
    ds_read_b128 a[108:111], v43 offset:49152
    ds_read_b128 a[112:115], v40 offset:49408
    ds_read_b128 a[116:119], v41 offset:49408
    ds_read_b128 a[120:123], v42 offset:49408
    ds_read_b128 a[124:127], v43 offset:49408
    ds_read_b128 a[128:131], v40 offset:49664
    ds_read_b128 a[132:135], v41 offset:49664
    ds_read_b128 a[136:139], v42 offset:49664
    ds_read_b128 a[140:143], v43 offset:49664
    s_waitcnt lgkmcnt(11)
    v_mfma_f32_16x16x32_bf16 v[96:99], a[96:99], a[96:99], v[84:87]
    ds_read_b64_tr_b16 a[144:145], v44 offset:49152
    ds_read_b64_tr_b16 a[146:147], v48 offset:49408
    v_mfma_f32_16x16x32_bf16 v[100:103], a[96:99], a[48:51], 0
    ds_read_b64_tr_b16 a[148:149], v45 offset:49152
    ds_read_b64_tr_b16 a[150:151], v49 offset:49408
    s_waitcnt lgkmcnt(14)
    v_mfma_f32_16x16x32_bf16 v[96:99], a[100:103], a[100:103], v[96:99]
    ds_read_b64_tr_b16 a[152:153], v46 offset:49152
    ds_read_b64_tr_b16 a[154:155], v50 offset:49408
    v_mfma_f32_16x16x32_bf16 v[100:103], a[100:103], a[52:55], v[100:103]
    ds_read_b64_tr_b16 a[156:157], v47 offset:49152
    ds_read_b64_tr_b16 a[158:159], v51 offset:49408
    s_waitcnt lgkmcnt(15)
    v_mfma_f32_16x16x32_bf16 v[96:99], a[104:107], a[104:107], v[96:99]
    ds_read_b64_tr_b16 a[160:161], v48 offset:49152
    ds_read_b64_tr_b16 a[162:163], v44 offset:49664
    v_mfma_f32_16x16x32_bf16 v[100:103], a[104:107], a[56:59], v[100:103]
    ds_read_b64_tr_b16 a[164:165], v49 offset:49152
    ds_read_b64_tr_b16 a[166:167], v45 offset:49664
    v_mfma_f32_16x16x32_bf16 v[96:99], a[108:111], a[108:111], v[96:99]
    ds_read_b64_tr_b16 a[168:169], v50 offset:49152
    ds_read_b64_tr_b16 a[170:171], v46 offset:49664
    v_mfma_f32_16x16x32_bf16 v[100:103], a[108:111], a[60:63], v[100:103]
    ds_read_b64_tr_b16 a[172:173], v51 offset:49152
    ds_read_b64_tr_b16 a[174:175], v47 offset:49664
    v_mfma_f32_16x16x32_bf16 v[96:99], a[112:115], a[112:115], v[96:99]
    ds_read_b64_tr_b16 a[176:177], v44 offset:49408
    ds_read_b64_tr_b16 a[178:179], v48 offset:49664
    v_mfma_f32_16x16x32_bf16 v[100:103], a[112:115], a[64:67], v[100:103]
    ds_read_b64_tr_b16 a[180:181], v45 offset:49408
    ds_read_b64_tr_b16 a[182:183], v49 offset:49664
    s_waitcnt lgkmcnt(15)
    v_mfma_f32_16x16x32_bf16 v[96:99], a[116:119], a[116:119], v[96:99]
    ds_read_b64_tr_b16 a[184:185], v46 offset:49408
    ds_read_b64_tr_b16 a[186:187], v50 offset:49664
    v_mfma_f32_16x16x32_bf16 v[100:103], a[116:119], a[68:71], v[100:103]
    ds_read_b64_tr_b16 a[188:189], v47 offset:49408
    ds_read_b64_tr_b16 a[190:191], v51 offset:49664
    v_mfma_f32_16x16x32_bf16 v[92:95], a[96:99], v[52:55], v[80:83]
    v_mfma_f32_16x16x32_bf16 v[92:95], a[100:103], v[52:55], v[92:95]
    v_mfma_f32_16x16x32_bf16 v[92:95], a[104:107], v[52:55], v[92:95]
    v_mfma_f32_16x16x32_bf16 v[92:95], a[108:111], v[52:55], v[92:95]
    s_nop 1
    v_fma_f32 v96, v100, 2.0, v96
    v_fma_f32 v97, v101, 2.0, v97
    v_mfma_f32_16x16x32_bf16 v[92:95], a[112:115], v[52:55], v[92:95]
    v_fma_f32 v98, v102, 2.0, v98
    v_fma_f32 v99, v103, 2.0, v99
    v_mfma_f32_16x16x32_bf16 v[92:95], a[116:119], v[52:55], v[92:95]
    v_cndmask_b32 v3, 0, v96, s[44:45]
    v_cndmask_b32 v3, v3, v97, s[46:47]
    v_mfma_f32_16x16x32_bf16 v[88:91], a[96:99], v[136:139], v[76:79]
    v_cndmask_b32 v3, v3, v98, s[48:49]
    v_cndmask_b32 v3, v3, v99, s[50:51]
    v_mfma_f32_16x16x32_bf16 v[88:91], a[100:103], v[140:143], v[88:91]
    s_nop 0
    s_nop 0
    v_mfma_f32_16x16x32_bf16 v[88:91], a[104:107], v[144:147], v[88:91]
    v_mfma_f32_16x16x4_f32 v[120:123], v3, v60, v[56:59]
    v_mfma_f32_16x16x32_bf16 v[88:91], a[108:111], v[148:151], v[88:91]
    v_mfma_f32_16x16x32_bf16 v[88:91], a[112:115], v[152:155], v[88:91]
    v_mfma_f32_16x16x32_bf16 v[88:91], a[116:119], v[156:159], v[88:91]
    s_waitcnt lgkmcnt(0)
    s_add_u32 m0, s42, 0
    s_add_u32 s59, s37, 294912
    buffer_load_dwordx4 v22, s[24:27], s59 offen offset:0 nt lds
    buffer_load_dwordx4 v23, s[24:27], s59 offen offset:1024 nt lds
    buffer_load_dwordx4 v24, s[24:27], s59 offen offset:2048 nt lds
    buffer_load_dwordx4 v25, s[24:27], s59 offen offset:3072 nt lds
    s_add_u32 m0, s42, 4096
    s_nop 0
    buffer_load_dwordx4 v26, s[24:27], s59 offen offset:0 nt lds
    buffer_load_dwordx4 v27, s[24:27], s59 offen offset:1024 nt lds
    buffer_load_dwordx4 v28, s[24:27], s59 offen offset:2048 nt lds
    buffer_load_dwordx4 v29, s[24:27], s59 offen offset:3072 nt lds
    s_add_u32 m0, s42, 8192
    s_nop 0
    buffer_load_dwordx4 v30, s[24:27], s59 offen offset:0 nt lds
    buffer_load_dwordx4 v31, s[24:27], s59 offen offset:1024 nt lds
    buffer_load_dwordx4 v32, s[24:27], s59 offen offset:2048 nt lds
    buffer_load_dwordx4 v33, s[24:27], s59 offen offset:3072 nt lds
    v_mfma_f32_16x16x32_bf16 v[112:115], a[120:123], a[120:123], v[84:87]
    v_mfma_f32_16x16x32_bf16 v[116:119], a[120:123], a[48:51], 0
    v_mfma_f32_16x16x32_bf16 v[112:115], a[124:127], a[124:127], v[112:115]
    v_mfma_f32_16x16x32_bf16 v[116:119], a[124:127], a[52:55], v[116:119]
    v_fma_f32 v128, -v92, v92, v120
    v_fma_f32 v129, -v93, v93, v121
    v_mfma_f32_16x16x32_bf16 v[112:115], a[128:131], a[128:131], v[112:115]
    v_fma_f32 v130, -v94, v94, v122
    v_fma_f32 v131, -v95, v95, v123
    v_mfma_f32_16x16x32_bf16 v[116:119], a[128:131], a[56:59], v[116:119]
    v_max_f32 v128, v128, v56
    v_max_f32 v129, v129, v56
    v_mfma_f32_16x16x32_bf16 v[112:115], a[132:135], a[132:135], v[112:115]
    v_max_f32 v130, v130, v56
    v_max_f32 v131, v131, v56
    v_mfma_f32_16x16x32_bf16 v[116:119], a[132:135], a[60:63], v[116:119]
    v_rsq_f32 v128, v128
    v_mfma_f32_16x16x32_bf16 v[112:115], a[136:139], a[136:139], v[112:115]
    v_rsq_f32 v129, v129
    v_mfma_f32_16x16x32_bf16 v[116:119], a[136:139], a[64:67], v[116:119]
    v_rsq_f32 v130, v130
    v_mfma_f32_16x16x32_bf16 v[112:115], a[140:143], a[140:143], v[112:115]
    v_rsq_f32 v131, v131
    v_mfma_f32_16x16x32_bf16 v[116:119], a[140:143], a[68:71], v[116:119]
    v_fma_f32 v88, -v92, v61, v88
    v_fma_f32 v89, -v93, v61, v89
    v_mfma_f32_16x16x32_bf16 v[108:111], a[120:123], v[52:55], v[80:83]
    v_fma_f32 v90, -v94, v61, v90
    v_fma_f32 v91, -v95, v61, v91
    v_mfma_f32_16x16x32_bf16 v[108:111], a[124:127], v[52:55], v[108:111]
    v_fma_f32 v88, v88, v128, v62
    v_fma_f32 v89, v89, v129, v62
    v_mfma_f32_16x16x32_bf16 v[108:111], a[128:131], v[52:55], v[108:111]
    v_fma_f32 v90, v90, v130, v62
    v_fma_f32 v91, v91, v131, v62
    v_mfma_f32_16x16x32_bf16 v[108:111], a[132:135], v[52:55], v[108:111]
    v_max3_f32 v1, v88, v89, v90
    v_max_f32 v1, v1, v91
    v_mfma_f32_16x16x32_bf16 v[108:111], a[136:139], v[52:55], v[108:111]
    v_cmp_lt_f32 vcc, s52, v1
    s_cbranch_vccnz L_site5
L_back5:
    v_mfma_f32_16x16x32_bf16 v[108:111], a[140:143], v[52:55], v[108:111]
    v_exp_f32 v96, v88
    v_mfma_f32_16x16x32_bf16 v[104:107], a[120:123], v[136:139], v[76:79]
    v_exp_f32 v97, v89
    v_mfma_f32_16x16x32_bf16 v[104:107], a[124:127], v[140:143], v[104:107]
    v_exp_f32 v98, v90
    v_mfma_f32_16x16x32_bf16 v[104:107], a[128:131], v[144:147], v[104:107]
    v_exp_f32 v99, v91
    v_mfma_f32_16x16x32_bf16 v[104:107], a[132:135], v[148:151], v[104:107]
    v_mul_f32 v88, v96, v128
    v_mul_f32 v89, v97, v129
    v_mfma_f32_16x16x32_bf16 v[104:107], a[136:139], v[152:155], v[104:107]
    v_mul_f32 v90, v98, v130
    v_mul_f32 v91, v99, v131
    v_mfma_f32_16x16x32_bf16 v[104:107], a[140:143], v[156:159], v[104:107]
    v_fma_f32 v112, v116, 2.0, v112
    v_fma_f32 v113, v117, 2.0, v113
    v_fma_f32 v114, v118, 2.0, v114
    v_fma_f32 v115, v119, 2.0, v115
    v_cndmask_b32 v4, 0, v112, s[44:45]
    v_cndmask_b32 v4, v4, v113, s[46:47]
    v_cndmask_b32 v4, v4, v114, s[48:49]
    v_cndmask_b32 v4, v4, v115, s[50:51]
    v_add_f32 v63, v63, v96
    v_fmac_f32 v64, v88, v92
    v_mfma_f32_16x16x4_f32 v[124:127], v4, v60, v[56:59]
    v_add_f32 v63, v63, v97
    v_fmac_f32 v64, v89, v93
    v_add_f32 v63, v63, v98
    v_fmac_f32 v64, v90, v94
    v_add_f32 v63, v63, v99
    v_fmac_f32 v64, v91, v95
    v_add_f32 v68, v68, v88
    v_add_f32 v69, v69, v89
    v_add_f32 v70, v70, v90
    v_add_f32 v71, v71, v91
    v_fma_f32 v132, -v108, v108, v124
    v_fma_f32 v133, -v109, v109, v125
    v_fma_f32 v134, -v110, v110, v126
    v_fma_f32 v135, -v111, v111, v127
    v_max_f32 v132, v132, v56
    v_max_f32 v133, v133, v56
    v_max_f32 v134, v134, v56
    v_max_f32 v135, v135, v56
    v_rsq_f32 v132, v132
    v_rsq_f32 v133, v133
    v_rsq_f32 v134, v134
    v_rsq_f32 v135, v135
    v_fma_f32 v104, -v108, v61, v104
    v_fma_f32 v105, -v109, v61, v105
    v_fma_f32 v106, -v110, v61, v106
    v_fma_f32 v107, -v111, v61, v107
    v_fma_f32 v104, v104, v132, v62
    v_fma_f32 v105, v105, v133, v62
    v_fma_f32 v106, v106, v134, v62
    v_fma_f32 v107, v107, v135, v62
    v_max3_f32 v1, v104, v105, v106
    v_max_f32 v1, v1, v107
    v_cmp_lt_f32 vcc, s52, v1
    s_cbranch_vccnz L_site6
L_back6:
    v_exp_f32 v112, v104
    v_exp_f32 v113, v105
    v_exp_f32 v114, v106
    v_exp_f32 v115, v107
    v_mul_f32 v104, v112, v132
    v_mul_f32 v105, v113, v133
    v_mul_f32 v106, v114, v134
    v_mul_f32 v107, v115, v135
    v_cvt_pk_bf16_f32 v72, v88, v89
    v_cvt_pk_bf16_f32 v73, v90, v91
    v_cvt_pk_bf16_f32 v74, v104, v105
    v_cvt_pk_bf16_f32 v75, v106, v107
    s_nop 1
    v_mfma_f32_16x16x32_bf16 a[0:3], a[144:147], v[72:75], a[0:3]
    v_add_f32 v68, v68, v104
    v_add_f32 v69, v69, v105
    v_mfma_f32_16x16x32_bf16 a[4:7], a[148:151], v[72:75], a[4:7]
    v_add_f32 v70, v70, v106
    v_add_f32 v71, v71, v107
    v_mfma_f32_16x16x32_bf16 a[8:11], a[152:155], v[72:75], a[8:11]
    v_cvt_pk_bf16_f32 v66, v68, v69
    v_cvt_pk_bf16_f32 v67, v70, v71
    v_mfma_f32_16x16x32_bf16 a[12:15], a[156:159], v[72:75], a[12:15]
    v_add_f32 v63, v63, v112
    v_fmac_f32 v64, v104, v108
    v_mfma_f32_16x16x32_bf16 a[16:19], a[160:163], v[72:75], a[16:19]
    v_add_f32 v63, v63, v113
    v_fmac_f32 v64, v105, v109
    v_mfma_f32_16x16x32_bf16 a[20:23], a[164:167], v[72:75], a[20:23]
    v_add_f32 v63, v63, v114
    v_fmac_f32 v64, v106, v110
    v_mfma_f32_16x16x32_bf16 a[24:27], a[168:171], v[72:75], a[24:27]
    v_add_f32 v63, v63, v115
    v_fmac_f32 v64, v107, v111
    v_mfma_f32_16x16x32_bf16 a[28:31], a[172:175], v[72:75], a[28:31]
    v_mfma_f32_16x16x32_bf16 a[32:35], a[176:179], v[72:75], a[32:35]
    v_mfma_f32_16x16x32_bf16 a[36:39], a[180:183], v[72:75], a[36:39]
    v_mfma_f32_16x16x32_bf16 a[40:43], a[184:187], v[72:75], a[40:43]
    v_mfma_f32_16x16x32_bf16 a[44:47], a[188:191], v[72:75], a[44:47]
    v_mfma_f32_16x16x16_bf16 a[0:3], a[72:73], v[66:67], a[0:3]
    v_mfma_f32_16x16x16_bf16 a[4:7], a[74:75], v[66:67], a[4:7]
    v_mfma_f32_16x16x16_bf16 a[8:11], a[76:77], v[66:67], a[8:11]
    v_mfma_f32_16x16x16_bf16 a[12:15], a[78:79], v[66:67], a[12:15]
    v_mfma_f32_16x16x16_bf16 a[16:19], a[80:81], v[66:67], a[16:19]
    v_mfma_f32_16x16x16_bf16 a[20:23], a[82:83], v[66:67], a[20:23]
    v_mfma_f32_16x16x16_bf16 a[24:27], a[84:85], v[66:67], a[24:27]
    v_mfma_f32_16x16x16_bf16 a[28:31], a[86:87], v[66:67], a[28:31]
    v_mfma_f32_16x16x16_bf16 a[32:35], a[88:89], v[66:67], a[32:35]
    v_mfma_f32_16x16x16_bf16 a[36:39], a[90:91], v[66:67], a[36:39]
    v_mfma_f32_16x16x16_bf16 a[40:43], a[92:93], v[66:67], a[40:43]
    v_mfma_f32_16x16x16_bf16 a[44:47], a[94:95], v[66:67], a[44:47]
    s_waitcnt vmcnt(28)
    ds_read_b128 a[48:51], v34 offset:0
    ds_read_b128 a[52:55], v35 offset:0
    ds_read_b128 a[56:59], v34 offset:128
    ds_read_b128 a[60:63], v35 offset:128
    ds_read_b128 a[64:67], v34 offset:256
    ds_read_b128 a[68:71], v35 offset:256
    s_waitcnt lgkmcnt(5)
    v_mfma_f32_16x16x32_bf16 v[84:87], a[48:51], a[48:51], 0
    ds_read_b64_tr_b16 a[72:73], v36 offset:0
    ds_read_b64_tr_b16 a[74:75], v37 offset:0
    v_mfma_f32_16x16x32_bf16 v[80:83], a[48:51], v[52:55], 0
    ds_read_b64_tr_b16 a[76:77], v38 offset:0
    ds_read_b64_tr_b16 a[78:79], v39 offset:0
    s_waitcnt lgkmcnt(8)
    v_mfma_f32_16x16x32_bf16 v[84:87], a[52:55], a[52:55], v[84:87]
    ds_read_b64_tr_b16 a[80:81], v36 offset:128
    ds_read_b64_tr_b16 a[82:83], v37 offset:128
    v_mfma_f32_16x16x32_bf16 v[80:83], a[52:55], v[52:55], v[80:83]
    ds_read_b64_tr_b16 a[84:85], v38 offset:128
    ds_read_b64_tr_b16 a[86:87], v39 offset:128
    s_waitcnt lgkmcnt(11)
    v_mfma_f32_16x16x32_bf16 v[84:87], a[56:59], a[56:59], v[84:87]
    ds_read_b64_tr_b16 a[88:89], v36 offset:256
    ds_read_b64_tr_b16 a[90:91], v37 offset:256
    v_mfma_f32_16x16x32_bf16 v[80:83], a[56:59], v[52:55], v[80:83]
    ds_read_b64_tr_b16 a[92:93], v38 offset:256
    ds_read_b64_tr_b16 a[94:95], v39 offset:256
    s_waitcnt lgkmcnt(14)
    v_mfma_f32_16x16x32_bf16 v[84:87], a[60:63], a[60:63], v[84:87]
    v_mfma_f32_16x16x32_bf16 v[80:83], a[60:63], v[52:55], v[80:83]
    s_waitcnt lgkmcnt(13)
    v_mfma_f32_16x16x32_bf16 v[84:87], a[64:67], a[64:67], v[84:87]
    v_mfma_f32_16x16x32_bf16 v[80:83], a[64:67], v[52:55], v[80:83]
    s_waitcnt lgkmcnt(12)
    v_mfma_f32_16x16x32_bf16 v[84:87], a[68:71], a[68:71], v[84:87]
    v_mfma_f32_16x16x32_bf16 v[80:83], a[68:71], v[52:55], v[80:83]
    s_waitcnt lgkmcnt(0)
    s_add_u32 m0, s40, 0
    s_add_u32 s57, s36, 73728
    buffer_load_dwordx4 v16, s[28:31], s57 offen offset:0 nt lds
    buffer_load_dwordx4 v17, s[28:31], s57 offen offset:1024 nt lds
    buffer_load_dwordx4 v18, s[28:31], s57 offen offset:2048 nt lds
    buffer_load_dwordx4 v19, s[28:31], s57 offen offset:3072 nt lds
    s_add_u32 m0, s40, 4096
    s_nop 0
    buffer_load_dwordx4 v20, s[28:31], s57 offen offset:0 nt lds
    buffer_load_dwordx4 v21, s[28:31], s57 offen offset:1024 nt lds
    v_mfma_f32_16x16x32_bf16 v[76:79], a[48:51], v[136:139], 0
    v_mfma_f32_16x16x32_bf16 v[76:79], a[52:55], v[140:143], v[76:79]
    v_mfma_f32_16x16x32_bf16 v[76:79], a[56:59], v[144:147], v[76:79]
    v_mfma_f32_16x16x32_bf16 v[76:79], a[60:63], v[148:151], v[76:79]
    v_mfma_f32_16x16x32_bf16 v[76:79], a[64:67], v[152:155], v[76:79]
    v_mfma_f32_16x16x32_bf16 v[76:79], a[68:71], v[156:159], v[76:79]
    s_waitcnt vmcnt(18)
    ds_read_b128 a[96:99], v40 offset:0
    ds_read_b128 a[100:103], v41 offset:0
    ds_read_b128 a[104:107], v42 offset:0
    ds_read_b128 a[108:111], v43 offset:0
    ds_read_b128 a[112:115], v40 offset:256
    ds_read_b128 a[116:119], v41 offset:256
    ds_read_b128 a[120:123], v42 offset:256
    ds_read_b128 a[124:127], v43 offset:256
    ds_read_b128 a[128:131], v40 offset:512
    ds_read_b128 a[132:135], v41 offset:512
    ds_read_b128 a[136:139], v42 offset:512
    ds_read_b128 a[140:143], v43 offset:512
    s_waitcnt lgkmcnt(11)
    v_mfma_f32_16x16x32_bf16 v[96:99], a[96:99], a[96:99], v[84:87]
    ds_read_b64_tr_b16 a[144:145], v44 offset:0
    ds_read_b64_tr_b16 a[146:147], v48 offset:256
    v_mfma_f32_16x16x32_bf16 v[100:103], a[96:99], a[48:51], 0
    ds_read_b64_tr_b16 a[148:149], v45 offset:0
    ds_read_b64_tr_b16 a[150:151], v49 offset:256
    s_waitcnt lgkmcnt(14)
    v_mfma_f32_16x16x32_bf16 v[96:99], a[100:103], a[100:103], v[96:99]
    ds_read_b64_tr_b16 a[152:153], v46 offset:0
    ds_read_b64_tr_b16 a[154:155], v50 offset:256
    v_mfma_f32_16x16x32_bf16 v[100:103], a[100:103], a[52:55], v[100:103]
    ds_read_b64_tr_b16 a[156:157], v47 offset:0
    ds_read_b64_tr_b16 a[158:159], v51 offset:256
    s_waitcnt lgkmcnt(15)
    v_mfma_f32_16x16x32_bf16 v[96:99], a[104:107], a[104:107], v[96:99]
    ds_read_b64_tr_b16 a[160:161], v48 offset:0
    ds_read_b64_tr_b16 a[162:163], v44 offset:512
    v_mfma_f32_16x16x32_bf16 v[100:103], a[104:107], a[56:59], v[100:103]
    ds_read_b64_tr_b16 a[164:165], v49 offset:0
    ds_read_b64_tr_b16 a[166:167], v45 offset:512
    v_mfma_f32_16x16x32_bf16 v[96:99], a[108:111], a[108:111], v[96:99]
    ds_read_b64_tr_b16 a[168:169], v50 offset:0
    ds_read_b64_tr_b16 a[170:171], v46 offset:512
    v_mfma_f32_16x16x32_bf16 v[100:103], a[108:111], a[60:63], v[100:103]
    ds_read_b64_tr_b16 a[172:173], v51 offset:0
    ds_read_b64_tr_b16 a[174:175], v47 offset:512
    v_mfma_f32_16x16x32_bf16 v[96:99], a[112:115], a[112:115], v[96:99]
    ds_read_b64_tr_b16 a[176:177], v44 offset:256
    ds_read_b64_tr_b16 a[178:179], v48 offset:512
    v_mfma_f32_16x16x32_bf16 v[100:103], a[112:115], a[64:67], v[100:103]
    ds_read_b64_tr_b16 a[180:181], v45 offset:256
    ds_read_b64_tr_b16 a[182:183], v49 offset:512
    s_waitcnt lgkmcnt(15)
    v_mfma_f32_16x16x32_bf16 v[96:99], a[116:119], a[116:119], v[96:99]
    ds_read_b64_tr_b16 a[184:185], v46 offset:256
    ds_read_b64_tr_b16 a[186:187], v50 offset:512
    v_mfma_f32_16x16x32_bf16 v[100:103], a[116:119], a[68:71], v[100:103]
    ds_read_b64_tr_b16 a[188:189], v47 offset:256
    ds_read_b64_tr_b16 a[190:191], v51 offset:512
    v_mfma_f32_16x16x32_bf16 v[92:95], a[96:99], v[52:55], v[80:83]
    v_mfma_f32_16x16x32_bf16 v[92:95], a[100:103], v[52:55], v[92:95]
    v_mfma_f32_16x16x32_bf16 v[92:95], a[104:107], v[52:55], v[92:95]
    v_mfma_f32_16x16x32_bf16 v[92:95], a[108:111], v[52:55], v[92:95]
    s_nop 1
    v_fma_f32 v96, v100, 2.0, v96
    v_fma_f32 v97, v101, 2.0, v97
    v_mfma_f32_16x16x32_bf16 v[92:95], a[112:115], v[52:55], v[92:95]
    v_fma_f32 v98, v102, 2.0, v98
    v_fma_f32 v99, v103, 2.0, v99
    v_mfma_f32_16x16x32_bf16 v[92:95], a[116:119], v[52:55], v[92:95]
    v_cndmask_b32 v3, 0, v96, s[44:45]
    v_cndmask_b32 v3, v3, v97, s[46:47]
    v_mfma_f32_16x16x32_bf16 v[88:91], a[96:99], v[136:139], v[76:79]
    v_cndmask_b32 v3, v3, v98, s[48:49]
    v_cndmask_b32 v3, v3, v99, s[50:51]
    v_mfma_f32_16x16x32_bf16 v[88:91], a[100:103], v[140:143], v[88:91]
    s_nop 0
    s_nop 0
    v_mfma_f32_16x16x32_bf16 v[88:91], a[104:107], v[144:147], v[88:91]
    v_mfma_f32_16x16x4_f32 v[120:123], v3, v60, v[56:59]
    v_mfma_f32_16x16x32_bf16 v[88:91], a[108:111], v[148:151], v[88:91]
    v_mfma_f32_16x16x32_bf16 v[88:91], a[112:115], v[152:155], v[88:91]
    v_mfma_f32_16x16x32_bf16 v[88:91], a[116:119], v[156:159], v[88:91]
    s_waitcnt lgkmcnt(0)
    s_add_u32 m0, s41, 0
    s_add_u32 s58, s37, 147456
    buffer_load_dwordx4 v22, s[24:27], s58 offen offset:0 nt lds
    buffer_load_dwordx4 v23, s[24:27], s58 offen offset:1024 nt lds
    buffer_load_dwordx4 v24, s[24:27], s58 offen offset:2048 nt lds
    buffer_load_dwordx4 v25, s[24:27], s58 offen offset:3072 nt lds
    s_add_u32 m0, s41, 4096
    s_nop 0
    buffer_load_dwordx4 v26, s[24:27], s58 offen offset:0 nt lds
    buffer_load_dwordx4 v27, s[24:27], s58 offen offset:1024 nt lds
    buffer_load_dwordx4 v28, s[24:27], s58 offen offset:2048 nt lds
    buffer_load_dwordx4 v29, s[24:27], s58 offen offset:3072 nt lds
    s_add_u32 m0, s41, 8192
    s_nop 0
    buffer_load_dwordx4 v30, s[24:27], s58 offen offset:0 nt lds
    buffer_load_dwordx4 v31, s[24:27], s58 offen offset:1024 nt lds
    buffer_load_dwordx4 v32, s[24:27], s58 offen offset:2048 nt lds
    buffer_load_dwordx4 v33, s[24:27], s58 offen offset:3072 nt lds
    v_mfma_f32_16x16x32_bf16 v[112:115], a[120:123], a[120:123], v[84:87]
    v_mfma_f32_16x16x32_bf16 v[116:119], a[120:123], a[48:51], 0
    v_mfma_f32_16x16x32_bf16 v[112:115], a[124:127], a[124:127], v[112:115]
    v_mfma_f32_16x16x32_bf16 v[116:119], a[124:127], a[52:55], v[116:119]
    v_fma_f32 v128, -v92, v92, v120
    v_fma_f32 v129, -v93, v93, v121
    v_mfma_f32_16x16x32_bf16 v[112:115], a[128:131], a[128:131], v[112:115]
    v_fma_f32 v130, -v94, v94, v122
    v_fma_f32 v131, -v95, v95, v123
    v_mfma_f32_16x16x32_bf16 v[116:119], a[128:131], a[56:59], v[116:119]
    v_max_f32 v128, v128, v56
    v_max_f32 v129, v129, v56
    v_mfma_f32_16x16x32_bf16 v[112:115], a[132:135], a[132:135], v[112:115]
    v_max_f32 v130, v130, v56
    v_max_f32 v131, v131, v56
    v_mfma_f32_16x16x32_bf16 v[116:119], a[132:135], a[60:63], v[116:119]
    v_rsq_f32 v128, v128
    v_mfma_f32_16x16x32_bf16 v[112:115], a[136:139], a[136:139], v[112:115]
    v_rsq_f32 v129, v129
    v_mfma_f32_16x16x32_bf16 v[116:119], a[136:139], a[64:67], v[116:119]
    v_rsq_f32 v130, v130
    v_mfma_f32_16x16x32_bf16 v[112:115], a[140:143], a[140:143], v[112:115]
    v_rsq_f32 v131, v131
    v_mfma_f32_16x16x32_bf16 v[116:119], a[140:143], a[68:71], v[116:119]
    v_fma_f32 v88, -v92, v61, v88
    v_fma_f32 v89, -v93, v61, v89
    v_mfma_f32_16x16x32_bf16 v[108:111], a[120:123], v[52:55], v[80:83]
    v_fma_f32 v90, -v94, v61, v90
    v_fma_f32 v91, -v95, v61, v91
    v_mfma_f32_16x16x32_bf16 v[108:111], a[124:127], v[52:55], v[108:111]
    v_fma_f32 v88, v88, v128, v62
    v_fma_f32 v89, v89, v129, v62
    v_mfma_f32_16x16x32_bf16 v[108:111], a[128:131], v[52:55], v[108:111]
    v_fma_f32 v90, v90, v130, v62
    v_fma_f32 v91, v91, v131, v62
    v_mfma_f32_16x16x32_bf16 v[108:111], a[132:135], v[52:55], v[108:111]
    v_max3_f32 v1, v88, v89, v90
    v_max_f32 v1, v1, v91
    v_mfma_f32_16x16x32_bf16 v[108:111], a[136:139], v[52:55], v[108:111]
    v_cmp_lt_f32 vcc, s52, v1
    s_cbranch_vccnz L_site7
L_back7:
    v_mfma_f32_16x16x32_bf16 v[108:111], a[140:143], v[52:55], v[108:111]
    v_exp_f32 v96, v88
    v_mfma_f32_16x16x32_bf16 v[104:107], a[120:123], v[136:139], v[76:79]
    v_exp_f32 v97, v89
    v_mfma_f32_16x16x32_bf16 v[104:107], a[124:127], v[140:143], v[104:107]
    v_exp_f32 v98, v90
    v_mfma_f32_16x16x32_bf16 v[104:107], a[128:131], v[144:147], v[104:107]
    v_exp_f32 v99, v91
    v_mfma_f32_16x16x32_bf16 v[104:107], a[132:135], v[148:151], v[104:107]
    v_mul_f32 v88, v96, v128
    v_mul_f32 v89, v97, v129
    v_mfma_f32_16x16x32_bf16 v[104:107], a[136:139], v[152:155], v[104:107]
    v_mul_f32 v90, v98, v130
    v_mul_f32 v91, v99, v131
    v_mfma_f32_16x16x32_bf16 v[104:107], a[140:143], v[156:159], v[104:107]
    v_fma_f32 v112, v116, 2.0, v112
    v_fma_f32 v113, v117, 2.0, v113
    v_fma_f32 v114, v118, 2.0, v114
    v_fma_f32 v115, v119, 2.0, v115
    v_cndmask_b32 v4, 0, v112, s[44:45]
    v_cndmask_b32 v4, v4, v113, s[46:47]
    v_cndmask_b32 v4, v4, v114, s[48:49]
    v_cndmask_b32 v4, v4, v115, s[50:51]
    v_add_f32 v63, v63, v96
    v_fmac_f32 v64, v88, v92
    v_mfma_f32_16x16x4_f32 v[124:127], v4, v60, v[56:59]
    v_add_f32 v63, v63, v97
    v_fmac_f32 v64, v89, v93
    v_add_f32 v63, v63, v98
    v_fmac_f32 v64, v90, v94
    v_add_f32 v63, v63, v99
    v_fmac_f32 v64, v91, v95
    v_mov_b32 v68, v88
    v_mov_b32 v69, v89
    v_mov_b32 v70, v90
    v_mov_b32 v71, v91
    v_fma_f32 v132, -v108, v108, v124
    v_fma_f32 v133, -v109, v109, v125
    v_fma_f32 v134, -v110, v110, v126
    v_fma_f32 v135, -v111, v111, v127
    v_max_f32 v132, v132, v56
    v_max_f32 v133, v133, v56
    v_max_f32 v134, v134, v56
    v_max_f32 v135, v135, v56
    v_rsq_f32 v132, v132
    v_rsq_f32 v133, v133
    v_rsq_f32 v134, v134
    v_rsq_f32 v135, v135
    v_fma_f32 v104, -v108, v61, v104
    v_fma_f32 v105, -v109, v61, v105
    v_fma_f32 v106, -v110, v61, v106
    v_fma_f32 v107, -v111, v61, v107
    v_fma_f32 v104, v104, v132, v62
    v_fma_f32 v105, v105, v133, v62
    v_fma_f32 v106, v106, v134, v62
    v_fma_f32 v107, v107, v135, v62
    v_max3_f32 v1, v104, v105, v106
    v_max_f32 v1, v1, v107
    v_cmp_lt_f32 vcc, s52, v1
    s_cbranch_vccnz L_site8
L_back8:
    v_exp_f32 v112, v104
    v_exp_f32 v113, v105
    v_exp_f32 v114, v106
    v_exp_f32 v115, v107
    v_mul_f32 v104, v112, v132
    v_mul_f32 v105, v113, v133
    v_mul_f32 v106, v114, v134
    v_mul_f32 v107, v115, v135
    v_cvt_pk_bf16_f32 v72, v88, v89
    v_cvt_pk_bf16_f32 v73, v90, v91
    v_cvt_pk_bf16_f32 v74, v104, v105
    v_cvt_pk_bf16_f32 v75, v106, v107
    s_nop 1
    v_mfma_f32_16x16x32_bf16 a[0:3], a[144:147], v[72:75], a[0:3]
    v_add_f32 v63, v63, v112
    v_fmac_f32 v64, v104, v108
    v_mfma_f32_16x16x32_bf16 a[4:7], a[148:151], v[72:75], a[4:7]
    v_add_f32 v63, v63, v113
    v_fmac_f32 v64, v105, v109
    v_mfma_f32_16x16x32_bf16 a[8:11], a[152:155], v[72:75], a[8:11]
    v_add_f32 v63, v63, v114
    v_fmac_f32 v64, v106, v110
    v_mfma_f32_16x16x32_bf16 a[12:15], a[156:159], v[72:75], a[12:15]
    v_add_f32 v63, v63, v115
    v_fmac_f32 v64, v107, v111
    v_mfma_f32_16x16x32_bf16 a[16:19], a[160:163], v[72:75], a[16:19]
    v_add_f32 v68, v68, v104
    v_add_f32 v69, v69, v105
    v_mfma_f32_16x16x32_bf16 a[20:23], a[164:167], v[72:75], a[20:23]
    v_add_f32 v70, v70, v106
    v_add_f32 v71, v71, v107
    v_mfma_f32_16x16x32_bf16 a[24:27], a[168:171], v[72:75], a[24:27]
    v_mfma_f32_16x16x32_bf16 a[28:31], a[172:175], v[72:75], a[28:31]
    v_mfma_f32_16x16x32_bf16 a[32:35], a[176:179], v[72:75], a[32:35]
    v_mfma_f32_16x16x32_bf16 a[36:39], a[180:183], v[72:75], a[36:39]
    v_mfma_f32_16x16x32_bf16 a[40:43], a[184:187], v[72:75], a[40:43]
    v_mfma_f32_16x16x32_bf16 a[44:47], a[188:191], v[72:75], a[44:47]
    s_waitcnt vmcnt(18)
    ds_read_b128 a[96:99], v40 offset:49152
    ds_read_b128 a[100:103], v41 offset:49152
    ds_read_b128 a[104:107], v42 offset:49152
    ds_read_b128 a[108:111], v43 offset:49152
    ds_read_b128 a[112:115], v40 offset:49408
    ds_read_b128 a[116:119], v41 offset:49408
    ds_read_b128 a[120:123], v42 offset:49408
    ds_read_b128 a[124:127], v43 offset:49408
    ds_read_b128 a[128:131], v40 offset:49664
    ds_read_b128 a[132:135], v41 offset:49664
    ds_read_b128 a[136:139], v42 offset:49664
    ds_read_b128 a[140:143], v43 offset:49664
    s_waitcnt lgkmcnt(11)
    v_mfma_f32_16x16x32_bf16 v[96:99], a[96:99], a[96:99], v[84:87]
    ds_read_b64_tr_b16 a[144:145], v44 offset:49152
    ds_read_b64_tr_b16 a[146:147], v48 offset:49408
    v_mfma_f32_16x16x32_bf16 v[100:103], a[96:99], a[48:51], 0
    ds_read_b64_tr_b16 a[148:149], v45 offset:49152
    ds_read_b64_tr_b16 a[150:151], v49 offset:49408
    s_waitcnt lgkmcnt(14)
    v_mfma_f32_16x16x32_bf16 v[96:99], a[100:103], a[100:103], v[96:99]
    ds_read_b64_tr_b16 a[152:153], v46 offset:49152
    ds_read_b64_tr_b16 a[154:155], v50 offset:49408
    v_mfma_f32_16x16x32_bf16 v[100:103], a[100:103], a[52:55], v[100:103]
    ds_read_b64_tr_b16 a[156:157], v47 offset:49152
    ds_read_b64_tr_b16 a[158:159], v51 offset:49408
    s_waitcnt lgkmcnt(15)
    v_mfma_f32_16x16x32_bf16 v[96:99], a[104:107], a[104:107], v[96:99]
    ds_read_b64_tr_b16 a[160:161], v48 offset:49152
    ds_read_b64_tr_b16 a[162:163], v44 offset:49664
    v_mfma_f32_16x16x32_bf16 v[100:103], a[104:107], a[56:59], v[100:103]
    ds_read_b64_tr_b16 a[164:165], v49 offset:49152
    ds_read_b64_tr_b16 a[166:167], v45 offset:49664
    v_mfma_f32_16x16x32_bf16 v[96:99], a[108:111], a[108:111], v[96:99]
    ds_read_b64_tr_b16 a[168:169], v50 offset:49152
    ds_read_b64_tr_b16 a[170:171], v46 offset:49664
    v_mfma_f32_16x16x32_bf16 v[100:103], a[108:111], a[60:63], v[100:103]
    ds_read_b64_tr_b16 a[172:173], v51 offset:49152
    ds_read_b64_tr_b16 a[174:175], v47 offset:49664
    v_mfma_f32_16x16x32_bf16 v[96:99], a[112:115], a[112:115], v[96:99]
    ds_read_b64_tr_b16 a[176:177], v44 offset:49408
    ds_read_b64_tr_b16 a[178:179], v48 offset:49664
    v_mfma_f32_16x16x32_bf16 v[100:103], a[112:115], a[64:67], v[100:103]
    ds_read_b64_tr_b16 a[180:181], v45 offset:49408
    ds_read_b64_tr_b16 a[182:183], v49 offset:49664
    s_waitcnt lgkmcnt(15)
    v_mfma_f32_16x16x32_bf16 v[96:99], a[116:119], a[116:119], v[96:99]
    ds_read_b64_tr_b16 a[184:185], v46 offset:49408
    ds_read_b64_tr_b16 a[186:187], v50 offset:49664
    v_mfma_f32_16x16x32_bf16 v[100:103], a[116:119], a[68:71], v[100:103]
    ds_read_b64_tr_b16 a[188:189], v47 offset:49408
    ds_read_b64_tr_b16 a[190:191], v51 offset:49664
    v_mfma_f32_16x16x32_bf16 v[92:95], a[96:99], v[52:55], v[80:83]
    v_mfma_f32_16x16x32_bf16 v[92:95], a[100:103], v[52:55], v[92:95]
    v_mfma_f32_16x16x32_bf16 v[92:95], a[104:107], v[52:55], v[92:95]
    v_mfma_f32_16x16x32_bf16 v[92:95], a[108:111], v[52:55], v[92:95]
    s_nop 1
    v_fma_f32 v96, v100, 2.0, v96
    v_fma_f32 v97, v101, 2.0, v97
    v_mfma_f32_16x16x32_bf16 v[92:95], a[112:115], v[52:55], v[92:95]
    v_fma_f32 v98, v102, 2.0, v98
    v_fma_f32 v99, v103, 2.0, v99
    v_mfma_f32_16x16x32_bf16 v[92:95], a[116:119], v[52:55], v[92:95]
    v_cndmask_b32 v3, 0, v96, s[44:45]
    v_cndmask_b32 v3, v3, v97, s[46:47]
    v_mfma_f32_16x16x32_bf16 v[88:91], a[96:99], v[136:139], v[76:79]
    v_cndmask_b32 v3, v3, v98, s[48:49]
    v_cndmask_b32 v3, v3, v99, s[50:51]
    v_mfma_f32_16x16x32_bf16 v[88:91], a[100:103], v[140:143], v[88:91]
    s_nop 0
    s_nop 0
    v_mfma_f32_16x16x32_bf16 v[88:91], a[104:107], v[144:147], v[88:91]
    v_mfma_f32_16x16x4_f32 v[120:123], v3, v60, v[56:59]
    v_mfma_f32_16x16x32_bf16 v[88:91], a[108:111], v[148:151], v[88:91]
    v_mfma_f32_16x16x32_bf16 v[88:91], a[112:115], v[152:155], v[88:91]
    v_mfma_f32_16x16x32_bf16 v[88:91], a[116:119], v[156:159], v[88:91]
    s_waitcnt lgkmcnt(0)
    s_add_u32 m0, s42, 0
    s_add_u32 s59, s37, 344064
    buffer_load_dwordx4 v22, s[24:27], s59 offen offset:0 nt lds
    buffer_load_dwordx4 v23, s[24:27], s59 offen offset:1024 nt lds
    buffer_load_dwordx4 v24, s[24:27], s59 offen offset:2048 nt lds
    buffer_load_dwordx4 v25, s[24:27], s59 offen offset:3072 nt lds
    s_add_u32 m0, s42, 4096
    s_nop 0
    buffer_load_dwordx4 v26, s[24:27], s59 offen offset:0 nt lds
    buffer_load_dwordx4 v27, s[24:27], s59 offen offset:1024 nt lds
    buffer_load_dwordx4 v28, s[24:27], s59 offen offset:2048 nt lds
    buffer_load_dwordx4 v29, s[24:27], s59 offen offset:3072 nt lds
    s_add_u32 m0, s42, 8192
    s_nop 0
    buffer_load_dwordx4 v30, s[24:27], s59 offen offset:0 nt lds
    buffer_load_dwordx4 v31, s[24:27], s59 offen offset:1024 nt lds
    buffer_load_dwordx4 v32, s[24:27], s59 offen offset:2048 nt lds
    buffer_load_dwordx4 v33, s[24:27], s59 offen offset:3072 nt lds
    v_mfma_f32_16x16x32_bf16 v[112:115], a[120:123], a[120:123], v[84:87]
    v_mfma_f32_16x16x32_bf16 v[116:119], a[120:123], a[48:51], 0
    v_mfma_f32_16x16x32_bf16 v[112:115], a[124:127], a[124:127], v[112:115]
    v_mfma_f32_16x16x32_bf16 v[116:119], a[124:127], a[52:55], v[116:119]
    v_fma_f32 v128, -v92, v92, v120
    v_fma_f32 v129, -v93, v93, v121
    v_mfma_f32_16x16x32_bf16 v[112:115], a[128:131], a[128:131], v[112:115]
    v_fma_f32 v130, -v94, v94, v122
    v_fma_f32 v131, -v95, v95, v123
    v_mfma_f32_16x16x32_bf16 v[116:119], a[128:131], a[56:59], v[116:119]
    v_max_f32 v128, v128, v56
    v_max_f32 v129, v129, v56
    v_mfma_f32_16x16x32_bf16 v[112:115], a[132:135], a[132:135], v[112:115]
    v_max_f32 v130, v130, v56
    v_max_f32 v131, v131, v56
    v_mfma_f32_16x16x32_bf16 v[116:119], a[132:135], a[60:63], v[116:119]
    v_rsq_f32 v128, v128
    v_mfma_f32_16x16x32_bf16 v[112:115], a[136:139], a[136:139], v[112:115]
    v_rsq_f32 v129, v129
    v_mfma_f32_16x16x32_bf16 v[116:119], a[136:139], a[64:67], v[116:119]
    v_rsq_f32 v130, v130
    v_mfma_f32_16x16x32_bf16 v[112:115], a[140:143], a[140:143], v[112:115]
    v_rsq_f32 v131, v131
    v_mfma_f32_16x16x32_bf16 v[116:119], a[140:143], a[68:71], v[116:119]
    v_fma_f32 v88, -v92, v61, v88
    v_fma_f32 v89, -v93, v61, v89
    v_mfma_f32_16x16x32_bf16 v[108:111], a[120:123], v[52:55], v[80:83]
    v_fma_f32 v90, -v94, v61, v90
    v_fma_f32 v91, -v95, v61, v91
    v_mfma_f32_16x16x32_bf16 v[108:111], a[124:127], v[52:55], v[108:111]
    v_fma_f32 v88, v88, v128, v62
    v_fma_f32 v89, v89, v129, v62
    v_mfma_f32_16x16x32_bf16 v[108:111], a[128:131], v[52:55], v[108:111]
    v_fma_f32 v90, v90, v130, v62
    v_fma_f32 v91, v91, v131, v62
    v_mfma_f32_16x16x32_bf16 v[108:111], a[132:135], v[52:55], v[108:111]
    v_max3_f32 v1, v88, v89, v90
    v_max_f32 v1, v1, v91
    v_mfma_f32_16x16x32_bf16 v[108:111], a[136:139], v[52:55], v[108:111]
    v_cmp_lt_f32 vcc, s52, v1
    s_cbranch_vccnz L_site9
L_back9:
    v_mfma_f32_16x16x32_bf16 v[108:111], a[140:143], v[52:55], v[108:111]
    v_exp_f32 v96, v88
    v_mfma_f32_16x16x32_bf16 v[104:107], a[120:123], v[136:139], v[76:79]
    v_exp_f32 v97, v89
    v_mfma_f32_16x16x32_bf16 v[104:107], a[124:127], v[140:143], v[104:107]
    v_exp_f32 v98, v90
    v_mfma_f32_16x16x32_bf16 v[104:107], a[128:131], v[144:147], v[104:107]
    v_exp_f32 v99, v91
    v_mfma_f32_16x16x32_bf16 v[104:107], a[132:135], v[148:151], v[104:107]
    v_mul_f32 v88, v96, v128
    v_mul_f32 v89, v97, v129
    v_mfma_f32_16x16x32_bf16 v[104:107], a[136:139], v[152:155], v[104:107]
    v_mul_f32 v90, v98, v130
    v_mul_f32 v91, v99, v131
    v_mfma_f32_16x16x32_bf16 v[104:107], a[140:143], v[156:159], v[104:107]
    v_fma_f32 v112, v116, 2.0, v112
    v_fma_f32 v113, v117, 2.0, v113
    v_fma_f32 v114, v118, 2.0, v114
    v_fma_f32 v115, v119, 2.0, v115
    v_cndmask_b32 v4, 0, v112, s[44:45]
    v_cndmask_b32 v4, v4, v113, s[46:47]
    v_cndmask_b32 v4, v4, v114, s[48:49]
    v_cndmask_b32 v4, v4, v115, s[50:51]
    v_add_f32 v63, v63, v96
    v_fmac_f32 v64, v88, v92
    v_mfma_f32_16x16x4_f32 v[124:127], v4, v60, v[56:59]
    v_add_f32 v63, v63, v97
    v_fmac_f32 v64, v89, v93
    v_add_f32 v63, v63, v98
    v_fmac_f32 v64, v90, v94
    v_add_f32 v63, v63, v99
    v_fmac_f32 v64, v91, v95
    v_add_f32 v68, v68, v88
    v_add_f32 v69, v69, v89
    v_add_f32 v70, v70, v90
    v_add_f32 v71, v71, v91
    v_fma_f32 v132, -v108, v108, v124
    v_fma_f32 v133, -v109, v109, v125
    v_fma_f32 v134, -v110, v110, v126
    v_fma_f32 v135, -v111, v111, v127
    v_max_f32 v132, v132, v56
    v_max_f32 v133, v133, v56
    v_max_f32 v134, v134, v56
    v_max_f32 v135, v135, v56
    v_rsq_f32 v132, v132
    v_rsq_f32 v133, v133
    v_rsq_f32 v134, v134
    v_rsq_f32 v135, v135
    v_fma_f32 v104, -v108, v61, v104
    v_fma_f32 v105, -v109, v61, v105
    v_fma_f32 v106, -v110, v61, v106
    v_fma_f32 v107, -v111, v61, v107
    v_fma_f32 v104, v104, v132, v62
    v_fma_f32 v105, v105, v133, v62
    v_fma_f32 v106, v106, v134, v62
    v_fma_f32 v107, v107, v135, v62
    v_max3_f32 v1, v104, v105, v106
    v_max_f32 v1, v1, v107
    v_cmp_lt_f32 vcc, s52, v1
    s_cbranch_vccnz L_site10
L_back10:
    v_exp_f32 v112, v104
    v_exp_f32 v113, v105
    v_exp_f32 v114, v106
    v_exp_f32 v115, v107
    v_mul_f32 v104, v112, v132
    v_mul_f32 v105, v113, v133
    v_mul_f32 v106, v114, v134
    v_mul_f32 v107, v115, v135
    v_cvt_pk_bf16_f32 v72, v88, v89
    v_cvt_pk_bf16_f32 v73, v90, v91
    v_cvt_pk_bf16_f32 v74, v104, v105
    v_cvt_pk_bf16_f32 v75, v106, v107
    s_nop 1
    v_mfma_f32_16x16x32_bf16 a[0:3], a[144:147], v[72:75], a[0:3]
    v_add_f32 v68, v68, v104
    v_add_f32 v69, v69, v105
    v_mfma_f32_16x16x32_bf16 a[4:7], a[148:151], v[72:75], a[4:7]
    v_add_f32 v70, v70, v106
    v_add_f32 v71, v71, v107
    v_mfma_f32_16x16x32_bf16 a[8:11], a[152:155], v[72:75], a[8:11]
    v_cvt_pk_bf16_f32 v66, v68, v69
    v_cvt_pk_bf16_f32 v67, v70, v71
    v_mfma_f32_16x16x32_bf16 a[12:15], a[156:159], v[72:75], a[12:15]
    v_add_f32 v63, v63, v112
    v_fmac_f32 v64, v104, v108
    v_mfma_f32_16x16x32_bf16 a[16:19], a[160:163], v[72:75], a[16:19]
    v_add_f32 v63, v63, v113
    v_fmac_f32 v64, v105, v109
    v_mfma_f32_16x16x32_bf16 a[20:23], a[164:167], v[72:75], a[20:23]
    v_add_f32 v63, v63, v114
    v_fmac_f32 v64, v106, v110
    v_mfma_f32_16x16x32_bf16 a[24:27], a[168:171], v[72:75], a[24:27]
    v_add_f32 v63, v63, v115
    v_fmac_f32 v64, v107, v111
    v_mfma_f32_16x16x32_bf16 a[28:31], a[172:175], v[72:75], a[28:31]
    v_mfma_f32_16x16x32_bf16 a[32:35], a[176:179], v[72:75], a[32:35]
    v_mfma_f32_16x16x32_bf16 a[36:39], a[180:183], v[72:75], a[36:39]
    v_mfma_f32_16x16x32_bf16 a[40:43], a[184:187], v[72:75], a[40:43]
    v_mfma_f32_16x16x32_bf16 a[44:47], a[188:191], v[72:75], a[44:47]
    v_mfma_f32_16x16x16_bf16 a[0:3], a[72:73], v[66:67], a[0:3]
    v_mfma_f32_16x16x16_bf16 a[4:7], a[74:75], v[66:67], a[4:7]
    v_mfma_f32_16x16x16_bf16 a[8:11], a[76:77], v[66:67], a[8:11]
    v_mfma_f32_16x16x16_bf16 a[12:15], a[78:79], v[66:67], a[12:15]
    v_mfma_f32_16x16x16_bf16 a[16:19], a[80:81], v[66:67], a[16:19]
    v_mfma_f32_16x16x16_bf16 a[20:23], a[82:83], v[66:67], a[20:23]
    v_mfma_f32_16x16x16_bf16 a[24:27], a[84:85], v[66:67], a[24:27]
    v_mfma_f32_16x16x16_bf16 a[28:31], a[86:87], v[66:67], a[28:31]
    v_mfma_f32_16x16x16_bf16 a[32:35], a[88:89], v[66:67], a[32:35]
    v_mfma_f32_16x16x16_bf16 a[36:39], a[90:91], v[66:67], a[36:39]
    v_mfma_f32_16x16x16_bf16 a[40:43], a[92:93], v[66:67], a[40:43]
    v_mfma_f32_16x16x16_bf16 a[44:47], a[94:95], v[66:67], a[44:47]
    s_waitcnt vmcnt(24)
    ds_read_b128 a[48:51], v34 offset:0
    ds_read_b128 a[52:55], v35 offset:0
    ds_read_b128 a[56:59], v34 offset:128
    ds_read_b128 a[60:63], v35 offset:128
    ds_read_b128 a[64:67], v34 offset:256
    ds_read_b128 a[68:71], v35 offset:256
    s_waitcnt lgkmcnt(5)
    v_mfma_f32_16x16x32_bf16 v[84:87], a[48:51], a[48:51], 0
    ds_read_b64_tr_b16 a[72:73], v36 offset:0
    ds_read_b64_tr_b16 a[74:75], v37 offset:0
    v_mfma_f32_16x16x32_bf16 v[80:83], a[48:51], v[52:55], 0
    ds_read_b64_tr_b16 a[76:77], v38 offset:0
    ds_read_b64_tr_b16 a[78:79], v39 offset:0
    s_waitcnt lgkmcnt(8)
    v_mfma_f32_16x16x32_bf16 v[84:87], a[52:55], a[52:55], v[84:87]
    ds_read_b64_tr_b16 a[80:81], v36 offset:128
    ds_read_b64_tr_b16 a[82:83], v37 offset:128
    v_mfma_f32_16x16x32_bf16 v[80:83], a[52:55], v[52:55], v[80:83]
    ds_read_b64_tr_b16 a[84:85], v38 offset:128
    ds_read_b64_tr_b16 a[86:87], v39 offset:128
    s_waitcnt lgkmcnt(11)
    v_mfma_f32_16x16x32_bf16 v[84:87], a[56:59], a[56:59], v[84:87]
    ds_read_b64_tr_b16 a[88:89], v36 offset:256
    ds_read_b64_tr_b16 a[90:91], v37 offset:256
    v_mfma_f32_16x16x32_bf16 v[80:83], a[56:59], v[52:55], v[80:83]
    ds_read_b64_tr_b16 a[92:93], v38 offset:256
    ds_read_b64_tr_b16 a[94:95], v39 offset:256
    s_waitcnt lgkmcnt(14)
    v_mfma_f32_16x16x32_bf16 v[84:87], a[60:63], a[60:63], v[84:87]
    v_mfma_f32_16x16x32_bf16 v[80:83], a[60:63], v[52:55], v[80:83]
    s_waitcnt lgkmcnt(13)
    v_mfma_f32_16x16x32_bf16 v[84:87], a[64:67], a[64:67], v[84:87]
    v_mfma_f32_16x16x32_bf16 v[80:83], a[64:67], v[52:55], v[80:83]
    s_waitcnt lgkmcnt(12)
    v_mfma_f32_16x16x32_bf16 v[84:87], a[68:71], a[68:71], v[84:87]
    v_mfma_f32_16x16x32_bf16 v[80:83], a[68:71], v[52:55], v[80:83]
    s_waitcnt lgkmcnt(0)
    v_mfma_f32_16x16x32_bf16 v[76:79], a[48:51], v[136:139], 0
    v_mfma_f32_16x16x32_bf16 v[76:79], a[52:55], v[140:143], v[76:79]
    v_mfma_f32_16x16x32_bf16 v[76:79], a[56:59], v[144:147], v[76:79]
    v_mfma_f32_16x16x32_bf16 v[76:79], a[60:63], v[148:151], v[76:79]
    v_mfma_f32_16x16x32_bf16 v[76:79], a[64:67], v[152:155], v[76:79]
    v_mfma_f32_16x16x32_bf16 v[76:79], a[68:71], v[156:159], v[76:79]
    s_waitcnt vmcnt(12)
    ds_read_b128 a[96:99], v40 offset:0
    ds_read_b128 a[100:103], v41 offset:0
    ds_read_b128 a[104:107], v42 offset:0
    ds_read_b128 a[108:111], v43 offset:0
    ds_read_b128 a[112:115], v40 offset:256
    ds_read_b128 a[116:119], v41 offset:256
    ds_read_b128 a[120:123], v42 offset:256
    ds_read_b128 a[124:127], v43 offset:256
    ds_read_b128 a[128:131], v40 offset:512
    ds_read_b128 a[132:135], v41 offset:512
    ds_read_b128 a[136:139], v42 offset:512
    ds_read_b128 a[140:143], v43 offset:512
    s_waitcnt lgkmcnt(11)
    v_mfma_f32_16x16x32_bf16 v[96:99], a[96:99], a[96:99], v[84:87]
    ds_read_b64_tr_b16 a[144:145], v44 offset:0
    ds_read_b64_tr_b16 a[146:147], v48 offset:256
    v_mfma_f32_16x16x32_bf16 v[100:103], a[96:99], a[48:51], 0
    ds_read_b64_tr_b16 a[148:149], v45 offset:0
    ds_read_b64_tr_b16 a[150:151], v49 offset:256
    s_waitcnt lgkmcnt(14)
    v_mfma_f32_16x16x32_bf16 v[96:99], a[100:103], a[100:103], v[96:99]
    ds_read_b64_tr_b16 a[152:153], v46 offset:0
    ds_read_b64_tr_b16 a[154:155], v50 offset:256
    v_mfma_f32_16x16x32_bf16 v[100:103], a[100:103], a[52:55], v[100:103]
    ds_read_b64_tr_b16 a[156:157], v47 offset:0
    ds_read_b64_tr_b16 a[158:159], v51 offset:256
    s_waitcnt lgkmcnt(15)
    v_mfma_f32_16x16x32_bf16 v[96:99], a[104:107], a[104:107], v[96:99]
    ds_read_b64_tr_b16 a[160:161], v48 offset:0
    ds_read_b64_tr_b16 a[162:163], v44 offset:512
    v_mfma_f32_16x16x32_bf16 v[100:103], a[104:107], a[56:59], v[100:103]
    ds_read_b64_tr_b16 a[164:165], v49 offset:0
    ds_read_b64_tr_b16 a[166:167], v45 offset:512
    v_mfma_f32_16x16x32_bf16 v[96:99], a[108:111], a[108:111], v[96:99]
    ds_read_b64_tr_b16 a[168:169], v50 offset:0
    ds_read_b64_tr_b16 a[170:171], v46 offset:512
    v_mfma_f32_16x16x32_bf16 v[100:103], a[108:111], a[60:63], v[100:103]
    ds_read_b64_tr_b16 a[172:173], v51 offset:0
    ds_read_b64_tr_b16 a[174:175], v47 offset:512
    v_mfma_f32_16x16x32_bf16 v[96:99], a[112:115], a[112:115], v[96:99]
    ds_read_b64_tr_b16 a[176:177], v44 offset:256
    ds_read_b64_tr_b16 a[178:179], v48 offset:512
    v_mfma_f32_16x16x32_bf16 v[100:103], a[112:115], a[64:67], v[100:103]
    ds_read_b64_tr_b16 a[180:181], v45 offset:256
    ds_read_b64_tr_b16 a[182:183], v49 offset:512
    s_waitcnt lgkmcnt(15)
    v_mfma_f32_16x16x32_bf16 v[96:99], a[116:119], a[116:119], v[96:99]
    ds_read_b64_tr_b16 a[184:185], v46 offset:256
    ds_read_b64_tr_b16 a[186:187], v50 offset:512
    v_mfma_f32_16x16x32_bf16 v[100:103], a[116:119], a[68:71], v[100:103]
    ds_read_b64_tr_b16 a[188:189], v47 offset:256
    ds_read_b64_tr_b16 a[190:191], v51 offset:512
    v_mfma_f32_16x16x32_bf16 v[92:95], a[96:99], v[52:55], v[80:83]
    v_mfma_f32_16x16x32_bf16 v[92:95], a[100:103], v[52:55], v[92:95]
    v_mfma_f32_16x16x32_bf16 v[92:95], a[104:107], v[52:55], v[92:95]
    v_mfma_f32_16x16x32_bf16 v[92:95], a[108:111], v[52:55], v[92:95]
    s_nop 1
    v_fma_f32 v96, v100, 2.0, v96
    v_fma_f32 v97, v101, 2.0, v97
    v_mfma_f32_16x16x32_bf16 v[92:95], a[112:115], v[52:55], v[92:95]
    v_fma_f32 v98, v102, 2.0, v98
    v_fma_f32 v99, v103, 2.0, v99
    v_mfma_f32_16x16x32_bf16 v[92:95], a[116:119], v[52:55], v[92:95]
    v_cndmask_b32 v3, 0, v96, s[44:45]
    v_cndmask_b32 v3, v3, v97, s[46:47]
    v_mfma_f32_16x16x32_bf16 v[88:91], a[96:99], v[136:139], v[76:79]
    v_cndmask_b32 v3, v3, v98, s[48:49]
    v_cndmask_b32 v3, v3, v99, s[50:51]
    v_mfma_f32_16x16x32_bf16 v[88:91], a[100:103], v[140:143], v[88:91]
    s_nop 0
    s_nop 0
    v_mfma_f32_16x16x32_bf16 v[88:91], a[104:107], v[144:147], v[88:91]
    v_mfma_f32_16x16x4_f32 v[120:123], v3, v60, v[56:59]
    v_mfma_f32_16x16x32_bf16 v[88:91], a[108:111], v[148:151], v[88:91]
    v_mfma_f32_16x16x32_bf16 v[88:91], a[112:115], v[152:155], v[88:91]
    v_mfma_f32_16x16x32_bf16 v[88:91], a[116:119], v[156:159], v[88:91]
    s_waitcnt lgkmcnt(0)
    v_mfma_f32_16x16x32_bf16 v[112:115], a[120:123], a[120:123], v[84:87]
    v_mfma_f32_16x16x32_bf16 v[116:119], a[120:123], a[48:51], 0
    v_mfma_f32_16x16x32_bf16 v[112:115], a[124:127], a[124:127], v[112:115]
    v_mfma_f32_16x16x32_bf16 v[116:119], a[124:127], a[52:55], v[116:119]
    s_nop 1
    v_fma_f32 v128, -v92, v92, v120
    v_fma_f32 v129, -v93, v93, v121
    v_mfma_f32_16x16x32_bf16 v[112:115], a[128:131], a[128:131], v[112:115]
    v_fma_f32 v130, -v94, v94, v122
    v_fma_f32 v131, -v95, v95, v123
    v_mfma_f32_16x16x32_bf16 v[116:119], a[128:131], a[56:59], v[116:119]
    v_max_f32 v128, v128, v56
    v_max_f32 v129, v129, v56
    v_mfma_f32_16x16x32_bf16 v[112:115], a[132:135], a[132:135], v[112:115]
    v_max_f32 v130, v130, v56
    v_max_f32 v131, v131, v56
    v_mfma_f32_16x16x32_bf16 v[116:119], a[132:135], a[60:63], v[116:119]
    v_rsq_f32 v128, v128
    v_mfma_f32_16x16x32_bf16 v[112:115], a[136:139], a[136:139], v[112:115]
    v_rsq_f32 v129, v129
    v_mfma_f32_16x16x32_bf16 v[116:119], a[136:139], a[64:67], v[116:119]
    v_rsq_f32 v130, v130
    v_mfma_f32_16x16x32_bf16 v[112:115], a[140:143], a[140:143], v[112:115]
    v_rsq_f32 v131, v131
    v_mfma_f32_16x16x32_bf16 v[116:119], a[140:143], a[68:71], v[116:119]
    v_fma_f32 v88, -v92, v61, v88
    v_fma_f32 v89, -v93, v61, v89
    v_mfma_f32_16x16x32_bf16 v[108:111], a[120:123], v[52:55], v[80:83]
    v_fma_f32 v90, -v94, v61, v90
    v_fma_f32 v91, -v95, v61, v91
    v_mfma_f32_16x16x32_bf16 v[108:111], a[124:127], v[52:55], v[108:111]
    v_fma_f32 v88, v88, v128, v62
    v_fma_f32 v89, v89, v129, v62
    v_mfma_f32_16x16x32_bf16 v[108:111], a[128:131], v[52:55], v[108:111]
    v_fma_f32 v90, v90, v130, v62
    v_fma_f32 v91, v91, v131, v62
    v_mfma_f32_16x16x32_bf16 v[108:111], a[132:135], v[52:55], v[108:111]
    v_max3_f32 v1, v88, v89, v90
    v_max_f32 v1, v1, v91
    v_mfma_f32_16x16x32_bf16 v[108:111], a[136:139], v[52:55], v[108:111]
    v_cmp_lt_f32 vcc, s52, v1
    s_cbranch_vccnz L_site11
L_back11:
    v_mfma_f32_16x16x32_bf16 v[108:111], a[140:143], v[52:55], v[108:111]
    v_exp_f32 v96, v88
    v_mfma_f32_16x16x32_bf16 v[104:107], a[120:123], v[136:139], v[76:79]
    v_exp_f32 v97, v89
    v_mfma_f32_16x16x32_bf16 v[104:107], a[124:127], v[140:143], v[104:107]
    v_exp_f32 v98, v90
    v_mfma_f32_16x16x32_bf16 v[104:107], a[128:131], v[144:147], v[104:107]
    v_exp_f32 v99, v91
    v_mfma_f32_16x16x32_bf16 v[104:107], a[132:135], v[148:151], v[104:107]
    v_mul_f32 v88, v96, v128
    v_mul_f32 v89, v97, v129
    v_mfma_f32_16x16x32_bf16 v[104:107], a[136:139], v[152:155], v[104:107]
    v_mul_f32 v90, v98, v130
    v_mul_f32 v91, v99, v131
    v_mfma_f32_16x16x32_bf16 v[104:107], a[140:143], v[156:159], v[104:107]
    v_fma_f32 v112, v116, 2.0, v112
    v_fma_f32 v113, v117, 2.0, v113
    v_fma_f32 v114, v118, 2.0, v114
    v_fma_f32 v115, v119, 2.0, v115
    v_cndmask_b32 v4, 0, v112, s[44:45]
    v_cndmask_b32 v4, v4, v113, s[46:47]
    v_cndmask_b32 v4, v4, v114, s[48:49]
    v_cndmask_b32 v4, v4, v115, s[50:51]
    v_add_f32 v63, v63, v96
    v_fmac_f32 v64, v88, v92
    v_mfma_f32_16x16x4_f32 v[124:127], v4, v60, v[56:59]
    v_add_f32 v63, v63, v97
    v_fmac_f32 v64, v89, v93
    v_add_f32 v63, v63, v98
    v_fmac_f32 v64, v90, v94
    v_add_f32 v63, v63, v99
    v_fmac_f32 v64, v91, v95
    v_mov_b32 v68, v88
    v_mov_b32 v69, v89
    v_mov_b32 v70, v90
    v_mov_b32 v71, v91
    v_fma_f32 v132, -v108, v108, v124
    v_fma_f32 v133, -v109, v109, v125
    v_fma_f32 v134, -v110, v110, v126
    v_fma_f32 v135, -v111, v111, v127
    v_max_f32 v132, v132, v56
    v_max_f32 v133, v133, v56
    v_max_f32 v134, v134, v56
    v_max_f32 v135, v135, v56
    v_rsq_f32 v132, v132
    v_rsq_f32 v133, v133
    v_rsq_f32 v134, v134
    v_rsq_f32 v135, v135
    v_fma_f32 v104, -v108, v61, v104
    v_fma_f32 v105, -v109, v61, v105
    v_fma_f32 v106, -v110, v61, v106
    v_fma_f32 v107, -v111, v61, v107
    v_fma_f32 v104, v104, v132, v62
    v_fma_f32 v105, v105, v133, v62
    v_fma_f32 v106, v106, v134, v62
    v_fma_f32 v107, v107, v135, v62
    v_max3_f32 v1, v104, v105, v106
    v_max_f32 v1, v1, v107
    v_cmp_lt_f32 vcc, s52, v1
    s_cbranch_vccnz L_site12
L_back12:
    v_exp_f32 v112, v104
    v_exp_f32 v113, v105
    v_exp_f32 v114, v106
    v_exp_f32 v115, v107
    v_mul_f32 v104, v112, v132
    v_mul_f32 v105, v113, v133
    v_mul_f32 v106, v114, v134
    v_mul_f32 v107, v115, v135
    v_cvt_pk_bf16_f32 v72, v88, v89
    v_cvt_pk_bf16_f32 v73, v90, v91
    v_cvt_pk_bf16_f32 v74, v104, v105
    v_cvt_pk_bf16_f32 v75, v106, v107
    s_nop 1
    v_mfma_f32_16x16x32_bf16 a[0:3], a[144:147], v[72:75], a[0:3]
    v_add_f32 v63, v63, v112
    v_fmac_f32 v64, v104, v108
    v_mfma_f32_16x16x32_bf16 a[4:7], a[148:151], v[72:75], a[4:7]
    v_add_f32 v63, v63, v113
    v_fmac_f32 v64, v105, v109
    v_mfma_f32_16x16x32_bf16 a[8:11], a[152:155], v[72:75], a[8:11]
    v_add_f32 v63, v63, v114
    v_fmac_f32 v64, v106, v110
    v_mfma_f32_16x16x32_bf16 a[12:15], a[156:159], v[72:75], a[12:15]
    v_add_f32 v63, v63, v115
    v_fmac_f32 v64, v107, v111
    v_mfma_f32_16x16x32_bf16 a[16:19], a[160:163], v[72:75], a[16:19]
    v_add_f32 v68, v68, v104
    v_add_f32 v69, v69, v105
    v_mfma_f32_16x16x32_bf16 a[20:23], a[164:167], v[72:75], a[20:23]
    v_add_f32 v70, v70, v106
    v_add_f32 v71, v71, v107
    v_mfma_f32_16x16x32_bf16 a[24:27], a[168:171], v[72:75], a[24:27]
    v_mfma_f32_16x16x32_bf16 a[28:31], a[172:175], v[72:75], a[28:31]
    v_mfma_f32_16x16x32_bf16 a[32:35], a[176:179], v[72:75], a[32:35]
    v_mfma_f32_16x16x32_bf16 a[36:39], a[180:183], v[72:75], a[36:39]
    v_mfma_f32_16x16x32_bf16 a[40:43], a[184:187], v[72:75], a[40:43]
    v_mfma_f32_16x16x32_bf16 a[44:47], a[188:191], v[72:75], a[44:47]
    s_waitcnt vmcnt(0)
    ds_read_b128 a[96:99], v40 offset:49152
    ds_read_b128 a[100:103], v41 offset:49152
    ds_read_b128 a[104:107], v42 offset:49152
    ds_read_b128 a[108:111], v43 offset:49152
    ds_read_b128 a[112:115], v40 offset:49408
    ds_read_b128 a[116:119], v41 offset:49408
    ds_read_b128 a[120:123], v42 offset:49408
    ds_read_b128 a[124:127], v43 offset:49408
    ds_read_b128 a[128:131], v40 offset:49664
    ds_read_b128 a[132:135], v41 offset:49664
    ds_read_b128 a[136:139], v42 offset:49664
    ds_read_b128 a[140:143], v43 offset:49664
    s_waitcnt lgkmcnt(11)
    v_mfma_f32_16x16x32_bf16 v[96:99], a[96:99], a[96:99], v[84:87]
    ds_read_b64_tr_b16 a[144:145], v44 offset:49152
    ds_read_b64_tr_b16 a[146:147], v48 offset:49408
    v_mfma_f32_16x16x32_bf16 v[100:103], a[96:99], a[48:51], 0
    ds_read_b64_tr_b16 a[148:149], v45 offset:49152
    ds_read_b64_tr_b16 a[150:151], v49 offset:49408
    s_waitcnt lgkmcnt(14)
    v_mfma_f32_16x16x32_bf16 v[96:99], a[100:103], a[100:103], v[96:99]
    ds_read_b64_tr_b16 a[152:153], v46 offset:49152
    ds_read_b64_tr_b16 a[154:155], v50 offset:49408
    v_mfma_f32_16x16x32_bf16 v[100:103], a[100:103], a[52:55], v[100:103]
    ds_read_b64_tr_b16 a[156:157], v47 offset:49152
    ds_read_b64_tr_b16 a[158:159], v51 offset:49408
    s_waitcnt lgkmcnt(15)
    v_mfma_f32_16x16x32_bf16 v[96:99], a[104:107], a[104:107], v[96:99]
    ds_read_b64_tr_b16 a[160:161], v48 offset:49152
    ds_read_b64_tr_b16 a[162:163], v44 offset:49664
    v_mfma_f32_16x16x32_bf16 v[100:103], a[104:107], a[56:59], v[100:103]
    ds_read_b64_tr_b16 a[164:165], v49 offset:49152
    ds_read_b64_tr_b16 a[166:167], v45 offset:49664
    v_mfma_f32_16x16x32_bf16 v[96:99], a[108:111], a[108:111], v[96:99]
    ds_read_b64_tr_b16 a[168:169], v50 offset:49152
    ds_read_b64_tr_b16 a[170:171], v46 offset:49664
    v_mfma_f32_16x16x32_bf16 v[100:103], a[108:111], a[60:63], v[100:103]
    ds_read_b64_tr_b16 a[172:173], v51 offset:49152
    ds_read_b64_tr_b16 a[174:175], v47 offset:49664
    v_mfma_f32_16x16x32_bf16 v[96:99], a[112:115], a[112:115], v[96:99]
    ds_read_b64_tr_b16 a[176:177], v44 offset:49408
    ds_read_b64_tr_b16 a[178:179], v48 offset:49664
    v_mfma_f32_16x16x32_bf16 v[100:103], a[112:115], a[64:67], v[100:103]
    ds_read_b64_tr_b16 a[180:181], v45 offset:49408
    ds_read_b64_tr_b16 a[182:183], v49 offset:49664
    s_waitcnt lgkmcnt(15)
    v_mfma_f32_16x16x32_bf16 v[96:99], a[116:119], a[116:119], v[96:99]
    ds_read_b64_tr_b16 a[184:185], v46 offset:49408
    ds_read_b64_tr_b16 a[186:187], v50 offset:49664
    v_mfma_f32_16x16x32_bf16 v[100:103], a[116:119], a[68:71], v[100:103]
    ds_read_b64_tr_b16 a[188:189], v47 offset:49408
    ds_read_b64_tr_b16 a[190:191], v51 offset:49664
    v_mfma_f32_16x16x32_bf16 v[92:95], a[96:99], v[52:55], v[80:83]
    v_mfma_f32_16x16x32_bf16 v[92:95], a[100:103], v[52:55], v[92:95]
    v_mfma_f32_16x16x32_bf16 v[92:95], a[104:107], v[52:55], v[92:95]
    v_mfma_f32_16x16x32_bf16 v[92:95], a[108:111], v[52:55], v[92:95]
    s_nop 1
    v_fma_f32 v96, v100, 2.0, v96
    v_fma_f32 v97, v101, 2.0, v97
    v_mfma_f32_16x16x32_bf16 v[92:95], a[112:115], v[52:55], v[92:95]
    v_fma_f32 v98, v102, 2.0, v98
    v_fma_f32 v99, v103, 2.0, v99
    v_mfma_f32_16x16x32_bf16 v[92:95], a[116:119], v[52:55], v[92:95]
    v_cndmask_b32 v3, 0, v96, s[44:45]
    v_cndmask_b32 v3, v3, v97, s[46:47]
    v_mfma_f32_16x16x32_bf16 v[88:91], a[96:99], v[136:139], v[76:79]
    v_cndmask_b32 v3, v3, v98, s[48:49]
    v_cndmask_b32 v3, v3, v99, s[50:51]
    v_mfma_f32_16x16x32_bf16 v[88:91], a[100:103], v[140:143], v[88:91]
    s_nop 0
    s_nop 0
    v_mfma_f32_16x16x32_bf16 v[88:91], a[104:107], v[144:147], v[88:91]
    v_mfma_f32_16x16x4_f32 v[120:123], v3, v60, v[56:59]
    v_mfma_f32_16x16x32_bf16 v[88:91], a[108:111], v[148:151], v[88:91]
    v_mfma_f32_16x16x32_bf16 v[88:91], a[112:115], v[152:155], v[88:91]
    v_mfma_f32_16x16x32_bf16 v[88:91], a[116:119], v[156:159], v[88:91]
    s_waitcnt lgkmcnt(0)
    v_mfma_f32_16x16x32_bf16 v[112:115], a[120:123], a[120:123], v[84:87]
    v_mfma_f32_16x16x32_bf16 v[116:119], a[120:123], a[48:51], 0
    v_mfma_f32_16x16x32_bf16 v[112:115], a[124:127], a[124:127], v[112:115]
    v_mfma_f32_16x16x32_bf16 v[116:119], a[124:127], a[52:55], v[116:119]
    s_nop 1
    v_fma_f32 v128, -v92, v92, v120
    v_fma_f32 v129, -v93, v93, v121
    v_mfma_f32_16x16x32_bf16 v[112:115], a[128:131], a[128:131], v[112:115]
    v_fma_f32 v130, -v94, v94, v122
    v_fma_f32 v131, -v95, v95, v123
    v_mfma_f32_16x16x32_bf16 v[116:119], a[128:131], a[56:59], v[116:119]
    v_max_f32 v128, v128, v56
    v_max_f32 v129, v129, v56
    v_mfma_f32_16x16x32_bf16 v[112:115], a[132:135], a[132:135], v[112:115]
    v_max_f32 v130, v130, v56
    v_max_f32 v131, v131, v56
    v_mfma_f32_16x16x32_bf16 v[116:119], a[132:135], a[60:63], v[116:119]
    v_rsq_f32 v128, v128
    v_mfma_f32_16x16x32_bf16 v[112:115], a[136:139], a[136:139], v[112:115]
    v_rsq_f32 v129, v129
    v_mfma_f32_16x16x32_bf16 v[116:119], a[136:139], a[64:67], v[116:119]
    v_rsq_f32 v130, v130
    v_mfma_f32_16x16x32_bf16 v[112:115], a[140:143], a[140:143], v[112:115]
    v_rsq_f32 v131, v131
    v_mfma_f32_16x16x32_bf16 v[116:119], a[140:143], a[68:71], v[116:119]
    v_fma_f32 v88, -v92, v61, v88
    v_fma_f32 v89, -v93, v61, v89
    v_mfma_f32_16x16x32_bf16 v[108:111], a[120:123], v[52:55], v[80:83]
    v_fma_f32 v90, -v94, v61, v90
    v_fma_f32 v91, -v95, v61, v91
    v_mfma_f32_16x16x32_bf16 v[108:111], a[124:127], v[52:55], v[108:111]
    v_fma_f32 v88, v88, v128, v62
    v_fma_f32 v89, v89, v129, v62
    v_mfma_f32_16x16x32_bf16 v[108:111], a[128:131], v[52:55], v[108:111]
    v_fma_f32 v90, v90, v130, v62
    v_fma_f32 v91, v91, v131, v62
    v_mfma_f32_16x16x32_bf16 v[108:111], a[132:135], v[52:55], v[108:111]
    v_max3_f32 v1, v88, v89, v90
    v_max_f32 v1, v1, v91
    v_mfma_f32_16x16x32_bf16 v[108:111], a[136:139], v[52:55], v[108:111]
    v_cmp_lt_f32 vcc, s52, v1
    s_cbranch_vccnz L_site13
L_back13:
    v_mfma_f32_16x16x32_bf16 v[108:111], a[140:143], v[52:55], v[108:111]
    v_exp_f32 v96, v88
    v_mfma_f32_16x16x32_bf16 v[104:107], a[120:123], v[136:139], v[76:79]
    v_exp_f32 v97, v89
    v_mfma_f32_16x16x32_bf16 v[104:107], a[124:127], v[140:143], v[104:107]
    v_exp_f32 v98, v90
    v_mfma_f32_16x16x32_bf16 v[104:107], a[128:131], v[144:147], v[104:107]
    v_exp_f32 v99, v91
    v_mfma_f32_16x16x32_bf16 v[104:107], a[132:135], v[148:151], v[104:107]
    v_mul_f32 v88, v96, v128
    v_mul_f32 v89, v97, v129
    v_mfma_f32_16x16x32_bf16 v[104:107], a[136:139], v[152:155], v[104:107]
    v_mul_f32 v90, v98, v130
    v_mul_f32 v91, v99, v131
    v_mfma_f32_16x16x32_bf16 v[104:107], a[140:143], v[156:159], v[104:107]
    v_fma_f32 v112, v116, 2.0, v112
    v_fma_f32 v113, v117, 2.0, v113
    v_fma_f32 v114, v118, 2.0, v114
    v_fma_f32 v115, v119, 2.0, v115
    v_cndmask_b32 v4, 0, v112, s[44:45]
    v_cndmask_b32 v4, v4, v113, s[46:47]
    v_cndmask_b32 v4, v4, v114, s[48:49]
    v_cndmask_b32 v4, v4, v115, s[50:51]
    v_add_f32 v63, v63, v96
    v_fmac_f32 v64, v88, v92
    v_mfma_f32_16x16x4_f32 v[124:127], v4, v60, v[56:59]
    v_add_f32 v63, v63, v97
    v_fmac_f32 v64, v89, v93
    v_add_f32 v63, v63, v98
    v_fmac_f32 v64, v90, v94
    v_add_f32 v63, v63, v99
    v_fmac_f32 v64, v91, v95
    v_add_f32 v68, v68, v88
    v_add_f32 v69, v69, v89
    v_add_f32 v70, v70, v90
    v_add_f32 v71, v71, v91
    v_fma_f32 v132, -v108, v108, v124
    v_fma_f32 v133, -v109, v109, v125
    v_fma_f32 v134, -v110, v110, v126
    v_fma_f32 v135, -v111, v111, v127
    v_max_f32 v132, v132, v56
    v_max_f32 v133, v133, v56
    v_max_f32 v134, v134, v56
    v_max_f32 v135, v135, v56
    v_rsq_f32 v132, v132
    v_rsq_f32 v133, v133
    v_rsq_f32 v134, v134
    v_rsq_f32 v135, v135
    v_fma_f32 v104, -v108, v61, v104
    v_fma_f32 v105, -v109, v61, v105
    v_fma_f32 v106, -v110, v61, v106
    v_fma_f32 v107, -v111, v61, v107
    v_fma_f32 v104, v104, v132, v62
    v_fma_f32 v105, v105, v133, v62
    v_fma_f32 v106, v106, v134, v62
    v_fma_f32 v107, v107, v135, v62
    v_max3_f32 v1, v104, v105, v106
    v_max_f32 v1, v1, v107
    v_cmp_lt_f32 vcc, s52, v1
    s_cbranch_vccnz L_site14
L_back14:
    v_exp_f32 v112, v104
    v_exp_f32 v113, v105
    v_exp_f32 v114, v106
    v_exp_f32 v115, v107
    v_mul_f32 v104, v112, v132
    v_mul_f32 v105, v113, v133
    v_mul_f32 v106, v114, v134
    v_mul_f32 v107, v115, v135
    v_cvt_pk_bf16_f32 v72, v88, v89
    v_cvt_pk_bf16_f32 v73, v90, v91
    v_cvt_pk_bf16_f32 v74, v104, v105
    v_cvt_pk_bf16_f32 v75, v106, v107
    s_nop 1
    v_mfma_f32_16x16x32_bf16 a[0:3], a[144:147], v[72:75], a[0:3]
    v_add_f32 v68, v68, v104
    v_add_f32 v69, v69, v105
    v_mfma_f32_16x16x32_bf16 a[4:7], a[148:151], v[72:75], a[4:7]
    v_add_f32 v70, v70, v106
    v_add_f32 v71, v71, v107
    v_mfma_f32_16x16x32_bf16 a[8:11], a[152:155], v[72:75], a[8:11]
    v_cvt_pk_bf16_f32 v66, v68, v69
    v_cvt_pk_bf16_f32 v67, v70, v71
    v_mfma_f32_16x16x32_bf16 a[12:15], a[156:159], v[72:75], a[12:15]
    v_add_f32 v63, v63, v112
    v_fmac_f32 v64, v104, v108
    v_mfma_f32_16x16x32_bf16 a[16:19], a[160:163], v[72:75], a[16:19]
    v_add_f32 v63, v63, v113
    v_fmac_f32 v64, v105, v109
    v_mfma_f32_16x16x32_bf16 a[20:23], a[164:167], v[72:75], a[20:23]
    v_add_f32 v63, v63, v114
    v_fmac_f32 v64, v106, v110
    v_mfma_f32_16x16x32_bf16 a[24:27], a[168:171], v[72:75], a[24:27]
    v_add_f32 v63, v63, v115
    v_fmac_f32 v64, v107, v111
    v_mfma_f32_16x16x32_bf16 a[28:31], a[172:175], v[72:75], a[28:31]
    v_mfma_f32_16x16x32_bf16 a[32:35], a[176:179], v[72:75], a[32:35]
    v_mfma_f32_16x16x32_bf16 a[36:39], a[180:183], v[72:75], a[36:39]
    v_mfma_f32_16x16x32_bf16 a[40:43], a[184:187], v[72:75], a[40:43]
    v_mfma_f32_16x16x32_bf16 a[44:47], a[188:191], v[72:75], a[44:47]
    v_mfma_f32_16x16x16_bf16 a[0:3], a[72:73], v[66:67], a[0:3]
    v_mfma_f32_16x16x16_bf16 a[4:7], a[74:75], v[66:67], a[4:7]
    v_mfma_f32_16x16x16_bf16 a[8:11], a[76:77], v[66:67], a[8:11]
    v_mfma_f32_16x16x16_bf16 a[12:15], a[78:79], v[66:67], a[12:15]
    v_mfma_f32_16x16x16_bf16 a[16:19], a[80:81], v[66:67], a[16:19]
    v_mfma_f32_16x16x16_bf16 a[20:23], a[82:83], v[66:67], a[20:23]
    v_mfma_f32_16x16x16_bf16 a[24:27], a[84:85], v[66:67], a[24:27]
    v_mfma_f32_16x16x16_bf16 a[28:31], a[86:87], v[66:67], a[28:31]
    v_mfma_f32_16x16x16_bf16 a[32:35], a[88:89], v[66:67], a[32:35]
    v_mfma_f32_16x16x16_bf16 a[36:39], a[90:91], v[66:67], a[36:39]
    v_mfma_f32_16x16x16_bf16 a[40:43], a[92:93], v[66:67], a[40:43]
    v_mfma_f32_16x16x16_bf16 a[44:47], a[94:95], v[66:67], a[44:47]
    s_lshl_b32 s56, s3, 15
    s_lshl_b32 s57, s2, 7
    s_add_u32 s56, s56, s57
    s_add_u32 s56, s56, 131072
    ds_write_b128 v238, a[0:3] offset:0
    ds_write_b128 v238, a[4:7] offset:1024
    ds_write_b128 v238, a[8:11] offset:2048
    ds_write_b128 v238, a[12:15] offset:3072
    ds_write_b128 v238, a[16:19] offset:4096
    ds_write_b128 v238, a[20:23] offset:5120
    ds_write_b128 v238, a[24:27] offset:6144
    ds_write_b128 v238, a[28:31] offset:7168
    ds_write_b128 v238, a[32:35] offset:8192
    ds_write_b128 v238, a[36:39] offset:9216
    ds_write_b128 v238, a[40:43] offset:10240
    ds_write_b128 v238, a[44:47] offset:11264
    ds_write_b128 v239, v[62:65]
    v_mov_b32 v44, 1.0
    s_waitcnt lgkmcnt(0)
    s_barrier
    ds_read_b128 v[16:19], v240 offset:0
    ds_read_b128 v[20:23], v240 offset:1024
    ds_read_b128 v[24:27], v240 offset:2048
    ds_read_b128 v[28:31], v240 offset:3072
    ds_read_b128 v[76:79], v237 offset:0
    ds_read_b128 v[80:83], v237 offset:1024
    ds_read_b128 v[84:87], v237 offset:2048
    ds_read_b128 v[88:91], v237 offset:12288
    ds_read_b128 v[92:95], v237 offset:13312
    ds_read_b128 v[96:99], v237 offset:14336
    ds_read_b128 v[100:103], v237 offset:24576
    ds_read_b128 v[104:107], v237 offset:25600
    ds_read_b128 v[108:111], v237 offset:26624
    ds_read_b128 v[112:115], v237 offset:36864
    ds_read_b128 v[116:119], v237 offset:37888
    ds_read_b128 v[120:123], v237 offset:38912
    s_waitcnt lgkmcnt(12)
    v_min3_f32 v9, v16, v20, v24
    v_min_f32 v9, v9, v28
    v_sub_f32 v32, v9, v16
    v_sub_f32 v33, v9, v20
    v_sub_f32 v34, v9, v24
    v_sub_f32 v35, v9, v28
    v_exp_f32 v32, v32
    v_exp_f32 v33, v33
    v_exp_f32 v34, v34
    v_exp_f32 v35, v35
    v_mul_f32 v1, v32, v17
    v_mul_f32 v2, v32, v18
    v_fmac_f32 v1, v33, v21
    v_fmac_f32 v2, v33, v22
    v_fmac_f32 v1, v34, v25
    v_fmac_f32 v2, v34, v26
    v_fmac_f32 v1, v35, v29
    v_fmac_f32 v2, v35, v30
    s_waitcnt lgkmcnt(9)
    v_mul_f32 v76, v76, v32
    v_mul_f32 v77, v77, v32
    v_mfma_f32_16x16x4_f32 v[36:39], v44, v1, 0
    v_mfma_f32_16x16x4_f32 v[40:43], v44, v2, 0
    v_mul_f32 v78, v78, v32
    v_mul_f32 v79, v79, v32
    v_mul_f32 v80, v80, v32
    v_mul_f32 v81, v81, v32
    v_mul_f32 v82, v82, v32
    v_mul_f32 v83, v83, v32
    v_mul_f32 v84, v84, v32
    v_mul_f32 v85, v85, v32
    v_mul_f32 v86, v86, v32
    v_mul_f32 v87, v87, v32
    s_waitcnt lgkmcnt(6)
    v_fmac_f32 v76, v88, v33
    v_fmac_f32 v77, v89, v33
    v_fmac_f32 v78, v90, v33
    v_fmac_f32 v79, v91, v33
    v_fmac_f32 v80, v92, v33
    v_fmac_f32 v81, v93, v33
    v_fmac_f32 v82, v94, v33
    v_fmac_f32 v83, v95, v33
    v_fmac_f32 v84, v96, v33
    v_fmac_f32 v85, v97, v33
    v_fmac_f32 v86, v98, v33
    v_fmac_f32 v87, v99, v33
    v_rcp_f32 v3, v36
    v_log_f32 v4, v36
    s_waitcnt lgkmcnt(3)
    v_fmac_f32 v76, v100, v34
    v_fmac_f32 v77, v101, v34
    v_fmac_f32 v78, v102, v34
    v_fmac_f32 v79, v103, v34
    v_fmac_f32 v80, v104, v34
    v_fmac_f32 v81, v105, v34
    v_fmac_f32 v82, v106, v34
    v_fmac_f32 v83, v107, v34
    v_fmac_f32 v84, v108, v34
    v_fmac_f32 v85, v109, v34
    v_fmac_f32 v86, v110, v34
    v_fmac_f32 v87, v111, v34
    v_mul_f32 v5, v60, v3
    v_mul_f32 v6, v40, v3
    v_sub_f32 v4, v4, v9
    s_waitcnt lgkmcnt(0)
    v_fmac_f32 v76, v112, v35
    v_fmac_f32 v77, v113, v35
    v_fmac_f32 v78, v114, v35
    v_fmac_f32 v79, v115, v35
    v_fmac_f32 v80, v116, v35
    v_fmac_f32 v81, v117, v35
    v_fmac_f32 v82, v118, v35
    v_fmac_f32 v83, v119, v35
    v_fmac_f32 v84, v120, v35
    v_fmac_f32 v85, v121, v35
    v_fmac_f32 v86, v122, v35
    v_fmac_f32 v87, v123, v35
    v_fma_f32 v76, v76, v5, -v6
    v_fma_f32 v77, v77, v5, -v6
    v_fma_f32 v78, v78, v5, -v6
    v_fma_f32 v79, v79, v5, -v6
    v_fma_f32 v80, v80, v5, -v6
    v_fma_f32 v81, v81, v5, -v6
    v_fma_f32 v82, v82, v5, -v6
    v_fma_f32 v83, v83, v5, -v6
    v_fma_f32 v84, v84, v5, -v6
    v_fma_f32 v85, v85, v5, -v6
    v_fma_f32 v86, v86, v5, -v6
    v_fma_f32 v87, v87, v5, -v6
    v_cvt_pk_bf16_f32 v88, v76, v77
    v_cvt_pk_bf16_f32 v89, v78, v79
    ds_write_b64 v236, v[88:89] offset:0
    v_cvt_pk_bf16_f32 v90, v80, v81
    v_cvt_pk_bf16_f32 v91, v82, v83
    ds_write_b64 v236, v[90:91] offset:512
    v_cvt_pk_bf16_f32 v92, v84, v85
    v_cvt_pk_bf16_f32 v93, v86, v87
    ds_write_b64 v236, v[92:93] offset:1024
    s_waitcnt lgkmcnt(0)
    s_barrier
    ds_read_b128 v[136:139], v241 offset:0
    ds_read_b128 v[140:143], v241 offset:1024
    ds_read_b128 v[144:147], v241 offset:2048
    ds_read_b128 v[148:151], v241 offset:3072
    ds_read_b128 v[152:155], v241 offset:4096
    ds_read_b128 v[156:159], v241 offset:5120
    s_waitcnt lgkmcnt(5)
    v_mfma_f32_16x16x32_bf16 v[16:19], v[160:163], v[136:139], 0
    v_mfma_f32_16x16x32_bf16 v[20:23], v[184:187], v[136:139], 0
    v_mfma_f32_16x16x32_bf16 v[24:27], v[208:211], v[136:139], 0
    s_waitcnt lgkmcnt(4)
    v_mfma_f32_16x16x32_bf16 v[16:19], v[164:167], v[140:143], v[16:19]
    v_mfma_f32_16x16x32_bf16 v[20:23], v[188:191], v[140:143], v[20:23]
    v_mfma_f32_16x16x32_bf16 v[24:27], v[212:215], v[140:143], v[24:27]
    s_waitcnt lgkmcnt(3)
    v_mfma_f32_16x16x32_bf16 v[16:19], v[168:171], v[144:147], v[16:19]
    v_mfma_f32_16x16x32_bf16 v[20:23], v[192:195], v[144:147], v[20:23]
    v_mfma_f32_16x16x32_bf16 v[24:27], v[216:219], v[144:147], v[24:27]
    s_waitcnt lgkmcnt(2)
    v_mfma_f32_16x16x32_bf16 v[16:19], v[172:175], v[148:151], v[16:19]
    v_mfma_f32_16x16x32_bf16 v[20:23], v[196:199], v[148:151], v[20:23]
    v_mfma_f32_16x16x32_bf16 v[24:27], v[220:223], v[148:151], v[24:27]
    s_waitcnt lgkmcnt(1)
    v_mfma_f32_16x16x32_bf16 v[16:19], v[176:179], v[152:155], v[16:19]
    v_mfma_f32_16x16x32_bf16 v[20:23], v[200:203], v[152:155], v[20:23]
    v_mfma_f32_16x16x32_bf16 v[24:27], v[224:227], v[152:155], v[24:27]
    s_waitcnt lgkmcnt(0)
    v_mfma_f32_16x16x32_bf16 v[16:19], v[180:183], v[156:159], v[16:19]
    v_mfma_f32_16x16x32_bf16 v[20:23], v[204:207], v[156:159], v[20:23]
    v_mfma_f32_16x16x32_bf16 v[24:27], v[228:231], v[156:159], v[24:27]
    v_mov_b32 v35, v4
    v_mov_b32 v39, v4
    s_nop 3
    v_cvt_pk_bf16_f32 v32, v16, v17
    v_cvt_pk_bf16_f32 v33, v18, v19
    v_cvt_pk_bf16_f32 v34, v20, v21
    v_cvt_pk_bf16_f32 v36, v22, v23
    v_cvt_pk_bf16_f32 v37, v24, v25
    v_cvt_pk_bf16_f32 v38, v26, v27
    buffer_store_dwordx4 v[32:35], v242, s[32:35], s56 offen
    buffer_store_dwordx4 v[36:39], v242, s[32:35], s56 offen offset:64
L_main_end:
    s_endpgm
L_site0:
    s_call_b64 s[54:55], L_rare1
    s_branch L_back0
L_site1:
    s_call_b64 s[54:55], L_rare0
    s_branch L_back1
L_site2:
    s_call_b64 s[54:55], L_rare1
    s_branch L_back2
L_site3:
    s_call_b64 s[54:55], L_rare0
    s_branch L_back3
L_site4:
    s_call_b64 s[54:55], L_rare1
    s_branch L_back4
L_site5:
    s_call_b64 s[54:55], L_rare0
    s_branch L_back5
L_site6:
    s_call_b64 s[54:55], L_rare1
    s_branch L_back6
L_site7:
    s_call_b64 s[54:55], L_rare0
    s_branch L_back7
L_site8:
    s_call_b64 s[54:55], L_rare1
    s_branch L_back8
L_site9:
    s_call_b64 s[54:55], L_rare0
    s_branch L_back9
L_site10:
    s_call_b64 s[54:55], L_rare1
    s_branch L_back10
L_site11:
    s_call_b64 s[54:55], L_rare0
    s_branch L_back11
L_site12:
    s_call_b64 s[54:55], L_rare1
    s_branch L_back12
L_site13:
    s_call_b64 s[54:55], L_rare0
    s_branch L_back13
L_site14:
    s_call_b64 s[54:55], L_rare1
    s_branch L_back14
L_rare0:
    s_nop 7
    s_nop 7
    v_mov_b32 v2, v1
    s_nop 1
    v_permlane32_swap_b32 v1, v2
    v_max_f32 v1, v1, v2
    v_mov_b32 v2, v1
    s_nop 1
    v_permlane16_swap_b32 v1, v2
    v_max_f32 v1, v1, v2
    v_max_f32 v1, 0, v1
    v_sub_f32 v62, v62, v1
    v_sub_f32 v88, v88, v1
    v_sub_f32 v89, v89, v1
    v_sub_f32 v90, v90, v1
    v_sub_f32 v91, v91, v1
    v_sub_f32 v1, 0, v1
    v_exp_f32 v1, v1
    s_nop 0
    v_mul_f32 v63, v63, v1
    v_mul_f32 v64, v64, v1
    v_mul_f32 v68, v68, v1
    v_mul_f32 v69, v69, v1
    v_mul_f32 v70, v70, v1
    v_mul_f32 v71, v71, v1
    v_accvgpr_read_b32 v2, a0
    v_mul_f32 v2, v2, v1
    v_accvgpr_write_b32 a0, v2
    v_accvgpr_read_b32 v2, a1
    v_mul_f32 v2, v2, v1
    v_accvgpr_write_b32 a1, v2
    v_accvgpr_read_b32 v2, a2
    v_mul_f32 v2, v2, v1
    v_accvgpr_write_b32 a2, v2
    v_accvgpr_read_b32 v2, a3
    v_mul_f32 v2, v2, v1
    v_accvgpr_write_b32 a3, v2
    v_accvgpr_read_b32 v2, a4
    v_mul_f32 v2, v2, v1
    v_accvgpr_write_b32 a4, v2
    v_accvgpr_read_b32 v2, a5
    v_mul_f32 v2, v2, v1
    v_accvgpr_write_b32 a5, v2
    v_accvgpr_read_b32 v2, a6
    v_mul_f32 v2, v2, v1
    v_accvgpr_write_b32 a6, v2
    v_accvgpr_read_b32 v2, a7
    v_mul_f32 v2, v2, v1
    v_accvgpr_write_b32 a7, v2
    v_accvgpr_read_b32 v2, a8
    v_mul_f32 v2, v2, v1
    v_accvgpr_write_b32 a8, v2
    v_accvgpr_read_b32 v2, a9
    v_mul_f32 v2, v2, v1
    v_accvgpr_write_b32 a9, v2
    v_accvgpr_read_b32 v2, a10
    v_mul_f32 v2, v2, v1
    v_accvgpr_write_b32 a10, v2
    v_accvgpr_read_b32 v2, a11
    v_mul_f32 v2, v2, v1
    v_accvgpr_write_b32 a11, v2
    v_accvgpr_read_b32 v2, a12
    v_mul_f32 v2, v2, v1
    v_accvgpr_write_b32 a12, v2
    v_accvgpr_read_b32 v2, a13
    v_mul_f32 v2, v2, v1
    v_accvgpr_write_b32 a13, v2
    v_accvgpr_read_b32 v2, a14
    v_mul_f32 v2, v2, v1
    v_accvgpr_write_b32 a14, v2
    v_accvgpr_read_b32 v2, a15
    v_mul_f32 v2, v2, v1
    v_accvgpr_write_b32 a15, v2
    v_accvgpr_read_b32 v2, a16
    v_mul_f32 v2, v2, v1
    v_accvgpr_write_b32 a16, v2
    v_accvgpr_read_b32 v2, a17
    v_mul_f32 v2, v2, v1
    v_accvgpr_write_b32 a17, v2
    v_accvgpr_read_b32 v2, a18
    v_mul_f32 v2, v2, v1
    v_accvgpr_write_b32 a18, v2
    v_accvgpr_read_b32 v2, a19
    v_mul_f32 v2, v2, v1
    v_accvgpr_write_b32 a19, v2
    v_accvgpr_read_b32 v2, a20
    v_mul_f32 v2, v2, v1
    v_accvgpr_write_b32 a20, v2
    v_accvgpr_read_b32 v2, a21
    v_mul_f32 v2, v2, v1
    v_accvgpr_write_b32 a21, v2
    v_accvgpr_read_b32 v2, a22
    v_mul_f32 v2, v2, v1
    v_accvgpr_write_b32 a22, v2
    v_accvgpr_read_b32 v2, a23
    v_mul_f32 v2, v2, v1
    v_accvgpr_write_b32 a23, v2
    v_accvgpr_read_b32 v2, a24
    v_mul_f32 v2, v2, v1
    v_accvgpr_write_b32 a24, v2
    v_accvgpr_read_b32 v2, a25
    v_mul_f32 v2, v2, v1
    v_accvgpr_write_b32 a25, v2
    v_accvgpr_read_b32 v2, a26
    v_mul_f32 v2, v2, v1
    v_accvgpr_write_b32 a26, v2
    v_accvgpr_read_b32 v2, a27
    v_mul_f32 v2, v2, v1
    v_accvgpr_write_b32 a27, v2
    v_accvgpr_read_b32 v2, a28
    v_mul_f32 v2, v2, v1
    v_accvgpr_write_b32 a28, v2
    v_accvgpr_read_b32 v2, a29
    v_mul_f32 v2, v2, v1
    v_accvgpr_write_b32 a29, v2
    v_accvgpr_read_b32 v2, a30
    v_mul_f32 v2, v2, v1
    v_accvgpr_write_b32 a30, v2
    v_accvgpr_read_b32 v2, a31
    v_mul_f32 v2, v2, v1
    v_accvgpr_write_b32 a31, v2
    v_accvgpr_read_b32 v2, a32
    v_mul_f32 v2, v2, v1
    v_accvgpr_write_b32 a32, v2
    v_accvgpr_read_b32 v2, a33
    v_mul_f32 v2, v2, v1
    v_accvgpr_write_b32 a33, v2
    v_accvgpr_read_b32 v2, a34
    v_mul_f32 v2, v2, v1
    v_accvgpr_write_b32 a34, v2
    v_accvgpr_read_b32 v2, a35
    v_mul_f32 v2, v2, v1
    v_accvgpr_write_b32 a35, v2
    v_accvgpr_read_b32 v2, a36
    v_mul_f32 v2, v2, v1
    v_accvgpr_write_b32 a36, v2
    v_accvgpr_read_b32 v2, a37
    v_mul_f32 v2, v2, v1
    v_accvgpr_write_b32 a37, v2
    v_accvgpr_read_b32 v2, a38
    v_mul_f32 v2, v2, v1
    v_accvgpr_write_b32 a38, v2
    v_accvgpr_read_b32 v2, a39
    v_mul_f32 v2, v2, v1
    v_accvgpr_write_b32 a39, v2
    v_accvgpr_read_b32 v2, a40
    v_mul_f32 v2, v2, v1
    v_accvgpr_write_b32 a40, v2
    v_accvgpr_read_b32 v2, a41
    v_mul_f32 v2, v2, v1
    v_accvgpr_write_b32 a41, v2
    v_accvgpr_read_b32 v2, a42
    v_mul_f32 v2, v2, v1
    v_accvgpr_write_b32 a42, v2
    v_accvgpr_read_b32 v2, a43
    v_mul_f32 v2, v2, v1
    v_accvgpr_write_b32 a43, v2
    v_accvgpr_read_b32 v2, a44
    v_mul_f32 v2, v2, v1
    v_accvgpr_write_b32 a44, v2
    v_accvgpr_read_b32 v2, a45
    v_mul_f32 v2, v2, v1
    v_accvgpr_write_b32 a45, v2
    v_accvgpr_read_b32 v2, a46
    v_mul_f32 v2, v2, v1
    v_accvgpr_write_b32 a46, v2
    v_accvgpr_read_b32 v2, a47
    v_mul_f32 v2, v2, v1
    v_accvgpr_write_b32 a47, v2
    s_nop 3
    s_setpc_b64 s[54:55]
L_rare1:
    s_nop 7
    s_nop 7
    v_mov_b32 v2, v1
    s_nop 1
    v_permlane32_swap_b32 v1, v2
    v_max_f32 v1, v1, v2
    v_mov_b32 v2, v1
    s_nop 1
    v_permlane16_swap_b32 v1, v2
    v_max_f32 v1, v1, v2
    v_max_f32 v1, 0, v1
    v_sub_f32 v62, v62, v1
    v_sub_f32 v104, v104, v1
    v_sub_f32 v105, v105, v1
    v_sub_f32 v106, v106, v1
    v_sub_f32 v107, v107, v1
    v_sub_f32 v1, 0, v1
    v_exp_f32 v1, v1
    s_nop 0
    v_mul_f32 v63, v63, v1
    v_mul_f32 v64, v64, v1
    v_mul_f32 v68, v68, v1
    v_mul_f32 v69, v69, v1
    v_mul_f32 v70, v70, v1
    v_mul_f32 v71, v71, v1
    v_mul_f32 v88, v88, v1
    v_mul_f32 v89, v89, v1
    v_mul_f32 v90, v90, v1
    v_mul_f32 v91, v91, v1
    v_accvgpr_read_b32 v2, a0
    v_mul_f32 v2, v2, v1
    v_accvgpr_write_b32 a0, v2
    v_accvgpr_read_b32 v2, a1
    v_mul_f32 v2, v2, v1
    v_accvgpr_write_b32 a1, v2
    v_accvgpr_read_b32 v2, a2
    v_mul_f32 v2, v2, v1
    v_accvgpr_write_b32 a2, v2
    v_accvgpr_read_b32 v2, a3
    v_mul_f32 v2, v2, v1
    v_accvgpr_write_b32 a3, v2
    v_accvgpr_read_b32 v2, a4
    v_mul_f32 v2, v2, v1
    v_accvgpr_write_b32 a4, v2
    v_accvgpr_read_b32 v2, a5
    v_mul_f32 v2, v2, v1
    v_accvgpr_write_b32 a5, v2
    v_accvgpr_read_b32 v2, a6
    v_mul_f32 v2, v2, v1
    v_accvgpr_write_b32 a6, v2
    v_accvgpr_read_b32 v2, a7
    v_mul_f32 v2, v2, v1
    v_accvgpr_write_b32 a7, v2
    v_accvgpr_read_b32 v2, a8
    v_mul_f32 v2, v2, v1
    v_accvgpr_write_b32 a8, v2
    v_accvgpr_read_b32 v2, a9
    v_mul_f32 v2, v2, v1
    v_accvgpr_write_b32 a9, v2
    v_accvgpr_read_b32 v2, a10
    v_mul_f32 v2, v2, v1
    v_accvgpr_write_b32 a10, v2
    v_accvgpr_read_b32 v2, a11
    v_mul_f32 v2, v2, v1
    v_accvgpr_write_b32 a11, v2
    v_accvgpr_read_b32 v2, a12
    v_mul_f32 v2, v2, v1
    v_accvgpr_write_b32 a12, v2
    v_accvgpr_read_b32 v2, a13
    v_mul_f32 v2, v2, v1
    v_accvgpr_write_b32 a13, v2
    v_accvgpr_read_b32 v2, a14
    v_mul_f32 v2, v2, v1
    v_accvgpr_write_b32 a14, v2
    v_accvgpr_read_b32 v2, a15
    v_mul_f32 v2, v2, v1
    v_accvgpr_write_b32 a15, v2
    v_accvgpr_read_b32 v2, a16
    v_mul_f32 v2, v2, v1
    v_accvgpr_write_b32 a16, v2
    v_accvgpr_read_b32 v2, a17
    v_mul_f32 v2, v2, v1
    v_accvgpr_write_b32 a17, v2
    v_accvgpr_read_b32 v2, a18
    v_mul_f32 v2, v2, v1
    v_accvgpr_write_b32 a18, v2
    v_accvgpr_read_b32 v2, a19
    v_mul_f32 v2, v2, v1
    v_accvgpr_write_b32 a19, v2
    v_accvgpr_read_b32 v2, a20
    v_mul_f32 v2, v2, v1
    v_accvgpr_write_b32 a20, v2
    v_accvgpr_read_b32 v2, a21
    v_mul_f32 v2, v2, v1
    v_accvgpr_write_b32 a21, v2
    v_accvgpr_read_b32 v2, a22
    v_mul_f32 v2, v2, v1
    v_accvgpr_write_b32 a22, v2
    v_accvgpr_read_b32 v2, a23
    v_mul_f32 v2, v2, v1
    v_accvgpr_write_b32 a23, v2
    v_accvgpr_read_b32 v2, a24
    v_mul_f32 v2, v2, v1
    v_accvgpr_write_b32 a24, v2
    v_accvgpr_read_b32 v2, a25
    v_mul_f32 v2, v2, v1
    v_accvgpr_write_b32 a25, v2
    v_accvgpr_read_b32 v2, a26
    v_mul_f32 v2, v2, v1
    v_accvgpr_write_b32 a26, v2
    v_accvgpr_read_b32 v2, a27
    v_mul_f32 v2, v2, v1
    v_accvgpr_write_b32 a27, v2
    v_accvgpr_read_b32 v2, a28
    v_mul_f32 v2, v2, v1
    v_accvgpr_write_b32 a28, v2
    v_accvgpr_read_b32 v2, a29
    v_mul_f32 v2, v2, v1
    v_accvgpr_write_b32 a29, v2
    v_accvgpr_read_b32 v2, a30
    v_mul_f32 v2, v2, v1
    v_accvgpr_write_b32 a30, v2
    v_accvgpr_read_b32 v2, a31
    v_mul_f32 v2, v2, v1
    v_accvgpr_write_b32 a31, v2
    v_accvgpr_read_b32 v2, a32
    v_mul_f32 v2, v2, v1
    v_accvgpr_write_b32 a32, v2
    v_accvgpr_read_b32 v2, a33
    v_mul_f32 v2, v2, v1
    v_accvgpr_write_b32 a33, v2
    v_accvgpr_read_b32 v2, a34
    v_mul_f32 v2, v2, v1
    v_accvgpr_write_b32 a34, v2
    v_accvgpr_read_b32 v2, a35
    v_mul_f32 v2, v2, v1
    v_accvgpr_write_b32 a35, v2
    v_accvgpr_read_b32 v2, a36
    v_mul_f32 v2, v2, v1
    v_accvgpr_write_b32 a36, v2
    v_accvgpr_read_b32 v2, a37
    v_mul_f32 v2, v2, v1
    v_accvgpr_write_b32 a37, v2
    v_accvgpr_read_b32 v2, a38
    v_mul_f32 v2, v2, v1
    v_accvgpr_write_b32 a38, v2
    v_accvgpr_read_b32 v2, a39
    v_mul_f32 v2, v2, v1
    v_accvgpr_write_b32 a39, v2
    v_accvgpr_read_b32 v2, a40
    v_mul_f32 v2, v2, v1
    v_accvgpr_write_b32 a40, v2
    v_accvgpr_read_b32 v2, a41
    v_mul_f32 v2, v2, v1
    v_accvgpr_write_b32 a41, v2
    v_accvgpr_read_b32 v2, a42
    v_mul_f32 v2, v2, v1
    v_accvgpr_write_b32 a42, v2
    v_accvgpr_read_b32 v2, a43
    v_mul_f32 v2, v2, v1
    v_accvgpr_write_b32 a43, v2
    v_accvgpr_read_b32 v2, a44
    v_mul_f32 v2, v2, v1
    v_accvgpr_write_b32 a44, v2
    v_accvgpr_read_b32 v2, a45
    v_mul_f32 v2, v2, v1
    v_accvgpr_write_b32 a45, v2
    v_accvgpr_read_b32 v2, a46
    v_mul_f32 v2, v2, v1
    v_accvgpr_write_b32 a46, v2
    v_accvgpr_read_b32 v2, a47
    v_mul_f32 v2, v2, v1
    v_accvgpr_write_b32 a47, v2
    s_nop 3
    s_setpc_b64 s[54:55]
L_main_codeend:
.p2align 8
comb_kernel:
    s_cmp_ge_u32 s2, 64
    s_cbranch_scc1 L_comb_end
    s_load_dwordx2 s[4:5], s[0:1], 0
    s_load_dwordx2 s[18:19], s[0:1], 56
    s_load_dwordx2 s[22:23], s[0:1], 72
    v_lshrrev_b32 v1, 6, v0
    v_and_b32 v0, 63, v0
    v_readfirstlane_b32 s3, v1
    v_lshlrev_b32 v65, 4, v0
    s_lshl_b32 s56, s2, 15
    s_lshl_b32 s57, s3, 13
    s_add_u32 s56, s56, s57
    s_add_u32 s56, s56, 131072
    s_add_u32 s57, s56, 4096
    s_waitcnt lgkmcnt(0)
    s_mov_b32 s32, s22
    s_mov_b32 s33, s23
    s_mov_b32 s34, 8388608
    s_mov_b32 s35, 0x20000
    buffer_load_dwordx4 v[16:19], v65, s[32:35], s56 offen offset:0
    buffer_load_dwordx4 v[20:23], v65, s[32:35], s56 offen offset:1024
    buffer_load_dwordx4 v[24:27], v65, s[32:35], s56 offen offset:2048
    buffer_load_dwordx4 v[28:31], v65, s[32:35], s56 offen offset:3072
    buffer_load_dwordx4 v[32:35], v65, s[32:35], s57 offen offset:0
    buffer_load_dwordx4 v[36:39], v65, s[32:35], s57 offen offset:1024
    buffer_load_dwordx4 v[40:43], v65, s[32:35], s57 offen offset:2048
    buffer_load_dwordx4 v[44:47], v65, s[32:35], s57 offen offset:3072
    s_mov_b32 s64, s4
    s_mov_b32 s65, s5
    s_mov_b32 s66, 6144
    s_mov_b32 s67, 0x20000
    s_mov_b32 s68, s18
    s_mov_b32 s69, s19
    s_mov_b32 s70, 6144
    s_mov_b32 s71, 0x20000
    v_mul_u32_u24 v1, 43, v0
    v_lshrrev_b32 v1, 7, v1
    v_mul_u32_u24 v2, 3, v1
    v_sub_u32 v2, v0, v2
    v_and_b32 v3, 3, v1
    v_mul_u32_u24 v3, 6, v3
    v_lshrrev_b32 v4, 2, v1
    v_mul_u32_u24 v4, 3, v4
    v_add3_u32 v3, v3, v4, v2
    v_lshlrev_b32 v3, 2, v3
    v_lshlrev_b32 v1, 5, v1
    v_lshl_add_u32 v5, v2, 3, v1
    v_cmp_gt_u32 vcc, 24, v0
    v_mov_b32 v4, 0x10000
    s_mul_i32 s58, s2, 96
    v_cndmask_b32 v3, v4, v3, vcc
    buffer_load_dword v6, v3, s[64:67], s58 offen
    s_waitcnt vmcnt(1)
    v_max3_f32 v7, v19, v23, v27
    v_max3_f32 v7, v7, v31, v35
    v_max3_f32 v7, v7, v39, v43
    v_max_f32 v7, v7, v47
    s_nop 1
    v_max_f32_dpp v7, v7, v7 row_ror:8 row_mask:0xf bank_mask:0xf
    v_mov_b32 v8, v7
    s_nop 1
    v_permlane32_swap_b32 v7, v8
    v_max_f32 v7, v7, v8
    v_mov_b32 v8, v7
    s_nop 1
    v_permlane16_swap_b32 v7, v8
    v_max_f32 v7, v7, v8
    v_sub_f32 v48, v19, v7
    v_sub_f32 v49, v23, v7
    v_sub_f32 v50, v27, v7
    v_sub_f32 v51, v31, v7
    v_sub_f32 v52, v35, v7
    v_sub_f32 v53, v39, v7
    v_sub_f32 v54, v43, v7
    v_sub_f32 v55, v47, v7
    v_exp_f32 v48, v48
    v_exp_f32 v49, v49
    v_exp_f32 v50, v50
    v_exp_f32 v51, v51
    v_exp_f32 v52, v52
    v_exp_f32 v53, v53
    v_exp_f32 v54, v54
    v_exp_f32 v55, v55
    v_lshlrev_b32 v64, 16, v16
    v_and_b32 v65, 0xffff0000, v16
    v_lshlrev_b32 v66, 16, v17
    v_and_b32 v67, 0xffff0000, v17
    v_lshlrev_b32 v68, 16, v18
    v_and_b32 v69, 0xffff0000, v18
    v_mul_f32 v56, v64, v48
    v_mul_f32 v57, v65, v48
    v_mul_f32 v58, v66, v48
    v_mul_f32 v59, v67, v48
    v_mul_f32 v60, v68, v48
    v_mul_f32 v61, v69, v48
    v_lshlrev_b32 v64, 16, v20
    v_and_b32 v65, 0xffff0000, v20
    v_lshlrev_b32 v66, 16, v21
    v_and_b32 v67, 0xffff0000, v21
    v_lshlrev_b32 v68, 16, v22
    v_and_b32 v69, 0xffff0000, v22
    v_fmac_f32 v56, v64, v49
    v_fmac_f32 v57, v65, v49
    v_fmac_f32 v58, v66, v49
    v_fmac_f32 v59, v67, v49
    v_fmac_f32 v60, v68, v49
    v_fmac_f32 v61, v69, v49
    v_add_f32 v48, v48, v49
    v_lshlrev_b32 v64, 16, v24
    v_and_b32 v65, 0xffff0000, v24
    v_lshlrev_b32 v66, 16, v25
    v_and_b32 v67, 0xffff0000, v25
    v_lshlrev_b32 v68, 16, v26
    v_and_b32 v69, 0xffff0000, v26
    v_fmac_f32 v56, v64, v50
    v_fmac_f32 v57, v65, v50
    v_fmac_f32 v58, v66, v50
    v_fmac_f32 v59, v67, v50
    v_fmac_f32 v60, v68, v50
    v_fmac_f32 v61, v69, v50
    v_add_f32 v48, v48, v50
    v_lshlrev_b32 v64, 16, v28
    v_and_b32 v65, 0xffff0000, v28
    v_lshlrev_b32 v66, 16, v29
    v_and_b32 v67, 0xffff0000, v29
    v_lshlrev_b32 v68, 16, v30
    v_and_b32 v69, 0xffff0000, v30
    v_fmac_f32 v56, v64, v51
    v_fmac_f32 v57, v65, v51
    v_fmac_f32 v58, v66, v51
    v_fmac_f32 v59, v67, v51
    v_fmac_f32 v60, v68, v51
    v_fmac_f32 v61, v69, v51
    v_add_f32 v48, v48, v51
    v_lshlrev_b32 v64, 16, v32
    v_and_b32 v65, 0xffff0000, v32
    v_lshlrev_b32 v66, 16, v33
    v_and_b32 v67, 0xffff0000, v33
    v_lshlrev_b32 v68, 16, v34
    v_and_b32 v69, 0xffff0000, v34
    v_fmac_f32 v56, v64, v52
    v_fmac_f32 v57, v65, v52
    v_fmac_f32 v58, v66, v52
    v_fmac_f32 v59, v67, v52
    v_fmac_f32 v60, v68, v52
    v_fmac_f32 v61, v69, v52
    v_add_f32 v48, v48, v52
    v_lshlrev_b32 v64, 16, v36
    v_and_b32 v65, 0xffff0000, v36
    v_lshlrev_b32 v66, 16, v37
    v_and_b32 v67, 0xffff0000, v37
    v_lshlrev_b32 v68, 16, v38
    v_and_b32 v69, 0xffff0000, v38
    v_fmac_f32 v56, v64, v53
    v_fmac_f32 v57, v65, v53
    v_fmac_f32 v58, v66, v53
    v_fmac_f32 v59, v67, v53
    v_fmac_f32 v60, v68, v53
    v_fmac_f32 v61, v69, v53
    v_add_f32 v48, v48, v53
    v_lshlrev_b32 v64, 16, v40
    v_and_b32 v65, 0xffff0000, v40
    v_lshlrev_b32 v66, 16, v41
    v_and_b32 v67, 0xffff0000, v41
    v_lshlrev_b32 v68, 16, v42
    v_and_b32 v69, 0xffff0000, v42
    v_fmac_f32 v56, v64, v54
    v_fmac_f32 v57, v65, v54
    v_fmac_f32 v58, v66, v54
    v_fmac_f32 v59, v67, v54
    v_fmac_f32 v60, v68, v54
    v_fmac_f32 v61, v69, v54
    v_add_f32 v48, v48, v54
    v_lshlrev_b32 v64, 16, v44
    v_and_b32 v65, 0xffff0000, v44
    v_lshlrev_b32 v66, 16, v45
    v_and_b32 v67, 0xffff0000, v45
    v_lshlrev_b32 v68, 16, v46
    v_and_b32 v69, 0xffff0000, v46
    v_fmac_f32 v56, v64, v55
    v_fmac_f32 v57, v65, v55
    v_fmac_f32 v58, v66, v55
    v_fmac_f32 v59, v67, v55
    v_fmac_f32 v60, v68, v55
    v_fmac_f32 v61, v69, v55
    v_add_f32 v48, v48, v55
    v_mov_b32 v62, v48
    v_mov_b32 v63, v7
    v_add_f32_dpp v56, v56, v56 row_ror:8 row_mask:0xf bank_mask:0xf
    v_add_f32_dpp v57, v57, v57 row_ror:8 row_mask:0xf bank_mask:0xf
    v_add_f32_dpp v58, v58, v58 row_ror:8 row_mask:0xf bank_mask:0xf
    v_add_f32_dpp v59, v59, v59 row_ror:8 row_mask:0xf bank_mask:0xf
    v_add_f32_dpp v60, v60, v60 row_ror:8 row_mask:0xf bank_mask:0xf
    v_add_f32_dpp v61, v61, v61 row_ror:8 row_mask:0xf bank_mask:0xf
    v_add_f32_dpp v62, v62, v62 row_ror:8 row_mask:0xf bank_mask:0xf
    v_mov_b32 v64, v56
    v_mov_b32 v65, v57
    v_mov_b32 v66, v58
    v_mov_b32 v67, v59
    v_mov_b32 v68, v60
    v_mov_b32 v69, v61
    v_mov_b32 v70, v62
    v_permlane16_swap_b32 v56, v64
    v_permlane16_swap_b32 v57, v65
    v_permlane16_swap_b32 v58, v66
    v_permlane16_swap_b32 v59, v67
    v_permlane16_swap_b32 v60, v68
    v_permlane16_swap_b32 v61, v69
    v_permlane16_swap_b32 v62, v70
    v_add_f32 v56, v56, v64
    v_add_f32 v57, v57, v65
    v_add_f32 v58, v58, v66
    v_add_f32 v59, v59, v67
    v_add_f32 v60, v60, v68
    v_add_f32 v61, v61, v69
    v_add_f32 v62, v62, v70
    v_mov_b32 v64, v56
    v_mov_b32 v65, v57
    v_mov_b32 v66, v58
    v_mov_b32 v67, v59
    v_mov_b32 v68, v60
    v_mov_b32 v69, v61
    v_mov_b32 v70, v62
    v_permlane32_swap_b32 v56, v64
    v_permlane32_swap_b32 v57, v65
    v_permlane32_swap_b32 v58, v66
    v_permlane32_swap_b32 v59, v67
    v_permlane32_swap_b32 v60, v68
    v_permlane32_swap_b32 v61, v69
    v_permlane32_swap_b32 v62, v70
    v_add_f32 v56, v56, v64
    v_add_f32 v57, v57, v65
    v_add_f32 v58, v58, v66
    v_add_f32 v59, v59, v67
    v_add_f32 v60, v60, v68
    v_add_f32 v61, v61, v69
    v_add_f32 v62, v62, v70
    v_lshlrev_b32 v64, 5, v0
    s_lshl_b32 s56, s3, 8
    v_add_u32 v64, s56, v64
    s_mov_b64 exec, 0xff
    ds_write_b128 v64, v[56:59]
    ds_write_b128 v64, v[60:63] offset:16
    s_mov_b64 exec, -1
    s_waitcnt lgkmcnt(0)
    s_barrier
    s_cmp_lg_u32 s3, 0
    s_cbranch_scc1 L_comb_end
    v_and_b32 v5, 0xff, v5
    v_mov_b32 v1, 24
    ds_read_b64 v[16:17], v5 offset:0
    ds_read_b64 v[24:25], v1 offset:0
    ds_read_b64 v[18:19], v5 offset:256
    ds_read_b64 v[26:27], v1 offset:256
    ds_read_b64 v[20:21], v5 offset:512
    ds_read_b64 v[28:29], v1 offset:512
    ds_read_b64 v[22:23], v5 offset:768
    ds_read_b64 v[30:31], v1 offset:768
    s_waitcnt lgkmcnt(0)
    v_max3_f32 v7, v25, v27, v29
    v_max_f32 v7, v7, v31
    v_sub_f32 v48, v25, v7
    v_sub_f32 v49, v27, v7
    v_sub_f32 v50, v29, v7
    v_sub_f32 v51, v31, v7
    v_exp_f32 v48, v48
    v_exp_f32 v49, v49
    v_exp_f32 v50, v50
    v_exp_f32 v51, v51
    v_mul_f32 v58, v24, v48
    v_mul_f32 v56, v16, v48
    v_mul_f32 v57, v17, v48
    v_fmac_f32 v58, v26, v49
    v_fmac_f32 v56, v18, v49
    v_fmac_f32 v57, v19, v49
    v_fmac_f32 v58, v28, v50
    v_fmac_f32 v56, v20, v50
    v_fmac_f32 v57, v21, v50
    v_fmac_f32 v58, v30, v51
    v_fmac_f32 v56, v22, v51
    v_fmac_f32 v57, v23, v51
    v_rcp_f32 v58, v58
    s_waitcnt vmcnt(0)
    v_lshlrev_b32 v64, 16, v6
    v_and_b32 v65, 0xffff0000, v6
    v_fmac_f32 v64, v56, v58
    v_fmac_f32 v65, v57, v58
    v_cvt_pk_bf16_f32 v64, v64, v65
    buffer_store_dword v64, v3, s[68:71], s58 offen
L_comb_end:
    s_endpgm
.section .rodata,"a"
.p2align 6
.amdhsa_kernel prep_kernel
  .amdhsa_next_free_vgpr 512
  .amdhsa_next_free_sgpr 102
  .amdhsa_accum_offset 256
  .amdhsa_group_segment_fixed_size 0
  .amdhsa_kernarg_size 80
  .amdhsa_user_sgpr_count 2
  .amdhsa_user_sgpr_kernarg_segment_ptr 1
  .amdhsa_system_sgpr_workgroup_id_x 1
  .amdhsa_float_denorm_mode_32 3
.end_amdhsa_kernel
.p2align 6
.amdhsa_kernel main_kernel
  .amdhsa_next_free_vgpr 448
  .amdhsa_next_free_sgpr 102
  .amdhsa_accum_offset 256
  .amdhsa_group_segment_fixed_size 0
  .amdhsa_kernarg_size 80
  .amdhsa_user_sgpr_count 2
  .amdhsa_user_sgpr_kernarg_segment_ptr 1
  .amdhsa_system_sgpr_workgroup_id_x 1
  .amdhsa_float_denorm_mode_32 3
.end_amdhsa_kernel
.p2align 6
.amdhsa_kernel comb_kernel
  .amdhsa_next_free_vgpr 72
  .amdhsa_next_free_sgpr 102
  .amdhsa_accum_offset 72
  .amdhsa_group_segment_fixed_size 0
  .amdhsa_kernarg_size 80
  .amdhsa_user_sgpr_count 2
  .amdhsa_user_sgpr_kernarg_segment_ptr 1
  .amdhsa_system_sgpr_workgroup_id_x 1
  .amdhsa_float_denorm_mode_32 3
.end_amdhsa_kernel
```

```asm
; @launch grid=(256,1,1) block=(256,1,1) lds=163840
.amdgcn_target "amdgcn-amd-amdhsa--gfx950"
.text
.globl standalone__detection_seg_dino__vision_kernel
.p2align 8
.type standalone__detection_seg_dino__vision_kernel,@function
standalone__detection_seg_dino__vision_kernel:
    s_cmp_ge_u32 s2, 256
    s_cbranch_scc1 L_end
    s_load_dwordx16 s[4:19], s[0:1], 0
    s_load_dwordx4 s[20:23], s[0:1], 64
    s_getpc_b64 s[54:55]
L_pc_main:
    v_lshlrev_b32 v233, 7, v0
    v_min_u32 v233, L_codeend - L_pc_main - 4, v233
    global_load_dword v232, v233, s[54:55]
    v_lshrrev_b32 v1, 6, v0
    v_and_b32 v0, 63, v0
    v_readfirstlane_b32 s3, v1
    v_lshlrev_b32 v65, 4, v0
    v_lshrrev_b32 v1, 2, v0
    v_and_b32 v1, 14, v1
    s_mov_b32 s56, 0x5000
    v_bfe_u32 v2, s56, v1, 2
    v_lshlrev_b32 v2, 5, v2
    v_xor_b32 v16, v65, v2
    s_mov_b32 s56, 0xaa55
    v_bfe_u32 v2, s56, v1, 2
    v_lshlrev_b32 v2, 5, v2
    v_xor_b32 v17, v65, v2
    s_mov_b32 s56, 0xfffa
    v_bfe_u32 v2, s56, v1, 2
    v_lshlrev_b32 v2, 5, v2
    v_xor_b32 v18, v65, v2
    v_xor_b32 v19, 16, v16
    v_xor_b32 v20, 0x1010, v17
    v_xor_b32 v21, 0x1010, v18
    v_lshrrev_b32 v1, 3, v0
    v_and_b32 v1, 6, v1
    s_mov_b32 s56, 0x40
    v_bfe_u32 v2, s56, v1, 2
    v_lshlrev_b32 v2, 5, v2
    v_xor_b32 v22, v65, v2
    s_mov_b32 s56, 0xa5
    v_bfe_u32 v2, s56, v1, 2
    v_lshlrev_b32 v2, 5, v2
    v_xor_b32 v23, v65, v2
    s_mov_b32 s56, 0xfe
    v_bfe_u32 v2, s56, v1, 2
    v_lshlrev_b32 v2, 5, v2
    v_xor_b32 v24, v65, v2
    v_xor_b32 v25, 0x80, v22
    v_xor_b32 v26, 0x1080, v23
    v_xor_b32 v27, 0x1080, v24
    v_xor_b32 v28, 0x1010, v22
    v_xor_b32 v29, 0x1010, v23
    v_xor_b32 v30, 0x2010, v24
    v_xor_b32 v31, 0x2090, v22
    v_xor_b32 v32, 0x2090, v23
    v_xor_b32 v33, 0x2090, v24
    s_mul_i32 s36, s3, 6144
    s_mul_i32 s37, s3, 12288
    s_add_u32 s40, s36, 0
    s_add_u32 s41, s37, 24576
    s_add_u32 s42, s37, 73728
    s_mul_i32 s56, s2, 393216
    s_mul_i32 s57, s2, 98304
    s_sub_u32 s43, s2, 128
    s_cmp_eq_u32 s3, 3
    s_cselect_b32 s43, s43, -1
    s_waitcnt lgkmcnt(0)
    s_add_u32 s28, s8, s57
    s_addc_u32 s29, s9, 0
    s_mov_b32 s30, 98304
    s_mov_b32 s31, 0x20000
    s_add_u32 s24, s6, s56
    s_addc_u32 s25, s7, 0
    s_mov_b32 s26, 393216
    s_mov_b32 s27, 0x20000
    s_mov_b32 s32, s22
    s_mov_b32 s33, s23
    s_mov_b32 s34, 8388608
    s_mov_b32 s35, 0x20000
    s_and_b32 s56, s2, 7
    s_cmp_ge_u32 s56, 3
    s_cbranch_scc1 L_nopf
    s_cmp_eq_u32 s3, 3
    s_cbranch_scc1 L_nopf
    s_lshr_b32 s57, s2, 3
    s_mul_i32 s56, s56, 24576
    s_cmp_eq_u32 s3, 1
    s_cselect_b32 s64, s12, s10
    s_cselect_b32 s65, s13, s11
    s_cselect_b32 s56, s56, 0
    s_cselect_b32 s58, 6, 18
    s_mov_b32 s66, 73728
    s_cmp_eq_u32 s3, 2
    s_cselect_b32 s64, s4, s64
    s_cselect_b32 s65, s5, s65
    s_cselect_b32 s66, 6144, s66
    s_cselect_b32 s58, 2, s58
    s_mov_b32 s67, 0x20000
    s_mul_i32 s57, s57, s58
    s_sub_u32 s58, s58, 1
    v_min_u32 v1, s58, v0
    v_add_u32 v1, s57, v1
    v_lshlrev_b32 v1, 7, v1
    buffer_load_dword v234, v1, s[64:67], s56 offen
L_nopf:
    s_cmp_lt_u32 s2, 3
    s_cbranch_scc1 L_prod
    s_load_dword s38, s[22:23], 0
    s_add_u32 m0, s40, 0
    s_add_u32 s57, s36, 0
    buffer_load_dwordx4 v16, s[28:31], s57 offen offset:0 nt lds
    buffer_load_dwordx4 v17, s[28:31], s57 offen offset:1024 nt lds
    buffer_load_dwordx4 v18, s[28:31], s57 offen offset:2048 nt lds
    buffer_load_dwordx4 v19, s[28:31], s57 offen offset:3072 nt lds
    s_add_u32 m0, s40, 4096
    s_nop 0
    buffer_load_dwordx4 v20, s[28:31], s57 offen offset:0 nt lds
    buffer_load_dwordx4 v21, s[28:31], s57 offen offset:1024 nt lds
    s_add_u32 m0, s41, 0
    s_add_u32 s58, s37, 0
    buffer_load_dwordx4 v22, s[24:27], s58 offen offset:0 nt lds
    buffer_load_dwordx4 v23, s[24:27], s58 offen offset:1024 nt lds
    buffer_load_dwordx4 v24, s[24:27], s58 offen offset:2048 nt lds
    buffer_load_dwordx4 v25, s[24:27], s58 offen offset:3072 nt lds
    s_add_u32 m0, s41, 4096
    s_nop 0
    buffer_load_dwordx4 v26, s[24:27], s58 offen offset:0 nt lds
    buffer_load_dwordx4 v27, s[24:27], s58 offen offset:1024 nt lds
    buffer_load_dwordx4 v28, s[24:27], s58 offen offset:2048 nt lds
    buffer_load_dwordx4 v29, s[24:27], s58 offen offset:3072 nt lds
    s_add_u32 m0, s41, 8192
    s_nop 0
    buffer_load_dwordx4 v30, s[24:27], s58 offen offset:0 nt lds
    buffer_load_dwordx4 v31, s[24:27], s58 offen offset:1024 nt lds
    buffer_load_dwordx4 v32, s[24:27], s58 offen offset:2048 nt lds
    buffer_load_dwordx4 v33, s[24:27], s58 offen offset:3072 nt lds
    s_cmp_ge_u32 s43, 72
    s_cbranch_scc1 L_j_nold
    s_mov_b32 s64, s14
    s_mov_b32 s65, s15
    s_mov_b32 s66, 73728
    s_mov_b32 s67, 0x20000
    s_mov_b32 s68, s16
    s_mov_b32 s69, s17
    s_mov_b32 s70, 73728
    s_mov_b32 s71, 0x20000
    s_mul_i32 s56, s43, 43
    s_lshr_b32 s56, s56, 8
    s_mul_i32 s57, s56, 6
    s_sub_u32 s57, s43, s57
    s_mul_i32 s57, s57, 12288
    s_mov_b32 m0, 122880
    s_nop 0
    buffer_load_dwordx4 v16, s[64:67], s57 offen offset:0  lds
    buffer_load_dwordx4 v17, s[64:67], s57 offen offset:1024  lds
    buffer_load_dwordx4 v18, s[64:67], s57 offen offset:2048  lds
    buffer_load_dwordx4 v19, s[64:67], s57 offen offset:3072  lds
    s_mov_b32 m0, 126976
    s_nop 0
    buffer_load_dwordx4 v20, s[64:67], s57 offen offset:0  lds
    buffer_load_dwordx4 v21, s[64:67], s57 offen offset:1024  lds
    s_add_u32 s57, s57, 6144
    s_mov_b32 m0, 129024
    s_nop 0
    buffer_load_dwordx4 v16, s[64:67], s57 offen offset:0  lds
    buffer_load_dwordx4 v17, s[64:67], s57 offen offset:1024  lds
    buffer_load_dwordx4 v18, s[64:67], s57 offen offset:2048  lds
    buffer_load_dwordx4 v19, s[64:67], s57 offen offset:3072  lds
    s_mov_b32 m0, 133120
    s_nop 0
    buffer_load_dwordx4 v20, s[64:67], s57 offen offset:0  lds
    buffer_load_dwordx4 v21, s[64:67], s57 offen offset:1024  lds
    v_lshrrev_b32 v1, 1, v0
    v_mul_u32_u24 v1, 352, v1
    v_add_u32 v1, v1, v65
    s_lshl_b32 s56, s56, 5
    s_mov_b32 m0, 135168
    s_nop 0
    buffer_load_dwordx4 v1, s[68:71], s56 offen lds
    s_mov_b32 m0, 136192
    s_add_u32 s56, s56, 12288
    buffer_load_dwordx4 v1, s[68:71], s56 offen lds
    s_mov_b32 m0, 137216
    s_add_u32 s56, s56, 12288
    buffer_load_dwordx4 v1, s[68:71], s56 offen lds
    s_mov_b32 m0, 138240
    s_add_u32 s56, s56, 12288
    buffer_load_dwordx4 v1, s[68:71], s56 offen lds
    s_mov_b32 m0, 139264
    s_add_u32 s56, s56, 12288
    buffer_load_dwordx4 v1, s[68:71], s56 offen lds
    s_mov_b32 m0, 140288
    s_add_u32 s56, s56, 12288
    buffer_load_dwordx4 v1, s[68:71], s56 offen lds
L_j_nold:
    s_add_u32 m0, s42, 0
    s_add_u32 s59, s37, 196608
    buffer_load_dwordx4 v22, s[24:27], s59 offen offset:0 nt lds
    buffer_load_dwordx4 v23, s[24:27], s59 offen offset:1024 nt lds
    buffer_load_dwordx4 v24, s[24:27], s59 offen offset:2048 nt lds
    buffer_load_dwordx4 v25, s[24:27], s59 offen offset:3072 nt lds
    s_add_u32 m0, s42, 4096
    s_nop 0
    buffer_load_dwordx4 v26, s[24:27], s59 offen offset:0 nt lds
    buffer_load_dwordx4 v27, s[24:27], s59 offen offset:1024 nt lds
    buffer_load_dwordx4 v28, s[24:27], s59 offen offset:2048 nt lds
    buffer_load_dwordx4 v29, s[24:27], s59 offen offset:3072 nt lds
    s_add_u32 m0, s42, 8192
    s_nop 0
    buffer_load_dwordx4 v30, s[24:27], s59 offen offset:0 nt lds
    buffer_load_dwordx4 v31, s[24:27], s59 offen offset:1024 nt lds
    buffer_load_dwordx4 v32, s[24:27], s59 offen offset:2048 nt lds
    buffer_load_dwordx4 v33, s[24:27], s59 offen offset:3072 nt lds
    v_and_b32 v1, 15, v0
    v_lshrrev_b32 v2, 4, v0
    v_lshrrev_b32 v6, 1, v2
    v_and_b32 v3, 1, v2
    v_lshl_or_b32 v3, v3, 1, v6
    v_lshrrev_b32 v4, 2, v0
    v_bfe_u32 v5, v0, 1, 1
    v_lshrrev_b32 v6, 3, v1
    v_and_or_b32 v6, v1, 6, v6
    v_xor_b32 v6, v6, v3
    v_mul_u32_u24 v7, 384, v1
    v_lshl_add_u32 v6, v6, 4, v7
    v_add_u32 v34, s40, v6
    v_xor_b32 v35, 64, v34
    v_lshrrev_b32 v6, 3, v1
    v_and_b32 v7, 7, v1
    v_lshl_or_b32 v6, v7, 1, v6
    v_xor_b32 v6, v6, v3
    v_mul_u32_u24 v7, 768, v1
    v_lshl_add_u32 v6, v6, 4, v7
    v_add_u32 v40, s41, v6
    v_xor_b32 v41, 0x40, v40
    v_xor_b32 v42, 0x80, v40
    v_xor_b32 v43, 0xc0, v40
    v_and_b32 v2, 1, v0
    v_lshlrev_b32 v2, 3, v2
    v_lshrrev_b32 v6, 3, v4
    v_and_or_b32 v6, v4, 6, v6
    v_xor_b32 v6, v6, v5
    v_mul_u32_u24 v7, 384, v4
    v_lshl_add_u32 v6, v6, 4, v7
    v_add3_u32 v36, s40, v6, v2
    v_xor_b32 v37, 0x20, v36
    v_xor_b32 v38, 0x40, v36
    v_xor_b32 v39, 0x60, v36
    v_lshrrev_b32 v6, 3, v4
    v_and_b32 v7, 7, v4
    v_lshl_or_b32 v6, v7, 1, v6
    v_xor_b32 v6, v6, v5
    v_mul_u32_u24 v7, 768, v4
    v_lshl_add_u32 v6, v6, 4, v7
    v_add3_u32 v44, s41, v6, v2
    v_xor_b32 v45, 0x20, v44
    v_xor_b32 v46, 0x40, v44
    v_xor_b32 v47, 0x60, v44
    v_xor_b32 v48, 0x80, v44
    v_xor_b32 v49, 0xa0, v44
    v_xor_b32 v50, 0xc0, v44
    v_xor_b32 v51, 0xe0, v44
    v_mov_b32 v52, 0x3f803f80
    v_mov_b32 v56, 0x3ebcbe62
    s_mov_b32 s44, 0x100001
    s_mov_b32 s45, 0x10000100
    v_mov_b32 v53, 0x3f803f80
    v_mov_b32 v57, 0x3ebcbe62
    s_mov_b32 s46, 0x200002
    s_mov_b32 s47, 0x20000200
    v_mov_b32 v54, 0x3f803f80
    v_mov_b32 v58, 0x3ebcbe62
    s_mov_b32 s48, 0x400004
    s_mov_b32 s49, 0x40000400
    v_mov_b32 v55, 0x3f803f80
    v_mov_b32 v59, 0x3ebcbe62
    s_mov_b32 s50, 0x800008
    s_mov_b32 s51, 0x80000800
    v_mov_b32 v60, 0x43400000
    v_lshrrev_b32 v1, 5, v0
    v_lshlrev_b32 v1, 8, v1
    v_and_b32 v2, 15, v0
    v_lshl_add_u32 v1, v2, 4, v1
    v_bfe_u32 v2, v0, 4, 1
    v_lshl_add_u32 v1, v2, 3, v1
    s_mul_i32 s56, s3, 1536
    s_add_u32 s56, s56, 147456
    v_add_u32 v236, s56, v1
    s_mul_i32 s56, s3, 3072
    s_add_u32 s56, s56, 24576
    v_add_u32 v237, s56, v65
    v_add_u32 v238, s41, v65
    s_lshl_b32 s56, s3, 10
    v_add_u32 v240, 159744, v65
    v_add_u32 v239, s56, v240
    v_add_u32 v241, 147456, v65
    v_bfe_u32 v1, v0, 2, 2
    v_lshlrev_b32 v1, 19, v1
    v_lshrrev_b32 v2, 4, v0
    v_lshl_or_b32 v1, v2, 15, v1
    v_and_b32 v2, 3, v0
    v_lshl_or_b32 v242, v2, 4, v1
    v_xor_b32 v243, 0x70, v242
    s_mul_i32 s56, s3, 18
    v_min_u32 v1, 17, v0
    v_add_u32 v1, s56, v1
    v_lshlrev_b32 v245, 7, v1
    s_mov_b32 s52, 0x41c00000
L_join:
    s_mul_i32 s60, s3, 18432
    s_waitcnt vmcnt(24)
    ds_read_b128 a[48:51], v34 offset:0
    ds_read_b128 a[52:55], v35 offset:0
    ds_read_b128 a[56:59], v34 offset:128
    ds_read_b128 a[60:63], v35 offset:128
    ds_read_b128 a[64:67], v34 offset:256
    ds_read_b128 a[68:71], v35 offset:256
    s_waitcnt lgkmcnt(0)
    v_mfma_f32_16x16x32_bf16 v[84:87], a[48:51], a[48:51], 0
    ds_read_b64_tr_b16 a[72:73], v36 offset:0
    ds_read_b64_tr_b16 a[74:75], v37 offset:0
    v_mfma_f32_16x16x32_bf16 v[80:83], a[48:51], v[52:55], 0
    ds_read_b64_tr_b16 a[76:77], v38 offset:0
    ds_read_b64_tr_b16 a[78:79], v39 offset:0
    v_mfma_f32_16x16x32_bf16 v[84:87], a[52:55], a[52:55], v[84:87]
    ds_read_b64_tr_b16 a[80:81], v36 offset:128
    ds_read_b64_tr_b16 a[82:83], v37 offset:128
    v_mfma_f32_16x16x32_bf16 v[80:83], a[52:55], v[52:55], v[80:83]
    ds_read_b64_tr_b16 a[84:85], v38 offset:128
    ds_read_b64_tr_b16 a[86:87], v39 offset:128
    v_mfma_f32_16x16x32_bf16 v[84:87], a[56:59], a[56:59], v[84:87]
    ds_read_b64_tr_b16 a[88:89], v36 offset:256
    ds_read_b64_tr_b16 a[90:91], v37 offset:256
    v_mfma_f32_16x16x32_bf16 v[80:83], a[56:59], v[52:55], v[80:83]
    ds_read_b64_tr_b16 a[92:93], v38 offset:256
    ds_read_b64_tr_b16 a[94:95], v39 offset:256
    v_mfma_f32_16x16x32_bf16 v[84:87], a[60:63], a[60:63], v[84:87]
    v_mfma_f32_16x16x32_bf16 v[80:83], a[60:63], v[52:55], v[80:83]
    v_mfma_f32_16x16x32_bf16 v[84:87], a[64:67], a[64:67], v[84:87]
    v_mfma_f32_16x16x32_bf16 v[80:83], a[64:67], v[52:55], v[80:83]
    v_mfma_f32_16x16x32_bf16 v[84:87], a[68:71], a[68:71], v[84:87]
    v_mfma_f32_16x16x32_bf16 v[80:83], a[68:71], v[52:55], v[80:83]
    s_waitcnt lgkmcnt(0)
    s_mul_i32 s39, s38, 0x9e3779b1
    s_add_u32 s39, s39, 0x7f4a7c16
    s_or_b32 s39, s39, 1
    s_barrier
    s_add_u32 m0, s40, 0
    s_add_u32 s57, s36, 24576
    buffer_load_dwordx4 v16, s[28:31], s57 offen offset:0 nt lds
    buffer_load_dwordx4 v17, s[28:31], s57 offen offset:1024 nt lds
    buffer_load_dwordx4 v18, s[28:31], s57 offen offset:2048 nt lds
    buffer_load_dwordx4 v19, s[28:31], s57 offen offset:3072 nt lds
    s_add_u32 m0, s40, 4096
    s_nop 0
    buffer_load_dwordx4 v20, s[28:31], s57 offen offset:0 nt lds
    buffer_load_dwordx4 v21, s[28:31], s57 offen offset:1024 nt lds
    s_mul_i32 s56, s3, 3072
    s_add_u32 s56, s56, 16384
    buffer_load_dwordx4 v[120:123], v65, s[32:35], s56 offen offset:0 sc1
    buffer_load_dwordx4 v[124:127], v65, s[32:35], s56 offen offset:1024 sc1
    buffer_load_dwordx4 v[128:131], v65, s[32:35], s56 offen offset:2048 sc1
    s_waitcnt vmcnt(21)
    ds_read_b128 a[96:99], v40 offset:0
    ds_read_b128 a[100:103], v41 offset:0
    ds_read_b128 a[104:107], v42 offset:0
    ds_read_b128 a[108:111], v43 offset:0
    ds_read_b128 a[112:115], v40 offset:256
    ds_read_b128 a[116:119], v41 offset:256
    ds_read_b128 a[120:123], v42 offset:256
    ds_read_b128 a[124:127], v43 offset:256
    ds_read_b128 a[128:131], v40 offset:512
    ds_read_b128 a[132:135], v41 offset:512
    ds_read_b128 a[136:139], v42 offset:512
    ds_read_b128 a[140:143], v43 offset:512
    ds_read_b64_tr_b16 a[144:145], v44 offset:0
    ds_read_b64_tr_b16 a[146:147], v48 offset:256
    ds_read_b64_tr_b16 a[148:149], v45 offset:0
    ds_read_b64_tr_b16 a[150:151], v49 offset:256
    ds_read_b64_tr_b16 a[152:153], v46 offset:0
    ds_read_b64_tr_b16 a[154:155], v50 offset:256
    ds_read_b64_tr_b16 a[156:157], v47 offset:0
    ds_read_b64_tr_b16 a[158:159], v51 offset:256
    ds_read_b64_tr_b16 a[160:161], v48 offset:0
    ds_read_b64_tr_b16 a[162:163], v44 offset:512
    ds_read_b64_tr_b16 a[164:165], v49 offset:0
    ds_read_b64_tr_b16 a[166:167], v45 offset:512
    ds_read_b64_tr_b16 a[168:169], v50 offset:0
    ds_read_b64_tr_b16 a[170:171], v46 offset:512
    ds_read_b64_tr_b16 a[172:173], v51 offset:0
    ds_read_b64_tr_b16 a[174:175], v47 offset:512
    ds_read_b64_tr_b16 a[176:177], v44 offset:256
    ds_read_b64_tr_b16 a[178:179], v48 offset:512
    ds_read_b64_tr_b16 a[180:181], v45 offset:256
    ds_read_b64_tr_b16 a[182:183], v49 offset:512
    ds_read_b64_tr_b16 a[184:185], v46 offset:256
    ds_read_b64_tr_b16 a[186:187], v50 offset:512
    ds_read_b64_tr_b16 a[188:189], v47 offset:256
    ds_read_b64_tr_b16 a[190:191], v51 offset:512
    s_waitcnt lgkmcnt(0)
    s_cmp_ge_u32 s43, 72
    s_cbranch_scc1 L_j_nocp
    v_bfe_u32 v1, v0, 2, 1
    v_and_b32 v2, 3, v0
    v_lshl_or_b32 v2, v1, 3, v2
    v_and_or_b32 v1, v0, 2, v1
    v_lshrrev_b32 v3, 4, v0
    v_xor_b32 v1, v1, v3
    v_mul_u32_u24 v2, 384, v2
    v_lshl_add_u32 v1, v1, 4, v2
    v_bfe_u32 v2, v0, 3, 1
    v_mul_u32_u24 v2, 6144, v2
    s_mov_b32 s56, 122880
    v_add3_u32 v96, s56, v1, v2
    v_xor_b32 v97, 64, v96
    v_and_b32 v1, 15, v0
    v_lshlrev_b32 v1, 3, v1
    v_lshl_add_u32 v1, v3, 8, v1
    v_add_u32 v100, 135168, v1
    s_waitcnt vmcnt(21)
    ds_read_b64_tr_b16 v[208:209], v100 offset:0
    ds_read_b64_tr_b16 v[210:211], v100 offset:128
    ds_read_b128 v[160:163], v96 offset:0
    ds_read_b128 v[184:187], v97 offset:1536
    ds_read_b64_tr_b16 v[212:213], v100 offset:1024
    ds_read_b64_tr_b16 v[214:215], v100 offset:1152
    ds_read_b128 v[164:167], v97 offset:0
    ds_read_b128 v[188:191], v96 offset:1536
    ds_read_b64_tr_b16 v[216:217], v100 offset:2048
    ds_read_b64_tr_b16 v[218:219], v100 offset:2176
    ds_read_b128 v[168:171], v96 offset:128
    ds_read_b128 v[192:195], v97 offset:1664
    ds_read_b64_tr_b16 v[220:221], v100 offset:3072
    ds_read_b64_tr_b16 v[222:223], v100 offset:3200
    ds_read_b128 v[172:175], v97 offset:128
    ds_read_b128 v[196:199], v96 offset:1664
    ds_read_b64_tr_b16 v[224:225], v100 offset:4096
    ds_read_b64_tr_b16 v[226:227], v100 offset:4224
    ds_read_b128 v[176:179], v96 offset:256
    ds_read_b128 v[200:203], v97 offset:1792
    ds_read_b64_tr_b16 v[228:229], v100 offset:5120
    ds_read_b64_tr_b16 v[230:231], v100 offset:5248
    ds_read_b128 v[180:183], v97 offset:256
    ds_read_b128 v[204:207], v96 offset:1792
    s_lshl_b32 s56, s43, 10
    s_add_u32 s56, s56, 2162688
    s_waitcnt lgkmcnt(15)
    v_mfma_f32_16x16x32_bf16 v[88:91], v[160:163], v[208:211], 0
    v_mfma_f32_16x16x32_bf16 v[92:95], v[184:187], v[208:211], 0
    v_mfma_f32_16x16x32_bf16 v[88:91], v[164:167], v[212:215], v[88:91]
    v_mfma_f32_16x16x32_bf16 v[92:95], v[188:191], v[212:215], v[92:95]
    s_waitcnt lgkmcnt(12)
    v_mfma_f32_16x16x32_bf16 v[88:91], v[168:171], v[216:219], v[88:91]
    v_mfma_f32_16x16x32_bf16 v[92:95], v[192:195], v[216:219], v[92:95]
    s_waitcnt lgkmcnt(8)
    v_mfma_f32_16x16x32_bf16 v[88:91], v[172:175], v[220:223], v[88:91]
    v_mfma_f32_16x16x32_bf16 v[92:95], v[196:199], v[220:223], v[92:95]
    s_waitcnt lgkmcnt(4)
    v_mfma_f32_16x16x32_bf16 v[88:91], v[176:179], v[224:227], v[88:91]
    v_mfma_f32_16x16x32_bf16 v[92:95], v[200:203], v[224:227], v[92:95]
    s_waitcnt lgkmcnt(0)
    v_mfma_f32_16x16x32_bf16 v[88:91], v[180:183], v[228:231], v[88:91]
    v_mfma_f32_16x16x32_bf16 v[92:95], v[204:207], v[228:231], v[92:95]
    s_nop 6
    v_cvt_pk_bf16_f32 v96, v88, v89
    v_cvt_pk_bf16_f32 v97, v90, v91
    v_cvt_pk_bf16_f32 v98, v92, v93
    v_cvt_pk_bf16_f32 v99, v94, v95
    buffer_store_dwordx4 v[96:99], v65, s[32:35], s56 offen sc1
L_j_nocp:
    s_barrier
    s_add_u32 m0, s41, 0
    s_add_u32 s58, s37, 49152
    buffer_load_dwordx4 v22, s[24:27], s58 offen offset:0 nt lds
    buffer_load_dwordx4 v23, s[24:27], s58 offen offset:1024 nt lds
    buffer_load_dwordx4 v24, s[24:27], s58 offen offset:2048 nt lds
    buffer_load_dwordx4 v25, s[24:27], s58 offen offset:3072 nt lds
    s_add_u32 m0, s41, 4096
    s_nop 0
    buffer_load_dwordx4 v26, s[24:27], s58 offen offset:0 nt lds
    buffer_load_dwordx4 v27, s[24:27], s58 offen offset:1024 nt lds
    buffer_load_dwordx4 v28, s[24:27], s58 offen offset:2048 nt lds
    buffer_load_dwordx4 v29, s[24:27], s58 offen offset:3072 nt lds
    s_add_u32 m0, s41, 8192
    s_nop 0
    buffer_load_dwordx4 v30, s[24:27], s58 offen offset:0 nt lds
    buffer_load_dwordx4 v31, s[24:27], s58 offen offset:1024 nt lds
    buffer_load_dwordx4 v32, s[24:27], s58 offen offset:2048 nt lds
    buffer_load_dwordx4 v33, s[24:27], s58 offen offset:3072 nt lds
    s_mul_i32 s56, s3, 1536
    v_lshlrev_b32 v5, 3, v0
    v_add_u32 v5, 153600, v5
    v_add_u32 v4, s56, v5
    s_waitcnt vmcnt(12)
    v_xor_b32 v1, s39, v122
    v_xor_b32 v2, s39, v126
    v_xor_b32 v3, s39, v130
    v_or3_b32 v1, v1, v2, v3
    v_cmp_ne_u32 vcc, 0, v1
    s_cbranch_vccnz L_qk_retry
L_qk_ok:
    ds_write_b64 v4, v[120:121] offset:0
    ds_write_b64 v4, v[124:125] offset:512
    ds_write_b64 v4, v[128:129] offset:1024
    s_cmp_ge_u32 s43, 72
    s_cbranch_scc1 L_j_nofl
    s_lshl_b32 s56, s43, 7
    v_mov_b32 v1, s39
    v_mov_b32 v2, 0
    s_mov_b64 exec, 1
    s_waitcnt vmcnt(12)
    buffer_store_dword v1, v2, s[32:35], s56 offen offset:128 sc1
    s_mov_b64 exec, -1
L_j_nofl:
    s_waitcnt lgkmcnt(0)
    s_barrier
    ds_read2st64_b64 v[136:139], v5 offset0:0 offset1:1
    ds_read2st64_b64 v[140:143], v5 offset0:2 offset1:3
    ds_read2st64_b64 v[144:147], v5 offset0:4 offset1:5
    ds_read2st64_b64 v[148:151], v5 offset0:6 offset1:7
    ds_read2st64_b64 v[152:155], v5 offset0:8 offset1:9
    ds_read2st64_b64 v[156:159], v5 offset0:10 offset1:11
    s_waitcnt lgkmcnt(5)
    v_mfma_f32_16x16x32_bf16 v[120:123], v[52:55], v[136:139], 0
    v_mfma_f32_16x16x32_bf16 v[76:79], a[48:51], v[136:139], 0
    s_waitcnt lgkmcnt(4)
    v_mfma_f32_16x16x32_bf16 v[120:123], v[52:55], v[140:143], v[120:123]
    v_mfma_f32_16x16x32_bf16 v[76:79], a[52:55], v[140:143], v[76:79]
    s_waitcnt lgkmcnt(3)
    v_mfma_f32_16x16x32_bf16 v[120:123], v[52:55], v[144:147], v[120:123]
    v_mfma_f32_16x16x32_bf16 v[76:79], a[56:59], v[144:147], v[76:79]
    s_waitcnt lgkmcnt(2)
    v_mfma_f32_16x16x32_bf16 v[120:123], v[52:55], v[148:151], v[120:123]
    v_mfma_f32_16x16x32_bf16 v[76:79], a[60:63], v[148:151], v[76:79]
    s_waitcnt lgkmcnt(1)
    v_mfma_f32_16x16x32_bf16 v[120:123], v[52:55], v[152:155], v[120:123]
    v_mfma_f32_16x16x32_bf16 v[76:79], a[64:67], v[152:155], v[76:79]
    s_waitcnt lgkmcnt(0)
    v_mfma_f32_16x16x32_bf16 v[120:123], v[52:55], v[156:159], v[120:123]
    v_mfma_f32_16x16x32_bf16 v[76:79], a[68:71], v[156:159], v[76:79]
    s_nop 6
    v_mul_f32 v61, 0x3baaaaab, v120
    v_mfma_f32_16x16x32_bf16 v[96:99], a[96:99], a[96:99], v[84:87]
    v_mfma_f32_16x16x32_bf16 v[100:103], a[96:99], a[48:51], 0
    v_mfma_f32_16x16x32_bf16 v[96:99], a[100:103], a[100:103], v[96:99]
    v_mfma_f32_16x16x32_bf16 v[100:103], a[100:103], a[52:55], v[100:103]
    v_mfma_f32_16x16x32_bf16 v[96:99], a[104:107], a[104:107], v[96:99]
    v_mfma_f32_16x16x32_bf16 v[100:103], a[104:107], a[56:59], v[100:103]
    v_mfma_f32_16x16x32_bf16 v[96:99], a[108:111], a[108:111], v[96:99]
    v_mfma_f32_16x16x32_bf16 v[100:103], a[108:111], a[60:63], v[100:103]
    v_mfma_f32_16x16x32_bf16 v[96:99], a[112:115], a[112:115], v[96:99]
    v_mfma_f32_16x16x32_bf16 v[100:103], a[112:115], a[64:67], v[100:103]
    v_mfma_f32_16x16x32_bf16 v[96:99], a[116:119], a[116:119], v[96:99]
    v_mfma_f32_16x16x32_bf16 v[100:103], a[116:119], a[68:71], v[100:103]
    v_mfma_f32_16x16x32_bf16 v[92:95], a[96:99], v[52:55], v[80:83]
    v_mfma_f32_16x16x32_bf16 v[92:95], a[100:103], v[52:55], v[92:95]
    v_mfma_f32_16x16x32_bf16 v[92:95], a[104:107], v[52:55], v[92:95]
    v_mfma_f32_16x16x32_bf16 v[92:95], a[108:111], v[52:55], v[92:95]
    s_nop 3
    v_fma_f32 v96, v100, 2.0, v96
    v_fma_f32 v97, v101, 2.0, v97
    v_mfma_f32_16x16x32_bf16 v[92:95], a[112:115], v[52:55], v[92:95]
    v_fma_f32 v98, v102, 2.0, v98
    v_fma_f32 v99, v103, 2.0, v99
    v_mfma_f32_16x16x32_bf16 v[92:95], a[116:119], v[52:55], v[92:95]
    v_cndmask_b32 v3, 0, v96, s[44:45]
    v_cndmask_b32 v3, v3, v97, s[46:47]
    v_mfma_f32_16x16x32_bf16 v[88:91], a[96:99], v[136:139], v[76:79]
    v_cndmask_b32 v3, v3, v98, s[48:49]
    v_cndmask_b32 v3, v3, v99, s[50:51]
    v_mfma_f32_16x16x32_bf16 v[88:91], a[100:103], v[140:143], v[88:91]
    s_nop 0
    s_nop 0
    v_mfma_f32_16x16x32_bf16 v[88:91], a[104:107], v[144:147], v[88:91]
    v_mfma_f32_16x16x4_f32 v[120:123], v3, v60, v[56:59]
    v_mfma_f32_16x16x32_bf16 v[88:91], a[108:111], v[148:151], v[88:91]
    v_mfma_f32_16x16x32_bf16 v[88:91], a[112:115], v[152:155], v[88:91]
    v_mfma_f32_16x16x32_bf16 v[88:91], a[116:119], v[156:159], v[88:91]
    v_mfma_f32_16x16x32_bf16 v[112:115], a[120:123], a[120:123], v[84:87]
    v_mfma_f32_16x16x32_bf16 v[116:119], a[120:123], a[48:51], 0
    v_mfma_f32_16x16x32_bf16 v[112:115], a[124:127], a[124:127], v[112:115]
    v_mfma_f32_16x16x32_bf16 v[116:119], a[124:127], a[52:55], v[116:119]
    s_nop 2
    v_fma_f32 v128, -v92, v92, v120
    v_fma_f32 v129, -v93, v93, v121
    v_mfma_f32_16x16x32_bf16 v[112:115], a[128:131], a[128:131], v[112:115]
    v_fma_f32 v130, -v94, v94, v122
    v_fma_f32 v131, -v95, v95, v123
    v_mfma_f32_16x16x32_bf16 v[116:119], a[128:131], a[56:59], v[116:119]
    v_max_f32 v128, v128, v56
    v_max_f32 v129, v129, v56
    v_mfma_f32_16x16x32_bf16 v[112:115], a[132:135], a[132:135], v[112:115]
    v_max_f32 v130, v130, v56
    v_max_f32 v131, v131, v56
    v_mfma_f32_16x16x32_bf16 v[116:119], a[132:135], a[60:63], v[116:119]
    v_rsq_f32 v128, v128
    v_mfma_f32_16x16x32_bf16 v[112:115], a[136:139], a[136:139], v[112:115]
    v_rsq_f32 v129, v129
    v_mfma_f32_16x16x32_bf16 v[116:119], a[136:139], a[64:67], v[116:119]
    v_rsq_f32 v130, v130
    v_mfma_f32_16x16x32_bf16 v[112:115], a[140:143], a[140:143], v[112:115]
    v_rsq_f32 v131, v131
    v_mfma_f32_16x16x32_bf16 v[116:119], a[140:143], a[68:71], v[116:119]
    v_fma_f32 v88, -v92, v61, v88
    v_fma_f32 v89, -v93, v61, v89
    v_mfma_f32_16x16x32_bf16 v[108:111], a[120:123], v[52:55], v[80:83]
    v_fma_f32 v90, -v94, v61, v90
    v_fma_f32 v91, -v95, v61, v91
    v_mfma_f32_16x16x32_bf16 v[108:111], a[124:127], v[52:55], v[108:111]
    v_mul_f32 v88, v88, v128
    v_mul_f32 v89, v89, v129
    v_mfma_f32_16x16x32_bf16 v[108:111], a[128:131], v[52:55], v[108:111]
    v_mul_f32 v90, v90, v130
    v_mul_f32 v91, v91, v131
    v_mfma_f32_16x16x32_bf16 v[108:111], a[132:135], v[52:55], v[108:111]
    v_max3_f32 v1, v88, v89, v90
    v_max_f32 v1, v1, v91
    v_mfma_f32_16x16x32_bf16 v[108:111], a[136:139], v[52:55], v[108:111]
    v_mov_b32 v2, v1
    s_nop 1
    v_permlane32_swap_b32 v1, v2
    v_mfma_f32_16x16x32_bf16 v[108:111], a[140:143], v[52:55], v[108:111]
    v_max_f32 v1, v1, v2
    v_mov_b32 v2, v1
    v_mfma_f32_16x16x32_bf16 v[104:107], a[120:123], v[136:139], v[76:79]
    s_nop 0
    v_permlane16_swap_b32 v1, v2
    v_max_f32 v1, v1, v2
    v_mfma_f32_16x16x32_bf16 v[104:107], a[124:127], v[140:143], v[104:107]
    v_sub_f32 v62, 0, v1
    v_sub_f32 v88, v88, v1
    v_mfma_f32_16x16x32_bf16 v[104:107], a[128:131], v[144:147], v[104:107]
    v_sub_f32 v89, v89, v1
    v_sub_f32 v90, v90, v1
    v_mfma_f32_16x16x32_bf16 v[104:107], a[132:135], v[148:151], v[104:107]
    v_sub_f32 v91, v91, v1
    v_mfma_f32_16x16x32_bf16 v[104:107], a[136:139], v[152:155], v[104:107]
    v_exp_f32 v96, v88
    v_mfma_f32_16x16x32_bf16 v[104:107], a[140:143], v[156:159], v[104:107]
    v_exp_f32 v97, v89
    v_exp_f32 v98, v90
    v_exp_f32 v99, v91
    v_mul_f32 v88, v96, v128
    v_mul_f32 v89, v97, v129
    v_mul_f32 v90, v98, v130
    v_mul_f32 v91, v99, v131
    v_fma_f32 v112, v116, 2.0, v112
    v_fma_f32 v113, v117, 2.0, v113
    v_fma_f32 v114, v118, 2.0, v114
    v_fma_f32 v115, v119, 2.0, v115
    v_cndmask_b32 v4, 0, v112, s[44:45]
    v_cndmask_b32 v4, v4, v113, s[46:47]
    v_cndmask_b32 v4, v4, v114, s[48:49]
    v_cndmask_b32 v4, v4, v115, s[50:51]
    v_mov_b32 v63, v96
    v_mul_f32 v64, v88, v92
    v_mfma_f32_16x16x4_f32 v[124:127], v4, v60, v[56:59]
    v_add_f32 v63, v63, v97
    v_fmac_f32 v64, v89, v93
    v_add_f32 v63, v63, v98
    v_fmac_f32 v64, v90, v94
    v_add_f32 v63, v63, v99
    v_fmac_f32 v64, v91, v95
    v_mov_b32 v68, v88
    v_mov_b32 v69, v89
    v_mov_b32 v70, v90
    v_mov_b32 v71, v91
    v_fma_f32 v132, -v108, v108, v124
    v_fma_f32 v133, -v109, v109, v125
    v_fma_f32 v134, -v110, v110, v126
    v_fma_f32 v135, -v111, v111, v127
    v_max_f32 v132, v132, v56
    v_max_f32 v133, v133, v56
    v_max_f32 v134, v134, v56
    v_max_f32 v135, v135, v56
    v_rsq_f32 v132, v132
    v_rsq_f32 v133, v133
    v_rsq_f32 v134, v134
    v_rsq_f32 v135, v135
    v_fma_f32 v104, -v108, v61, v104
    v_fma_f32 v105, -v109, v61, v105
    v_fma_f32 v106, -v110, v61, v106
    v_fma_f32 v107, -v111, v61, v107
    v_fma_f32 v104, v104, v132, v62
    v_fma_f32 v105, v105, v133, v62
    v_fma_f32 v106, v106, v134, v62
    v_fma_f32 v107, v107, v135, v62
    v_max3_f32 v1, v104, v105, v106
    v_max_f32 v1, v1, v107
    v_cmp_lt_f32 vcc, s52, v1
    s_cbranch_vccnz L_site0
L_back0:
    v_exp_f32 v112, v104
    v_exp_f32 v113, v105
    v_exp_f32 v114, v106
    v_exp_f32 v115, v107
    v_mul_f32 v104, v112, v132
    v_mul_f32 v105, v113, v133
    v_mul_f32 v106, v114, v134
    v_mul_f32 v107, v115, v135
    v_cvt_pk_bf16_f32 v72, v88, v89
    v_cvt_pk_bf16_f32 v73, v90, v91
    v_cvt_pk_bf16_f32 v74, v104, v105
    v_cvt_pk_bf16_f32 v75, v106, v107
    s_nop 1
    v_mfma_f32_16x16x32_bf16 a[0:3], a[144:147], v[72:75], 0
    v_add_f32 v63, v63, v112
    v_fmac_f32 v64, v104, v108
    v_mfma_f32_16x16x32_bf16 a[4:7], a[148:151], v[72:75], 0
    v_add_f32 v63, v63, v113
    v_fmac_f32 v64, v105, v109
    v_mfma_f32_16x16x32_bf16 a[8:11], a[152:155], v[72:75], 0
    v_add_f32 v63, v63, v114
    v_fmac_f32 v64, v106, v110
    v_mfma_f32_16x16x32_bf16 a[12:15], a[156:159], v[72:75], 0
    v_add_f32 v63, v63, v115
    v_fmac_f32 v64, v107, v111
    v_mfma_f32_16x16x32_bf16 a[16:19], a[160:163], v[72:75], 0
    v_add_f32 v68, v68, v104
    v_add_f32 v69, v69, v105
    v_mfma_f32_16x16x32_bf16 a[20:23], a[164:167], v[72:75], 0
    v_add_f32 v70, v70, v106
    v_add_f32 v71, v71, v107
    v_mfma_f32_16x16x32_bf16 a[24:27], a[168:171], v[72:75], 0
    v_mfma_f32_16x16x32_bf16 a[28:31], a[172:175], v[72:75], 0
    v_mfma_f32_16x16x32_bf16 a[32:35], a[176:179], v[72:75], 0
    v_mfma_f32_16x16x32_bf16 a[36:39], a[180:183], v[72:75], 0
    v_mfma_f32_16x16x32_bf16 a[40:43], a[184:187], v[72:75], 0
    v_mfma_f32_16x16x32_bf16 a[44:47], a[188:191], v[72:75], 0
    ds_read_b128 a[96:99], v40 offset:49152
    ds_read_b128 a[100:103], v41 offset:49152
    ds_read_b128 a[104:107], v42 offset:49152
    ds_read_b128 a[108:111], v43 offset:49152
    ds_read_b128 a[112:115], v40 offset:49408
    ds_read_b128 a[116:119], v41 offset:49408
    ds_read_b128 a[120:123], v42 offset:49408
    ds_read_b128 a[124:127], v43 offset:49408
    ds_read_b128 a[128:131], v40 offset:49664
    ds_read_b128 a[132:135], v41 offset:49664
    ds_read_b128 a[136:139], v42 offset:49664
    ds_read_b128 a[140:143], v43 offset:49664
    s_waitcnt lgkmcnt(11)
    v_mfma_f32_16x16x32_bf16 v[96:99], a[96:99], a[96:99], v[84:87]
    ds_read_b64_tr_b16 a[144:145], v44 offset:49152
    ds_read_b64_tr_b16 a[146:147], v48 offset:49408
    v_mfma_f32_16x16x32_bf16 v[100:103], a[96:99], a[48:51], 0
    ds_read_b64_tr_b16 a[148:149], v45 offset:49152
    ds_read_b64_tr_b16 a[150:151], v49 offset:49408
    s_waitcnt lgkmcnt(14)
    v_mfma_f32_16x16x32_bf16 v[96:99], a[100:103], a[100:103], v[96:99]
    ds_read_b64_tr_b16 a[152:153], v46 offset:49152
    ds_read_b64_tr_b16 a[154:155], v50 offset:49408
    v_mfma_f32_16x16x32_bf16 v[100:103], a[100:103], a[52:55], v[100:103]
    ds_read_b64_tr_b16 a[156:157], v47 offset:49152
    ds_read_b64_tr_b16 a[158:159], v51 offset:49408
    s_waitcnt lgkmcnt(15)
    v_mfma_f32_16x16x32_bf16 v[96:99], a[104:107], a[104:107], v[96:99]
    ds_read_b64_tr_b16 a[160:161], v48 offset:49152
    ds_read_b64_tr_b16 a[162:163], v44 offset:49664
    v_mfma_f32_16x16x32_bf16 v[100:103], a[104:107], a[56:59], v[100:103]
    ds_read_b64_tr_b16 a[164:165], v49 offset:49152
    ds_read_b64_tr_b16 a[166:167], v45 offset:49664
    v_mfma_f32_16x16x32_bf16 v[96:99], a[108:111], a[108:111], v[96:99]
    ds_read_b64_tr_b16 a[168:169], v50 offset:49152
    ds_read_b64_tr_b16 a[170:171], v46 offset:49664
    v_mfma_f32_16x16x32_bf16 v[100:103], a[108:111], a[60:63], v[100:103]
    ds_read_b64_tr_b16 a[172:173], v51 offset:49152
    ds_read_b64_tr_b16 a[174:175], v47 offset:49664
    v_mfma_f32_16x16x32_bf16 v[96:99], a[112:115], a[112:115], v[96:99]
    ds_read_b64_tr_b16 a[176:177], v44 offset:49408
    ds_read_b64_tr_b16 a[178:179], v48 offset:49664
    v_mfma_f32_16x16x32_bf16 v[100:103], a[112:115], a[64:67], v[100:103]
    ds_read_b64_tr_b16 a[180:181], v45 offset:49408
    ds_read_b64_tr_b16 a[182:183], v49 offset:49664
    s_waitcnt lgkmcnt(15)
    v_mfma_f32_16x16x32_bf16 v[96:99], a[116:119], a[116:119], v[96:99]
    ds_read_b64_tr_b16 a[184:185], v46 offset:49408
    ds_read_b64_tr_b16 a[186:187], v50 offset:49664
    v_mfma_f32_16x16x32_bf16 v[100:103], a[116:119], a[68:71], v[100:103]
    ds_read_b64_tr_b16 a[188:189], v47 offset:49408
    ds_read_b64_tr_b16 a[190:191], v51 offset:49664
    v_mfma_f32_16x16x32_bf16 v[92:95], a[96:99], v[52:55], v[80:83]
    v_mfma_f32_16x16x32_bf16 v[92:95], a[100:103], v[52:55], v[92:95]
    v_mfma_f32_16x16x32_bf16 v[92:95], a[104:107], v[52:55], v[92:95]
    v_mfma_f32_16x16x32_bf16 v[92:95], a[108:111], v[52:55], v[92:95]
    s_nop 1
    v_fma_f32 v96, v100, 2.0, v96
    v_fma_f32 v97, v101, 2.0, v97
    v_mfma_f32_16x16x32_bf16 v[92:95], a[112:115], v[52:55], v[92:95]
    v_fma_f32 v98, v102, 2.0, v98
    v_fma_f32 v99, v103, 2.0, v99
    v_mfma_f32_16x16x32_bf16 v[92:95], a[116:119], v[52:55], v[92:95]
    v_cndmask_b32 v3, 0, v96, s[44:45]
    v_cndmask_b32 v3, v3, v97, s[46:47]
    v_mfma_f32_16x16x32_bf16 v[88:91], a[96:99], v[136:139], v[76:79]
    v_cndmask_b32 v3, v3, v98, s[48:49]
    v_cndmask_b32 v3, v3, v99, s[50:51]
    v_mfma_f32_16x16x32_bf16 v[88:91], a[100:103], v[140:143], v[88:91]
    s_nop 0
    s_nop 0
    v_mfma_f32_16x16x32_bf16 v[88:91], a[104:107], v[144:147], v[88:91]
    v_mfma_f32_16x16x4_f32 v[120:123], v3, v60, v[56:59]
    v_mfma_f32_16x16x32_bf16 v[88:91], a[108:111], v[148:151], v[88:91]
    v_mfma_f32_16x16x32_bf16 v[88:91], a[112:115], v[152:155], v[88:91]
    v_mfma_f32_16x16x32_bf16 v[88:91], a[116:119], v[156:159], v[88:91]
    s_waitcnt lgkmcnt(0)
    s_barrier
    s_add_u32 m0, s42, 0
    s_add_u32 s59, s37, 245760
    buffer_load_dwordx4 v22, s[24:27], s59 offen offset:0 nt lds
    buffer_load_dwordx4 v23, s[24:27], s59 offen offset:1024 nt lds
    buffer_load_dwordx4 v24, s[24:27], s59 offen offset:2048 nt lds
    buffer_load_dwordx4 v25, s[24:27], s59 offen offset:3072 nt lds
    s_add_u32 m0, s42, 4096
    s_nop 0
    buffer_load_dwordx4 v26, s[24:27], s59 offen offset:0 nt lds
    buffer_load_dwordx4 v27, s[24:27], s59 offen offset:1024 nt lds
    buffer_load_dwordx4 v28, s[24:27], s59 offen offset:2048 nt lds
    buffer_load_dwordx4 v29, s[24:27], s59 offen offset:3072 nt lds
    s_add_u32 m0, s42, 8192
    s_nop 0
    buffer_load_dwordx4 v30, s[24:27], s59 offen offset:0 nt lds
    buffer_load_dwordx4 v31, s[24:27], s59 offen offset:1024 nt lds
    buffer_load_dwordx4 v32, s[24:27], s59 offen offset:2048 nt lds
    buffer_load_dwordx4 v33, s[24:27], s59 offen offset:3072 nt lds
    v_mfma_f32_16x16x32_bf16 v[112:115], a[120:123], a[120:123], v[84:87]
    v_mfma_f32_16x16x32_bf16 v[116:119], a[120:123], a[48:51], 0
    v_mfma_f32_16x16x32_bf16 v[112:115], a[124:127], a[124:127], v[112:115]
    v_mfma_f32_16x16x32_bf16 v[116:119], a[124:127], a[52:55], v[116:119]
    v_fma_f32 v128, -v92, v92, v120
    v_fma_f32 v129, -v93, v93, v121
    v_mfma_f32_16x16x32_bf16 v[112:115], a[128:131], a[128:131], v[112:115]
    v_fma_f32 v130, -v94, v94, v122
    v_fma_f32 v131, -v95, v95, v123
    v_mfma_f32_16x16x32_bf16 v[116:119], a[128:131], a[56:59], v[116:119]
    v_max_f32 v128, v128, v56
    v_max_f32 v129, v129, v56
    v_mfma_f32_16x16x32_bf16 v[112:115], a[132:135], a[132:135], v[112:115]
    v_max_f32 v130, v130, v56
    v_max_f32 v131, v131, v56
    v_mfma_f32_16x16x32_bf16 v[116:119], a[132:135], a[60:63], v[116:119]
    v_rsq_f32 v128, v128
    v_mfma_f32_16x16x32_bf16 v[112:115], a[136:139], a[136:139], v[112:115]
    v_rsq_f32 v129, v129
    v_mfma_f32_16x16x32_bf16 v[116:119], a[136:139], a[64:67], v[116:119]
    v_rsq_f32 v130, v130
    v_mfma_f32_16x16x32_bf16 v[112:115], a[140:143], a[140:143], v[112:115]
    v_rsq_f32 v131, v131
    v_mfma_f32_16x16x32_bf16 v[116:119], a[140:143], a[68:71], v[116:119]
    v_fma_f32 v88, -v92, v61, v88
    v_fma_f32 v89, -v93, v61, v89
    v_mfma_f32_16x16x32_bf16 v[108:111], a[120:123], v[52:55], v[80:83]
    v_fma_f32 v90, -v94, v61, v90
    v_fma_f32 v91, -v95, v61, v91
    v_mfma_f32_16x16x32_bf16 v[108:111], a[124:127], v[52:55], v[108:111]
    v_fma_f32 v88, v88, v128, v62
    v_fma_f32 v89, v89, v129, v62
    v_mfma_f32_16x16x32_bf16 v[108:111], a[128:131], v[52:55], v[108:111]
    v_fma_f32 v90, v90, v130, v62
    v_fma_f32 v91, v91, v131, v62
    v_mfma_f32_16x16x32_bf16 v[108:111], a[132:135], v[52:55], v[108:111]
    v_max3_f32 v1, v88, v89, v90
    v_max_f32 v1, v1, v91
    v_mfma_f32_16x16x32_bf16 v[108:111], a[136:139], v[52:55], v[108:111]
    v_cmp_lt_f32 vcc, s52, v1
    s_cbranch_vccnz L_site1
L_back1:
    v_mfma_f32_16x16x32_bf16 v[108:111], a[140:143], v[52:55], v[108:111]
    v_exp_f32 v96, v88
    v_mfma_f32_16x16x32_bf16 v[104:107], a[120:123], v[136:139], v[76:79]
    v_exp_f32 v97, v89
    v_mfma_f32_16x16x32_bf16 v[104:107], a[124:127], v[140:143], v[104:107]
    v_exp_f32 v98, v90
    v_mfma_f32_16x16x32_bf16 v[104:107], a[128:131], v[144:147], v[104:107]
    v_exp_f32 v99, v91
    v_mfma_f32_16x16x32_bf16 v[104:107], a[132:135], v[148:151], v[104:107]
    v_mul_f32 v88, v96, v128
    v_mul_f32 v89, v97, v129
    v_mfma_f32_16x16x32_bf16 v[104:107], a[136:139], v[152:155], v[104:107]
    v_mul_f32 v90, v98, v130
    v_mul_f32 v91, v99, v131
    v_mfma_f32_16x16x32_bf16 v[104:107], a[140:143], v[156:159], v[104:107]
    v_fma_f32 v112, v116, 2.0, v112
    v_fma_f32 v113, v117, 2.0, v113
    v_fma_f32 v114, v118, 2.0, v114
    v_fma_f32 v115, v119, 2.0, v115
    v_cndmask_b32 v4, 0, v112, s[44:45]
    v_cndmask_b32 v4, v4, v113, s[46:47]
    v_cndmask_b32 v4, v4, v114, s[48:49]
    v_cndmask_b32 v4, v4, v115, s[50:51]
    v_add_f32 v63, v63, v96
    v_fmac_f32 v64, v88, v92
    v_mfma_f32_16x16x4_f32 v[124:127], v4, v60, v[56:59]
    v_add_f32 v63, v63, v97
    v_fmac_f32 v64, v89, v93
    v_add_f32 v63, v63, v98
    v_fmac_f32 v64, v90, v94
    v_add_f32 v63, v63, v99
    v_fmac_f32 v64, v91, v95
    v_add_f32 v68, v68, v88
    v_add_f32 v69, v69, v89
    v_add_f32 v70, v70, v90
    v_add_f32 v71, v71, v91
    v_fma_f32 v132, -v108, v108, v124
    v_fma_f32 v133, -v109, v109, v125
    v_fma_f32 v134, -v110, v110, v126
    v_fma_f32 v135, -v111, v111, v127
    v_max_f32 v132, v132, v56
    v_max_f32 v133, v133, v56
    v_max_f32 v134, v134, v56
    v_max_f32 v135, v135, v56
    v_rsq_f32 v132, v132
    v_rsq_f32 v133, v133
    v_rsq_f32 v134, v134
    v_rsq_f32 v135, v135
    v_fma_f32 v104, -v108, v61, v104
    v_fma_f32 v105, -v109, v61, v105
    v_fma_f32 v106, -v110, v61, v106
    v_fma_f32 v107, -v111, v61, v107
    v_fma_f32 v104, v104, v132, v62
    v_fma_f32 v105, v105, v133, v62
    v_fma_f32 v106, v106, v134, v62
    v_fma_f32 v107, v107, v135, v62
    v_max3_f32 v1, v104, v105, v106
    v_max_f32 v1, v1, v107
    v_cmp_lt_f32 vcc, s52, v1
    s_cbranch_vccnz L_site2
L_back2:
    v_exp_f32 v112, v104
    v_exp_f32 v113, v105
    v_exp_f32 v114, v106
    v_exp_f32 v115, v107
    v_mul_f32 v104, v112, v132
    v_mul_f32 v105, v113, v133
    v_mul_f32 v106, v114, v134
    v_mul_f32 v107, v115, v135
    v_cvt_pk_bf16_f32 v72, v88, v89
    v_cvt_pk_bf16_f32 v73, v90, v91
    v_cvt_pk_bf16_f32 v74, v104, v105
    v_cvt_pk_bf16_f32 v75, v106, v107
    s_nop 1
    v_mfma_f32_16x16x32_bf16 a[0:3], a[144:147], v[72:75], a[0:3]
    v_add_f32 v68, v68, v104
    v_add_f32 v69, v69, v105
    v_mfma_f32_16x16x32_bf16 a[4:7], a[148:151], v[72:75], a[4:7]
    v_add_f32 v70, v70, v106
    v_add_f32 v71, v71, v107
    v_mfma_f32_16x16x32_bf16 a[8:11], a[152:155], v[72:75], a[8:11]
    v_cvt_pk_bf16_f32 v66, v68, v69
    v_cvt_pk_bf16_f32 v67, v70, v71
    v_mfma_f32_16x16x32_bf16 a[12:15], a[156:159], v[72:75], a[12:15]
    v_add_f32 v63, v63, v112
    v_fmac_f32 v64, v104, v108
    v_mfma_f32_16x16x32_bf16 a[16:19], a[160:163], v[72:75], a[16:19]
    v_add_f32 v63, v63, v113
    v_fmac_f32 v64, v105, v109
    v_mfma_f32_16x16x32_bf16 a[20:23], a[164:167], v[72:75], a[20:23]
    v_add_f32 v63, v63, v114
    v_fmac_f32 v64, v106, v110
    v_mfma_f32_16x16x32_bf16 a[24:27], a[168:171], v[72:75], a[24:27]
    v_add_f32 v63, v63, v115
    v_fmac_f32 v64, v107, v111
    v_mfma_f32_16x16x32_bf16 a[28:31], a[172:175], v[72:75], a[28:31]
    v_mfma_f32_16x16x32_bf16 a[32:35], a[176:179], v[72:75], a[32:35]
    v_mfma_f32_16x16x32_bf16 a[36:39], a[180:183], v[72:75], a[36:39]
    v_mfma_f32_16x16x32_bf16 a[40:43], a[184:187], v[72:75], a[40:43]
    v_mfma_f32_16x16x32_bf16 a[44:47], a[188:191], v[72:75], a[44:47]
    v_mfma_f32_16x16x16_bf16 a[0:3], a[72:73], v[66:67], a[0:3]
    v_mfma_f32_16x16x16_bf16 a[4:7], a[74:75], v[66:67], a[4:7]
    v_mfma_f32_16x16x16_bf16 a[8:11], a[76:77], v[66:67], a[8:11]
    v_mfma_f32_16x16x16_bf16 a[12:15], a[78:79], v[66:67], a[12:15]
    v_mfma_f32_16x16x16_bf16 a[16:19], a[80:81], v[66:67], a[16:19]
    v_mfma_f32_16x16x16_bf16 a[20:23], a[82:83], v[66:67], a[20:23]
    v_mfma_f32_16x16x16_bf16 a[24:27], a[84:85], v[66:67], a[24:27]
    v_mfma_f32_16x16x16_bf16 a[28:31], a[86:87], v[66:67], a[28:31]
    v_mfma_f32_16x16x16_bf16 a[32:35], a[88:89], v[66:67], a[32:35]
    v_mfma_f32_16x16x16_bf16 a[36:39], a[90:91], v[66:67], a[36:39]
    v_mfma_f32_16x16x16_bf16 a[40:43], a[92:93], v[66:67], a[40:43]
    v_mfma_f32_16x16x16_bf16 a[44:47], a[94:95], v[66:67], a[44:47]
    ds_read_b128 a[48:51], v34 offset:0
    ds_read_b128 a[52:55], v35 offset:0
    ds_read_b128 a[56:59], v34 offset:128
    ds_read_b128 a[60:63], v35 offset:128
    ds_read_b128 a[64:67], v34 offset:256
    ds_read_b128 a[68:71], v35 offset:256
    s_waitcnt lgkmcnt(5)
    v_mfma_f32_16x16x32_bf16 v[84:87], a[48:51], a[48:51], 0
    ds_read_b64_tr_b16 a[72:73], v36 offset:0
    ds_read_b64_tr_b16 a[74:75], v37 offset:0
    v_mfma_f32_16x16x32_bf16 v[80:83], a[48:51], v[52:55], 0
    ds_read_b64_tr_b16 a[76:77], v38 offset:0
    ds_read_b64_tr_b16 a[78:79], v39 offset:0
    s_waitcnt lgkmcnt(8)
    v_mfma_f32_16x16x32_bf16 v[84:87], a[52:55], a[52:55], v[84:87]
    ds_read_b64_tr_b16 a[80:81], v36 offset:128
    ds_read_b64_tr_b16 a[82:83], v37 offset:128
    v_mfma_f32_16x16x32_bf16 v[80:83], a[52:55], v[52:55], v[80:83]
    ds_read_b64_tr_b16 a[84:85], v38 offset:128
    ds_read_b64_tr_b16 a[86:87], v39 offset:128
    s_waitcnt lgkmcnt(11)
    v_mfma_f32_16x16x32_bf16 v[84:87], a[56:59], a[56:59], v[84:87]
    ds_read_b64_tr_b16 a[88:89], v36 offset:256
    ds_read_b64_tr_b16 a[90:91], v37 offset:256
    v_mfma_f32_16x16x32_bf16 v[80:83], a[56:59], v[52:55], v[80:83]
    ds_read_b64_tr_b16 a[92:93], v38 offset:256
    ds_read_b64_tr_b16 a[94:95], v39 offset:256
    s_waitcnt lgkmcnt(14)
    v_mfma_f32_16x16x32_bf16 v[84:87], a[60:63], a[60:63], v[84:87]
    v_mfma_f32_16x16x32_bf16 v[80:83], a[60:63], v[52:55], v[80:83]
    s_waitcnt lgkmcnt(13)
    v_mfma_f32_16x16x32_bf16 v[84:87], a[64:67], a[64:67], v[84:87]
    v_mfma_f32_16x16x32_bf16 v[80:83], a[64:67], v[52:55], v[80:83]
    s_waitcnt lgkmcnt(12)
    v_mfma_f32_16x16x32_bf16 v[84:87], a[68:71], a[68:71], v[84:87]
    v_mfma_f32_16x16x32_bf16 v[80:83], a[68:71], v[52:55], v[80:83]
    s_waitcnt lgkmcnt(0)
    s_barrier
    buffer_load_dword v244, v245, s[32:35], 0 offen offset:128 sc1
    s_add_u32 m0, s40, 0
    s_add_u32 s57, s36, 49152
    buffer_load_dwordx4 v16, s[28:31], s57 offen offset:0 nt lds
    buffer_load_dwordx4 v17, s[28:31], s57 offen offset:1024 nt lds
    buffer_load_dwordx4 v18, s[28:31], s57 offen offset:2048 nt lds
    buffer_load_dwordx4 v19, s[28:31], s57 offen offset:3072 nt lds
    s_add_u32 m0, s40, 4096
    s_nop 0
    buffer_load_dwordx4 v20, s[28:31], s57 offen offset:0 nt lds
    buffer_load_dwordx4 v21, s[28:31], s57 offen offset:1024 nt lds
    v_mfma_f32_16x16x32_bf16 v[76:79], a[48:51], v[136:139], 0
    v_mfma_f32_16x16x32_bf16 v[76:79], a[52:55], v[140:143], v[76:79]
    v_mfma_f32_16x16x32_bf16 v[76:79], a[56:59], v[144:147], v[76:79]
    v_mfma_f32_16x16x32_bf16 v[76:79], a[60:63], v[148:151], v[76:79]
    v_mfma_f32_16x16x32_bf16 v[76:79], a[64:67], v[152:155], v[76:79]
    v_mfma_f32_16x16x32_bf16 v[76:79], a[68:71], v[156:159], v[76:79]
    s_waitcnt vmcnt(19)
    ds_read_b128 a[96:99], v40 offset:0
    ds_read_b128 a[100:103], v41 offset:0
    ds_read_b128 a[104:107], v42 offset:0
    ds_read_b128 a[108:111], v43 offset:0
    ds_read_b128 a[112:115], v40 offset:256
    ds_read_b128 a[116:119], v41 offset:256
    ds_read_b128 a[120:123], v42 offset:256
    ds_read_b128 a[124:127], v43 offset:256
    ds_read_b128 a[128:131], v40 offset:512
    ds_read_b128 a[132:135], v41 offset:512
    ds_read_b128 a[136:139], v42 offset:512
    ds_read_b128 a[140:143], v43 offset:512
    s_waitcnt lgkmcnt(11)
    v_mfma_f32_16x16x32_bf16 v[96:99], a[96:99], a[96:99], v[84:87]
    ds_read_b64_tr_b16 a[144:145], v44 offset:0
    ds_read_b64_tr_b16 a[146:147], v48 offset:256
    v_mfma_f32_16x16x32_bf16 v[100:103], a[96:99], a[48:51], 0
    ds_read_b64_tr_b16 a[148:149], v45 offset:0
    ds_read_b64_tr_b16 a[150:151], v49 offset:256
    s_waitcnt lgkmcnt(14)
    v_mfma_f32_16x16x32_bf16 v[96:99], a[100:103], a[100:103], v[96:99]
    ds_read_b64_tr_b16 a[152:153], v46 offset:0
    ds_read_b64_tr_b16 a[154:155], v50 offset:256
    v_mfma_f32_16x16x32_bf16 v[100:103], a[100:103], a[52:55], v[100:103]
    ds_read_b64_tr_b16 a[156:157], v47 offset:0
    ds_read_b64_tr_b16 a[158:159], v51 offset:256
    s_waitcnt lgkmcnt(15)
    v_mfma_f32_16x16x32_bf16 v[96:99], a[104:107], a[104:107], v[96:99]
    ds_read_b64_tr_b16 a[160:161], v48 offset:0
    ds_read_b64_tr_b16 a[162:163], v44 offset:512
    v_mfma_f32_16x16x32_bf16 v[100:103], a[104:107], a[56:59], v[100:103]
    ds_read_b64_tr_b16 a[164:165], v49 offset:0
    ds_read_b64_tr_b16 a[166:167], v45 offset:512
    v_mfma_f32_16x16x32_bf16 v[96:99], a[108:111], a[108:111], v[96:99]
    ds_read_b64_tr_b16 a[168:169], v50 offset:0
    ds_read_b64_tr_b16 a[170:171], v46 offset:512
    v_mfma_f32_16x16x32_bf16 v[100:103], a[108:111], a[60:63], v[100:103]
    ds_read_b64_tr_b16 a[172:173], v51 offset:0
    ds_read_b64_tr_b16 a[174:175], v47 offset:512
    v_mfma_f32_16x16x32_bf16 v[96:99], a[112:115], a[112:115], v[96:99]
    ds_read_b64_tr_b16 a[176:177], v44 offset:256
    ds_read_b64_tr_b16 a[178:179], v48 offset:512
    v_mfma_f32_16x16x32_bf16 v[100:103], a[112:115], a[64:67], v[100:103]
    ds_read_b64_tr_b16 a[180:181], v45 offset:256
    ds_read_b64_tr_b16 a[182:183], v49 offset:512
    s_waitcnt lgkmcnt(15)
    v_mfma_f32_16x16x32_bf16 v[96:99], a[116:119], a[116:119], v[96:99]
    ds_read_b64_tr_b16 a[184:185], v46 offset:256
    ds_read_b64_tr_b16 a[186:187], v50 offset:512
    v_mfma_f32_16x16x32_bf16 v[100:103], a[116:119], a[68:71], v[100:103]
    ds_read_b64_tr_b16 a[188:189], v47 offset:256
    ds_read_b64_tr_b16 a[190:191], v51 offset:512
    v_mfma_f32_16x16x32_bf16 v[92:95], a[96:99], v[52:55], v[80:83]
    v_mfma_f32_16x16x32_bf16 v[92:95], a[100:103], v[52:55], v[92:95]
    v_mfma_f32_16x16x32_bf16 v[92:95], a[104:107], v[52:55], v[92:95]
    v_mfma_f32_16x16x32_bf16 v[92:95], a[108:111], v[52:55], v[92:95]
    s_nop 1
    v_fma_f32 v96, v100, 2.0, v96
    v_fma_f32 v97, v101, 2.0, v97
    v_mfma_f32_16x16x32_bf16 v[92:95], a[112:115], v[52:55], v[92:95]
    v_fma_f32 v98, v102, 2.0, v98
    v_fma_f32 v99, v103, 2.0, v99
    v_mfma_f32_16x16x32_bf16 v[92:95], a[116:119], v[52:55], v[92:95]
    v_cndmask_b32 v3, 0, v96, s[44:45]
    v_cndmask_b32 v3, v3, v97, s[46:47]
    v_mfma_f32_16x16x32_bf16 v[88:91], a[96:99], v[136:139], v[76:79]
    v_cndmask_b32 v3, v3, v98, s[48:49]
    v_cndmask_b32 v3, v3, v99, s[50:51]
    v_mfma_f32_16x16x32_bf16 v[88:91], a[100:103], v[140:143], v[88:91]
    s_nop 0
    s_nop 0
    v_mfma_f32_16x16x32_bf16 v[88:91], a[104:107], v[144:147], v[88:91]
    v_mfma_f32_16x16x4_f32 v[120:123], v3, v60, v[56:59]
    v_mfma_f32_16x16x32_bf16 v[88:91], a[108:111], v[148:151], v[88:91]
    v_mfma_f32_16x16x32_bf16 v[88:91], a[112:115], v[152:155], v[88:91]
    v_mfma_f32_16x16x32_bf16 v[88:91], a[116:119], v[156:159], v[88:91]
    s_waitcnt lgkmcnt(0)
    s_barrier
    s_add_u32 m0, s41, 0
    s_add_u32 s58, s37, 98304
    buffer_load_dwordx4 v22, s[24:27], s58 offen offset:0 nt lds
    buffer_load_dwordx4 v23, s[24:27], s58 offen offset:1024 nt lds
    buffer_load_dwordx4 v24, s[24:27], s58 offen offset:2048 nt lds
    buffer_load_dwordx4 v25, s[24:27], s58 offen offset:3072 nt lds
    s_add_u32 m0, s41, 4096
    s_nop 0
    buffer_load_dwordx4 v26, s[24:27], s58 offen offset:0 nt lds
    buffer_load_dwordx4 v27, s[24:27], s58 offen offset:1024 nt lds
    buffer_load_dwordx4 v28, s[24:27], s58 offen offset:2048 nt lds
    buffer_load_dwordx4 v29, s[24:27], s58 offen offset:3072 nt lds
    s_add_u32 m0, s41, 8192
    s_nop 0
    buffer_load_dwordx4 v30, s[24:27], s58 offen offset:0 nt lds
    buffer_load_dwordx4 v31, s[24:27], s58 offen offset:1024 nt lds
    buffer_load_dwordx4 v32, s[24:27], s58 offen offset:2048 nt lds
    buffer_load_dwordx4 v33, s[24:27], s58 offen offset:3072 nt lds
    v_mfma_f32_16x16x32_bf16 v[112:115], a[120:123], a[120:123], v[84:87]
    v_mfma_f32_16x16x32_bf16 v[116:119], a[120:123], a[48:51], 0
    v_mfma_f32_16x16x32_bf16 v[112:115], a[124:127], a[124:127], v[112:115]
    v_mfma_f32_16x16x32_bf16 v[116:119], a[124:127], a[52:55], v[116:119]
    v_fma_f32 v128, -v92, v92, v120
    v_fma_f32 v129, -v93, v93, v121
    v_mfma_f32_16x16x32_bf16 v[112:115], a[128:131], a[128:131], v[112:115]
    v_fma_f32 v130, -v94, v94, v122
    v_fma_f32 v131, -v95, v95, v123
    v_mfma_f32_16x16x32_bf16 v[116:119], a[128:131], a[56:59], v[116:119]
    v_max_f32 v128, v128, v56
    v_max_f32 v129, v129, v56
    v_mfma_f32_16x16x32_bf16 v[112:115], a[132:135], a[132:135], v[112:115]
    v_max_f32 v130, v130, v56
    v_max_f32 v131, v131, v56
    v_mfma_f32_16x16x32_bf16 v[116:119], a[132:135], a[60:63], v[116:119]
    v_rsq_f32 v128, v128
    v_mfma_f32_16x16x32_bf16 v[112:115], a[136:139], a[136:139], v[112:115]
    v_rsq_f32 v129, v129
    v_mfma_f32_16x16x32_bf16 v[116:119], a[136:139], a[64:67], v[116:119]
    v_rsq_f32 v130, v130
    v_mfma_f32_16x16x32_bf16 v[112:115], a[140:143], a[140:143], v[112:115]
    v_rsq_f32 v131, v131
    v_mfma_f32_16x16x32_bf16 v[116:119], a[140:143], a[68:71], v[116:119]
    v_fma_f32 v88, -v92, v61, v88
    v_fma_f32 v89, -v93, v61, v89
    v_mfma_f32_16x16x32_bf16 v[108:111], a[120:123], v[52:55], v[80:83]
    v_fma_f32 v90, -v94, v61, v90
    v_fma_f32 v91, -v95, v61, v91
    v_mfma_f32_16x16x32_bf16 v[108:111], a[124:127], v[52:55], v[108:111]
    v_fma_f32 v88, v88, v128, v62
    v_fma_f32 v89, v89, v129, v62
    v_mfma_f32_16x16x32_bf16 v[108:111], a[128:131], v[52:55], v[108:111]
    v_fma_f32 v90, v90, v130, v62
    v_fma_f32 v91, v91, v131, v62
    v_mfma_f32_16x16x32_bf16 v[108:111], a[132:135], v[52:55], v[108:111]
    v_max3_f32 v1, v88, v89, v90
    v_max_f32 v1, v1, v91
    v_mfma_f32_16x16x32_bf16 v[108:111], a[136:139], v[52:55], v[108:111]
    v_cmp_lt_f32 vcc, s52, v1
    s_cbranch_vccnz L_site3
L_back3:
    v_mfma_f32_16x16x32_bf16 v[108:111], a[140:143], v[52:55], v[108:111]
    v_exp_f32 v96, v88
    v_mfma_f32_16x16x32_bf16 v[104:107], a[120:123], v[136:139], v[76:79]
    v_exp_f32 v97, v89
    v_mfma_f32_16x16x32_bf16 v[104:107], a[124:127], v[140:143], v[104:107]
    v_exp_f32 v98, v90
    v_mfma_f32_16x16x32_bf16 v[104:107], a[128:131], v[144:147], v[104:107]
    v_exp_f32 v99, v91
    v_mfma_f32_16x16x32_bf16 v[104:107], a[132:135], v[148:151], v[104:107]
    v_mul_f32 v88, v96, v128
    v_mul_f32 v89, v97, v129
    v_mfma_f32_16x16x32_bf16 v[104:107], a[136:139], v[152:155], v[104:107]
    v_mul_f32 v90, v98, v130
    v_mul_f32 v91, v99, v131
    v_mfma_f32_16x16x32_bf16 v[104:107], a[140:143], v[156:159], v[104:107]
    v_fma_f32 v112, v116, 2.0, v112
    v_fma_f32 v113, v117, 2.0, v113
    v_fma_f32 v114, v118, 2.0, v114
    v_fma_f32 v115, v119, 2.0, v115
    v_cndmask_b32 v4, 0, v112, s[44:45]
    v_cndmask_b32 v4, v4, v113, s[46:47]
    v_cndmask_b32 v4, v4, v114, s[48:49]
    v_cndmask_b32 v4, v4, v115, s[50:51]
    v_add_f32 v63, v63, v96
    v_fmac_f32 v64, v88, v92
    v_mfma_f32_16x16x4_f32 v[124:127], v4, v60, v[56:59]
    v_add_f32 v63, v63, v97
    v_fmac_f32 v64, v89, v93
    v_add_f32 v63, v63, v98
    v_fmac_f32 v64, v90, v94
    v_add_f32 v63, v63, v99
    v_fmac_f32 v64, v91, v95
    v_mov_b32 v68, v88
    v_mov_b32 v69, v89
    v_mov_b32 v70, v90
    v_mov_b32 v71, v91
    v_fma_f32 v132, -v108, v108, v124
    v_fma_f32 v133, -v109, v109, v125
    v_fma_f32 v134, -v110, v110, v126
    v_fma_f32 v135, -v111, v111, v127
    v_max_f32 v132, v132, v56
    v_max_f32 v133, v133, v56
    v_max_f32 v134, v134, v56
    v_max_f32 v135, v135, v56
    v_rsq_f32 v132, v132
    v_rsq_f32 v133, v133
    v_rsq_f32 v134, v134
    v_rsq_f32 v135, v135
    v_fma_f32 v104, -v108, v61, v104
    v_fma_f32 v105, -v109, v61, v105
    v_fma_f32 v106, -v110, v61, v106
    v_fma_f32 v107, -v111, v61, v107
    v_fma_f32 v104, v104, v132, v62
    v_fma_f32 v105, v105, v133, v62
    v_fma_f32 v106, v106, v134, v62
    v_fma_f32 v107, v107, v135, v62
    v_max3_f32 v1, v104, v105, v106
    v_max_f32 v1, v1, v107
    v_cmp_lt_f32 vcc, s52, v1
    s_cbranch_vccnz L_site4
L_back4:
    v_exp_f32 v112, v104
    v_exp_f32 v113, v105
    v_exp_f32 v114, v106
    v_exp_f32 v115, v107
    v_mul_f32 v104, v112, v132
    v_mul_f32 v105, v113, v133
    v_mul_f32 v106, v114, v134
    v_mul_f32 v107, v115, v135
    v_cvt_pk_bf16_f32 v72, v88, v89
    v_cvt_pk_bf16_f32 v73, v90, v91
    v_cvt_pk_bf16_f32 v74, v104, v105
    v_cvt_pk_bf16_f32 v75, v106, v107
    s_nop 1
    v_mfma_f32_16x16x32_bf16 a[0:3], a[144:147], v[72:75], a[0:3]
    v_add_f32 v63, v63, v112
    v_fmac_f32 v64, v104, v108
    v_mfma_f32_16x16x32_bf16 a[4:7], a[148:151], v[72:75], a[4:7]
    v_add_f32 v63, v63, v113
    v_fmac_f32 v64, v105, v109
    v_mfma_f32_16x16x32_bf16 a[8:11], a[152:155], v[72:75], a[8:11]
    v_add_f32 v63, v63, v114
    v_fmac_f32 v64, v106, v110
    v_mfma_f32_16x16x32_bf16 a[12:15], a[156:159], v[72:75], a[12:15]
    v_add_f32 v63, v63, v115
    v_fmac_f32 v64, v107, v111
    v_mfma_f32_16x16x32_bf16 a[16:19], a[160:163], v[72:75], a[16:19]
    v_add_f32 v68, v68, v104
    v_add_f32 v69, v69, v105
    v_mfma_f32_16x16x32_bf16 a[20:23], a[164:167], v[72:75], a[20:23]
    v_add_f32 v70, v70, v106
    v_add_f32 v71, v71, v107
    v_mfma_f32_16x16x32_bf16 a[24:27], a[168:171], v[72:75], a[24:27]
    v_mfma_f32_16x16x32_bf16 a[28:31], a[172:175], v[72:75], a[28:31]
    v_mfma_f32_16x16x32_bf16 a[32:35], a[176:179], v[72:75], a[32:35]
    v_mfma_f32_16x16x32_bf16 a[36:39], a[180:183], v[72:75], a[36:39]
    v_mfma_f32_16x16x32_bf16 a[40:43], a[184:187], v[72:75], a[40:43]
    v_mfma_f32_16x16x32_bf16 a[44:47], a[188:191], v[72:75], a[44:47]
    s_waitcnt vmcnt(18)
    v_cmp_ne_u32 vcc, s39, v244
    s_cbranch_vccnz L_fl_retry
L_fl_ok:
    ds_read_b128 a[96:99], v40 offset:49152
    ds_read_b128 a[100:103], v41 offset:49152
    ds_read_b128 a[104:107], v42 offset:49152
    ds_read_b128 a[108:111], v43 offset:49152
    ds_read_b128 a[112:115], v40 offset:49408
    ds_read_b128 a[116:119], v41 offset:49408
    ds_read_b128 a[120:123], v42 offset:49408
    ds_read_b128 a[124:127], v43 offset:49408
    ds_read_b128 a[128:131], v40 offset:49664
    ds_read_b128 a[132:135], v41 offset:49664
    ds_read_b128 a[136:139], v42 offset:49664
    ds_read_b128 a[140:143], v43 offset:49664
    s_waitcnt lgkmcnt(11)
    v_mfma_f32_16x16x32_bf16 v[96:99], a[96:99], a[96:99], v[84:87]
    ds_read_b64_tr_b16 a[144:145], v44 offset:49152
    ds_read_b64_tr_b16 a[146:147], v48 offset:49408
    v_mfma_f32_16x16x32_bf16 v[100:103], a[96:99], a[48:51], 0
    ds_read_b64_tr_b16 a[148:149], v45 offset:49152
    ds_read_b64_tr_b16 a[150:151], v49 offset:49408
    s_waitcnt lgkmcnt(14)
    v_mfma_f32_16x16x32_bf16 v[96:99], a[100:103], a[100:103], v[96:99]
    ds_read_b64_tr_b16 a[152:153], v46 offset:49152
    ds_read_b64_tr_b16 a[154:155], v50 offset:49408
    v_mfma_f32_16x16x32_bf16 v[100:103], a[100:103], a[52:55], v[100:103]
    ds_read_b64_tr_b16 a[156:157], v47 offset:49152
    ds_read_b64_tr_b16 a[158:159], v51 offset:49408
    s_waitcnt lgkmcnt(15)
    v_mfma_f32_16x16x32_bf16 v[96:99], a[104:107], a[104:107], v[96:99]
    ds_read_b64_tr_b16 a[160:161], v48 offset:49152
    ds_read_b64_tr_b16 a[162:163], v44 offset:49664
    v_mfma_f32_16x16x32_bf16 v[100:103], a[104:107], a[56:59], v[100:103]
    ds_read_b64_tr_b16 a[164:165], v49 offset:49152
    ds_read_b64_tr_b16 a[166:167], v45 offset:49664
    v_mfma_f32_16x16x32_bf16 v[96:99], a[108:111], a[108:111], v[96:99]
    ds_read_b64_tr_b16 a[168:169], v50 offset:49152
    ds_read_b64_tr_b16 a[170:171], v46 offset:49664
    v_mfma_f32_16x16x32_bf16 v[100:103], a[108:111], a[60:63], v[100:103]
    ds_read_b64_tr_b16 a[172:173], v51 offset:49152
    ds_read_b64_tr_b16 a[174:175], v47 offset:49664
    v_mfma_f32_16x16x32_bf16 v[96:99], a[112:115], a[112:115], v[96:99]
    ds_read_b64_tr_b16 a[176:177], v44 offset:49408
    ds_read_b64_tr_b16 a[178:179], v48 offset:49664
    v_mfma_f32_16x16x32_bf16 v[100:103], a[112:115], a[64:67], v[100:103]
    ds_read_b64_tr_b16 a[180:181], v45 offset:49408
    ds_read_b64_tr_b16 a[182:183], v49 offset:49664
    s_waitcnt lgkmcnt(15)
    v_mfma_f32_16x16x32_bf16 v[96:99], a[116:119], a[116:119], v[96:99]
    ds_read_b64_tr_b16 a[184:185], v46 offset:49408
    ds_read_b64_tr_b16 a[186:187], v50 offset:49664
    v_mfma_f32_16x16x32_bf16 v[100:103], a[116:119], a[68:71], v[100:103]
    ds_read_b64_tr_b16 a[188:189], v47 offset:49408
    ds_read_b64_tr_b16 a[190:191], v51 offset:49664
    v_mfma_f32_16x16x32_bf16 v[92:95], a[96:99], v[52:55], v[80:83]
    v_mfma_f32_16x16x32_bf16 v[92:95], a[100:103], v[52:55], v[92:95]
    v_mfma_f32_16x16x32_bf16 v[92:95], a[104:107], v[52:55], v[92:95]
    v_mfma_f32_16x16x32_bf16 v[92:95], a[108:111], v[52:55], v[92:95]
    s_nop 1
    v_fma_f32 v96, v100, 2.0, v96
    v_fma_f32 v97, v101, 2.0, v97
    v_mfma_f32_16x16x32_bf16 v[92:95], a[112:115], v[52:55], v[92:95]
    v_fma_f32 v98, v102, 2.0, v98
    v_fma_f32 v99, v103, 2.0, v99
    v_mfma_f32_16x16x32_bf16 v[92:95], a[116:119], v[52:55], v[92:95]
    v_cndmask_b32 v3, 0, v96, s[44:45]
    v_cndmask_b32 v3, v3, v97, s[46:47]
    v_mfma_f32_16x16x32_bf16 v[88:91], a[96:99], v[136:139], v[76:79]
    v_cndmask_b32 v3, v3, v98, s[48:49]
    v_cndmask_b32 v3, v3, v99, s[50:51]
    v_mfma_f32_16x16x32_bf16 v[88:91], a[100:103], v[140:143], v[88:91]
    s_nop 0
    s_nop 0
    v_mfma_f32_16x16x32_bf16 v[88:91], a[104:107], v[144:147], v[88:91]
    v_mfma_f32_16x16x4_f32 v[120:123], v3, v60, v[56:59]
    v_mfma_f32_16x16x32_bf16 v[88:91], a[108:111], v[148:151], v[88:91]
    v_mfma_f32_16x16x32_bf16 v[88:91], a[112:115], v[152:155], v[88:91]
    v_mfma_f32_16x16x32_bf16 v[88:91], a[116:119], v[156:159], v[88:91]
    s_waitcnt lgkmcnt(0)
    s_barrier
    s_add_u32 m0, s42, 0
    s_add_u32 s59, s37, 294912
    buffer_load_dwordx4 v22, s[24:27], s59 offen offset:0 nt lds
    buffer_load_dwordx4 v23, s[24:27], s59 offen offset:1024 nt lds
    s_add_u32 s61, s60, 2162688
    buffer_load_dwordx4 v[160:163], v65, s[32:35], s61 offen offset:0 sc1
    buffer_load_dwordx4 v24, s[24:27], s59 offen offset:2048 nt lds
    buffer_load_dwordx4 v[164:167], v65, s[32:35], s61 offen offset:1024 sc1
    buffer_load_dwordx4 v25, s[24:27], s59 offen offset:3072 nt lds
    s_add_u32 m0, s42, 4096
    s_nop 0
    buffer_load_dwordx4 v26, s[24:27], s59 offen offset:0 nt lds
    buffer_load_dwordx4 v[168:171], v65, s[32:35], s61 offen offset:2048 sc1
    buffer_load_dwordx4 v27, s[24:27], s59 offen offset:1024 nt lds
    buffer_load_dwordx4 v[172:175], v65, s[32:35], s61 offen offset:3072 sc1
    buffer_load_dwordx4 v28, s[24:27], s59 offen offset:2048 nt lds
    buffer_load_dwordx4 v29, s[24:27], s59 offen offset:3072 nt lds
    s_add_u32 s61, s60, 2166784
    buffer_load_dwordx4 v[176:179], v65, s[32:35], s61 offen offset:0 sc1
    s_add_u32 m0, s42, 8192
    s_nop 0
    buffer_load_dwordx4 v30, s[24:27], s59 offen offset:0 nt lds
    buffer_load_dwordx4 v[180:183], v65, s[32:35], s61 offen offset:1024 sc1
    buffer_load_dwordx4 v31, s[24:27], s59 offen offset:1024 nt lds
    buffer_load_dwordx4 v32, s[24:27], s59 offen offset:2048 nt lds
    buffer_load_dwordx4 v[184:187], v65, s[32:35], s61 offen offset:2048 sc1
    buffer_load_dwordx4 v33, s[24:27], s59 offen offset:3072 nt lds
    buffer_load_dwordx4 v[188:191], v65, s[32:35], s61 offen offset:3072 sc1
    v_mfma_f32_16x16x32_bf16 v[112:115], a[120:123], a[120:123], v[84:87]
    v_mfma_f32_16x16x32_bf16 v[116:119], a[120:123], a[48:51], 0
    v_mfma_f32_16x16x32_bf16 v[112:115], a[124:127], a[124:127], v[112:115]
    v_mfma_f32_16x16x32_bf16 v[116:119], a[124:127], a[52:55], v[116:119]
    v_fma_f32 v128, -v92, v92, v120
    v_fma_f32 v129, -v93, v93, v121
    v_mfma_f32_16x16x32_bf16 v[112:115], a[128:131], a[128:131], v[112:115]
    v_fma_f32 v130, -v94, v94, v122
    v_fma_f32 v131, -v95, v95, v123
    v_mfma_f32_16x16x32_bf16 v[116:119], a[128:131], a[56:59], v[116:119]
    v_max_f32 v128, v128, v56
    v_max_f32 v129, v129, v56
    v_mfma_f32_16x16x32_bf16 v[112:115], a[132:135], a[132:135], v[112:115]
    v_max_f32 v130, v130, v56
    v_max_f32 v131, v131, v56
    v_mfma_f32_16x16x32_bf16 v[116:119], a[132:135], a[60:63], v[116:119]
    v_rsq_f32 v128, v128
    v_mfma_f32_16x16x32_bf16 v[112:115], a[136:139], a[136:139], v[112:115]
    v_rsq_f32 v129, v129
    v_mfma_f32_16x16x32_bf16 v[116:119], a[136:139], a[64:67], v[116:119]
    v_rsq_f32 v130, v130
    v_mfma_f32_16x16x32_bf16 v[112:115], a[140:143], a[140:143], v[112:115]
    v_rsq_f32 v131, v131
    v_mfma_f32_16x16x32_bf16 v[116:119], a[140:143], a[68:71], v[116:119]
    v_fma_f32 v88, -v92, v61, v88
    v_fma_f32 v89, -v93, v61, v89
    v_mfma_f32_16x16x32_bf16 v[108:111], a[120:123], v[52:55], v[80:83]
    v_fma_f32 v90, -v94, v61, v90
    v_fma_f32 v91, -v95, v61, v91
    v_mfma_f32_16x16x32_bf16 v[108:111], a[124:127], v[52:55], v[108:111]
    v_fma_f32 v88, v88, v128, v62
    v_fma_f32 v89, v89, v129, v62
    v_mfma_f32_16x16x32_bf16 v[108:111], a[128:131], v[52:55], v[108:111]
    v_fma_f32 v90, v90, v130, v62
    v_fma_f32 v91, v91, v131, v62
    v_mfma_f32_16x16x32_bf16 v[108:111], a[132:135], v[52:55], v[108:111]
    v_max3_f32 v1, v88, v89, v90
    v_max_f32 v1, v1, v91
    v_mfma_f32_16x16x32_bf16 v[108:111], a[136:139], v[52:55], v[108:111]
    v_cmp_lt_f32 vcc, s52, v1
    s_cbranch_vccnz L_site5
L_back5:
    v_mfma_f32_16x16x32_bf16 v[108:111], a[140:143], v[52:55], v[108:111]
    v_exp_f32 v96, v88
    v_mfma_f32_16x16x32_bf16 v[104:107], a[120:123], v[136:139], v[76:79]
    v_exp_f32 v97, v89
    v_mfma_f32_16x16x32_bf16 v[104:107], a[124:127], v[140:143], v[104:107]
    v_exp_f32 v98, v90
    v_mfma_f32_16x16x32_bf16 v[104:107], a[128:131], v[144:147], v[104:107]
    v_exp_f32 v99, v91
    v_mfma_f32_16x16x32_bf16 v[104:107], a[132:135], v[148:151], v[104:107]
    v_mul_f32 v88, v96, v128
    v_mul_f32 v89, v97, v129
    v_mfma_f32_16x16x32_bf16 v[104:107], a[136:139], v[152:155], v[104:107]
    v_mul_f32 v90, v98, v130
    v_mul_f32 v91, v99, v131
    v_mfma_f32_16x16x32_bf16 v[104:107], a[140:143], v[156:159], v[104:107]
    v_fma_f32 v112, v116, 2.0, v112
    v_fma_f32 v113, v117, 2.0, v113
    v_fma_f32 v114, v118, 2.0, v114
    v_fma_f32 v115, v119, 2.0, v115
    v_cndmask_b32 v4, 0, v112, s[44:45]
    v_cndmask_b32 v4, v4, v113, s[46:47]
    v_cndmask_b32 v4, v4, v114, s[48:49]
    v_cndmask_b32 v4, v4, v115, s[50:51]
    v_add_f32 v63, v63, v96
    v_fmac_f32 v64, v88, v92
    v_mfma_f32_16x16x4_f32 v[124:127], v4, v60, v[56:59]
    v_add_f32 v63, v63, v97
    v_fmac_f32 v64, v89, v93
    v_add_f32 v63, v63, v98
    v_fmac_f32 v64, v90, v94
    v_add_f32 v63, v63, v99
    v_fmac_f32 v64, v91, v95
    v_add_f32 v68, v68, v88
    v_add_f32 v69, v69, v89
    v_add_f32 v70, v70, v90
    v_add_f32 v71, v71, v91
    v_fma_f32 v132, -v108, v108, v124
    v_fma_f32 v133, -v109, v109, v125
    v_fma_f32 v134, -v110, v110, v126
    v_fma_f32 v135, -v111, v111, v127
    v_max_f32 v132, v132, v56
    v_max_f32 v133, v133, v56
    v_max_f32 v134, v134, v56
    v_max_f32 v135, v135, v56
    v_rsq_f32 v132, v132
    v_rsq_f32 v133, v133
    v_rsq_f32 v134, v134
    v_rsq_f32 v135, v135
    v_fma_f32 v104, -v108, v61, v104
    v_fma_f32 v105, -v109, v61, v105
    v_fma_f32 v106, -v110, v61, v106
    v_fma_f32 v107, -v111, v61, v107
    v_fma_f32 v104, v104, v132, v62
    v_fma_f32 v105, v105, v133, v62
    v_fma_f32 v106, v106, v134, v62
    v_fma_f32 v107, v107, v135, v62
    v_max3_f32 v1, v104, v105, v106
    v_max_f32 v1, v1, v107
    v_cmp_lt_f32 vcc, s52, v1
    s_cbranch_vccnz L_site6
L_back6:
    v_exp_f32 v112, v104
    v_exp_f32 v113, v105
    v_exp_f32 v114, v106
    v_exp_f32 v115, v107
    v_mul_f32 v104, v112, v132
    v_mul_f32 v105, v113, v133
    v_mul_f32 v106, v114, v134
    v_mul_f32 v107, v115, v135
    v_cvt_pk_bf16_f32 v72, v88, v89
    v_cvt_pk_bf16_f32 v73, v90, v91
    v_cvt_pk_bf16_f32 v74, v104, v105
    v_cvt_pk_bf16_f32 v75, v106, v107
    s_nop 1
    v_mfma_f32_16x16x32_bf16 a[0:3], a[144:147], v[72:75], a[0:3]
    v_add_f32 v68, v68, v104
    v_add_f32 v69, v69, v105
    v_mfma_f32_16x16x32_bf16 a[4:7], a[148:151], v[72:75], a[4:7]
    v_add_f32 v70, v70, v106
    v_add_f32 v71, v71, v107
    v_mfma_f32_16x16x32_bf16 a[8:11], a[152:155], v[72:75], a[8:11]
    v_cvt_pk_bf16_f32 v66, v68, v69
    v_cvt_pk_bf16_f32 v67, v70, v71
    v_mfma_f32_16x16x32_bf16 a[12:15], a[156:159], v[72:75], a[12:15]
    v_add_f32 v63, v63, v112
    v_fmac_f32 v64, v104, v108
    v_mfma_f32_16x16x32_bf16 a[16:19], a[160:163], v[72:75], a[16:19]
    v_add_f32 v63, v63, v113
    v_fmac_f32 v64, v105, v109
    v_mfma_f32_16x16x32_bf16 a[20:23], a[164:167], v[72:75], a[20:23]
    v_add_f32 v63, v63, v114
    v_fmac_f32 v64, v106, v110
    v_mfma_f32_16x16x32_bf16 a[24:27], a[168:171], v[72:75], a[24:27]
    v_add_f32 v63, v63, v115
    v_fmac_f32 v64, v107, v111
    v_mfma_f32_16x16x32_bf16 a[28:31], a[172:175], v[72:75], a[28:31]
    v_mfma_f32_16x16x32_bf16 a[32:35], a[176:179], v[72:75], a[32:35]
    v_mfma_f32_16x16x32_bf16 a[36:39], a[180:183], v[72:75], a[36:39]
    v_mfma_f32_16x16x32_bf16 a[40:43], a[184:187], v[72:75], a[40:43]
    v_mfma_f32_16x16x32_bf16 a[44:47], a[188:191], v[72:75], a[44:47]
    v_mfma_f32_16x16x16_bf16 a[0:3], a[72:73], v[66:67], a[0:3]
    v_mfma_f32_16x16x16_bf16 a[4:7], a[74:75], v[66:67], a[4:7]
    v_mfma_f32_16x16x16_bf16 a[8:11], a[76:77], v[66:67], a[8:11]
    v_mfma_f32_16x16x16_bf16 a[12:15], a[78:79], v[66:67], a[12:15]
    v_mfma_f32_16x16x16_bf16 a[16:19], a[80:81], v[66:67], a[16:19]
    v_mfma_f32_16x16x16_bf16 a[20:23], a[82:83], v[66:67], a[20:23]
    v_mfma_f32_16x16x16_bf16 a[24:27], a[84:85], v[66:67], a[24:27]
    v_mfma_f32_16x16x16_bf16 a[28:31], a[86:87], v[66:67], a[28:31]
    v_mfma_f32_16x16x16_bf16 a[32:35], a[88:89], v[66:67], a[32:35]
    v_mfma_f32_16x16x16_bf16 a[36:39], a[90:91], v[66:67], a[36:39]
    v_mfma_f32_16x16x16_bf16 a[40:43], a[92:93], v[66:67], a[40:43]
    v_mfma_f32_16x16x16_bf16 a[44:47], a[94:95], v[66:67], a[44:47]
    s_waitcnt vmcnt(32)
    ds_read_b128 a[48:51], v34 offset:0
    ds_read_b128 a[52:55], v35 offset:0
    ds_read_b128 a[56:59], v34 offset:128
    ds_read_b128 a[60:63], v35 offset:128
    ds_read_b128 a[64:67], v34 offset:256
    ds_read_b128 a[68:71], v35 offset:256
    s_waitcnt lgkmcnt(5)
    v_mfma_f32_16x16x32_bf16 v[84:87], a[48:51], a[48:51], 0
    ds_read_b64_tr_b16 a[72:73], v36 offset:0
    ds_read_b64_tr_b16 a[74:75], v37 offset:0
    v_mfma_f32_16x16x32_bf16 v[80:83], a[48:51], v[52:55], 0
    ds_read_b64_tr_b16 a[76:77], v38 offset:0
    ds_read_b64_tr_b16 a[78:79], v39 offset:0
    s_waitcnt lgkmcnt(8)
    v_mfma_f32_16x16x32_bf16 v[84:87], a[52:55], a[52:55], v[84:87]
    ds_read_b64_tr_b16 a[80:81], v36 offset:128
    ds_read_b64_tr_b16 a[82:83], v37 offset:128
    v_mfma_f32_16x16x32_bf16 v[80:83], a[52:55], v[52:55], v[80:83]
    ds_read_b64_tr_b16 a[84:85], v38 offset:128
    ds_read_b64_tr_b16 a[86:87], v39 offset:128
    s_waitcnt lgkmcnt(11)
    v_mfma_f32_16x16x32_bf16 v[84:87], a[56:59], a[56:59], v[84:87]
    ds_read_b64_tr_b16 a[88:89], v36 offset:256
    ds_read_b64_tr_b16 a[90:91], v37 offset:256
    v_mfma_f32_16x16x32_bf16 v[80:83], a[56:59], v[52:55], v[80:83]
    ds_read_b64_tr_b16 a[92:93], v38 offset:256
    ds_read_b64_tr_b16 a[94:95], v39 offset:256
    s_waitcnt lgkmcnt(14)
    v_mfma_f32_16x16x32_bf16 v[84:87], a[60:63], a[60:63], v[84:87]
    v_mfma_f32_16x16x32_bf16 v[80:83], a[60:63], v[52:55], v[80:83]
    s_waitcnt lgkmcnt(13)
    v_mfma_f32_16x16x32_bf16 v[84:87], a[64:67], a[64:67], v[84:87]
    v_mfma_f32_16x16x32_bf16 v[80:83], a[64:67], v[52:55], v[80:83]
    s_waitcnt lgkmcnt(12)
    v_mfma_f32_16x16x32_bf16 v[84:87], a[68:71], a[68:71], v[84:87]
    v_mfma_f32_16x16x32_bf16 v[80:83], a[68:71], v[52:55], v[80:83]
    s_waitcnt lgkmcnt(0)
    s_barrier
    s_add_u32 m0, s40, 0
    s_add_u32 s57, s36, 73728
    buffer_load_dwordx4 v16, s[28:31], s57 offen offset:0 nt lds
    buffer_load_dwordx4 v17, s[28:31], s57 offen offset:1024 nt lds
    s_add_u32 s61, s60, 2170880
    buffer_load_dwordx4 v[192:195], v65, s[32:35], s61 offen offset:0 sc1
    buffer_load_dwordx4 v18, s[28:31], s57 offen offset:2048 nt lds
    buffer_load_dwordx4 v[196:199], v65, s[32:35], s61 offen offset:1024 sc1
    buffer_load_dwordx4 v19, s[28:31], s57 offen offset:3072 nt lds
    s_add_u32 m0, s40, 4096
    s_nop 0
    buffer_load_dwordx4 v20, s[28:31], s57 offen offset:0 nt lds
    buffer_load_dwordx4 v[200:203], v65, s[32:35], s61 offen offset:2048 sc1
    buffer_load_dwordx4 v21, s[28:31], s57 offen offset:1024 nt lds
    buffer_load_dwordx4 v[204:207], v65, s[32:35], s61 offen offset:3072 sc1
    v_mfma_f32_16x16x32_bf16 v[76:79], a[48:51], v[136:139], 0
    v_mfma_f32_16x16x32_bf16 v[76:79], a[52:55], v[140:143], v[76:79]
    v_mfma_f32_16x16x32_bf16 v[76:79], a[56:59], v[144:147], v[76:79]
    v_mfma_f32_16x16x32_bf16 v[76:79], a[60:63], v[148:151], v[76:79]
    v_mfma_f32_16x16x32_bf16 v[76:79], a[64:67], v[152:155], v[76:79]
    v_mfma_f32_16x16x32_bf16 v[76:79], a[68:71], v[156:159], v[76:79]
    s_waitcnt vmcnt(30)
    ds_read_b128 a[96:99], v40 offset:0
    ds_read_b128 a[100:103], v41 offset:0
    ds_read_b128 a[104:107], v42 offset:0
    ds_read_b128 a[108:111], v43 offset:0
    ds_read_b128 a[112:115], v40 offset:256
    ds_read_b128 a[116:119], v41 offset:256
    ds_read_b128 a[120:123], v42 offset:256
    ds_read_b128 a[124:127], v43 offset:256
    ds_read_b128 a[128:131], v40 offset:512
    ds_read_b128 a[132:135], v41 offset:512
    ds_read_b128 a[136:139], v42 offset:512
    ds_read_b128 a[140:143], v43 offset:512
    s_waitcnt lgkmcnt(11)
    v_mfma_f32_16x16x32_bf16 v[96:99], a[96:99], a[96:99], v[84:87]
    ds_read_b64_tr_b16 a[144:145], v44 offset:0
    ds_read_b64_tr_b16 a[146:147], v48 offset:256
    v_mfma_f32_16x16x32_bf16 v[100:103], a[96:99], a[48:51], 0
    ds_read_b64_tr_b16 a[148:149], v45 offset:0
    ds_read_b64_tr_b16 a[150:151], v49 offset:256
    s_waitcnt lgkmcnt(14)
    v_mfma_f32_16x16x32_bf16 v[96:99], a[100:103], a[100:103], v[96:99]
    ds_read_b64_tr_b16 a[152:153], v46 offset:0
    ds_read_b64_tr_b16 a[154:155], v50 offset:256
    v_mfma_f32_16x16x32_bf16 v[100:103], a[100:103], a[52:55], v[100:103]
    ds_read_b64_tr_b16 a[156:157], v47 offset:0
    ds_read_b64_tr_b16 a[158:159], v51 offset:256
    s_waitcnt lgkmcnt(15)
    v_mfma_f32_16x16x32_bf16 v[96:99], a[104:107], a[104:107], v[96:99]
    ds_read_b64_tr_b16 a[160:161], v48 offset:0
    ds_read_b64_tr_b16 a[162:163], v44 offset:512
    v_mfma_f32_16x16x32_bf16 v[100:103], a[104:107], a[56:59], v[100:103]
    ds_read_b64_tr_b16 a[164:165], v49 offset:0
    ds_read_b64_tr_b16 a[166:167], v45 offset:512
    v_mfma_f32_16x16x32_bf16 v[96:99], a[108:111], a[108:111], v[96:99]
    ds_read_b64_tr_b16 a[168:169], v50 offset:0
    ds_read_b64_tr_b16 a[170:171], v46 offset:512
    v_mfma_f32_16x16x32_bf16 v[100:103], a[108:111], a[60:63], v[100:103]
    ds_read_b64_tr_b16 a[172:173], v51 offset:0
    ds_read_b64_tr_b16 a[174:175], v47 offset:512
    v_mfma_f32_16x16x32_bf16 v[96:99], a[112:115], a[112:115], v[96:99]
    ds_read_b64_tr_b16 a[176:177], v44 offset:256
    ds_read_b64_tr_b16 a[178:179], v48 offset:512
    v_mfma_f32_16x16x32_bf16 v[100:103], a[112:115], a[64:67], v[100:103]
    ds_read_b64_tr_b16 a[180:181], v45 offset:256
    ds_read_b64_tr_b16 a[182:183], v49 offset:512
    s_waitcnt lgkmcnt(15)
    v_mfma_f32_16x16x32_bf16 v[96:99], a[116:119], a[116:119], v[96:99]
    ds_read_b64_tr_b16 a[184:185], v46 offset:256
    ds_read_b64_tr_b16 a[186:187], v50 offset:512
    v_mfma_f32_16x16x32_bf16 v[100:103], a[116:119], a[68:71], v[100:103]
    ds_read_b64_tr_b16 a[188:189], v47 offset:256
    ds_read_b64_tr_b16 a[190:191], v51 offset:512
    v_mfma_f32_16x16x32_bf16 v[92:95], a[96:99], v[52:55], v[80:83]
    v_mfma_f32_16x16x32_bf16 v[92:95], a[100:103], v[52:55], v[92:95]
    v_mfma_f32_16x16x32_bf16 v[92:95], a[104:107], v[52:55], v[92:95]
    v_mfma_f32_16x16x32_bf16 v[92:95], a[108:111], v[52:55], v[92:95]
    s_nop 1
    v_fma_f32 v96, v100, 2.0, v96
    v_fma_f32 v97, v101, 2.0, v97
    v_mfma_f32_16x16x32_bf16 v[92:95], a[112:115], v[52:55], v[92:95]
    v_fma_f32 v98, v102, 2.0, v98
    v_fma_f32 v99, v103, 2.0, v99
    v_mfma_f32_16x16x32_bf16 v[92:95], a[116:119], v[52:55], v[92:95]
    v_cndmask_b32 v3, 0, v96, s[44:45]
    v_cndmask_b32 v3, v3, v97, s[46:47]
    v_mfma_f32_16x16x32_bf16 v[88:91], a[96:99], v[136:139], v[76:79]
    v_cndmask_b32 v3, v3, v98, s[48:49]
    v_cndmask_b32 v3, v3, v99, s[50:51]
    v_mfma_f32_16x16x32_bf16 v[88:91], a[100:103], v[140:143], v[88:91]
    s_nop 0
    s_nop 0
    v_mfma_f32_16x16x32_bf16 v[88:91], a[104:107], v[144:147], v[88:91]
    v_mfma_f32_16x16x4_f32 v[120:123], v3, v60, v[56:59]
    v_mfma_f32_16x16x32_bf16 v[88:91], a[108:111], v[148:151], v[88:91]
    v_mfma_f32_16x16x32_bf16 v[88:91], a[112:115], v[152:155], v[88:91]
    v_mfma_f32_16x16x32_bf16 v[88:91], a[116:119], v[156:159], v[88:91]
    s_waitcnt lgkmcnt(0)
    v_mfma_f32_16x16x32_bf16 v[112:115], a[120:123], a[120:123], v[84:87]
    v_mfma_f32_16x16x32_bf16 v[116:119], a[120:123], a[48:51], 0
    v_mfma_f32_16x16x32_bf16 v[112:115], a[124:127], a[124:127], v[112:115]
    v_mfma_f32_16x16x32_bf16 v[116:119], a[124:127], a[52:55], v[116:119]
    s_nop 1
    v_fma_f32 v128, -v92, v92, v120
    v_fma_f32 v129, -v93, v93, v121
    v_mfma_f32_16x16x32_bf16 v[112:115], a[128:131], a[128:131], v[112:115]
    v_fma_f32 v130, -v94, v94, v122
    v_fma_f32 v131, -v95, v95, v123
    v_mfma_f32_16x16x32_bf16 v[116:119], a[128:131], a[56:59], v[116:119]
    v_max_f32 v128, v128, v56
    v_max_f32 v129, v129, v56
    v_mfma_f32_16x16x32_bf16 v[112:115], a[132:135], a[132:135], v[112:115]
    v_max_f32 v130, v130, v56
    v_max_f32 v131, v131, v56
    v_mfma_f32_16x16x32_bf16 v[116:119], a[132:135], a[60:63], v[116:119]
    v_rsq_f32 v128, v128
    v_mfma_f32_16x16x32_bf16 v[112:115], a[136:139], a[136:139], v[112:115]
    v_rsq_f32 v129, v129
    v_mfma_f32_16x16x32_bf16 v[116:119], a[136:139], a[64:67], v[116:119]
    v_rsq_f32 v130, v130
    v_mfma_f32_16x16x32_bf16 v[112:115], a[140:143], a[140:143], v[112:115]
    v_rsq_f32 v131, v131
    v_mfma_f32_16x16x32_bf16 v[116:119], a[140:143], a[68:71], v[116:119]
    v_fma_f32 v88, -v92, v61, v88
    v_fma_f32 v89, -v93, v61, v89
    v_mfma_f32_16x16x32_bf16 v[108:111], a[120:123], v[52:55], v[80:83]
    v_fma_f32 v90, -v94, v61, v90
    v_fma_f32 v91, -v95, v61, v91
    v_mfma_f32_16x16x32_bf16 v[108:111], a[124:127], v[52:55], v[108:111]
    v_fma_f32 v88, v88, v128, v62
    v_fma_f32 v89, v89, v129, v62
    v_mfma_f32_16x16x32_bf16 v[108:111], a[128:131], v[52:55], v[108:111]
    v_fma_f32 v90, v90, v130, v62
    v_fma_f32 v91, v91, v131, v62
    v_mfma_f32_16x16x32_bf16 v[108:111], a[132:135], v[52:55], v[108:111]
    v_max3_f32 v1, v88, v89, v90
    v_max_f32 v1, v1, v91
    v_mfma_f32_16x16x32_bf16 v[108:111], a[136:139], v[52:55], v[108:111]
    v_cmp_lt_f32 vcc, s52, v1
    s_cbranch_vccnz L_site7
L_back7:
    v_mfma_f32_16x16x32_bf16 v[108:111], a[140:143], v[52:55], v[108:111]
    v_exp_f32 v96, v88
    v_mfma_f32_16x16x32_bf16 v[104:107], a[120:123], v[136:139], v[76:79]
    v_exp_f32 v97, v89
    v_mfma_f32_16x16x32_bf16 v[104:107], a[124:127], v[140:143], v[104:107]
    v_exp_f32 v98, v90
    v_mfma_f32_16x16x32_bf16 v[104:107], a[128:131], v[144:147], v[104:107]
    v_exp_f32 v99, v91
    v_mfma_f32_16x16x32_bf16 v[104:107], a[132:135], v[148:151], v[104:107]
    v_mul_f32 v88, v96, v128
    v_mul_f32 v89, v97, v129
    v_mfma_f32_16x16x32_bf16 v[104:107], a[136:139], v[152:155], v[104:107]
    v_mul_f32 v90, v98, v130
    v_mul_f32 v91, v99, v131
    v_mfma_f32_16x16x32_bf16 v[104:107], a[140:143], v[156:159], v[104:107]
    v_fma_f32 v112, v116, 2.0, v112
    v_fma_f32 v113, v117, 2.0, v113
    v_fma_f32 v114, v118, 2.0, v114
    v_fma_f32 v115, v119, 2.0, v115
    v_cndmask_b32 v4, 0, v112, s[44:45]
    v_cndmask_b32 v4, v4, v113, s[46:47]
    v_cndmask_b32 v4, v4, v114, s[48:49]
    v_cndmask_b32 v4, v4, v115, s[50:51]
    v_add_f32 v63, v63, v96
    v_fmac_f32 v64, v88, v92
    v_mfma_f32_16x16x4_f32 v[124:127], v4, v60, v[56:59]
    v_add_f32 v63, v63, v97
    v_fmac_f32 v64, v89, v93
    v_add_f32 v63, v63, v98
    v_fmac_f32 v64, v90, v94
    v_add_f32 v63, v63, v99
    v_fmac_f32 v64, v91, v95
    v_mov_b32 v68, v88
    v_mov_b32 v69, v89
    v_mov_b32 v70, v90
    v_mov_b32 v71, v91
    v_fma_f32 v132, -v108, v108, v124
    v_fma_f32 v133, -v109, v109, v125
    v_fma_f32 v134, -v110, v110, v126
    v_fma_f32 v135, -v111, v111, v127
    v_max_f32 v132, v132, v56
    v_max_f32 v133, v133, v56
    v_max_f32 v134, v134, v56
    v_max_f32 v135, v135, v56
    v_rsq_f32 v132, v132
    v_rsq_f32 v133, v133
    v_rsq_f32 v134, v134
    v_rsq_f32 v135, v135
    v_fma_f32 v104, -v108, v61, v104
    v_fma_f32 v105, -v109, v61, v105
    v_fma_f32 v106, -v110, v61, v106
    v_fma_f32 v107, -v111, v61, v107
    v_fma_f32 v104, v104, v132, v62
    v_fma_f32 v105, v105, v133, v62
    v_fma_f32 v106, v106, v134, v62
    v_fma_f32 v107, v107, v135, v62
    v_max3_f32 v1, v104, v105, v106
    v_max_f32 v1, v1, v107
    v_cmp_lt_f32 vcc, s52, v1
    s_cbranch_vccnz L_site8
L_back8:
    v_exp_f32 v112, v104
    v_exp_f32 v113, v105
    v_exp_f32 v114, v106
    v_exp_f32 v115, v107
    v_mul_f32 v104, v112, v132
    v_mul_f32 v105, v113, v133
    v_mul_f32 v106, v114, v134
    v_mul_f32 v107, v115, v135
    v_cvt_pk_bf16_f32 v72, v88, v89
    v_cvt_pk_bf16_f32 v73, v90, v91
    v_cvt_pk_bf16_f32 v74, v104, v105
    v_cvt_pk_bf16_f32 v75, v106, v107
    s_nop 1
    v_mfma_f32_16x16x32_bf16 a[0:3], a[144:147], v[72:75], a[0:3]
    v_add_f32 v63, v63, v112
    v_fmac_f32 v64, v104, v108
    v_mfma_f32_16x16x32_bf16 a[4:7], a[148:151], v[72:75], a[4:7]
    v_add_f32 v63, v63, v113
    v_fmac_f32 v64, v105, v109
    v_mfma_f32_16x16x32_bf16 a[8:11], a[152:155], v[72:75], a[8:11]
    v_add_f32 v63, v63, v114
    v_fmac_f32 v64, v106, v110
    v_mfma_f32_16x16x32_bf16 a[12:15], a[156:159], v[72:75], a[12:15]
    v_add_f32 v63, v63, v115
    v_fmac_f32 v64, v107, v111
    v_mfma_f32_16x16x32_bf16 a[16:19], a[160:163], v[72:75], a[16:19]
    v_add_f32 v68, v68, v104
    v_add_f32 v69, v69, v105
    v_mfma_f32_16x16x32_bf16 a[20:23], a[164:167], v[72:75], a[20:23]
    v_add_f32 v70, v70, v106
    v_add_f32 v71, v71, v107
    v_mfma_f32_16x16x32_bf16 a[24:27], a[168:171], v[72:75], a[24:27]
    v_mfma_f32_16x16x32_bf16 a[28:31], a[172:175], v[72:75], a[28:31]
    v_mfma_f32_16x16x32_bf16 a[32:35], a[176:179], v[72:75], a[32:35]
    v_mfma_f32_16x16x32_bf16 a[36:39], a[180:183], v[72:75], a[36:39]
    v_mfma_f32_16x16x32_bf16 a[40:43], a[184:187], v[72:75], a[40:43]
    v_mfma_f32_16x16x32_bf16 a[44:47], a[188:191], v[72:75], a[44:47]
    s_barrier
    s_add_u32 m0, s41, 0
    s_add_u32 s58, s37, 147456
    buffer_load_dwordx4 v22, s[24:27], s58 offen offset:0 nt lds
    buffer_load_dwordx4 v23, s[24:27], s58 offen offset:1024 nt lds
    s_add_u32 s61, s60, 2174976
    buffer_load_dwordx4 v[208:211], v65, s[32:35], s61 offen offset:0 sc1
    buffer_load_dwordx4 v24, s[24:27], s58 offen offset:2048 nt lds
    buffer_load_dwordx4 v[212:215], v65, s[32:35], s61 offen offset:1024 sc1
    buffer_load_dwordx4 v25, s[24:27], s58 offen offset:3072 nt lds
    s_add_u32 m0, s41, 4096
    s_nop 0
    buffer_load_dwordx4 v26, s[24:27], s58 offen offset:0 nt lds
    buffer_load_dwordx4 v[216:219], v65, s[32:35], s61 offen offset:2048 sc1
    buffer_load_dwordx4 v27, s[24:27], s58 offen offset:1024 nt lds
    buffer_load_dwordx4 v[220:223], v65, s[32:35], s61 offen offset:3072 sc1
    buffer_load_dwordx4 v28, s[24:27], s58 offen offset:2048 nt lds
    buffer_load_dwordx4 v29, s[24:27], s58 offen offset:3072 nt lds
    s_add_u32 s61, s60, 2179072
    buffer_load_dwordx4 v[224:227], v65, s[32:35], s61 offen offset:0 sc1
    s_add_u32 m0, s41, 8192
    s_nop 0
    buffer_load_dwordx4 v30, s[24:27], s58 offen offset:0 nt lds
    buffer_load_dwordx4 v[228:231], v65, s[32:35], s61 offen offset:1024 sc1
    buffer_load_dwordx4 v31, s[24:27], s58 offen offset:1024 nt lds
    buffer_load_dwordx4 v32, s[24:27], s58 offen offset:2048 nt lds
    buffer_load_dwordx4 v33, s[24:27], s58 offen offset:3072 nt lds
    s_waitcnt vmcnt(29)
    ds_read_b128 a[96:99], v40 offset:49152
    ds_read_b128 a[100:103], v41 offset:49152
    ds_read_b128 a[104:107], v42 offset:49152
    ds_read_b128 a[108:111], v43 offset:49152
    ds_read_b128 a[112:115], v40 offset:49408
    ds_read_b128 a[116:119], v41 offset:49408
    ds_read_b128 a[120:123], v42 offset:49408
    ds_read_b128 a[124:127], v43 offset:49408
    ds_read_b128 a[128:131], v40 offset:49664
    ds_read_b128 a[132:135], v41 offset:49664
    ds_read_b128 a[136:139], v42 offset:49664
    ds_read_b128 a[140:143], v43 offset:49664
    s_waitcnt lgkmcnt(11)
    v_mfma_f32_16x16x32_bf16 v[96:99], a[96:99], a[96:99], v[84:87]
    ds_read_b64_tr_b16 a[144:145], v44 offset:49152
    ds_read_b64_tr_b16 a[146:147], v48 offset:49408
    v_mfma_f32_16x16x32_bf16 v[100:103], a[96:99], a[48:51], 0
    ds_read_b64_tr_b16 a[148:149], v45 offset:49152
    ds_read_b64_tr_b16 a[150:151], v49 offset:49408
    s_waitcnt lgkmcnt(14)
    v_mfma_f32_16x16x32_bf16 v[96:99], a[100:103], a[100:103], v[96:99]
    ds_read_b64_tr_b16 a[152:153], v46 offset:49152
    ds_read_b64_tr_b16 a[154:155], v50 offset:49408
    v_mfma_f32_16x16x32_bf16 v[100:103], a[100:103], a[52:55], v[100:103]
    ds_read_b64_tr_b16 a[156:157], v47 offset:49152
    ds_read_b64_tr_b16 a[158:159], v51 offset:49408
    s_waitcnt lgkmcnt(15)
    v_mfma_f32_16x16x32_bf16 v[96:99], a[104:107], a[104:107], v[96:99]
    ds_read_b64_tr_b16 a[160:161], v48 offset:49152
    ds_read_b64_tr_b16 a[162:163], v44 offset:49664
    v_mfma_f32_16x16x32_bf16 v[100:103], a[104:107], a[56:59], v[100:103]
    ds_read_b64_tr_b16 a[164:165], v49 offset:49152
    ds_read_b64_tr_b16 a[166:167], v45 offset:49664
    v_mfma_f32_16x16x32_bf16 v[96:99], a[108:111], a[108:111], v[96:99]
    ds_read_b64_tr_b16 a[168:169], v50 offset:49152
    ds_read_b64_tr_b16 a[170:171], v46 offset:49664
    v_mfma_f32_16x16x32_bf16 v[100:103], a[108:111], a[60:63], v[100:103]
    ds_read_b64_tr_b16 a[172:173], v51 offset:49152
    ds_read_b64_tr_b16 a[174:175], v47 offset:49664
    v_mfma_f32_16x16x32_bf16 v[96:99], a[112:115], a[112:115], v[96:99]
    ds_read_b64_tr_b16 a[176:177], v44 offset:49408
    ds_read_b64_tr_b16 a[178:179], v48 offset:49664
    v_mfma_f32_16x16x32_bf16 v[100:103], a[112:115], a[64:67], v[100:103]
    ds_read_b64_tr_b16 a[180:181], v45 offset:49408
    ds_read_b64_tr_b16 a[182:183], v49 offset:49664
    s_waitcnt lgkmcnt(15)
    v_mfma_f32_16x16x32_bf16 v[96:99], a[116:119], a[116:119], v[96:99]
    ds_read_b64_tr_b16 a[184:185], v46 offset:49408
    ds_read_b64_tr_b16 a[186:187], v50 offset:49664
    v_mfma_f32_16x16x32_bf16 v[100:103], a[116:119], a[68:71], v[100:103]
    ds_read_b64_tr_b16 a[188:189], v47 offset:49408
    ds_read_b64_tr_b16 a[190:191], v51 offset:49664
    v_mfma_f32_16x16x32_bf16 v[92:95], a[96:99], v[52:55], v[80:83]
    v_mfma_f32_16x16x32_bf16 v[92:95], a[100:103], v[52:55], v[92:95]
    v_mfma_f32_16x16x32_bf16 v[92:95], a[104:107], v[52:55], v[92:95]
    v_mfma_f32_16x16x32_bf16 v[92:95], a[108:111], v[52:55], v[92:95]
    s_nop 1
    v_fma_f32 v96, v100, 2.0, v96
    v_fma_f32 v97, v101, 2.0, v97
    v_mfma_f32_16x16x32_bf16 v[92:95], a[112:115], v[52:55], v[92:95]
    v_fma_f32 v98, v102, 2.0, v98
    v_fma_f32 v99, v103, 2.0, v99
    v_mfma_f32_16x16x32_bf16 v[92:95], a[116:119], v[52:55], v[92:95]
    v_cndmask_b32 v3, 0, v96, s[44:45]
    v_cndmask_b32 v3, v3, v97, s[46:47]
    v_mfma_f32_16x16x32_bf16 v[88:91], a[96:99], v[136:139], v[76:79]
    v_cndmask_b32 v3, v3, v98, s[48:49]
    v_cndmask_b32 v3, v3, v99, s[50:51]
    v_mfma_f32_16x16x32_bf16 v[88:91], a[100:103], v[140:143], v[88:91]
    s_nop 0
    s_nop 0
    v_mfma_f32_16x16x32_bf16 v[88:91], a[104:107], v[144:147], v[88:91]
    v_mfma_f32_16x16x4_f32 v[120:123], v3, v60, v[56:59]
    v_mfma_f32_16x16x32_bf16 v[88:91], a[108:111], v[148:151], v[88:91]
    v_mfma_f32_16x16x32_bf16 v[88:91], a[112:115], v[152:155], v[88:91]
    v_mfma_f32_16x16x32_bf16 v[88:91], a[116:119], v[156:159], v[88:91]
    s_waitcnt lgkmcnt(0)
    v_mfma_f32_16x16x32_bf16 v[112:115], a[120:123], a[120:123], v[84:87]
    v_mfma_f32_16x16x32_bf16 v[116:119], a[120:123], a[48:51], 0
    v_mfma_f32_16x16x32_bf16 v[112:115], a[124:127], a[124:127], v[112:115]
    v_mfma_f32_16x16x32_bf16 v[116:119], a[124:127], a[52:55], v[116:119]
    s_nop 1
    v_fma_f32 v128, -v92, v92, v120
    v_fma_f32 v129, -v93, v93, v121
    v_mfma_f32_16x16x32_bf16 v[112:115], a[128:131], a[128:131], v[112:115]
    v_fma_f32 v130, -v94, v94, v122
    v_fma_f32 v131, -v95, v95, v123
    v_mfma_f32_16x16x32_bf16 v[116:119], a[128:131], a[56:59], v[116:119]
    v_max_f32 v128, v128, v56
    v_max_f32 v129, v129, v56
    v_mfma_f32_16x16x32_bf16 v[112:115], a[132:135], a[132:135], v[112:115]
    v_max_f32 v130, v130, v56
    v_max_f32 v131, v131, v56
    v_mfma_f32_16x16x32_bf16 v[116:119], a[132:135], a[60:63], v[116:119]
    v_rsq_f32 v128, v128
    v_mfma_f32_16x16x32_bf16 v[112:115], a[136:139], a[136:139], v[112:115]
    v_rsq_f32 v129, v129
    v_mfma_f32_16x16x32_bf16 v[116:119], a[136:139], a[64:67], v[116:119]
    v_rsq_f32 v130, v130
    v_mfma_f32_16x16x32_bf16 v[112:115], a[140:143], a[140:143], v[112:115]
    v_rsq_f32 v131, v131
    v_mfma_f32_16x16x32_bf16 v[116:119], a[140:143], a[68:71], v[116:119]
    v_fma_f32 v88, -v92, v61, v88
    v_fma_f32 v89, -v93, v61, v89
    v_mfma_f32_16x16x32_bf16 v[108:111], a[120:123], v[52:55], v[80:83]
    v_fma_f32 v90, -v94, v61, v90
    v_fma_f32 v91, -v95, v61, v91
    v_mfma_f32_16x16x32_bf16 v[108:111], a[124:127], v[52:55], v[108:111]
    v_fma_f32 v88, v88, v128, v62
    v_fma_f32 v89, v89, v129, v62
    v_mfma_f32_16x16x32_bf16 v[108:111], a[128:131], v[52:55], v[108:111]
    v_fma_f32 v90, v90, v130, v62
    v_fma_f32 v91, v91, v131, v62
    v_mfma_f32_16x16x32_bf16 v[108:111], a[132:135], v[52:55], v[108:111]
    v_max3_f32 v1, v88, v89, v90
    v_max_f32 v1, v1, v91
    v_mfma_f32_16x16x32_bf16 v[108:111], a[136:139], v[52:55], v[108:111]
    v_cmp_lt_f32 vcc, s52, v1
    s_cbranch_vccnz L_site9
L_back9:
    v_mfma_f32_16x16x32_bf16 v[108:111], a[140:143], v[52:55], v[108:111]
    v_exp_f32 v96, v88
    v_mfma_f32_16x16x32_bf16 v[104:107], a[120:123], v[136:139], v[76:79]
    v_exp_f32 v97, v89
    v_mfma_f32_16x16x32_bf16 v[104:107], a[124:127], v[140:143], v[104:107]
    v_exp_f32 v98, v90
    v_mfma_f32_16x16x32_bf16 v[104:107], a[128:131], v[144:147], v[104:107]
    v_exp_f32 v99, v91
    v_mfma_f32_16x16x32_bf16 v[104:107], a[132:135], v[148:151], v[104:107]
    v_mul_f32 v88, v96, v128
    v_mul_f32 v89, v97, v129
    v_mfma_f32_16x16x32_bf16 v[104:107], a[136:139], v[152:155], v[104:107]
    v_mul_f32 v90, v98, v130
    v_mul_f32 v91, v99, v131
    v_mfma_f32_16x16x32_bf16 v[104:107], a[140:143], v[156:159], v[104:107]
    v_fma_f32 v112, v116, 2.0, v112
    v_fma_f32 v113, v117, 2.0, v113
    v_fma_f32 v114, v118, 2.0, v114
    v_fma_f32 v115, v119, 2.0, v115
    v_cndmask_b32 v4, 0, v112, s[44:45]
    v_cndmask_b32 v4, v4, v113, s[46:47]
    v_cndmask_b32 v4, v4, v114, s[48:49]
    v_cndmask_b32 v4, v4, v115, s[50:51]
    v_add_f32 v63, v63, v96
    v_fmac_f32 v64, v88, v92
    v_mfma_f32_16x16x4_f32 v[124:127], v4, v60, v[56:59]
    v_add_f32 v63, v63, v97
    v_fmac_f32 v64, v89, v93
    v_add_f32 v63, v63, v98
    v_fmac_f32 v64, v90, v94
    v_add_f32 v63, v63, v99
    v_fmac_f32 v64, v91, v95
    v_add_f32 v68, v68, v88
    v_add_f32 v69, v69, v89
    v_add_f32 v70, v70, v90
    v_add_f32 v71, v71, v91
    v_fma_f32 v132, -v108, v108, v124
    v_fma_f32 v133, -v109, v109, v125
    v_fma_f32 v134, -v110, v110, v126
    v_fma_f32 v135, -v111, v111, v127
    v_max_f32 v132, v132, v56
    v_max_f32 v133, v133, v56
    v_max_f32 v134, v134, v56
    v_max_f32 v135, v135, v56
    v_rsq_f32 v132, v132
    v_rsq_f32 v133, v133
    v_rsq_f32 v134, v134
    v_rsq_f32 v135, v135
    v_fma_f32 v104, -v108, v61, v104
    v_fma_f32 v105, -v109, v61, v105
    v_fma_f32 v106, -v110, v61, v106
    v_fma_f32 v107, -v111, v61, v107
    v_fma_f32 v104, v104, v132, v62
    v_fma_f32 v105, v105, v133, v62
    v_fma_f32 v106, v106, v134, v62
    v_fma_f32 v107, v107, v135, v62
    v_max3_f32 v1, v104, v105, v106
    v_max_f32 v1, v1, v107
    v_cmp_lt_f32 vcc, s52, v1
    s_cbranch_vccnz L_site10
L_back10:
    v_exp_f32 v112, v104
    v_exp_f32 v113, v105
    v_exp_f32 v114, v106
    v_exp_f32 v115, v107
    v_mul_f32 v104, v112, v132
    v_mul_f32 v105, v113, v133
    v_mul_f32 v106, v114, v134
    v_mul_f32 v107, v115, v135
    v_cvt_pk_bf16_f32 v72, v88, v89
    v_cvt_pk_bf16_f32 v73, v90, v91
    v_cvt_pk_bf16_f32 v74, v104, v105
    v_cvt_pk_bf16_f32 v75, v106, v107
    s_nop 1
    v_mfma_f32_16x16x32_bf16 a[0:3], a[144:147], v[72:75], a[0:3]
    v_add_f32 v68, v68, v104
    v_add_f32 v69, v69, v105
    v_mfma_f32_16x16x32_bf16 a[4:7], a[148:151], v[72:75], a[4:7]
    v_add_f32 v70, v70, v106
    v_add_f32 v71, v71, v107
    v_mfma_f32_16x16x32_bf16 a[8:11], a[152:155], v[72:75], a[8:11]
    v_cvt_pk_bf16_f32 v66, v68, v69
    v_cvt_pk_bf16_f32 v67, v70, v71
    v_mfma_f32_16x16x32_bf16 a[12:15], a[156:159], v[72:75], a[12:15]
    v_add_f32 v63, v63, v112
    v_fmac_f32 v64, v104, v108
    v_mfma_f32_16x16x32_bf16 a[16:19], a[160:163], v[72:75], a[16:19]
    v_add_f32 v63, v63, v113
    v_fmac_f32 v64, v105, v109
    v_mfma_f32_16x16x32_bf16 a[20:23], a[164:167], v[72:75], a[20:23]
    v_add_f32 v63, v63, v114
    v_fmac_f32 v64, v106, v110
    v_mfma_f32_16x16x32_bf16 a[24:27], a[168:171], v[72:75], a[24:27]
    v_add_f32 v63, v63, v115
    v_fmac_f32 v64, v107, v111
    v_mfma_f32_16x16x32_bf16 a[28:31], a[172:175], v[72:75], a[28:31]
    v_mfma_f32_16x16x32_bf16 a[32:35], a[176:179], v[72:75], a[32:35]
    v_mfma_f32_16x16x32_bf16 a[36:39], a[180:183], v[72:75], a[36:39]
    v_mfma_f32_16x16x32_bf16 a[40:43], a[184:187], v[72:75], a[40:43]
    v_mfma_f32_16x16x32_bf16 a[44:47], a[188:191], v[72:75], a[44:47]
    v_mfma_f32_16x16x16_bf16 a[0:3], a[72:73], v[66:67], a[0:3]
    v_mfma_f32_16x16x16_bf16 a[4:7], a[74:75], v[66:67], a[4:7]
    v_mfma_f32_16x16x16_bf16 a[8:11], a[76:77], v[66:67], a[8:11]
    v_mfma_f32_16x16x16_bf16 a[12:15], a[78:79], v[66:67], a[12:15]
    v_mfma_f32_16x16x16_bf16 a[16:19], a[80:81], v[66:67], a[16:19]
    v_mfma_f32_16x16x16_bf16 a[20:23], a[82:83], v[66:67], a[20:23]
    v_mfma_f32_16x16x16_bf16 a[24:27], a[84:85], v[66:67], a[24:27]
    v_mfma_f32_16x16x16_bf16 a[28:31], a[86:87], v[66:67], a[28:31]
    v_mfma_f32_16x16x16_bf16 a[32:35], a[88:89], v[66:67], a[32:35]
    v_mfma_f32_16x16x16_bf16 a[36:39], a[90:91], v[66:67], a[36:39]
    v_mfma_f32_16x16x16_bf16 a[40:43], a[92:93], v[66:67], a[40:43]
    v_mfma_f32_16x16x16_bf16 a[44:47], a[94:95], v[66:67], a[44:47]
    s_waitcnt vmcnt(19)
    ds_read_b128 a[48:51], v34 offset:0
    ds_read_b128 a[52:55], v35 offset:0
    ds_read_b128 a[56:59], v34 offset:128
    ds_read_b128 a[60:63], v35 offset:128
    ds_read_b128 a[64:67], v34 offset:256
    ds_read_b128 a[68:71], v35 offset:256
    s_waitcnt lgkmcnt(5)
    v_mfma_f32_16x16x32_bf16 v[84:87], a[48:51], a[48:51], 0
    ds_read_b64_tr_b16 a[72:73], v36 offset:0
    ds_read_b64_tr_b16 a[74:75], v37 offset:0
    v_mfma_f32_16x16x32_bf16 v[80:83], a[48:51], v[52:55], 0
    ds_read_b64_tr_b16 a[76:77], v38 offset:0
    ds_read_b64_tr_b16 a[78:79], v39 offset:0
    s_waitcnt lgkmcnt(8)
    v_mfma_f32_16x16x32_bf16 v[84:87], a[52:55], a[52:55], v[84:87]
    ds_read_b64_tr_b16 a[80:81], v36 offset:128
    ds_read_b64_tr_b16 a[82:83], v37 offset:128
    v_mfma_f32_16x16x32_bf16 v[80:83], a[52:55], v[52:55], v[80:83]
    ds_read_b64_tr_b16 a[84:85], v38 offset:128
    ds_read_b64_tr_b16 a[86:87], v39 offset:128
    s_waitcnt lgkmcnt(11)
    v_mfma_f32_16x16x32_bf16 v[84:87], a[56:59], a[56:59], v[84:87]
    ds_read_b64_tr_b16 a[88:89], v36 offset:256
    ds_read_b64_tr_b16 a[90:91], v37 offset:256
    v_mfma_f32_16x16x32_bf16 v[80:83], a[56:59], v[52:55], v[80:83]
    ds_read_b64_tr_b16 a[92:93], v38 offset:256
    ds_read_b64_tr_b16 a[94:95], v39 offset:256
    s_waitcnt lgkmcnt(14)
    v_mfma_f32_16x16x32_bf16 v[84:87], a[60:63], a[60:63], v[84:87]
    v_mfma_f32_16x16x32_bf16 v[80:83], a[60:63], v[52:55], v[80:83]
    s_waitcnt lgkmcnt(13)
    v_mfma_f32_16x16x32_bf16 v[84:87], a[64:67], a[64:67], v[84:87]
    v_mfma_f32_16x16x32_bf16 v[80:83], a[64:67], v[52:55], v[80:83]
    s_waitcnt lgkmcnt(12)
    v_mfma_f32_16x16x32_bf16 v[84:87], a[68:71], a[68:71], v[84:87]
    v_mfma_f32_16x16x32_bf16 v[80:83], a[68:71], v[52:55], v[80:83]
    s_waitcnt lgkmcnt(0)
    v_mfma_f32_16x16x32_bf16 v[76:79], a[48:51], v[136:139], 0
    v_mfma_f32_16x16x32_bf16 v[76:79], a[52:55], v[140:143], v[76:79]
    v_mfma_f32_16x16x32_bf16 v[76:79], a[56:59], v[144:147], v[76:79]
    v_mfma_f32_16x16x32_bf16 v[76:79], a[60:63], v[148:151], v[76:79]
    v_mfma_f32_16x16x32_bf16 v[76:79], a[64:67], v[152:155], v[76:79]
    v_mfma_f32_16x16x32_bf16 v[76:79], a[68:71], v[156:159], v[76:79]
    s_barrier
    s_add_u32 m0, s42, 0
    s_add_u32 s59, s37, 344064
    buffer_load_dwordx4 v22, s[24:27], s59 offen offset:0 nt lds
    buffer_load_dwordx4 v23, s[24:27], s59 offen offset:1024 nt lds
    buffer_load_dwordx4 v24, s[24:27], s59 offen offset:2048 nt lds
    buffer_load_dwordx4 v25, s[24:27], s59 offen offset:3072 nt lds
    s_add_u32 m0, s42, 4096
    s_nop 0
    buffer_load_dwordx4 v26, s[24:27], s59 offen offset:0 nt lds
    buffer_load_dwordx4 v27, s[24:27], s59 offen offset:1024 nt lds
    buffer_load_dwordx4 v28, s[24:27], s59 offen offset:2048 nt lds
    buffer_load_dwordx4 v29, s[24:27], s59 offen offset:3072 nt lds
    s_add_u32 m0, s42, 8192
    s_nop 0
    buffer_load_dwordx4 v30, s[24:27], s59 offen offset:0 nt lds
    buffer_load_dwordx4 v31, s[24:27], s59 offen offset:1024 nt lds
    buffer_load_dwordx4 v32, s[24:27], s59 offen offset:2048 nt lds
    buffer_load_dwordx4 v33, s[24:27], s59 offen offset:3072 nt lds
    s_waitcnt vmcnt(12)
    ds_read_b128 a[96:99], v40 offset:0
    ds_read_b128 a[100:103], v41 offset:0
    ds_read_b128 a[104:107], v42 offset:0
    ds_read_b128 a[108:111], v43 offset:0
    ds_read_b128 a[112:115], v40 offset:256
    ds_read_b128 a[116:119], v41 offset:256
    ds_read_b128 a[120:123], v42 offset:256
    ds_read_b128 a[124:127], v43 offset:256
    ds_read_b128 a[128:131], v40 offset:512
    ds_read_b128 a[132:135], v41 offset:512
    ds_read_b128 a[136:139], v42 offset:512
    ds_read_b128 a[140:143], v43 offset:512
    s_waitcnt lgkmcnt(11)
    v_mfma_f32_16x16x32_bf16 v[96:99], a[96:99], a[96:99], v[84:87]
    ds_read_b64_tr_b16 a[144:145], v44 offset:0
    ds_read_b64_tr_b16 a[146:147], v48 offset:256
    v_mfma_f32_16x16x32_bf16 v[100:103], a[96:99], a[48:51], 0
    ds_read_b64_tr_b16 a[148:149], v45 offset:0
    ds_read_b64_tr_b16 a[150:151], v49 offset:256
    s_waitcnt lgkmcnt(14)
    v_mfma_f32_16x16x32_bf16 v[96:99], a[100:103], a[100:103], v[96:99]
    ds_read_b64_tr_b16 a[152:153], v46 offset:0
    ds_read_b64_tr_b16 a[154:155], v50 offset:256
    v_mfma_f32_16x16x32_bf16 v[100:103], a[100:103], a[52:55], v[100:103]
    ds_read_b64_tr_b16 a[156:157], v47 offset:0
    ds_read_b64_tr_b16 a[158:159], v51 offset:256
    s_waitcnt lgkmcnt(15)
    v_mfma_f32_16x16x32_bf16 v[96:99], a[104:107], a[104:107], v[96:99]
    ds_read_b64_tr_b16 a[160:161], v48 offset:0
    ds_read_b64_tr_b16 a[162:163], v44 offset:512
    v_mfma_f32_16x16x32_bf16 v[100:103], a[104:107], a[56:59], v[100:103]
    ds_read_b64_tr_b16 a[164:165], v49 offset:0
    ds_read_b64_tr_b16 a[166:167], v45 offset:512
    v_mfma_f32_16x16x32_bf16 v[96:99], a[108:111], a[108:111], v[96:99]
    ds_read_b64_tr_b16 a[168:169], v50 offset:0
    ds_read_b64_tr_b16 a[170:171], v46 offset:512
    v_mfma_f32_16x16x32_bf16 v[100:103], a[108:111], a[60:63], v[100:103]
    ds_read_b64_tr_b16 a[172:173], v51 offset:0
    ds_read_b64_tr_b16 a[174:175], v47 offset:512
    v_mfma_f32_16x16x32_bf16 v[96:99], a[112:115], a[112:115], v[96:99]
    ds_read_b64_tr_b16 a[176:177], v44 offset:256
    ds_read_b64_tr_b16 a[178:179], v48 offset:512
    v_mfma_f32_16x16x32_bf16 v[100:103], a[112:115], a[64:67], v[100:103]
    ds_read_b64_tr_b16 a[180:181], v45 offset:256
    ds_read_b64_tr_b16 a[182:183], v49 offset:512
    s_waitcnt lgkmcnt(15)
    v_mfma_f32_16x16x32_bf16 v[96:99], a[116:119], a[116:119], v[96:99]
    ds_read_b64_tr_b16 a[184:185], v46 offset:256
    ds_read_b64_tr_b16 a[186:187], v50 offset:512
    v_mfma_f32_16x16x32_bf16 v[100:103], a[116:119], a[68:71], v[100:103]
    ds_read_b64_tr_b16 a[188:189], v47 offset:256
    ds_read_b64_tr_b16 a[190:191], v51 offset:512
    v_mfma_f32_16x16x32_bf16 v[92:95], a[96:99], v[52:55], v[80:83]
    v_mfma_f32_16x16x32_bf16 v[92:95], a[100:103], v[52:55], v[92:95]
    v_mfma_f32_16x16x32_bf16 v[92:95], a[104:107], v[52:55], v[92:95]
    v_mfma_f32_16x16x32_bf16 v[92:95], a[108:111], v[52:55], v[92:95]
    s_nop 1
    v_fma_f32 v96, v100, 2.0, v96
    v_fma_f32 v97, v101, 2.0, v97
    v_mfma_f32_16x16x32_bf16 v[92:95], a[112:115], v[52:55], v[92:95]
    v_fma_f32 v98, v102, 2.0, v98
    v_fma_f32 v99, v103, 2.0, v99
    v_mfma_f32_16x16x32_bf16 v[92:95], a[116:119], v[52:55], v[92:95]
    v_cndmask_b32 v3, 0, v96, s[44:45]
    v_cndmask_b32 v3, v3, v97, s[46:47]
    v_mfma_f32_16x16x32_bf16 v[88:91], a[96:99], v[136:139], v[76:79]
    v_cndmask_b32 v3, v3, v98, s[48:49]
    v_cndmask_b32 v3, v3, v99, s[50:51]
    v_mfma_f32_16x16x32_bf16 v[88:91], a[100:103], v[140:143], v[88:91]
    s_nop 0
    s_nop 0
    v_mfma_f32_16x16x32_bf16 v[88:91], a[104:107], v[144:147], v[88:91]
    v_mfma_f32_16x16x4_f32 v[120:123], v3, v60, v[56:59]
    v_mfma_f32_16x16x32_bf16 v[88:91], a[108:111], v[148:151], v[88:91]
    v_mfma_f32_16x16x32_bf16 v[88:91], a[112:115], v[152:155], v[88:91]
    v_mfma_f32_16x16x32_bf16 v[88:91], a[116:119], v[156:159], v[88:91]
    s_waitcnt lgkmcnt(0)
    v_mfma_f32_16x16x32_bf16 v[112:115], a[120:123], a[120:123], v[84:87]
    v_mfma_f32_16x16x32_bf16 v[116:119], a[120:123], a[48:51], 0
    v_mfma_f32_16x16x32_bf16 v[112:115], a[124:127], a[124:127], v[112:115]
    v_mfma_f32_16x16x32_bf16 v[116:119], a[124:127], a[52:55], v[116:119]
    s_nop 1
    v_fma_f32 v128, -v92, v92, v120
    v_fma_f32 v129, -v93, v93, v121
    v_mfma_f32_16x16x32_bf16 v[112:115], a[128:131], a[128:131], v[112:115]
    v_fma_f32 v130, -v94, v94, v122
    v_fma_f32 v131, -v95, v95, v123
    v_mfma_f32_16x16x32_bf16 v[116:119], a[128:131], a[56:59], v[116:119]
    v_max_f32 v128, v128, v56
    v_max_f32 v129, v129, v56
    v_mfma_f32_16x16x32_bf16 v[112:115], a[132:135], a[132:135], v[112:115]
    v_max_f32 v130, v130, v56
    v_max_f32 v131, v131, v56
    v_mfma_f32_16x16x32_bf16 v[116:119], a[132:135], a[60:63], v[116:119]
    v_rsq_f32 v128, v128
    v_mfma_f32_16x16x32_bf16 v[112:115], a[136:139], a[136:139], v[112:115]
    v_rsq_f32 v129, v129
    v_mfma_f32_16x16x32_bf16 v[116:119], a[136:139], a[64:67], v[116:119]
    v_rsq_f32 v130, v130
    v_mfma_f32_16x16x32_bf16 v[112:115], a[140:143], a[140:143], v[112:115]
    v_rsq_f32 v131, v131
    v_mfma_f32_16x16x32_bf16 v[116:119], a[140:143], a[68:71], v[116:119]
    v_fma_f32 v88, -v92, v61, v88
    v_fma_f32 v89, -v93, v61, v89
    v_mfma_f32_16x16x32_bf16 v[108:111], a[120:123], v[52:55], v[80:83]
    v_fma_f32 v90, -v94, v61, v90
    v_fma_f32 v91, -v95, v61, v91
    v_mfma_f32_16x16x32_bf16 v[108:111], a[124:127], v[52:55], v[108:111]
    v_fma_f32 v88, v88, v128, v62
    v_fma_f32 v89, v89, v129, v62
    v_mfma_f32_16x16x32_bf16 v[108:111], a[128:131], v[52:55], v[108:111]
    v_fma_f32 v90, v90, v130, v62
    v_fma_f32 v91, v91, v131, v62
    v_mfma_f32_16x16x32_bf16 v[108:111], a[132:135], v[52:55], v[108:111]
    v_max3_f32 v1, v88, v89, v90
    v_max_f32 v1, v1, v91
    v_mfma_f32_16x16x32_bf16 v[108:111], a[136:139], v[52:55], v[108:111]
    v_cmp_lt_f32 vcc, s52, v1
    s_cbranch_vccnz L_site11
L_back11:
    v_mfma_f32_16x16x32_bf16 v[108:111], a[140:143], v[52:55], v[108:111]
    v_exp_f32 v96, v88
    v_mfma_f32_16x16x32_bf16 v[104:107], a[120:123], v[136:139], v[76:79]
    v_exp_f32 v97, v89
    v_mfma_f32_16x16x32_bf16 v[104:107], a[124:127], v[140:143], v[104:107]
    v_exp_f32 v98, v90
    v_mfma_f32_16x16x32_bf16 v[104:107], a[128:131], v[144:147], v[104:107]
    v_exp_f32 v99, v91
    v_mfma_f32_16x16x32_bf16 v[104:107], a[132:135], v[148:151], v[104:107]
    v_mul_f32 v88, v96, v128
    v_mul_f32 v89, v97, v129
    v_mfma_f32_16x16x32_bf16 v[104:107], a[136:139], v[152:155], v[104:107]
    v_mul_f32 v90, v98, v130
    v_mul_f32 v91, v99, v131
    v_mfma_f32_16x16x32_bf16 v[104:107], a[140:143], v[156:159], v[104:107]
    v_fma_f32 v112, v116, 2.0, v112
    v_fma_f32 v113, v117, 2.0, v113
    v_fma_f32 v114, v118, 2.0, v114
    v_fma_f32 v115, v119, 2.0, v115
    v_cndmask_b32 v4, 0, v112, s[44:45]
    v_cndmask_b32 v4, v4, v113, s[46:47]
    v_cndmask_b32 v4, v4, v114, s[48:49]
    v_cndmask_b32 v4, v4, v115, s[50:51]
    v_add_f32 v63, v63, v96
    v_fmac_f32 v64, v88, v92
    v_mfma_f32_16x16x4_f32 v[124:127], v4, v60, v[56:59]
    v_add_f32 v63, v63, v97
    v_fmac_f32 v64, v89, v93
    v_add_f32 v63, v63, v98
    v_fmac_f32 v64, v90, v94
    v_add_f32 v63, v63, v99
    v_fmac_f32 v64, v91, v95
    v_mov_b32 v68, v88
    v_mov_b32 v69, v89
    v_mov_b32 v70, v90
    v_mov_b32 v71, v91
    v_fma_f32 v132, -v108, v108, v124
    v_fma_f32 v133, -v109, v109, v125
    v_fma_f32 v134, -v110, v110, v126
    v_fma_f32 v135, -v111, v111, v127
    v_max_f32 v132, v132, v56
    v_max_f32 v133, v133, v56
    v_max_f32 v134, v134, v56
    v_max_f32 v135, v135, v56
    v_rsq_f32 v132, v132
    v_rsq_f32 v133, v133
    v_rsq_f32 v134, v134
    v_rsq_f32 v135, v135
    v_fma_f32 v104, -v108, v61, v104
    v_fma_f32 v105, -v109, v61, v105
    v_fma_f32 v106, -v110, v61, v106
    v_fma_f32 v107, -v111, v61, v107
    v_fma_f32 v104, v104, v132, v62
    v_fma_f32 v105, v105, v133, v62
    v_fma_f32 v106, v106, v134, v62
    v_fma_f32 v107, v107, v135, v62
    v_max3_f32 v1, v104, v105, v106
    v_max_f32 v1, v1, v107
    v_cmp_lt_f32 vcc, s52, v1
    s_cbranch_vccnz L_site12
L_back12:
    v_exp_f32 v112, v104
    v_exp_f32 v113, v105
    v_exp_f32 v114, v106
    v_exp_f32 v115, v107
    v_mul_f32 v104, v112, v132
    v_mul_f32 v105, v113, v133
    v_mul_f32 v106, v114, v134
    v_mul_f32 v107, v115, v135
    v_cvt_pk_bf16_f32 v72, v88, v89
    v_cvt_pk_bf16_f32 v73, v90, v91
    v_cvt_pk_bf16_f32 v74, v104, v105
    v_cvt_pk_bf16_f32 v75, v106, v107
    s_nop 1
    v_mfma_f32_16x16x32_bf16 a[0:3], a[144:147], v[72:75], a[0:3]
    v_add_f32 v63, v63, v112
    v_fmac_f32 v64, v104, v108
    v_mfma_f32_16x16x32_bf16 a[4:7], a[148:151], v[72:75], a[4:7]
    v_add_f32 v63, v63, v113
    v_fmac_f32 v64, v105, v109
    v_mfma_f32_16x16x32_bf16 a[8:11], a[152:155], v[72:75], a[8:11]
    v_add_f32 v63, v63, v114
    v_fmac_f32 v64, v106, v110
    v_mfma_f32_16x16x32_bf16 a[12:15], a[156:159], v[72:75], a[12:15]
    v_add_f32 v63, v63, v115
    v_fmac_f32 v64, v107, v111
    v_mfma_f32_16x16x32_bf16 a[16:19], a[160:163], v[72:75], a[16:19]
    v_add_f32 v68, v68, v104
    v_add_f32 v69, v69, v105
    v_mfma_f32_16x16x32_bf16 a[20:23], a[164:167], v[72:75], a[20:23]
    v_add_f32 v70, v70, v106
    v_add_f32 v71, v71, v107
    v_mfma_f32_16x16x32_bf16 a[24:27], a[168:171], v[72:75], a[24:27]
    v_mfma_f32_16x16x32_bf16 a[28:31], a[172:175], v[72:75], a[28:31]
    v_mfma_f32_16x16x32_bf16 a[32:35], a[176:179], v[72:75], a[32:35]
    v_mfma_f32_16x16x32_bf16 a[36:39], a[180:183], v[72:75], a[36:39]
    v_mfma_f32_16x16x32_bf16 a[40:43], a[184:187], v[72:75], a[40:43]
    v_mfma_f32_16x16x32_bf16 a[44:47], a[188:191], v[72:75], a[44:47]
    s_waitcnt vmcnt(0)
    ds_read_b128 a[96:99], v40 offset:49152
    ds_read_b128 a[100:103], v41 offset:49152
    ds_read_b128 a[104:107], v42 offset:49152
    ds_read_b128 a[108:111], v43 offset:49152
    ds_read_b128 a[112:115], v40 offset:49408
    ds_read_b128 a[116:119], v41 offset:49408
    ds_read_b128 a[120:123], v42 offset:49408
    ds_read_b128 a[124:127], v43 offset:49408
    ds_read_b128 a[128:131], v40 offset:49664
    ds_read_b128 a[132:135], v41 offset:49664
    ds_read_b128 a[136:139], v42 offset:49664
    ds_read_b128 a[140:143], v43 offset:49664
    s_waitcnt lgkmcnt(11)
    v_mfma_f32_16x16x32_bf16 v[96:99], a[96:99], a[96:99], v[84:87]
    ds_read_b64_tr_b16 a[144:145], v44 offset:49152
    ds_read_b64_tr_b16 a[146:147], v48 offset:49408
    v_mfma_f32_16x16x32_bf16 v[100:103], a[96:99], a[48:51], 0
    ds_read_b64_tr_b16 a[148:149], v45 offset:49152
    ds_read_b64_tr_b16 a[150:151], v49 offset:49408
    s_waitcnt lgkmcnt(14)
    v_mfma_f32_16x16x32_bf16 v[96:99], a[100:103], a[100:103], v[96:99]
    ds_read_b64_tr_b16 a[152:153], v46 offset:49152
    ds_read_b64_tr_b16 a[154:155], v50 offset:49408
    v_mfma_f32_16x16x32_bf16 v[100:103], a[100:103], a[52:55], v[100:103]
    ds_read_b64_tr_b16 a[156:157], v47 offset:49152
    ds_read_b64_tr_b16 a[158:159], v51 offset:49408
    s_waitcnt lgkmcnt(15)
    v_mfma_f32_16x16x32_bf16 v[96:99], a[104:107], a[104:107], v[96:99]
    ds_read_b64_tr_b16 a[160:161], v48 offset:49152
    ds_read_b64_tr_b16 a[162:163], v44 offset:49664
    v_mfma_f32_16x16x32_bf16 v[100:103], a[104:107], a[56:59], v[100:103]
    ds_read_b64_tr_b16 a[164:165], v49 offset:49152
    ds_read_b64_tr_b16 a[166:167], v45 offset:49664
    v_mfma_f32_16x16x32_bf16 v[96:99], a[108:111], a[108:111], v[96:99]
    ds_read_b64_tr_b16 a[168:169], v50 offset:49152
    ds_read_b64_tr_b16 a[170:171], v46 offset:49664
    v_mfma_f32_16x16x32_bf16 v[100:103], a[108:111], a[60:63], v[100:103]
    ds_read_b64_tr_b16 a[172:173], v51 offset:49152
    ds_read_b64_tr_b16 a[174:175], v47 offset:49664
    v_mfma_f32_16x16x32_bf16 v[96:99], a[112:115], a[112:115], v[96:99]
    ds_read_b64_tr_b16 a[176:177], v44 offset:49408
    ds_read_b64_tr_b16 a[178:179], v48 offset:49664
    v_mfma_f32_16x16x32_bf16 v[100:103], a[112:115], a[64:67], v[100:103]
    ds_read_b64_tr_b16 a[180:181], v45 offset:49408
    ds_read_b64_tr_b16 a[182:183], v49 offset:49664
    s_waitcnt lgkmcnt(15)
    v_mfma_f32_16x16x32_bf16 v[96:99], a[116:119], a[116:119], v[96:99]
    ds_read_b64_tr_b16 a[184:185], v46 offset:49408
    ds_read_b64_tr_b16 a[186:187], v50 offset:49664
    v_mfma_f32_16x16x32_bf16 v[100:103], a[116:119], a[68:71], v[100:103]
    ds_read_b64_tr_b16 a[188:189], v47 offset:49408
    ds_read_b64_tr_b16 a[190:191], v51 offset:49664
    v_mfma_f32_16x16x32_bf16 v[92:95], a[96:99], v[52:55], v[80:83]
    v_mfma_f32_16x16x32_bf16 v[92:95], a[100:103], v[52:55], v[92:95]
    v_mfma_f32_16x16x32_bf16 v[92:95], a[104:107], v[52:55], v[92:95]
    v_mfma_f32_16x16x32_bf16 v[92:95], a[108:111], v[52:55], v[92:95]
    s_nop 1
    v_fma_f32 v96, v100, 2.0, v96
    v_fma_f32 v97, v101, 2.0, v97
    v_mfma_f32_16x16x32_bf16 v[92:95], a[112:115], v[52:55], v[92:95]
    v_fma_f32 v98, v102, 2.0, v98
    v_fma_f32 v99, v103, 2.0, v99
    v_mfma_f32_16x16x32_bf16 v[92:95], a[116:119], v[52:55], v[92:95]
    v_cndmask_b32 v3, 0, v96, s[44:45]
    v_cndmask_b32 v3, v3, v97, s[46:47]
    v_mfma_f32_16x16x32_bf16 v[88:91], a[96:99], v[136:139], v[76:79]
    v_cndmask_b32 v3, v3, v98, s[48:49]
    v_cndmask_b32 v3, v3, v99, s[50:51]
    v_mfma_f32_16x16x32_bf16 v[88:91], a[100:103], v[140:143], v[88:91]
    s_nop 0
    s_nop 0
    v_mfma_f32_16x16x32_bf16 v[88:91], a[104:107], v[144:147], v[88:91]
    v_mfma_f32_16x16x4_f32 v[120:123], v3, v60, v[56:59]
    v_mfma_f32_16x16x32_bf16 v[88:91], a[108:111], v[148:151], v[88:91]
    v_mfma_f32_16x16x32_bf16 v[88:91], a[112:115], v[152:155], v[88:91]
    v_mfma_f32_16x16x32_bf16 v[88:91], a[116:119], v[156:159], v[88:91]
    s_waitcnt lgkmcnt(0)
    v_mfma_f32_16x16x32_bf16 v[112:115], a[120:123], a[120:123], v[84:87]
    v_mfma_f32_16x16x32_bf16 v[116:119], a[120:123], a[48:51], 0
    v_mfma_f32_16x16x32_bf16 v[112:115], a[124:127], a[124:127], v[112:115]
    v_mfma_f32_16x16x32_bf16 v[116:119], a[124:127], a[52:55], v[116:119]
    s_nop 1
    v_fma_f32 v128, -v92, v92, v120
    v_fma_f32 v129, -v93, v93, v121
    v_mfma_f32_16x16x32_bf16 v[112:115], a[128:131], a[128:131], v[112:115]
    v_fma_f32 v130, -v94, v94, v122
    v_fma_f32 v131, -v95, v95, v123
    v_mfma_f32_16x16x32_bf16 v[116:119], a[128:131], a[56:59], v[116:119]
    v_max_f32 v128, v128, v56
    v_max_f32 v129, v129, v56
    v_mfma_f32_16x16x32_bf16 v[112:115], a[132:135], a[132:135], v[112:115]
    v_max_f32 v130, v130, v56
    v_max_f32 v131, v131, v56
    v_mfma_f32_16x16x32_bf16 v[116:119], a[132:135], a[60:63], v[116:119]
    v_rsq_f32 v128, v128
    v_mfma_f32_16x16x32_bf16 v[112:115], a[136:139], a[136:139], v[112:115]
    v_rsq_f32 v129, v129
    v_mfma_f32_16x16x32_bf16 v[116:119], a[136:139], a[64:67], v[116:119]
    v_rsq_f32 v130, v130
    v_mfma_f32_16x16x32_bf16 v[112:115], a[140:143], a[140:143], v[112:115]
    v_rsq_f32 v131, v131
    v_mfma_f32_16x16x32_bf16 v[116:119], a[140:143], a[68:71], v[116:119]
    v_fma_f32 v88, -v92, v61, v88
    v_fma_f32 v89, -v93, v61, v89
    v_mfma_f32_16x16x32_bf16 v[108:111], a[120:123], v[52:55], v[80:83]
    v_fma_f32 v90, -v94, v61, v90
    v_fma_f32 v91, -v95, v61, v91
    v_mfma_f32_16x16x32_bf16 v[108:111], a[124:127], v[52:55], v[108:111]
    v_fma_f32 v88, v88, v128, v62
    v_fma_f32 v89, v89, v129, v62
    v_mfma_f32_16x16x32_bf16 v[108:111], a[128:131], v[52:55], v[108:111]
    v_fma_f32 v90, v90, v130, v62
    v_fma_f32 v91, v91, v131, v62
    v_mfma_f32_16x16x32_bf16 v[108:111], a[132:135], v[52:55], v[108:111]
    v_max3_f32 v1, v88, v89, v90
    v_max_f32 v1, v1, v91
    v_mfma_f32_16x16x32_bf16 v[108:111], a[136:139], v[52:55], v[108:111]
    v_cmp_lt_f32 vcc, s52, v1
    s_cbranch_vccnz L_site13
L_back13:
    v_mfma_f32_16x16x32_bf16 v[108:111], a[140:143], v[52:55], v[108:111]
    v_exp_f32 v96, v88
    v_mfma_f32_16x16x32_bf16 v[104:107], a[120:123], v[136:139], v[76:79]
    v_exp_f32 v97, v89
    v_mfma_f32_16x16x32_bf16 v[104:107], a[124:127], v[140:143], v[104:107]
    v_exp_f32 v98, v90
    v_mfma_f32_16x16x32_bf16 v[104:107], a[128:131], v[144:147], v[104:107]
    v_exp_f32 v99, v91
    v_mfma_f32_16x16x32_bf16 v[104:107], a[132:135], v[148:151], v[104:107]
    v_mul_f32 v88, v96, v128
    v_mul_f32 v89, v97, v129
    v_mfma_f32_16x16x32_bf16 v[104:107], a[136:139], v[152:155], v[104:107]
    v_mul_f32 v90, v98, v130
    v_mul_f32 v91, v99, v131
    v_mfma_f32_16x16x32_bf16 v[104:107], a[140:143], v[156:159], v[104:107]
    v_fma_f32 v112, v116, 2.0, v112
    v_fma_f32 v113, v117, 2.0, v113
    v_fma_f32 v114, v118, 2.0, v114
    v_fma_f32 v115, v119, 2.0, v115
    v_cndmask_b32 v4, 0, v112, s[44:45]
    v_cndmask_b32 v4, v4, v113, s[46:47]
    v_cndmask_b32 v4, v4, v114, s[48:49]
    v_cndmask_b32 v4, v4, v115, s[50:51]
    v_add_f32 v63, v63, v96
    v_fmac_f32 v64, v88, v92
    v_mfma_f32_16x16x4_f32 v[124:127], v4, v60, v[56:59]
    v_add_f32 v63, v63, v97
    v_fmac_f32 v64, v89, v93
    v_add_f32 v63, v63, v98
    v_fmac_f32 v64, v90, v94
    v_add_f32 v63, v63, v99
    v_fmac_f32 v64, v91, v95
    v_add_f32 v68, v68, v88
    v_add_f32 v69, v69, v89
    v_add_f32 v70, v70, v90
    v_add_f32 v71, v71, v91
    v_fma_f32 v132, -v108, v108, v124
    v_fma_f32 v133, -v109, v109, v125
    v_fma_f32 v134, -v110, v110, v126
    v_fma_f32 v135, -v111, v111, v127
    v_max_f32 v132, v132, v56
    v_max_f32 v133, v133, v56
    v_max_f32 v134, v134, v56
    v_max_f32 v135, v135, v56
    v_rsq_f32 v132, v132
    v_rsq_f32 v133, v133
    v_rsq_f32 v134, v134
    v_rsq_f32 v135, v135
    v_fma_f32 v104, -v108, v61, v104
    v_fma_f32 v105, -v109, v61, v105
    v_fma_f32 v106, -v110, v61, v106
    v_fma_f32 v107, -v111, v61, v107
    v_fma_f32 v104, v104, v132, v62
    v_fma_f32 v105, v105, v133, v62
    v_fma_f32 v106, v106, v134, v62
    v_fma_f32 v107, v107, v135, v62
    v_max3_f32 v1, v104, v105, v106
    v_max_f32 v1, v1, v107
    v_cmp_lt_f32 vcc, s52, v1
    s_cbranch_vccnz L_site14
L_back14:
    v_exp_f32 v112, v104
    v_exp_f32 v113, v105
    v_exp_f32 v114, v106
    v_exp_f32 v115, v107
    v_mul_f32 v104, v112, v132
    v_mul_f32 v105, v113, v133
    v_mul_f32 v106, v114, v134
    v_mul_f32 v107, v115, v135
    v_cvt_pk_bf16_f32 v72, v88, v89
    v_cvt_pk_bf16_f32 v73, v90, v91
    v_cvt_pk_bf16_f32 v74, v104, v105
    v_cvt_pk_bf16_f32 v75, v106, v107
    s_nop 1
    v_mfma_f32_16x16x32_bf16 a[0:3], a[144:147], v[72:75], a[0:3]
    v_add_f32 v68, v68, v104
    v_add_f32 v69, v69, v105
    v_mfma_f32_16x16x32_bf16 a[4:7], a[148:151], v[72:75], a[4:7]
    v_add_f32 v70, v70, v106
    v_add_f32 v71, v71, v107
    v_mfma_f32_16x16x32_bf16 a[8:11], a[152:155], v[72:75], a[8:11]
    v_cvt_pk_bf16_f32 v66, v68, v69
    v_cvt_pk_bf16_f32 v67, v70, v71
    v_mfma_f32_16x16x32_bf16 a[12:15], a[156:159], v[72:75], a[12:15]
    v_add_f32 v63, v63, v112
    v_fmac_f32 v64, v104, v108
    v_mfma_f32_16x16x32_bf16 a[16:19], a[160:163], v[72:75], a[16:19]
    v_add_f32 v63, v63, v113
    v_fmac_f32 v64, v105, v109
    v_mfma_f32_16x16x32_bf16 a[20:23], a[164:167], v[72:75], a[20:23]
    v_add_f32 v63, v63, v114
    v_fmac_f32 v64, v106, v110
    v_mfma_f32_16x16x32_bf16 a[24:27], a[168:171], v[72:75], a[24:27]
    v_add_f32 v63, v63, v115
    v_fmac_f32 v64, v107, v111
    v_mfma_f32_16x16x32_bf16 a[28:31], a[172:175], v[72:75], a[28:31]
    v_mfma_f32_16x16x32_bf16 a[32:35], a[176:179], v[72:75], a[32:35]
    v_mfma_f32_16x16x32_bf16 a[36:39], a[180:183], v[72:75], a[36:39]
    v_mfma_f32_16x16x32_bf16 a[40:43], a[184:187], v[72:75], a[40:43]
    v_mfma_f32_16x16x32_bf16 a[44:47], a[188:191], v[72:75], a[44:47]
    v_mfma_f32_16x16x16_bf16 a[0:3], a[72:73], v[66:67], a[0:3]
    v_mfma_f32_16x16x16_bf16 a[4:7], a[74:75], v[66:67], a[4:7]
    v_mfma_f32_16x16x16_bf16 a[8:11], a[76:77], v[66:67], a[8:11]
    v_mfma_f32_16x16x16_bf16 a[12:15], a[78:79], v[66:67], a[12:15]
    v_mfma_f32_16x16x16_bf16 a[16:19], a[80:81], v[66:67], a[16:19]
    v_mfma_f32_16x16x16_bf16 a[20:23], a[82:83], v[66:67], a[20:23]
    v_mfma_f32_16x16x16_bf16 a[24:27], a[84:85], v[66:67], a[24:27]
    v_mfma_f32_16x16x16_bf16 a[28:31], a[86:87], v[66:67], a[28:31]
    v_mfma_f32_16x16x16_bf16 a[32:35], a[88:89], v[66:67], a[32:35]
    v_mfma_f32_16x16x16_bf16 a[36:39], a[90:91], v[66:67], a[36:39]
    v_mfma_f32_16x16x16_bf16 a[40:43], a[92:93], v[66:67], a[40:43]
    v_mfma_f32_16x16x16_bf16 a[44:47], a[94:95], v[66:67], a[44:47]
    s_lshl_b32 s56, s3, 17
    s_lshl_b32 s57, s2, 7
    s_add_u32 s56, s56, s57
    s_add_u32 s56, s56, 65536
    v_mov_b32 v232, 0x53800000
    s_mov_b32 s43, 1
    ds_write_b128 v238, a[0:3] offset:0
    ds_write_b128 v238, a[4:7] offset:1024
    ds_write_b128 v238, a[8:11] offset:2048
    ds_write_b128 v238, a[12:15] offset:3072
    ds_write_b128 v238, a[16:19] offset:4096
    ds_write_b128 v238, a[20:23] offset:5120
    ds_write_b128 v238, a[24:27] offset:6144
    ds_write_b128 v238, a[28:31] offset:7168
    ds_write_b128 v238, a[32:35] offset:8192
    ds_write_b128 v238, a[36:39] offset:9216
    ds_write_b128 v238, a[40:43] offset:10240
    ds_write_b128 v238, a[44:47] offset:11264
    ds_write_b128 v239, v[62:65]
    v_mov_b32 v44, 1.0
    s_waitcnt lgkmcnt(0)
    s_barrier
    ds_read_b128 v[16:19], v240 offset:0
    ds_read_b128 v[20:23], v240 offset:1024
    ds_read_b128 v[24:27], v240 offset:2048
    ds_read_b128 v[28:31], v240 offset:3072
    ds_read_b128 v[76:79], v237 offset:0
    ds_read_b128 v[80:83], v237 offset:1024
    ds_read_b128 v[84:87], v237 offset:2048
    ds_read_b128 v[88:91], v237 offset:12288
    ds_read_b128 v[92:95], v237 offset:13312
    ds_read_b128 v[96:99], v237 offset:14336
    ds_read_b128 v[100:103], v237 offset:24576
    ds_read_b128 v[104:107], v237 offset:25600
    ds_read_b128 v[108:111], v237 offset:26624
    ds_read_b128 v[112:115], v237 offset:36864
    ds_read_b128 v[116:119], v237 offset:37888
    ds_read_b128 v[120:123], v237 offset:38912
    s_waitcnt lgkmcnt(12)
    v_min3_f32 v9, v16, v20, v24
    v_min_f32 v9, v9, v28
    v_sub_f32 v32, v9, v16
    v_sub_f32 v33, v9, v20
    v_sub_f32 v34, v9, v24
    v_sub_f32 v35, v9, v28
    v_exp_f32 v32, v32
    v_exp_f32 v33, v33
    v_exp_f32 v34, v34
    v_exp_f32 v35, v35
    v_mul_f32 v1, v32, v17
    v_mul_f32 v2, v32, v18
    v_fmac_f32 v1, v33, v21
    v_fmac_f32 v2, v33, v22
    v_fmac_f32 v1, v34, v25
    v_fmac_f32 v2, v34, v26
    v_fmac_f32 v1, v35, v29
    v_fmac_f32 v2, v35, v30
    s_waitcnt lgkmcnt(9)
    v_mul_f32 v76, v76, v32
    v_mul_f32 v77, v77, v32
    v_mfma_f32_16x16x4_f32 v[36:39], v44, v1, 0
    v_mfma_f32_16x16x4_f32 v[40:43], v44, v2, 0
    v_mul_f32 v78, v78, v32
    v_mul_f32 v79, v79, v32
    v_mul_f32 v80, v80, v32
    v_mul_f32 v81, v81, v32
    v_mul_f32 v82, v82, v32
    v_mul_f32 v83, v83, v32
    v_mul_f32 v84, v84, v32
    v_mul_f32 v85, v85, v32
    v_mul_f32 v86, v86, v32
    v_mul_f32 v87, v87, v32
    s_waitcnt lgkmcnt(6)
    v_fmac_f32 v76, v88, v33
    v_fmac_f32 v77, v89, v33
    v_fmac_f32 v78, v90, v33
    v_fmac_f32 v79, v91, v33
    v_fmac_f32 v80, v92, v33
    v_fmac_f32 v81, v93, v33
    v_fmac_f32 v82, v94, v33
    v_fmac_f32 v83, v95, v33
    v_fmac_f32 v84, v96, v33
    v_fmac_f32 v85, v97, v33
    v_fmac_f32 v86, v98, v33
    v_fmac_f32 v87, v99, v33
    v_rcp_f32 v3, v36
    v_log_f32 v4, v36
    s_waitcnt lgkmcnt(3)
    v_fmac_f32 v76, v100, v34
    v_fmac_f32 v77, v101, v34
    v_fmac_f32 v78, v102, v34
    v_fmac_f32 v79, v103, v34
    v_fmac_f32 v80, v104, v34
    v_fmac_f32 v81, v105, v34
    v_fmac_f32 v82, v106, v34
    v_fmac_f32 v83, v107, v34
    v_fmac_f32 v84, v108, v34
    v_fmac_f32 v85, v109, v34
    v_fmac_f32 v86, v110, v34
    v_fmac_f32 v87, v111, v34
    v_mul_f32 v5, v60, v3
    v_mul_f32 v6, v40, v3
    v_sub_f32 v4, v4, v9
    s_waitcnt lgkmcnt(0)
    v_fmac_f32 v76, v112, v35
    v_fmac_f32 v77, v113, v35
    v_fmac_f32 v78, v114, v35
    v_fmac_f32 v79, v115, v35
    v_fmac_f32 v80, v116, v35
    v_fmac_f32 v81, v117, v35
    v_fmac_f32 v82, v118, v35
    v_fmac_f32 v83, v119, v35
    v_fmac_f32 v84, v120, v35
    v_fmac_f32 v85, v121, v35
    v_fmac_f32 v86, v122, v35
    v_fmac_f32 v87, v123, v35
    v_fma_f32 v76, v76, v5, -v6
    v_fma_f32 v77, v77, v5, -v6
    v_fma_f32 v78, v78, v5, -v6
    v_fma_f32 v79, v79, v5, -v6
    v_fma_f32 v80, v80, v5, -v6
    v_fma_f32 v81, v81, v5, -v6
    v_fma_f32 v82, v82, v5, -v6
    v_fma_f32 v83, v83, v5, -v6
    v_fma_f32 v84, v84, v5, -v6
    v_fma_f32 v85, v85, v5, -v6
    v_fma_f32 v86, v86, v5, -v6
    v_fma_f32 v87, v87, v5, -v6
    v_cvt_pk_bf16_f32 v88, v76, v77
    v_cvt_pk_bf16_f32 v89, v78, v79
    ds_write_b64 v236, v[88:89] offset:0
    v_cvt_pk_bf16_f32 v90, v80, v81
    v_cvt_pk_bf16_f32 v91, v82, v83
    ds_write_b64 v236, v[90:91] offset:512
    v_cvt_pk_bf16_f32 v92, v84, v85
    v_cvt_pk_bf16_f32 v93, v86, v87
    ds_write_b64 v236, v[92:93] offset:1024
    s_waitcnt lgkmcnt(0)
    s_barrier
    ds_read_b128 v[136:139], v241 offset:0
    ds_read_b128 v[140:143], v241 offset:1024
    ds_read_b128 v[144:147], v241 offset:2048
    ds_read_b128 v[148:151], v241 offset:3072
    ds_read_b128 v[152:155], v241 offset:4096
    ds_read_b128 v[156:159], v241 offset:5120
    s_waitcnt lgkmcnt(5)
    v_mfma_f32_16x16x32_bf16 v[16:19], v[160:163], v[136:139], 0
    v_mfma_f32_16x16x32_bf16 v[20:23], v[184:187], v[136:139], 0
    v_mfma_f32_16x16x32_bf16 v[24:27], v[208:211], v[136:139], 0
    s_waitcnt lgkmcnt(4)
    v_mfma_f32_16x16x32_bf16 v[16:19], v[164:167], v[140:143], v[16:19]
    v_mfma_f32_16x16x32_bf16 v[20:23], v[188:191], v[140:143], v[20:23]
    v_mfma_f32_16x16x32_bf16 v[24:27], v[212:215], v[140:143], v[24:27]
    s_waitcnt lgkmcnt(3)
    v_mfma_f32_16x16x32_bf16 v[16:19], v[168:171], v[144:147], v[16:19]
    v_mfma_f32_16x16x32_bf16 v[20:23], v[192:195], v[144:147], v[20:23]
    v_mfma_f32_16x16x32_bf16 v[24:27], v[216:219], v[144:147], v[24:27]
    s_waitcnt lgkmcnt(2)
    v_mfma_f32_16x16x32_bf16 v[16:19], v[172:175], v[148:151], v[16:19]
    v_mfma_f32_16x16x32_bf16 v[20:23], v[196:199], v[148:151], v[20:23]
    v_mfma_f32_16x16x32_bf16 v[24:27], v[220:223], v[148:151], v[24:27]
    s_waitcnt lgkmcnt(1)
    v_mfma_f32_16x16x32_bf16 v[16:19], v[176:179], v[152:155], v[16:19]
    v_mfma_f32_16x16x32_bf16 v[20:23], v[200:203], v[152:155], v[20:23]
    v_mfma_f32_16x16x32_bf16 v[24:27], v[224:227], v[152:155], v[24:27]
    s_waitcnt lgkmcnt(0)
    v_mfma_f32_16x16x32_bf16 v[16:19], v[180:183], v[156:159], v[16:19]
    v_mfma_f32_16x16x32_bf16 v[20:23], v[204:207], v[156:159], v[20:23]
    v_mfma_f32_16x16x32_bf16 v[24:27], v[228:231], v[156:159], v[24:27]
    v_mov_b32 v35, v4
    v_add_u32 v39, s39, v4
    s_nop 3
    v_cvt_pk_bf16_f32 v32, v16, v17
    v_cvt_pk_bf16_f32 v33, v18, v19
    v_cvt_pk_bf16_f32 v34, v20, v21
    buffer_store_dwordx4 v[32:35], v242, s[32:35], s56 offen sc1
    v_cvt_pk_bf16_f32 v36, v22, v23
    v_cvt_pk_bf16_f32 v37, v24, v25
    v_cvt_pk_bf16_f32 v38, v26, v27
    buffer_store_dwordx4 v[36:39], v243, s[32:35], s56 offen sc1
    s_sub_u32 s58, s2, 64
    s_cmp_ge_u32 s58, 64
    s_cbranch_scc1 L_fin
    s_lshl_b32 s60, s58, 15
    s_lshl_b32 s57, s3, 13
    s_add_u32 s60, s60, s57
    s_add_u32 s60, s60, 65536
    s_add_u32 s61, s60, 4096
    buffer_load_dwordx4 v[76:79], v65, s[32:35], s60 offen offset:0 sc1
    buffer_load_dwordx4 v[80:83], v65, s[32:35], s60 offen offset:1024 sc1
    buffer_load_dwordx4 v[84:87], v65, s[32:35], s60 offen offset:2048 sc1
    buffer_load_dwordx4 v[88:91], v65, s[32:35], s60 offen offset:3072 sc1
    buffer_load_dwordx4 v[92:95], v65, s[32:35], s61 offen offset:0 sc1
    buffer_load_dwordx4 v[96:99], v65, s[32:35], s61 offen offset:1024 sc1
    buffer_load_dwordx4 v[100:103], v65, s[32:35], s61 offen offset:2048 sc1
    buffer_load_dwordx4 v[104:107], v65, s[32:35], s61 offen offset:3072 sc1
    s_mov_b32 s64, s4
    s_mov_b32 s65, s5
    s_mov_b32 s66, 6144
    s_mov_b32 s67, 0x20000
    s_mov_b32 s68, s18
    s_mov_b32 s69, s19
    s_mov_b32 s70, 6144
    s_mov_b32 s71, 0x20000
    v_bfe_u32 v48, v0, 2, 1
    v_cmp_eq_u32 vcc, 1, v48
    v_mul_u32_u24 v49, 7, v48
    v_xor_b32 v49, v0, v49
    v_and_b32 v49, 3, v49
    s_lshr_b32 s56, s58, 4
    s_lshl_b32 s56, s56, 2
    v_add_u32 v49, s56, v49
    v_lshlrev_b32 v50, 2, v49
    ds_bpermute_b32 v42, v50, v4
    v_mov_b32 v40, s39
    v_cndmask_b32 v41, 0, v40, vcc
    v_sub_u32 v40, v40, v41
    v_sub_u32 v40, v40, v41
    v_lshrrev_b32 v50, 4, v0
    v_mad_u32_u24 v50, v48, 3, v50
    v_lshrrev_b32 v51, 1, v50
    v_and_b32 v50, 1, v50
    v_lshlrev_b32 v50, 2, v50
    v_lshl_add_u32 v50, v51, 5, v50
    v_bfe_u32 v51, v0, 3, 1
    v_lshl_add_u32 v50, v51, 1, v50
    v_mul_u32_u24 v49, 384, v49
    s_bfe_u32 s56, s58, 0x20002
    s_mul_i32 s56, s56, 96
    s_and_b32 s57, s58, 3
    s_lshl_b32 s57, s57, 3
    s_add_u32 s56, s56, s57
    v_add3_u32 v43, s56, v49, v50
    v_cmp_gt_u32 vcc, 48, v0
    v_mov_b32 v51, 0x10000
    s_nop 0
    v_cndmask_b32 v43, v51, v43, vcc
    buffer_load_ushort v44, v43, s[64:67], 0 offen
    s_lshl_b32 s56, s3, 2
    v_add_u32 v45, s56, v65
    v_and_b32 v46, 0x70, v65
    v_mov_b32 v16, 0
    v_mov_b32 v17, 0
    v_mov_b32 v18, 0
    v_mov_b32 v19, 0
    v_mov_b32 v20, 0
    v_mov_b32 v21, 0
    v_mov_b32 v22, 0
    s_mov_b32 s53, 0
    s_waitcnt lgkmcnt(0)
    s_waitcnt vmcnt(0)
    v_sub_u32_dpp v48, v79, v79 row_half_mirror row_mask:0xf bank_mask:0xf
    v_cmp_eq_u32 vcc, v48, v40
    s_mov_b64 s[6:7], vcc
    s_not_b64 s[24:25], vcc
    s_cbranch_scc0 L_c_a0
    s_mov_b64 exec, s[24:25]
    buffer_load_dwordx4 v[76:79], v65, s[32:35], s60 offen offset:0 sc1
    s_mov_b64 exec, -1
L_c_a0:
    v_sub_u32_dpp v48, v83, v83 row_half_mirror row_mask:0xf bank_mask:0xf
    v_cmp_eq_u32 vcc, v48, v40
    s_mov_b64 s[8:9], vcc
    s_not_b64 s[26:27], vcc
    s_cbranch_scc0 L_c_a1
    s_mov_b64 exec, s[26:27]
    buffer_load_dwordx4 v[80:83], v65, s[32:35], s60 offen offset:1024 sc1
    s_mov_b64 exec, -1
L_c_a1:
    v_sub_u32_dpp v48, v87, v87 row_half_mirror row_mask:0xf bank_mask:0xf
    v_cmp_eq_u32 vcc, v48, v40
    s_mov_b64 s[10:11], vcc
    s_not_b64 s[28:29], vcc
    s_cbranch_scc0 L_c_a2
    s_mov_b64 exec, s[28:29]
    buffer_load_dwordx4 v[84:87], v65, s[32:35], s60 offen offset:2048 sc1
    s_mov_b64 exec, -1
L_c_a2:
    v_sub_u32_dpp v48, v91, v91 row_half_mirror row_mask:0xf bank_mask:0xf
    v_cmp_eq_u32 vcc, v48, v40
    s_mov_b64 s[12:13], vcc
    s_not_b64 s[30:31], vcc
    s_cbranch_scc0 L_c_a3
    s_mov_b64 exec, s[30:31]
    buffer_load_dwordx4 v[88:91], v65, s[32:35], s60 offen offset:3072 sc1
    s_mov_b64 exec, -1
L_c_a3:
    v_sub_u32_dpp v48, v95, v95 row_half_mirror row_mask:0xf bank_mask:0xf
    v_cmp_eq_u32 vcc, v48, v40
    s_mov_b64 s[14:15], vcc
    s_not_b64 s[44:45], vcc
    s_cbranch_scc0 L_c_a4
    s_mov_b64 exec, s[44:45]
    buffer_load_dwordx4 v[92:95], v65, s[32:35], s61 offen offset:0 sc1
    s_mov_b64 exec, -1
L_c_a4:
    v_sub_u32_dpp v48, v99, v99 row_half_mirror row_mask:0xf bank_mask:0xf
    v_cmp_eq_u32 vcc, v48, v40
    s_mov_b64 s[16:17], vcc
    s_not_b64 s[46:47], vcc
    s_cbranch_scc0 L_c_a5
    s_mov_b64 exec, s[46:47]
    buffer_load_dwordx4 v[96:99], v65, s[32:35], s61 offen offset:1024 sc1
    s_mov_b64 exec, -1
L_c_a5:
    v_sub_u32_dpp v48, v103, v103 row_half_mirror row_mask:0xf bank_mask:0xf
    v_cmp_eq_u32 vcc, v48, v40
    s_mov_b64 s[36:37], vcc
    s_not_b64 s[48:49], vcc
    s_cbranch_scc0 L_c_a6
    s_mov_b64 exec, s[48:49]
    buffer_load_dwordx4 v[100:103], v65, s[32:35], s61 offen offset:2048 sc1
    s_mov_b64 exec, -1
L_c_a6:
    v_sub_u32_dpp v48, v107, v107 row_half_mirror row_mask:0xf bank_mask:0xf
    v_cmp_eq_u32 vcc, v48, v40
    s_mov_b64 s[40:41], vcc
    s_not_b64 s[50:51], vcc
    s_cbranch_scc0 L_c_a7
    s_mov_b64 exec, s[50:51]
    buffer_load_dwordx4 v[104:107], v65, s[32:35], s61 offen offset:3072 sc1
    s_mov_b64 exec, -1
L_c_a7:
L_c_acc:
    s_mov_b64 exec, s[6:7]
    v_sub_u32 v49, v79, v41
    v_sub_f32 v49, v49, v42
    v_exp_f32 v49, v49
    s_nop 0
    v_cvt_pk_bf16_f32 v49, v49, 0
    v_lshlrev_b32 v50, 16, v49
    v_dot2_f32_bf16 v16, v76, v49, v16
    v_dot2_f32_bf16 v18, v77, v49, v18
    v_dot2_f32_bf16 v20, v78, v49, v20
    v_add_f32 v22, v22, v50
    v_dot2_f32_bf16 v17, v76, v50, v17
    v_dot2_f32_bf16 v19, v77, v50, v19
    v_dot2_f32_bf16 v21, v78, v50, v21
    s_mov_b64 exec, s[8:9]
    v_sub_u32 v49, v83, v41
    v_sub_f32 v49, v49, v42
    v_exp_f32 v49, v49
    s_nop 0
    v_cvt_pk_bf16_f32 v49, v49, 0
    v_lshlrev_b32 v50, 16, v49
    v_dot2_f32_bf16 v16, v80, v49, v16
    v_dot2_f32_bf16 v18, v81, v49, v18
    v_dot2_f32_bf16 v20, v82, v49, v20
    v_add_f32 v22, v22, v50
    v_dot2_f32_bf16 v17, v80, v50, v17
    v_dot2_f32_bf16 v19, v81, v50, v19
    v_dot2_f32_bf16 v21, v82, v50, v21
    s_mov_b64 exec, s[10:11]
    v_sub_u32 v49, v87, v41
    v_sub_f32 v49, v49, v42
    v_exp_f32 v49, v49
    s_nop 0
    v_cvt_pk_bf16_f32 v49, v49, 0
    v_lshlrev_b32 v50, 16, v49
    v_dot2_f32_bf16 v16, v84, v49, v16
    v_dot2_f32_bf16 v18, v85, v49, v18
    v_dot2_f32_bf16 v20, v86, v49, v20
    v_add_f32 v22, v22, v50
    v_dot2_f32_bf16 v17, v84, v50, v17
    v_dot2_f32_bf16 v19, v85, v50, v19
    v_dot2_f32_bf16 v21, v86, v50, v21
    s_mov_b64 exec, s[12:13]
    v_sub_u32 v49, v91, v41
    v_sub_f32 v49, v49, v42
    v_exp_f32 v49, v49
    s_nop 0
    v_cvt_pk_bf16_f32 v49, v49, 0
    v_lshlrev_b32 v50, 16, v49
    v_dot2_f32_bf16 v16, v88, v49, v16
    v_dot2_f32_bf16 v18, v89, v49, v18
    v_dot2_f32_bf16 v20, v90, v49, v20
    v_add_f32 v22, v22, v50
    v_dot2_f32_bf16 v17, v88, v50, v17
    v_dot2_f32_bf16 v19, v89, v50, v19
    v_dot2_f32_bf16 v21, v90, v50, v21
    s_mov_b64 exec, s[14:15]
    v_sub_u32 v49, v95, v41
    v_sub_f32 v49, v49, v42
    v_exp_f32 v49, v49
    s_nop 0
    v_cvt_pk_bf16_f32 v49, v49, 0
    v_lshlrev_b32 v50, 16, v49
    v_dot2_f32_bf16 v16, v92, v49, v16
    v_dot2_f32_bf16 v18, v93, v49, v18
    v_dot2_f32_bf16 v20, v94, v49, v20
    v_add_f32 v22, v22, v50
    v_dot2_f32_bf16 v17, v92, v50, v17
    v_dot2_f32_bf16 v19, v93, v50, v19
    v_dot2_f32_bf16 v21, v94, v50, v21
    s_mov_b64 exec, s[16:17]
    v_sub_u32 v49, v99, v41
    v_sub_f32 v49, v49, v42
    v_exp_f32 v49, v49
    s_nop 0
    v_cvt_pk_bf16_f32 v49, v49, 0
    v_lshlrev_b32 v50, 16, v49
    v_dot2_f32_bf16 v16, v96, v49, v16
    v_dot2_f32_bf16 v18, v97, v49, v18
    v_dot2_f32_bf16 v20, v98, v49, v20
    v_add_f32 v22, v22, v50
    v_dot2_f32_bf16 v17, v96, v50, v17
    v_dot2_f32_bf16 v19, v97, v50, v19
    v_dot2_f32_bf16 v21, v98, v50, v21
    s_mov_b64 exec, s[36:37]
    v_sub_u32 v49, v103, v41
    v_sub_f32 v49, v49, v42
    v_exp_f32 v49, v49
    s_nop 0
    v_cvt_pk_bf16_f32 v49, v49, 0
    v_lshlrev_b32 v50, 16, v49
    v_dot2_f32_bf16 v16, v100, v49, v16
    v_dot2_f32_bf16 v18, v101, v49, v18
    v_dot2_f32_bf16 v20, v102, v49, v20
    v_add_f32 v22, v22, v50
    v_dot2_f32_bf16 v17, v100, v50, v17
    v_dot2_f32_bf16 v19, v101, v50, v19
    v_dot2_f32_bf16 v21, v102, v50, v21
    s_mov_b64 exec, s[40:41]
    v_sub_u32 v49, v107, v41
    v_sub_f32 v49, v49, v42
    v_exp_f32 v49, v49
    s_nop 0
    v_cvt_pk_bf16_f32 v49, v49, 0
    v_lshlrev_b32 v50, 16, v49
    v_dot2_f32_bf16 v16, v104, v49, v16
    v_dot2_f32_bf16 v18, v105, v49, v18
    v_dot2_f32_bf16 v20, v106, v49, v20
    v_add_f32 v22, v22, v50
    v_dot2_f32_bf16 v17, v104, v50, v17
    v_dot2_f32_bf16 v19, v105, v50, v19
    v_dot2_f32_bf16 v21, v106, v50, v21
    s_mov_b64 exec, -1
L_c_loop:
    s_or_b64 vcc, s[24:25], s[26:27]
    s_or_b64 vcc, vcc, s[28:29]
    s_or_b64 vcc, vcc, s[30:31]
    s_or_b64 vcc, vcc, s[44:45]
    s_or_b64 vcc, vcc, s[46:47]
    s_or_b64 vcc, vcc, s[48:49]
    s_or_b64 vcc, vcc, s[50:51]
    s_cbranch_scc0 L_c_red
    s_add_u32 s53, s53, 1
    s_cmp_gt_u32 s53, 65536
    s_cbranch_scc1 L_c_red
    s_waitcnt vmcnt(0)
    s_cmp_eq_u64 s[24:25], 0
    s_cbranch_scc1 L_c_b0
    v_sub_u32_dpp v48, v79, v79 row_half_mirror row_mask:0xf bank_mask:0xf
    v_cmp_eq_u32 vcc, v48, v40
    s_and_b64 s[6:7], vcc, s[24:25]
    s_andn2_b64 s[24:25], s[24:25], vcc
    s_cbranch_scc0 L_c_n0
    s_mov_b64 exec, s[24:25]
    buffer_load_dwordx4 v[76:79], v65, s[32:35], s60 offen offset:0 sc1
L_c_n0:
    s_mov_b64 exec, s[6:7]
    s_cbranch_execz L_c_e0
    v_sub_u32 v49, v79, v41
    v_sub_f32 v49, v49, v42
    v_exp_f32 v49, v49
    s_nop 0
    v_cvt_pk_bf16_f32 v49, v49, 0
    v_lshlrev_b32 v50, 16, v49
    v_dot2_f32_bf16 v16, v76, v49, v16
    v_dot2_f32_bf16 v18, v77, v49, v18
    v_dot2_f32_bf16 v20, v78, v49, v20
    v_add_f32 v22, v22, v50
    v_dot2_f32_bf16 v17, v76, v50, v17
    v_dot2_f32_bf16 v19, v77, v50, v19
    v_dot2_f32_bf16 v21, v78, v50, v21
L_c_e0:
    s_mov_b64 exec, -1
L_c_b0:
    s_cmp_eq_u64 s[26:27], 0
    s_cbranch_scc1 L_c_b1
    v_sub_u32_dpp v48, v83, v83 row_half_mirror row_mask:0xf bank_mask:0xf
    v_cmp_eq_u32 vcc, v48, v40
    s_and_b64 s[6:7], vcc, s[26:27]
    s_andn2_b64 s[26:27], s[26:27], vcc
    s_cbranch_scc0 L_c_n1
    s_mov_b64 exec, s[26:27]
    buffer_load_dwordx4 v[80:83], v65, s[32:35], s60 offen offset:1024 sc1
L_c_n1:
    s_mov_b64 exec, s[6:7]
    s_cbranch_execz L_c_e1
    v_sub_u32 v49, v83, v41
    v_sub_f32 v49, v49, v42
    v_exp_f32 v49, v49
    s_nop 0
    v_cvt_pk_bf16_f32 v49, v49, 0
    v_lshlrev_b32 v50, 16, v49
    v_dot2_f32_bf16 v16, v80, v49, v16
    v_dot2_f32_bf16 v18, v81, v49, v18
    v_dot2_f32_bf16 v20, v82, v49, v20
    v_add_f32 v22, v22, v50
    v_dot2_f32_bf16 v17, v80, v50, v17
    v_dot2_f32_bf16 v19, v81, v50, v19
    v_dot2_f32_bf16 v21, v82, v50, v21
L_c_e1:
    s_mov_b64 exec, -1
L_c_b1:
    s_cmp_eq_u64 s[28:29], 0
    s_cbranch_scc1 L_c_b2
    v_sub_u32_dpp v48, v87, v87 row_half_mirror row_mask:0xf bank_mask:0xf
    v_cmp_eq_u32 vcc, v48, v40
    s_and_b64 s[6:7], vcc, s[28:29]
    s_andn2_b64 s[28:29], s[28:29], vcc
    s_cbranch_scc0 L_c_n2
    s_mov_b64 exec, s[28:29]
    buffer_load_dwordx4 v[84:87], v65, s[32:35], s60 offen offset:2048 sc1
L_c_n2:
    s_mov_b64 exec, s[6:7]
    s_cbranch_execz L_c_e2
    v_sub_u32 v49, v87, v41
    v_sub_f32 v49, v49, v42
    v_exp_f32 v49, v49
    s_nop 0
    v_cvt_pk_bf16_f32 v49, v49, 0
    v_lshlrev_b32 v50, 16, v49
    v_dot2_f32_bf16 v16, v84, v49, v16
    v_dot2_f32_bf16 v18, v85, v49, v18
    v_dot2_f32_bf16 v20, v86, v49, v20
    v_add_f32 v22, v22, v50
    v_dot2_f32_bf16 v17, v84, v50, v17
    v_dot2_f32_bf16 v19, v85, v50, v19
    v_dot2_f32_bf16 v21, v86, v50, v21
L_c_e2:
    s_mov_b64 exec, -1
L_c_b2:
    s_cmp_eq_u64 s[30:31], 0
    s_cbranch_scc1 L_c_b3
    v_sub_u32_dpp v48, v91, v91 row_half_mirror row_mask:0xf bank_mask:0xf
    v_cmp_eq_u32 vcc, v48, v40
    s_and_b64 s[6:7], vcc, s[30:31]
    s_andn2_b64 s[30:31], s[30:31], vcc
    s_cbranch_scc0 L_c_n3
    s_mov_b64 exec, s[30:31]
    buffer_load_dwordx4 v[88:91], v65, s[32:35], s60 offen offset:3072 sc1
L_c_n3:
    s_mov_b64 exec, s[6:7]
    s_cbranch_execz L_c_e3
    v_sub_u32 v49, v91, v41
    v_sub_f32 v49, v49, v42
    v_exp_f32 v49, v49
    s_nop 0
    v_cvt_pk_bf16_f32 v49, v49, 0
    v_lshlrev_b32 v50, 16, v49
    v_dot2_f32_bf16 v16, v88, v49, v16
    v_dot2_f32_bf16 v18, v89, v49, v18
    v_dot2_f32_bf16 v20, v90, v49, v20
    v_add_f32 v22, v22, v50
    v_dot2_f32_bf16 v17, v88, v50, v17
    v_dot2_f32_bf16 v19, v89, v50, v19
    v_dot2_f32_bf16 v21, v90, v50, v21
L_c_e3:
    s_mov_b64 exec, -1
L_c_b3:
    s_cmp_eq_u64 s[44:45], 0
    s_cbranch_scc1 L_c_b4
    v_sub_u32_dpp v48, v95, v95 row_half_mirror row_mask:0xf bank_mask:0xf
    v_cmp_eq_u32 vcc, v48, v40
    s_and_b64 s[6:7], vcc, s[44:45]
    s_andn2_b64 s[44:45], s[44:45], vcc
    s_cbranch_scc0 L_c_n4
    s_mov_b64 exec, s[44:45]
    buffer_load_dwordx4 v[92:95], v65, s[32:35], s61 offen offset:0 sc1
L_c_n4:
    s_mov_b64 exec, s[6:7]
    s_cbranch_execz L_c_e4
    v_sub_u32 v49, v95, v41
    v_sub_f32 v49, v49, v42
    v_exp_f32 v49, v49
    s_nop 0
    v_cvt_pk_bf16_f32 v49, v49, 0
    v_lshlrev_b32 v50, 16, v49
    v_dot2_f32_bf16 v16, v92, v49, v16
    v_dot2_f32_bf16 v18, v93, v49, v18
    v_dot2_f32_bf16 v20, v94, v49, v20
    v_add_f32 v22, v22, v50
    v_dot2_f32_bf16 v17, v92, v50, v17
    v_dot2_f32_bf16 v19, v93, v50, v19
    v_dot2_f32_bf16 v21, v94, v50, v21
L_c_e4:
    s_mov_b64 exec, -1
L_c_b4:
    s_cmp_eq_u64 s[46:47], 0
    s_cbranch_scc1 L_c_b5
    v_sub_u32_dpp v48, v99, v99 row_half_mirror row_mask:0xf bank_mask:0xf
    v_cmp_eq_u32 vcc, v48, v40
    s_and_b64 s[6:7], vcc, s[46:47]
    s_andn2_b64 s[46:47], s[46:47], vcc
    s_cbranch_scc0 L_c_n5
    s_mov_b64 exec, s[46:47]
    buffer_load_dwordx4 v[96:99], v65, s[32:35], s61 offen offset:1024 sc1
L_c_n5:
    s_mov_b64 exec, s[6:7]
    s_cbranch_execz L_c_e5
    v_sub_u32 v49, v99, v41
    v_sub_f32 v49, v49, v42
    v_exp_f32 v49, v49
    s_nop 0
    v_cvt_pk_bf16_f32 v49, v49, 0
    v_lshlrev_b32 v50, 16, v49
    v_dot2_f32_bf16 v16, v96, v49, v16
    v_dot2_f32_bf16 v18, v97, v49, v18
    v_dot2_f32_bf16 v20, v98, v49, v20
    v_add_f32 v22, v22, v50
    v_dot2_f32_bf16 v17, v96, v50, v17
    v_dot2_f32_bf16 v19, v97, v50, v19
    v_dot2_f32_bf16 v21, v98, v50, v21
L_c_e5:
    s_mov_b64 exec, -1
L_c_b5:
    s_cmp_eq_u64 s[48:49], 0
    s_cbranch_scc1 L_c_b6
    v_sub_u32_dpp v48, v103, v103 row_half_mirror row_mask:0xf bank_mask:0xf
    v_cmp_eq_u32 vcc, v48, v40
    s_and_b64 s[6:7], vcc, s[48:49]
    s_andn2_b64 s[48:49], s[48:49], vcc
    s_cbranch_scc0 L_c_n6
    s_mov_b64 exec, s[48:49]
    buffer_load_dwordx4 v[100:103], v65, s[32:35], s61 offen offset:2048 sc1
L_c_n6:
    s_mov_b64 exec, s[6:7]
    s_cbranch_execz L_c_e6
    v_sub_u32 v49, v103, v41
    v_sub_f32 v49, v49, v42
    v_exp_f32 v49, v49
    s_nop 0
    v_cvt_pk_bf16_f32 v49, v49, 0
    v_lshlrev_b32 v50, 16, v49
    v_dot2_f32_bf16 v16, v100, v49, v16
    v_dot2_f32_bf16 v18, v101, v49, v18
    v_dot2_f32_bf16 v20, v102, v49, v20
    v_add_f32 v22, v22, v50
    v_dot2_f32_bf16 v17, v100, v50, v17
    v_dot2_f32_bf16 v19, v101, v50, v19
    v_dot2_f32_bf16 v21, v102, v50, v21
L_c_e6:
    s_mov_b64 exec, -1
L_c_b6:
    s_cmp_eq_u64 s[50:51], 0
    s_cbranch_scc1 L_c_b7
    v_sub_u32_dpp v48, v107, v107 row_half_mirror row_mask:0xf bank_mask:0xf
    v_cmp_eq_u32 vcc, v48, v40
    s_and_b64 s[6:7], vcc, s[50:51]
    s_andn2_b64 s[50:51], s[50:51], vcc
    s_cbranch_scc0 L_c_n7
    s_mov_b64 exec, s[50:51]
    buffer_load_dwordx4 v[104:107], v65, s[32:35], s61 offen offset:3072 sc1
L_c_n7:
    s_mov_b64 exec, s[6:7]
    s_cbranch_execz L_c_e7
    v_sub_u32 v49, v107, v41
    v_sub_f32 v49, v49, v42
    v_exp_f32 v49, v49
    s_nop 0
    v_cvt_pk_bf16_f32 v49, v49, 0
    v_lshlrev_b32 v50, 16, v49
    v_dot2_f32_bf16 v16, v104, v49, v16
    v_dot2_f32_bf16 v18, v105, v49, v18
    v_dot2_f32_bf16 v20, v106, v49, v20
    v_add_f32 v22, v22, v50
    v_dot2_f32_bf16 v17, v104, v50, v17
    v_dot2_f32_bf16 v19, v105, v50, v19
    v_dot2_f32_bf16 v21, v106, v50, v21
L_c_e7:
    s_mov_b64 exec, -1
L_c_b7:
    s_branch L_c_loop
L_c_red:
    s_waitcnt vmcnt(0)
    v_mov_b32 v23, v22
    v_permlane32_swap_b32 v16, v20
    v_permlane32_swap_b32 v17, v21
    v_permlane32_swap_b32 v18, v22
    v_permlane32_swap_b32 v19, v23
    v_add_f32 v16, v16, v20
    v_add_f32 v17, v17, v21
    v_add_f32 v18, v18, v22
    v_add_f32 v19, v19, v23
    s_nop 0
    v_permlane16_swap_b32 v16, v18
    v_permlane16_swap_b32 v17, v19
    v_add_f32 v16, v16, v18
    v_add_f32 v17, v17, v19
    s_nop 0
    v_add_f32_dpp v48, v16, v16 row_ror:8 row_mask:0xf bank_mask:0x3
    s_nop 1
    v_add_f32_dpp v48, v17, v17 row_ror:8 row_mask:0xf bank_mask:0xc
    ds_write_b32 v45, v48
    s_waitcnt lgkmcnt(0)
    s_barrier
    ds_read_b128 v[48:51], v46 offset:768
    ds_read_b128 v[52:55], v65
    v_lshlrev_b32 v18, 16, v44
    s_waitcnt lgkmcnt(1)
    v_add_f32 v48, v48, v49
    v_add_f32 v50, v50, v51
    v_add_f32 v48, v48, v50
    v_cmp_nlt_f32 vcc, v48, v232
    v_rcp_f32 v48, v48
    s_waitcnt lgkmcnt(0)
    s_cbranch_vccnz L_c_slow
L_c_out:
    s_cmp_lg_u32 s3, 0
    s_cbranch_scc1 L_fin
    v_add_f32 v52, v52, v53
    v_add_f32 v54, v54, v55
    v_add_f32 v52, v52, v54
    v_fmac_f32 v18, v52, v48
    v_cvt_pk_bf16_f32 v18, v18, v18
    buffer_store_short v18, v43, s[68:71], 0 offen
    s_cmp_lg_u32 s58, 0
    s_cbranch_scc1 L_fin
    v_mov_b32 v48, s39
    v_mov_b32 v49, 0
    s_mov_b64 exec, 1
    buffer_store_dword v48, v49, s[32:35], 0 offen offset:0 sc1
    s_mov_b64 exec, -1
L_fin:
L_end:
    s_endpgm
L_prod:
    s_mov_b32 s64, s10
    s_mov_b32 s65, s11
    s_mov_b32 s66, 73728
    s_mov_b32 s67, 0x20000
    s_mov_b32 s68, s12
    s_mov_b32 s69, s13
    s_mov_b32 s70, 73728
    s_mov_b32 s71, 0x20000
    s_mov_b32 s72, s4
    s_mov_b32 s73, s5
    s_mov_b32 s74, 6144
    s_mov_b32 s75, 0x20000
    s_cmp_lg_u32 s3, 0
    s_cbranch_scc1 L_p_noq
    s_mov_b32 m0, 147456
    s_nop 0
    buffer_load_dwordx4 v16, s[72:75], 0 offen offset:0  lds
    buffer_load_dwordx4 v17, s[72:75], 0 offen offset:1024  lds
    buffer_load_dwordx4 v18, s[72:75], 0 offen offset:2048  lds
    buffer_load_dwordx4 v19, s[72:75], 0 offen offset:3072  lds
    s_mov_b32 m0, 151552
    s_nop 0
    buffer_load_dwordx4 v20, s[72:75], 0 offen offset:0  lds
    buffer_load_dwordx4 v21, s[72:75], 0 offen offset:1024  lds
L_p_noq:
    s_mul_i32 s56, s3, 18432
    s_add_u32 m0, s56, 73728
    s_nop 0
    buffer_load_dwordx4 v16, s[64:67], s56 offen offset:0  lds
    buffer_load_dwordx4 v17, s[64:67], s56 offen offset:1024  lds
    buffer_load_dwordx4 v18, s[64:67], s56 offen offset:2048  lds
    buffer_load_dwordx4 v19, s[64:67], s56 offen offset:3072  lds
    s_add_u32 m0, s56, 77824
    s_nop 0
    buffer_load_dwordx4 v20, s[64:67], s56 offen offset:0  lds
    buffer_load_dwordx4 v21, s[64:67], s56 offen offset:1024  lds
    s_add_u32 s56, s56, 6144
    s_add_u32 m0, s56, 73728
    s_nop 0
    buffer_load_dwordx4 v16, s[64:67], s56 offen offset:0  lds
    buffer_load_dwordx4 v17, s[64:67], s56 offen offset:1024  lds
    buffer_load_dwordx4 v18, s[64:67], s56 offen offset:2048  lds
    buffer_load_dwordx4 v19, s[64:67], s56 offen offset:3072  lds
    s_add_u32 m0, s56, 77824
    s_nop 0
    buffer_load_dwordx4 v20, s[64:67], s56 offen offset:0  lds
    buffer_load_dwordx4 v21, s[64:67], s56 offen offset:1024  lds
    s_add_u32 s56, s56, 6144
    s_add_u32 m0, s56, 73728
    s_nop 0
    buffer_load_dwordx4 v16, s[64:67], s56 offen offset:0  lds
    buffer_load_dwordx4 v17, s[64:67], s56 offen offset:1024  lds
    buffer_load_dwordx4 v18, s[64:67], s56 offen offset:2048  lds
    buffer_load_dwordx4 v19, s[64:67], s56 offen offset:3072  lds
    s_add_u32 m0, s56, 77824
    s_nop 0
    buffer_load_dwordx4 v20, s[64:67], s56 offen offset:0  lds
    buffer_load_dwordx4 v21, s[64:67], s56 offen offset:1024  lds
    s_lshl_b32 s59, s2, 2
    s_add_u32 s59, s59, s3
    s_mul_i32 s56, s59, 6144
    s_lshl_b32 s43, s59, 10
    s_add_u32 m0, s41, 6144
    s_nop 0
    buffer_load_dwordx4 v16, s[68:71], s56 offen offset:0  lds
    buffer_load_dwordx4 v17, s[68:71], s56 offen offset:1024  lds
    buffer_load_dwordx4 v18, s[68:71], s56 offen offset:2048  lds
    buffer_load_dwordx4 v19, s[68:71], s56 offen offset:3072  lds
    s_add_u32 m0, s41, 10240
    s_nop 0
    buffer_load_dwordx4 v20, s[68:71], s56 offen offset:0  lds
    buffer_load_dwordx4 v21, s[68:71], s56 offen offset:1024  lds
    s_add_u32 m0, s40, 0
    s_add_u32 s57, s36, 0
    buffer_load_dwordx4 v16, s[28:31], s57 offen offset:0 nt lds
    buffer_load_dwordx4 v17, s[28:31], s57 offen offset:1024 nt lds
    buffer_load_dwordx4 v18, s[28:31], s57 offen offset:2048 nt lds
    buffer_load_dwordx4 v19, s[28:31], s57 offen offset:3072 nt lds
    s_add_u32 m0, s40, 4096
    s_nop 0
    buffer_load_dwordx4 v20, s[28:31], s57 offen offset:0 nt lds
    buffer_load_dwordx4 v21, s[28:31], s57 offen offset:1024 nt lds
    v_and_b32 v1, 15, v0
    v_lshrrev_b32 v2, 4, v0
    v_lshrrev_b32 v6, 1, v2
    v_and_b32 v3, 1, v2
    v_lshl_or_b32 v3, v3, 1, v6
    v_lshrrev_b32 v4, 2, v0
    v_bfe_u32 v5, v0, 1, 1
    v_lshrrev_b32 v6, 3, v1
    v_and_or_b32 v6, v1, 6, v6
    v_xor_b32 v6, v6, v3
    v_mul_u32_u24 v7, 384, v1
    v_lshl_add_u32 v6, v6, 4, v7
    v_add_u32 v34, s40, v6
    v_xor_b32 v35, 64, v34
    v_lshrrev_b32 v6, 3, v1
    v_and_b32 v7, 7, v1
    v_lshl_or_b32 v6, v7, 1, v6
    v_xor_b32 v6, v6, v3
    v_mul_u32_u24 v7, 768, v1
    v_lshl_add_u32 v6, v6, 4, v7
    v_add_u32 v40, s41, v6
    v_xor_b32 v41, 0x40, v40
    v_xor_b32 v42, 0x80, v40
    v_xor_b32 v43, 0xc0, v40
    v_and_b32 v2, 1, v0
    v_lshlrev_b32 v2, 3, v2
    v_lshrrev_b32 v6, 3, v4
    v_and_or_b32 v6, v4, 6, v6
    v_xor_b32 v6, v6, v5
    v_mul_u32_u24 v7, 384, v4
    v_lshl_add_u32 v6, v6, 4, v7
    v_add3_u32 v36, s40, v6, v2
    v_xor_b32 v37, 0x20, v36
    v_xor_b32 v38, 0x40, v36
    v_xor_b32 v39, 0x60, v36
    v_lshrrev_b32 v6, 3, v4
    v_and_b32 v7, 7, v4
    v_lshl_or_b32 v6, v7, 1, v6
    v_xor_b32 v6, v6, v5
    v_mul_u32_u24 v7, 768, v4
    v_lshl_add_u32 v6, v6, 4, v7
    v_add3_u32 v44, s41, v6, v2
    v_xor_b32 v45, 0x20, v44
    v_xor_b32 v46, 0x40, v44
    v_xor_b32 v47, 0x60, v44
    v_xor_b32 v48, 0x80, v44
    v_xor_b32 v49, 0xa0, v44
    v_xor_b32 v50, 0xc0, v44
    v_xor_b32 v51, 0xe0, v44
    v_mov_b32 v52, 0x3f803f80
    v_mov_b32 v56, 0x3ebcbe62
    s_mov_b32 s44, 0x100001
    s_mov_b32 s45, 0x10000100
    v_mov_b32 v53, 0x3f803f80
    v_mov_b32 v57, 0x3ebcbe62
    s_mov_b32 s46, 0x200002
    s_mov_b32 s47, 0x20000200
    v_mov_b32 v54, 0x3f803f80
    v_mov_b32 v58, 0x3ebcbe62
    s_mov_b32 s48, 0x400004
    s_mov_b32 s49, 0x40000400
    v_mov_b32 v55, 0x3f803f80
    v_mov_b32 v59, 0x3ebcbe62
    s_mov_b32 s50, 0x800008
    s_mov_b32 s51, 0x80000800
    v_mov_b32 v60, 0x43400000
    v_lshrrev_b32 v1, 5, v0
    v_lshlrev_b32 v1, 8, v1
    v_and_b32 v2, 15, v0
    v_lshl_add_u32 v1, v2, 4, v1
    v_bfe_u32 v2, v0, 4, 1
    v_lshl_add_u32 v1, v2, 3, v1
    s_mul_i32 s56, s3, 1536
    s_add_u32 s56, s56, 147456
    v_add_u32 v236, s56, v1
    s_mul_i32 s56, s3, 3072
    s_add_u32 s56, s56, 24576
    v_add_u32 v237, s56, v65
    v_add_u32 v238, s41, v65
    s_lshl_b32 s56, s3, 10
    v_add_u32 v240, 159744, v65
    v_add_u32 v239, s56, v240
    v_add_u32 v241, 147456, v65
    v_bfe_u32 v1, v0, 2, 2
    v_lshlrev_b32 v1, 19, v1
    v_lshrrev_b32 v2, 4, v0
    v_lshl_or_b32 v1, v2, 15, v1
    v_and_b32 v2, 3, v0
    v_lshl_or_b32 v242, v2, 4, v1
    v_xor_b32 v243, 0x70, v242
    s_mul_i32 s56, s3, 18
    v_min_u32 v1, 17, v0
    v_add_u32 v1, s56, v1
    v_lshlrev_b32 v245, 7, v1
    s_mov_b32 s52, 0x41c00000
    v_lshrrev_b32 v1, 5, v0
    v_lshlrev_b32 v1, 8, v1
    v_and_b32 v2, 15, v0
    v_lshl_add_u32 v1, v2, 4, v1
    v_bfe_u32 v2, v0, 4, 1
    v_lshl_add_u32 v1, v2, 3, v1
    s_mul_i32 s56, s3, 1536
    s_add_u32 s56, s56, 153600
    v_add_u32 v134, s56, v1
    v_bfe_u32 v1, v0, 4, 1
    v_lshrrev_b32 v5, 5, v0
    v_lshl_or_b32 v1, v1, 1, v5
    v_bfe_u32 v2, v0, 2, 2
    v_lshl_add_u32 v3, v1, 3, v2
    v_mul_u32_u24 v3, 384, v3
    v_and_b32 v4, 1, v0
    v_lshl_add_u32 v3, v4, 3, v3
    v_add_u32 v3, 73728, v3
    v_and_or_b32 v2, v2, 2, v5
    v_bfe_u32 v4, v0, 1, 1
    v_xor_b32 v2, v2, v4
    s_mul_i32 s56, s3, 6
    s_add_u32 s57, s56, 0
    v_xor_b32 v4, s57, v2
    v_lshl_add_u32 v124, v4, 4, v3
    v_xor_b32 v125, 64, v124
    s_add_u32 s57, s56, 2
    v_xor_b32 v4, s57, v2
    v_lshl_add_u32 v126, v4, 4, v3
    v_xor_b32 v127, 64, v126
    s_add_u32 s57, s56, 4
    v_xor_b32 v4, s57, v2
    v_lshl_add_u32 v128, v4, 4, v3
    v_xor_b32 v129, 64, v128
    s_sub_u32 s56, 147456, s40
    v_add_u32 v132, s56, v34
    v_xor_b32 v133, 64, v132
    s_and_b32 s56, s3, 1
    s_lshl_b32 s56, s56, 2
    s_lshr_b32 s57, s3, 1
    s_mul_i32 s57, s57, 24576
    s_add_u32 s57, s57, 30720
    v_and_b32 v1, 11, v0
    v_or_b32 v1, s56, v1
    v_bfe_u32 v2, v0, 3, 1
    v_and_or_b32 v2, v1, 6, v2
    v_lshrrev_b32 v3, 4, v0
    v_xor_b32 v2, v2, v3
    v_mul_u32_u24 v1, 384, v1
    v_lshl_add_u32 v1, v2, 4, v1
    v_bfe_u32 v2, v0, 2, 1
    v_mul_u32_u24 v2, 12288, v2
    v_add3_u32 v130, s57, v1, v2
    v_xor_b32 v131, 64, v130
    v_add_u32 v7, 153600, v65
    s_waitcnt vmcnt(12)
    s_barrier
    ds_read_b128 v[136:139], v132 offset:0
    ds_read_b128 v[140:143], v133 offset:0
    ds_read_b128 v[144:147], v132 offset:128
    ds_read_b128 v[148:151], v133 offset:128
    ds_read_b128 v[152:155], v132 offset:256
    ds_read_b128 v[156:159], v133 offset:256
    ds_read_b64_tr_b16 v[160:161], v124 offset:0
    ds_read_b64_tr_b16 v[162:163], v125 offset:1536
    ds_read_b64_tr_b16 v[184:185], v126 offset:0
    ds_read_b64_tr_b16 v[186:187], v127 offset:1536
    ds_read_b64_tr_b16 v[208:209], v128 offset:0
    ds_read_b64_tr_b16 v[210:211], v129 offset:1536
    ds_read_b64_tr_b16 v[164:165], v124 offset:12288
    ds_read_b64_tr_b16 v[166:167], v125 offset:13824
    s_waitcnt lgkmcnt(13)
    v_mfma_f32_16x16x32_bf16 v[112:115], v[136:139], v[136:139], 0
    ds_read_b64_tr_b16 v[188:189], v126 offset:12288
    ds_read_b64_tr_b16 v[190:191], v127 offset:13824
    ds_read_b64_tr_b16 v[212:213], v128 offset:12288
    v_mfma_f32_16x16x32_bf16 v[116:119], v[52:55], v[136:139], 0
    ds_read_b64_tr_b16 v[214:215], v129 offset:13824
    ds_read_b64_tr_b16 v[168:169], v124 offset:24576
    ds_read_b64_tr_b16 v[170:171], v125 offset:26112
    s_waitcnt lgkmcnt(15)
    v_mfma_f32_16x16x32_bf16 v[112:115], v[140:143], v[140:143], v[112:115]
    ds_read_b64_tr_b16 v[192:193], v126 offset:24576
    ds_read_b64_tr_b16 v[194:195], v127 offset:26112
    ds_read_b64_tr_b16 v[216:217], v128 offset:24576
    v_mfma_f32_16x16x32_bf16 v[116:119], v[52:55], v[140:143], v[116:119]
    ds_read_b64_tr_b16 v[218:219], v129 offset:26112
    ds_read_b64_tr_b16 v[172:173], v124 offset:36864
    ds_read_b64_tr_b16 v[174:175], v125 offset:38400
    v_mfma_f32_16x16x32_bf16 v[112:115], v[144:147], v[144:147], v[112:115]
    ds_read_b64_tr_b16 v[196:197], v126 offset:36864
    ds_read_b64_tr_b16 v[198:199], v127 offset:38400
    ds_read_b64_tr_b16 v[220:221], v128 offset:36864
    v_mfma_f32_16x16x32_bf16 v[116:119], v[52:55], v[144:147], v[116:119]
    ds_read_b64_tr_b16 v[222:223], v129 offset:38400
    ds_read_b64_tr_b16 v[176:177], v124 offset:49152
    ds_read_b64_tr_b16 v[178:179], v125 offset:50688
    v_mfma_f32_16x16x32_bf16 v[112:115], v[148:151], v[148:151], v[112:115]
    ds_read_b64_tr_b16 v[200:201], v126 offset:49152
    ds_read_b64_tr_b16 v[202:203], v127 offset:50688
    ds_read_b64_tr_b16 v[224:225], v128 offset:49152
    v_mfma_f32_16x16x32_bf16 v[116:119], v[52:55], v[148:151], v[116:119]
    ds_read_b64_tr_b16 v[226:227], v129 offset:50688
    ds_read_b64_tr_b16 v[180:181], v124 offset:61440
    ds_read_b64_tr_b16 v[182:183], v125 offset:62976
    v_mfma_f32_16x16x32_bf16 v[112:115], v[152:155], v[152:155], v[112:115]
    ds_read_b64_tr_b16 v[204:205], v126 offset:61440
    ds_read_b64_tr_b16 v[206:207], v127 offset:62976
    ds_read_b64_tr_b16 v[228:229], v128 offset:61440
    v_mfma_f32_16x16x32_bf16 v[116:119], v[52:55], v[152:155], v[116:119]
    ds_read_b64_tr_b16 v[230:231], v129 offset:62976
    s_waitcnt lgkmcnt(15)
    v_mfma_f32_16x16x32_bf16 v[112:115], v[156:159], v[156:159], v[112:115]
    v_mfma_f32_16x16x32_bf16 v[116:119], v[52:55], v[156:159], v[116:119]
    v_mfma_f32_16x16x32_bf16 v[88:91], v[160:163], v[136:139], 0
    v_mfma_f32_16x16x32_bf16 v[100:103], v[160:163], v[52:55], 0
    v_mfma_f32_16x16x32_bf16 v[92:95], v[184:187], v[136:139], 0
    v_mfma_f32_16x16x32_bf16 v[104:107], v[184:187], v[52:55], 0
    v_mfma_f32_16x16x32_bf16 v[96:99], v[208:211], v[136:139], 0
    s_nop 1
    v_cndmask_b32 v3, 0, v112, s[44:45]
    v_cndmask_b32 v3, v3, v113, s[46:47]
    v_mfma_f32_16x16x32_bf16 v[108:111], v[208:211], v[52:55], 0
    v_cndmask_b32 v3, v3, v114, s[48:49]
    v_cndmask_b32 v3, v3, v115, s[50:51]
    v_mfma_f32_16x16x32_bf16 v[88:91], v[164:167], v[140:143], v[88:91]
    v_mfma_f32_16x16x32_bf16 v[100:103], v[164:167], v[52:55], v[100:103]
    v_mfma_f32_16x16x32_bf16 v[92:95], v[188:191], v[140:143], v[92:95]
    v_mfma_f32_16x16x4_f32 v[120:123], v60, v3, v[56:59]
    v_mfma_f32_16x16x32_bf16 v[104:107], v[188:191], v[52:55], v[104:107]
    v_mul_f32 v6, 0x3baaaaab, v116
    v_mfma_f32_16x16x32_bf16 v[96:99], v[212:215], v[140:143], v[96:99]
    v_mfma_f32_16x16x32_bf16 v[108:111], v[212:215], v[52:55], v[108:111]
    v_mfma_f32_16x16x32_bf16 v[88:91], v[168:171], v[144:147], v[88:91]
    v_mfma_f32_16x16x32_bf16 v[100:103], v[168:171], v[52:55], v[100:103]
    v_mfma_f32_16x16x32_bf16 v[92:95], v[192:195], v[144:147], v[92:95]
    v_mfma_f32_16x16x32_bf16 v[104:107], v[192:195], v[52:55], v[104:107]
    v_mfma_f32_16x16x32_bf16 v[96:99], v[216:219], v[144:147], v[96:99]
    v_mfma_f32_16x16x32_bf16 v[108:111], v[216:219], v[52:55], v[108:111]
    v_mfma_f32_16x16x32_bf16 v[88:91], v[172:175], v[148:151], v[88:91]
    v_mfma_f32_16x16x32_bf16 v[100:103], v[172:175], v[52:55], v[100:103]
    s_waitcnt lgkmcnt(14)
    v_mfma_f32_16x16x32_bf16 v[92:95], v[196:199], v[148:151], v[92:95]
    v_fma_f32 v5, -v116, v116, v120
    v_max_f32 v5, v5, v56
    v_mfma_f32_16x16x32_bf16 v[104:107], v[196:199], v[52:55], v[104:107]
    v_rsq_f32 v5, v5
    s_waitcnt lgkmcnt(12)
    v_mfma_f32_16x16x32_bf16 v[96:99], v[220:223], v[148:151], v[96:99]
    v_mul_f32 v5, v60, v5
    v_mfma_f32_16x16x32_bf16 v[108:111], v[220:223], v[52:55], v[108:111]
    s_waitcnt lgkmcnt(10)
    v_mfma_f32_16x16x32_bf16 v[88:91], v[176:179], v[152:155], v[88:91]
    v_mfma_f32_16x16x32_bf16 v[100:103], v[176:179], v[52:55], v[100:103]
    s_waitcnt lgkmcnt(8)
    v_mfma_f32_16x16x32_bf16 v[92:95], v[200:203], v[152:155], v[92:95]
    v_mfma_f32_16x16x32_bf16 v[104:107], v[200:203], v[52:55], v[104:107]
    s_waitcnt lgkmcnt(6)
    v_mfma_f32_16x16x32_bf16 v[96:99], v[224:227], v[152:155], v[96:99]
    v_mfma_f32_16x16x32_bf16 v[108:111], v[224:227], v[52:55], v[108:111]
    s_waitcnt lgkmcnt(4)
    v_mfma_f32_16x16x32_bf16 v[88:91], v[180:183], v[156:159], v[88:91]
    v_mfma_f32_16x16x32_bf16 v[100:103], v[180:183], v[52:55], v[100:103]
    s_waitcnt lgkmcnt(2)
    v_mfma_f32_16x16x32_bf16 v[92:95], v[204:207], v[156:159], v[92:95]
    v_mfma_f32_16x16x32_bf16 v[104:107], v[204:207], v[52:55], v[104:107]
    s_waitcnt lgkmcnt(0)
    v_mfma_f32_16x16x32_bf16 v[96:99], v[228:231], v[156:159], v[96:99]
    v_mfma_f32_16x16x32_bf16 v[108:111], v[228:231], v[52:55], v[108:111]
    s_load_dword s38, s[22:23], 0
    s_add_u32 m0, s41, 0
    s_add_u32 s58, s37, 0
    buffer_load_dwordx4 v22, s[24:27], s58 offen offset:0 nt lds
    buffer_load_dwordx4 v23, s[24:27], s58 offen offset:1024 nt lds
    buffer_load_dwordx4 v24, s[24:27], s58 offen offset:2048 nt lds
    buffer_load_dwordx4 v25, s[24:27], s58 offen offset:3072 nt lds
    s_add_u32 m0, s41, 4096
    s_nop 0
    buffer_load_dwordx4 v26, s[24:27], s58 offen offset:0 nt lds
    buffer_load_dwordx4 v27, s[24:27], s58 offen offset:1024 nt lds
    v_fma_f32 v88, -v6, v100, v88
    v_fma_f32 v89, -v6, v101, v89
    v_fma_f32 v90, -v6, v102, v90
    v_fma_f32 v91, -v6, v103, v91
    v_fma_f32 v92, -v6, v104, v92
    v_fma_f32 v93, -v6, v105, v93
    v_fma_f32 v94, -v6, v106, v94
    v_fma_f32 v95, -v6, v107, v95
    v_fma_f32 v96, -v6, v108, v96
    v_fma_f32 v97, -v6, v109, v97
    v_fma_f32 v98, -v6, v110, v98
    v_fma_f32 v99, -v6, v111, v99
    v_mul_f32 v88, v88, v5
    v_mul_f32 v89, v89, v5
    v_mul_f32 v90, v90, v5
    v_mul_f32 v91, v91, v5
    v_mul_f32 v92, v92, v5
    v_mul_f32 v93, v93, v5
    v_mul_f32 v94, v94, v5
    v_mul_f32 v95, v95, v5
    v_mul_f32 v96, v96, v5
    v_mul_f32 v97, v97, v5
    v_mul_f32 v98, v98, v5
    v_mul_f32 v99, v99, v5
    v_cvt_pk_bf16_f32 v100, v88, v89
    v_cvt_pk_bf16_f32 v101, v90, v91
    ds_write_b64 v134, v[100:101] offset:0
    v_cvt_pk_bf16_f32 v102, v92, v93
    v_cvt_pk_bf16_f32 v103, v94, v95
    ds_write_b64 v134, v[102:103] offset:512
    v_cvt_pk_bf16_f32 v104, v96, v97
    v_cvt_pk_bf16_f32 v105, v98, v99
    ds_write_b64 v134, v[104:105] offset:1024
    s_waitcnt vmcnt(12)
    s_waitcnt lgkmcnt(0)
    s_barrier
    ds_read_b128 v[136:139], v7 offset:0
    ds_read_b128 a[96:99], v130 offset:0
    ds_read_b128 v[140:143], v7 offset:1024
    ds_read_b128 a[100:103], v131 offset:0
    ds_read_b128 v[144:147], v7 offset:2048
    ds_read_b128 a[104:107], v130 offset:128
    ds_read_b128 v[148:151], v7 offset:3072
    ds_read_b128 a[108:111], v131 offset:128
    ds_read_b128 v[152:155], v7 offset:4096
    ds_read_b128 a[112:115], v130 offset:256
    ds_read_b128 v[156:159], v7 offset:5120
    ds_read_b128 a[116:119], v131 offset:256
    s_mul_i32 s39, s38, 0x9e3779b1
    s_add_u32 s39, s39, 0x7f4a7c16
    s_or_b32 s39, s39, 1
    s_add_u32 s43, s43, 16384
    v_mov_b32 v102, s39
    v_mov_b32 v103, s39
    s_waitcnt lgkmcnt(10)
    v_mfma_f32_16x16x32_bf16 v[88:91], a[96:99], v[136:139], 0
    s_waitcnt lgkmcnt(8)
    v_mfma_f32_16x16x32_bf16 v[88:91], a[100:103], v[140:143], v[88:91]
    s_waitcnt lgkmcnt(6)
    v_mfma_f32_16x16x32_bf16 v[88:91], a[104:107], v[144:147], v[88:91]
    s_waitcnt lgkmcnt(4)
    v_mfma_f32_16x16x32_bf16 v[88:91], a[108:111], v[148:151], v[88:91]
    s_waitcnt lgkmcnt(2)
    v_mfma_f32_16x16x32_bf16 v[88:91], a[112:115], v[152:155], v[88:91]
    s_waitcnt lgkmcnt(0)
    v_mfma_f32_16x16x32_bf16 v[88:91], a[116:119], v[156:159], v[88:91]
    s_nop 7
    v_mul_f32 v88, 0x419fecaf, v88
    v_mul_f32 v89, 0x419fecaf, v89
    v_mul_f32 v90, 0x419fecaf, v90
    v_mul_f32 v91, 0x419fecaf, v91
    v_cvt_pk_bf16_f32 v100, v88, v89
    v_cvt_pk_bf16_f32 v101, v90, v91
    buffer_store_dwordx4 v[100:103], v65, s[32:35], s43 offen sc1
    s_mov_b32 s43, -1
    s_barrier
    buffer_load_dwordx4 v28, s[24:27], s58 offen offset:2048 nt lds
    buffer_load_dwordx4 v29, s[24:27], s58 offen offset:3072 nt lds
    s_add_u32 m0, s41, 8192
    s_nop 0
    buffer_load_dwordx4 v30, s[24:27], s58 offen offset:0 nt lds
    buffer_load_dwordx4 v31, s[24:27], s58 offen offset:1024 nt lds
    buffer_load_dwordx4 v32, s[24:27], s58 offen offset:2048 nt lds
    buffer_load_dwordx4 v33, s[24:27], s58 offen offset:3072 nt lds
    s_add_u32 m0, s42, 0
    s_add_u32 s59, s37, 196608
    buffer_load_dwordx4 v22, s[24:27], s59 offen offset:0 nt lds
    buffer_load_dwordx4 v23, s[24:27], s59 offen offset:1024 nt lds
    buffer_load_dwordx4 v24, s[24:27], s59 offen offset:2048 nt lds
    buffer_load_dwordx4 v25, s[24:27], s59 offen offset:3072 nt lds
    s_add_u32 m0, s42, 4096
    s_nop 0
    buffer_load_dwordx4 v26, s[24:27], s59 offen offset:0 nt lds
    buffer_load_dwordx4 v27, s[24:27], s59 offen offset:1024 nt lds
    buffer_load_dwordx4 v28, s[24:27], s59 offen offset:2048 nt lds
    buffer_load_dwordx4 v29, s[24:27], s59 offen offset:3072 nt lds
    s_add_u32 m0, s42, 8192
    s_nop 0
    buffer_load_dwordx4 v30, s[24:27], s59 offen offset:0 nt lds
    buffer_load_dwordx4 v31, s[24:27], s59 offen offset:1024 nt lds
    buffer_load_dwordx4 v32, s[24:27], s59 offen offset:2048 nt lds
    buffer_load_dwordx4 v33, s[24:27], s59 offen offset:3072 nt lds
    s_branch L_join
L_c_slow:
    s_cmp_eq_u32 s43, 0
    s_cbranch_scc1 L_c_out
    s_mov_b32 s43, 0
    v_sub_u32 v49, v79, v41
    v_max_f32 v42, v42, v49
    v_sub_u32 v49, v83, v41
    v_max_f32 v42, v42, v49
    v_sub_u32 v49, v87, v41
    v_max_f32 v42, v42, v49
    v_sub_u32 v49, v91, v41
    v_max_f32 v42, v42, v49
    v_sub_u32 v49, v95, v41
    v_max_f32 v42, v42, v49
    v_sub_u32 v49, v99, v41
    v_max_f32 v42, v42, v49
    v_sub_u32 v49, v103, v41
    v_max_f32 v42, v42, v49
    v_sub_u32 v49, v107, v41
    v_max_f32 v42, v42, v49
    s_nop 1
    v_max_f32_dpp v42, v42, v42 row_ror:8 row_mask:0xf bank_mask:0xf
    v_mov_b32 v48, v42
    s_nop 1
    v_permlane32_swap_b32 v42, v48
    v_max_f32 v42, v42, v48
    v_mov_b32 v48, v42
    s_nop 1
    v_permlane16_swap_b32 v42, v48
    v_max_f32 v42, v42, v48
    s_lshl_b32 s56, s3, 2
    v_add_u32 v48, s56, v46
    ds_write_b32 v48, v42 offset:1024
    s_waitcnt lgkmcnt(0)
    s_barrier
    ds_read_b128 v[48:51], v46 offset:1024
    v_mov_b32 v16, 0
    v_mov_b32 v17, 0
    v_mov_b32 v18, 0
    v_mov_b32 v19, 0
    v_mov_b32 v20, 0
    v_mov_b32 v21, 0
    v_mov_b32 v22, 0
    s_mov_b64 s[6:7], -1
    s_mov_b64 s[24:25], 0
    s_mov_b64 s[8:9], -1
    s_mov_b64 s[26:27], 0
    s_mov_b64 s[10:11], -1
    s_mov_b64 s[28:29], 0
    s_mov_b64 s[12:13], -1
    s_mov_b64 s[30:31], 0
    s_mov_b64 s[14:15], -1
    s_mov_b64 s[44:45], 0
    s_mov_b64 s[16:17], -1
    s_mov_b64 s[46:47], 0
    s_mov_b64 s[36:37], -1
    s_mov_b64 s[48:49], 0
    s_mov_b64 s[40:41], -1
    s_mov_b64 s[50:51], 0
    s_waitcnt lgkmcnt(0)
    v_max3_f32 v42, v48, v49, v50
    v_max_f32 v42, v42, v51
    s_branch L_c_acc
L_qk_retry:
    s_mov_b32 s53, 0
L_qk_again:
    s_mul_i32 s56, s3, 3072
    s_add_u32 s56, s56, 16384
    buffer_load_dwordx4 v[120:123], v65, s[32:35], s56 offen offset:0 sc1
    buffer_load_dwordx4 v[124:127], v65, s[32:35], s56 offen offset:1024 sc1
    buffer_load_dwordx4 v[128:131], v65, s[32:35], s56 offen offset:2048 sc1
    s_add_u32 s53, s53, 1
    s_waitcnt vmcnt(0)
    v_xor_b32 v1, s39, v122
    v_xor_b32 v2, s39, v126
    v_xor_b32 v3, s39, v130
    v_or3_b32 v1, v1, v2, v3
    v_cmp_ne_u32 vcc, 0, v1
    s_cbranch_vccz L_qk_ok
    s_cmp_lt_u32 s53, 65536
    s_cbranch_scc1 L_qk_again
    s_branch L_qk_ok
L_fl_retry:
    s_mov_b32 s53, 0
L_fl_again:
    buffer_load_dword v244, v245, s[32:35], 0 offen offset:128 sc1
    s_add_u32 s53, s53, 1
    s_waitcnt vmcnt(0)
    v_cmp_ne_u32 vcc, s39, v244
    s_cbranch_vccz L_fl_ok
    s_cmp_lt_u32 s53, 65536
    s_cbranch_scc1 L_fl_again
    s_branch L_fl_ok
L_site0:
    s_call_b64 s[54:55], L_rare1
    s_branch L_back0
L_site1:
    s_call_b64 s[54:55], L_rare0
    s_branch L_back1
L_site2:
    s_call_b64 s[54:55], L_rare1
    s_branch L_back2
L_site3:
    s_call_b64 s[54:55], L_rare0
    s_branch L_back3
L_site4:
    s_call_b64 s[54:55], L_rare1
    s_branch L_back4
L_site5:
    s_call_b64 s[54:55], L_rare0
    s_branch L_back5
L_site6:
    s_call_b64 s[54:55], L_rare1
    s_branch L_back6
L_site7:
    s_call_b64 s[54:55], L_rare0
    s_branch L_back7
L_site8:
    s_call_b64 s[54:55], L_rare1
    s_branch L_back8
L_site9:
    s_call_b64 s[54:55], L_rare0
    s_branch L_back9
L_site10:
    s_call_b64 s[54:55], L_rare1
    s_branch L_back10
L_site11:
    s_call_b64 s[54:55], L_rare0
    s_branch L_back11
L_site12:
    s_call_b64 s[54:55], L_rare1
    s_branch L_back12
L_site13:
    s_call_b64 s[54:55], L_rare0
    s_branch L_back13
L_site14:
    s_call_b64 s[54:55], L_rare1
    s_branch L_back14
L_rare0:
    s_nop 7
    s_nop 7
    v_mov_b32 v2, v1
    s_nop 1
    v_permlane32_swap_b32 v1, v2
    v_max_f32 v1, v1, v2
    v_mov_b32 v2, v1
    s_nop 1
    v_permlane16_swap_b32 v1, v2
    v_max_f32 v1, v1, v2
    v_max_f32 v1, 0, v1
    v_sub_f32 v62, v62, v1
    v_sub_f32 v88, v88, v1
    v_sub_f32 v89, v89, v1
    v_sub_f32 v90, v90, v1
    v_sub_f32 v91, v91, v1
    v_sub_f32 v1, 0, v1
    v_exp_f32 v1, v1
    s_nop 0
    v_mul_f32 v63, v63, v1
    v_mul_f32 v64, v64, v1
    v_mul_f32 v68, v68, v1
    v_mul_f32 v69, v69, v1
    v_mul_f32 v70, v70, v1
    v_mul_f32 v71, v71, v1
    v_accvgpr_read_b32 v2, a0
    v_mul_f32 v2, v2, v1
    v_accvgpr_write_b32 a0, v2
    v_accvgpr_read_b32 v2, a1
    v_mul_f32 v2, v2, v1
    v_accvgpr_write_b32 a1, v2
    v_accvgpr_read_b32 v2, a2
    v_mul_f32 v2, v2, v1
    v_accvgpr_write_b32 a2, v2
    v_accvgpr_read_b32 v2, a3
    v_mul_f32 v2, v2, v1
    v_accvgpr_write_b32 a3, v2
    v_accvgpr_read_b32 v2, a4
    v_mul_f32 v2, v2, v1
    v_accvgpr_write_b32 a4, v2
    v_accvgpr_read_b32 v2, a5
    v_mul_f32 v2, v2, v1
    v_accvgpr_write_b32 a5, v2
    v_accvgpr_read_b32 v2, a6
    v_mul_f32 v2, v2, v1
    v_accvgpr_write_b32 a6, v2
    v_accvgpr_read_b32 v2, a7
    v_mul_f32 v2, v2, v1
    v_accvgpr_write_b32 a7, v2
    v_accvgpr_read_b32 v2, a8
    v_mul_f32 v2, v2, v1
    v_accvgpr_write_b32 a8, v2
    v_accvgpr_read_b32 v2, a9
    v_mul_f32 v2, v2, v1
    v_accvgpr_write_b32 a9, v2
    v_accvgpr_read_b32 v2, a10
    v_mul_f32 v2, v2, v1
    v_accvgpr_write_b32 a10, v2
    v_accvgpr_read_b32 v2, a11
    v_mul_f32 v2, v2, v1
    v_accvgpr_write_b32 a11, v2
    v_accvgpr_read_b32 v2, a12
    v_mul_f32 v2, v2, v1
    v_accvgpr_write_b32 a12, v2
    v_accvgpr_read_b32 v2, a13
    v_mul_f32 v2, v2, v1
    v_accvgpr_write_b32 a13, v2
    v_accvgpr_read_b32 v2, a14
    v_mul_f32 v2, v2, v1
    v_accvgpr_write_b32 a14, v2
    v_accvgpr_read_b32 v2, a15
    v_mul_f32 v2, v2, v1
    v_accvgpr_write_b32 a15, v2
    v_accvgpr_read_b32 v2, a16
    v_mul_f32 v2, v2, v1
    v_accvgpr_write_b32 a16, v2
    v_accvgpr_read_b32 v2, a17
    v_mul_f32 v2, v2, v1
    v_accvgpr_write_b32 a17, v2
    v_accvgpr_read_b32 v2, a18
    v_mul_f32 v2, v2, v1
    v_accvgpr_write_b32 a18, v2
    v_accvgpr_read_b32 v2, a19
    v_mul_f32 v2, v2, v1
    v_accvgpr_write_b32 a19, v2
    v_accvgpr_read_b32 v2, a20
    v_mul_f32 v2, v2, v1
    v_accvgpr_write_b32 a20, v2
    v_accvgpr_read_b32 v2, a21
    v_mul_f32 v2, v2, v1
    v_accvgpr_write_b32 a21, v2
    v_accvgpr_read_b32 v2, a22
    v_mul_f32 v2, v2, v1
    v_accvgpr_write_b32 a22, v2
    v_accvgpr_read_b32 v2, a23
    v_mul_f32 v2, v2, v1
    v_accvgpr_write_b32 a23, v2
    v_accvgpr_read_b32 v2, a24
    v_mul_f32 v2, v2, v1
    v_accvgpr_write_b32 a24, v2
    v_accvgpr_read_b32 v2, a25
    v_mul_f32 v2, v2, v1
    v_accvgpr_write_b32 a25, v2
    v_accvgpr_read_b32 v2, a26
    v_mul_f32 v2, v2, v1
    v_accvgpr_write_b32 a26, v2
    v_accvgpr_read_b32 v2, a27
    v_mul_f32 v2, v2, v1
    v_accvgpr_write_b32 a27, v2
    v_accvgpr_read_b32 v2, a28
    v_mul_f32 v2, v2, v1
    v_accvgpr_write_b32 a28, v2
    v_accvgpr_read_b32 v2, a29
    v_mul_f32 v2, v2, v1
    v_accvgpr_write_b32 a29, v2
    v_accvgpr_read_b32 v2, a30
    v_mul_f32 v2, v2, v1
    v_accvgpr_write_b32 a30, v2
    v_accvgpr_read_b32 v2, a31
    v_mul_f32 v2, v2, v1
    v_accvgpr_write_b32 a31, v2
    v_accvgpr_read_b32 v2, a32
    v_mul_f32 v2, v2, v1
    v_accvgpr_write_b32 a32, v2
    v_accvgpr_read_b32 v2, a33
    v_mul_f32 v2, v2, v1
    v_accvgpr_write_b32 a33, v2
    v_accvgpr_read_b32 v2, a34
    v_mul_f32 v2, v2, v1
    v_accvgpr_write_b32 a34, v2
    v_accvgpr_read_b32 v2, a35
    v_mul_f32 v2, v2, v1
    v_accvgpr_write_b32 a35, v2
    v_accvgpr_read_b32 v2, a36
    v_mul_f32 v2, v2, v1
    v_accvgpr_write_b32 a36, v2
    v_accvgpr_read_b32 v2, a37
    v_mul_f32 v2, v2, v1
    v_accvgpr_write_b32 a37, v2
    v_accvgpr_read_b32 v2, a38
    v_mul_f32 v2, v2, v1
    v_accvgpr_write_b32 a38, v2
    v_accvgpr_read_b32 v2, a39
    v_mul_f32 v2, v2, v1
    v_accvgpr_write_b32 a39, v2
    v_accvgpr_read_b32 v2, a40
    v_mul_f32 v2, v2, v1
    v_accvgpr_write_b32 a40, v2
    v_accvgpr_read_b32 v2, a41
    v_mul_f32 v2, v2, v1
    v_accvgpr_write_b32 a41, v2
    v_accvgpr_read_b32 v2, a42
    v_mul_f32 v2, v2, v1
    v_accvgpr_write_b32 a42, v2
    v_accvgpr_read_b32 v2, a43
    v_mul_f32 v2, v2, v1
    v_accvgpr_write_b32 a43, v2
    v_accvgpr_read_b32 v2, a44
    v_mul_f32 v2, v2, v1
    v_accvgpr_write_b32 a44, v2
    v_accvgpr_read_b32 v2, a45
    v_mul_f32 v2, v2, v1
    v_accvgpr_write_b32 a45, v2
    v_accvgpr_read_b32 v2, a46
    v_mul_f32 v2, v2, v1
    v_accvgpr_write_b32 a46, v2
    v_accvgpr_read_b32 v2, a47
    v_mul_f32 v2, v2, v1
    v_accvgpr_write_b32 a47, v2
    s_nop 3
    s_setpc_b64 s[54:55]
L_rare1:
    s_nop 7
    s_nop 7
    v_mov_b32 v2, v1
    s_nop 1
    v_permlane32_swap_b32 v1, v2
    v_max_f32 v1, v1, v2
    v_mov_b32 v2, v1
    s_nop 1
    v_permlane16_swap_b32 v1, v2
    v_max_f32 v1, v1, v2
    v_max_f32 v1, 0, v1
    v_sub_f32 v62, v62, v1
    v_sub_f32 v104, v104, v1
    v_sub_f32 v105, v105, v1
    v_sub_f32 v106, v106, v1
    v_sub_f32 v107, v107, v1
    v_sub_f32 v1, 0, v1
    v_exp_f32 v1, v1
    s_nop 0
    v_mul_f32 v63, v63, v1
    v_mul_f32 v64, v64, v1
    v_mul_f32 v68, v68, v1
    v_mul_f32 v69, v69, v1
    v_mul_f32 v70, v70, v1
    v_mul_f32 v71, v71, v1
    v_mul_f32 v88, v88, v1
    v_mul_f32 v89, v89, v1
    v_mul_f32 v90, v90, v1
    v_mul_f32 v91, v91, v1
    v_accvgpr_read_b32 v2, a0
    v_mul_f32 v2, v2, v1
    v_accvgpr_write_b32 a0, v2
    v_accvgpr_read_b32 v2, a1
    v_mul_f32 v2, v2, v1
    v_accvgpr_write_b32 a1, v2
    v_accvgpr_read_b32 v2, a2
    v_mul_f32 v2, v2, v1
    v_accvgpr_write_b32 a2, v2
    v_accvgpr_read_b32 v2, a3
    v_mul_f32 v2, v2, v1
    v_accvgpr_write_b32 a3, v2
    v_accvgpr_read_b32 v2, a4
    v_mul_f32 v2, v2, v1
    v_accvgpr_write_b32 a4, v2
    v_accvgpr_read_b32 v2, a5
    v_mul_f32 v2, v2, v1
    v_accvgpr_write_b32 a5, v2
    v_accvgpr_read_b32 v2, a6
    v_mul_f32 v2, v2, v1
    v_accvgpr_write_b32 a6, v2
    v_accvgpr_read_b32 v2, a7
    v_mul_f32 v2, v2, v1
    v_accvgpr_write_b32 a7, v2
    v_accvgpr_read_b32 v2, a8
    v_mul_f32 v2, v2, v1
    v_accvgpr_write_b32 a8, v2
    v_accvgpr_read_b32 v2, a9
    v_mul_f32 v2, v2, v1
    v_accvgpr_write_b32 a9, v2
    v_accvgpr_read_b32 v2, a10
    v_mul_f32 v2, v2, v1
    v_accvgpr_write_b32 a10, v2
    v_accvgpr_read_b32 v2, a11
    v_mul_f32 v2, v2, v1
    v_accvgpr_write_b32 a11, v2
    v_accvgpr_read_b32 v2, a12
    v_mul_f32 v2, v2, v1
    v_accvgpr_write_b32 a12, v2
    v_accvgpr_read_b32 v2, a13
    v_mul_f32 v2, v2, v1
    v_accvgpr_write_b32 a13, v2
    v_accvgpr_read_b32 v2, a14
    v_mul_f32 v2, v2, v1
    v_accvgpr_write_b32 a14, v2
    v_accvgpr_read_b32 v2, a15
    v_mul_f32 v2, v2, v1
    v_accvgpr_write_b32 a15, v2
    v_accvgpr_read_b32 v2, a16
    v_mul_f32 v2, v2, v1
    v_accvgpr_write_b32 a16, v2
    v_accvgpr_read_b32 v2, a17
    v_mul_f32 v2, v2, v1
    v_accvgpr_write_b32 a17, v2
    v_accvgpr_read_b32 v2, a18
    v_mul_f32 v2, v2, v1
    v_accvgpr_write_b32 a18, v2
    v_accvgpr_read_b32 v2, a19
    v_mul_f32 v2, v2, v1
    v_accvgpr_write_b32 a19, v2
    v_accvgpr_read_b32 v2, a20
    v_mul_f32 v2, v2, v1
    v_accvgpr_write_b32 a20, v2
    v_accvgpr_read_b32 v2, a21
    v_mul_f32 v2, v2, v1
    v_accvgpr_write_b32 a21, v2
    v_accvgpr_read_b32 v2, a22
    v_mul_f32 v2, v2, v1
    v_accvgpr_write_b32 a22, v2
    v_accvgpr_read_b32 v2, a23
    v_mul_f32 v2, v2, v1
    v_accvgpr_write_b32 a23, v2
    v_accvgpr_read_b32 v2, a24
    v_mul_f32 v2, v2, v1
    v_accvgpr_write_b32 a24, v2
    v_accvgpr_read_b32 v2, a25
    v_mul_f32 v2, v2, v1
    v_accvgpr_write_b32 a25, v2
    v_accvgpr_read_b32 v2, a26
    v_mul_f32 v2, v2, v1
    v_accvgpr_write_b32 a26, v2
    v_accvgpr_read_b32 v2, a27
    v_mul_f32 v2, v2, v1
    v_accvgpr_write_b32 a27, v2
    v_accvgpr_read_b32 v2, a28
    v_mul_f32 v2, v2, v1
    v_accvgpr_write_b32 a28, v2
    v_accvgpr_read_b32 v2, a29
    v_mul_f32 v2, v2, v1
    v_accvgpr_write_b32 a29, v2
    v_accvgpr_read_b32 v2, a30
    v_mul_f32 v2, v2, v1
    v_accvgpr_write_b32 a30, v2
    v_accvgpr_read_b32 v2, a31
    v_mul_f32 v2, v2, v1
    v_accvgpr_write_b32 a31, v2
    v_accvgpr_read_b32 v2, a32
    v_mul_f32 v2, v2, v1
    v_accvgpr_write_b32 a32, v2
    v_accvgpr_read_b32 v2, a33
    v_mul_f32 v2, v2, v1
    v_accvgpr_write_b32 a33, v2
    v_accvgpr_read_b32 v2, a34
    v_mul_f32 v2, v2, v1
    v_accvgpr_write_b32 a34, v2
    v_accvgpr_read_b32 v2, a35
    v_mul_f32 v2, v2, v1
    v_accvgpr_write_b32 a35, v2
    v_accvgpr_read_b32 v2, a36
    v_mul_f32 v2, v2, v1
    v_accvgpr_write_b32 a36, v2
    v_accvgpr_read_b32 v2, a37
    v_mul_f32 v2, v2, v1
    v_accvgpr_write_b32 a37, v2
    v_accvgpr_read_b32 v2, a38
    v_mul_f32 v2, v2, v1
    v_accvgpr_write_b32 a38, v2
    v_accvgpr_read_b32 v2, a39
    v_mul_f32 v2, v2, v1
    v_accvgpr_write_b32 a39, v2
    v_accvgpr_read_b32 v2, a40
    v_mul_f32 v2, v2, v1
    v_accvgpr_write_b32 a40, v2
    v_accvgpr_read_b32 v2, a41
    v_mul_f32 v2, v2, v1
    v_accvgpr_write_b32 a41, v2
    v_accvgpr_read_b32 v2, a42
    v_mul_f32 v2, v2, v1
    v_accvgpr_write_b32 a42, v2
    v_accvgpr_read_b32 v2, a43
    v_mul_f32 v2, v2, v1
    v_accvgpr_write_b32 a43, v2
    v_accvgpr_read_b32 v2, a44
    v_mul_f32 v2, v2, v1
    v_accvgpr_write_b32 a44, v2
    v_accvgpr_read_b32 v2, a45
    v_mul_f32 v2, v2, v1
    v_accvgpr_write_b32 a45, v2
    v_accvgpr_read_b32 v2, a46
    v_mul_f32 v2, v2, v1
    v_accvgpr_write_b32 a46, v2
    v_accvgpr_read_b32 v2, a47
    v_mul_f32 v2, v2, v1
    v_accvgpr_write_b32 a47, v2
    s_nop 3
    s_setpc_b64 s[54:55]
L_codeend:
.section .rodata,"a"
.p2align 6
.amdhsa_kernel standalone__detection_seg_dino__vision_kernel
  .amdhsa_next_free_vgpr 448
  .amdhsa_next_free_sgpr 102
  .amdhsa_accum_offset 256
  .amdhsa_group_segment_fixed_size 0
  .amdhsa_kernarg_size 80
  .amdhsa_user_sgpr_count 2
  .amdhsa_user_sgpr_kernarg_segment_ptr 1
  .amdhsa_system_sgpr_workgroup_id_x 1
  .amdhsa_float_denorm_mode_32 3
.end_amdhsa_kernel
```

```asm
; @launch grid=(256,1,1) block=(256,1,1) lds=163840
.amdgcn_target "amdgcn-amd-amdhsa--gfx950"
.text
.globl standalone__detection_seg_dino__vision_kernel
.p2align 8
.type standalone__detection_seg_dino__vision_kernel,@function
standalone__detection_seg_dino__vision_kernel:
    s_cmp_ge_u32 s2, 256
    s_cbranch_scc1 L_end
    s_load_dwordx16 s[4:19], s[0:1], 0
    s_load_dwordx4 s[20:23], s[0:1], 64
    s_getpc_b64 s[54:55]
L_pc_main:
    v_lshlrev_b32 v233, 7, v0
    v_min_u32 v233, L_codeend - L_pc_main - 4, v233
    global_load_dword v232, v233, s[54:55]
    s_mov_b64 s[100:101], s[54:55]
    v_lshrrev_b32 v1, 6, v0
    v_and_b32 v0, 63, v0
    v_readfirstlane_b32 s3, v1
    v_lshlrev_b32 v65, 4, v0
    v_lshrrev_b32 v1, 2, v0
    v_and_b32 v1, 14, v1
    s_mov_b32 s56, 0x5000
    v_bfe_u32 v2, s56, v1, 2
    v_lshlrev_b32 v2, 5, v2
    v_xor_b32 v16, v65, v2
    s_mov_b32 s56, 0xaa55
    v_bfe_u32 v2, s56, v1, 2
    v_lshlrev_b32 v2, 5, v2
    v_xor_b32 v17, v65, v2
    s_mov_b32 s56, 0xfffa
    v_bfe_u32 v2, s56, v1, 2
    v_lshlrev_b32 v2, 5, v2
    v_xor_b32 v18, v65, v2
    v_xor_b32 v19, 16, v16
    v_xor_b32 v20, 0x1010, v17
    v_xor_b32 v21, 0x1010, v18
    v_lshrrev_b32 v1, 3, v0
    v_and_b32 v1, 6, v1
    s_mov_b32 s56, 0x40
    v_bfe_u32 v2, s56, v1, 2
    v_lshlrev_b32 v2, 5, v2
    v_xor_b32 v22, v65, v2
    s_mov_b32 s56, 0xa5
    v_bfe_u32 v2, s56, v1, 2
    v_lshlrev_b32 v2, 5, v2
    v_xor_b32 v23, v65, v2
    s_mov_b32 s56, 0xfe
    v_bfe_u32 v2, s56, v1, 2
    v_lshlrev_b32 v2, 5, v2
    v_xor_b32 v24, v65, v2
    v_xor_b32 v25, 0x80, v22
    v_xor_b32 v26, 0x1080, v23
    v_xor_b32 v27, 0x1080, v24
    v_xor_b32 v28, 0x1010, v22
    v_xor_b32 v29, 0x1010, v23
    v_xor_b32 v30, 0x2010, v24
    v_xor_b32 v31, 0x2090, v22
    v_xor_b32 v32, 0x2090, v23
    v_xor_b32 v33, 0x2090, v24
    v_mov_b32 v248, 0x10000
    s_mul_i32 s36, s3, 6144
    s_mul_i32 s37, s3, 12288
    s_add_u32 s40, s36, 0
    s_add_u32 s41, s37, 24576
    s_add_u32 s42, s37, 73728
    s_mul_i32 s56, s2, 393216
    s_mul_i32 s57, s2, 98304
    s_waitcnt lgkmcnt(0)
    s_add_u32 s28, s8, s57
    s_addc_u32 s29, s9, 0
    s_mov_b32 s30, 98304
    s_mov_b32 s31, 0x20000
    s_add_u32 s24, s6, s56
    s_addc_u32 s25, s7, 0
    s_mov_b32 s26, 393216
    s_mov_b32 s27, 0x20000
    s_mov_b32 s32, s22
    s_mov_b32 s33, s23
    s_mov_b32 s34, 8388608
    s_mov_b32 s35, 0x20000
    s_and_b32 s56, s2, 7
    s_cmp_ge_u32 s56, 6
    s_cbranch_scc1 L_nopf
    s_cmp_ge_u32 s56, 3
    s_cselect_b32 s64, s16, s10
    s_cselect_b32 s65, s17, s11
    s_cselect_b32 s68, s14, s12
    s_cselect_b32 s69, s15, s13
    s_cselect_b32 s57, 3, 0
    s_sub_u32 s43, s56, s57
    s_mov_b32 s66, 73728
    s_mov_b32 s67, 0x20000
    s_mov_b32 s70, 73728
    s_mov_b32 s71, 0x20000
    s_mov_b32 s72, s4
    s_mov_b32 s73, s5
    s_mov_b32 s74, 6144
    s_mov_b32 s75, 0x20000
    s_lshr_b32 s57, s2, 3
    s_cmp_eq_u32 s3, 0
    s_cbranch_scc1 L_pf0
    s_cmp_eq_u32 s3, 1
    s_cbranch_scc0 L_pfdone
    s_mul_i32 s56, s43, 24576
    s_mul_i32 s58, s57, 768
    s_add_u32 s56, s56, s58
    s_lshl_b32 s57, s57, 8
    v_min_u32 v1, 5, v0
    v_lshlrev_b32 v1, 7, v1
    buffer_load_dword v234, v1, s[68:71], s56 offen
    v_min_u32 v2, 128, v1
    buffer_load_dword v235, v2, s[72:75], s57 offen
    s_branch L_pfdone
L_pf0:
    s_mul_i32 s57, s57, 2304
    v_min_u32 v1, 17, v0
    v_lshlrev_b32 v1, 7, v1
    buffer_load_dword v234, v1, s[64:67], s57 offen
L_pfdone:
    s_cmp_lt_u32 s2, 3
    s_cbranch_scc1 L_prod
    s_cmp_lt_u32 s2, 6
    s_cbranch_scc1 L_vprod
L_nopf:
    s_load_dword s38, s[22:23], 0
    s_add_u32 m0, s40, 0
    s_add_u32 s57, s36, 0
    buffer_load_dwordx4 v16, s[28:31], s57 offen offset:0 nt lds
    buffer_load_dwordx4 v17, s[28:31], s57 offen offset:1024 nt lds
    buffer_load_dwordx4 v18, s[28:31], s57 offen offset:2048 nt lds
    buffer_load_dwordx4 v19, s[28:31], s57 offen offset:3072 nt lds
    s_add_u32 m0, s40, 4096
    s_nop 0
    buffer_load_dwordx4 v20, s[28:31], s57 offen offset:0 nt lds
    buffer_load_dwordx4 v21, s[28:31], s57 offen offset:1024 nt lds
    s_mov_b32 s43, -1
    s_sub_u32 s59, s2, 64
    s_cmp_ge_u32 s59, 64
    s_cbranch_scc1 L_nocs
    s_mov_b32 s64, s4
    s_mov_b32 s65, s5
    s_mov_b32 s66, 6144
    s_mov_b32 s67, 0x20000
    s_mov_b32 s68, s18
    s_mov_b32 s69, s19
    s_mov_b32 s70, 6144
    s_mov_b32 s71, 0x20000
    v_bfe_u32 v1, v0, 2, 1
    v_mul_u32_u24 v2, 7, v1
    v_xor_b32 v2, v0, v2
    v_and_b32 v2, 3, v2
    s_lshr_b32 s56, s59, 4
    s_lshl_b32 s56, s56, 2
    v_add_u32 v2, s56, v2
    v_lshlrev_b32 v252, 2, v2
    v_lshrrev_b32 v3, 4, v0
    v_mad_u32_u24 v3, v1, 3, v3
    v_lshrrev_b32 v4, 1, v3
    v_and_b32 v3, 1, v3
    v_lshlrev_b32 v3, 2, v3
    v_lshl_add_u32 v3, v4, 5, v3
    v_bfe_u32 v4, v0, 3, 1
    v_lshl_add_u32 v3, v4, 1, v3
    v_mul_u32_u24 v2, 384, v2
    s_bfe_u32 s56, s59, 0x20002
    s_mul_i32 s56, s56, 96
    s_and_b32 s57, s59, 3
    s_lshl_b32 s57, s57, 3
    s_add_u32 s56, s56, s57
    v_add3_u32 v248, s56, v2, v3
    v_cmp_gt_u32 vcc, 48, v0
    v_mov_b32 v4, 0x10000
    s_lshl_b32 s56, s3, 2
    v_cndmask_b32 v248, v4, v248, vcc
    buffer_load_ushort v249, v248, s[64:67], 0 offen
    buffer_load_ushort v246, v248, s[68:71], 0 offen
    v_add_u32 v250, s56, v65
    v_and_b32 v251, 0x70, v65
L_nocs:
    s_add_u32 m0, s41, 0
    s_add_u32 s58, s37, 0
    buffer_load_dwordx4 v22, s[24:27], s58 offen offset:0 nt lds
    buffer_load_dwordx4 v23, s[24:27], s58 offen offset:1024 nt lds
    buffer_load_dwordx4 v24, s[24:27], s58 offen offset:2048 nt lds
    buffer_load_dwordx4 v25, s[24:27], s58 offen offset:3072 nt lds
    s_add_u32 m0, s41, 4096
    s_nop 0
    buffer_load_dwordx4 v26, s[24:27], s58 offen offset:0 nt lds
    buffer_load_dwordx4 v27, s[24:27], s58 offen offset:1024 nt lds
    buffer_load_dwordx4 v28, s[24:27], s58 offen offset:2048 nt lds
    buffer_load_dwordx4 v29, s[24:27], s58 offen offset:3072 nt lds
    s_add_u32 m0, s41, 8192
    s_nop 0
    buffer_load_dwordx4 v30, s[24:27], s58 offen offset:0 nt lds
    buffer_load_dwordx4 v31, s[24:27], s58 offen offset:1024 nt lds
    buffer_load_dwordx4 v32, s[24:27], s58 offen offset:2048 nt lds
    buffer_load_dwordx4 v33, s[24:27], s58 offen offset:3072 nt lds
    s_add_u32 m0, s42, 0
    s_add_u32 s59, s37, 196608
    buffer_load_dwordx4 v22, s[24:27], s59 offen offset:0 nt lds
    buffer_load_dwordx4 v23, s[24:27], s59 offen offset:1024 nt lds
    buffer_load_dwordx4 v24, s[24:27], s59 offen offset:2048 nt lds
    buffer_load_dwordx4 v25, s[24:27], s59 offen offset:3072 nt lds
    s_add_u32 m0, s42, 4096
    s_nop 0
    buffer_load_dwordx4 v26, s[24:27], s59 offen offset:0 nt lds
    buffer_load_dwordx4 v27, s[24:27], s59 offen offset:1024 nt lds
    buffer_load_dwordx4 v28, s[24:27], s59 offen offset:2048 nt lds
    buffer_load_dwordx4 v29, s[24:27], s59 offen offset:3072 nt lds
    s_add_u32 m0, s42, 8192
    s_nop 0
    buffer_load_dwordx4 v30, s[24:27], s59 offen offset:0 nt lds
    buffer_load_dwordx4 v31, s[24:27], s59 offen offset:1024 nt lds
    buffer_load_dwordx4 v32, s[24:27], s59 offen offset:2048 nt lds
    buffer_load_dwordx4 v33, s[24:27], s59 offen offset:3072 nt lds
    v_and_b32 v1, 15, v0
    v_lshrrev_b32 v2, 4, v0
    v_lshrrev_b32 v6, 1, v2
    v_and_b32 v3, 1, v2
    v_lshl_or_b32 v3, v3, 1, v6
    v_lshrrev_b32 v4, 2, v0
    v_bfe_u32 v5, v0, 1, 1
    v_lshrrev_b32 v6, 3, v1
    v_and_or_b32 v6, v1, 6, v6
    v_xor_b32 v6, v6, v3
    v_mul_u32_u24 v7, 384, v1
    v_lshl_add_u32 v6, v6, 4, v7
    v_add_u32 v34, s40, v6
    v_xor_b32 v35, 64, v34
    v_lshrrev_b32 v6, 3, v1
    v_and_b32 v7, 7, v1
    v_lshl_or_b32 v6, v7, 1, v6
    v_xor_b32 v6, v6, v3
    v_mul_u32_u24 v7, 768, v1
    v_lshl_add_u32 v6, v6, 4, v7
    v_add_u32 v40, s41, v6
    v_xor_b32 v41, 0x40, v40
    v_xor_b32 v42, 0x80, v40
    v_xor_b32 v43, 0xc0, v40
    v_and_b32 v2, 1, v0
    v_lshlrev_b32 v2, 3, v2
    v_lshrrev_b32 v6, 3, v4
    v_and_or_b32 v6, v4, 6, v6
    v_xor_b32 v6, v6, v5
    v_mul_u32_u24 v7, 384, v4
    v_lshl_add_u32 v6, v6, 4, v7
    v_add3_u32 v36, s40, v6, v2
    v_xor_b32 v37, 0x20, v36
    v_xor_b32 v38, 0x40, v36
    v_xor_b32 v39, 0x60, v36
    v_lshrrev_b32 v6, 3, v4
    v_and_b32 v7, 7, v4
    v_lshl_or_b32 v6, v7, 1, v6
    v_xor_b32 v6, v6, v5
    v_mul_u32_u24 v7, 768, v4
    v_lshl_add_u32 v6, v6, 4, v7
    v_add3_u32 v44, s41, v6, v2
    v_xor_b32 v45, 0x20, v44
    v_xor_b32 v46, 0x40, v44
    v_xor_b32 v47, 0x60, v44
    v_xor_b32 v48, 0x80, v44
    v_xor_b32 v49, 0xa0, v44
    v_xor_b32 v50, 0xc0, v44
    v_xor_b32 v51, 0xe0, v44
    v_mov_b32 v52, 0x3f803f80
    v_mov_b32 v56, 0x3ebcbe62
    s_mov_b32 s44, 0x100001
    s_mov_b32 s45, 0x10000100
    v_mov_b32 v53, 0x3f803f80
    v_mov_b32 v57, 0x3ebcbe62
    s_mov_b32 s46, 0x200002
    s_mov_b32 s47, 0x20000200
    v_mov_b32 v54, 0x3f803f80
    v_mov_b32 v58, 0x3ebcbe62
    s_mov_b32 s48, 0x400004
    s_mov_b32 s49, 0x40000400
    v_mov_b32 v55, 0x3f803f80
    v_mov_b32 v59, 0x3ebcbe62
    s_mov_b32 s50, 0x800008
    s_mov_b32 s51, 0x80000800
    v_mov_b32 v60, 0x43400000
    v_lshrrev_b32 v1, 5, v0
    v_lshlrev_b32 v1, 8, v1
    v_and_b32 v2, 15, v0
    v_lshl_add_u32 v1, v2, 4, v1
    v_bfe_u32 v2, v0, 4, 1
    v_lshl_add_u32 v1, v2, 3, v1
    s_mul_i32 s56, s3, 1536
    s_add_u32 s56, s56, 147456
    v_add_u32 v236, s56, v1
    s_mul_i32 s56, s3, 3072
    s_add_u32 s56, s56, 24576
    v_add_u32 v237, s56, v65
    v_add_u32 v238, s41, v65
    s_lshl_b32 s56, s3, 10
    v_add_u32 v240, 159744, v65
    v_add_u32 v239, s56, v240
    v_add_u32 v241, 147456, v65
    v_bfe_u32 v1, v0, 2, 2
    v_lshlrev_b32 v1, 19, v1
    v_lshrrev_b32 v2, 4, v0
    v_lshl_or_b32 v1, v2, 15, v1
    v_and_b32 v2, 3, v0
    v_lshl_or_b32 v242, v2, 4, v1
    v_xor_b32 v243, 0x70, v242
    s_mul_i32 s56, s3, 3
    v_min_u32 v1, 2, v0
    v_add_u32 v1, s56, v1
    v_lshlrev_b32 v245, 7, v1
    s_mov_b32 s52, 0x41c00000
L_join:
    s_mul_i32 s60, s3, 18432
    s_mov_b32 s72, s22
    s_mov_b32 s73, s23
    s_mov_b32 s74, 8388608
    s_mov_b32 s75, 0x20000
    s_cmp_lt_u32 s2, 6
    s_cselect_b32 s74, 0, s74
    s_waitcnt vmcnt(24)
    ds_read_b128 a[48:51], v34 offset:0
    ds_read_b128 a[52:55], v35 offset:0
    ds_read_b128 a[56:59], v34 offset:128
    ds_read_b128 a[60:63], v35 offset:128
    ds_read_b128 a[64:67], v34 offset:256
    ds_read_b128 a[68:71], v35 offset:256
    s_waitcnt lgkmcnt(0)
    v_mfma_f32_16x16x32_bf16 v[84:87], a[48:51], a[48:51], 0
    ds_read_b64_tr_b16 a[72:73], v36 offset:0
    ds_read_b64_tr_b16 a[74:75], v37 offset:0
    v_mfma_f32_16x16x32_bf16 v[80:83], a[48:51], v[52:55], 0
    ds_read_b64_tr_b16 a[76:77], v38 offset:0
    ds_read_b64_tr_b16 a[78:79], v39 offset:0
    v_mfma_f32_16x16x32_bf16 v[84:87], a[52:55], a[52:55], v[84:87]
    ds_read_b64_tr_b16 a[80:81], v36 offset:128
    ds_read_b64_tr_b16 a[82:83], v37 offset:128
    v_mfma_f32_16x16x32_bf16 v[80:83], a[52:55], v[52:55], v[80:83]
    ds_read_b64_tr_b16 a[84:85], v38 offset:128
    ds_read_b64_tr_b16 a[86:87], v39 offset:128
    v_mfma_f32_16x16x32_bf16 v[84:87], a[56:59], a[56:59], v[84:87]
    ds_read_b64_tr_b16 a[88:89], v36 offset:256
    ds_read_b64_tr_b16 a[90:91], v37 offset:256
    v_mfma_f32_16x16x32_bf16 v[80:83], a[56:59], v[52:55], v[80:83]
    ds_read_b64_tr_b16 a[92:93], v38 offset:256
    ds_read_b64_tr_b16 a[94:95], v39 offset:256
    v_mfma_f32_16x16x32_bf16 v[84:87], a[60:63], a[60:63], v[84:87]
    v_mfma_f32_16x16x32_bf16 v[80:83], a[60:63], v[52:55], v[80:83]
    v_mfma_f32_16x16x32_bf16 v[84:87], a[64:67], a[64:67], v[84:87]
    v_mfma_f32_16x16x32_bf16 v[80:83], a[64:67], v[52:55], v[80:83]
    v_mfma_f32_16x16x32_bf16 v[84:87], a[68:71], a[68:71], v[84:87]
    v_mfma_f32_16x16x32_bf16 v[80:83], a[68:71], v[52:55], v[80:83]
    s_waitcnt lgkmcnt(0)
    s_mul_i32 s39, s38, 0x9e3779b1
    s_add_u32 s39, s39, 0x7f4a7c16
    s_or_b32 s39, s39, 1
    s_barrier
    s_add_u32 m0, s40, 0
    s_add_u32 s57, s36, 24576
    buffer_load_dwordx4 v16, s[28:31], s57 offen offset:0 nt lds
    buffer_load_dwordx4 v17, s[28:31], s57 offen offset:1024 nt lds
    buffer_load_dwordx4 v18, s[28:31], s57 offen offset:2048 nt lds
    buffer_load_dwordx4 v19, s[28:31], s57 offen offset:3072 nt lds
    s_add_u32 m0, s40, 4096
    s_nop 0
    buffer_load_dwordx4 v20, s[28:31], s57 offen offset:0 nt lds
    buffer_load_dwordx4 v21, s[28:31], s57 offen offset:1024 nt lds
    s_waitcnt vmcnt(18)
    ds_read_b128 a[96:99], v40 offset:0
    ds_read_b128 a[100:103], v41 offset:0
    ds_read_b128 a[104:107], v42 offset:0
    ds_read_b128 a[108:111], v43 offset:0
    ds_read_b128 a[112:115], v40 offset:256
    ds_read_b128 a[116:119], v41 offset:256
    ds_read_b128 a[120:123], v42 offset:256
    ds_read_b128 a[124:127], v43 offset:256
    ds_read_b128 a[128:131], v40 offset:512
    ds_read_b128 a[132:135], v41 offset:512
    ds_read_b128 a[136:139], v42 offset:512
    ds_read_b128 a[140:143], v43 offset:512
    ds_read_b64_tr_b16 a[144:145], v44 offset:0
    ds_read_b64_tr_b16 a[146:147], v48 offset:256
    ds_read_b64_tr_b16 a[148:149], v45 offset:0
    ds_read_b64_tr_b16 a[150:151], v49 offset:256
    ds_read_b64_tr_b16 a[152:153], v46 offset:0
    ds_read_b64_tr_b16 a[154:155], v50 offset:256
    ds_read_b64_tr_b16 a[156:157], v47 offset:0
    ds_read_b64_tr_b16 a[158:159], v51 offset:256
    ds_read_b64_tr_b16 a[160:161], v48 offset:0
    ds_read_b64_tr_b16 a[162:163], v44 offset:512
    ds_read_b64_tr_b16 a[164:165], v49 offset:0
    ds_read_b64_tr_b16 a[166:167], v45 offset:512
    ds_read_b64_tr_b16 a[168:169], v50 offset:0
    ds_read_b64_tr_b16 a[170:171], v46 offset:512
    ds_read_b64_tr_b16 a[172:173], v51 offset:0
    ds_read_b64_tr_b16 a[174:175], v47 offset:512
    ds_read_b64_tr_b16 a[176:177], v44 offset:256
    ds_read_b64_tr_b16 a[178:179], v48 offset:512
    ds_read_b64_tr_b16 a[180:181], v45 offset:256
    ds_read_b64_tr_b16 a[182:183], v49 offset:512
    ds_read_b64_tr_b16 a[184:185], v46 offset:256
    ds_read_b64_tr_b16 a[186:187], v50 offset:512
    ds_read_b64_tr_b16 a[188:189], v47 offset:256
    ds_read_b64_tr_b16 a[190:191], v51 offset:512
    s_waitcnt lgkmcnt(0)
    s_cmp_ge_u32 s43, 3
    s_cbranch_scc1 L_v_nofl
    s_mul_i32 s56, s3, 3
    s_add_u32 s56, s56, s43
    s_lshl_b32 s56, s56, 7
    v_mov_b32 v1, s39
    v_mov_b32 v2, 0
    s_mov_b64 exec, 1
    s_waitcnt vmcnt(12)
    buffer_store_dword v1, v2, s[32:35], s56 offen offset:128 sc1
    s_mov_b64 exec, -1
L_v_nofl:
    s_mul_i32 s56, s3, 3072
    s_add_u32 s56, s56, 16384
    buffer_load_dwordx4 v[120:123], v65, s[32:35], s56 offen offset:0 sc1
    buffer_load_dwordx4 v[124:127], v65, s[32:35], s56 offen offset:1024 sc1
    buffer_load_dwordx4 v[128:131], v65, s[32:35], s56 offen offset:2048 sc1
    s_barrier
    s_add_u32 m0, s41, 0
    s_add_u32 s58, s37, 49152
    buffer_load_dwordx4 v22, s[24:27], s58 offen offset:0 nt lds
    buffer_load_dwordx4 v23, s[24:27], s58 offen offset:1024 nt lds
    buffer_load_dwordx4 v24, s[24:27], s58 offen offset:2048 nt lds
    buffer_load_dwordx4 v25, s[24:27], s58 offen offset:3072 nt lds
    s_add_u32 m0, s41, 4096
    s_nop 0
    buffer_load_dwordx4 v26, s[24:27], s58 offen offset:0 nt lds
    buffer_load_dwordx4 v27, s[24:27], s58 offen offset:1024 nt lds
    buffer_load_dwordx4 v28, s[24:27], s58 offen offset:2048 nt lds
    buffer_load_dwordx4 v29, s[24:27], s58 offen offset:3072 nt lds
    s_add_u32 m0, s41, 8192
    s_nop 0
    buffer_load_dwordx4 v30, s[24:27], s58 offen offset:0 nt lds
    buffer_load_dwordx4 v31, s[24:27], s58 offen offset:1024 nt lds
    buffer_load_dwordx4 v32, s[24:27], s58 offen offset:2048 nt lds
    buffer_load_dwordx4 v33, s[24:27], s58 offen offset:3072 nt lds
    s_mul_i32 s56, s3, 1536
    v_lshlrev_b32 v5, 3, v0
    v_add_u32 v5, 153600, v5
    v_add_u32 v4, s56, v5
    s_waitcnt vmcnt(12)
    v_xor_b32 v1, s39, v122
    v_xor_b32 v2, s39, v126
    v_xor_b32 v3, s39, v130
    v_or3_b32 v1, v1, v2, v3
    v_cmp_ne_u32 vcc, 0, v1
    s_cbranch_vccnz L_qk_retry
L_qk_ok:
    ds_write_b64 v4, v[120:121] offset:0
    ds_write_b64 v4, v[124:125] offset:512
    ds_write_b64 v4, v[128:129] offset:1024
    s_waitcnt lgkmcnt(0)
    s_barrier
    ds_read2st64_b64 v[136:139], v5 offset0:0 offset1:1
    ds_read2st64_b64 v[140:143], v5 offset0:2 offset1:3
    ds_read2st64_b64 v[144:147], v5 offset0:4 offset1:5
    ds_read2st64_b64 v[148:151], v5 offset0:6 offset1:7
    ds_read2st64_b64 v[152:155], v5 offset0:8 offset1:9
    ds_read2st64_b64 v[156:159], v5 offset0:10 offset1:11
    s_waitcnt lgkmcnt(5)
    v_mfma_f32_16x16x32_bf16 v[120:123], v[52:55], v[136:139], 0
    v_mfma_f32_16x16x32_bf16 v[76:79], a[48:51], v[136:139], 0
    s_waitcnt lgkmcnt(4)
    v_mfma_f32_16x16x32_bf16 v[120:123], v[52:55], v[140:143], v[120:123]
    v_mfma_f32_16x16x32_bf16 v[76:79], a[52:55], v[140:143], v[76:79]
    s_waitcnt lgkmcnt(3)
    v_mfma_f32_16x16x32_bf16 v[120:123], v[52:55], v[144:147], v[120:123]
    v_mfma_f32_16x16x32_bf16 v[76:79], a[56:59], v[144:147], v[76:79]
    s_waitcnt lgkmcnt(2)
    v_mfma_f32_16x16x32_bf16 v[120:123], v[52:55], v[148:151], v[120:123]
    v_mfma_f32_16x16x32_bf16 v[76:79], a[60:63], v[148:151], v[76:79]
    s_waitcnt lgkmcnt(1)
    v_mfma_f32_16x16x32_bf16 v[120:123], v[52:55], v[152:155], v[120:123]
    v_mfma_f32_16x16x32_bf16 v[76:79], a[64:67], v[152:155], v[76:79]
    s_waitcnt lgkmcnt(0)
    v_mfma_f32_16x16x32_bf16 v[120:123], v[52:55], v[156:159], v[120:123]
    v_mfma_f32_16x16x32_bf16 v[76:79], a[68:71], v[156:159], v[76:79]
    s_nop 6
    v_mul_f32 v61, 0x3baaaaab, v120
    v_mfma_f32_16x16x32_bf16 v[96:99], a[96:99], a[96:99], v[84:87]
    v_mfma_f32_16x16x32_bf16 v[100:103], a[96:99], a[48:51], 0
    v_mfma_f32_16x16x32_bf16 v[96:99], a[100:103], a[100:103], v[96:99]
    v_mfma_f32_16x16x32_bf16 v[100:103], a[100:103], a[52:55], v[100:103]
    v_mfma_f32_16x16x32_bf16 v[96:99], a[104:107], a[104:107], v[96:99]
    v_mfma_f32_16x16x32_bf16 v[100:103], a[104:107], a[56:59], v[100:103]
    v_mfma_f32_16x16x32_bf16 v[96:99], a[108:111], a[108:111], v[96:99]
    v_mfma_f32_16x16x32_bf16 v[100:103], a[108:111], a[60:63], v[100:103]
    v_mfma_f32_16x16x32_bf16 v[96:99], a[112:115], a[112:115], v[96:99]
    v_mfma_f32_16x16x32_bf16 v[100:103], a[112:115], a[64:67], v[100:103]
    v_mfma_f32_16x16x32_bf16 v[96:99], a[116:119], a[116:119], v[96:99]
    v_mfma_f32_16x16x32_bf16 v[100:103], a[116:119], a[68:71], v[100:103]
    v_mfma_f32_16x16x32_bf16 v[92:95], a[96:99], v[52:55], v[80:83]
    v_mfma_f32_16x16x32_bf16 v[92:95], a[100:103], v[52:55], v[92:95]
    v_mfma_f32_16x16x32_bf16 v[92:95], a[104:107], v[52:55], v[92:95]
    v_mfma_f32_16x16x32_bf16 v[92:95], a[108:111], v[52:55], v[92:95]
    s_nop 3
    v_fma_f32 v96, v100, 2.0, v96
    v_fma_f32 v97, v101, 2.0, v97
    v_mfma_f32_16x16x32_bf16 v[92:95], a[112:115], v[52:55], v[92:95]
    v_fma_f32 v98, v102, 2.0, v98
    v_fma_f32 v99, v103, 2.0, v99
    v_mfma_f32_16x16x32_bf16 v[92:95], a[116:119], v[52:55], v[92:95]
    v_cndmask_b32 v3, 0, v96, s[44:45]
    v_cndmask_b32 v3, v3, v97, s[46:47]
    v_mfma_f32_16x16x32_bf16 v[88:91], a[96:99], v[136:139], v[76:79]
    v_cndmask_b32 v3, v3, v98, s[48:49]
    v_cndmask_b32 v3, v3, v99, s[50:51]
    v_mfma_f32_16x16x32_bf16 v[88:91], a[100:103], v[140:143], v[88:91]
    s_nop 0
    s_nop 0
    v_mfma_f32_16x16x32_bf16 v[88:91], a[104:107], v[144:147], v[88:91]
    v_mfma_f32_16x16x4_f32 v[120:123], v3, v60, v[56:59]
    v_mfma_f32_16x16x32_bf16 v[88:91], a[108:111], v[148:151], v[88:91]
    v_mfma_f32_16x16x32_bf16 v[88:91], a[112:115], v[152:155], v[88:91]
    v_mfma_f32_16x16x32_bf16 v[88:91], a[116:119], v[156:159], v[88:91]
    v_mfma_f32_16x16x32_bf16 v[112:115], a[120:123], a[120:123], v[84:87]
    v_mfma_f32_16x16x32_bf16 v[116:119], a[120:123], a[48:51], 0
    v_mfma_f32_16x16x32_bf16 v[112:115], a[124:127], a[124:127], v[112:115]
    v_mfma_f32_16x16x32_bf16 v[116:119], a[124:127], a[52:55], v[116:119]
    s_nop 2
    v_fma_f32 v128, -v92, v92, v120
    v_fma_f32 v129, -v93, v93, v121
    v_mfma_f32_16x16x32_bf16 v[112:115], a[128:131], a[128:131], v[112:115]
    v_fma_f32 v130, -v94, v94, v122
    v_fma_f32 v131, -v95, v95, v123
    v_mfma_f32_16x16x32_bf16 v[116:119], a[128:131], a[56:59], v[116:119]
    v_max_f32 v128, v128, v56
    v_max_f32 v129, v129, v56
    v_mfma_f32_16x16x32_bf16 v[112:115], a[132:135], a[132:135], v[112:115]
    v_max_f32 v130, v130, v56
    v_max_f32 v131, v131, v56
    v_mfma_f32_16x16x32_bf16 v[116:119], a[132:135], a[60:63], v[116:119]
    v_rsq_f32 v128, v128
    v_mfma_f32_16x16x32_bf16 v[112:115], a[136:139], a[136:139], v[112:115]
    v_rsq_f32 v129, v129
    v_mfma_f32_16x16x32_bf16 v[116:119], a[136:139], a[64:67], v[116:119]
    v_rsq_f32 v130, v130
    v_mfma_f32_16x16x32_bf16 v[112:115], a[140:143], a[140:143], v[112:115]
    v_rsq_f32 v131, v131
    v_mfma_f32_16x16x32_bf16 v[116:119], a[140:143], a[68:71], v[116:119]
    v_fma_f32 v88, -v92, v61, v88
    v_fma_f32 v89, -v93, v61, v89
    v_mfma_f32_16x16x32_bf16 v[108:111], a[120:123], v[52:55], v[80:83]
    v_fma_f32 v90, -v94, v61, v90
    v_fma_f32 v91, -v95, v61, v91
    v_mfma_f32_16x16x32_bf16 v[108:111], a[124:127], v[52:55], v[108:111]
    v_mul_f32 v88, v88, v128
    v_mul_f32 v89, v89, v129
    v_mfma_f32_16x16x32_bf16 v[108:111], a[128:131], v[52:55], v[108:111]
    v_mul_f32 v90, v90, v130
    v_mul_f32 v91, v91, v131
    v_mfma_f32_16x16x32_bf16 v[108:111], a[132:135], v[52:55], v[108:111]
    v_max3_f32 v1, v88, v89, v90
    v_max_f32 v1, v1, v91
    v_mfma_f32_16x16x32_bf16 v[108:111], a[136:139], v[52:55], v[108:111]
    v_mov_b32 v2, v1
    s_nop 1
    v_permlane32_swap_b32 v1, v2
    v_mfma_f32_16x16x32_bf16 v[108:111], a[140:143], v[52:55], v[108:111]
    v_max_f32 v1, v1, v2
    v_mov_b32 v2, v1
    v_mfma_f32_16x16x32_bf16 v[104:107], a[120:123], v[136:139], v[76:79]
    s_nop 0
    v_permlane16_swap_b32 v1, v2
    v_max_f32 v1, v1, v2
    v_mfma_f32_16x16x32_bf16 v[104:107], a[124:127], v[140:143], v[104:107]
    v_sub_f32 v62, 0, v1
    v_sub_f32 v88, v88, v1
    v_mfma_f32_16x16x32_bf16 v[104:107], a[128:131], v[144:147], v[104:107]
    v_sub_f32 v89, v89, v1
    v_sub_f32 v90, v90, v1
    v_mfma_f32_16x16x32_bf16 v[104:107], a[132:135], v[148:151], v[104:107]
    v_sub_f32 v91, v91, v1
    v_mfma_f32_16x16x32_bf16 v[104:107], a[136:139], v[152:155], v[104:107]
    v_exp_f32 v96, v88
    v_mfma_f32_16x16x32_bf16 v[104:107], a[140:143], v[156:159], v[104:107]
    v_exp_f32 v97, v89
    v_exp_f32 v98, v90
    v_exp_f32 v99, v91
    v_mul_f32 v88, v96, v128
    v_mul_f32 v89, v97, v129
    v_mul_f32 v90, v98, v130
    v_mul_f32 v91, v99, v131
    v_fma_f32 v112, v116, 2.0, v112
    v_fma_f32 v113, v117, 2.0, v113
    v_fma_f32 v114, v118, 2.0, v114
    v_fma_f32 v115, v119, 2.0, v115
    v_cndmask_b32 v4, 0, v112, s[44:45]
    v_cndmask_b32 v4, v4, v113, s[46:47]
    v_cndmask_b32 v4, v4, v114, s[48:49]
    v_cndmask_b32 v4, v4, v115, s[50:51]
    v_mov_b32 v63, v96
    v_mul_f32 v64, v88, v92
    v_mfma_f32_16x16x4_f32 v[124:127], v4, v60, v[56:59]
    v_add_f32 v63, v63, v97
    v_fmac_f32 v64, v89, v93
    v_add_f32 v63, v63, v98
    v_fmac_f32 v64, v90, v94
    v_add_f32 v63, v63, v99
    v_fmac_f32 v64, v91, v95
    v_mov_b32 v68, v88
    v_mov_b32 v69, v89
    v_mov_b32 v70, v90
    v_mov_b32 v71, v91
    v_fma_f32 v132, -v108, v108, v124
    v_fma_f32 v133, -v109, v109, v125
    v_fma_f32 v134, -v110, v110, v126
    v_fma_f32 v135, -v111, v111, v127
    v_max_f32 v132, v132, v56
    v_max_f32 v133, v133, v56
    v_max_f32 v134, v134, v56
    v_max_f32 v135, v135, v56
    v_rsq_f32 v132, v132
    v_rsq_f32 v133, v133
    v_rsq_f32 v134, v134
    v_rsq_f32 v135, v135
    v_fma_f32 v104, -v108, v61, v104
    v_fma_f32 v105, -v109, v61, v105
    v_fma_f32 v106, -v110, v61, v106
    v_fma_f32 v107, -v111, v61, v107
    v_fma_f32 v104, v104, v132, v62
    v_fma_f32 v105, v105, v133, v62
    v_fma_f32 v106, v106, v134, v62
    v_fma_f32 v107, v107, v135, v62
    v_max3_f32 v1, v104, v105, v106
    v_max_f32 v1, v1, v107
    v_cmp_lt_f32 vcc, s52, v1
    s_cbranch_vccnz L_site0
L_back0:
    v_exp_f32 v112, v104
    v_exp_f32 v113, v105
    v_exp_f32 v114, v106
    v_exp_f32 v115, v107
    v_mul_f32 v104, v112, v132
    v_mul_f32 v105, v113, v133
    v_mul_f32 v106, v114, v134
    v_mul_f32 v107, v115, v135
    v_cvt_pk_bf16_f32 v72, v88, v89
    v_cvt_pk_bf16_f32 v73, v90, v91
    v_cvt_pk_bf16_f32 v74, v104, v105
    v_cvt_pk_bf16_f32 v75, v106, v107
    s_nop 1
    v_mfma_f32_16x16x32_bf16 a[0:3], a[144:147], v[72:75], 0
    v_add_f32 v63, v63, v112
    v_fmac_f32 v64, v104, v108
    v_mfma_f32_16x16x32_bf16 a[4:7], a[148:151], v[72:75], 0
    v_add_f32 v63, v63, v113
    v_fmac_f32 v64, v105, v109
    v_mfma_f32_16x16x32_bf16 a[8:11], a[152:155], v[72:75], 0
    v_add_f32 v63, v63, v114
    v_fmac_f32 v64, v106, v110
    v_mfma_f32_16x16x32_bf16 a[12:15], a[156:159], v[72:75], 0
    v_add_f32 v63, v63, v115
    v_fmac_f32 v64, v107, v111
    v_mfma_f32_16x16x32_bf16 a[16:19], a[160:163], v[72:75], 0
    v_add_f32 v68, v68, v104
    v_add_f32 v69, v69, v105
    v_mfma_f32_16x16x32_bf16 a[20:23], a[164:167], v[72:75], 0
    v_add_f32 v70, v70, v106
    v_add_f32 v71, v71, v107
    v_mfma_f32_16x16x32_bf16 a[24:27], a[168:171], v[72:75], 0
    v_mfma_f32_16x16x32_bf16 a[28:31], a[172:175], v[72:75], 0
    v_mfma_f32_16x16x32_bf16 a[32:35], a[176:179], v[72:75], 0
    v_mfma_f32_16x16x32_bf16 a[36:39], a[180:183], v[72:75], 0
    v_mfma_f32_16x16x32_bf16 a[40:43], a[184:187], v[72:75], 0
    v_mfma_f32_16x16x32_bf16 a[44:47], a[188:191], v[72:75], 0
    ds_read_b128 a[96:99], v40 offset:49152
    ds_read_b128 a[100:103], v41 offset:49152
    ds_read_b128 a[104:107], v42 offset:49152
    ds_read_b128 a[108:111], v43 offset:49152
    ds_read_b128 a[112:115], v40 offset:49408
    ds_read_b128 a[116:119], v41 offset:49408
    ds_read_b128 a[120:123], v42 offset:49408
    ds_read_b128 a[124:127], v43 offset:49408
    ds_read_b128 a[128:131], v40 offset:49664
    ds_read_b128 a[132:135], v41 offset:49664
    ds_read_b128 a[136:139], v42 offset:49664
    ds_read_b128 a[140:143], v43 offset:49664
    s_waitcnt lgkmcnt(11)
    v_mfma_f32_16x16x32_bf16 v[96:99], a[96:99], a[96:99], v[84:87]
    ds_read_b64_tr_b16 a[144:145], v44 offset:49152
    ds_read_b64_tr_b16 a[146:147], v48 offset:49408
    v_mfma_f32_16x16x32_bf16 v[100:103], a[96:99], a[48:51], 0
    ds_read_b64_tr_b16 a[148:149], v45 offset:49152
    ds_read_b64_tr_b16 a[150:151], v49 offset:49408
    s_waitcnt lgkmcnt(14)
    v_mfma_f32_16x16x32_bf16 v[96:99], a[100:103], a[100:103], v[96:99]
    ds_read_b64_tr_b16 a[152:153], v46 offset:49152
    ds_read_b64_tr_b16 a[154:155], v50 offset:49408
    v_mfma_f32_16x16x32_bf16 v[100:103], a[100:103], a[52:55], v[100:103]
    ds_read_b64_tr_b16 a[156:157], v47 offset:49152
    ds_read_b64_tr_b16 a[158:159], v51 offset:49408
    s_waitcnt lgkmcnt(15)
    v_mfma_f32_16x16x32_bf16 v[96:99], a[104:107], a[104:107], v[96:99]
    ds_read_b64_tr_b16 a[160:161], v48 offset:49152
    ds_read_b64_tr_b16 a[162:163], v44 offset:49664
    v_mfma_f32_16x16x32_bf16 v[100:103], a[104:107], a[56:59], v[100:103]
    ds_read_b64_tr_b16 a[164:165], v49 offset:49152
    ds_read_b64_tr_b16 a[166:167], v45 offset:49664
    v_mfma_f32_16x16x32_bf16 v[96:99], a[108:111], a[108:111], v[96:99]
    ds_read_b64_tr_b16 a[168:169], v50 offset:49152
    ds_read_b64_tr_b16 a[170:171], v46 offset:49664
    v_mfma_f32_16x16x32_bf16 v[100:103], a[108:111], a[60:63], v[100:103]
    ds_read_b64_tr_b16 a[172:173], v51 offset:49152
    ds_read_b64_tr_b16 a[174:175], v47 offset:49664
    v_mfma_f32_16x16x32_bf16 v[96:99], a[112:115], a[112:115], v[96:99]
    ds_read_b64_tr_b16 a[176:177], v44 offset:49408
    ds_read_b64_tr_b16 a[178:179], v48 offset:49664
    v_mfma_f32_16x16x32_bf16 v[100:103], a[112:115], a[64:67], v[100:103]
    ds_read_b64_tr_b16 a[180:181], v45 offset:49408
    ds_read_b64_tr_b16 a[182:183], v49 offset:49664
    s_waitcnt lgkmcnt(15)
    v_mfma_f32_16x16x32_bf16 v[96:99], a[116:119], a[116:119], v[96:99]
    ds_read_b64_tr_b16 a[184:185], v46 offset:49408
    ds_read_b64_tr_b16 a[186:187], v50 offset:49664
    v_mfma_f32_16x16x32_bf16 v[100:103], a[116:119], a[68:71], v[100:103]
    ds_read_b64_tr_b16 a[188:189], v47 offset:49408
    ds_read_b64_tr_b16 a[190:191], v51 offset:49664
    v_mfma_f32_16x16x32_bf16 v[92:95], a[96:99], v[52:55], v[80:83]
    v_mfma_f32_16x16x32_bf16 v[92:95], a[100:103], v[52:55], v[92:95]
    v_mfma_f32_16x16x32_bf16 v[92:95], a[104:107], v[52:55], v[92:95]
    v_mfma_f32_16x16x32_bf16 v[92:95], a[108:111], v[52:55], v[92:95]
    s_nop 1
    v_fma_f32 v96, v100, 2.0, v96
    v_fma_f32 v97, v101, 2.0, v97
    v_mfma_f32_16x16x32_bf16 v[92:95], a[112:115], v[52:55], v[92:95]
    v_fma_f32 v98, v102, 2.0, v98
    v_fma_f32 v99, v103, 2.0, v99
    v_mfma_f32_16x16x32_bf16 v[92:95], a[116:119], v[52:55], v[92:95]
    v_cndmask_b32 v3, 0, v96, s[44:45]
    v_cndmask_b32 v3, v3, v97, s[46:47]
    v_mfma_f32_16x16x32_bf16 v[88:91], a[96:99], v[136:139], v[76:79]
    v_cndmask_b32 v3, v3, v98, s[48:49]
    v_cndmask_b32 v3, v3, v99, s[50:51]
    v_mfma_f32_16x16x32_bf16 v[88:91], a[100:103], v[140:143], v[88:91]
    s_nop 0
    s_nop 0
    v_mfma_f32_16x16x32_bf16 v[88:91], a[104:107], v[144:147], v[88:91]
    v_mfma_f32_16x16x4_f32 v[120:123], v3, v60, v[56:59]
    v_mfma_f32_16x16x32_bf16 v[88:91], a[108:111], v[148:151], v[88:91]
    v_mfma_f32_16x16x32_bf16 v[88:91], a[112:115], v[152:155], v[88:91]
    v_mfma_f32_16x16x32_bf16 v[88:91], a[116:119], v[156:159], v[88:91]
    s_waitcnt lgkmcnt(0)
    s_barrier
    s_add_u32 m0, s42, 0
    s_add_u32 s59, s37, 245760
    buffer_load_dwordx4 v22, s[24:27], s59 offen offset:0 nt lds
    buffer_load_dwordx4 v23, s[24:27], s59 offen offset:1024 nt lds
    buffer_load_dwordx4 v24, s[24:27], s59 offen offset:2048 nt lds
    buffer_load_dwordx4 v25, s[24:27], s59 offen offset:3072 nt lds
    s_add_u32 m0, s42, 4096
    s_nop 0
    buffer_load_dwordx4 v26, s[24:27], s59 offen offset:0 nt lds
    buffer_load_dwordx4 v27, s[24:27], s59 offen offset:1024 nt lds
    buffer_load_dwordx4 v28, s[24:27], s59 offen offset:2048 nt lds
    buffer_load_dwordx4 v29, s[24:27], s59 offen offset:3072 nt lds
    s_add_u32 m0, s42, 8192
    s_nop 0
    buffer_load_dwordx4 v30, s[24:27], s59 offen offset:0 nt lds
    buffer_load_dwordx4 v31, s[24:27], s59 offen offset:1024 nt lds
    buffer_load_dwordx4 v32, s[24:27], s59 offen offset:2048 nt lds
    buffer_load_dwordx4 v33, s[24:27], s59 offen offset:3072 nt lds
    v_mfma_f32_16x16x32_bf16 v[112:115], a[120:123], a[120:123], v[84:87]
    v_mfma_f32_16x16x32_bf16 v[116:119], a[120:123], a[48:51], 0
    v_mfma_f32_16x16x32_bf16 v[112:115], a[124:127], a[124:127], v[112:115]
    v_mfma_f32_16x16x32_bf16 v[116:119], a[124:127], a[52:55], v[116:119]
    v_fma_f32 v128, -v92, v92, v120
    v_fma_f32 v129, -v93, v93, v121
    v_mfma_f32_16x16x32_bf16 v[112:115], a[128:131], a[128:131], v[112:115]
    v_fma_f32 v130, -v94, v94, v122
    v_fma_f32 v131, -v95, v95, v123
    v_mfma_f32_16x16x32_bf16 v[116:119], a[128:131], a[56:59], v[116:119]
    v_max_f32 v128, v128, v56
    v_max_f32 v129, v129, v56
    v_mfma_f32_16x16x32_bf16 v[112:115], a[132:135], a[132:135], v[112:115]
    v_max_f32 v130, v130, v56
    v_max_f32 v131, v131, v56
    v_mfma_f32_16x16x32_bf16 v[116:119], a[132:135], a[60:63], v[116:119]
    v_rsq_f32 v128, v128
    v_mfma_f32_16x16x32_bf16 v[112:115], a[136:139], a[136:139], v[112:115]
    v_rsq_f32 v129, v129
    v_mfma_f32_16x16x32_bf16 v[116:119], a[136:139], a[64:67], v[116:119]
    v_rsq_f32 v130, v130
    v_mfma_f32_16x16x32_bf16 v[112:115], a[140:143], a[140:143], v[112:115]
    v_rsq_f32 v131, v131
    v_mfma_f32_16x16x32_bf16 v[116:119], a[140:143], a[68:71], v[116:119]
    v_fma_f32 v88, -v92, v61, v88
    v_fma_f32 v89, -v93, v61, v89
    v_mfma_f32_16x16x32_bf16 v[108:111], a[120:123], v[52:55], v[80:83]
    v_fma_f32 v90, -v94, v61, v90
    v_fma_f32 v91, -v95, v61, v91
    v_mfma_f32_16x16x32_bf16 v[108:111], a[124:127], v[52:55], v[108:111]
    v_fma_f32 v88, v88, v128, v62
    v_fma_f32 v89, v89, v129, v62
    v_mfma_f32_16x16x32_bf16 v[108:111], a[128:131], v[52:55], v[108:111]
    v_fma_f32 v90, v90, v130, v62
    v_fma_f32 v91, v91, v131, v62
    v_mfma_f32_16x16x32_bf16 v[108:111], a[132:135], v[52:55], v[108:111]
    v_max3_f32 v1, v88, v89, v90
    v_max_f32 v1, v1, v91
    v_mfma_f32_16x16x32_bf16 v[108:111], a[136:139], v[52:55], v[108:111]
    v_cmp_lt_f32 vcc, s52, v1
    s_cbranch_vccnz L_site1
L_back1:
    v_mfma_f32_16x16x32_bf16 v[108:111], a[140:143], v[52:55], v[108:111]
    v_exp_f32 v96, v88
    v_mfma_f32_16x16x32_bf16 v[104:107], a[120:123], v[136:139], v[76:79]
    v_exp_f32 v97, v89
    v_mfma_f32_16x16x32_bf16 v[104:107], a[124:127], v[140:143], v[104:107]
    v_exp_f32 v98, v90
    v_mfma_f32_16x16x32_bf16 v[104:107], a[128:131], v[144:147], v[104:107]
    v_exp_f32 v99, v91
    v_mfma_f32_16x16x32_bf16 v[104:107], a[132:135], v[148:151], v[104:107]
    v_mul_f32 v88, v96, v128
    v_mul_f32 v89, v97, v129
    v_mfma_f32_16x16x32_bf16 v[104:107], a[136:139], v[152:155], v[104:107]
    v_mul_f32 v90, v98, v130
    v_mul_f32 v91, v99, v131
    v_mfma_f32_16x16x32_bf16 v[104:107], a[140:143], v[156:159], v[104:107]
    v_fma_f32 v112, v116, 2.0, v112
    v_fma_f32 v113, v117, 2.0, v113
    v_fma_f32 v114, v118, 2.0, v114
    v_fma_f32 v115, v119, 2.0, v115
    v_cndmask_b32 v4, 0, v112, s[44:45]
    v_cndmask_b32 v4, v4, v113, s[46:47]
    v_cndmask_b32 v4, v4, v114, s[48:49]
    v_cndmask_b32 v4, v4, v115, s[50:51]
    v_add_f32 v63, v63, v96
    v_fmac_f32 v64, v88, v92
    v_mfma_f32_16x16x4_f32 v[124:127], v4, v60, v[56:59]
    v_add_f32 v63, v63, v97
    v_fmac_f32 v64, v89, v93
    v_add_f32 v63, v63, v98
    v_fmac_f32 v64, v90, v94
    v_add_f32 v63, v63, v99
    v_fmac_f32 v64, v91, v95
    v_add_f32 v68, v68, v88
    v_add_f32 v69, v69, v89
    v_add_f32 v70, v70, v90
    v_add_f32 v71, v71, v91
    v_fma_f32 v132, -v108, v108, v124
    v_fma_f32 v133, -v109, v109, v125
    v_fma_f32 v134, -v110, v110, v126
    v_fma_f32 v135, -v111, v111, v127
    v_max_f32 v132, v132, v56
    v_max_f32 v133, v133, v56
    v_max_f32 v134, v134, v56
    v_max_f32 v135, v135, v56
    v_rsq_f32 v132, v132
    v_rsq_f32 v133, v133
    v_rsq_f32 v134, v134
    v_rsq_f32 v135, v135
    v_fma_f32 v104, -v108, v61, v104
    v_fma_f32 v105, -v109, v61, v105
    v_fma_f32 v106, -v110, v61, v106
    v_fma_f32 v107, -v111, v61, v107
    v_fma_f32 v104, v104, v132, v62
    v_fma_f32 v105, v105, v133, v62
    v_fma_f32 v106, v106, v134, v62
    v_fma_f32 v107, v107, v135, v62
    v_max3_f32 v1, v104, v105, v106
    v_max_f32 v1, v1, v107
    v_cmp_lt_f32 vcc, s52, v1
    s_cbranch_vccnz L_site2
L_back2:
    v_exp_f32 v112, v104
    v_exp_f32 v113, v105
    v_exp_f32 v114, v106
    v_exp_f32 v115, v107
    v_mul_f32 v104, v112, v132
    v_mul_f32 v105, v113, v133
    v_mul_f32 v106, v114, v134
    v_mul_f32 v107, v115, v135
    v_cvt_pk_bf16_f32 v72, v88, v89
    v_cvt_pk_bf16_f32 v73, v90, v91
    v_cvt_pk_bf16_f32 v74, v104, v105
    v_cvt_pk_bf16_f32 v75, v106, v107
    s_nop 1
    v_mfma_f32_16x16x32_bf16 a[0:3], a[144:147], v[72:75], a[0:3]
    v_add_f32 v68, v68, v104
    v_add_f32 v69, v69, v105
    v_mfma_f32_16x16x32_bf16 a[4:7], a[148:151], v[72:75], a[4:7]
    v_add_f32 v70, v70, v106
    v_add_f32 v71, v71, v107
    v_mfma_f32_16x16x32_bf16 a[8:11], a[152:155], v[72:75], a[8:11]
    v_cvt_pk_bf16_f32 v66, v68, v69
    v_cvt_pk_bf16_f32 v67, v70, v71
    v_mfma_f32_16x16x32_bf16 a[12:15], a[156:159], v[72:75], a[12:15]
    v_add_f32 v63, v63, v112
    v_fmac_f32 v64, v104, v108
    v_mfma_f32_16x16x32_bf16 a[16:19], a[160:163], v[72:75], a[16:19]
    v_add_f32 v63, v63, v113
    v_fmac_f32 v64, v105, v109
    v_mfma_f32_16x16x32_bf16 a[20:23], a[164:167], v[72:75], a[20:23]
    v_add_f32 v63, v63, v114
    v_fmac_f32 v64, v106, v110
    v_mfma_f32_16x16x32_bf16 a[24:27], a[168:171], v[72:75], a[24:27]
    v_add_f32 v63, v63, v115
    v_fmac_f32 v64, v107, v111
    v_mfma_f32_16x16x32_bf16 a[28:31], a[172:175], v[72:75], a[28:31]
    v_mfma_f32_16x16x32_bf16 a[32:35], a[176:179], v[72:75], a[32:35]
    v_mfma_f32_16x16x32_bf16 a[36:39], a[180:183], v[72:75], a[36:39]
    v_mfma_f32_16x16x32_bf16 a[40:43], a[184:187], v[72:75], a[40:43]
    v_mfma_f32_16x16x32_bf16 a[44:47], a[188:191], v[72:75], a[44:47]
    v_mfma_f32_16x16x16_bf16 a[0:3], a[72:73], v[66:67], a[0:3]
    v_mfma_f32_16x16x16_bf16 a[4:7], a[74:75], v[66:67], a[4:7]
    v_mfma_f32_16x16x16_bf16 a[8:11], a[76:77], v[66:67], a[8:11]
    v_mfma_f32_16x16x16_bf16 a[12:15], a[78:79], v[66:67], a[12:15]
    v_mfma_f32_16x16x16_bf16 a[16:19], a[80:81], v[66:67], a[16:19]
    v_mfma_f32_16x16x16_bf16 a[20:23], a[82:83], v[66:67], a[20:23]
    v_mfma_f32_16x16x16_bf16 a[24:27], a[84:85], v[66:67], a[24:27]
    v_mfma_f32_16x16x16_bf16 a[28:31], a[86:87], v[66:67], a[28:31]
    v_mfma_f32_16x16x16_bf16 a[32:35], a[88:89], v[66:67], a[32:35]
    v_mfma_f32_16x16x16_bf16 a[36:39], a[90:91], v[66:67], a[36:39]
    v_mfma_f32_16x16x16_bf16 a[40:43], a[92:93], v[66:67], a[40:43]
    v_mfma_f32_16x16x16_bf16 a[44:47], a[94:95], v[66:67], a[44:47]
    ds_read_b128 a[48:51], v34 offset:0
    ds_read_b128 a[52:55], v35 offset:0
    ds_read_b128 a[56:59], v34 offset:128
    ds_read_b128 a[60:63], v35 offset:128
    ds_read_b128 a[64:67], v34 offset:256
    ds_read_b128 a[68:71], v35 offset:256
    s_waitcnt lgkmcnt(5)
    v_mfma_f32_16x16x32_bf16 v[84:87], a[48:51], a[48:51], 0
    ds_read_b64_tr_b16 a[72:73], v36 offset:0
    ds_read_b64_tr_b16 a[74:75], v37 offset:0
    v_mfma_f32_16x16x32_bf16 v[80:83], a[48:51], v[52:55], 0
    ds_read_b64_tr_b16 a[76:77], v38 offset:0
    ds_read_b64_tr_b16 a[78:79], v39 offset:0
    s_waitcnt lgkmcnt(8)
    v_mfma_f32_16x16x32_bf16 v[84:87], a[52:55], a[52:55], v[84:87]
    ds_read_b64_tr_b16 a[80:81], v36 offset:128
    ds_read_b64_tr_b16 a[82:83], v37 offset:128
    v_mfma_f32_16x16x32_bf16 v[80:83], a[52:55], v[52:55], v[80:83]
    ds_read_b64_tr_b16 a[84:85], v38 offset:128
    ds_read_b64_tr_b16 a[86:87], v39 offset:128
    s_waitcnt lgkmcnt(11)
    v_mfma_f32_16x16x32_bf16 v[84:87], a[56:59], a[56:59], v[84:87]
    ds_read_b64_tr_b16 a[88:89], v36 offset:256
    ds_read_b64_tr_b16 a[90:91], v37 offset:256
    v_mfma_f32_16x16x32_bf16 v[80:83], a[56:59], v[52:55], v[80:83]
    ds_read_b64_tr_b16 a[92:93], v38 offset:256
    ds_read_b64_tr_b16 a[94:95], v39 offset:256
    s_waitcnt lgkmcnt(14)
    v_mfma_f32_16x16x32_bf16 v[84:87], a[60:63], a[60:63], v[84:87]
    v_mfma_f32_16x16x32_bf16 v[80:83], a[60:63], v[52:55], v[80:83]
    s_waitcnt lgkmcnt(13)
    v_mfma_f32_16x16x32_bf16 v[84:87], a[64:67], a[64:67], v[84:87]
    v_mfma_f32_16x16x32_bf16 v[80:83], a[64:67], v[52:55], v[80:83]
    s_waitcnt lgkmcnt(12)
    v_mfma_f32_16x16x32_bf16 v[84:87], a[68:71], a[68:71], v[84:87]
    v_mfma_f32_16x16x32_bf16 v[80:83], a[68:71], v[52:55], v[80:83]
    s_waitcnt lgkmcnt(0)
    s_barrier
    buffer_load_dword v244, v245, s[32:35], 0 offen offset:128 sc1
    s_add_u32 m0, s40, 0
    s_add_u32 s57, s36, 49152
    buffer_load_dwordx4 v16, s[28:31], s57 offen offset:0 nt lds
    buffer_load_dwordx4 v17, s[28:31], s57 offen offset:1024 nt lds
    buffer_load_dwordx4 v18, s[28:31], s57 offen offset:2048 nt lds
    buffer_load_dwordx4 v19, s[28:31], s57 offen offset:3072 nt lds
    s_add_u32 m0, s40, 4096
    s_nop 0
    buffer_load_dwordx4 v20, s[28:31], s57 offen offset:0 nt lds
    buffer_load_dwordx4 v21, s[28:31], s57 offen offset:1024 nt lds
    v_mfma_f32_16x16x32_bf16 v[76:79], a[48:51], v[136:139], 0
    v_mfma_f32_16x16x32_bf16 v[76:79], a[52:55], v[140:143], v[76:79]
    v_mfma_f32_16x16x32_bf16 v[76:79], a[56:59], v[144:147], v[76:79]
    v_mfma_f32_16x16x32_bf16 v[76:79], a[60:63], v[148:151], v[76:79]
    v_mfma_f32_16x16x32_bf16 v[76:79], a[64:67], v[152:155], v[76:79]
    v_mfma_f32_16x16x32_bf16 v[76:79], a[68:71], v[156:159], v[76:79]
    s_waitcnt vmcnt(19)
    ds_read_b128 a[96:99], v40 offset:0
    ds_read_b128 a[100:103], v41 offset:0
    ds_read_b128 a[104:107], v42 offset:0
    ds_read_b128 a[108:111], v43 offset:0
    ds_read_b128 a[112:115], v40 offset:256
    ds_read_b128 a[116:119], v41 offset:256
    ds_read_b128 a[120:123], v42 offset:256
    ds_read_b128 a[124:127], v43 offset:256
    ds_read_b128 a[128:131], v40 offset:512
    ds_read_b128 a[132:135], v41 offset:512
    ds_read_b128 a[136:139], v42 offset:512
    ds_read_b128 a[140:143], v43 offset:512
    s_waitcnt lgkmcnt(11)
    v_mfma_f32_16x16x32_bf16 v[96:99], a[96:99], a[96:99], v[84:87]
    ds_read_b64_tr_b16 a[144:145], v44 offset:0
    ds_read_b64_tr_b16 a[146:147], v48 offset:256
    v_mfma_f32_16x16x32_bf16 v[100:103], a[96:99], a[48:51], 0
    ds_read_b64_tr_b16 a[148:149], v45 offset:0
    ds_read_b64_tr_b16 a[150:151], v49 offset:256
    s_waitcnt lgkmcnt(14)
    v_mfma_f32_16x16x32_bf16 v[96:99], a[100:103], a[100:103], v[96:99]
    ds_read_b64_tr_b16 a[152:153], v46 offset:0
    ds_read_b64_tr_b16 a[154:155], v50 offset:256
    v_mfma_f32_16x16x32_bf16 v[100:103], a[100:103], a[52:55], v[100:103]
    ds_read_b64_tr_b16 a[156:157], v47 offset:0
    ds_read_b64_tr_b16 a[158:159], v51 offset:256
    s_waitcnt lgkmcnt(15)
    v_mfma_f32_16x16x32_bf16 v[96:99], a[104:107], a[104:107], v[96:99]
    ds_read_b64_tr_b16 a[160:161], v48 offset:0
    ds_read_b64_tr_b16 a[162:163], v44 offset:512
    v_mfma_f32_16x16x32_bf16 v[100:103], a[104:107], a[56:59], v[100:103]
    ds_read_b64_tr_b16 a[164:165], v49 offset:0
    ds_read_b64_tr_b16 a[166:167], v45 offset:512
    v_mfma_f32_16x16x32_bf16 v[96:99], a[108:111], a[108:111], v[96:99]
    ds_read_b64_tr_b16 a[168:169], v50 offset:0
    ds_read_b64_tr_b16 a[170:171], v46 offset:512
    v_mfma_f32_16x16x32_bf16 v[100:103], a[108:111], a[60:63], v[100:103]
    ds_read_b64_tr_b16 a[172:173], v51 offset:0
    ds_read_b64_tr_b16 a[174:175], v47 offset:512
    v_mfma_f32_16x16x32_bf16 v[96:99], a[112:115], a[112:115], v[96:99]
    ds_read_b64_tr_b16 a[176:177], v44 offset:256
    ds_read_b64_tr_b16 a[178:179], v48 offset:512
    v_mfma_f32_16x16x32_bf16 v[100:103], a[112:115], a[64:67], v[100:103]
    ds_read_b64_tr_b16 a[180:181], v45 offset:256
    ds_read_b64_tr_b16 a[182:183], v49 offset:512
    s_waitcnt lgkmcnt(15)
    v_mfma_f32_16x16x32_bf16 v[96:99], a[116:119], a[116:119], v[96:99]
    ds_read_b64_tr_b16 a[184:185], v46 offset:256
    ds_read_b64_tr_b16 a[186:187], v50 offset:512
    v_mfma_f32_16x16x32_bf16 v[100:103], a[116:119], a[68:71], v[100:103]
    ds_read_b64_tr_b16 a[188:189], v47 offset:256
    ds_read_b64_tr_b16 a[190:191], v51 offset:512
    v_mfma_f32_16x16x32_bf16 v[92:95], a[96:99], v[52:55], v[80:83]
    v_mfma_f32_16x16x32_bf16 v[92:95], a[100:103], v[52:55], v[92:95]
    v_mfma_f32_16x16x32_bf16 v[92:95], a[104:107], v[52:55], v[92:95]
    v_mfma_f32_16x16x32_bf16 v[92:95], a[108:111], v[52:55], v[92:95]
    s_nop 1
    v_fma_f32 v96, v100, 2.0, v96
    v_fma_f32 v97, v101, 2.0, v97
    v_mfma_f32_16x16x32_bf16 v[92:95], a[112:115], v[52:55], v[92:95]
    v_fma_f32 v98, v102, 2.0, v98
    v_fma_f32 v99, v103, 2.0, v99
    v_mfma_f32_16x16x32_bf16 v[92:95], a[116:119], v[52:55], v[92:95]
    v_cndmask_b32 v3, 0, v96, s[44:45]
    v_cndmask_b32 v3, v3, v97, s[46:47]
    v_mfma_f32_16x16x32_bf16 v[88:91], a[96:99], v[136:139], v[76:79]
    v_cndmask_b32 v3, v3, v98, s[48:49]
    v_cndmask_b32 v3, v3, v99, s[50:51]
    v_mfma_f32_16x16x32_bf16 v[88:91], a[100:103], v[140:143], v[88:91]
    s_nop 0
    s_nop 0
    v_mfma_f32_16x16x32_bf16 v[88:91], a[104:107], v[144:147], v[88:91]
    v_mfma_f32_16x16x4_f32 v[120:123], v3, v60, v[56:59]
    v_mfma_f32_16x16x32_bf16 v[88:91], a[108:111], v[148:151], v[88:91]
    v_mfma_f32_16x16x32_bf16 v[88:91], a[112:115], v[152:155], v[88:91]
    v_mfma_f32_16x16x32_bf16 v[88:91], a[116:119], v[156:159], v[88:91]
    s_waitcnt lgkmcnt(0)
    s_barrier
    s_add_u32 m0, s41, 0
    s_add_u32 s58, s37, 98304
    buffer_load_dwordx4 v22, s[24:27], s58 offen offset:0 nt lds
    buffer_load_dwordx4 v23, s[24:27], s58 offen offset:1024 nt lds
    buffer_load_dwordx4 v24, s[24:27], s58 offen offset:2048 nt lds
    buffer_load_dwordx4 v25, s[24:27], s58 offen offset:3072 nt lds
    s_add_u32 m0, s41, 4096
    s_nop 0
    buffer_load_dwordx4 v26, s[24:27], s58 offen offset:0 nt lds
    buffer_load_dwordx4 v27, s[24:27], s58 offen offset:1024 nt lds
    buffer_load_dwordx4 v28, s[24:27], s58 offen offset:2048 nt lds
    buffer_load_dwordx4 v29, s[24:27], s58 offen offset:3072 nt lds
    s_add_u32 m0, s41, 8192
    s_nop 0
    buffer_load_dwordx4 v30, s[24:27], s58 offen offset:0 nt lds
    buffer_load_dwordx4 v31, s[24:27], s58 offen offset:1024 nt lds
    buffer_load_dwordx4 v32, s[24:27], s58 offen offset:2048 nt lds
    buffer_load_dwordx4 v33, s[24:27], s58 offen offset:3072 nt lds
    v_mfma_f32_16x16x32_bf16 v[112:115], a[120:123], a[120:123], v[84:87]
    v_mfma_f32_16x16x32_bf16 v[116:119], a[120:123], a[48:51], 0
    v_mfma_f32_16x16x32_bf16 v[112:115], a[124:127], a[124:127], v[112:115]
    v_mfma_f32_16x16x32_bf16 v[116:119], a[124:127], a[52:55], v[116:119]
    v_fma_f32 v128, -v92, v92, v120
    v_fma_f32 v129, -v93, v93, v121
    v_mfma_f32_16x16x32_bf16 v[112:115], a[128:131], a[128:131], v[112:115]
    v_fma_f32 v130, -v94, v94, v122
    v_fma_f32 v131, -v95, v95, v123
    v_mfma_f32_16x16x32_bf16 v[116:119], a[128:131], a[56:59], v[116:119]
    v_max_f32 v128, v128, v56
    v_max_f32 v129, v129, v56
    v_mfma_f32_16x16x32_bf16 v[112:115], a[132:135], a[132:135], v[112:115]
    v_max_f32 v130, v130, v56
    v_max_f32 v131, v131, v56
    v_mfma_f32_16x16x32_bf16 v[116:119], a[132:135], a[60:63], v[116:119]
    v_rsq_f32 v128, v128
    v_mfma_f32_16x16x32_bf16 v[112:115], a[136:139], a[136:139], v[112:115]
    v_rsq_f32 v129, v129
    v_mfma_f32_16x16x32_bf16 v[116:119], a[136:139], a[64:67], v[116:119]
    v_rsq_f32 v130, v130
    v_mfma_f32_16x16x32_bf16 v[112:115], a[140:143], a[140:143], v[112:115]
    v_rsq_f32 v131, v131
    v_mfma_f32_16x16x32_bf16 v[116:119], a[140:143], a[68:71], v[116:119]
    v_fma_f32 v88, -v92, v61, v88
    v_fma_f32 v89, -v93, v61, v89
    v_mfma_f32_16x16x32_bf16 v[108:111], a[120:123], v[52:55], v[80:83]
    v_fma_f32 v90, -v94, v61, v90
    v_fma_f32 v91, -v95, v61, v91
    v_mfma_f32_16x16x32_bf16 v[108:111], a[124:127], v[52:55], v[108:111]
    v_fma_f32 v88, v88, v128, v62
    v_fma_f32 v89, v89, v129, v62
    v_mfma_f32_16x16x32_bf16 v[108:111], a[128:131], v[52:55], v[108:111]
    v_fma_f32 v90, v90, v130, v62
    v_fma_f32 v91, v91, v131, v62
    v_mfma_f32_16x16x32_bf16 v[108:111], a[132:135], v[52:55], v[108:111]
    v_max3_f32 v1, v88, v89, v90
    v_max_f32 v1, v1, v91
    v_mfma_f32_16x16x32_bf16 v[108:111], a[136:139], v[52:55], v[108:111]
    v_cmp_lt_f32 vcc, s52, v1
    s_cbranch_vccnz L_site3
L_back3:
    v_mfma_f32_16x16x32_bf16 v[108:111], a[140:143], v[52:55], v[108:111]
    v_exp_f32 v96, v88
    v_mfma_f32_16x16x32_bf16 v[104:107], a[120:123], v[136:139], v[76:79]
    v_exp_f32 v97, v89
    v_mfma_f32_16x16x32_bf16 v[104:107], a[124:127], v[140:143], v[104:107]
    v_exp_f32 v98, v90
    v_mfma_f32_16x16x32_bf16 v[104:107], a[128:131], v[144:147], v[104:107]
    v_exp_f32 v99, v91
    v_mfma_f32_16x16x32_bf16 v[104:107], a[132:135], v[148:151], v[104:107]
    v_mul_f32 v88, v96, v128
    v_mul_f32 v89, v97, v129
    v_mfma_f32_16x16x32_bf16 v[104:107], a[136:139], v[152:155], v[104:107]
    v_mul_f32 v90, v98, v130
    v_mul_f32 v91, v99, v131
    v_mfma_f32_16x16x32_bf16 v[104:107], a[140:143], v[156:159], v[104:107]
    v_fma_f32 v112, v116, 2.0, v112
    v_fma_f32 v113, v117, 2.0, v113
    v_fma_f32 v114, v118, 2.0, v114
    v_fma_f32 v115, v119, 2.0, v115
    v_cndmask_b32 v4, 0, v112, s[44:45]
    v_cndmask_b32 v4, v4, v113, s[46:47]
    v_cndmask_b32 v4, v4, v114, s[48:49]
    v_cndmask_b32 v4, v4, v115, s[50:51]
    v_add_f32 v63, v63, v96
    v_fmac_f32 v64, v88, v92
    v_mfma_f32_16x16x4_f32 v[124:127], v4, v60, v[56:59]
    v_add_f32 v63, v63, v97
    v_fmac_f32 v64, v89, v93
    v_add_f32 v63, v63, v98
    v_fmac_f32 v64, v90, v94
    v_add_f32 v63, v63, v99
    v_fmac_f32 v64, v91, v95
    v_mov_b32 v68, v88
    v_mov_b32 v69, v89
    v_mov_b32 v70, v90
    v_mov_b32 v71, v91
    v_fma_f32 v132, -v108, v108, v124
    v_fma_f32 v133, -v109, v109, v125
    v_fma_f32 v134, -v110, v110, v126
    v_fma_f32 v135, -v111, v111, v127
    v_max_f32 v132, v132, v56
    v_max_f32 v133, v133, v56
    v_max_f32 v134, v134, v56
    v_max_f32 v135, v135, v56
    v_rsq_f32 v132, v132
    v_rsq_f32 v133, v133
    v_rsq_f32 v134, v134
    v_rsq_f32 v135, v135
    v_fma_f32 v104, -v108, v61, v104
    v_fma_f32 v105, -v109, v61, v105
    v_fma_f32 v106, -v110, v61, v106
    v_fma_f32 v107, -v111, v61, v107
    v_fma_f32 v104, v104, v132, v62
    v_fma_f32 v105, v105, v133, v62
    v_fma_f32 v106, v106, v134, v62
    v_fma_f32 v107, v107, v135, v62
    v_max3_f32 v1, v104, v105, v106
    v_max_f32 v1, v1, v107
    v_cmp_lt_f32 vcc, s52, v1
    s_cbranch_vccnz L_site4
L_back4:
    v_exp_f32 v112, v104
    v_exp_f32 v113, v105
    v_exp_f32 v114, v106
    v_exp_f32 v115, v107
    v_mul_f32 v104, v112, v132
    v_mul_f32 v105, v113, v133
    v_mul_f32 v106, v114, v134
    v_mul_f32 v107, v115, v135
    v_cvt_pk_bf16_f32 v72, v88, v89
    v_cvt_pk_bf16_f32 v73, v90, v91
    v_cvt_pk_bf16_f32 v74, v104, v105
    v_cvt_pk_bf16_f32 v75, v106, v107
    s_nop 1
    v_mfma_f32_16x16x32_bf16 a[0:3], a[144:147], v[72:75], a[0:3]
    v_add_f32 v63, v63, v112
    v_fmac_f32 v64, v104, v108
    v_mfma_f32_16x16x32_bf16 a[4:7], a[148:151], v[72:75], a[4:7]
    v_add_f32 v63, v63, v113
    v_fmac_f32 v64, v105, v109
    v_mfma_f32_16x16x32_bf16 a[8:11], a[152:155], v[72:75], a[8:11]
    v_add_f32 v63, v63, v114
    v_fmac_f32 v64, v106, v110
    v_mfma_f32_16x16x32_bf16 a[12:15], a[156:159], v[72:75], a[12:15]
    v_add_f32 v63, v63, v115
    v_fmac_f32 v64, v107, v111
    v_mfma_f32_16x16x32_bf16 a[16:19], a[160:163], v[72:75], a[16:19]
    v_add_f32 v68, v68, v104
    v_add_f32 v69, v69, v105
    v_mfma_f32_16x16x32_bf16 a[20:23], a[164:167], v[72:75], a[20:23]
    v_add_f32 v70, v70, v106
    v_add_f32 v71, v71, v107
    v_mfma_f32_16x16x32_bf16 a[24:27], a[168:171], v[72:75], a[24:27]
    v_mfma_f32_16x16x32_bf16 a[28:31], a[172:175], v[72:75], a[28:31]
    v_mfma_f32_16x16x32_bf16 a[32:35], a[176:179], v[72:75], a[32:35]
    v_mfma_f32_16x16x32_bf16 a[36:39], a[180:183], v[72:75], a[36:39]
    v_mfma_f32_16x16x32_bf16 a[40:43], a[184:187], v[72:75], a[40:43]
    v_mfma_f32_16x16x32_bf16 a[44:47], a[188:191], v[72:75], a[44:47]
    s_waitcnt vmcnt(19)
    s_waitcnt vmcnt(18)
    v_cmp_ne_u32 vcc, s39, v244
    s_cbranch_vccnz L_fl_retry
L_fl_ok:
    ds_read_b128 a[96:99], v40 offset:49152
    ds_read_b128 a[100:103], v41 offset:49152
    ds_read_b128 a[104:107], v42 offset:49152
    ds_read_b128 a[108:111], v43 offset:49152
    ds_read_b128 a[112:115], v40 offset:49408
    ds_read_b128 a[116:119], v41 offset:49408
    ds_read_b128 a[120:123], v42 offset:49408
    ds_read_b128 a[124:127], v43 offset:49408
    ds_read_b128 a[128:131], v40 offset:49664
    ds_read_b128 a[132:135], v41 offset:49664
    ds_read_b128 a[136:139], v42 offset:49664
    ds_read_b128 a[140:143], v43 offset:49664
    s_waitcnt lgkmcnt(11)
    v_mfma_f32_16x16x32_bf16 v[96:99], a[96:99], a[96:99], v[84:87]
    ds_read_b64_tr_b16 a[144:145], v44 offset:49152
    ds_read_b64_tr_b16 a[146:147], v48 offset:49408
    v_mfma_f32_16x16x32_bf16 v[100:103], a[96:99], a[48:51], 0
    ds_read_b64_tr_b16 a[148:149], v45 offset:49152
    ds_read_b64_tr_b16 a[150:151], v49 offset:49408
    s_waitcnt lgkmcnt(14)
    v_mfma_f32_16x16x32_bf16 v[96:99], a[100:103], a[100:103], v[96:99]
    ds_read_b64_tr_b16 a[152:153], v46 offset:49152
    ds_read_b64_tr_b16 a[154:155], v50 offset:49408
    v_mfma_f32_16x16x32_bf16 v[100:103], a[100:103], a[52:55], v[100:103]
    ds_read_b64_tr_b16 a[156:157], v47 offset:49152
    ds_read_b64_tr_b16 a[158:159], v51 offset:49408
    s_waitcnt lgkmcnt(15)
    v_mfma_f32_16x16x32_bf16 v[96:99], a[104:107], a[104:107], v[96:99]
    ds_read_b64_tr_b16 a[160:161], v48 offset:49152
    ds_read_b64_tr_b16 a[162:163], v44 offset:49664
    v_mfma_f32_16x16x32_bf16 v[100:103], a[104:107], a[56:59], v[100:103]
    ds_read_b64_tr_b16 a[164:165], v49 offset:49152
    ds_read_b64_tr_b16 a[166:167], v45 offset:49664
    v_mfma_f32_16x16x32_bf16 v[96:99], a[108:111], a[108:111], v[96:99]
    ds_read_b64_tr_b16 a[168:169], v50 offset:49152
    ds_read_b64_tr_b16 a[170:171], v46 offset:49664
    v_mfma_f32_16x16x32_bf16 v[100:103], a[108:111], a[60:63], v[100:103]
    ds_read_b64_tr_b16 a[172:173], v51 offset:49152
    ds_read_b64_tr_b16 a[174:175], v47 offset:49664
    v_mfma_f32_16x16x32_bf16 v[96:99], a[112:115], a[112:115], v[96:99]
    ds_read_b64_tr_b16 a[176:177], v44 offset:49408
    ds_read_b64_tr_b16 a[178:179], v48 offset:49664
    v_mfma_f32_16x16x32_bf16 v[100:103], a[112:115], a[64:67], v[100:103]
    ds_read_b64_tr_b16 a[180:181], v45 offset:49408
    ds_read_b64_tr_b16 a[182:183], v49 offset:49664
    s_waitcnt lgkmcnt(15)
    v_mfma_f32_16x16x32_bf16 v[96:99], a[116:119], a[116:119], v[96:99]
    ds_read_b64_tr_b16 a[184:185], v46 offset:49408
    ds_read_b64_tr_b16 a[186:187], v50 offset:49664
    v_mfma_f32_16x16x32_bf16 v[100:103], a[116:119], a[68:71], v[100:103]
    ds_read_b64_tr_b16 a[188:189], v47 offset:49408
    ds_read_b64_tr_b16 a[190:191], v51 offset:49664
    v_mfma_f32_16x16x32_bf16 v[92:95], a[96:99], v[52:55], v[80:83]
    v_mfma_f32_16x16x32_bf16 v[92:95], a[100:103], v[52:55], v[92:95]
    v_mfma_f32_16x16x32_bf16 v[92:95], a[104:107], v[52:55], v[92:95]
    v_mfma_f32_16x16x32_bf16 v[92:95], a[108:111], v[52:55], v[92:95]
    s_nop 1
    v_fma_f32 v96, v100, 2.0, v96
    v_fma_f32 v97, v101, 2.0, v97
    v_mfma_f32_16x16x32_bf16 v[92:95], a[112:115], v[52:55], v[92:95]
    v_fma_f32 v98, v102, 2.0, v98
    v_fma_f32 v99, v103, 2.0, v99
    v_mfma_f32_16x16x32_bf16 v[92:95], a[116:119], v[52:55], v[92:95]
    v_cndmask_b32 v3, 0, v96, s[44:45]
    v_cndmask_b32 v3, v3, v97, s[46:47]
    v_mfma_f32_16x16x32_bf16 v[88:91], a[96:99], v[136:139], v[76:79]
    v_cndmask_b32 v3, v3, v98, s[48:49]
    v_cndmask_b32 v3, v3, v99, s[50:51]
    v_mfma_f32_16x16x32_bf16 v[88:91], a[100:103], v[140:143], v[88:91]
    s_nop 0
    s_nop 0
    v_mfma_f32_16x16x32_bf16 v[88:91], a[104:107], v[144:147], v[88:91]
    v_mfma_f32_16x16x4_f32 v[120:123], v3, v60, v[56:59]
    v_mfma_f32_16x16x32_bf16 v[88:91], a[108:111], v[148:151], v[88:91]
    v_mfma_f32_16x16x32_bf16 v[88:91], a[112:115], v[152:155], v[88:91]
    v_mfma_f32_16x16x32_bf16 v[88:91], a[116:119], v[156:159], v[88:91]
    s_waitcnt lgkmcnt(0)
    s_barrier
    s_add_u32 m0, s42, 0
    s_add_u32 s59, s37, 294912
    buffer_load_dwordx4 v22, s[24:27], s59 offen offset:0 nt lds
    buffer_load_dwordx4 v23, s[24:27], s59 offen offset:1024 nt lds
    s_add_u32 s61, s60, 2162688
    buffer_load_dwordx4 v[160:163], v65, s[72:75], s61 offen offset:0 sc1
    buffer_load_dwordx4 v24, s[24:27], s59 offen offset:2048 nt lds
    buffer_load_dwordx4 v25, s[24:27], s59 offen offset:3072 nt lds
    s_add_u32 m0, s42, 4096
    s_nop 0
    buffer_load_dwordx4 v26, s[24:27], s59 offen offset:0 nt lds
    buffer_load_dwordx4 v27, s[24:27], s59 offen offset:1024 nt lds
    buffer_load_dwordx4 v[164:167], v65, s[72:75], s61 offen offset:1024 sc1
    buffer_load_dwordx4 v28, s[24:27], s59 offen offset:2048 nt lds
    buffer_load_dwordx4 v29, s[24:27], s59 offen offset:3072 nt lds
    s_add_u32 m0, s42, 8192
    s_nop 0
    buffer_load_dwordx4 v30, s[24:27], s59 offen offset:0 nt lds
    buffer_load_dwordx4 v31, s[24:27], s59 offen offset:1024 nt lds
    buffer_load_dwordx4 v[168:171], v65, s[72:75], s61 offen offset:2048 sc1
    buffer_load_dwordx4 v32, s[24:27], s59 offen offset:2048 nt lds
    buffer_load_dwordx4 v33, s[24:27], s59 offen offset:3072 nt lds
    v_mfma_f32_16x16x32_bf16 v[112:115], a[120:123], a[120:123], v[84:87]
    v_mfma_f32_16x16x32_bf16 v[116:119], a[120:123], a[48:51], 0
    v_mfma_f32_16x16x32_bf16 v[112:115], a[124:127], a[124:127], v[112:115]
    v_mfma_f32_16x16x32_bf16 v[116:119], a[124:127], a[52:55], v[116:119]
    v_fma_f32 v128, -v92, v92, v120
    v_fma_f32 v129, -v93, v93, v121
    v_mfma_f32_16x16x32_bf16 v[112:115], a[128:131], a[128:131], v[112:115]
    v_fma_f32 v130, -v94, v94, v122
    v_fma_f32 v131, -v95, v95, v123
    v_mfma_f32_16x16x32_bf16 v[116:119], a[128:131], a[56:59], v[116:119]
    v_max_f32 v128, v128, v56
    v_max_f32 v129, v129, v56
    v_mfma_f32_16x16x32_bf16 v[112:115], a[132:135], a[132:135], v[112:115]
    v_max_f32 v130, v130, v56
    v_max_f32 v131, v131, v56
    v_mfma_f32_16x16x32_bf16 v[116:119], a[132:135], a[60:63], v[116:119]
    v_rsq_f32 v128, v128
    v_mfma_f32_16x16x32_bf16 v[112:115], a[136:139], a[136:139], v[112:115]
    v_rsq_f32 v129, v129
    v_mfma_f32_16x16x32_bf16 v[116:119], a[136:139], a[64:67], v[116:119]
    v_rsq_f32 v130, v130
    v_mfma_f32_16x16x32_bf16 v[112:115], a[140:143], a[140:143], v[112:115]
    v_rsq_f32 v131, v131
    v_mfma_f32_16x16x32_bf16 v[116:119], a[140:143], a[68:71], v[116:119]
    v_fma_f32 v88, -v92, v61, v88
    v_fma_f32 v89, -v93, v61, v89
    v_mfma_f32_16x16x32_bf16 v[108:111], a[120:123], v[52:55], v[80:83]
    v_fma_f32 v90, -v94, v61, v90
    v_fma_f32 v91, -v95, v61, v91
    v_mfma_f32_16x16x32_bf16 v[108:111], a[124:127], v[52:55], v[108:111]
    v_fma_f32 v88, v88, v128, v62
    v_fma_f32 v89, v89, v129, v62
    v_mfma_f32_16x16x32_bf16 v[108:111], a[128:131], v[52:55], v[108:111]
    v_fma_f32 v90, v90, v130, v62
    v_fma_f32 v91, v91, v131, v62
    v_mfma_f32_16x16x32_bf16 v[108:111], a[132:135], v[52:55], v[108:111]
    v_max3_f32 v1, v88, v89, v90
    v_max_f32 v1, v1, v91
    v_mfma_f32_16x16x32_bf16 v[108:111], a[136:139], v[52:55], v[108:111]
    v_cmp_lt_f32 vcc, s52, v1
    s_cbranch_vccnz L_site5
L_back5:
    v_mfma_f32_16x16x32_bf16 v[108:111], a[140:143], v[52:55], v[108:111]
    v_exp_f32 v96, v88
    v_mfma_f32_16x16x32_bf16 v[104:107], a[120:123], v[136:139], v[76:79]
    v_exp_f32 v97, v89
    v_mfma_f32_16x16x32_bf16 v[104:107], a[124:127], v[140:143], v[104:107]
    v_exp_f32 v98, v90
    v_mfma_f32_16x16x32_bf16 v[104:107], a[128:131], v[144:147], v[104:107]
    v_exp_f32 v99, v91
    v_mfma_f32_16x16x32_bf16 v[104:107], a[132:135], v[148:151], v[104:107]
    v_mul_f32 v88, v96, v128
    v_mul_f32 v89, v97, v129
    v_mfma_f32_16x16x32_bf16 v[104:107], a[136:139], v[152:155], v[104:107]
    v_mul_f32 v90, v98, v130
    v_mul_f32 v91, v99, v131
    v_mfma_f32_16x16x32_bf16 v[104:107], a[140:143], v[156:159], v[104:107]
    v_fma_f32 v112, v116, 2.0, v112
    v_fma_f32 v113, v117, 2.0, v113
    v_fma_f32 v114, v118, 2.0, v114
    v_fma_f32 v115, v119, 2.0, v115
    v_cndmask_b32 v4, 0, v112, s[44:45]
    v_cndmask_b32 v4, v4, v113, s[46:47]
    v_cndmask_b32 v4, v4, v114, s[48:49]
    v_cndmask_b32 v4, v4, v115, s[50:51]
    v_add_f32 v63, v63, v96
    v_fmac_f32 v64, v88, v92
    v_mfma_f32_16x16x4_f32 v[124:127], v4, v60, v[56:59]
    v_add_f32 v63, v63, v97
    v_fmac_f32 v64, v89, v93
    v_add_f32 v63, v63, v98
    v_fmac_f32 v64, v90, v94
    v_add_f32 v63, v63, v99
    v_fmac_f32 v64, v91, v95
    v_add_f32 v68, v68, v88
    v_add_f32 v69, v69, v89
    v_add_f32 v70, v70, v90
    v_add_f32 v71, v71, v91
    v_fma_f32 v132, -v108, v108, v124
    v_fma_f32 v133, -v109, v109, v125
    v_fma_f32 v134, -v110, v110, v126
    v_fma_f32 v135, -v111, v111, v127
    v_max_f32 v132, v132, v56
    v_max_f32 v133, v133, v56
    v_max_f32 v134, v134, v56
    v_max_f32 v135, v135, v56
    v_rsq_f32 v132, v132
    v_rsq_f32 v133, v133
    v_rsq_f32 v134, v134
    v_rsq_f32 v135, v135
    v_fma_f32 v104, -v108, v61, v104
    v_fma_f32 v105, -v109, v61, v105
    v_fma_f32 v106, -v110, v61, v106
    v_fma_f32 v107, -v111, v61, v107
    v_fma_f32 v104, v104, v132, v62
    v_fma_f32 v105, v105, v133, v62
    v_fma_f32 v106, v106, v134, v62
    v_fma_f32 v107, v107, v135, v62
    v_max3_f32 v1, v104, v105, v106
    v_max_f32 v1, v1, v107
    v_cmp_lt_f32 vcc, s52, v1
    s_cbranch_vccnz L_site6
L_back6:
    v_exp_f32 v112, v104
    v_exp_f32 v113, v105
    v_exp_f32 v114, v106
    v_exp_f32 v115, v107
    v_mul_f32 v104, v112, v132
    v_mul_f32 v105, v113, v133
    v_mul_f32 v106, v114, v134
    v_mul_f32 v107, v115, v135
    v_cvt_pk_bf16_f32 v72, v88, v89
    v_cvt_pk_bf16_f32 v73, v90, v91
    v_cvt_pk_bf16_f32 v74, v104, v105
    v_cvt_pk_bf16_f32 v75, v106, v107
    s_nop 1
    v_mfma_f32_16x16x32_bf16 a[0:3], a[144:147], v[72:75], a[0:3]
    v_add_f32 v68, v68, v104
    v_add_f32 v69, v69, v105
    v_mfma_f32_16x16x32_bf16 a[4:7], a[148:151], v[72:75], a[4:7]
    v_add_f32 v70, v70, v106
    v_add_f32 v71, v71, v107
    v_mfma_f32_16x16x32_bf16 a[8:11], a[152:155], v[72:75], a[8:11]
    v_cvt_pk_bf16_f32 v66, v68, v69
    v_cvt_pk_bf16_f32 v67, v70, v71
    v_mfma_f32_16x16x32_bf16 a[12:15], a[156:159], v[72:75], a[12:15]
    v_add_f32 v63, v63, v112
    v_fmac_f32 v64, v104, v108
    v_mfma_f32_16x16x32_bf16 a[16:19], a[160:163], v[72:75], a[16:19]
    v_add_f32 v63, v63, v113
    v_fmac_f32 v64, v105, v109
    v_mfma_f32_16x16x32_bf16 a[20:23], a[164:167], v[72:75], a[20:23]
    v_add_f32 v63, v63, v114
    v_fmac_f32 v64, v106, v110
    v_mfma_f32_16x16x32_bf16 a[24:27], a[168:171], v[72:75], a[24:27]
    v_add_f32 v63, v63, v115
    v_fmac_f32 v64, v107, v111
    v_mfma_f32_16x16x32_bf16 a[28:31], a[172:175], v[72:75], a[28:31]
    v_mfma_f32_16x16x32_bf16 a[32:35], a[176:179], v[72:75], a[32:35]
    v_mfma_f32_16x16x32_bf16 a[36:39], a[180:183], v[72:75], a[36:39]
    v_mfma_f32_16x16x32_bf16 a[40:43], a[184:187], v[72:75], a[40:43]
    v_mfma_f32_16x16x32_bf16 a[44:47], a[188:191], v[72:75], a[44:47]
    v_mfma_f32_16x16x16_bf16 a[0:3], a[72:73], v[66:67], a[0:3]
    v_mfma_f32_16x16x16_bf16 a[4:7], a[74:75], v[66:67], a[4:7]
    v_mfma_f32_16x16x16_bf16 a[8:11], a[76:77], v[66:67], a[8:11]
    v_mfma_f32_16x16x16_bf16 a[12:15], a[78:79], v[66:67], a[12:15]
    v_mfma_f32_16x16x16_bf16 a[16:19], a[80:81], v[66:67], a[16:19]
    v_mfma_f32_16x16x16_bf16 a[20:23], a[82:83], v[66:67], a[20:23]
    v_mfma_f32_16x16x16_bf16 a[24:27], a[84:85], v[66:67], a[24:27]
    v_mfma_f32_16x16x16_bf16 a[28:31], a[86:87], v[66:67], a[28:31]
    v_mfma_f32_16x16x16_bf16 a[32:35], a[88:89], v[66:67], a[32:35]
    v_mfma_f32_16x16x16_bf16 a[36:39], a[90:91], v[66:67], a[36:39]
    v_mfma_f32_16x16x16_bf16 a[40:43], a[92:93], v[66:67], a[40:43]
    v_mfma_f32_16x16x16_bf16 a[44:47], a[94:95], v[66:67], a[44:47]
    s_waitcnt vmcnt(27)
    ds_read_b128 a[48:51], v34 offset:0
    ds_read_b128 a[52:55], v35 offset:0
    ds_read_b128 a[56:59], v34 offset:128
    ds_read_b128 a[60:63], v35 offset:128
    ds_read_b128 a[64:67], v34 offset:256
    ds_read_b128 a[68:71], v35 offset:256
    s_waitcnt lgkmcnt(5)
    v_mfma_f32_16x16x32_bf16 v[84:87], a[48:51], a[48:51], 0
    ds_read_b64_tr_b16 a[72:73], v36 offset:0
    ds_read_b64_tr_b16 a[74:75], v37 offset:0
    v_mfma_f32_16x16x32_bf16 v[80:83], a[48:51], v[52:55], 0
    ds_read_b64_tr_b16 a[76:77], v38 offset:0
    ds_read_b64_tr_b16 a[78:79], v39 offset:0
    s_waitcnt lgkmcnt(8)
    v_mfma_f32_16x16x32_bf16 v[84:87], a[52:55], a[52:55], v[84:87]
    ds_read_b64_tr_b16 a[80:81], v36 offset:128
    ds_read_b64_tr_b16 a[82:83], v37 offset:128
    v_mfma_f32_16x16x32_bf16 v[80:83], a[52:55], v[52:55], v[80:83]
    ds_read_b64_tr_b16 a[84:85], v38 offset:128
    ds_read_b64_tr_b16 a[86:87], v39 offset:128
    s_waitcnt lgkmcnt(11)
    v_mfma_f32_16x16x32_bf16 v[84:87], a[56:59], a[56:59], v[84:87]
    ds_read_b64_tr_b16 a[88:89], v36 offset:256
    ds_read_b64_tr_b16 a[90:91], v37 offset:256
    v_mfma_f32_16x16x32_bf16 v[80:83], a[56:59], v[52:55], v[80:83]
    ds_read_b64_tr_b16 a[92:93], v38 offset:256
    ds_read_b64_tr_b16 a[94:95], v39 offset:256
    s_waitcnt lgkmcnt(14)
    v_mfma_f32_16x16x32_bf16 v[84:87], a[60:63], a[60:63], v[84:87]
    v_mfma_f32_16x16x32_bf16 v[80:83], a[60:63], v[52:55], v[80:83]
    s_waitcnt lgkmcnt(13)
    v_mfma_f32_16x16x32_bf16 v[84:87], a[64:67], a[64:67], v[84:87]
    v_mfma_f32_16x16x32_bf16 v[80:83], a[64:67], v[52:55], v[80:83]
    s_waitcnt lgkmcnt(12)
    v_mfma_f32_16x16x32_bf16 v[84:87], a[68:71], a[68:71], v[84:87]
    v_mfma_f32_16x16x32_bf16 v[80:83], a[68:71], v[52:55], v[80:83]
    s_waitcnt lgkmcnt(0)
    s_barrier
    s_add_u32 m0, s40, 0
    s_add_u32 s57, s36, 73728
    buffer_load_dwordx4 v16, s[28:31], s57 offen offset:0 nt lds
    buffer_load_dwordx4 v17, s[28:31], s57 offen offset:1024 nt lds
    buffer_load_dwordx4 v[172:175], v65, s[72:75], s61 offen offset:3072 sc1
    buffer_load_dwordx4 v18, s[28:31], s57 offen offset:2048 nt lds
    buffer_load_dwordx4 v19, s[28:31], s57 offen offset:3072 nt lds
    s_add_u32 m0, s40, 4096
    s_nop 0
    buffer_load_dwordx4 v20, s[28:31], s57 offen offset:0 nt lds
    s_add_u32 s61, s60, 2166784
    buffer_load_dwordx4 v[176:179], v65, s[72:75], s61 offen offset:0 sc1
    buffer_load_dwordx4 v21, s[28:31], s57 offen offset:1024 nt lds
    v_mfma_f32_16x16x32_bf16 v[76:79], a[48:51], v[136:139], 0
    v_mfma_f32_16x16x32_bf16 v[76:79], a[52:55], v[140:143], v[76:79]
    v_mfma_f32_16x16x32_bf16 v[76:79], a[56:59], v[144:147], v[76:79]
    v_mfma_f32_16x16x32_bf16 v[76:79], a[60:63], v[148:151], v[76:79]
    v_mfma_f32_16x16x32_bf16 v[76:79], a[64:67], v[152:155], v[76:79]
    v_mfma_f32_16x16x32_bf16 v[76:79], a[68:71], v[156:159], v[76:79]
    s_waitcnt vmcnt(23)
    ds_read_b128 a[96:99], v40 offset:0
    ds_read_b128 a[100:103], v41 offset:0
    ds_read_b128 a[104:107], v42 offset:0
    ds_read_b128 a[108:111], v43 offset:0
    ds_read_b128 a[112:115], v40 offset:256
    ds_read_b128 a[116:119], v41 offset:256
    ds_read_b128 a[120:123], v42 offset:256
    ds_read_b128 a[124:127], v43 offset:256
    ds_read_b128 a[128:131], v40 offset:512
    ds_read_b128 a[132:135], v41 offset:512
    ds_read_b128 a[136:139], v42 offset:512
    ds_read_b128 a[140:143], v43 offset:512
    s_waitcnt lgkmcnt(11)
    v_mfma_f32_16x16x32_bf16 v[96:99], a[96:99], a[96:99], v[84:87]
    ds_read_b64_tr_b16 a[144:145], v44 offset:0
    ds_read_b64_tr_b16 a[146:147], v48 offset:256
    v_mfma_f32_16x16x32_bf16 v[100:103], a[96:99], a[48:51], 0
    ds_read_b64_tr_b16 a[148:149], v45 offset:0
    ds_read_b64_tr_b16 a[150:151], v49 offset:256
    s_waitcnt lgkmcnt(14)
    v_mfma_f32_16x16x32_bf16 v[96:99], a[100:103], a[100:103], v[96:99]
    ds_read_b64_tr_b16 a[152:153], v46 offset:0
    ds_read_b64_tr_b16 a[154:155], v50 offset:256
    v_mfma_f32_16x16x32_bf16 v[100:103], a[100:103], a[52:55], v[100:103]
    ds_read_b64_tr_b16 a[156:157], v47 offset:0
    ds_read_b64_tr_b16 a[158:159], v51 offset:256
    s_waitcnt lgkmcnt(15)
    v_mfma_f32_16x16x32_bf16 v[96:99], a[104:107], a[104:107], v[96:99]
    ds_read_b64_tr_b16 a[160:161], v48 offset:0
    ds_read_b64_tr_b16 a[162:163], v44 offset:512
    v_mfma_f32_16x16x32_bf16 v[100:103], a[104:107], a[56:59], v[100:103]
    ds_read_b64_tr_b16 a[164:165], v49 offset:0
    ds_read_b64_tr_b16 a[166:167], v45 offset:512
    v_mfma_f32_16x16x32_bf16 v[96:99], a[108:111], a[108:111], v[96:99]
    ds_read_b64_tr_b16 a[168:169], v50 offset:0
    ds_read_b64_tr_b16 a[170:171], v46 offset:512
    v_mfma_f32_16x16x32_bf16 v[100:103], a[108:111], a[60:63], v[100:103]
    ds_read_b64_tr_b16 a[172:173], v51 offset:0
    ds_read_b64_tr_b16 a[174:175], v47 offset:512
    v_mfma_f32_16x16x32_bf16 v[96:99], a[112:115], a[112:115], v[96:99]
    ds_read_b64_tr_b16 a[176:177], v44 offset:256
    ds_read_b64_tr_b16 a[178:179], v48 offset:512
    v_mfma_f32_16x16x32_bf16 v[100:103], a[112:115], a[64:67], v[100:103]
    ds_read_b64_tr_b16 a[180:181], v45 offset:256
    ds_read_b64_tr_b16 a[182:183], v49 offset:512
    s_waitcnt lgkmcnt(15)
    v_mfma_f32_16x16x32_bf16 v[96:99], a[116:119], a[116:119], v[96:99]
    ds_read_b64_tr_b16 a[184:185], v46 offset:256
    ds_read_b64_tr_b16 a[186:187], v50 offset:512
    v_mfma_f32_16x16x32_bf16 v[100:103], a[116:119], a[68:71], v[100:103]
    ds_read_b64_tr_b16 a[188:189], v47 offset:256
    ds_read_b64_tr_b16 a[190:191], v51 offset:512
    v_mfma_f32_16x16x32_bf16 v[92:95], a[96:99], v[52:55], v[80:83]
    v_mfma_f32_16x16x32_bf16 v[92:95], a[100:103], v[52:55], v[92:95]
    v_mfma_f32_16x16x32_bf16 v[92:95], a[104:107], v[52:55], v[92:95]
    v_mfma_f32_16x16x32_bf16 v[92:95], a[108:111], v[52:55], v[92:95]
    s_nop 1
    v_fma_f32 v96, v100, 2.0, v96
    v_fma_f32 v97, v101, 2.0, v97
    v_mfma_f32_16x16x32_bf16 v[92:95], a[112:115], v[52:55], v[92:95]
    v_fma_f32 v98, v102, 2.0, v98
    v_fma_f32 v99, v103, 2.0, v99
    v_mfma_f32_16x16x32_bf16 v[92:95], a[116:119], v[52:55], v[92:95]
    v_cndmask_b32 v3, 0, v96, s[44:45]
    v_cndmask_b32 v3, v3, v97, s[46:47]
    v_mfma_f32_16x16x32_bf16 v[88:91], a[96:99], v[136:139], v[76:79]
    v_cndmask_b32 v3, v3, v98, s[48:49]
    v_cndmask_b32 v3, v3, v99, s[50:51]
    v_mfma_f32_16x16x32_bf16 v[88:91], a[100:103], v[140:143], v[88:91]
    s_nop 0
    s_nop 0
    v_mfma_f32_16x16x32_bf16 v[88:91], a[104:107], v[144:147], v[88:91]
    v_mfma_f32_16x16x4_f32 v[120:123], v3, v60, v[56:59]
    v_mfma_f32_16x16x32_bf16 v[88:91], a[108:111], v[148:151], v[88:91]
    v_mfma_f32_16x16x32_bf16 v[88:91], a[112:115], v[152:155], v[88:91]
    v_mfma_f32_16x16x32_bf16 v[88:91], a[116:119], v[156:159], v[88:91]
    s_waitcnt lgkmcnt(0)
    v_mfma_f32_16x16x32_bf16 v[112:115], a[120:123], a[120:123], v[84:87]
    v_mfma_f32_16x16x32_bf16 v[116:119], a[120:123], a[48:51], 0
    v_mfma_f32_16x16x32_bf16 v[112:115], a[124:127], a[124:127], v[112:115]
    v_mfma_f32_16x16x32_bf16 v[116:119], a[124:127], a[52:55], v[116:119]
    s_nop 1
    v_fma_f32 v128, -v92, v92, v120
    v_fma_f32 v129, -v93, v93, v121
    v_mfma_f32_16x16x32_bf16 v[112:115], a[128:131], a[128:131], v[112:115]
    v_fma_f32 v130, -v94, v94, v122
    v_fma_f32 v131, -v95, v95, v123
    v_mfma_f32_16x16x32_bf16 v[116:119], a[128:131], a[56:59], v[116:119]
    v_max_f32 v128, v128, v56
    v_max_f32 v129, v129, v56
    v_mfma_f32_16x16x32_bf16 v[112:115], a[132:135], a[132:135], v[112:115]
    v_max_f32 v130, v130, v56
    v_max_f32 v131, v131, v56
    v_mfma_f32_16x16x32_bf16 v[116:119], a[132:135], a[60:63], v[116:119]
    v_rsq_f32 v128, v128
    v_mfma_f32_16x16x32_bf16 v[112:115], a[136:139], a[136:139], v[112:115]
    v_rsq_f32 v129, v129
    v_mfma_f32_16x16x32_bf16 v[116:119], a[136:139], a[64:67], v[116:119]
    v_rsq_f32 v130, v130
    v_mfma_f32_16x16x32_bf16 v[112:115], a[140:143], a[140:143], v[112:115]
    v_rsq_f32 v131, v131
    v_mfma_f32_16x16x32_bf16 v[116:119], a[140:143], a[68:71], v[116:119]
    v_fma_f32 v88, -v92, v61, v88
    v_fma_f32 v89, -v93, v61, v89
    v_mfma_f32_16x16x32_bf16 v[108:111], a[120:123], v[52:55], v[80:83]
    v_fma_f32 v90, -v94, v61, v90
    v_fma_f32 v91, -v95, v61, v91
    v_mfma_f32_16x16x32_bf16 v[108:111], a[124:127], v[52:55], v[108:111]
    v_fma_f32 v88, v88, v128, v62
    v_fma_f32 v89, v89, v129, v62
    v_mfma_f32_16x16x32_bf16 v[108:111], a[128:131], v[52:55], v[108:111]
    v_fma_f32 v90, v90, v130, v62
    v_fma_f32 v91, v91, v131, v62
    v_mfma_f32_16x16x32_bf16 v[108:111], a[132:135], v[52:55], v[108:111]
    v_max3_f32 v1, v88, v89, v90
    v_max_f32 v1, v1, v91
    v_mfma_f32_16x16x32_bf16 v[108:111], a[136:139], v[52:55], v[108:111]
    v_cmp_lt_f32 vcc, s52, v1
    s_cbranch_vccnz L_site7
L_back7:
    v_mfma_f32_16x16x32_bf16 v[108:111], a[140:143], v[52:55], v[108:111]
    v_exp_f32 v96, v88
    v_mfma_f32_16x16x32_bf16 v[104:107], a[120:123], v[136:139], v[76:79]
    v_exp_f32 v97, v89
    v_mfma_f32_16x16x32_bf16 v[104:107], a[124:127], v[140:143], v[104:107]
    v_exp_f32 v98, v90
    v_mfma_f32_16x16x32_bf16 v[104:107], a[128:131], v[144:147], v[104:107]
    v_exp_f32 v99, v91
    v_mfma_f32_16x16x32_bf16 v[104:107], a[132:135], v[148:151], v[104:107]
    v_mul_f32 v88, v96, v128
    v_mul_f32 v89, v97, v129
    v_mfma_f32_16x16x32_bf16 v[104:107], a[136:139], v[152:155], v[104:107]
    v_mul_f32 v90, v98, v130
    v_mul_f32 v91, v99, v131
    v_mfma_f32_16x16x32_bf16 v[104:107], a[140:143], v[156:159], v[104:107]
    v_fma_f32 v112, v116, 2.0, v112
    v_fma_f32 v113, v117, 2.0, v113
    v_fma_f32 v114, v118, 2.0, v114
    v_fma_f32 v115, v119, 2.0, v115
    v_cndmask_b32 v4, 0, v112, s[44:45]
    v_cndmask_b32 v4, v4, v113, s[46:47]
    v_cndmask_b32 v4, v4, v114, s[48:49]
    v_cndmask_b32 v4, v4, v115, s[50:51]
    v_add_f32 v63, v63, v96
    v_fmac_f32 v64, v88, v92
    v_mfma_f32_16x16x4_f32 v[124:127], v4, v60, v[56:59]
    v_add_f32 v63, v63, v97
    v_fmac_f32 v64, v89, v93
    v_add_f32 v63, v63, v98
    v_fmac_f32 v64, v90, v94
    v_add_f32 v63, v63, v99
    v_fmac_f32 v64, v91, v95
    v_mov_b32 v68, v88
    v_mov_b32 v69, v89
    v_mov_b32 v70, v90
    v_mov_b32 v71, v91
    v_fma_f32 v132, -v108, v108, v124
    v_fma_f32 v133, -v109, v109, v125
    v_fma_f32 v134, -v110, v110, v126
    v_fma_f32 v135, -v111, v111, v127
    v_max_f32 v132, v132, v56
    v_max_f32 v133, v133, v56
    v_max_f32 v134, v134, v56
    v_max_f32 v135, v135, v56
    v_rsq_f32 v132, v132
    v_rsq_f32 v133, v133
    v_rsq_f32 v134, v134
    v_rsq_f32 v135, v135
    v_fma_f32 v104, -v108, v61, v104
    v_fma_f32 v105, -v109, v61, v105
    v_fma_f32 v106, -v110, v61, v106
    v_fma_f32 v107, -v111, v61, v107
    v_fma_f32 v104, v104, v132, v62
    v_fma_f32 v105, v105, v133, v62
    v_fma_f32 v106, v106, v134, v62
    v_fma_f32 v107, v107, v135, v62
    v_max3_f32 v1, v104, v105, v106
    v_max_f32 v1, v1, v107
    v_cmp_lt_f32 vcc, s52, v1
    s_cbranch_vccnz L_site8
L_back8:
    v_exp_f32 v112, v104
    v_exp_f32 v113, v105
    v_exp_f32 v114, v106
    v_exp_f32 v115, v107
    v_mul_f32 v104, v112, v132
    v_mul_f32 v105, v113, v133
    v_mul_f32 v106, v114, v134
    v_mul_f32 v107, v115, v135
    v_cvt_pk_bf16_f32 v72, v88, v89
    v_cvt_pk_bf16_f32 v73, v90, v91
    v_cvt_pk_bf16_f32 v74, v104, v105
    v_cvt_pk_bf16_f32 v75, v106, v107
    s_nop 1
    v_mfma_f32_16x16x32_bf16 a[0:3], a[144:147], v[72:75], a[0:3]
    v_add_f32 v63, v63, v112
    v_fmac_f32 v64, v104, v108
    v_mfma_f32_16x16x32_bf16 a[4:7], a[148:151], v[72:75], a[4:7]
    v_add_f32 v63, v63, v113
    v_fmac_f32 v64, v105, v109
    v_mfma_f32_16x16x32_bf16 a[8:11], a[152:155], v[72:75], a[8:11]
    v_add_f32 v63, v63, v114
    v_fmac_f32 v64, v106, v110
    v_mfma_f32_16x16x32_bf16 a[12:15], a[156:159], v[72:75], a[12:15]
    v_add_f32 v63, v63, v115
    v_fmac_f32 v64, v107, v111
    v_mfma_f32_16x16x32_bf16 a[16:19], a[160:163], v[72:75], a[16:19]
    v_add_f32 v68, v68, v104
    v_add_f32 v69, v69, v105
    v_mfma_f32_16x16x32_bf16 a[20:23], a[164:167], v[72:75], a[20:23]
    v_add_f32 v70, v70, v106
    v_add_f32 v71, v71, v107
    v_mfma_f32_16x16x32_bf16 a[24:27], a[168:171], v[72:75], a[24:27]
    v_mfma_f32_16x16x32_bf16 a[28:31], a[172:175], v[72:75], a[28:31]
    v_mfma_f32_16x16x32_bf16 a[32:35], a[176:179], v[72:75], a[32:35]
    v_mfma_f32_16x16x32_bf16 a[36:39], a[180:183], v[72:75], a[36:39]
    v_mfma_f32_16x16x32_bf16 a[40:43], a[184:187], v[72:75], a[40:43]
    v_mfma_f32_16x16x32_bf16 a[44:47], a[188:191], v[72:75], a[44:47]
    s_barrier
    s_add_u32 m0, s41, 0
    s_add_u32 s58, s37, 147456
    buffer_load_dwordx4 v22, s[24:27], s58 offen offset:0 nt lds
    buffer_load_dwordx4 v23, s[24:27], s58 offen offset:1024 nt lds
    buffer_load_dwordx4 v24, s[24:27], s58 offen offset:2048 nt lds
    buffer_load_dwordx4 v[180:183], v65, s[72:75], s61 offen offset:1024 sc1
    buffer_load_dwordx4 v25, s[24:27], s58 offen offset:3072 nt lds
    s_add_u32 m0, s41, 4096
    s_nop 0
    buffer_load_dwordx4 v26, s[24:27], s58 offen offset:0 nt lds
    buffer_load_dwordx4 v27, s[24:27], s58 offen offset:1024 nt lds
    buffer_load_dwordx4 v28, s[24:27], s58 offen offset:2048 nt lds
    buffer_load_dwordx4 v[184:187], v65, s[72:75], s61 offen offset:2048 sc1
    buffer_load_dwordx4 v29, s[24:27], s58 offen offset:3072 nt lds
    s_add_u32 m0, s41, 8192
    s_nop 0
    buffer_load_dwordx4 v30, s[24:27], s58 offen offset:0 nt lds
    buffer_load_dwordx4 v31, s[24:27], s58 offen offset:1024 nt lds
    buffer_load_dwordx4 v32, s[24:27], s58 offen offset:2048 nt lds
    buffer_load_dwordx4 v[188:191], v65, s[72:75], s61 offen offset:3072 sc1
    buffer_load_dwordx4 v33, s[24:27], s58 offen offset:3072 nt lds
    s_waitcnt vmcnt(23)
    ds_read_b128 a[96:99], v40 offset:49152
    ds_read_b128 a[100:103], v41 offset:49152
    ds_read_b128 a[104:107], v42 offset:49152
    ds_read_b128 a[108:111], v43 offset:49152
    ds_read_b128 a[112:115], v40 offset:49408
    ds_read_b128 a[116:119], v41 offset:49408
    ds_read_b128 a[120:123], v42 offset:49408
    ds_read_b128 a[124:127], v43 offset:49408
    ds_read_b128 a[128:131], v40 offset:49664
    ds_read_b128 a[132:135], v41 offset:49664
    ds_read_b128 a[136:139], v42 offset:49664
    ds_read_b128 a[140:143], v43 offset:49664
    s_waitcnt lgkmcnt(11)
    v_mfma_f32_16x16x32_bf16 v[96:99], a[96:99], a[96:99], v[84:87]
    ds_read_b64_tr_b16 a[144:145], v44 offset:49152
    ds_read_b64_tr_b16 a[146:147], v48 offset:49408
    v_mfma_f32_16x16x32_bf16 v[100:103], a[96:99], a[48:51], 0
    ds_read_b64_tr_b16 a[148:149], v45 offset:49152
    ds_read_b64_tr_b16 a[150:151], v49 offset:49408
    s_waitcnt lgkmcnt(14)
    v_mfma_f32_16x16x32_bf16 v[96:99], a[100:103], a[100:103], v[96:99]
    ds_read_b64_tr_b16 a[152:153], v46 offset:49152
    ds_read_b64_tr_b16 a[154:155], v50 offset:49408
    v_mfma_f32_16x16x32_bf16 v[100:103], a[100:103], a[52:55], v[100:103]
    ds_read_b64_tr_b16 a[156:157], v47 offset:49152
    ds_read_b64_tr_b16 a[158:159], v51 offset:49408
    s_waitcnt lgkmcnt(15)
    v_mfma_f32_16x16x32_bf16 v[96:99], a[104:107], a[104:107], v[96:99]
    ds_read_b64_tr_b16 a[160:161], v48 offset:49152
    ds_read_b64_tr_b16 a[162:163], v44 offset:49664
    v_mfma_f32_16x16x32_bf16 v[100:103], a[104:107], a[56:59], v[100:103]
    ds_read_b64_tr_b16 a[164:165], v49 offset:49152
    ds_read_b64_tr_b16 a[166:167], v45 offset:49664
    v_mfma_f32_16x16x32_bf16 v[96:99], a[108:111], a[108:111], v[96:99]
    ds_read_b64_tr_b16 a[168:169], v50 offset:49152
    ds_read_b64_tr_b16 a[170:171], v46 offset:49664
    v_mfma_f32_16x16x32_bf16 v[100:103], a[108:111], a[60:63], v[100:103]
    ds_read_b64_tr_b16 a[172:173], v51 offset:49152
    ds_read_b64_tr_b16 a[174:175], v47 offset:49664
    v_mfma_f32_16x16x32_bf16 v[96:99], a[112:115], a[112:115], v[96:99]
    ds_read_b64_tr_b16 a[176:177], v44 offset:49408
    ds_read_b64_tr_b16 a[178:179], v48 offset:49664
    v_mfma_f32_16x16x32_bf16 v[100:103], a[112:115], a[64:67], v[100:103]
    ds_read_b64_tr_b16 a[180:181], v45 offset:49408
    ds_read_b64_tr_b16 a[182:183], v49 offset:49664
    s_waitcnt lgkmcnt(15)
    v_mfma_f32_16x16x32_bf16 v[96:99], a[116:119], a[116:119], v[96:99]
    ds_read_b64_tr_b16 a[184:185], v46 offset:49408
    ds_read_b64_tr_b16 a[186:187], v50 offset:49664
    v_mfma_f32_16x16x32_bf16 v[100:103], a[116:119], a[68:71], v[100:103]
    ds_read_b64_tr_b16 a[188:189], v47 offset:49408
    ds_read_b64_tr_b16 a[190:191], v51 offset:49664
    v_mfma_f32_16x16x32_bf16 v[92:95], a[96:99], v[52:55], v[80:83]
    v_mfma_f32_16x16x32_bf16 v[92:95], a[100:103], v[52:55], v[92:95]
    v_mfma_f32_16x16x32_bf16 v[92:95], a[104:107], v[52:55], v[92:95]
    v_mfma_f32_16x16x32_bf16 v[92:95], a[108:111], v[52:55], v[92:95]
    s_nop 1
    v_fma_f32 v96, v100, 2.0, v96
    v_fma_f32 v97, v101, 2.0, v97
    v_mfma_f32_16x16x32_bf16 v[92:95], a[112:115], v[52:55], v[92:95]
    v_fma_f32 v98, v102, 2.0, v98
    v_fma_f32 v99, v103, 2.0, v99
    v_mfma_f32_16x16x32_bf16 v[92:95], a[116:119], v[52:55], v[92:95]
    v_cndmask_b32 v3, 0, v96, s[44:45]
    v_cndmask_b32 v3, v3, v97, s[46:47]
    v_mfma_f32_16x16x32_bf16 v[88:91], a[96:99], v[136:139], v[76:79]
    v_cndmask_b32 v3, v3, v98, s[48:49]
    v_cndmask_b32 v3, v3, v99, s[50:51]
    v_mfma_f32_16x16x32_bf16 v[88:91], a[100:103], v[140:143], v[88:91]
    s_nop 0
    s_nop 0
    v_mfma_f32_16x16x32_bf16 v[88:91], a[104:107], v[144:147], v[88:91]
    v_mfma_f32_16x16x4_f32 v[120:123], v3, v60, v[56:59]
    v_mfma_f32_16x16x32_bf16 v[88:91], a[108:111], v[148:151], v[88:91]
    v_mfma_f32_16x16x32_bf16 v[88:91], a[112:115], v[152:155], v[88:91]
    v_mfma_f32_16x16x32_bf16 v[88:91], a[116:119], v[156:159], v[88:91]
    s_waitcnt lgkmcnt(0)
    v_mfma_f32_16x16x32_bf16 v[112:115], a[120:123], a[120:123], v[84:87]
    v_mfma_f32_16x16x32_bf16 v[116:119], a[120:123], a[48:51], 0
    v_mfma_f32_16x16x32_bf16 v[112:115], a[124:127], a[124:127], v[112:115]
    v_mfma_f32_16x16x32_bf16 v[116:119], a[124:127], a[52:55], v[116:119]
    s_nop 1
    v_fma_f32 v128, -v92, v92, v120
    v_fma_f32 v129, -v93, v93, v121
    v_mfma_f32_16x16x32_bf16 v[112:115], a[128:131], a[128:131], v[112:115]
    v_fma_f32 v130, -v94, v94, v122
    v_fma_f32 v131, -v95, v95, v123
    v_mfma_f32_16x16x32_bf16 v[116:119], a[128:131], a[56:59], v[116:119]
    v_max_f32 v128, v128, v56
    v_max_f32 v129, v129, v56
    v_mfma_f32_16x16x32_bf16 v[112:115], a[132:135], a[132:135], v[112:115]
    v_max_f32 v130, v130, v56
    v_max_f32 v131, v131, v56
    v_mfma_f32_16x16x32_bf16 v[116:119], a[132:135], a[60:63], v[116:119]
    v_rsq_f32 v128, v128
    v_mfma_f32_16x16x32_bf16 v[112:115], a[136:139], a[136:139], v[112:115]
    v_rsq_f32 v129, v129
    v_mfma_f32_16x16x32_bf16 v[116:119], a[136:139], a[64:67], v[116:119]
    v_rsq_f32 v130, v130
    v_mfma_f32_16x16x32_bf16 v[112:115], a[140:143], a[140:143], v[112:115]
    v_rsq_f32 v131, v131
    v_mfma_f32_16x16x32_bf16 v[116:119], a[140:143], a[68:71], v[116:119]
    v_fma_f32 v88, -v92, v61, v88
    v_fma_f32 v89, -v93, v61, v89
    v_mfma_f32_16x16x32_bf16 v[108:111], a[120:123], v[52:55], v[80:83]
    v_fma_f32 v90, -v94, v61, v90
    v_fma_f32 v91, -v95, v61, v91
    v_mfma_f32_16x16x32_bf16 v[108:111], a[124:127], v[52:55], v[108:111]
    v_fma_f32 v88, v88, v128, v62
    v_fma_f32 v89, v89, v129, v62
    v_mfma_f32_16x16x32_bf16 v[108:111], a[128:131], v[52:55], v[108:111]
    v_fma_f32 v90, v90, v130, v62
    v_fma_f32 v91, v91, v131, v62
    v_mfma_f32_16x16x32_bf16 v[108:111], a[132:135], v[52:55], v[108:111]
    v_max3_f32 v1, v88, v89, v90
    v_max_f32 v1, v1, v91
    v_mfma_f32_16x16x32_bf16 v[108:111], a[136:139], v[52:55], v[108:111]
    v_cmp_lt_f32 vcc, s52, v1
    s_cbranch_vccnz L_site9
L_back9:
    v_mfma_f32_16x16x32_bf16 v[108:111], a[140:143], v[52:55], v[108:111]
    v_exp_f32 v96, v88
    v_mfma_f32_16x16x32_bf16 v[104:107], a[120:123], v[136:139], v[76:79]
    v_exp_f32 v97, v89
    v_mfma_f32_16x16x32_bf16 v[104:107], a[124:127], v[140:143], v[104:107]
    v_exp_f32 v98, v90
    v_mfma_f32_16x16x32_bf16 v[104:107], a[128:131], v[144:147], v[104:107]
    v_exp_f32 v99, v91
    v_mfma_f32_16x16x32_bf16 v[104:107], a[132:135], v[148:151], v[104:107]
    v_mul_f32 v88, v96, v128
    v_mul_f32 v89, v97, v129
    v_mfma_f32_16x16x32_bf16 v[104:107], a[136:139], v[152:155], v[104:107]
    v_mul_f32 v90, v98, v130
    v_mul_f32 v91, v99, v131
    v_mfma_f32_16x16x32_bf16 v[104:107], a[140:143], v[156:159], v[104:107]
    v_fma_f32 v112, v116, 2.0, v112
    v_fma_f32 v113, v117, 2.0, v113
    v_fma_f32 v114, v118, 2.0, v114
    v_fma_f32 v115, v119, 2.0, v115
    v_cndmask_b32 v4, 0, v112, s[44:45]
    v_cndmask_b32 v4, v4, v113, s[46:47]
    v_cndmask_b32 v4, v4, v114, s[48:49]
    v_cndmask_b32 v4, v4, v115, s[50:51]
    v_add_f32 v63, v63, v96
    v_fmac_f32 v64, v88, v92
    v_mfma_f32_16x16x4_f32 v[124:127], v4, v60, v[56:59]
    v_add_f32 v63, v63, v97
    v_fmac_f32 v64, v89, v93
    v_add_f32 v63, v63, v98
    v_fmac_f32 v64, v90, v94
    v_add_f32 v63, v63, v99
    v_fmac_f32 v64, v91, v95
    v_add_f32 v68, v68, v88
    v_add_f32 v69, v69, v89
    v_add_f32 v70, v70, v90
    v_add_f32 v71, v71, v91
    v_fma_f32 v132, -v108, v108, v124
    v_fma_f32 v133, -v109, v109, v125
    v_fma_f32 v134, -v110, v110, v126
    v_fma_f32 v135, -v111, v111, v127
    v_max_f32 v132, v132, v56
    v_max_f32 v133, v133, v56
    v_max_f32 v134, v134, v56
    v_max_f32 v135, v135, v56
    v_rsq_f32 v132, v132
    v_rsq_f32 v133, v133
    v_rsq_f32 v134, v134
    v_rsq_f32 v135, v135
    v_fma_f32 v104, -v108, v61, v104
    v_fma_f32 v105, -v109, v61, v105
    v_fma_f32 v106, -v110, v61, v106
    v_fma_f32 v107, -v111, v61, v107
    v_fma_f32 v104, v104, v132, v62
    v_fma_f32 v105, v105, v133, v62
    v_fma_f32 v106, v106, v134, v62
    v_fma_f32 v107, v107, v135, v62
    v_max3_f32 v1, v104, v105, v106
    v_max_f32 v1, v1, v107
    v_cmp_lt_f32 vcc, s52, v1
    s_cbranch_vccnz L_site10
L_back10:
    v_exp_f32 v112, v104
    v_exp_f32 v113, v105
    v_exp_f32 v114, v106
    v_exp_f32 v115, v107
    v_mul_f32 v104, v112, v132
    v_mul_f32 v105, v113, v133
    v_mul_f32 v106, v114, v134
    v_mul_f32 v107, v115, v135
    v_cvt_pk_bf16_f32 v72, v88, v89
    v_cvt_pk_bf16_f32 v73, v90, v91
    v_cvt_pk_bf16_f32 v74, v104, v105
    v_cvt_pk_bf16_f32 v75, v106, v107
    s_nop 1
    v_mfma_f32_16x16x32_bf16 a[0:3], a[144:147], v[72:75], a[0:3]
    v_add_f32 v68, v68, v104
    v_add_f32 v69, v69, v105
    v_mfma_f32_16x16x32_bf16 a[4:7], a[148:151], v[72:75], a[4:7]
    v_add_f32 v70, v70, v106
    v_add_f32 v71, v71, v107
    v_mfma_f32_16x16x32_bf16 a[8:11], a[152:155], v[72:75], a[8:11]
    v_cvt_pk_bf16_f32 v66, v68, v69
    v_cvt_pk_bf16_f32 v67, v70, v71
    v_mfma_f32_16x16x32_bf16 a[12:15], a[156:159], v[72:75], a[12:15]
    v_add_f32 v63, v63, v112
    v_fmac_f32 v64, v104, v108
    v_mfma_f32_16x16x32_bf16 a[16:19], a[160:163], v[72:75], a[16:19]
    v_add_f32 v63, v63, v113
    v_fmac_f32 v64, v105, v109
    v_mfma_f32_16x16x32_bf16 a[20:23], a[164:167], v[72:75], a[20:23]
    v_add_f32 v63, v63, v114
    v_fmac_f32 v64, v106, v110
    v_mfma_f32_16x16x32_bf16 a[24:27], a[168:171], v[72:75], a[24:27]
    v_add_f32 v63, v63, v115
    v_fmac_f32 v64, v107, v111
    v_mfma_f32_16x16x32_bf16 a[28:31], a[172:175], v[72:75], a[28:31]
    v_mfma_f32_16x16x32_bf16 a[32:35], a[176:179], v[72:75], a[32:35]
    v_mfma_f32_16x16x32_bf16 a[36:39], a[180:183], v[72:75], a[36:39]
    v_mfma_f32_16x16x32_bf16 a[40:43], a[184:187], v[72:75], a[40:43]
    v_mfma_f32_16x16x32_bf16 a[44:47], a[188:191], v[72:75], a[44:47]
    v_mfma_f32_16x16x16_bf16 a[0:3], a[72:73], v[66:67], a[0:3]
    v_mfma_f32_16x16x16_bf16 a[4:7], a[74:75], v[66:67], a[4:7]
    v_mfma_f32_16x16x16_bf16 a[8:11], a[76:77], v[66:67], a[8:11]
    v_mfma_f32_16x16x16_bf16 a[12:15], a[78:79], v[66:67], a[12:15]
    v_mfma_f32_16x16x16_bf16 a[16:19], a[80:81], v[66:67], a[16:19]
    v_mfma_f32_16x16x16_bf16 a[20:23], a[82:83], v[66:67], a[20:23]
    v_mfma_f32_16x16x16_bf16 a[24:27], a[84:85], v[66:67], a[24:27]
    v_mfma_f32_16x16x16_bf16 a[28:31], a[86:87], v[66:67], a[28:31]
    v_mfma_f32_16x16x16_bf16 a[32:35], a[88:89], v[66:67], a[32:35]
    v_mfma_f32_16x16x16_bf16 a[36:39], a[90:91], v[66:67], a[36:39]
    v_mfma_f32_16x16x16_bf16 a[40:43], a[92:93], v[66:67], a[40:43]
    v_mfma_f32_16x16x16_bf16 a[44:47], a[94:95], v[66:67], a[44:47]
    v_lshlrev_b32 v233, 7, v0
    v_min_u32 v233, L_end - L_tail, v233
    v_add_u32 v233, L_tail - L_pc_main, v233
    global_load_dword v234, v233, s[100:101]
    s_waitcnt vmcnt(16)
    ds_read_b128 a[48:51], v34 offset:0
    ds_read_b128 a[52:55], v35 offset:0
    ds_read_b128 a[56:59], v34 offset:128
    ds_read_b128 a[60:63], v35 offset:128
    ds_read_b128 a[64:67], v34 offset:256
    ds_read_b128 a[68:71], v35 offset:256
    s_waitcnt lgkmcnt(5)
    v_mfma_f32_16x16x32_bf16 v[84:87], a[48:51], a[48:51], 0
    ds_read_b64_tr_b16 a[72:73], v36 offset:0
    ds_read_b64_tr_b16 a[74:75], v37 offset:0
    v_mfma_f32_16x16x32_bf16 v[80:83], a[48:51], v[52:55], 0
    ds_read_b64_tr_b16 a[76:77], v38 offset:0
    ds_read_b64_tr_b16 a[78:79], v39 offset:0
    s_waitcnt lgkmcnt(8)
    v_mfma_f32_16x16x32_bf16 v[84:87], a[52:55], a[52:55], v[84:87]
    ds_read_b64_tr_b16 a[80:81], v36 offset:128
    ds_read_b64_tr_b16 a[82:83], v37 offset:128
    v_mfma_f32_16x16x32_bf16 v[80:83], a[52:55], v[52:55], v[80:83]
    ds_read_b64_tr_b16 a[84:85], v38 offset:128
    ds_read_b64_tr_b16 a[86:87], v39 offset:128
    s_waitcnt lgkmcnt(11)
    v_mfma_f32_16x16x32_bf16 v[84:87], a[56:59], a[56:59], v[84:87]
    ds_read_b64_tr_b16 a[88:89], v36 offset:256
    ds_read_b64_tr_b16 a[90:91], v37 offset:256
    v_mfma_f32_16x16x32_bf16 v[80:83], a[56:59], v[52:55], v[80:83]
    ds_read_b64_tr_b16 a[92:93], v38 offset:256
    ds_read_b64_tr_b16 a[94:95], v39 offset:256
    s_waitcnt lgkmcnt(14)
    v_mfma_f32_16x16x32_bf16 v[84:87], a[60:63], a[60:63], v[84:87]
    v_mfma_f32_16x16x32_bf16 v[80:83], a[60:63], v[52:55], v[80:83]
    s_waitcnt lgkmcnt(13)
    v_mfma_f32_16x16x32_bf16 v[84:87], a[64:67], a[64:67], v[84:87]
    v_mfma_f32_16x16x32_bf16 v[80:83], a[64:67], v[52:55], v[80:83]
    s_waitcnt lgkmcnt(12)
    v_mfma_f32_16x16x32_bf16 v[84:87], a[68:71], a[68:71], v[84:87]
    v_mfma_f32_16x16x32_bf16 v[80:83], a[68:71], v[52:55], v[80:83]
    s_waitcnt lgkmcnt(0)
    v_mfma_f32_16x16x32_bf16 v[76:79], a[48:51], v[136:139], 0
    v_mfma_f32_16x16x32_bf16 v[76:79], a[52:55], v[140:143], v[76:79]
    v_mfma_f32_16x16x32_bf16 v[76:79], a[56:59], v[144:147], v[76:79]
    v_mfma_f32_16x16x32_bf16 v[76:79], a[60:63], v[148:151], v[76:79]
    v_mfma_f32_16x16x32_bf16 v[76:79], a[64:67], v[152:155], v[76:79]
    v_mfma_f32_16x16x32_bf16 v[76:79], a[68:71], v[156:159], v[76:79]
    s_barrier
    s_add_u32 m0, s42, 0
    s_add_u32 s59, s37, 344064
    buffer_load_dwordx4 v22, s[24:27], s59 offen offset:0 nt lds
    buffer_load_dwordx4 v23, s[24:27], s59 offen offset:1024 nt lds
    buffer_load_dwordx4 v24, s[24:27], s59 offen offset:2048 nt lds
    buffer_load_dwordx4 v25, s[24:27], s59 offen offset:3072 nt lds
    s_add_u32 m0, s42, 4096
    s_nop 0
    buffer_load_dwordx4 v26, s[24:27], s59 offen offset:0 nt lds
    buffer_load_dwordx4 v27, s[24:27], s59 offen offset:1024 nt lds
    buffer_load_dwordx4 v28, s[24:27], s59 offen offset:2048 nt lds
    buffer_load_dwordx4 v29, s[24:27], s59 offen offset:3072 nt lds
    s_add_u32 m0, s42, 8192
    s_nop 0
    buffer_load_dwordx4 v30, s[24:27], s59 offen offset:0 nt lds
    buffer_load_dwordx4 v31, s[24:27], s59 offen offset:1024 nt lds
    buffer_load_dwordx4 v32, s[24:27], s59 offen offset:2048 nt lds
    buffer_load_dwordx4 v33, s[24:27], s59 offen offset:3072 nt lds
    s_waitcnt vmcnt(13)
    ds_read_b128 a[96:99], v40 offset:0
    ds_read_b128 a[100:103], v41 offset:0
    ds_read_b128 a[104:107], v42 offset:0
    ds_read_b128 a[108:111], v43 offset:0
    ds_read_b128 a[112:115], v40 offset:256
    ds_read_b128 a[116:119], v41 offset:256
    ds_read_b128 a[120:123], v42 offset:256
    ds_read_b128 a[124:127], v43 offset:256
    ds_read_b128 a[128:131], v40 offset:512
    ds_read_b128 a[132:135], v41 offset:512
    ds_read_b128 a[136:139], v42 offset:512
    ds_read_b128 a[140:143], v43 offset:512
    s_waitcnt lgkmcnt(11)
    v_mfma_f32_16x16x32_bf16 v[96:99], a[96:99], a[96:99], v[84:87]
    ds_read_b64_tr_b16 a[144:145], v44 offset:0
    ds_read_b64_tr_b16 a[146:147], v48 offset:256
    v_mfma_f32_16x16x32_bf16 v[100:103], a[96:99], a[48:51], 0
    ds_read_b64_tr_b16 a[148:149], v45 offset:0
    ds_read_b64_tr_b16 a[150:151], v49 offset:256
    s_waitcnt lgkmcnt(14)
    v_mfma_f32_16x16x32_bf16 v[96:99], a[100:103], a[100:103], v[96:99]
    ds_read_b64_tr_b16 a[152:153], v46 offset:0
    ds_read_b64_tr_b16 a[154:155], v50 offset:256
    v_mfma_f32_16x16x32_bf16 v[100:103], a[100:103], a[52:55], v[100:103]
    ds_read_b64_tr_b16 a[156:157], v47 offset:0
    ds_read_b64_tr_b16 a[158:159], v51 offset:256
    s_waitcnt lgkmcnt(15)
    v_mfma_f32_16x16x32_bf16 v[96:99], a[104:107], a[104:107], v[96:99]
    ds_read_b64_tr_b16 a[160:161], v48 offset:0
    ds_read_b64_tr_b16 a[162:163], v44 offset:512
    v_mfma_f32_16x16x32_bf16 v[100:103], a[104:107], a[56:59], v[100:103]
    ds_read_b64_tr_b16 a[164:165], v49 offset:0
    ds_read_b64_tr_b16 a[166:167], v45 offset:512
    v_mfma_f32_16x16x32_bf16 v[96:99], a[108:111], a[108:111], v[96:99]
    ds_read_b64_tr_b16 a[168:169], v50 offset:0
    ds_read_b64_tr_b16 a[170:171], v46 offset:512
    v_mfma_f32_16x16x32_bf16 v[100:103], a[108:111], a[60:63], v[100:103]
    ds_read_b64_tr_b16 a[172:173], v51 offset:0
    ds_read_b64_tr_b16 a[174:175], v47 offset:512
    v_mfma_f32_16x16x32_bf16 v[96:99], a[112:115], a[112:115], v[96:99]
    ds_read_b64_tr_b16 a[176:177], v44 offset:256
    ds_read_b64_tr_b16 a[178:179], v48 offset:512
    v_mfma_f32_16x16x32_bf16 v[100:103], a[112:115], a[64:67], v[100:103]
    s_add_u32 s61, s60, 2170880
    buffer_load_dwordx4 v[192:195], v65, s[32:35], s61 offen offset:0 sc1
    ds_read_b64_tr_b16 a[180:181], v45 offset:256
    ds_read_b64_tr_b16 a[182:183], v49 offset:512
    s_waitcnt lgkmcnt(15)
    v_mfma_f32_16x16x32_bf16 v[96:99], a[116:119], a[116:119], v[96:99]
    ds_read_b64_tr_b16 a[184:185], v46 offset:256
    ds_read_b64_tr_b16 a[186:187], v50 offset:512
    v_mfma_f32_16x16x32_bf16 v[100:103], a[116:119], a[68:71], v[100:103]
    ds_read_b64_tr_b16 a[188:189], v47 offset:256
    ds_read_b64_tr_b16 a[190:191], v51 offset:512
    v_mfma_f32_16x16x32_bf16 v[92:95], a[96:99], v[52:55], v[80:83]
    v_mfma_f32_16x16x32_bf16 v[92:95], a[100:103], v[52:55], v[92:95]
    v_mfma_f32_16x16x32_bf16 v[92:95], a[104:107], v[52:55], v[92:95]
    v_mfma_f32_16x16x32_bf16 v[92:95], a[108:111], v[52:55], v[92:95]
    s_nop 1
    v_fma_f32 v96, v100, 2.0, v96
    v_fma_f32 v97, v101, 2.0, v97
    v_mfma_f32_16x16x32_bf16 v[92:95], a[112:115], v[52:55], v[92:95]
    v_fma_f32 v98, v102, 2.0, v98
    v_fma_f32 v99, v103, 2.0, v99
    v_mfma_f32_16x16x32_bf16 v[92:95], a[116:119], v[52:55], v[92:95]
    v_cndmask_b32 v3, 0, v96, s[44:45]
    v_cndmask_b32 v3, v3, v97, s[46:47]
    v_mfma_f32_16x16x32_bf16 v[88:91], a[96:99], v[136:139], v[76:79]
    v_cndmask_b32 v3, v3, v98, s[48:49]
    v_cndmask_b32 v3, v3, v99, s[50:51]
    v_mfma_f32_16x16x32_bf16 v[88:91], a[100:103], v[140:143], v[88:91]
    buffer_load_dwordx4 v[196:199], v65, s[32:35], s61 offen offset:1024 sc1
    s_nop 0
    s_nop 0
    v_mfma_f32_16x16x32_bf16 v[88:91], a[104:107], v[144:147], v[88:91]
    v_mfma_f32_16x16x4_f32 v[120:123], v3, v60, v[56:59]
    v_mfma_f32_16x16x32_bf16 v[88:91], a[108:111], v[148:151], v[88:91]
    v_mfma_f32_16x16x32_bf16 v[88:91], a[112:115], v[152:155], v[88:91]
    v_mfma_f32_16x16x32_bf16 v[88:91], a[116:119], v[156:159], v[88:91]
    s_waitcnt lgkmcnt(0)
    v_mfma_f32_16x16x32_bf16 v[112:115], a[120:123], a[120:123], v[84:87]
    v_mfma_f32_16x16x32_bf16 v[116:119], a[120:123], a[48:51], 0
    v_mfma_f32_16x16x32_bf16 v[112:115], a[124:127], a[124:127], v[112:115]
    v_mfma_f32_16x16x32_bf16 v[116:119], a[124:127], a[52:55], v[116:119]
    s_nop 1
    v_fma_f32 v128, -v92, v92, v120
    v_fma_f32 v129, -v93, v93, v121
    v_mfma_f32_16x16x32_bf16 v[112:115], a[128:131], a[128:131], v[112:115]
    v_fma_f32 v130, -v94, v94, v122
    v_fma_f32 v131, -v95, v95, v123
    v_mfma_f32_16x16x32_bf16 v[116:119], a[128:131], a[56:59], v[116:119]
    buffer_load_dwordx4 v[200:203], v65, s[32:35], s61 offen offset:2048 sc1
    v_max_f32 v128, v128, v56
    v_max_f32 v129, v129, v56
    v_mfma_f32_16x16x32_bf16 v[112:115], a[132:135], a[132:135], v[112:115]
    v_max_f32 v130, v130, v56
    v_max_f32 v131, v131, v56
    v_mfma_f32_16x16x32_bf16 v[116:119], a[132:135], a[60:63], v[116:119]
    v_rsq_f32 v128, v128
    v_mfma_f32_16x16x32_bf16 v[112:115], a[136:139], a[136:139], v[112:115]
    v_rsq_f32 v129, v129
    v_mfma_f32_16x16x32_bf16 v[116:119], a[136:139], a[64:67], v[116:119]
    v_rsq_f32 v130, v130
    v_mfma_f32_16x16x32_bf16 v[112:115], a[140:143], a[140:143], v[112:115]
    v_rsq_f32 v131, v131
    v_mfma_f32_16x16x32_bf16 v[116:119], a[140:143], a[68:71], v[116:119]
    v_fma_f32 v88, -v92, v61, v88
    v_fma_f32 v89, -v93, v61, v89
    v_mfma_f32_16x16x32_bf16 v[108:111], a[120:123], v[52:55], v[80:83]
    v_fma_f32 v90, -v94, v61, v90
    v_fma_f32 v91, -v95, v61, v91
    v_mfma_f32_16x16x32_bf16 v[108:111], a[124:127], v[52:55], v[108:111]
    v_fma_f32 v88, v88, v128, v62
    v_fma_f32 v89, v89, v129, v62
    v_mfma_f32_16x16x32_bf16 v[108:111], a[128:131], v[52:55], v[108:111]
    v_fma_f32 v90, v90, v130, v62
    v_fma_f32 v91, v91, v131, v62
    v_mfma_f32_16x16x32_bf16 v[108:111], a[132:135], v[52:55], v[108:111]
    buffer_load_dwordx4 v[204:207], v65, s[32:35], s61 offen offset:3072 sc1
    v_max3_f32 v1, v88, v89, v90
    v_max_f32 v1, v1, v91
    v_mfma_f32_16x16x32_bf16 v[108:111], a[136:139], v[52:55], v[108:111]
    v_cmp_lt_f32 vcc, s52, v1
    s_cbranch_vccnz L_site11
L_back11:
    v_mfma_f32_16x16x32_bf16 v[108:111], a[140:143], v[52:55], v[108:111]
    v_exp_f32 v96, v88
    v_mfma_f32_16x16x32_bf16 v[104:107], a[120:123], v[136:139], v[76:79]
    v_exp_f32 v97, v89
    v_mfma_f32_16x16x32_bf16 v[104:107], a[124:127], v[140:143], v[104:107]
    v_exp_f32 v98, v90
    v_mfma_f32_16x16x32_bf16 v[104:107], a[128:131], v[144:147], v[104:107]
    v_exp_f32 v99, v91
    v_mfma_f32_16x16x32_bf16 v[104:107], a[132:135], v[148:151], v[104:107]
    v_mul_f32 v88, v96, v128
    v_mul_f32 v89, v97, v129
    v_mfma_f32_16x16x32_bf16 v[104:107], a[136:139], v[152:155], v[104:107]
    v_mul_f32 v90, v98, v130
    v_mul_f32 v91, v99, v131
    v_mfma_f32_16x16x32_bf16 v[104:107], a[140:143], v[156:159], v[104:107]
    v_fma_f32 v112, v116, 2.0, v112
    v_fma_f32 v113, v117, 2.0, v113
    v_fma_f32 v114, v118, 2.0, v114
    v_fma_f32 v115, v119, 2.0, v115
    v_cndmask_b32 v4, 0, v112, s[44:45]
    v_cndmask_b32 v4, v4, v113, s[46:47]
    v_cndmask_b32 v4, v4, v114, s[48:49]
    v_cndmask_b32 v4, v4, v115, s[50:51]
    v_add_f32 v63, v63, v96
    v_fmac_f32 v64, v88, v92
    v_mfma_f32_16x16x4_f32 v[124:127], v4, v60, v[56:59]
    v_add_f32 v63, v63, v97
    v_fmac_f32 v64, v89, v93
    v_add_f32 v63, v63, v98
    v_fmac_f32 v64, v90, v94
    v_add_f32 v63, v63, v99
    v_fmac_f32 v64, v91, v95
    v_mov_b32 v68, v88
    v_mov_b32 v69, v89
    v_mov_b32 v70, v90
    v_mov_b32 v71, v91
    v_fma_f32 v132, -v108, v108, v124
    v_fma_f32 v133, -v109, v109, v125
    v_fma_f32 v134, -v110, v110, v126
    v_fma_f32 v135, -v111, v111, v127
    v_max_f32 v132, v132, v56
    v_max_f32 v133, v133, v56
    v_max_f32 v134, v134, v56
    v_max_f32 v135, v135, v56
    v_rsq_f32 v132, v132
    v_rsq_f32 v133, v133
    v_rsq_f32 v134, v134
    v_rsq_f32 v135, v135
    v_fma_f32 v104, -v108, v61, v104
    v_fma_f32 v105, -v109, v61, v105
    v_fma_f32 v106, -v110, v61, v106
    v_fma_f32 v107, -v111, v61, v107
    v_fma_f32 v104, v104, v132, v62
    v_fma_f32 v105, v105, v133, v62
    v_fma_f32 v106, v106, v134, v62
    v_fma_f32 v107, v107, v135, v62
    v_max3_f32 v1, v104, v105, v106
    v_max_f32 v1, v1, v107
    v_cmp_lt_f32 vcc, s52, v1
    s_cbranch_vccnz L_site12
L_back12:
    v_exp_f32 v112, v104
    v_exp_f32 v113, v105
    v_exp_f32 v114, v106
    v_exp_f32 v115, v107
    v_mul_f32 v104, v112, v132
    v_mul_f32 v105, v113, v133
    v_mul_f32 v106, v114, v134
    v_mul_f32 v107, v115, v135
    v_cvt_pk_bf16_f32 v72, v88, v89
    v_cvt_pk_bf16_f32 v73, v90, v91
    v_cvt_pk_bf16_f32 v74, v104, v105
    v_cvt_pk_bf16_f32 v75, v106, v107
    s_nop 1
    v_mfma_f32_16x16x32_bf16 a[0:3], a[144:147], v[72:75], a[0:3]
    v_add_f32 v63, v63, v112
    v_fmac_f32 v64, v104, v108
    v_mfma_f32_16x16x32_bf16 a[4:7], a[148:151], v[72:75], a[4:7]
    s_add_u32 s61, s60, 2174976
    buffer_load_dwordx4 v[208:211], v65, s[32:35], s61 offen offset:0 sc1
    v_add_f32 v63, v63, v113
    v_fmac_f32 v64, v105, v109
    v_mfma_f32_16x16x32_bf16 a[8:11], a[152:155], v[72:75], a[8:11]
    v_add_f32 v63, v63, v114
    v_fmac_f32 v64, v106, v110
    v_mfma_f32_16x16x32_bf16 a[12:15], a[156:159], v[72:75], a[12:15]
    v_add_f32 v63, v63, v115
    v_fmac_f32 v64, v107, v111
    v_mfma_f32_16x16x32_bf16 a[16:19], a[160:163], v[72:75], a[16:19]
    v_add_f32 v68, v68, v104
    v_add_f32 v69, v69, v105
    v_mfma_f32_16x16x32_bf16 a[20:23], a[164:167], v[72:75], a[20:23]
    v_add_f32 v70, v70, v106
    v_add_f32 v71, v71, v107
    v_mfma_f32_16x16x32_bf16 a[24:27], a[168:171], v[72:75], a[24:27]
    v_mfma_f32_16x16x32_bf16 a[28:31], a[172:175], v[72:75], a[28:31]
    v_mfma_f32_16x16x32_bf16 a[32:35], a[176:179], v[72:75], a[32:35]
    v_mfma_f32_16x16x32_bf16 a[36:39], a[180:183], v[72:75], a[36:39]
    v_mfma_f32_16x16x32_bf16 a[40:43], a[184:187], v[72:75], a[40:43]
    v_mfma_f32_16x16x32_bf16 a[44:47], a[188:191], v[72:75], a[44:47]
    buffer_load_dwordx4 v[212:215], v65, s[32:35], s61 offen offset:1024 sc1
    buffer_load_dwordx4 v[216:219], v65, s[32:35], s61 offen offset:2048 sc1
    s_cmp_lt_u32 s2, 6
    s_cbranch_scc0 L_nolate
    s_add_u32 s56, s60, 2162688
    buffer_load_dwordx4 v[160:163], v65, s[32:35], s56 offen offset:0 sc1
    buffer_load_dwordx4 v[164:167], v65, s[32:35], s56 offen offset:1024 sc1
    buffer_load_dwordx4 v[168:171], v65, s[32:35], s56 offen offset:2048 sc1
    buffer_load_dwordx4 v[172:175], v65, s[32:35], s56 offen offset:3072 sc1
    s_add_u32 s56, s60, 2166784
    buffer_load_dwordx4 v[176:179], v65, s[32:35], s56 offen offset:0 sc1
    buffer_load_dwordx4 v[180:183], v65, s[32:35], s56 offen offset:1024 sc1
    buffer_load_dwordx4 v[184:187], v65, s[32:35], s56 offen offset:2048 sc1
    buffer_load_dwordx4 v[188:191], v65, s[32:35], s56 offen offset:3072 sc1
    s_waitcnt vmcnt(15)
    s_branch L_landed
L_nolate:
    s_waitcnt vmcnt(7)
L_landed:
    ds_read_b128 a[96:99], v40 offset:49152
    ds_read_b128 a[100:103], v41 offset:49152
    ds_read_b128 a[104:107], v42 offset:49152
    ds_read_b128 a[108:111], v43 offset:49152
    ds_read_b128 a[112:115], v40 offset:49408
    ds_read_b128 a[116:119], v41 offset:49408
    ds_read_b128 a[120:123], v42 offset:49408
    ds_read_b128 a[124:127], v43 offset:49408
    ds_read_b128 a[128:131], v40 offset:49664
    ds_read_b128 a[132:135], v41 offset:49664
    ds_read_b128 a[136:139], v42 offset:49664
    ds_read_b128 a[140:143], v43 offset:49664
    s_waitcnt lgkmcnt(11)
    v_mfma_f32_16x16x32_bf16 v[96:99], a[96:99], a[96:99], v[84:87]
    ds_read_b64_tr_b16 a[144:145], v44 offset:49152
    ds_read_b64_tr_b16 a[146:147], v48 offset:49408
    v_mfma_f32_16x16x32_bf16 v[100:103], a[96:99], a[48:51], 0
    buffer_load_dwordx4 v[220:223], v65, s[32:35], s61 offen offset:3072 sc1
    ds_read_b64_tr_b16 a[148:149], v45 offset:49152
    ds_read_b64_tr_b16 a[150:151], v49 offset:49408
    s_waitcnt lgkmcnt(14)
    v_mfma_f32_16x16x32_bf16 v[96:99], a[100:103], a[100:103], v[96:99]
    ds_read_b64_tr_b16 a[152:153], v46 offset:49152
    ds_read_b64_tr_b16 a[154:155], v50 offset:49408
    v_mfma_f32_16x16x32_bf16 v[100:103], a[100:103], a[52:55], v[100:103]
    s_add_u32 s61, s60, 2179072
    buffer_load_dwordx4 v[224:227], v65, s[32:35], s61 offen offset:0 sc1
    ds_read_b64_tr_b16 a[156:157], v47 offset:49152
    ds_read_b64_tr_b16 a[158:159], v51 offset:49408
    s_waitcnt lgkmcnt(15)
    v_mfma_f32_16x16x32_bf16 v[96:99], a[104:107], a[104:107], v[96:99]
    ds_read_b64_tr_b16 a[160:161], v48 offset:49152
    ds_read_b64_tr_b16 a[162:163], v44 offset:49664
    v_mfma_f32_16x16x32_bf16 v[100:103], a[104:107], a[56:59], v[100:103]
    buffer_load_dwordx4 v[228:231], v65, s[32:35], s61 offen offset:1024 sc1
    ds_read_b64_tr_b16 a[164:165], v49 offset:49152
    ds_read_b64_tr_b16 a[166:167], v45 offset:49664
    v_mfma_f32_16x16x32_bf16 v[96:99], a[108:111], a[108:111], v[96:99]
    ds_read_b64_tr_b16 a[168:169], v50 offset:49152
    ds_read_b64_tr_b16 a[170:171], v46 offset:49664
    v_mfma_f32_16x16x32_bf16 v[100:103], a[108:111], a[60:63], v[100:103]
    ds_read_b64_tr_b16 a[172:173], v51 offset:49152
    ds_read_b64_tr_b16 a[174:175], v47 offset:49664
    v_mfma_f32_16x16x32_bf16 v[96:99], a[112:115], a[112:115], v[96:99]
    ds_read_b64_tr_b16 a[176:177], v44 offset:49408
    ds_read_b64_tr_b16 a[178:179], v48 offset:49664
    v_mfma_f32_16x16x32_bf16 v[100:103], a[112:115], a[64:67], v[100:103]
    ds_read_b64_tr_b16 a[180:181], v45 offset:49408
    ds_read_b64_tr_b16 a[182:183], v49 offset:49664
    s_waitcnt lgkmcnt(15)
    v_mfma_f32_16x16x32_bf16 v[96:99], a[116:119], a[116:119], v[96:99]
    ds_read_b64_tr_b16 a[184:185], v46 offset:49408
    ds_read_b64_tr_b16 a[186:187], v50 offset:49664
    v_mfma_f32_16x16x32_bf16 v[100:103], a[116:119], a[68:71], v[100:103]
    ds_read_b64_tr_b16 a[188:189], v47 offset:49408
    ds_read_b64_tr_b16 a[190:191], v51 offset:49664
    v_mfma_f32_16x16x32_bf16 v[92:95], a[96:99], v[52:55], v[80:83]
    v_mfma_f32_16x16x32_bf16 v[92:95], a[100:103], v[52:55], v[92:95]
    v_mfma_f32_16x16x32_bf16 v[92:95], a[104:107], v[52:55], v[92:95]
    v_mfma_f32_16x16x32_bf16 v[92:95], a[108:111], v[52:55], v[92:95]
    s_nop 1
    v_fma_f32 v96, v100, 2.0, v96
    v_fma_f32 v97, v101, 2.0, v97
    v_mfma_f32_16x16x32_bf16 v[92:95], a[112:115], v[52:55], v[92:95]
    v_fma_f32 v98, v102, 2.0, v98
    v_fma_f32 v99, v103, 2.0, v99
    v_mfma_f32_16x16x32_bf16 v[92:95], a[116:119], v[52:55], v[92:95]
    v_cndmask_b32 v3, 0, v96, s[44:45]
    v_cndmask_b32 v3, v3, v97, s[46:47]
    v_mfma_f32_16x16x32_bf16 v[88:91], a[96:99], v[136:139], v[76:79]
    v_cndmask_b32 v3, v3, v98, s[48:49]
    v_cndmask_b32 v3, v3, v99, s[50:51]
    v_mfma_f32_16x16x32_bf16 v[88:91], a[100:103], v[140:143], v[88:91]
    s_nop 0
    s_nop 0
    v_mfma_f32_16x16x32_bf16 v[88:91], a[104:107], v[144:147], v[88:91]
    v_mfma_f32_16x16x4_f32 v[120:123], v3, v60, v[56:59]
    v_mfma_f32_16x16x32_bf16 v[88:91], a[108:111], v[148:151], v[88:91]
    v_mfma_f32_16x16x32_bf16 v[88:91], a[112:115], v[152:155], v[88:91]
    v_mfma_f32_16x16x32_bf16 v[88:91], a[116:119], v[156:159], v[88:91]
    s_waitcnt lgkmcnt(0)
    v_mfma_f32_16x16x32_bf16 v[112:115], a[120:123], a[120:123], v[84:87]
    v_mfma_f32_16x16x32_bf16 v[116:119], a[120:123], a[48:51], 0
    v_mfma_f32_16x16x32_bf16 v[112:115], a[124:127], a[124:127], v[112:115]
    v_mfma_f32_16x16x32_bf16 v[116:119], a[124:127], a[52:55], v[116:119]
    s_nop 1
    v_fma_f32 v128, -v92, v92, v120
    v_fma_f32 v129, -v93, v93, v121
    v_mfma_f32_16x16x32_bf16 v[112:115], a[128:131], a[128:131], v[112:115]
    v_fma_f32 v130, -v94, v94, v122
    v_fma_f32 v131, -v95, v95, v123
    v_mfma_f32_16x16x32_bf16 v[116:119], a[128:131], a[56:59], v[116:119]
    v_max_f32 v128, v128, v56
    v_max_f32 v129, v129, v56
    v_mfma_f32_16x16x32_bf16 v[112:115], a[132:135], a[132:135], v[112:115]
    v_max_f32 v130, v130, v56
    v_max_f32 v131, v131, v56
    v_mfma_f32_16x16x32_bf16 v[116:119], a[132:135], a[60:63], v[116:119]
    v_rsq_f32 v128, v128
    v_mfma_f32_16x16x32_bf16 v[112:115], a[136:139], a[136:139], v[112:115]
    v_rsq_f32 v129, v129
    v_mfma_f32_16x16x32_bf16 v[116:119], a[136:139], a[64:67], v[116:119]
    v_rsq_f32 v130, v130
    v_mfma_f32_16x16x32_bf16 v[112:115], a[140:143], a[140:143], v[112:115]
    v_rsq_f32 v131, v131
    v_mfma_f32_16x16x32_bf16 v[116:119], a[140:143], a[68:71], v[116:119]
    v_fma_f32 v88, -v92, v61, v88
    v_fma_f32 v89, -v93, v61, v89
    v_mfma_f32_16x16x32_bf16 v[108:111], a[120:123], v[52:55], v[80:83]
    v_fma_f32 v90, -v94, v61, v90
    v_fma_f32 v91, -v95, v61, v91
    v_mfma_f32_16x16x32_bf16 v[108:111], a[124:127], v[52:55], v[108:111]
    v_fma_f32 v88, v88, v128, v62
    v_fma_f32 v89, v89, v129, v62
    v_mfma_f32_16x16x32_bf16 v[108:111], a[128:131], v[52:55], v[108:111]
    v_fma_f32 v90, v90, v130, v62
    v_fma_f32 v91, v91, v131, v62
    v_mfma_f32_16x16x32_bf16 v[108:111], a[132:135], v[52:55], v[108:111]
    v_max3_f32 v1, v88, v89, v90
    v_max_f32 v1, v1, v91
    v_mfma_f32_16x16x32_bf16 v[108:111], a[136:139], v[52:55], v[108:111]
    v_cmp_lt_f32 vcc, s52, v1
    s_cbranch_vccnz L_site13
L_back13:
    v_mfma_f32_16x16x32_bf16 v[108:111], a[140:143], v[52:55], v[108:111]
    v_exp_f32 v96, v88
    v_mfma_f32_16x16x32_bf16 v[104:107], a[120:123], v[136:139], v[76:79]
    v_exp_f32 v97, v89
    v_mfma_f32_16x16x32_bf16 v[104:107], a[124:127], v[140:143], v[104:107]
    v_exp_f32 v98, v90
    v_mfma_f32_16x16x32_bf16 v[104:107], a[128:131], v[144:147], v[104:107]
    v_exp_f32 v99, v91
    v_mfma_f32_16x16x32_bf16 v[104:107], a[132:135], v[148:151], v[104:107]
    v_mul_f32 v88, v96, v128
    v_mul_f32 v89, v97, v129
    v_mfma_f32_16x16x32_bf16 v[104:107], a[136:139], v[152:155], v[104:107]
    v_mul_f32 v90, v98, v130
    v_mul_f32 v91, v99, v131
    v_mfma_f32_16x16x32_bf16 v[104:107], a[140:143], v[156:159], v[104:107]
    v_fma_f32 v112, v116, 2.0, v112
    v_fma_f32 v113, v117, 2.0, v113
    v_fma_f32 v114, v118, 2.0, v114
    v_fma_f32 v115, v119, 2.0, v115
    v_cndmask_b32 v4, 0, v112, s[44:45]
    v_cndmask_b32 v4, v4, v113, s[46:47]
    v_cndmask_b32 v4, v4, v114, s[48:49]
    v_cndmask_b32 v4, v4, v115, s[50:51]
    v_add_f32 v63, v63, v96
    v_fmac_f32 v64, v88, v92
    v_mfma_f32_16x16x4_f32 v[124:127], v4, v60, v[56:59]
    v_add_f32 v63, v63, v97
    v_fmac_f32 v64, v89, v93
    v_add_f32 v63, v63, v98
    v_fmac_f32 v64, v90, v94
    v_add_f32 v63, v63, v99
    v_fmac_f32 v64, v91, v95
    v_add_f32 v68, v68, v88
    v_add_f32 v69, v69, v89
    v_add_f32 v70, v70, v90
    v_add_f32 v71, v71, v91
    v_fma_f32 v132, -v108, v108, v124
    v_fma_f32 v133, -v109, v109, v125
    v_fma_f32 v134, -v110, v110, v126
    v_fma_f32 v135, -v111, v111, v127
    v_max_f32 v132, v132, v56
    v_max_f32 v133, v133, v56
    v_max_f32 v134, v134, v56
    v_max_f32 v135, v135, v56
    v_rsq_f32 v132, v132
    v_rsq_f32 v133, v133
    v_rsq_f32 v134, v134
    v_rsq_f32 v135, v135
    v_fma_f32 v104, -v108, v61, v104
    v_fma_f32 v105, -v109, v61, v105
    v_fma_f32 v106, -v110, v61, v106
    v_fma_f32 v107, -v111, v61, v107
    v_fma_f32 v104, v104, v132, v62
    v_fma_f32 v105, v105, v133, v62
    v_fma_f32 v106, v106, v134, v62
    v_fma_f32 v107, v107, v135, v62
    v_max3_f32 v1, v104, v105, v106
    v_max_f32 v1, v1, v107
    v_cmp_lt_f32 vcc, s52, v1
    s_cbranch_vccnz L_site14
L_back14:
    v_exp_f32 v112, v104
    v_exp_f32 v113, v105
    v_exp_f32 v114, v106
    v_exp_f32 v115, v107
    v_mul_f32 v104, v112, v132
    v_mul_f32 v105, v113, v133
    v_mul_f32 v106, v114, v134
    v_mul_f32 v107, v115, v135
    v_cvt_pk_bf16_f32 v72, v88, v89
    v_cvt_pk_bf16_f32 v73, v90, v91
    v_cvt_pk_bf16_f32 v74, v104, v105
    v_cvt_pk_bf16_f32 v75, v106, v107
    s_nop 1
    v_mfma_f32_16x16x32_bf16 a[0:3], a[144:147], v[72:75], a[0:3]
    v_add_f32 v68, v68, v104
    v_add_f32 v69, v69, v105
    v_mfma_f32_16x16x32_bf16 a[4:7], a[148:151], v[72:75], a[4:7]
    v_add_f32 v70, v70, v106
    v_add_f32 v71, v71, v107
    v_mfma_f32_16x16x32_bf16 a[8:11], a[152:155], v[72:75], a[8:11]
    v_cvt_pk_bf16_f32 v66, v68, v69
    v_cvt_pk_bf16_f32 v67, v70, v71
    v_mfma_f32_16x16x32_bf16 a[12:15], a[156:159], v[72:75], a[12:15]
    v_add_f32 v63, v63, v112
    v_fmac_f32 v64, v104, v108
    v_mfma_f32_16x16x32_bf16 a[16:19], a[160:163], v[72:75], a[16:19]
    v_add_f32 v63, v63, v113
    v_fmac_f32 v64, v105, v109
    v_mfma_f32_16x16x32_bf16 a[20:23], a[164:167], v[72:75], a[20:23]
    v_add_f32 v63, v63, v114
    v_fmac_f32 v64, v106, v110
    v_mfma_f32_16x16x32_bf16 a[24:27], a[168:171], v[72:75], a[24:27]
    v_add_f32 v63, v63, v115
    v_fmac_f32 v64, v107, v111
    v_mfma_f32_16x16x32_bf16 a[28:31], a[172:175], v[72:75], a[28:31]
    v_mfma_f32_16x16x32_bf16 a[32:35], a[176:179], v[72:75], a[32:35]
    v_mfma_f32_16x16x32_bf16 a[36:39], a[180:183], v[72:75], a[36:39]
    v_mfma_f32_16x16x32_bf16 a[40:43], a[184:187], v[72:75], a[40:43]
    v_mfma_f32_16x16x32_bf16 a[44:47], a[188:191], v[72:75], a[44:47]
    v_mfma_f32_16x16x16_bf16 a[0:3], a[72:73], v[66:67], a[0:3]
    v_mfma_f32_16x16x16_bf16 a[4:7], a[74:75], v[66:67], a[4:7]
    v_mfma_f32_16x16x16_bf16 a[8:11], a[76:77], v[66:67], a[8:11]
    v_mfma_f32_16x16x16_bf16 a[12:15], a[78:79], v[66:67], a[12:15]
    v_mfma_f32_16x16x16_bf16 a[16:19], a[80:81], v[66:67], a[16:19]
    v_mfma_f32_16x16x16_bf16 a[20:23], a[82:83], v[66:67], a[20:23]
    v_mfma_f32_16x16x16_bf16 a[24:27], a[84:85], v[66:67], a[24:27]
    v_mfma_f32_16x16x16_bf16 a[28:31], a[86:87], v[66:67], a[28:31]
    v_mfma_f32_16x16x16_bf16 a[32:35], a[88:89], v[66:67], a[32:35]
    v_mfma_f32_16x16x16_bf16 a[36:39], a[90:91], v[66:67], a[36:39]
    v_mfma_f32_16x16x16_bf16 a[40:43], a[92:93], v[66:67], a[40:43]
    v_mfma_f32_16x16x16_bf16 a[44:47], a[94:95], v[66:67], a[44:47]
L_tail:
    s_lshl_b32 s56, s3, 17
    s_lshl_b32 s57, s2, 7
    s_add_u32 s56, s56, s57
    s_add_u32 s56, s56, 65536
    v_mov_b32 v232, 0x53800000
    s_mov_b32 s43, 1
    ds_write_b128 v238, a[0:3] offset:0
    ds_write_b128 v238, a[4:7] offset:1024
    ds_write_b128 v238, a[8:11] offset:2048
    ds_write_b128 v238, a[12:15] offset:3072
    ds_write_b128 v238, a[16:19] offset:4096
    ds_write_b128 v238, a[20:23] offset:5120
    ds_write_b128 v238, a[24:27] offset:6144
    ds_write_b128 v238, a[28:31] offset:7168
    ds_write_b128 v238, a[32:35] offset:8192
    ds_write_b128 v238, a[36:39] offset:9216
    ds_write_b128 v238, a[40:43] offset:10240
    ds_write_b128 v238, a[44:47] offset:11264
    ds_write_b128 v239, v[62:65]
    v_mov_b32 v44, 1.0
    s_waitcnt lgkmcnt(0)
    s_barrier
    ds_read_b128 v[16:19], v240 offset:0
    ds_read_b128 v[20:23], v240 offset:1024
    ds_read_b128 v[24:27], v240 offset:2048
    ds_read_b128 v[28:31], v240 offset:3072
    ds_read_b128 v[76:79], v237 offset:0
    ds_read_b128 v[80:83], v237 offset:1024
    ds_read_b128 v[84:87], v237 offset:2048
    ds_read_b128 v[88:91], v237 offset:12288
    ds_read_b128 v[92:95], v237 offset:13312
    ds_read_b128 v[96:99], v237 offset:14336
    ds_read_b128 v[100:103], v237 offset:24576
    ds_read_b128 v[104:107], v237 offset:25600
    ds_read_b128 v[108:111], v237 offset:26624
    ds_read_b128 v[112:115], v237 offset:36864
    ds_read_b128 v[116:119], v237 offset:37888
    ds_read_b128 v[120:123], v237 offset:38912
    s_waitcnt lgkmcnt(12)
    v_min3_f32 v9, v16, v20, v24
    v_min_f32 v9, v9, v28
    v_sub_f32 v32, v9, v16
    v_sub_f32 v33, v9, v20
    v_sub_f32 v34, v9, v24
    v_sub_f32 v35, v9, v28
    v_exp_f32 v32, v32
    v_exp_f32 v33, v33
    v_exp_f32 v34, v34
    v_exp_f32 v35, v35
    v_mul_f32 v1, v32, v17
    v_mul_f32 v2, v32, v18
    v_fmac_f32 v1, v33, v21
    v_fmac_f32 v2, v33, v22
    v_fmac_f32 v1, v34, v25
    v_fmac_f32 v2, v34, v26
    v_fmac_f32 v1, v35, v29
    v_fmac_f32 v2, v35, v30
    s_waitcnt lgkmcnt(9)
    v_mul_f32 v76, v76, v32
    v_mul_f32 v77, v77, v32
    v_mfma_f32_16x16x4_f32 v[36:39], v44, v1, 0
    v_mfma_f32_16x16x4_f32 v[40:43], v44, v2, 0
    v_mul_f32 v78, v78, v32
    v_mul_f32 v79, v79, v32
    v_mul_f32 v80, v80, v32
    v_mul_f32 v81, v81, v32
    v_mul_f32 v82, v82, v32
    v_mul_f32 v83, v83, v32
    v_mul_f32 v84, v84, v32
    v_mul_f32 v85, v85, v32
    v_mul_f32 v86, v86, v32
    v_mul_f32 v87, v87, v32
    s_waitcnt lgkmcnt(6)
    v_fmac_f32 v76, v88, v33
    v_fmac_f32 v77, v89, v33
    v_fmac_f32 v78, v90, v33
    v_fmac_f32 v79, v91, v33
    v_fmac_f32 v80, v92, v33
    v_fmac_f32 v81, v93, v33
    v_fmac_f32 v82, v94, v33
    v_fmac_f32 v83, v95, v33
    v_fmac_f32 v84, v96, v33
    v_fmac_f32 v85, v97, v33
    v_fmac_f32 v86, v98, v33
    v_fmac_f32 v87, v99, v33
    v_rcp_f32 v3, v36
    v_log_f32 v4, v36
    s_waitcnt lgkmcnt(3)
    v_fmac_f32 v76, v100, v34
    v_fmac_f32 v77, v101, v34
    v_fmac_f32 v78, v102, v34
    v_fmac_f32 v79, v103, v34
    v_fmac_f32 v80, v104, v34
    v_fmac_f32 v81, v105, v34
    v_fmac_f32 v82, v106, v34
    v_fmac_f32 v83, v107, v34
    v_fmac_f32 v84, v108, v34
    v_fmac_f32 v85, v109, v34
    v_fmac_f32 v86, v110, v34
    v_fmac_f32 v87, v111, v34
    v_mul_f32 v5, v60, v3
    v_mul_f32 v6, v40, v3
    v_sub_f32 v4, v4, v9
    s_waitcnt lgkmcnt(0)
    v_fmac_f32 v76, v112, v35
    v_fmac_f32 v77, v113, v35
    v_fmac_f32 v78, v114, v35
    v_fmac_f32 v79, v115, v35
    v_fmac_f32 v80, v116, v35
    v_fmac_f32 v81, v117, v35
    v_fmac_f32 v82, v118, v35
    v_fmac_f32 v83, v119, v35
    v_fmac_f32 v84, v120, v35
    v_fmac_f32 v85, v121, v35
    v_fmac_f32 v86, v122, v35
    v_fmac_f32 v87, v123, v35
    v_fma_f32 v76, v76, v5, -v6
    v_fma_f32 v77, v77, v5, -v6
    v_fma_f32 v78, v78, v5, -v6
    v_fma_f32 v79, v79, v5, -v6
    v_fma_f32 v80, v80, v5, -v6
    v_fma_f32 v81, v81, v5, -v6
    v_fma_f32 v82, v82, v5, -v6
    v_fma_f32 v83, v83, v5, -v6
    v_fma_f32 v84, v84, v5, -v6
    v_fma_f32 v85, v85, v5, -v6
    v_fma_f32 v86, v86, v5, -v6
    v_fma_f32 v87, v87, v5, -v6
    v_cvt_pk_bf16_f32 v88, v76, v77
    v_cvt_pk_bf16_f32 v89, v78, v79
    ds_write_b64 v236, v[88:89] offset:0
    v_cvt_pk_bf16_f32 v90, v80, v81
    v_cvt_pk_bf16_f32 v91, v82, v83
    ds_write_b64 v236, v[90:91] offset:512
    v_cvt_pk_bf16_f32 v92, v84, v85
    v_cvt_pk_bf16_f32 v93, v86, v87
    ds_write_b64 v236, v[92:93] offset:1024
    s_waitcnt vmcnt(0)
    s_waitcnt lgkmcnt(0)
    s_barrier
    ds_read_b128 v[136:139], v241 offset:0
    ds_read_b128 v[140:143], v241 offset:1024
    ds_read_b128 v[144:147], v241 offset:2048
    ds_read_b128 v[148:151], v241 offset:3072
    ds_read_b128 v[152:155], v241 offset:4096
    ds_read_b128 v[156:159], v241 offset:5120
    s_waitcnt lgkmcnt(5)
    v_mfma_f32_16x16x32_bf16 v[16:19], v[160:163], v[136:139], 0
    v_mfma_f32_16x16x32_bf16 v[20:23], v[184:187], v[136:139], 0
    v_mfma_f32_16x16x32_bf16 v[24:27], v[208:211], v[136:139], 0
    s_waitcnt lgkmcnt(4)
    v_mfma_f32_16x16x32_bf16 v[16:19], v[164:167], v[140:143], v[16:19]
    v_mfma_f32_16x16x32_bf16 v[20:23], v[188:191], v[140:143], v[20:23]
    v_mfma_f32_16x16x32_bf16 v[24:27], v[212:215], v[140:143], v[24:27]
    s_waitcnt lgkmcnt(3)
    v_mfma_f32_16x16x32_bf16 v[16:19], v[168:171], v[144:147], v[16:19]
    v_mfma_f32_16x16x32_bf16 v[20:23], v[192:195], v[144:147], v[20:23]
    v_mfma_f32_16x16x32_bf16 v[24:27], v[216:219], v[144:147], v[24:27]
    s_waitcnt lgkmcnt(2)
    v_mfma_f32_16x16x32_bf16 v[16:19], v[172:175], v[148:151], v[16:19]
    v_mfma_f32_16x16x32_bf16 v[20:23], v[196:199], v[148:151], v[20:23]
    v_mfma_f32_16x16x32_bf16 v[24:27], v[220:223], v[148:151], v[24:27]
    s_waitcnt lgkmcnt(1)
    v_mfma_f32_16x16x32_bf16 v[16:19], v[176:179], v[152:155], v[16:19]
    v_mfma_f32_16x16x32_bf16 v[20:23], v[200:203], v[152:155], v[20:23]
    v_mfma_f32_16x16x32_bf16 v[24:27], v[224:227], v[152:155], v[24:27]
    s_waitcnt lgkmcnt(0)
    v_mfma_f32_16x16x32_bf16 v[16:19], v[180:183], v[156:159], v[16:19]
    v_mfma_f32_16x16x32_bf16 v[20:23], v[204:207], v[156:159], v[20:23]
    v_mfma_f32_16x16x32_bf16 v[24:27], v[228:231], v[156:159], v[24:27]
    v_mov_b32 v35, v4
    v_add_u32 v39, s39, v4
    s_nop 3
    v_cvt_pk_bf16_f32 v32, v16, v17
    v_cvt_pk_bf16_f32 v33, v18, v19
    v_cvt_pk_bf16_f32 v34, v20, v21
    buffer_store_dwordx4 v[32:35], v242, s[32:35], s56 offen sc1
    v_cvt_pk_bf16_f32 v36, v22, v23
    v_cvt_pk_bf16_f32 v37, v24, v25
    v_cvt_pk_bf16_f32 v38, v26, v27
    buffer_store_dwordx4 v[36:39], v243, s[32:35], s56 offen sc1
    s_sub_u32 s58, s2, 64
    s_cmp_ge_u32 s58, 64
    s_cbranch_scc1 L_fin
    s_lshl_b32 s60, s58, 15
    s_lshl_b32 s57, s3, 13
    s_add_u32 s60, s60, s57
    s_add_u32 s60, s60, 65536
    s_add_u32 s61, s60, 4096
    buffer_load_dwordx4 v[76:79], v65, s[32:35], s60 offen offset:0 sc1
    buffer_load_dwordx4 v[80:83], v65, s[32:35], s60 offen offset:1024 sc1
    buffer_load_dwordx4 v[84:87], v65, s[32:35], s60 offen offset:2048 sc1
    buffer_load_dwordx4 v[88:91], v65, s[32:35], s60 offen offset:3072 sc1
    buffer_load_dwordx4 v[92:95], v65, s[32:35], s61 offen offset:0 sc1
    buffer_load_dwordx4 v[96:99], v65, s[32:35], s61 offen offset:1024 sc1
    buffer_load_dwordx4 v[100:103], v65, s[32:35], s61 offen offset:2048 sc1
    buffer_load_dwordx4 v[104:107], v65, s[32:35], s61 offen offset:3072 sc1
    s_mov_b32 s68, s18
    s_mov_b32 s69, s19
    s_mov_b32 s70, 6144
    s_mov_b32 s71, 0x20000
    ds_bpermute_b32 v42, v252, v4
    v_bfe_u32 v48, v0, 2, 1
    v_cmp_eq_u32 vcc, 1, v48
    v_mov_b32 v246, s39
    s_nop 0
    v_cndmask_b32 v247, 0, v246, vcc
    v_sub_u32 v246, v246, v247
    v_sub_u32 v246, v246, v247
    v_mov_b32 v16, 0
    v_mov_b32 v17, 0
    v_mov_b32 v18, 0
    v_mov_b32 v19, 0
    v_mov_b32 v20, 0
    v_mov_b32 v21, 0
    v_mov_b32 v22, 0
    s_mov_b32 s53, 0
    s_waitcnt lgkmcnt(0)
    s_waitcnt vmcnt(0)
    v_sub_u32_dpp v48, v79, v79 row_half_mirror row_mask:0xf bank_mask:0xf
    v_cmp_eq_u32 vcc, v48, v246
    s_mov_b64 s[6:7], vcc
    s_not_b64 s[24:25], vcc
    s_cbranch_scc0 L_c_a0
    s_mov_b64 exec, s[24:25]
    buffer_load_dwordx4 v[76:79], v65, s[32:35], s60 offen offset:0 sc1
    s_mov_b64 exec, -1
L_c_a0:
    v_sub_u32_dpp v48, v83, v83 row_half_mirror row_mask:0xf bank_mask:0xf
    v_cmp_eq_u32 vcc, v48, v246
    s_mov_b64 s[8:9], vcc
    s_not_b64 s[26:27], vcc
    s_cbranch_scc0 L_c_a1
    s_mov_b64 exec, s[26:27]
    buffer_load_dwordx4 v[80:83], v65, s[32:35], s60 offen offset:1024 sc1
    s_mov_b64 exec, -1
L_c_a1:
    v_sub_u32_dpp v48, v87, v87 row_half_mirror row_mask:0xf bank_mask:0xf
    v_cmp_eq_u32 vcc, v48, v246
    s_mov_b64 s[10:11], vcc
    s_not_b64 s[28:29], vcc
    s_cbranch_scc0 L_c_a2
    s_mov_b64 exec, s[28:29]
    buffer_load_dwordx4 v[84:87], v65, s[32:35], s60 offen offset:2048 sc1
    s_mov_b64 exec, -1
L_c_a2:
    v_sub_u32_dpp v48, v91, v91 row_half_mirror row_mask:0xf bank_mask:0xf
    v_cmp_eq_u32 vcc, v48, v246
    s_mov_b64 s[12:13], vcc
    s_not_b64 s[30:31], vcc
    s_cbranch_scc0 L_c_a3
    s_mov_b64 exec, s[30:31]
    buffer_load_dwordx4 v[88:91], v65, s[32:35], s60 offen offset:3072 sc1
    s_mov_b64 exec, -1
L_c_a3:
    v_sub_u32_dpp v48, v95, v95 row_half_mirror row_mask:0xf bank_mask:0xf
    v_cmp_eq_u32 vcc, v48, v246
    s_mov_b64 s[14:15], vcc
    s_not_b64 s[44:45], vcc
    s_cbranch_scc0 L_c_a4
    s_mov_b64 exec, s[44:45]
    buffer_load_dwordx4 v[92:95], v65, s[32:35], s61 offen offset:0 sc1
    s_mov_b64 exec, -1
L_c_a4:
    v_sub_u32_dpp v48, v99, v99 row_half_mirror row_mask:0xf bank_mask:0xf
    v_cmp_eq_u32 vcc, v48, v246
    s_mov_b64 s[16:17], vcc
    s_not_b64 s[46:47], vcc
    s_cbranch_scc0 L_c_a5
    s_mov_b64 exec, s[46:47]
    buffer_load_dwordx4 v[96:99], v65, s[32:35], s61 offen offset:1024 sc1
    s_mov_b64 exec, -1
L_c_a5:
    v_sub_u32_dpp v48, v103, v103 row_half_mirror row_mask:0xf bank_mask:0xf
    v_cmp_eq_u32 vcc, v48, v246
    s_mov_b64 s[36:37], vcc
    s_not_b64 s[48:49], vcc
    s_cbranch_scc0 L_c_a6
    s_mov_b64 exec, s[48:49]
    buffer_load_dwordx4 v[100:103], v65, s[32:35], s61 offen offset:2048 sc1
    s_mov_b64 exec, -1
L_c_a6:
    v_sub_u32_dpp v48, v107, v107 row_half_mirror row_mask:0xf bank_mask:0xf
    v_cmp_eq_u32 vcc, v48, v246
    s_mov_b64 s[40:41], vcc
    s_not_b64 s[50:51], vcc
    s_cbranch_scc0 L_c_a7
    s_mov_b64 exec, s[50:51]
    buffer_load_dwordx4 v[104:107], v65, s[32:35], s61 offen offset:3072 sc1
    s_mov_b64 exec, -1
L_c_a7:
L_c_acc:
    s_mov_b64 exec, s[6:7]
    v_sub_u32 v49, v79, v247
    v_sub_f32 v49, v49, v42
    v_exp_f32 v49, v49
    s_nop 0
    v_cvt_pk_bf16_f32 v49, v49, 0
    v_lshlrev_b32 v50, 16, v49
    v_dot2_f32_bf16 v16, v76, v49, v16
    v_dot2_f32_bf16 v18, v77, v49, v18
    v_dot2_f32_bf16 v20, v78, v49, v20
    v_add_f32 v22, v22, v50
    v_dot2_f32_bf16 v17, v76, v50, v17
    v_dot2_f32_bf16 v19, v77, v50, v19
    v_dot2_f32_bf16 v21, v78, v50, v21
    s_mov_b64 exec, s[8:9]
    v_sub_u32 v49, v83, v247
    v_sub_f32 v49, v49, v42
    v_exp_f32 v49, v49
    s_nop 0
    v_cvt_pk_bf16_f32 v49, v49, 0
    v_lshlrev_b32 v50, 16, v49
    v_dot2_f32_bf16 v16, v80, v49, v16
    v_dot2_f32_bf16 v18, v81, v49, v18
    v_dot2_f32_bf16 v20, v82, v49, v20
    v_add_f32 v22, v22, v50
    v_dot2_f32_bf16 v17, v80, v50, v17
    v_dot2_f32_bf16 v19, v81, v50, v19
    v_dot2_f32_bf16 v21, v82, v50, v21
    s_mov_b64 exec, s[10:11]
    v_sub_u32 v49, v87, v247
    v_sub_f32 v49, v49, v42
    v_exp_f32 v49, v49
    s_nop 0
    v_cvt_pk_bf16_f32 v49, v49, 0
    v_lshlrev_b32 v50, 16, v49
    v_dot2_f32_bf16 v16, v84, v49, v16
    v_dot2_f32_bf16 v18, v85, v49, v18
    v_dot2_f32_bf16 v20, v86, v49, v20
    v_add_f32 v22, v22, v50
    v_dot2_f32_bf16 v17, v84, v50, v17
    v_dot2_f32_bf16 v19, v85, v50, v19
    v_dot2_f32_bf16 v21, v86, v50, v21
    s_mov_b64 exec, s[12:13]
    v_sub_u32 v49, v91, v247
    v_sub_f32 v49, v49, v42
    v_exp_f32 v49, v49
    s_nop 0
    v_cvt_pk_bf16_f32 v49, v49, 0
    v_lshlrev_b32 v50, 16, v49
    v_dot2_f32_bf16 v16, v88, v49, v16
    v_dot2_f32_bf16 v18, v89, v49, v18
    v_dot2_f32_bf16 v20, v90, v49, v20
    v_add_f32 v22, v22, v50
    v_dot2_f32_bf16 v17, v88, v50, v17
    v_dot2_f32_bf16 v19, v89, v50, v19
    v_dot2_f32_bf16 v21, v90, v50, v21
    s_mov_b64 exec, s[14:15]
    v_sub_u32 v49, v95, v247
    v_sub_f32 v49, v49, v42
    v_exp_f32 v49, v49
    s_nop 0
    v_cvt_pk_bf16_f32 v49, v49, 0
    v_lshlrev_b32 v50, 16, v49
    v_dot2_f32_bf16 v16, v92, v49, v16
    v_dot2_f32_bf16 v18, v93, v49, v18
    v_dot2_f32_bf16 v20, v94, v49, v20
    v_add_f32 v22, v22, v50
    v_dot2_f32_bf16 v17, v92, v50, v17
    v_dot2_f32_bf16 v19, v93, v50, v19
    v_dot2_f32_bf16 v21, v94, v50, v21
    s_mov_b64 exec, s[16:17]
    v_sub_u32 v49, v99, v247
    v_sub_f32 v49, v49, v42
    v_exp_f32 v49, v49
    s_nop 0
    v_cvt_pk_bf16_f32 v49, v49, 0
    v_lshlrev_b32 v50, 16, v49
    v_dot2_f32_bf16 v16, v96, v49, v16
    v_dot2_f32_bf16 v18, v97, v49, v18
    v_dot2_f32_bf16 v20, v98, v49, v20
    v_add_f32 v22, v22, v50
    v_dot2_f32_bf16 v17, v96, v50, v17
    v_dot2_f32_bf16 v19, v97, v50, v19
    v_dot2_f32_bf16 v21, v98, v50, v21
    s_mov_b64 exec, s[36:37]
    v_sub_u32 v49, v103, v247
    v_sub_f32 v49, v49, v42
    v_exp_f32 v49, v49
    s_nop 0
    v_cvt_pk_bf16_f32 v49, v49, 0
    v_lshlrev_b32 v50, 16, v49
    v_dot2_f32_bf16 v16, v100, v49, v16
    v_dot2_f32_bf16 v18, v101, v49, v18
    v_dot2_f32_bf16 v20, v102, v49, v20
    v_add_f32 v22, v22, v50
    v_dot2_f32_bf16 v17, v100, v50, v17
    v_dot2_f32_bf16 v19, v101, v50, v19
    v_dot2_f32_bf16 v21, v102, v50, v21
    s_mov_b64 exec, s[40:41]
    v_sub_u32 v49, v107, v247
    v_sub_f32 v49, v49, v42
    v_exp_f32 v49, v49
    s_nop 0
    v_cvt_pk_bf16_f32 v49, v49, 0
    v_lshlrev_b32 v50, 16, v49
    v_dot2_f32_bf16 v16, v104, v49, v16
    v_dot2_f32_bf16 v18, v105, v49, v18
    v_dot2_f32_bf16 v20, v106, v49, v20
    v_add_f32 v22, v22, v50
    v_dot2_f32_bf16 v17, v104, v50, v17
    v_dot2_f32_bf16 v19, v105, v50, v19
    v_dot2_f32_bf16 v21, v106, v50, v21
    s_mov_b64 exec, -1
L_c_loop:
    s_or_b64 vcc, s[24:25], s[26:27]
    s_or_b64 vcc, vcc, s[28:29]
    s_or_b64 vcc, vcc, s[30:31]
    s_or_b64 vcc, vcc, s[44:45]
    s_or_b64 vcc, vcc, s[46:47]
    s_or_b64 vcc, vcc, s[48:49]
    s_or_b64 vcc, vcc, s[50:51]
    s_cbranch_scc0 L_c_red
    s_add_u32 s53, s53, 1
    s_cmp_gt_u32 s53, 65536
    s_cbranch_scc1 L_c_red
    s_waitcnt vmcnt(0)
    s_cmp_eq_u64 s[24:25], 0
    s_cbranch_scc1 L_c_b0
    v_sub_u32_dpp v48, v79, v79 row_half_mirror row_mask:0xf bank_mask:0xf
    v_cmp_eq_u32 vcc, v48, v246
    s_and_b64 s[6:7], vcc, s[24:25]
    s_andn2_b64 s[24:25], s[24:25], vcc
    s_cbranch_scc0 L_c_n0
    s_mov_b64 exec, s[24:25]
    buffer_load_dwordx4 v[76:79], v65, s[32:35], s60 offen offset:0 sc1
L_c_n0:
    s_mov_b64 exec, s[6:7]
    s_cbranch_execz L_c_e0
    v_sub_u32 v49, v79, v247
    v_sub_f32 v49, v49, v42
    v_exp_f32 v49, v49
    s_nop 0
    v_cvt_pk_bf16_f32 v49, v49, 0
    v_lshlrev_b32 v50, 16, v49
    v_dot2_f32_bf16 v16, v76, v49, v16
    v_dot2_f32_bf16 v18, v77, v49, v18
    v_dot2_f32_bf16 v20, v78, v49, v20
    v_add_f32 v22, v22, v50
    v_dot2_f32_bf16 v17, v76, v50, v17
    v_dot2_f32_bf16 v19, v77, v50, v19
    v_dot2_f32_bf16 v21, v78, v50, v21
L_c_e0:
    s_mov_b64 exec, -1
L_c_b0:
    s_cmp_eq_u64 s[26:27], 0
    s_cbranch_scc1 L_c_b1
    v_sub_u32_dpp v48, v83, v83 row_half_mirror row_mask:0xf bank_mask:0xf
    v_cmp_eq_u32 vcc, v48, v246
    s_and_b64 s[6:7], vcc, s[26:27]
    s_andn2_b64 s[26:27], s[26:27], vcc
    s_cbranch_scc0 L_c_n1
    s_mov_b64 exec, s[26:27]
    buffer_load_dwordx4 v[80:83], v65, s[32:35], s60 offen offset:1024 sc1
L_c_n1:
    s_mov_b64 exec, s[6:7]
    s_cbranch_execz L_c_e1
    v_sub_u32 v49, v83, v247
    v_sub_f32 v49, v49, v42
    v_exp_f32 v49, v49
    s_nop 0
    v_cvt_pk_bf16_f32 v49, v49, 0
    v_lshlrev_b32 v50, 16, v49
    v_dot2_f32_bf16 v16, v80, v49, v16
    v_dot2_f32_bf16 v18, v81, v49, v18
    v_dot2_f32_bf16 v20, v82, v49, v20
    v_add_f32 v22, v22, v50
    v_dot2_f32_bf16 v17, v80, v50, v17
    v_dot2_f32_bf16 v19, v81, v50, v19
    v_dot2_f32_bf16 v21, v82, v50, v21
L_c_e1:
    s_mov_b64 exec, -1
L_c_b1:
    s_cmp_eq_u64 s[28:29], 0
    s_cbranch_scc1 L_c_b2
    v_sub_u32_dpp v48, v87, v87 row_half_mirror row_mask:0xf bank_mask:0xf
    v_cmp_eq_u32 vcc, v48, v246
    s_and_b64 s[6:7], vcc, s[28:29]
    s_andn2_b64 s[28:29], s[28:29], vcc
    s_cbranch_scc0 L_c_n2
    s_mov_b64 exec, s[28:29]
    buffer_load_dwordx4 v[84:87], v65, s[32:35], s60 offen offset:2048 sc1
L_c_n2:
    s_mov_b64 exec, s[6:7]
    s_cbranch_execz L_c_e2
    v_sub_u32 v49, v87, v247
    v_sub_f32 v49, v49, v42
    v_exp_f32 v49, v49
    s_nop 0
    v_cvt_pk_bf16_f32 v49, v49, 0
    v_lshlrev_b32 v50, 16, v49
    v_dot2_f32_bf16 v16, v84, v49, v16
    v_dot2_f32_bf16 v18, v85, v49, v18
    v_dot2_f32_bf16 v20, v86, v49, v20
    v_add_f32 v22, v22, v50
    v_dot2_f32_bf16 v17, v84, v50, v17
    v_dot2_f32_bf16 v19, v85, v50, v19
    v_dot2_f32_bf16 v21, v86, v50, v21
L_c_e2:
    s_mov_b64 exec, -1
L_c_b2:
    s_cmp_eq_u64 s[30:31], 0
    s_cbranch_scc1 L_c_b3
    v_sub_u32_dpp v48, v91, v91 row_half_mirror row_mask:0xf bank_mask:0xf
    v_cmp_eq_u32 vcc, v48, v246
    s_and_b64 s[6:7], vcc, s[30:31]
    s_andn2_b64 s[30:31], s[30:31], vcc
    s_cbranch_scc0 L_c_n3
    s_mov_b64 exec, s[30:31]
    buffer_load_dwordx4 v[88:91], v65, s[32:35], s60 offen offset:3072 sc1
L_c_n3:
    s_mov_b64 exec, s[6:7]
    s_cbranch_execz L_c_e3
    v_sub_u32 v49, v91, v247
    v_sub_f32 v49, v49, v42
    v_exp_f32 v49, v49
    s_nop 0
    v_cvt_pk_bf16_f32 v49, v49, 0
    v_lshlrev_b32 v50, 16, v49
    v_dot2_f32_bf16 v16, v88, v49, v16
    v_dot2_f32_bf16 v18, v89, v49, v18
    v_dot2_f32_bf16 v20, v90, v49, v20
    v_add_f32 v22, v22, v50
    v_dot2_f32_bf16 v17, v88, v50, v17
    v_dot2_f32_bf16 v19, v89, v50, v19
    v_dot2_f32_bf16 v21, v90, v50, v21
L_c_e3:
    s_mov_b64 exec, -1
L_c_b3:
    s_cmp_eq_u64 s[44:45], 0
    s_cbranch_scc1 L_c_b4
    v_sub_u32_dpp v48, v95, v95 row_half_mirror row_mask:0xf bank_mask:0xf
    v_cmp_eq_u32 vcc, v48, v246
    s_and_b64 s[6:7], vcc, s[44:45]
    s_andn2_b64 s[44:45], s[44:45], vcc
    s_cbranch_scc0 L_c_n4
    s_mov_b64 exec, s[44:45]
    buffer_load_dwordx4 v[92:95], v65, s[32:35], s61 offen offset:0 sc1
L_c_n4:
    s_mov_b64 exec, s[6:7]
    s_cbranch_execz L_c_e4
    v_sub_u32 v49, v95, v247
    v_sub_f32 v49, v49, v42
    v_exp_f32 v49, v49
    s_nop 0
    v_cvt_pk_bf16_f32 v49, v49, 0
    v_lshlrev_b32 v50, 16, v49
    v_dot2_f32_bf16 v16, v92, v49, v16
    v_dot2_f32_bf16 v18, v93, v49, v18
    v_dot2_f32_bf16 v20, v94, v49, v20
    v_add_f32 v22, v22, v50
    v_dot2_f32_bf16 v17, v92, v50, v17
    v_dot2_f32_bf16 v19, v93, v50, v19
    v_dot2_f32_bf16 v21, v94, v50, v21
L_c_e4:
    s_mov_b64 exec, -1
L_c_b4:
    s_cmp_eq_u64 s[46:47], 0
    s_cbranch_scc1 L_c_b5
    v_sub_u32_dpp v48, v99, v99 row_half_mirror row_mask:0xf bank_mask:0xf
    v_cmp_eq_u32 vcc, v48, v246
    s_and_b64 s[6:7], vcc, s[46:47]
    s_andn2_b64 s[46:47], s[46:47], vcc
    s_cbranch_scc0 L_c_n5
    s_mov_b64 exec, s[46:47]
    buffer_load_dwordx4 v[96:99], v65, s[32:35], s61 offen offset:1024 sc1
L_c_n5:
    s_mov_b64 exec, s[6:7]
    s_cbranch_execz L_c_e5
    v_sub_u32 v49, v99, v247
    v_sub_f32 v49, v49, v42
    v_exp_f32 v49, v49
    s_nop 0
    v_cvt_pk_bf16_f32 v49, v49, 0
    v_lshlrev_b32 v50, 16, v49
    v_dot2_f32_bf16 v16, v96, v49, v16
    v_dot2_f32_bf16 v18, v97, v49, v18
    v_dot2_f32_bf16 v20, v98, v49, v20
    v_add_f32 v22, v22, v50
    v_dot2_f32_bf16 v17, v96, v50, v17
    v_dot2_f32_bf16 v19, v97, v50, v19
    v_dot2_f32_bf16 v21, v98, v50, v21
L_c_e5:
    s_mov_b64 exec, -1
L_c_b5:
    s_cmp_eq_u64 s[48:49], 0
    s_cbranch_scc1 L_c_b6
    v_sub_u32_dpp v48, v103, v103 row_half_mirror row_mask:0xf bank_mask:0xf
    v_cmp_eq_u32 vcc, v48, v246
    s_and_b64 s[6:7], vcc, s[48:49]
    s_andn2_b64 s[48:49], s[48:49], vcc
    s_cbranch_scc0 L_c_n6
    s_mov_b64 exec, s[48:49]
    buffer_load_dwordx4 v[100:103], v65, s[32:35], s61 offen offset:2048 sc1
L_c_n6:
    s_mov_b64 exec, s[6:7]
    s_cbranch_execz L_c_e6
    v_sub_u32 v49, v103, v247
    v_sub_f32 v49, v49, v42
    v_exp_f32 v49, v49
    s_nop 0
    v_cvt_pk_bf16_f32 v49, v49, 0
    v_lshlrev_b32 v50, 16, v49
    v_dot2_f32_bf16 v16, v100, v49, v16
    v_dot2_f32_bf16 v18, v101, v49, v18
    v_dot2_f32_bf16 v20, v102, v49, v20
    v_add_f32 v22, v22, v50
    v_dot2_f32_bf16 v17, v100, v50, v17
    v_dot2_f32_bf16 v19, v101, v50, v19
    v_dot2_f32_bf16 v21, v102, v50, v21
L_c_e6:
    s_mov_b64 exec, -1
L_c_b6:
    s_cmp_eq_u64 s[50:51], 0
    s_cbranch_scc1 L_c_b7
    v_sub_u32_dpp v48, v107, v107 row_half_mirror row_mask:0xf bank_mask:0xf
    v_cmp_eq_u32 vcc, v48, v246
    s_and_b64 s[6:7], vcc, s[50:51]
    s_andn2_b64 s[50:51], s[50:51], vcc
    s_cbranch_scc0 L_c_n7
    s_mov_b64 exec, s[50:51]
    buffer_load_dwordx4 v[104:107], v65, s[32:35], s61 offen offset:3072 sc1
L_c_n7:
    s_mov_b64 exec, s[6:7]
    s_cbranch_execz L_c_e7
    v_sub_u32 v49, v107, v247
    v_sub_f32 v49, v49, v42
    v_exp_f32 v49, v49
    s_nop 0
    v_cvt_pk_bf16_f32 v49, v49, 0
    v_lshlrev_b32 v50, 16, v49
    v_dot2_f32_bf16 v16, v104, v49, v16
    v_dot2_f32_bf16 v18, v105, v49, v18
    v_dot2_f32_bf16 v20, v106, v49, v20
    v_add_f32 v22, v22, v50
    v_dot2_f32_bf16 v17, v104, v50, v17
    v_dot2_f32_bf16 v19, v105, v50, v19
    v_dot2_f32_bf16 v21, v106, v50, v21
L_c_e7:
    s_mov_b64 exec, -1
L_c_b7:
    s_branch L_c_loop
L_c_red:
    s_waitcnt vmcnt(0)
    v_mov_b32 v23, v22
    v_permlane32_swap_b32 v16, v20
    v_permlane32_swap_b32 v17, v21
    v_permlane32_swap_b32 v18, v22
    v_permlane32_swap_b32 v19, v23
    v_add_f32 v16, v16, v20
    v_add_f32 v17, v17, v21
    v_add_f32 v18, v18, v22
    v_add_f32 v19, v19, v23
    s_nop 0
    v_permlane16_swap_b32 v16, v18
    v_permlane16_swap_b32 v17, v19
    v_add_f32 v16, v16, v18
    v_add_f32 v17, v17, v19
    s_nop 0
    v_add_f32_dpp v48, v16, v16 row_ror:8 row_mask:0xf bank_mask:0x3
    s_nop 1
    v_add_f32_dpp v48, v17, v17 row_ror:8 row_mask:0xf bank_mask:0xc
    ds_write_b32 v250, v48
    s_waitcnt lgkmcnt(0)
    s_barrier
    ds_read_b128 v[48:51], v251 offset:768
    ds_read_b128 v[52:55], v65
    v_lshlrev_b32 v18, 16, v249
    s_waitcnt lgkmcnt(1)
    v_add_f32 v48, v48, v49
    v_add_f32 v50, v50, v51
    v_add_f32 v48, v48, v50
    v_cmp_nlt_f32 vcc, v48, v232
    v_rcp_f32 v48, v48
    s_waitcnt lgkmcnt(0)
    s_cbranch_vccnz L_c_slow
L_c_out:
    s_cmp_lg_u32 s3, 0
    s_cbranch_scc1 L_fin
    v_add_f32 v52, v52, v53
    v_add_f32 v54, v54, v55
    v_add_f32 v52, v52, v54
    v_fmac_f32 v18, v52, v48
    v_cvt_pk_bf16_f32 v18, v18, v18
    buffer_store_short v18, v248, s[68:71], 0 offen
    s_cmp_lg_u32 s58, 0
    s_cbranch_scc1 L_fin
    v_mov_b32 v48, s39
    v_mov_b32 v49, 0
    s_mov_b64 exec, 1
    buffer_store_dword v48, v49, s[32:35], 0 offen offset:0 sc1
    s_mov_b64 exec, -1
L_fin:
L_end:
    s_endpgm
L_prod:
    s_cmp_lg_u32 s3, 0
    s_cbranch_scc1 L_p_noq
    s_mov_b32 m0, 147456
    s_nop 0
    buffer_load_dwordx4 v16, s[72:75], 0 offen offset:0  lds
    buffer_load_dwordx4 v17, s[72:75], 0 offen offset:1024  lds
    buffer_load_dwordx4 v18, s[72:75], 0 offen offset:2048  lds
    buffer_load_dwordx4 v19, s[72:75], 0 offen offset:3072  lds
    s_mov_b32 m0, 151552
    s_nop 0
    buffer_load_dwordx4 v20, s[72:75], 0 offen offset:0  lds
    buffer_load_dwordx4 v21, s[72:75], 0 offen offset:1024  lds
L_p_noq:
    s_mul_i32 s60, s3, 18432
    s_add_u32 m0, s60, 73728
    s_nop 0
    buffer_load_dwordx4 v16, s[64:67], s60 offen offset:0  lds
    buffer_load_dwordx4 v17, s[64:67], s60 offen offset:1024  lds
    buffer_load_dwordx4 v18, s[64:67], s60 offen offset:2048  lds
    buffer_load_dwordx4 v19, s[64:67], s60 offen offset:3072  lds
    s_add_u32 m0, s60, 77824
    s_nop 0
    buffer_load_dwordx4 v20, s[64:67], s60 offen offset:0  lds
    buffer_load_dwordx4 v21, s[64:67], s60 offen offset:1024  lds
    s_add_u32 s60, s60, 6144
    s_add_u32 m0, s60, 73728
    s_nop 0
    buffer_load_dwordx4 v16, s[64:67], s60 offen offset:0  lds
    buffer_load_dwordx4 v17, s[64:67], s60 offen offset:1024  lds
    buffer_load_dwordx4 v18, s[64:67], s60 offen offset:2048  lds
    buffer_load_dwordx4 v19, s[64:67], s60 offen offset:3072  lds
    s_add_u32 m0, s60, 77824
    s_nop 0
    buffer_load_dwordx4 v20, s[64:67], s60 offen offset:0  lds
    buffer_load_dwordx4 v21, s[64:67], s60 offen offset:1024  lds
    s_add_u32 s60, s60, 6144
    s_add_u32 m0, s60, 73728
    s_nop 0
    buffer_load_dwordx4 v16, s[64:67], s60 offen offset:0  lds
    v_mov_b32 v52, 0x3f803f80
    v_mov_b32 v56, 0x3ebcbe62
    s_mov_b32 s44, 0x100001
    s_mov_b32 s45, 0x10000100
    v_mov_b32 v53, 0x3f803f80
    v_mov_b32 v57, 0x3ebcbe62
    s_mov_b32 s46, 0x200002
    buffer_load_dwordx4 v17, s[64:67], s60 offen offset:1024  lds
    s_mov_b32 s47, 0x20000200
    v_mov_b32 v54, 0x3f803f80
    v_mov_b32 v58, 0x3ebcbe62
    s_mov_b32 s48, 0x400004
    s_mov_b32 s49, 0x40000400
    v_mov_b32 v55, 0x3f803f80
    v_mov_b32 v59, 0x3ebcbe62
    buffer_load_dwordx4 v18, s[64:67], s60 offen offset:2048  lds
    s_mov_b32 s50, 0x800008
    s_mov_b32 s51, 0x80000800
    v_mov_b32 v60, 0x43400000
    v_lshrrev_b32 v1, 5, v0
    v_lshlrev_b32 v1, 8, v1
    v_and_b32 v2, 15, v0
    v_lshl_add_u32 v1, v2, 4, v1
    buffer_load_dwordx4 v19, s[64:67], s60 offen offset:3072  lds
    v_bfe_u32 v2, v0, 4, 1
    v_lshl_add_u32 v1, v2, 3, v1
    s_mul_i32 s56, s3, 1536
    s_add_u32 s56, s56, 153600
    v_add_u32 v134, s56, v1
    v_bfe_u32 v1, v0, 4, 1
    v_lshrrev_b32 v5, 5, v0
    s_add_u32 m0, s60, 77824
    s_nop 0
    buffer_load_dwordx4 v20, s[64:67], s60 offen offset:0  lds
    v_lshl_or_b32 v1, v1, 1, v5
    v_bfe_u32 v2, v0, 2, 2
    v_lshl_add_u32 v3, v1, 3, v2
    v_mul_u32_u24 v3, 384, v3
    v_and_b32 v4, 1, v0
    v_lshl_add_u32 v3, v4, 3, v3
    v_add_u32 v3, 73728, v3
    buffer_load_dwordx4 v21, s[64:67], s60 offen offset:1024  lds
    v_and_or_b32 v2, v2, 2, v5
    v_bfe_u32 v4, v0, 1, 1
    v_xor_b32 v2, v2, v4
    s_mul_i32 s56, s3, 6
    s_add_u32 s57, s56, 0
    v_xor_b32 v4, s57, v2
    v_lshl_add_u32 v124, v4, 4, v3
    s_lshl_b32 s61, s43, 2
    s_add_u32 s61, s61, s3
    s_mul_i32 s60, s61, 6144
    s_add_u32 m0, s41, 6144
    s_nop 0
    buffer_load_dwordx4 v16, s[68:71], s60 offen offset:0  lds
    v_xor_b32 v125, 64, v124
    s_add_u32 s57, s56, 2
    v_xor_b32 v4, s57, v2
    v_lshl_add_u32 v126, v4, 4, v3
    v_xor_b32 v127, 64, v126
    s_add_u32 s57, s56, 4
    v_xor_b32 v4, s57, v2
    buffer_load_dwordx4 v17, s[68:71], s60 offen offset:1024  lds
    v_lshl_add_u32 v128, v4, 4, v3
    v_xor_b32 v129, 64, v128
    v_and_b32 v2, 15, v0
    v_bfe_u32 v3, v0, 3, 1
    v_and_or_b32 v4, v0, 6, v3
    v_xor_b32 v4, v4, v1
    v_mul_u32_u24 v2, 384, v2
    buffer_load_dwordx4 v18, s[68:71], s60 offen offset:2048  lds
    v_lshl_add_u32 v2, v4, 4, v2
    v_add_u32 v132, 147456, v2
    v_xor_b32 v133, 64, v132
    s_and_b32 s56, s3, 1
    s_lshl_b32 s56, s56, 2
    s_lshr_b32 s57, s3, 1
    s_mul_i32 s57, s57, 24576
    buffer_load_dwordx4 v19, s[68:71], s60 offen offset:3072  lds
    s_add_u32 s57, s57, 30720
    v_and_b32 v1, 11, v0
    v_or_b32 v1, s56, v1
    v_and_or_b32 v2, v1, 6, v3
    v_lshrrev_b32 v3, 4, v0
    v_xor_b32 v2, v2, v3
    v_mul_u32_u24 v1, 384, v1
    s_add_u32 m0, s41, 10240
    s_nop 0
    buffer_load_dwordx4 v20, s[68:71], s60 offen offset:0  lds
    v_lshl_add_u32 v1, v2, 4, v1
    v_bfe_u32 v2, v0, 2, 1
    v_mul_u32_u24 v2, 12288, v2
    v_add3_u32 v130, s57, v1, v2
    v_xor_b32 v131, 64, v130
    v_add_u32 v135, 153600, v65
    buffer_load_dwordx4 v21, s[68:71], s60 offen offset:1024  lds
    s_waitcnt vmcnt(24)
    s_barrier
    s_load_dword s38, s[22:23], 0
    ds_read_b128 v[136:139], v132 offset:0
    ds_read_b128 v[140:143], v133 offset:0
    ds_read_b128 v[144:147], v132 offset:128
    ds_read_b128 v[148:151], v133 offset:128
    ds_read_b128 v[152:155], v132 offset:256
    ds_read_b128 v[156:159], v133 offset:256
    s_add_u32 m0, s40, 0
    s_add_u32 s57, s36, 0
    buffer_load_dwordx4 v16, s[28:31], s57 offen offset:0 nt lds
    buffer_load_dwordx4 v17, s[28:31], s57 offen offset:1024 nt lds
    buffer_load_dwordx4 v18, s[28:31], s57 offen offset:2048 nt lds
    buffer_load_dwordx4 v19, s[28:31], s57 offen offset:3072 nt lds
    s_add_u32 m0, s40, 4096
    s_nop 0
    buffer_load_dwordx4 v20, s[28:31], s57 offen offset:0 nt lds
    buffer_load_dwordx4 v21, s[28:31], s57 offen offset:1024 nt lds
    s_waitcnt lgkmcnt(0)
    v_mfma_f32_16x16x32_bf16 v[112:115], v[136:139], v[136:139], 0
    v_mfma_f32_16x16x32_bf16 v[116:119], v[52:55], v[136:139], 0
    s_add_u32 m0, s41, 0
    s_add_u32 s58, s37, 0
    buffer_load_dwordx4 v22, s[24:27], s58 offen offset:0 nt lds
    v_mfma_f32_16x16x32_bf16 v[112:115], v[140:143], v[140:143], v[112:115]
    v_mfma_f32_16x16x32_bf16 v[116:119], v[52:55], v[140:143], v[116:119]
    buffer_load_dwordx4 v23, s[24:27], s58 offen offset:1024 nt lds
    v_mfma_f32_16x16x32_bf16 v[112:115], v[144:147], v[144:147], v[112:115]
    v_mfma_f32_16x16x32_bf16 v[116:119], v[52:55], v[144:147], v[116:119]
    buffer_load_dwordx4 v24, s[24:27], s58 offen offset:2048 nt lds
    v_mfma_f32_16x16x32_bf16 v[112:115], v[148:151], v[148:151], v[112:115]
    v_mfma_f32_16x16x32_bf16 v[116:119], v[52:55], v[148:151], v[116:119]
    v_mfma_f32_16x16x32_bf16 v[112:115], v[152:155], v[152:155], v[112:115]
    v_mfma_f32_16x16x32_bf16 v[116:119], v[52:55], v[152:155], v[116:119]
    v_mfma_f32_16x16x32_bf16 v[112:115], v[156:159], v[156:159], v[112:115]
    v_mfma_f32_16x16x32_bf16 v[116:119], v[52:55], v[156:159], v[116:119]
    s_mul_i32 s39, s38, 0x9e3779b1
    s_add_u32 s39, s39, 0x7f4a7c16
    s_or_b32 s39, s39, 1
    s_lshl_b32 s61, s61, 10
    s_add_u32 s61, s61, 16384
    s_waitcnt vmcnt(15)
    s_barrier
    ds_read_b64_tr_b16 v[160:161], v124 offset:0
    ds_read_b64_tr_b16 v[162:163], v125 offset:1536
    ds_read_b64_tr_b16 v[184:185], v126 offset:0
    ds_read_b64_tr_b16 v[186:187], v127 offset:1536
    ds_read_b64_tr_b16 v[208:209], v128 offset:0
    ds_read_b64_tr_b16 v[210:211], v129 offset:1536
    ds_read_b64_tr_b16 v[164:165], v124 offset:12288
    ds_read_b64_tr_b16 v[166:167], v125 offset:13824
    ds_read_b64_tr_b16 v[188:189], v126 offset:12288
    ds_read_b64_tr_b16 v[190:191], v127 offset:13824
    ds_read_b64_tr_b16 v[212:213], v128 offset:12288
    ds_read_b64_tr_b16 v[214:215], v129 offset:13824
    v_cndmask_b32 v3, 0, v112, s[44:45]
    v_cndmask_b32 v3, v3, v113, s[46:47]
    v_cndmask_b32 v3, v3, v114, s[48:49]
    v_cndmask_b32 v3, v3, v115, s[50:51]
    v_mul_f32 v6, 0x3baaaaab, v116
    ds_read_b64_tr_b16 v[168:169], v124 offset:24576
    ds_read_b64_tr_b16 v[170:171], v125 offset:26112
    v_mfma_f32_16x16x4_f32 v[120:123], v60, v3, v[56:59]
    s_waitcnt lgkmcnt(12)
    v_mfma_f32_16x16x32_bf16 v[88:91], v[160:163], v[136:139], 0
    ds_read_b64_tr_b16 v[192:193], v126 offset:24576
    v_mfma_f32_16x16x32_bf16 v[100:103], v[160:163], v[52:55], 0
    ds_read_b64_tr_b16 v[194:195], v127 offset:26112
    s_waitcnt lgkmcnt(12)
    v_mfma_f32_16x16x32_bf16 v[92:95], v[184:187], v[136:139], 0
    ds_read_b64_tr_b16 v[216:217], v128 offset:24576
    v_mfma_f32_16x16x32_bf16 v[104:107], v[184:187], v[52:55], 0
    ds_read_b64_tr_b16 v[218:219], v129 offset:26112
    s_waitcnt lgkmcnt(12)
    v_mfma_f32_16x16x32_bf16 v[96:99], v[208:211], v[136:139], 0
    ds_read_b64_tr_b16 v[172:173], v124 offset:36864
    v_mfma_f32_16x16x32_bf16 v[108:111], v[208:211], v[52:55], 0
    ds_read_b64_tr_b16 v[174:175], v125 offset:38400
    s_waitcnt lgkmcnt(12)
    v_mfma_f32_16x16x32_bf16 v[88:91], v[164:167], v[140:143], v[88:91]
    ds_read_b64_tr_b16 v[196:197], v126 offset:36864
    v_mfma_f32_16x16x32_bf16 v[100:103], v[164:167], v[52:55], v[100:103]
    ds_read_b64_tr_b16 v[198:199], v127 offset:38400
    s_waitcnt lgkmcnt(12)
    v_mfma_f32_16x16x32_bf16 v[92:95], v[188:191], v[140:143], v[92:95]
    ds_read_b64_tr_b16 v[220:221], v128 offset:36864
    v_mfma_f32_16x16x32_bf16 v[104:107], v[188:191], v[52:55], v[104:107]
    ds_read_b64_tr_b16 v[222:223], v129 offset:38400
    s_waitcnt lgkmcnt(12)
    v_mfma_f32_16x16x32_bf16 v[96:99], v[212:215], v[140:143], v[96:99]
    ds_read_b64_tr_b16 v[176:177], v124 offset:49152
    v_mfma_f32_16x16x32_bf16 v[108:111], v[212:215], v[52:55], v[108:111]
    ds_read_b64_tr_b16 v[178:179], v125 offset:50688
    s_waitcnt lgkmcnt(12)
    v_mfma_f32_16x16x32_bf16 v[88:91], v[168:171], v[144:147], v[88:91]
    ds_read_b64_tr_b16 v[200:201], v126 offset:49152
    v_mfma_f32_16x16x32_bf16 v[100:103], v[168:171], v[52:55], v[100:103]
    ds_read_b64_tr_b16 v[202:203], v127 offset:50688
    s_waitcnt lgkmcnt(12)
    v_mfma_f32_16x16x32_bf16 v[92:95], v[192:195], v[144:147], v[92:95]
    ds_read_b64_tr_b16 v[224:225], v128 offset:49152
    v_mfma_f32_16x16x32_bf16 v[104:107], v[192:195], v[52:55], v[104:107]
    ds_read_b64_tr_b16 v[226:227], v129 offset:50688
    s_waitcnt lgkmcnt(12)
    v_mfma_f32_16x16x32_bf16 v[96:99], v[216:219], v[144:147], v[96:99]
    ds_read_b64_tr_b16 v[180:181], v124 offset:61440
    v_mfma_f32_16x16x32_bf16 v[108:111], v[216:219], v[52:55], v[108:111]
    ds_read_b64_tr_b16 v[182:183], v125 offset:62976
    s_waitcnt lgkmcnt(12)
    v_mfma_f32_16x16x32_bf16 v[88:91], v[172:175], v[148:151], v[88:91]
    ds_read_b64_tr_b16 v[204:205], v126 offset:61440
    v_mfma_f32_16x16x32_bf16 v[100:103], v[172:175], v[52:55], v[100:103]
    ds_read_b64_tr_b16 v[206:207], v127 offset:62976
    s_waitcnt lgkmcnt(12)
    v_mfma_f32_16x16x32_bf16 v[92:95], v[196:199], v[148:151], v[92:95]
    ds_read_b64_tr_b16 v[228:229], v128 offset:61440
    v_mfma_f32_16x16x32_bf16 v[104:107], v[196:199], v[52:55], v[104:107]
    ds_read_b64_tr_b16 v[230:231], v129 offset:62976
    s_waitcnt lgkmcnt(12)
    v_mfma_f32_16x16x32_bf16 v[96:99], v[220:223], v[148:151], v[96:99]
    v_fma_f32 v5, -v116, v116, v120
    v_mfma_f32_16x16x32_bf16 v[108:111], v[220:223], v[52:55], v[108:111]
    v_max_f32 v5, v5, v56
    s_waitcnt lgkmcnt(10)
    v_mfma_f32_16x16x32_bf16 v[88:91], v[176:179], v[152:155], v[88:91]
    v_rsq_f32 v5, v5
    v_mfma_f32_16x16x32_bf16 v[100:103], v[176:179], v[52:55], v[100:103]
    v_mov_b32 v122, s39
    s_waitcnt lgkmcnt(8)
    v_mfma_f32_16x16x32_bf16 v[92:95], v[200:203], v[152:155], v[92:95]
    v_mul_f32 v5, v60, v5
    v_mfma_f32_16x16x32_bf16 v[104:107], v[200:203], v[52:55], v[104:107]
    v_mov_b32 v123, s39
    s_waitcnt lgkmcnt(6)
    v_mfma_f32_16x16x32_bf16 v[96:99], v[224:227], v[152:155], v[96:99]
    v_mfma_f32_16x16x32_bf16 v[108:111], v[224:227], v[52:55], v[108:111]
    s_waitcnt lgkmcnt(4)
    v_mfma_f32_16x16x32_bf16 v[88:91], v[180:183], v[156:159], v[88:91]
    v_mfma_f32_16x16x32_bf16 v[100:103], v[180:183], v[52:55], v[100:103]
    s_waitcnt lgkmcnt(2)
    v_mfma_f32_16x16x32_bf16 v[92:95], v[204:207], v[156:159], v[92:95]
    v_mfma_f32_16x16x32_bf16 v[104:107], v[204:207], v[52:55], v[104:107]
    s_waitcnt lgkmcnt(0)
    v_mfma_f32_16x16x32_bf16 v[96:99], v[228:231], v[156:159], v[96:99]
    v_mfma_f32_16x16x32_bf16 v[108:111], v[228:231], v[52:55], v[108:111]
    s_nop 1
    v_fma_f32 v88, -v6, v100, v88
    v_fma_f32 v89, -v6, v101, v89
    v_fma_f32 v90, -v6, v102, v90
    v_fma_f32 v91, -v6, v103, v91
    v_mul_f32 v88, v88, v5
    v_mul_f32 v89, v89, v5
    v_mul_f32 v90, v90, v5
    v_mul_f32 v91, v91, v5
    v_cvt_pk_bf16_f32 v112, v88, v89
    v_cvt_pk_bf16_f32 v113, v90, v91
    ds_write_b64 v134, v[112:113] offset:0
    v_fma_f32 v92, -v6, v104, v92
    v_fma_f32 v93, -v6, v105, v93
    v_fma_f32 v94, -v6, v106, v94
    v_fma_f32 v95, -v6, v107, v95
    v_mul_f32 v92, v92, v5
    v_mul_f32 v93, v93, v5
    v_mul_f32 v94, v94, v5
    v_mul_f32 v95, v95, v5
    v_cvt_pk_bf16_f32 v114, v92, v93
    v_cvt_pk_bf16_f32 v115, v94, v95
    ds_write_b64 v134, v[114:115] offset:512
    v_fma_f32 v96, -v6, v108, v96
    v_fma_f32 v97, -v6, v109, v97
    v_fma_f32 v98, -v6, v110, v98
    v_fma_f32 v99, -v6, v111, v99
    v_mul_f32 v96, v96, v5
    v_mul_f32 v97, v97, v5
    v_mul_f32 v98, v98, v5
    v_mul_f32 v99, v99, v5
    v_cvt_pk_bf16_f32 v116, v96, v97
    v_cvt_pk_bf16_f32 v117, v98, v99
    ds_write_b64 v134, v[116:117] offset:1024
    s_waitcnt vmcnt(9)
    s_waitcnt lgkmcnt(0)
    s_barrier
    ds_read_b128 v[136:139], v135 offset:0
    ds_read_b128 a[96:99], v130 offset:0
    ds_read_b128 v[140:143], v135 offset:1024
    ds_read_b128 a[100:103], v131 offset:0
    ds_read_b128 v[144:147], v135 offset:2048
    ds_read_b128 a[104:107], v130 offset:128
    ds_read_b128 v[148:151], v135 offset:3072
    ds_read_b128 a[108:111], v131 offset:128
    ds_read_b128 v[152:155], v135 offset:4096
    ds_read_b128 a[112:115], v130 offset:256
    ds_read_b128 v[156:159], v135 offset:5120
    ds_read_b128 a[116:119], v131 offset:256
    s_waitcnt lgkmcnt(10)
    v_mfma_f32_16x16x32_bf16 v[88:91], a[96:99], v[136:139], 0
    s_waitcnt lgkmcnt(8)
    v_mfma_f32_16x16x32_bf16 v[92:95], a[100:103], v[140:143], 0
    s_waitcnt lgkmcnt(6)
    v_mfma_f32_16x16x32_bf16 v[88:91], a[104:107], v[144:147], v[88:91]
    s_waitcnt lgkmcnt(4)
    v_mfma_f32_16x16x32_bf16 v[92:95], a[108:111], v[148:151], v[92:95]
    s_waitcnt lgkmcnt(2)
    v_mfma_f32_16x16x32_bf16 v[88:91], a[112:115], v[152:155], v[88:91]
    s_waitcnt lgkmcnt(0)
    v_mfma_f32_16x16x32_bf16 v[92:95], a[116:119], v[156:159], v[92:95]
    s_nop 7
    v_add_f32 v88, v88, v92
    v_add_f32 v89, v89, v93
    v_add_f32 v90, v90, v94
    v_add_f32 v91, v91, v95
    v_mul_f32 v88, 0x419fecaf, v88
    v_mul_f32 v89, 0x419fecaf, v89
    v_mul_f32 v90, 0x419fecaf, v90
    v_mul_f32 v91, 0x419fecaf, v91
    v_cvt_pk_bf16_f32 v120, v88, v89
    v_cvt_pk_bf16_f32 v121, v90, v91
    buffer_store_dwordx4 v[120:123], v65, s[32:35], s61 offen sc1
    buffer_load_dwordx4 v25, s[24:27], s58 offen offset:3072 nt lds
    s_add_u32 m0, s41, 4096
    s_nop 0
    buffer_load_dwordx4 v26, s[24:27], s58 offen offset:0 nt lds
    buffer_load_dwordx4 v27, s[24:27], s58 offen offset:1024 nt lds
    s_barrier
    buffer_load_dwordx4 v28, s[24:27], s58 offen offset:2048 nt lds
    buffer_load_dwordx4 v29, s[24:27], s58 offen offset:3072 nt lds
    s_add_u32 m0, s41, 8192
    s_nop 0
    buffer_load_dwordx4 v30, s[24:27], s58 offen offset:0 nt lds
    buffer_load_dwordx4 v31, s[24:27], s58 offen offset:1024 nt lds
    buffer_load_dwordx4 v32, s[24:27], s58 offen offset:2048 nt lds
    buffer_load_dwordx4 v33, s[24:27], s58 offen offset:3072 nt lds
    v_and_b32 v1, 15, v0
    v_lshrrev_b32 v2, 4, v0
    v_lshrrev_b32 v6, 1, v2
    v_and_b32 v3, 1, v2
    v_lshl_or_b32 v3, v3, 1, v6
    v_lshrrev_b32 v4, 2, v0
    v_bfe_u32 v5, v0, 1, 1
    v_lshrrev_b32 v6, 3, v1
    v_and_or_b32 v6, v1, 6, v6
    v_xor_b32 v6, v6, v3
    v_mul_u32_u24 v7, 384, v1
    v_lshl_add_u32 v6, v6, 4, v7
    v_add_u32 v34, s40, v6
    v_xor_b32 v35, 64, v34
    v_lshrrev_b32 v6, 3, v1
    v_and_b32 v7, 7, v1
    v_lshl_or_b32 v6, v7, 1, v6
    v_xor_b32 v6, v6, v3
    v_mul_u32_u24 v7, 768, v1
    v_lshl_add_u32 v6, v6, 4, v7
    v_add_u32 v40, s41, v6
    v_xor_b32 v41, 0x40, v40
    v_xor_b32 v42, 0x80, v40
    v_xor_b32 v43, 0xc0, v40
    v_and_b32 v2, 1, v0
    v_lshlrev_b32 v2, 3, v2
    v_lshrrev_b32 v6, 3, v4
    v_and_or_b32 v6, v4, 6, v6
    v_xor_b32 v6, v6, v5
    v_mul_u32_u24 v7, 384, v4
    v_lshl_add_u32 v6, v6, 4, v7
    v_add3_u32 v36, s40, v6, v2
    v_xor_b32 v37, 0x20, v36
    v_xor_b32 v38, 0x40, v36
    v_xor_b32 v39, 0x60, v36
    v_lshrrev_b32 v6, 3, v4
    v_and_b32 v7, 7, v4
    v_lshl_or_b32 v6, v7, 1, v6
    v_xor_b32 v6, v6, v5
    v_mul_u32_u24 v7, 768, v4
    v_lshl_add_u32 v6, v6, 4, v7
    v_add3_u32 v44, s41, v6, v2
    v_xor_b32 v45, 0x20, v44
    v_xor_b32 v46, 0x40, v44
    v_xor_b32 v47, 0x60, v44
    v_xor_b32 v48, 0x80, v44
    v_xor_b32 v49, 0xa0, v44
    v_xor_b32 v50, 0xc0, v44
    v_xor_b32 v51, 0xe0, v44
    v_lshrrev_b32 v1, 5, v0
    v_lshlrev_b32 v1, 8, v1
    v_and_b32 v2, 15, v0
    v_lshl_add_u32 v1, v2, 4, v1
    v_bfe_u32 v2, v0, 4, 1
    v_lshl_add_u32 v1, v2, 3, v1
    s_mul_i32 s56, s3, 1536
    s_add_u32 s56, s56, 147456
    v_add_u32 v236, s56, v1
    s_mul_i32 s56, s3, 3072
    s_add_u32 s56, s56, 24576
    v_add_u32 v237, s56, v65
    v_add_u32 v238, s41, v65
    s_lshl_b32 s56, s3, 10
    v_add_u32 v240, 159744, v65
    v_add_u32 v239, s56, v240
    v_add_u32 v241, 147456, v65
    v_bfe_u32 v1, v0, 2, 2
    v_lshlrev_b32 v1, 19, v1
    v_lshrrev_b32 v2, 4, v0
    v_lshl_or_b32 v1, v2, 15, v1
    v_and_b32 v2, 3, v0
    v_lshl_or_b32 v242, v2, 4, v1
    v_xor_b32 v243, 0x70, v242
    s_mul_i32 s56, s3, 3
    v_min_u32 v1, 2, v0
    v_add_u32 v1, s56, v1
    v_lshlrev_b32 v245, 7, v1
    s_mov_b32 s52, 0x41c00000
    s_add_u32 m0, s42, 0
    s_add_u32 s59, s37, 196608
    buffer_load_dwordx4 v22, s[24:27], s59 offen offset:0 nt lds
    buffer_load_dwordx4 v23, s[24:27], s59 offen offset:1024 nt lds
    buffer_load_dwordx4 v24, s[24:27], s59 offen offset:2048 nt lds
    buffer_load_dwordx4 v25, s[24:27], s59 offen offset:3072 nt lds
    s_add_u32 m0, s42, 4096
    s_nop 0
    buffer_load_dwordx4 v26, s[24:27], s59 offen offset:0 nt lds
    buffer_load_dwordx4 v27, s[24:27], s59 offen offset:1024 nt lds
    buffer_load_dwordx4 v28, s[24:27], s59 offen offset:2048 nt lds
    buffer_load_dwordx4 v29, s[24:27], s59 offen offset:3072 nt lds
    s_add_u32 m0, s42, 8192
    s_nop 0
    buffer_load_dwordx4 v30, s[24:27], s59 offen offset:0 nt lds
    buffer_load_dwordx4 v31, s[24:27], s59 offen offset:1024 nt lds
    buffer_load_dwordx4 v32, s[24:27], s59 offen offset:2048 nt lds
    buffer_load_dwordx4 v33, s[24:27], s59 offen offset:3072 nt lds
    s_mov_b32 s43, -1
    s_branch L_join
L_vprod:
    s_mul_i32 s60, s3, 18432
    s_add_u32 m0, s60, 73728
    s_nop 0
    buffer_load_dwordx4 v16, s[64:67], s60 offen offset:0  lds
    buffer_load_dwordx4 v17, s[64:67], s60 offen offset:1024  lds
    buffer_load_dwordx4 v18, s[64:67], s60 offen offset:2048  lds
    buffer_load_dwordx4 v19, s[64:67], s60 offen offset:3072  lds
    s_add_u32 m0, s60, 77824
    s_nop 0
    buffer_load_dwordx4 v20, s[64:67], s60 offen offset:0  lds
    buffer_load_dwordx4 v21, s[64:67], s60 offen offset:1024  lds
    s_add_u32 s60, s60, 6144
    s_add_u32 m0, s60, 73728
    s_nop 0
    buffer_load_dwordx4 v16, s[64:67], s60 offen offset:0  lds
    buffer_load_dwordx4 v17, s[64:67], s60 offen offset:1024  lds
    buffer_load_dwordx4 v18, s[64:67], s60 offen offset:2048  lds
    buffer_load_dwordx4 v19, s[64:67], s60 offen offset:3072  lds
    s_add_u32 m0, s60, 77824
    s_nop 0
    buffer_load_dwordx4 v20, s[64:67], s60 offen offset:0  lds
    buffer_load_dwordx4 v21, s[64:67], s60 offen offset:1024  lds
    s_add_u32 s60, s60, 6144
    s_add_u32 m0, s60, 73728
    s_nop 0
    buffer_load_dwordx4 v16, s[64:67], s60 offen offset:0  lds
    v_lshrrev_b32 v1, 4, v0
    v_and_b32 v5, 1, v1
    v_bfe_u32 v2, v0, 2, 2
    v_lshl_add_u32 v3, v1, 3, v2
    buffer_load_dwordx4 v17, s[64:67], s60 offen offset:1024  lds
    v_mul_u32_u24 v3, 384, v3
    v_and_b32 v4, 1, v0
    v_lshl_add_u32 v3, v4, 3, v3
    v_add_u32 v3, 73728, v3
    buffer_load_dwordx4 v18, s[64:67], s60 offen offset:2048  lds
    v_and_or_b32 v2, v2, 2, v5
    v_bfe_u32 v4, v0, 1, 1
    v_xor_b32 v2, v2, v4
    s_mul_i32 s56, s3, 6
    buffer_load_dwordx4 v19, s[64:67], s60 offen offset:3072  lds
    s_add_u32 s57, s56, 0
    v_xor_b32 v4, s57, v2
    v_lshl_add_u32 v136, v4, 4, v3
    v_xor_b32 v137, 64, v136
    s_add_u32 m0, s60, 77824
    s_nop 0
    buffer_load_dwordx4 v20, s[64:67], s60 offen offset:0  lds
    s_add_u32 s57, s56, 2
    v_xor_b32 v4, s57, v2
    v_lshl_add_u32 v138, v4, 4, v3
    v_xor_b32 v139, 64, v138
    buffer_load_dwordx4 v21, s[64:67], s60 offen offset:1024  lds
    s_add_u32 s57, s56, 4
    v_xor_b32 v4, s57, v2
    v_lshl_add_u32 v140, v4, 4, v3
    v_xor_b32 v141, 64, v140
    s_lshl_b32 s61, s43, 2
    s_add_u32 s61, s61, s3
    s_mul_i32 s60, s61, 6144
    s_add_u32 m0, s41, 6144
    s_nop 0
    buffer_load_dwordx4 v16, s[68:71], s60 offen offset:0  lds
    v_bfe_u32 v1, v0, 2, 1
    v_and_b32 v2, 3, v0
    v_lshl_or_b32 v2, v1, 3, v2
    v_and_or_b32 v1, v0, 2, v1
    buffer_load_dwordx4 v17, s[68:71], s60 offen offset:1024  lds
    v_lshrrev_b32 v3, 4, v0
    v_xor_b32 v1, v1, v3
    v_mul_u32_u24 v2, 384, v2
    v_lshl_add_u32 v1, v1, 4, v2
    buffer_load_dwordx4 v18, s[68:71], s60 offen offset:2048  lds
    v_bfe_u32 v2, v0, 3, 1
    v_mul_u32_u24 v2, 12288, v2
    s_mov_b32 s56, 30720
    v_add3_u32 v142, s56, v1, v2
    buffer_load_dwordx4 v19, s[68:71], s60 offen offset:3072  lds
    v_xor_b32 v143, 64, v142
    s_add_u32 m0, s41, 10240
    s_nop 0
    buffer_load_dwordx4 v20, s[68:71], s60 offen offset:0  lds
    buffer_load_dwordx4 v21, s[68:71], s60 offen offset:1024  lds
    s_load_dword s38, s[22:23], 0
    s_barrier
    s_add_u32 m0, s40, 0
    s_add_u32 s57, s36, 0
    buffer_load_dwordx4 v16, s[28:31], s57 offen offset:0 nt lds
    buffer_load_dwordx4 v17, s[28:31], s57 offen offset:1024 nt lds
    buffer_load_dwordx4 v18, s[28:31], s57 offen offset:2048 nt lds
    buffer_load_dwordx4 v19, s[28:31], s57 offen offset:3072 nt lds
    s_add_u32 m0, s40, 4096
    s_nop 0
    buffer_load_dwordx4 v20, s[28:31], s57 offen offset:0 nt lds
    buffer_load_dwordx4 v21, s[28:31], s57 offen offset:1024 nt lds
    s_add_u32 m0, s41, 0
    s_add_u32 s58, s37, 0
    buffer_load_dwordx4 v22, s[24:27], s58 offen offset:0 nt lds
    buffer_load_dwordx4 v23, s[24:27], s58 offen offset:1024 nt lds
    buffer_load_dwordx4 v24, s[24:27], s58 offen offset:2048 nt lds
    s_waitcnt vmcnt(9)
    s_barrier
    ds_read_b128 a[96:99], v142 offset:0
    ds_read_b128 a[100:103], v143 offset:0
    ds_read_b128 a[104:107], v142 offset:128
    ds_read_b128 a[108:111], v143 offset:128
    ds_read_b128 a[112:115], v142 offset:256
    ds_read_b128 a[116:119], v143 offset:256
    ds_read_b128 a[120:123], v143 offset:1536
    ds_read_b128 a[124:127], v142 offset:1536
    ds_read_b128 a[128:131], v143 offset:1664
    ds_read_b128 a[132:135], v142 offset:1664
    ds_read_b128 a[136:139], v143 offset:1792
    ds_read_b128 a[140:143], v142 offset:1792
    ds_read_b128 a[144:147], v142 offset:24576
    ds_read_b128 a[148:151], v143 offset:24576
    ds_read_b128 a[152:155], v142 offset:24704
    ds_read_b128 a[156:159], v143 offset:24704
    ds_read_b128 a[160:163], v142 offset:24832
    ds_read_b128 a[164:167], v143 offset:24832
    ds_read_b128 a[168:171], v143 offset:26112
    ds_read_b128 a[172:175], v142 offset:26112
    ds_read_b128 a[176:179], v143 offset:26240
    ds_read_b128 a[180:183], v142 offset:26240
    ds_read_b128 a[184:187], v143 offset:26368
    ds_read_b128 a[188:191], v142 offset:26368
    ds_read_b64_tr_b16 v[160:161], v136 offset:0
    ds_read_b64_tr_b16 v[162:163], v137 offset:1536
    ds_read_b64_tr_b16 v[164:165], v136 offset:12288
    ds_read_b64_tr_b16 v[166:167], v137 offset:13824
    ds_read_b64_tr_b16 v[168:169], v136 offset:24576
    ds_read_b64_tr_b16 v[170:171], v137 offset:26112
    ds_read_b64_tr_b16 v[172:173], v136 offset:36864
    ds_read_b64_tr_b16 v[174:175], v137 offset:38400
    ds_read_b64_tr_b16 v[176:177], v136 offset:49152
    ds_read_b64_tr_b16 v[178:179], v137 offset:50688
    ds_read_b64_tr_b16 v[180:181], v136 offset:61440
    ds_read_b64_tr_b16 v[182:183], v137 offset:62976
    ds_read_b64_tr_b16 v[184:185], v138 offset:0
    ds_read_b64_tr_b16 v[186:187], v139 offset:1536
    ds_read_b64_tr_b16 v[188:189], v138 offset:12288
    ds_read_b64_tr_b16 v[190:191], v139 offset:13824
    ds_read_b64_tr_b16 v[192:193], v138 offset:24576
    ds_read_b64_tr_b16 v[194:195], v139 offset:26112
    ds_read_b64_tr_b16 v[196:197], v138 offset:36864
    ds_read_b64_tr_b16 v[198:199], v139 offset:38400
    ds_read_b64_tr_b16 v[200:201], v138 offset:49152
    ds_read_b64_tr_b16 v[202:203], v139 offset:50688
    ds_read_b64_tr_b16 v[204:205], v138 offset:61440
    ds_read_b64_tr_b16 v[206:207], v139 offset:62976
    ds_read_b64_tr_b16 v[208:209], v140 offset:0
    ds_read_b64_tr_b16 v[210:211], v141 offset:1536
    ds_read_b64_tr_b16 v[212:213], v140 offset:12288
    ds_read_b64_tr_b16 v[214:215], v141 offset:13824
    ds_read_b64_tr_b16 v[216:217], v140 offset:24576
    ds_read_b64_tr_b16 v[218:219], v141 offset:26112
    ds_read_b64_tr_b16 v[220:221], v140 offset:36864
    ds_read_b64_tr_b16 v[222:223], v141 offset:38400
    ds_read_b64_tr_b16 v[224:225], v140 offset:49152
    ds_read_b64_tr_b16 v[226:227], v141 offset:50688
    ds_read_b64_tr_b16 v[228:229], v140 offset:61440
    ds_read_b64_tr_b16 v[230:231], v141 offset:62976
    s_waitcnt lgkmcnt(0)
    s_barrier
    s_mul_i32 s60, s3, 18432
    s_lshl_b32 s61, s43, 11
    s_add_u32 s60, s60, s61
    s_add_u32 s60, s60, 2162688
    v_mfma_f32_16x16x32_bf16 v[88:91], a[96:99], v[160:163], 0
    v_mfma_f32_16x16x32_bf16 v[92:95], a[120:123], v[160:163], 0
    v_mfma_f32_16x16x32_bf16 v[96:99], a[144:147], v[160:163], 0
    v_mfma_f32_16x16x32_bf16 v[100:103], a[168:171], v[160:163], 0
    buffer_load_dwordx4 v25, s[24:27], s58 offen offset:3072 nt lds
    v_mfma_f32_16x16x32_bf16 v[88:91], a[100:103], v[164:167], v[88:91]
    v_mfma_f32_16x16x32_bf16 v[92:95], a[124:127], v[164:167], v[92:95]
    v_mfma_f32_16x16x32_bf16 v[96:99], a[148:151], v[164:167], v[96:99]
    v_mfma_f32_16x16x32_bf16 v[100:103], a[172:175], v[164:167], v[100:103]
    s_add_u32 m0, s41, 4096
    s_nop 0
    buffer_load_dwordx4 v26, s[24:27], s58 offen offset:0 nt lds
    v_mfma_f32_16x16x32_bf16 v[88:91], a[104:107], v[168:171], v[88:91]
    v_mfma_f32_16x16x32_bf16 v[92:95], a[128:131], v[168:171], v[92:95]
    v_mfma_f32_16x16x32_bf16 v[96:99], a[152:155], v[168:171], v[96:99]
    v_mfma_f32_16x16x32_bf16 v[100:103], a[176:179], v[168:171], v[100:103]
    buffer_load_dwordx4 v27, s[24:27], s58 offen offset:1024 nt lds
    v_mfma_f32_16x16x32_bf16 v[88:91], a[108:111], v[172:175], v[88:91]
    v_mfma_f32_16x16x32_bf16 v[92:95], a[132:135], v[172:175], v[92:95]
    v_mfma_f32_16x16x32_bf16 v[96:99], a[156:159], v[172:175], v[96:99]
    v_mfma_f32_16x16x32_bf16 v[100:103], a[180:183], v[172:175], v[100:103]
    buffer_load_dwordx4 v28, s[24:27], s58 offen offset:2048 nt lds
    v_mfma_f32_16x16x32_bf16 v[88:91], a[112:115], v[176:179], v[88:91]
    v_mfma_f32_16x16x32_bf16 v[92:95], a[136:139], v[176:179], v[92:95]
    v_mfma_f32_16x16x32_bf16 v[96:99], a[160:163], v[176:179], v[96:99]
    v_mfma_f32_16x16x32_bf16 v[100:103], a[184:187], v[176:179], v[100:103]
    buffer_load_dwordx4 v29, s[24:27], s58 offen offset:3072 nt lds
    v_mfma_f32_16x16x32_bf16 v[88:91], a[116:119], v[180:183], v[88:91]
    v_mfma_f32_16x16x32_bf16 v[92:95], a[140:143], v[180:183], v[92:95]
    v_mfma_f32_16x16x32_bf16 v[96:99], a[164:167], v[180:183], v[96:99]
    v_mfma_f32_16x16x32_bf16 v[100:103], a[188:191], v[180:183], v[100:103]
    v_mfma_f32_16x16x32_bf16 v[104:107], a[96:99], v[184:187], 0
    v_mfma_f32_16x16x32_bf16 v[108:111], a[120:123], v[184:187], 0
    v_mfma_f32_16x16x32_bf16 v[112:115], a[144:147], v[184:187], 0
    v_mfma_f32_16x16x32_bf16 v[116:119], a[168:171], v[184:187], 0
    s_add_u32 m0, s41, 8192
    s_nop 0
    buffer_load_dwordx4 v30, s[24:27], s58 offen offset:0 nt lds
    v_mfma_f32_16x16x32_bf16 v[104:107], a[100:103], v[188:191], v[104:107]
    v_mfma_f32_16x16x32_bf16 v[108:111], a[124:127], v[188:191], v[108:111]
    v_mfma_f32_16x16x32_bf16 v[112:115], a[148:151], v[188:191], v[112:115]
    v_mfma_f32_16x16x32_bf16 v[116:119], a[172:175], v[188:191], v[116:119]
    buffer_load_dwordx4 v31, s[24:27], s58 offen offset:1024 nt lds
    v_mfma_f32_16x16x32_bf16 v[104:107], a[104:107], v[192:195], v[104:107]
    v_mfma_f32_16x16x32_bf16 v[108:111], a[128:131], v[192:195], v[108:111]
    v_mfma_f32_16x16x32_bf16 v[112:115], a[152:155], v[192:195], v[112:115]
    v_mfma_f32_16x16x32_bf16 v[116:119], a[176:179], v[192:195], v[116:119]
    buffer_load_dwordx4 v32, s[24:27], s58 offen offset:2048 nt lds
    v_cvt_pk_bf16_f32 v144, v88, v89
    v_cvt_pk_bf16_f32 v145, v90, v91
    v_cvt_pk_bf16_f32 v146, v92, v93
    v_cvt_pk_bf16_f32 v147, v94, v95
    buffer_store_dwordx4 v[144:147], v65, s[32:35], s60 offen offset:0 sc1
    v_cvt_pk_bf16_f32 v148, v96, v97
    v_cvt_pk_bf16_f32 v149, v98, v99
    v_cvt_pk_bf16_f32 v150, v100, v101
    v_cvt_pk_bf16_f32 v151, v102, v103
    buffer_store_dwordx4 v[148:151], v65, s[32:35], s60 offen offset:1024 sc1
    s_add_u32 s60, s60, 6144
    v_mfma_f32_16x16x32_bf16 v[104:107], a[108:111], v[196:199], v[104:107]
    v_mfma_f32_16x16x32_bf16 v[108:111], a[132:135], v[196:199], v[108:111]
    v_mfma_f32_16x16x32_bf16 v[112:115], a[156:159], v[196:199], v[112:115]
    v_mfma_f32_16x16x32_bf16 v[116:119], a[180:183], v[196:199], v[116:119]
    buffer_load_dwordx4 v33, s[24:27], s58 offen offset:3072 nt lds
    v_mfma_f32_16x16x32_bf16 v[104:107], a[112:115], v[200:203], v[104:107]
    v_mfma_f32_16x16x32_bf16 v[108:111], a[136:139], v[200:203], v[108:111]
    v_mfma_f32_16x16x32_bf16 v[112:115], a[160:163], v[200:203], v[112:115]
    v_mfma_f32_16x16x32_bf16 v[116:119], a[184:187], v[200:203], v[116:119]
    s_add_u32 m0, s42, 0
    s_add_u32 s59, s37, 196608
    buffer_load_dwordx4 v22, s[24:27], s59 offen offset:0 nt lds
    v_mfma_f32_16x16x32_bf16 v[104:107], a[116:119], v[204:207], v[104:107]
    v_mfma_f32_16x16x32_bf16 v[108:111], a[140:143], v[204:207], v[108:111]
    v_mfma_f32_16x16x32_bf16 v[112:115], a[164:167], v[204:207], v[112:115]
    v_mfma_f32_16x16x32_bf16 v[116:119], a[188:191], v[204:207], v[116:119]
    v_mfma_f32_16x16x32_bf16 v[120:123], a[96:99], v[208:211], 0
    v_mfma_f32_16x16x32_bf16 v[124:127], a[120:123], v[208:211], 0
    v_mfma_f32_16x16x32_bf16 v[128:131], a[144:147], v[208:211], 0
    v_mfma_f32_16x16x32_bf16 v[132:135], a[168:171], v[208:211], 0
    buffer_load_dwordx4 v23, s[24:27], s59 offen offset:1024 nt lds
    v_mfma_f32_16x16x32_bf16 v[120:123], a[100:103], v[212:215], v[120:123]
    v_mfma_f32_16x16x32_bf16 v[124:127], a[124:127], v[212:215], v[124:127]
    v_mfma_f32_16x16x32_bf16 v[128:131], a[148:151], v[212:215], v[128:131]
    v_mfma_f32_16x16x32_bf16 v[132:135], a[172:175], v[212:215], v[132:135]
    buffer_load_dwordx4 v24, s[24:27], s59 offen offset:2048 nt lds
    v_mfma_f32_16x16x32_bf16 v[120:123], a[104:107], v[216:219], v[120:123]
    v_mfma_f32_16x16x32_bf16 v[124:127], a[128:131], v[216:219], v[124:127]
    v_mfma_f32_16x16x32_bf16 v[128:131], a[152:155], v[216:219], v[128:131]
    v_mfma_f32_16x16x32_bf16 v[132:135], a[176:179], v[216:219], v[132:135]
    buffer_load_dwordx4 v25, s[24:27], s59 offen offset:3072 nt lds
    v_cvt_pk_bf16_f32 v152, v104, v105
    v_cvt_pk_bf16_f32 v153, v106, v107
    v_cvt_pk_bf16_f32 v154, v108, v109
    v_cvt_pk_bf16_f32 v155, v110, v111
    buffer_store_dwordx4 v[152:155], v65, s[32:35], s60 offen offset:0 sc1
    v_cvt_pk_bf16_f32 v156, v112, v113
    v_cvt_pk_bf16_f32 v157, v114, v115
    v_cvt_pk_bf16_f32 v158, v116, v117
    v_cvt_pk_bf16_f32 v159, v118, v119
    buffer_store_dwordx4 v[156:159], v65, s[32:35], s60 offen offset:1024 sc1
    s_add_u32 s60, s60, 6144
    v_mfma_f32_16x16x32_bf16 v[120:123], a[108:111], v[220:223], v[120:123]
    v_mfma_f32_16x16x32_bf16 v[124:127], a[132:135], v[220:223], v[124:127]
    v_mfma_f32_16x16x32_bf16 v[128:131], a[156:159], v[220:223], v[128:131]
    v_mfma_f32_16x16x32_bf16 v[132:135], a[180:183], v[220:223], v[132:135]
    s_add_u32 m0, s42, 4096
    s_nop 0
    buffer_load_dwordx4 v26, s[24:27], s59 offen offset:0 nt lds
    v_mfma_f32_16x16x32_bf16 v[120:123], a[112:115], v[224:227], v[120:123]
    v_mfma_f32_16x16x32_bf16 v[124:127], a[136:139], v[224:227], v[124:127]
    v_mfma_f32_16x16x32_bf16 v[128:131], a[160:163], v[224:227], v[128:131]
    v_mfma_f32_16x16x32_bf16 v[132:135], a[184:187], v[224:227], v[132:135]
    buffer_load_dwordx4 v27, s[24:27], s59 offen offset:1024 nt lds
    v_mfma_f32_16x16x32_bf16 v[120:123], a[116:119], v[228:231], v[120:123]
    v_mfma_f32_16x16x32_bf16 v[124:127], a[140:143], v[228:231], v[124:127]
    v_mfma_f32_16x16x32_bf16 v[128:131], a[164:167], v[228:231], v[128:131]
    v_mfma_f32_16x16x32_bf16 v[132:135], a[188:191], v[228:231], v[132:135]
    s_nop 4
    v_cvt_pk_bf16_f32 v144, v120, v121
    v_cvt_pk_bf16_f32 v145, v122, v123
    v_cvt_pk_bf16_f32 v146, v124, v125
    v_cvt_pk_bf16_f32 v147, v126, v127
    buffer_store_dwordx4 v[144:147], v65, s[32:35], s60 offen offset:0 sc1
    v_cvt_pk_bf16_f32 v148, v128, v129
    v_cvt_pk_bf16_f32 v149, v130, v131
    v_cvt_pk_bf16_f32 v150, v132, v133
    v_cvt_pk_bf16_f32 v151, v134, v135
    buffer_store_dwordx4 v[148:151], v65, s[32:35], s60 offen offset:1024 sc1
    v_and_b32 v1, 15, v0
    v_lshrrev_b32 v2, 4, v0
    v_lshrrev_b32 v6, 1, v2
    v_and_b32 v3, 1, v2
    v_lshl_or_b32 v3, v3, 1, v6
    v_lshrrev_b32 v4, 2, v0
    v_bfe_u32 v5, v0, 1, 1
    v_lshrrev_b32 v6, 3, v1
    v_and_or_b32 v6, v1, 6, v6
    v_xor_b32 v6, v6, v3
    v_mul_u32_u24 v7, 384, v1
    v_lshl_add_u32 v6, v6, 4, v7
    v_add_u32 v34, s40, v6
    v_xor_b32 v35, 64, v34
    v_lshrrev_b32 v6, 3, v1
    v_and_b32 v7, 7, v1
    v_lshl_or_b32 v6, v7, 1, v6
    v_xor_b32 v6, v6, v3
    v_mul_u32_u24 v7, 768, v1
    v_lshl_add_u32 v6, v6, 4, v7
    v_add_u32 v40, s41, v6
    v_xor_b32 v41, 0x40, v40
    v_xor_b32 v42, 0x80, v40
    v_xor_b32 v43, 0xc0, v40
    v_and_b32 v2, 1, v0
    v_lshlrev_b32 v2, 3, v2
    v_lshrrev_b32 v6, 3, v4
    v_and_or_b32 v6, v4, 6, v6
    v_xor_b32 v6, v6, v5
    v_mul_u32_u24 v7, 384, v4
    v_lshl_add_u32 v6, v6, 4, v7
    v_add3_u32 v36, s40, v6, v2
    v_xor_b32 v37, 0x20, v36
    v_xor_b32 v38, 0x40, v36
    v_xor_b32 v39, 0x60, v36
    v_lshrrev_b32 v6, 3, v4
    v_and_b32 v7, 7, v4
    v_lshl_or_b32 v6, v7, 1, v6
    v_xor_b32 v6, v6, v5
    v_mul_u32_u24 v7, 768, v4
    v_lshl_add_u32 v6, v6, 4, v7
    v_add3_u32 v44, s41, v6, v2
    v_xor_b32 v45, 0x20, v44
    v_xor_b32 v46, 0x40, v44
    v_xor_b32 v47, 0x60, v44
    v_xor_b32 v48, 0x80, v44
    v_xor_b32 v49, 0xa0, v44
    v_xor_b32 v50, 0xc0, v44
    v_xor_b32 v51, 0xe0, v44
    v_mov_b32 v52, 0x3f803f80
    v_mov_b32 v56, 0x3ebcbe62
    s_mov_b32 s44, 0x100001
    s_mov_b32 s45, 0x10000100
    v_mov_b32 v53, 0x3f803f80
    v_mov_b32 v57, 0x3ebcbe62
    s_mov_b32 s46, 0x200002
    s_mov_b32 s47, 0x20000200
    v_mov_b32 v54, 0x3f803f80
    v_mov_b32 v58, 0x3ebcbe62
    s_mov_b32 s48, 0x400004
    s_mov_b32 s49, 0x40000400
    v_mov_b32 v55, 0x3f803f80
    v_mov_b32 v59, 0x3ebcbe62
    s_mov_b32 s50, 0x800008
    s_mov_b32 s51, 0x80000800
    v_mov_b32 v60, 0x43400000
    v_lshrrev_b32 v1, 5, v0
    v_lshlrev_b32 v1, 8, v1
    v_and_b32 v2, 15, v0
    v_lshl_add_u32 v1, v2, 4, v1
    v_bfe_u32 v2, v0, 4, 1
    v_lshl_add_u32 v1, v2, 3, v1
    s_mul_i32 s56, s3, 1536
    s_add_u32 s56, s56, 147456
    v_add_u32 v236, s56, v1
    s_mul_i32 s56, s3, 3072
    s_add_u32 s56, s56, 24576
    v_add_u32 v237, s56, v65
    v_add_u32 v238, s41, v65
    s_lshl_b32 s56, s3, 10
    v_add_u32 v240, 159744, v65
    v_add_u32 v239, s56, v240
    v_add_u32 v241, 147456, v65
    v_bfe_u32 v1, v0, 2, 2
    v_lshlrev_b32 v1, 19, v1
    v_lshrrev_b32 v2, 4, v0
    v_lshl_or_b32 v1, v2, 15, v1
    v_and_b32 v2, 3, v0
    v_lshl_or_b32 v242, v2, 4, v1
    v_xor_b32 v243, 0x70, v242
    s_mul_i32 s56, s3, 3
    v_min_u32 v1, 2, v0
    v_add_u32 v1, s56, v1
    v_lshlrev_b32 v245, 7, v1
    s_mov_b32 s52, 0x41c00000
    buffer_load_dwordx4 v28, s[24:27], s59 offen offset:2048 nt lds
    buffer_load_dwordx4 v29, s[24:27], s59 offen offset:3072 nt lds
    s_add_u32 m0, s42, 8192
    s_nop 0
    buffer_load_dwordx4 v30, s[24:27], s59 offen offset:0 nt lds
    buffer_load_dwordx4 v31, s[24:27], s59 offen offset:1024 nt lds
    buffer_load_dwordx4 v32, s[24:27], s59 offen offset:2048 nt lds
    buffer_load_dwordx4 v33, s[24:27], s59 offen offset:3072 nt lds
    s_branch L_join
L_c_slow:
    s_cmp_eq_u32 s43, 0
    s_cbranch_scc1 L_c_out
    s_mov_b32 s43, 0
    v_sub_u32 v49, v79, v247
    v_max_f32 v42, v42, v49
    v_sub_u32 v49, v83, v247
    v_max_f32 v42, v42, v49
    v_sub_u32 v49, v87, v247
    v_max_f32 v42, v42, v49
    v_sub_u32 v49, v91, v247
    v_max_f32 v42, v42, v49
    v_sub_u32 v49, v95, v247
    v_max_f32 v42, v42, v49
    v_sub_u32 v49, v99, v247
    v_max_f32 v42, v42, v49
    v_sub_u32 v49, v103, v247
    v_max_f32 v42, v42, v49
    v_sub_u32 v49, v107, v247
    v_max_f32 v42, v42, v49
    s_nop 1
    v_max_f32_dpp v42, v42, v42 row_ror:8 row_mask:0xf bank_mask:0xf
    v_mov_b32 v48, v42
    s_nop 1
    v_permlane32_swap_b32 v42, v48
    v_max_f32 v42, v42, v48
    v_mov_b32 v48, v42
    s_nop 1
    v_permlane16_swap_b32 v42, v48
    v_max_f32 v42, v42, v48
    s_lshl_b32 s56, s3, 2
    v_add_u32 v48, s56, v251
    ds_write_b32 v48, v42 offset:1024
    s_waitcnt lgkmcnt(0)
    s_barrier
    ds_read_b128 v[48:51], v251 offset:1024
    v_mov_b32 v16, 0
    v_mov_b32 v17, 0
    v_mov_b32 v18, 0
    v_mov_b32 v19, 0
    v_mov_b32 v20, 0
    v_mov_b32 v21, 0
    v_mov_b32 v22, 0
    s_mov_b64 s[6:7], -1
    s_mov_b64 s[24:25], 0
    s_mov_b64 s[8:9], -1
    s_mov_b64 s[26:27], 0
    s_mov_b64 s[10:11], -1
    s_mov_b64 s[28:29], 0
    s_mov_b64 s[12:13], -1
    s_mov_b64 s[30:31], 0
    s_mov_b64 s[14:15], -1
    s_mov_b64 s[44:45], 0
    s_mov_b64 s[16:17], -1
    s_mov_b64 s[46:47], 0
    s_mov_b64 s[36:37], -1
    s_mov_b64 s[48:49], 0
    s_mov_b64 s[40:41], -1
    s_mov_b64 s[50:51], 0
    s_waitcnt lgkmcnt(0)
    v_max3_f32 v42, v48, v49, v50
    v_max_f32 v42, v42, v51
    s_branch L_c_acc
L_qk_retry:
    s_mov_b32 s53, 0
L_qk_again:
    s_mul_i32 s56, s3, 3072
    s_add_u32 s56, s56, 16384
    buffer_load_dwordx4 v[120:123], v65, s[32:35], s56 offen offset:0 sc1
    buffer_load_dwordx4 v[124:127], v65, s[32:35], s56 offen offset:1024 sc1
    buffer_load_dwordx4 v[128:131], v65, s[32:35], s56 offen offset:2048 sc1
    s_add_u32 s53, s53, 1
    s_waitcnt vmcnt(0)
    v_xor_b32 v1, s39, v122
    v_xor_b32 v2, s39, v126
    v_xor_b32 v3, s39, v130
    v_or3_b32 v1, v1, v2, v3
    v_cmp_ne_u32 vcc, 0, v1
    s_cbranch_vccz L_qk_ok
    s_cmp_lt_u32 s53, 65536
    s_cbranch_scc1 L_qk_again
    s_branch L_qk_ok
L_fl_retry:
    s_mov_b32 s53, 0
L_fl_again:
    buffer_load_dword v244, v245, s[32:35], 0 offen offset:128 sc1
    s_add_u32 s53, s53, 1
    s_waitcnt vmcnt(0)
    v_cmp_ne_u32 vcc, s39, v244
    s_cbranch_vccz L_fl_ok
    s_cmp_lt_u32 s53, 65536
    s_cbranch_scc1 L_fl_again
    s_branch L_fl_ok
L_site0:
    s_call_b64 s[54:55], L_rare1
    s_branch L_back0
L_site1:
    s_call_b64 s[54:55], L_rare0
    s_branch L_back1
L_site2:
    s_call_b64 s[54:55], L_rare1
    s_branch L_back2
L_site3:
    s_call_b64 s[54:55], L_rare0
    s_branch L_back3
L_site4:
    s_call_b64 s[54:55], L_rare1
    s_branch L_back4
L_site5:
    s_call_b64 s[54:55], L_rare0
    s_branch L_back5
L_site6:
    s_call_b64 s[54:55], L_rare1
    s_branch L_back6
L_site7:
    s_call_b64 s[54:55], L_rare0
    s_branch L_back7
L_site8:
    s_call_b64 s[54:55], L_rare1
    s_branch L_back8
L_site9:
    s_call_b64 s[54:55], L_rare0
    s_branch L_back9
L_site10:
    s_call_b64 s[54:55], L_rare1
    s_branch L_back10
L_site11:
    s_call_b64 s[54:55], L_rare0
    s_branch L_back11
L_site12:
    s_call_b64 s[54:55], L_rare1
    s_branch L_back12
L_site13:
    s_call_b64 s[54:55], L_rare0
    s_branch L_back13
L_site14:
    s_call_b64 s[54:55], L_rare1
    s_branch L_back14
L_rare0:
    s_nop 7
    s_nop 7
    v_mov_b32 v2, v1
    s_nop 1
    v_permlane32_swap_b32 v1, v2
    v_max_f32 v1, v1, v2
    v_mov_b32 v2, v1
    s_nop 1
    v_permlane16_swap_b32 v1, v2
    v_max_f32 v1, v1, v2
    v_max_f32 v1, 0, v1
    v_sub_f32 v62, v62, v1
    v_sub_f32 v88, v88, v1
    v_sub_f32 v89, v89, v1
    v_sub_f32 v90, v90, v1
    v_sub_f32 v91, v91, v1
    v_sub_f32 v1, 0, v1
    v_exp_f32 v1, v1
    s_nop 0
    v_mul_f32 v63, v63, v1
    v_mul_f32 v64, v64, v1
    v_mul_f32 v68, v68, v1
    v_mul_f32 v69, v69, v1
    v_mul_f32 v70, v70, v1
    v_mul_f32 v71, v71, v1
    v_accvgpr_read_b32 v2, a0
    v_mul_f32 v2, v2, v1
    v_accvgpr_write_b32 a0, v2
    v_accvgpr_read_b32 v2, a1
    v_mul_f32 v2, v2, v1
    v_accvgpr_write_b32 a1, v2
    v_accvgpr_read_b32 v2, a2
    v_mul_f32 v2, v2, v1
    v_accvgpr_write_b32 a2, v2
    v_accvgpr_read_b32 v2, a3
    v_mul_f32 v2, v2, v1
    v_accvgpr_write_b32 a3, v2
    v_accvgpr_read_b32 v2, a4
    v_mul_f32 v2, v2, v1
    v_accvgpr_write_b32 a4, v2
    v_accvgpr_read_b32 v2, a5
    v_mul_f32 v2, v2, v1
    v_accvgpr_write_b32 a5, v2
    v_accvgpr_read_b32 v2, a6
    v_mul_f32 v2, v2, v1
    v_accvgpr_write_b32 a6, v2
    v_accvgpr_read_b32 v2, a7
    v_mul_f32 v2, v2, v1
    v_accvgpr_write_b32 a7, v2
    v_accvgpr_read_b32 v2, a8
    v_mul_f32 v2, v2, v1
    v_accvgpr_write_b32 a8, v2
    v_accvgpr_read_b32 v2, a9
    v_mul_f32 v2, v2, v1
    v_accvgpr_write_b32 a9, v2
    v_accvgpr_read_b32 v2, a10
    v_mul_f32 v2, v2, v1
    v_accvgpr_write_b32 a10, v2
    v_accvgpr_read_b32 v2, a11
    v_mul_f32 v2, v2, v1
    v_accvgpr_write_b32 a11, v2
    v_accvgpr_read_b32 v2, a12
    v_mul_f32 v2, v2, v1
    v_accvgpr_write_b32 a12, v2
    v_accvgpr_read_b32 v2, a13
    v_mul_f32 v2, v2, v1
    v_accvgpr_write_b32 a13, v2
    v_accvgpr_read_b32 v2, a14
    v_mul_f32 v2, v2, v1
    v_accvgpr_write_b32 a14, v2
    v_accvgpr_read_b32 v2, a15
    v_mul_f32 v2, v2, v1
    v_accvgpr_write_b32 a15, v2
    v_accvgpr_read_b32 v2, a16
    v_mul_f32 v2, v2, v1
    v_accvgpr_write_b32 a16, v2
    v_accvgpr_read_b32 v2, a17
    v_mul_f32 v2, v2, v1
    v_accvgpr_write_b32 a17, v2
    v_accvgpr_read_b32 v2, a18
    v_mul_f32 v2, v2, v1
    v_accvgpr_write_b32 a18, v2
    v_accvgpr_read_b32 v2, a19
    v_mul_f32 v2, v2, v1
    v_accvgpr_write_b32 a19, v2
    v_accvgpr_read_b32 v2, a20
    v_mul_f32 v2, v2, v1
    v_accvgpr_write_b32 a20, v2
    v_accvgpr_read_b32 v2, a21
    v_mul_f32 v2, v2, v1
    v_accvgpr_write_b32 a21, v2
    v_accvgpr_read_b32 v2, a22
    v_mul_f32 v2, v2, v1
    v_accvgpr_write_b32 a22, v2
    v_accvgpr_read_b32 v2, a23
    v_mul_f32 v2, v2, v1
    v_accvgpr_write_b32 a23, v2
    v_accvgpr_read_b32 v2, a24
    v_mul_f32 v2, v2, v1
    v_accvgpr_write_b32 a24, v2
    v_accvgpr_read_b32 v2, a25
    v_mul_f32 v2, v2, v1
    v_accvgpr_write_b32 a25, v2
    v_accvgpr_read_b32 v2, a26
    v_mul_f32 v2, v2, v1
    v_accvgpr_write_b32 a26, v2
    v_accvgpr_read_b32 v2, a27
    v_mul_f32 v2, v2, v1
    v_accvgpr_write_b32 a27, v2
    v_accvgpr_read_b32 v2, a28
    v_mul_f32 v2, v2, v1
    v_accvgpr_write_b32 a28, v2
    v_accvgpr_read_b32 v2, a29
    v_mul_f32 v2, v2, v1
    v_accvgpr_write_b32 a29, v2
    v_accvgpr_read_b32 v2, a30
    v_mul_f32 v2, v2, v1
    v_accvgpr_write_b32 a30, v2
    v_accvgpr_read_b32 v2, a31
    v_mul_f32 v2, v2, v1
    v_accvgpr_write_b32 a31, v2
    v_accvgpr_read_b32 v2, a32
    v_mul_f32 v2, v2, v1
    v_accvgpr_write_b32 a32, v2
    v_accvgpr_read_b32 v2, a33
    v_mul_f32 v2, v2, v1
    v_accvgpr_write_b32 a33, v2
    v_accvgpr_read_b32 v2, a34
    v_mul_f32 v2, v2, v1
    v_accvgpr_write_b32 a34, v2
    v_accvgpr_read_b32 v2, a35
    v_mul_f32 v2, v2, v1
    v_accvgpr_write_b32 a35, v2
    v_accvgpr_read_b32 v2, a36
    v_mul_f32 v2, v2, v1
    v_accvgpr_write_b32 a36, v2
    v_accvgpr_read_b32 v2, a37
    v_mul_f32 v2, v2, v1
    v_accvgpr_write_b32 a37, v2
    v_accvgpr_read_b32 v2, a38
    v_mul_f32 v2, v2, v1
    v_accvgpr_write_b32 a38, v2
    v_accvgpr_read_b32 v2, a39
    v_mul_f32 v2, v2, v1
    v_accvgpr_write_b32 a39, v2
    v_accvgpr_read_b32 v2, a40
    v_mul_f32 v2, v2, v1
    v_accvgpr_write_b32 a40, v2
    v_accvgpr_read_b32 v2, a41
    v_mul_f32 v2, v2, v1
    v_accvgpr_write_b32 a41, v2
    v_accvgpr_read_b32 v2, a42
    v_mul_f32 v2, v2, v1
    v_accvgpr_write_b32 a42, v2
    v_accvgpr_read_b32 v2, a43
    v_mul_f32 v2, v2, v1
    v_accvgpr_write_b32 a43, v2
    v_accvgpr_read_b32 v2, a44
    v_mul_f32 v2, v2, v1
    v_accvgpr_write_b32 a44, v2
    v_accvgpr_read_b32 v2, a45
    v_mul_f32 v2, v2, v1
    v_accvgpr_write_b32 a45, v2
    v_accvgpr_read_b32 v2, a46
    v_mul_f32 v2, v2, v1
    v_accvgpr_write_b32 a46, v2
    v_accvgpr_read_b32 v2, a47
    v_mul_f32 v2, v2, v1
    v_accvgpr_write_b32 a47, v2
    s_nop 3
    s_setpc_b64 s[54:55]
L_rare1:
    s_nop 7
    s_nop 7
    v_mov_b32 v2, v1
    s_nop 1
    v_permlane32_swap_b32 v1, v2
    v_max_f32 v1, v1, v2
    v_mov_b32 v2, v1
    s_nop 1
    v_permlane16_swap_b32 v1, v2
    v_max_f32 v1, v1, v2
    v_max_f32 v1, 0, v1
    v_sub_f32 v62, v62, v1
    v_sub_f32 v104, v104, v1
    v_sub_f32 v105, v105, v1
    v_sub_f32 v106, v106, v1
    v_sub_f32 v107, v107, v1
    v_sub_f32 v1, 0, v1
    v_exp_f32 v1, v1
    s_nop 0
    v_mul_f32 v63, v63, v1
    v_mul_f32 v64, v64, v1
    v_mul_f32 v68, v68, v1
    v_mul_f32 v69, v69, v1
    v_mul_f32 v70, v70, v1
    v_mul_f32 v71, v71, v1
    v_mul_f32 v88, v88, v1
    v_mul_f32 v89, v89, v1
    v_mul_f32 v90, v90, v1
    v_mul_f32 v91, v91, v1
    v_accvgpr_read_b32 v2, a0
    v_mul_f32 v2, v2, v1
    v_accvgpr_write_b32 a0, v2
    v_accvgpr_read_b32 v2, a1
    v_mul_f32 v2, v2, v1
    v_accvgpr_write_b32 a1, v2
    v_accvgpr_read_b32 v2, a2
    v_mul_f32 v2, v2, v1
    v_accvgpr_write_b32 a2, v2
    v_accvgpr_read_b32 v2, a3
    v_mul_f32 v2, v2, v1
    v_accvgpr_write_b32 a3, v2
    v_accvgpr_read_b32 v2, a4
    v_mul_f32 v2, v2, v1
    v_accvgpr_write_b32 a4, v2
    v_accvgpr_read_b32 v2, a5
    v_mul_f32 v2, v2, v1
    v_accvgpr_write_b32 a5, v2
    v_accvgpr_read_b32 v2, a6
    v_mul_f32 v2, v2, v1
    v_accvgpr_write_b32 a6, v2
    v_accvgpr_read_b32 v2, a7
    v_mul_f32 v2, v2, v1
    v_accvgpr_write_b32 a7, v2
    v_accvgpr_read_b32 v2, a8
    v_mul_f32 v2, v2, v1
    v_accvgpr_write_b32 a8, v2
    v_accvgpr_read_b32 v2, a9
    v_mul_f32 v2, v2, v1
    v_accvgpr_write_b32 a9, v2
    v_accvgpr_read_b32 v2, a10
    v_mul_f32 v2, v2, v1
    v_accvgpr_write_b32 a10, v2
    v_accvgpr_read_b32 v2, a11
    v_mul_f32 v2, v2, v1
    v_accvgpr_write_b32 a11, v2
    v_accvgpr_read_b32 v2, a12
    v_mul_f32 v2, v2, v1
    v_accvgpr_write_b32 a12, v2
    v_accvgpr_read_b32 v2, a13
    v_mul_f32 v2, v2, v1
    v_accvgpr_write_b32 a13, v2
    v_accvgpr_read_b32 v2, a14
    v_mul_f32 v2, v2, v1
    v_accvgpr_write_b32 a14, v2
    v_accvgpr_read_b32 v2, a15
    v_mul_f32 v2, v2, v1
    v_accvgpr_write_b32 a15, v2
    v_accvgpr_read_b32 v2, a16
    v_mul_f32 v2, v2, v1
    v_accvgpr_write_b32 a16, v2
    v_accvgpr_read_b32 v2, a17
    v_mul_f32 v2, v2, v1
    v_accvgpr_write_b32 a17, v2
    v_accvgpr_read_b32 v2, a18
    v_mul_f32 v2, v2, v1
    v_accvgpr_write_b32 a18, v2
    v_accvgpr_read_b32 v2, a19
    v_mul_f32 v2, v2, v1
    v_accvgpr_write_b32 a19, v2
    v_accvgpr_read_b32 v2, a20
    v_mul_f32 v2, v2, v1
    v_accvgpr_write_b32 a20, v2
    v_accvgpr_read_b32 v2, a21
    v_mul_f32 v2, v2, v1
    v_accvgpr_write_b32 a21, v2
    v_accvgpr_read_b32 v2, a22
    v_mul_f32 v2, v2, v1
    v_accvgpr_write_b32 a22, v2
    v_accvgpr_read_b32 v2, a23
    v_mul_f32 v2, v2, v1
    v_accvgpr_write_b32 a23, v2
    v_accvgpr_read_b32 v2, a24
    v_mul_f32 v2, v2, v1
    v_accvgpr_write_b32 a24, v2
    v_accvgpr_read_b32 v2, a25
    v_mul_f32 v2, v2, v1
    v_accvgpr_write_b32 a25, v2
    v_accvgpr_read_b32 v2, a26
    v_mul_f32 v2, v2, v1
    v_accvgpr_write_b32 a26, v2
    v_accvgpr_read_b32 v2, a27
    v_mul_f32 v2, v2, v1
    v_accvgpr_write_b32 a27, v2
    v_accvgpr_read_b32 v2, a28
    v_mul_f32 v2, v2, v1
    v_accvgpr_write_b32 a28, v2
    v_accvgpr_read_b32 v2, a29
    v_mul_f32 v2, v2, v1
    v_accvgpr_write_b32 a29, v2
    v_accvgpr_read_b32 v2, a30
    v_mul_f32 v2, v2, v1
    v_accvgpr_write_b32 a30, v2
    v_accvgpr_read_b32 v2, a31
    v_mul_f32 v2, v2, v1
    v_accvgpr_write_b32 a31, v2
    v_accvgpr_read_b32 v2, a32
    v_mul_f32 v2, v2, v1
    v_accvgpr_write_b32 a32, v2
    v_accvgpr_read_b32 v2, a33
    v_mul_f32 v2, v2, v1
    v_accvgpr_write_b32 a33, v2
    v_accvgpr_read_b32 v2, a34
    v_mul_f32 v2, v2, v1
    v_accvgpr_write_b32 a34, v2
    v_accvgpr_read_b32 v2, a35
    v_mul_f32 v2, v2, v1
    v_accvgpr_write_b32 a35, v2
    v_accvgpr_read_b32 v2, a36
    v_mul_f32 v2, v2, v1
    v_accvgpr_write_b32 a36, v2
    v_accvgpr_read_b32 v2, a37
    v_mul_f32 v2, v2, v1
    v_accvgpr_write_b32 a37, v2
    v_accvgpr_read_b32 v2, a38
    v_mul_f32 v2, v2, v1
    v_accvgpr_write_b32 a38, v2
    v_accvgpr_read_b32 v2, a39
    v_mul_f32 v2, v2, v1
    v_accvgpr_write_b32 a39, v2
    v_accvgpr_read_b32 v2, a40
    v_mul_f32 v2, v2, v1
    v_accvgpr_write_b32 a40, v2
    v_accvgpr_read_b32 v2, a41
    v_mul_f32 v2, v2, v1
    v_accvgpr_write_b32 a41, v2
    v_accvgpr_read_b32 v2, a42
    v_mul_f32 v2, v2, v1
    v_accvgpr_write_b32 a42, v2
    v_accvgpr_read_b32 v2, a43
    v_mul_f32 v2, v2, v1
    v_accvgpr_write_b32 a43, v2
    v_accvgpr_read_b32 v2, a44
    v_mul_f32 v2, v2, v1
    v_accvgpr_write_b32 a44, v2
    v_accvgpr_read_b32 v2, a45
    v_mul_f32 v2, v2, v1
    v_accvgpr_write_b32 a45, v2
    v_accvgpr_read_b32 v2, a46
    v_mul_f32 v2, v2, v1
    v_accvgpr_write_b32 a46, v2
    v_accvgpr_read_b32 v2, a47
    v_mul_f32 v2, v2, v1
    v_accvgpr_write_b32 a47, v2
    s_nop 3
    s_setpc_b64 s[54:55]
L_codeend:
.section .rodata,"a"
.p2align 6
.amdhsa_kernel standalone__detection_seg_dino__vision_kernel
  .amdhsa_next_free_vgpr 448
  .amdhsa_next_free_sgpr 102
  .amdhsa_accum_offset 256
  .amdhsa_group_segment_fixed_size 0
  .amdhsa_kernarg_size 80
  .amdhsa_user_sgpr_count 2
  .amdhsa_user_sgpr_kernarg_segment_ptr 1
  .amdhsa_system_sgpr_workgroup_id_x 1
  .amdhsa_float_denorm_mode_32 3
.end_amdhsa_kernel
```

```asm
; @launch grid=(256,1,1) block=(256,1,1) lds=163840
.amdgcn_target "amdgcn-amd-amdhsa--gfx950"
.text
.globl standalone__detection_seg_dino__vision_kernel
.p2align 8
.type standalone__detection_seg_dino__vision_kernel,@function
standalone__detection_seg_dino__vision_kernel:
    s_cmp_ge_u32 s2, 256
    s_cbranch_scc1 L_end
    s_load_dwordx16 s[4:19], s[0:1], 0
    s_load_dwordx4 s[20:23], s[0:1], 64
    s_getpc_b64 s[54:55]
L_pc_main:
    v_lshlrev_b32 v233, 7, v0
    v_min_u32 v233, L_codeend - L_pc_main - 4, v233
    global_load_dword v232, v233, s[54:55]
    s_mov_b64 s[100:101], s[54:55]
    v_lshrrev_b32 v1, 6, v0
    v_and_b32 v0, 63, v0
    v_readfirstlane_b32 s3, v1
    v_lshlrev_b32 v65, 4, v0
    v_lshrrev_b32 v1, 2, v0
    v_and_b32 v1, 14, v1
    s_mov_b32 s56, 0x5000
    v_bfe_u32 v2, s56, v1, 2
    v_lshlrev_b32 v2, 5, v2
    v_xor_b32 v16, v65, v2
    s_mov_b32 s56, 0xaa55
    v_bfe_u32 v2, s56, v1, 2
    v_lshlrev_b32 v2, 5, v2
    v_xor_b32 v17, v65, v2
    s_mov_b32 s56, 0xfffa
    v_bfe_u32 v2, s56, v1, 2
    v_lshlrev_b32 v2, 5, v2
    v_xor_b32 v18, v65, v2
    v_xor_b32 v19, 16, v16
    v_xor_b32 v20, 0x1010, v17
    v_xor_b32 v21, 0x1010, v18
    v_lshrrev_b32 v1, 3, v0
    v_and_b32 v1, 6, v1
    s_mov_b32 s56, 0x40
    v_bfe_u32 v2, s56, v1, 2
    v_lshlrev_b32 v2, 5, v2
    v_xor_b32 v22, v65, v2
    s_mov_b32 s56, 0xa5
    v_bfe_u32 v2, s56, v1, 2
    v_lshlrev_b32 v2, 5, v2
    v_xor_b32 v23, v65, v2
    s_mov_b32 s56, 0xfe
    v_bfe_u32 v2, s56, v1, 2
    v_lshlrev_b32 v2, 5, v2
    v_xor_b32 v24, v65, v2
    v_xor_b32 v25, 0x80, v22
    v_xor_b32 v26, 0x1080, v23
    v_xor_b32 v27, 0x1080, v24
    v_xor_b32 v28, 0x1010, v22
    v_xor_b32 v29, 0x1010, v23
    v_xor_b32 v30, 0x2010, v24
    v_xor_b32 v31, 0x2090, v22
    v_xor_b32 v32, 0x2090, v23
    v_xor_b32 v33, 0x2090, v24
    v_mov_b32 v248, 0x10000
    s_mul_i32 s36, s3, 6144
    s_mul_i32 s37, s3, 12288
    s_add_u32 s40, s36, 0
    s_add_u32 s41, s37, 24576
    s_add_u32 s42, s37, 73728
    s_mul_i32 s56, s2, 393216
    s_mul_i32 s57, s2, 98304
    s_waitcnt lgkmcnt(0)
    s_add_u32 s28, s8, s57
    s_addc_u32 s29, s9, 0
    s_mov_b32 s30, 98304
    s_mov_b32 s31, 0x20000
    s_add_u32 s24, s6, s56
    s_addc_u32 s25, s7, 0
    s_mov_b32 s26, 393216
    s_mov_b32 s27, 0x20000
    s_mov_b32 s32, s22
    s_mov_b32 s33, s23
    s_mov_b32 s34, 8388608
    s_mov_b32 s35, 0x20000
    s_mov_b32 s0, 0
    s_and_b32 s56, s2, 7
    s_cmp_eq_u32 s56, 6
    s_cselect_b32 s57, 0, s56
    s_cmp_lg_u32 s57, 0
    s_cbranch_scc1 L_nopf
    s_cmp_lg_u32 s56, 0
    s_cselect_b32 s64, s16, s10
    s_cselect_b32 s65, s17, s11
    s_cselect_b32 s68, s14, s12
    s_cselect_b32 s69, s15, s13
    s_lshr_b32 s43, s2, 3
    s_mov_b32 s66, 73728
    s_mov_b32 s67, 0x20000
    s_mov_b32 s70, 73728
    s_mov_b32 s71, 0x20000
    s_mov_b32 s72, s4
    s_mov_b32 s73, s5
    s_mov_b32 s74, 6144
    s_mov_b32 s75, 0x20000
    s_mul_i32 s57, s43, 2304
    v_min_u32 v1, 17, v0
    v_lshlrev_b32 v1, 7, v1
    s_cmp_eq_u32 s3, 0
    s_cbranch_scc1 L_pf0
    s_cmp_eq_u32 s3, 1
    s_cbranch_scc0 L_pfdone
    s_lshl_b32 s58, s43, 8
    buffer_load_dword v234, v1, s[68:71], s57 offen
    v_min_u32 v2, 128, v1
    buffer_load_dword v235, v2, s[72:75], s58 offen
    s_branch L_pfdone
L_pf0:
    buffer_load_dword v234, v1, s[64:67], s57 offen
L_pfdone:
    s_cmp_ge_u32 s43, 3
    s_cbranch_scc1 L_nopf
    s_mov_b32 s0, 1
    s_cmp_eq_u32 s56, 0
    s_cbranch_scc1 L_prod
    s_branch L_vprod
L_nopf:
    s_load_dword s38, s[22:23], 0
    s_add_u32 m0, s40, 0
    s_add_u32 s57, s36, 0
    buffer_load_dwordx4 v16, s[28:31], s57 offen offset:0 nt lds
    buffer_load_dwordx4 v17, s[28:31], s57 offen offset:1024 nt lds
    buffer_load_dwordx4 v18, s[28:31], s57 offen offset:2048 nt lds
    buffer_load_dwordx4 v19, s[28:31], s57 offen offset:3072 nt lds
    s_add_u32 m0, s40, 4096
    s_nop 0
    buffer_load_dwordx4 v20, s[28:31], s57 offen offset:0 nt lds
    buffer_load_dwordx4 v21, s[28:31], s57 offen offset:1024 nt lds
    s_mov_b32 s43, -1
    s_sub_u32 s59, s2, 64
    s_cmp_ge_u32 s59, 64
    s_cbranch_scc1 L_nocs
    s_mov_b32 s64, s4
    s_mov_b32 s65, s5
    s_mov_b32 s66, 6144
    s_mov_b32 s67, 0x20000
    s_mov_b32 s68, s18
    s_mov_b32 s69, s19
    s_mov_b32 s70, 6144
    s_mov_b32 s71, 0x20000
    v_bfe_u32 v1, v0, 2, 1
    v_mul_u32_u24 v2, 7, v1
    v_xor_b32 v2, v0, v2
    v_and_b32 v2, 3, v2
    s_lshr_b32 s56, s59, 4
    s_lshl_b32 s56, s56, 2
    v_add_u32 v2, s56, v2
    v_lshlrev_b32 v252, 2, v2
    v_lshrrev_b32 v3, 4, v0
    v_mad_u32_u24 v3, v1, 3, v3
    v_lshrrev_b32 v4, 1, v3
    v_and_b32 v3, 1, v3
    v_lshlrev_b32 v3, 2, v3
    v_lshl_add_u32 v3, v4, 5, v3
    v_bfe_u32 v4, v0, 3, 1
    v_lshl_add_u32 v3, v4, 1, v3
    v_mul_u32_u24 v2, 384, v2
    s_bfe_u32 s56, s59, 0x20002
    s_mul_i32 s56, s56, 96
    s_and_b32 s57, s59, 3
    s_lshl_b32 s57, s57, 3
    s_add_u32 s56, s56, s57
    v_add3_u32 v248, s56, v2, v3
    v_cmp_gt_u32 vcc, 48, v0
    v_mov_b32 v4, 0x10000
    s_lshl_b32 s56, s3, 2
    v_cndmask_b32 v248, v4, v248, vcc
    buffer_load_ushort v249, v248, s[64:67], 0 offen
    buffer_load_ushort v246, v248, s[68:71], 0 offen
    v_add_u32 v250, s56, v65
    v_and_b32 v251, 0x70, v65
L_nocs:
    s_add_u32 m0, s41, 0
    s_add_u32 s58, s37, 0
    buffer_load_dwordx4 v22, s[24:27], s58 offen offset:0 nt lds
    buffer_load_dwordx4 v23, s[24:27], s58 offen offset:1024 nt lds
    buffer_load_dwordx4 v24, s[24:27], s58 offen offset:2048 nt lds
    buffer_load_dwordx4 v25, s[24:27], s58 offen offset:3072 nt lds
    s_add_u32 m0, s41, 4096
    s_nop 0
    buffer_load_dwordx4 v26, s[24:27], s58 offen offset:0 nt lds
    buffer_load_dwordx4 v27, s[24:27], s58 offen offset:1024 nt lds
    buffer_load_dwordx4 v28, s[24:27], s58 offen offset:2048 nt lds
    buffer_load_dwordx4 v29, s[24:27], s58 offen offset:3072 nt lds
    s_add_u32 m0, s41, 8192
    s_nop 0
    buffer_load_dwordx4 v30, s[24:27], s58 offen offset:0 nt lds
    buffer_load_dwordx4 v31, s[24:27], s58 offen offset:1024 nt lds
    buffer_load_dwordx4 v32, s[24:27], s58 offen offset:2048 nt lds
    buffer_load_dwordx4 v33, s[24:27], s58 offen offset:3072 nt lds
    s_add_u32 m0, s42, 0
    s_add_u32 s59, s37, 196608
    buffer_load_dwordx4 v22, s[24:27], s59 offen offset:0 nt lds
    buffer_load_dwordx4 v23, s[24:27], s59 offen offset:1024 nt lds
    buffer_load_dwordx4 v24, s[24:27], s59 offen offset:2048 nt lds
    buffer_load_dwordx4 v25, s[24:27], s59 offen offset:3072 nt lds
    s_add_u32 m0, s42, 4096
    s_nop 0
    buffer_load_dwordx4 v26, s[24:27], s59 offen offset:0 nt lds
    buffer_load_dwordx4 v27, s[24:27], s59 offen offset:1024 nt lds
    buffer_load_dwordx4 v28, s[24:27], s59 offen offset:2048 nt lds
    buffer_load_dwordx4 v29, s[24:27], s59 offen offset:3072 nt lds
    s_add_u32 m0, s42, 8192
    s_nop 0
    buffer_load_dwordx4 v30, s[24:27], s59 offen offset:0 nt lds
    buffer_load_dwordx4 v31, s[24:27], s59 offen offset:1024 nt lds
    buffer_load_dwordx4 v32, s[24:27], s59 offen offset:2048 nt lds
    buffer_load_dwordx4 v33, s[24:27], s59 offen offset:3072 nt lds
    v_and_b32 v1, 15, v0
    v_lshrrev_b32 v6, 5, v0
    v_bfe_u32 v3, v0, 4, 1
    v_lshl_or_b32 v3, v3, 1, v6
    v_lshrrev_b32 v4, 2, v0
    v_bfe_u32 v5, v0, 1, 1
    v_lshrrev_b32 v6, 3, v1
    v_and_or_b32 v6, v1, 6, v6
    v_xor_b32 v6, v6, v3
    v_mul_u32_u24 v7, 384, v1
    v_lshl_add_u32 v6, v6, 4, v7
    v_add_u32 v34, s40, v6
    v_xor_b32 v35, 64, v34
    v_lshrrev_b32 v6, 3, v1
    v_and_b32 v7, 7, v1
    v_lshl_or_b32 v6, v7, 1, v6
    v_xor_b32 v6, v6, v3
    v_mul_u32_u24 v7, 768, v1
    v_lshl_add_u32 v6, v6, 4, v7
    v_add_u32 v40, s41, v6
    v_xor_b32 v41, 0x40, v40
    v_xor_b32 v42, 0x80, v40
    v_xor_b32 v43, 0xc0, v40
    v_and_b32 v2, 1, v0
    v_lshlrev_b32 v2, 3, v2
    s_mul_i32 s56, s3, 96
    v_lshrrev_b32 v6, 3, v4
    v_and_or_b32 v6, v4, 6, v6
    v_xor_b32 v6, v6, v5
    v_lshl_add_u32 v6, v6, 4, v2
    v_mul_u32_u24 v7, 384, v4
    s_add_u32 s57, s56, 0
    v_xad_u32 v36, v6, s57, v7
    s_add_u32 s57, s56, 32
    v_xad_u32 v37, v6, s57, v7
    s_add_u32 s57, s56, 64
    v_xad_u32 v38, v6, s57, v7
    v_lshrrev_b32 v6, 3, v4
    v_and_b32 v3, 7, v4
    v_lshl_or_b32 v6, v3, 1, v6
    v_xor_b32 v6, v6, v5
    v_lshl_add_u32 v6, v6, 4, v2
    v_lshlrev_b32 v7, 1, v7
    v_add_u32 v7, 24576, v7
    s_add_u32 s57, s56, 0
    v_xad_u32 v44, v6, s57, v7
    s_add_u32 s57, s56, 384
    v_xad_u32 v45, v6, s57, v7
    s_add_u32 s57, s56, 32
    v_xad_u32 v46, v6, s57, v7
    s_add_u32 s57, s56, 416
    v_xad_u32 v47, v6, s57, v7
    s_add_u32 s57, s56, 64
    v_xad_u32 v48, v6, s57, v7
    s_add_u32 s57, s56, 448
    v_xad_u32 v49, v6, s57, v7
    v_mov_b32 v52, 0x3f803f80
    v_mov_b32 v56, 0x3ebcbe62
    s_mov_b32 s44, 0x100001
    s_mov_b32 s45, 0x10000100
    v_mov_b32 v53, 0x3f803f80
    v_mov_b32 v57, 0x3ebcbe62
    s_mov_b32 s46, 0x200002
    s_mov_b32 s47, 0x20000200
    v_mov_b32 v54, 0x3f803f80
    v_mov_b32 v58, 0x3ebcbe62
    s_mov_b32 s48, 0x400004
    s_mov_b32 s49, 0x40000400
    v_mov_b32 v55, 0x3f803f80
    v_mov_b32 v59, 0x3ebcbe62
    s_mov_b32 s50, 0x800008
    s_mov_b32 s51, 0x80000800
    v_mov_b32 v60, 0x43400000
    v_lshrrev_b32 v1, 5, v0
    v_lshlrev_b32 v1, 8, v1
    v_and_b32 v2, 15, v0
    v_lshl_add_u32 v1, v2, 4, v1
    v_bfe_u32 v2, v0, 4, 1
    v_lshl_add_u32 v1, v2, 3, v1
    s_mul_i32 s56, s3, 1536
    s_add_u32 s56, s56, 147456
    v_add_u32 v236, s56, v1
    s_mul_i32 s56, s3, 3072
    s_add_u32 s56, s56, 24576
    v_add_u32 v237, s56, v65
    v_add_u32 v238, s41, v65
    s_lshl_b32 s56, s3, 10
    v_add_u32 v240, 159744, v65
    v_add_u32 v239, s56, v240
    v_add_u32 v241, 147456, v65
    v_bfe_u32 v1, v0, 2, 2
    v_lshrrev_b32 v2, 4, v0
    v_lshl_or_b32 v1, v1, 4, v2
    v_mul_u32_u24 v1, 37120, v1
    v_and_b32 v2, 3, v0
    v_lshl_or_b32 v242, v2, 4, v1
    v_xor_b32 v243, 0x70, v242
    s_mul_i32 s56, s3, 3
    v_min_u32 v1, 2, v0
    v_add_u32 v1, s56, v1
    v_lshlrev_b32 v245, 7, v1
    v_lshlrev_b32 v1, 3, v0
    v_add_u32 v254, 126976, v1
    s_lshl_b32 s56, s3, 9
    v_add_u32 v238, s56, v254
    v_add_u32 v253, 122880, v65
    s_lshl_b32 s56, s3, 10
    v_add_u32 v237, s56, v253
    s_mov_b32 s52, 0x41c00000
L_join:
    s_mul_i32 s60, s3, 18432
    s_mov_b32 s72, s22
    s_mov_b32 s73, s23
    s_mov_b32 s74, 8388608
    s_mov_b32 s75, 0x20000
    s_cmp_eq_u32 s0, 1
    s_cselect_b32 s74, 0, s74
    s_waitcnt vmcnt(24)
    s_waitcnt lgkmcnt(0)
    s_barrier
    ds_read_b128 a[48:51], v34 offset:0
    ds_read_b128 a[52:55], v35 offset:0
    ds_read_b128 a[56:59], v34 offset:128
    ds_read_b128 a[60:63], v35 offset:128
    ds_read_b128 a[64:67], v34 offset:256
    ds_read_b128 a[68:71], v35 offset:256
    s_waitcnt lgkmcnt(5)
    v_mfma_f32_16x16x32_bf16 v[84:87], a[48:51], a[48:51], 0
    ds_read_b64_tr_b16 a[72:73], v36 offset:0
    ds_read_b64_tr_b16 a[74:75], v36 offset:6144
    v_mfma_f32_16x16x32_bf16 v[80:83], a[48:51], v[52:55], 0
    ds_read_b64_tr_b16 a[76:77], v36 offset:12288
    ds_read_b64_tr_b16 a[78:79], v36 offset:18432
    s_waitcnt lgkmcnt(8)
    v_mfma_f32_16x16x32_bf16 v[84:87], a[52:55], a[52:55], v[84:87]
    ds_read_b64_tr_b16 a[80:81], v37 offset:0
    ds_read_b64_tr_b16 a[82:83], v37 offset:6144
    v_mfma_f32_16x16x32_bf16 v[80:83], a[52:55], v[52:55], v[80:83]
    ds_read_b64_tr_b16 a[84:85], v37 offset:12288
    ds_read_b64_tr_b16 a[86:87], v37 offset:18432
    s_waitcnt lgkmcnt(11)
    v_mfma_f32_16x16x32_bf16 v[84:87], a[56:59], a[56:59], v[84:87]
    ds_read_b64_tr_b16 a[88:89], v38 offset:0
    ds_read_b64_tr_b16 a[90:91], v38 offset:6144
    v_mfma_f32_16x16x32_bf16 v[80:83], a[56:59], v[52:55], v[80:83]
    ds_read_b64_tr_b16 a[92:93], v38 offset:12288
    ds_read_b64_tr_b16 a[94:95], v38 offset:18432
    s_waitcnt lgkmcnt(14)
    v_mfma_f32_16x16x32_bf16 v[84:87], a[60:63], a[60:63], v[84:87]
    v_mfma_f32_16x16x32_bf16 v[80:83], a[60:63], v[52:55], v[80:83]
    s_waitcnt lgkmcnt(13)
    v_mfma_f32_16x16x32_bf16 v[84:87], a[64:67], a[64:67], v[84:87]
    v_mfma_f32_16x16x32_bf16 v[80:83], a[64:67], v[52:55], v[80:83]
    s_waitcnt lgkmcnt(12)
    v_mfma_f32_16x16x32_bf16 v[84:87], a[68:71], a[68:71], v[84:87]
    v_mfma_f32_16x16x32_bf16 v[80:83], a[68:71], v[52:55], v[80:83]
    s_waitcnt lgkmcnt(0)
    s_mul_i32 s39, s38, 0x9e3779b1
    s_add_u32 s39, s39, 0x7f4a7c16
    s_or_b32 s39, s39, 1
    s_mul_i32 s56, s3, 3072
    s_add_u32 s56, s56, 16384
    buffer_load_dwordx4 v[136:139], v65, s[32:35], s56 offen offset:0 sc1
    buffer_load_dwordx4 v[140:143], v65, s[32:35], s56 offen offset:1024 sc1
    buffer_load_dwordx4 v[144:147], v65, s[32:35], s56 offen offset:2048 sc1
    s_waitcnt vmcnt(15)
    s_barrier
    ds_read_b128 a[96:99], v40 offset:0
    ds_read_b128 a[100:103], v41 offset:0
    ds_read_b128 a[104:107], v42 offset:0
    ds_read_b128 a[108:111], v43 offset:0
    ds_read_b128 a[112:115], v40 offset:256
    ds_read_b128 a[116:119], v41 offset:256
    ds_read_b128 a[120:123], v42 offset:256
    ds_read_b128 a[124:127], v43 offset:256
    ds_read_b128 a[128:131], v40 offset:512
    ds_read_b128 a[132:135], v41 offset:512
    ds_read_b128 a[136:139], v42 offset:512
    ds_read_b128 a[140:143], v43 offset:512
    ds_read_b64_tr_b16 a[144:145], v44 offset:0
    ds_read_b64_tr_b16 a[146:147], v45 offset:0
    ds_read_b64_tr_b16 a[148:149], v44 offset:12288
    ds_read_b64_tr_b16 a[150:151], v45 offset:12288
    ds_read_b64_tr_b16 a[152:153], v44 offset:24576
    ds_read_b64_tr_b16 a[154:155], v45 offset:24576
    ds_read_b64_tr_b16 a[156:157], v44 offset:36864
    ds_read_b64_tr_b16 a[158:159], v45 offset:36864
    ds_read_b64_tr_b16 a[160:161], v46 offset:0
    ds_read_b64_tr_b16 a[162:163], v47 offset:0
    ds_read_b64_tr_b16 a[164:165], v46 offset:12288
    ds_read_b64_tr_b16 a[166:167], v47 offset:12288
    ds_read_b64_tr_b16 a[168:169], v46 offset:24576
    ds_read_b64_tr_b16 a[170:171], v47 offset:24576
    ds_read_b64_tr_b16 a[172:173], v46 offset:36864
    ds_read_b64_tr_b16 a[174:175], v47 offset:36864
    ds_read_b64_tr_b16 a[176:177], v48 offset:0
    ds_read_b64_tr_b16 a[178:179], v49 offset:0
    ds_read_b64_tr_b16 a[180:181], v48 offset:12288
    ds_read_b64_tr_b16 a[182:183], v49 offset:12288
    ds_read_b64_tr_b16 a[184:185], v48 offset:24576
    ds_read_b64_tr_b16 a[186:187], v49 offset:24576
    ds_read_b64_tr_b16 a[188:189], v48 offset:36864
    ds_read_b64_tr_b16 a[190:191], v49 offset:36864
    s_waitcnt lgkmcnt(0)
    s_barrier
    s_cmp_ge_u32 s43, 3
    s_cbranch_scc1 L_v_nofl
    s_mul_i32 s56, s3, 3
    s_add_u32 s56, s56, s43
    s_lshl_b32 s56, s56, 7
    v_mov_b32 v1, s39
    v_mov_b32 v2, 0
    s_mov_b64 exec, 1
    s_waitcnt vmcnt(9)
    buffer_store_dword v1, v2, s[32:35], s56 offen offset:128 sc1
    s_mov_b64 exec, -1
L_v_nofl:
    v_mfma_f32_16x16x32_bf16 v[96:99], a[96:99], a[96:99], v[84:87]
    s_add_u32 m0, s40, 0
    s_add_u32 s57, s36, 24576
    buffer_load_dwordx4 v16, s[28:31], s57 offen offset:0 nt lds
    v_add_u32 v44, 49152, v44
    v_add_u32 v45, 49152, v45
    v_mfma_f32_16x16x32_bf16 v[100:103], a[96:99], a[48:51], 0
    buffer_load_dwordx4 v17, s[28:31], s57 offen offset:1024 nt lds
    v_add_u32 v46, 49152, v46
    v_add_u32 v47, 49152, v47
    v_mfma_f32_16x16x32_bf16 v[96:99], a[100:103], a[100:103], v[96:99]
    buffer_load_dwordx4 v18, s[28:31], s57 offen offset:2048 nt lds
    v_add_u32 v48, 49152, v48
    v_add_u32 v49, 49152, v49
    v_mfma_f32_16x16x32_bf16 v[100:103], a[100:103], a[52:55], v[100:103]
    v_mfma_f32_16x16x32_bf16 v[96:99], a[104:107], a[104:107], v[96:99]
    v_mfma_f32_16x16x32_bf16 v[100:103], a[104:107], a[56:59], v[100:103]
    v_mfma_f32_16x16x32_bf16 v[96:99], a[108:111], a[108:111], v[96:99]
    v_mfma_f32_16x16x32_bf16 v[100:103], a[108:111], a[60:63], v[100:103]
    v_mfma_f32_16x16x32_bf16 v[96:99], a[112:115], a[112:115], v[96:99]
    v_mfma_f32_16x16x32_bf16 v[100:103], a[112:115], a[64:67], v[100:103]
    v_mfma_f32_16x16x32_bf16 v[96:99], a[116:119], a[116:119], v[96:99]
    v_mfma_f32_16x16x32_bf16 v[100:103], a[116:119], a[68:71], v[100:103]
    v_mfma_f32_16x16x32_bf16 v[92:95], a[96:99], v[52:55], v[80:83]
    v_mfma_f32_16x16x32_bf16 v[92:95], a[100:103], v[52:55], v[92:95]
    v_mfma_f32_16x16x32_bf16 v[92:95], a[104:107], v[52:55], v[92:95]
    v_mfma_f32_16x16x32_bf16 v[92:95], a[108:111], v[52:55], v[92:95]
    s_nop 3
    v_fma_f32 v96, v100, 2.0, v96
    v_fma_f32 v97, v101, 2.0, v97
    v_mfma_f32_16x16x32_bf16 v[92:95], a[112:115], v[52:55], v[92:95]
    buffer_load_dwordx4 v19, s[28:31], s57 offen offset:3072 nt lds
    v_fma_f32 v98, v102, 2.0, v98
    v_fma_f32 v99, v103, 2.0, v99
    v_mfma_f32_16x16x32_bf16 v[92:95], a[116:119], v[52:55], v[92:95]
    v_cndmask_b32 v3, 0, v96, s[44:45]
    v_cndmask_b32 v3, v3, v97, s[46:47]
    v_mfma_f32_16x16x32_bf16 v[112:115], a[120:123], a[120:123], v[84:87]
    v_cndmask_b32 v3, v3, v98, s[48:49]
    v_cndmask_b32 v3, v3, v99, s[50:51]
    v_mfma_f32_16x16x32_bf16 v[116:119], a[120:123], a[48:51], 0
    s_nop 0
    s_nop 0
    v_mfma_f32_16x16x32_bf16 v[112:115], a[124:127], a[124:127], v[112:115]
    v_mfma_f32_16x16x4_f32 v[120:123], v3, v60, v[56:59]
    v_mfma_f32_16x16x32_bf16 v[116:119], a[124:127], a[52:55], v[116:119]
    v_mfma_f32_16x16x32_bf16 v[112:115], a[128:131], a[128:131], v[112:115]
    v_mfma_f32_16x16x32_bf16 v[116:119], a[128:131], a[56:59], v[116:119]
    v_mfma_f32_16x16x32_bf16 v[112:115], a[132:135], a[132:135], v[112:115]
    s_nop 5
    v_fma_f32 v128, -v92, v92, v120
    v_fma_f32 v129, -v93, v93, v121
    v_mfma_f32_16x16x32_bf16 v[116:119], a[132:135], a[60:63], v[116:119]
    v_fma_f32 v130, -v94, v94, v122
    v_fma_f32 v131, -v95, v95, v123
    v_mfma_f32_16x16x32_bf16 v[112:115], a[136:139], a[136:139], v[112:115]
    v_max_f32 v128, v128, v56
    v_max_f32 v129, v129, v56
    v_mfma_f32_16x16x32_bf16 v[116:119], a[136:139], a[64:67], v[116:119]
    s_add_u32 m0, s40, 4096
    s_nop 0
    buffer_load_dwordx4 v20, s[28:31], s57 offen offset:0 nt lds
    v_max_f32 v130, v130, v56
    v_max_f32 v131, v131, v56
    v_mfma_f32_16x16x32_bf16 v[112:115], a[140:143], a[140:143], v[112:115]
    v_rsq_f32 v128, v128
    v_mfma_f32_16x16x32_bf16 v[116:119], a[140:143], a[68:71], v[116:119]
    v_rsq_f32 v129, v129
    v_mfma_f32_16x16x32_bf16 v[108:111], a[120:123], v[52:55], v[80:83]
    v_rsq_f32 v130, v130
    v_mfma_f32_16x16x32_bf16 v[108:111], a[124:127], v[52:55], v[108:111]
    v_rsq_f32 v131, v131
    v_mfma_f32_16x16x32_bf16 v[108:111], a[128:131], v[52:55], v[108:111]
    v_mfma_f32_16x16x32_bf16 v[108:111], a[132:135], v[52:55], v[108:111]
    v_mfma_f32_16x16x32_bf16 v[108:111], a[136:139], v[52:55], v[108:111]
    v_fma_f32 v112, v116, 2.0, v112
    v_fma_f32 v113, v117, 2.0, v113
    v_mfma_f32_16x16x32_bf16 v[108:111], a[140:143], v[52:55], v[108:111]
    v_fma_f32 v114, v118, 2.0, v114
    v_fma_f32 v115, v119, 2.0, v115
    v_cndmask_b32 v4, 0, v112, s[44:45]
    v_cndmask_b32 v4, v4, v113, s[46:47]
    v_cndmask_b32 v4, v4, v114, s[48:49]
    v_cndmask_b32 v4, v4, v115, s[50:51]
    s_nop 0
    s_nop 0
    v_mfma_f32_16x16x4_f32 v[124:127], v4, v60, v[56:59]
    s_nop 9
    v_fma_f32 v132, -v108, v108, v124
    v_fma_f32 v133, -v109, v109, v125
    v_fma_f32 v134, -v110, v110, v126
    v_fma_f32 v135, -v111, v111, v127
    v_max_f32 v132, v132, v56
    v_max_f32 v133, v133, v56
    v_max_f32 v134, v134, v56
    v_max_f32 v135, v135, v56
    v_rsq_f32 v132, v132
    v_rsq_f32 v133, v133
    v_rsq_f32 v134, v134
    v_rsq_f32 v135, v135
    s_mul_i32 s56, s3, 1536
    v_lshlrev_b32 v5, 3, v0
    v_add_u32 v5, 153600, v5
    v_add_u32 v4, s56, v5
    buffer_load_dwordx4 v21, s[28:31], s57 offen offset:1024 nt lds
    s_add_u32 m0, s41, 0
    s_add_u32 s58, s37, 49152
    buffer_load_dwordx4 v22, s[24:27], s58 offen offset:0 nt lds
    buffer_load_dwordx4 v23, s[24:27], s58 offen offset:1024 nt lds
    buffer_load_dwordx4 v24, s[24:27], s58 offen offset:2048 nt lds
    buffer_load_dwordx4 v25, s[24:27], s58 offen offset:3072 nt lds
    s_add_u32 m0, s41, 4096
    s_nop 0
    buffer_load_dwordx4 v26, s[24:27], s58 offen offset:0 nt lds
    buffer_load_dwordx4 v27, s[24:27], s58 offen offset:1024 nt lds
    s_waitcnt vmcnt(12)
    v_xor_b32 v1, s39, v138
    v_xor_b32 v2, s39, v142
    v_xor_b32 v3, s39, v146
    v_or3_b32 v1, v1, v2, v3
    v_cmp_ne_u32 vcc, 0, v1
    s_cbranch_vccnz L_qk_retry
L_qk_ok:
    ds_write_b64 v4, v[136:137] offset:0
    ds_write_b64 v4, v[140:141] offset:512
    ds_write_b64 v4, v[144:145] offset:1024
    s_waitcnt lgkmcnt(0)
    s_barrier
    ds_read2st64_b64 v[136:139], v5 offset0:0 offset1:1
    ds_read2st64_b64 v[140:143], v5 offset0:2 offset1:3
    ds_read2st64_b64 v[144:147], v5 offset0:4 offset1:5
    ds_read2st64_b64 v[148:151], v5 offset0:6 offset1:7
    ds_read2st64_b64 v[152:155], v5 offset0:8 offset1:9
    ds_read2st64_b64 v[156:159], v5 offset0:10 offset1:11
    s_waitcnt lgkmcnt(5)
    v_mfma_f32_16x16x32_bf16 v[120:123], v[52:55], v[136:139], 0
    buffer_load_dwordx4 v28, s[24:27], s58 offen offset:2048 nt lds
    v_mfma_f32_16x16x32_bf16 v[76:79], a[48:51], v[136:139], 0
    s_waitcnt lgkmcnt(4)
    v_mfma_f32_16x16x32_bf16 v[120:123], v[52:55], v[140:143], v[120:123]
    v_mfma_f32_16x16x32_bf16 v[76:79], a[52:55], v[140:143], v[76:79]
    s_waitcnt lgkmcnt(3)
    v_mfma_f32_16x16x32_bf16 v[120:123], v[52:55], v[144:147], v[120:123]
    v_mfma_f32_16x16x32_bf16 v[76:79], a[56:59], v[144:147], v[76:79]
    s_waitcnt lgkmcnt(2)
    v_mfma_f32_16x16x32_bf16 v[120:123], v[52:55], v[148:151], v[120:123]
    v_mfma_f32_16x16x32_bf16 v[76:79], a[60:63], v[148:151], v[76:79]
    s_waitcnt lgkmcnt(1)
    v_mfma_f32_16x16x32_bf16 v[120:123], v[52:55], v[152:155], v[120:123]
    buffer_load_dwordx4 v29, s[24:27], s58 offen offset:3072 nt lds
    v_mfma_f32_16x16x32_bf16 v[76:79], a[64:67], v[152:155], v[76:79]
    s_waitcnt lgkmcnt(0)
    v_mfma_f32_16x16x32_bf16 v[120:123], v[52:55], v[156:159], v[120:123]
    v_mfma_f32_16x16x32_bf16 v[76:79], a[68:71], v[156:159], v[76:79]
    s_nop 6
    v_mul_f32 v61, 0x3baaaaab, v120
    v_mfma_f32_16x16x32_bf16 v[88:91], a[96:99], v[136:139], v[76:79]
    v_mov_b32 v9, 0
    v_mfma_f32_16x16x32_bf16 v[88:91], a[100:103], v[140:143], v[88:91]
    v_mfma_f32_16x16x32_bf16 v[88:91], a[104:107], v[144:147], v[88:91]
    v_mfma_f32_16x16x32_bf16 v[88:91], a[108:111], v[148:151], v[88:91]
    v_mfma_f32_16x16x32_bf16 v[88:91], a[112:115], v[152:155], v[88:91]
    v_mfma_f32_16x16x32_bf16 v[88:91], a[116:119], v[156:159], v[88:91]
    ds_write_b32 v254, v9 offset:4096
    v_mfma_f32_16x16x32_bf16 v[104:107], a[120:123], v[136:139], v[76:79]
    v_mfma_f32_16x16x32_bf16 v[104:107], a[124:127], v[140:143], v[104:107]
    v_mfma_f32_16x16x32_bf16 v[104:107], a[128:131], v[144:147], v[104:107]
    v_mfma_f32_16x16x32_bf16 v[104:107], a[132:135], v[148:151], v[104:107]
    s_nop 2
    v_fma_f32 v88, -v92, v61, v88
    v_fma_f32 v89, -v93, v61, v89
    v_mfma_f32_16x16x32_bf16 v[104:107], a[136:139], v[152:155], v[104:107]
    s_add_u32 m0, s41, 8192
    s_nop 0
    buffer_load_dwordx4 v30, s[24:27], s58 offen offset:0 nt lds
    v_fma_f32 v90, -v94, v61, v90
    v_fma_f32 v91, -v95, v61, v91
    v_mfma_f32_16x16x32_bf16 v[104:107], a[140:143], v[156:159], v[104:107]
    v_mul_f32 v88, v88, v128
    v_mul_f32 v89, v89, v129
    v_mul_f32 v90, v90, v130
    v_mul_f32 v91, v91, v131
    v_max3_f32 v1, v88, v89, v90
    v_max_f32 v1, v1, v91
    s_nop 1
    v_fma_f32 v104, -v108, v61, v104
    v_fma_f32 v105, -v109, v61, v105
    v_fma_f32 v106, -v110, v61, v106
    v_fma_f32 v107, -v111, v61, v107
    v_mul_f32 v104, v104, v132
    v_mul_f32 v105, v105, v133
    v_mul_f32 v106, v106, v134
    v_mul_f32 v107, v107, v135
    v_max3_f32 v1, v1, v104, v105
    v_max3_f32 v1, v1, v106, v107
    v_mov_b32 v2, v1
    s_nop 1
    v_permlane32_swap_b32 v1, v2
    v_max_f32 v1, v1, v2
    v_mov_b32 v2, v1
    s_nop 1
    v_permlane16_swap_b32 v1, v2
    v_max_f32 v1, v1, v2
    ds_write_b32 v239, v1
    s_waitcnt lgkmcnt(0)
    s_barrier
    ds_read_b32 v12, v240 offset:0
    ds_read_b32 v13, v240 offset:1024
    ds_read_b32 v14, v240 offset:2048
    ds_read_b32 v15, v240 offset:3072
    buffer_load_dwordx4 v31, s[24:27], s58 offen offset:1024 nt lds
    s_waitcnt lgkmcnt(0)
    v_max3_f32 v1, v12, v13, v14
    v_max_f32 v1, v1, v15
    v_sub_f32 v88, v88, v1
    v_sub_f32 v89, v89, v1
    v_sub_f32 v90, v90, v1
    v_sub_f32 v91, v91, v1
    v_sub_f32 v104, v104, v1
    v_sub_f32 v105, v105, v1
    v_sub_f32 v106, v106, v1
    v_sub_f32 v107, v107, v1
    v_sub_f32 v62, 0, v1
    v_sub_f32 v255, 0, v1
    v_exp_f32 v96, v88
    v_exp_f32 v97, v89
    v_exp_f32 v98, v90
    v_exp_f32 v99, v91
    v_mul_f32 v88, v96, v128
    v_mul_f32 v89, v97, v129
    v_mul_f32 v90, v98, v130
    v_mul_f32 v91, v99, v131
    v_exp_f32 v112, v104
    v_exp_f32 v113, v105
    v_exp_f32 v114, v106
    v_exp_f32 v115, v107
    v_cvt_pk_bf16_f32 v72, v88, v89
    v_cvt_pk_bf16_f32 v73, v90, v91
    v_mul_f32 v104, v112, v132
    v_mul_f32 v105, v113, v133
    v_mul_f32 v106, v114, v134
    v_mul_f32 v107, v115, v135
    v_cvt_pk_bf16_f32 v74, v104, v105
    v_cvt_pk_bf16_f32 v75, v106, v107
    ds_write_b128 v237, v[72:75]
    v_mov_b32 v63, v96
    v_mul_f32 v64, v88, v92
    v_add_f32 v63, v63, v97
    v_fmac_f32 v64, v89, v93
    v_add_f32 v63, v63, v98
    v_fmac_f32 v64, v90, v94
    v_add_f32 v63, v63, v99
    v_fmac_f32 v64, v91, v95
    v_mov_b32 v68, v88
    v_mov_b32 v69, v89
    v_mov_b32 v70, v90
    v_mov_b32 v71, v91
    s_waitcnt lgkmcnt(0)
    s_barrier
    ds_read_b128 v[92:95], v253 offset:0
    ds_read_b128 v[96:99], v253 offset:1024
    ds_read_b128 v[100:103], v253 offset:2048
    ds_read_b128 v[116:119], v253 offset:3072
    s_waitcnt lgkmcnt(3)
    v_mfma_f32_16x16x32_bf16 a[0:3], a[144:147], v[92:95], 0
    buffer_load_dwordx4 v32, s[24:27], s58 offen offset:2048 nt lds
    v_add_f32 v68, v68, v104
    v_add_f32 v69, v69, v105
    v_mfma_f32_16x16x32_bf16 a[4:7], a[160:163], v[92:95], 0
    buffer_load_dwordx4 v33, s[24:27], s58 offen offset:3072 nt lds
    v_add_f32 v70, v70, v106
    v_add_f32 v71, v71, v107
    v_mfma_f32_16x16x32_bf16 a[8:11], a[176:179], v[92:95], 0
    v_add_f32 v63, v63, v112
    v_fma_f32 v64, v104, v108, v64
    s_waitcnt lgkmcnt(2)
    v_mfma_f32_16x16x32_bf16 a[0:3], a[148:151], v[96:99], a[0:3]
    v_add_f32 v63, v63, v113
    v_fma_f32 v64, v105, v109, v64
    v_mfma_f32_16x16x32_bf16 a[4:7], a[164:167], v[96:99], a[4:7]
    v_add_f32 v63, v63, v114
    v_fma_f32 v64, v106, v110, v64
    v_mfma_f32_16x16x32_bf16 a[8:11], a[180:183], v[96:99], a[8:11]
    v_add_f32 v63, v63, v115
    v_fma_f32 v64, v107, v111, v64
    s_waitcnt lgkmcnt(1)
    v_mfma_f32_16x16x32_bf16 a[0:3], a[152:155], v[100:103], a[0:3]
    v_mfma_f32_16x16x32_bf16 a[4:7], a[168:171], v[100:103], a[4:7]
    v_mfma_f32_16x16x32_bf16 a[8:11], a[184:187], v[100:103], a[8:11]
    s_waitcnt lgkmcnt(0)
    v_mfma_f32_16x16x32_bf16 a[0:3], a[156:159], v[116:119], a[0:3]
    v_mfma_f32_16x16x32_bf16 a[4:7], a[172:175], v[116:119], a[4:7]
    v_mfma_f32_16x16x32_bf16 a[8:11], a[188:191], v[116:119], a[8:11]
    s_barrier
    ds_read_b128 a[96:99], v40 offset:49152
    ds_read_b128 a[100:103], v41 offset:49152
    ds_read_b128 a[104:107], v42 offset:49152
    ds_read_b128 a[108:111], v43 offset:49152
    ds_read_b128 a[112:115], v40 offset:49408
    ds_read_b128 a[116:119], v41 offset:49408
    ds_read_b128 a[120:123], v42 offset:49408
    ds_read_b128 a[124:127], v43 offset:49408
    ds_read_b128 a[128:131], v40 offset:49664
    ds_read_b128 a[132:135], v41 offset:49664
    ds_read_b128 a[136:139], v42 offset:49664
    ds_read_b128 a[140:143], v43 offset:49664
    s_waitcnt lgkmcnt(11)
    v_mfma_f32_16x16x32_bf16 v[96:99], a[96:99], a[96:99], v[84:87]
    ds_read_b64_tr_b16 a[144:145], v44 offset:0
    ds_read_b64_tr_b16 a[146:147], v45 offset:0
    v_mfma_f32_16x16x32_bf16 v[100:103], a[96:99], a[48:51], 0
    ds_read_b64_tr_b16 a[148:149], v44 offset:12288
    ds_read_b64_tr_b16 a[150:151], v45 offset:12288
    s_waitcnt lgkmcnt(14)
    v_mfma_f32_16x16x32_bf16 v[96:99], a[100:103], a[100:103], v[96:99]
    ds_read_b64_tr_b16 a[152:153], v44 offset:24576
    ds_read_b64_tr_b16 a[154:155], v45 offset:24576
    v_mfma_f32_16x16x32_bf16 v[100:103], a[100:103], a[52:55], v[100:103]
    ds_read_b64_tr_b16 a[156:157], v44 offset:36864
    ds_read_b64_tr_b16 a[158:159], v45 offset:36864
    s_waitcnt lgkmcnt(15)
    v_mfma_f32_16x16x32_bf16 v[96:99], a[104:107], a[104:107], v[96:99]
    ds_read_b64_tr_b16 a[160:161], v46 offset:0
    ds_read_b64_tr_b16 a[162:163], v47 offset:0
    v_mfma_f32_16x16x32_bf16 v[100:103], a[104:107], a[56:59], v[100:103]
    ds_read_b64_tr_b16 a[164:165], v46 offset:12288
    ds_read_b64_tr_b16 a[166:167], v47 offset:12288
    v_mfma_f32_16x16x32_bf16 v[96:99], a[108:111], a[108:111], v[96:99]
    ds_read_b64_tr_b16 a[168:169], v46 offset:24576
    ds_read_b64_tr_b16 a[170:171], v47 offset:24576
    v_mfma_f32_16x16x32_bf16 v[100:103], a[108:111], a[60:63], v[100:103]
    ds_read_b64_tr_b16 a[172:173], v46 offset:36864
    ds_read_b64_tr_b16 a[174:175], v47 offset:36864
    v_mfma_f32_16x16x32_bf16 v[96:99], a[112:115], a[112:115], v[96:99]
    ds_read_b64_tr_b16 a[176:177], v48 offset:0
    ds_read_b64_tr_b16 a[178:179], v49 offset:0
    v_mfma_f32_16x16x32_bf16 v[100:103], a[112:115], a[64:67], v[100:103]
    ds_read_b64_tr_b16 a[180:181], v48 offset:12288
    ds_read_b64_tr_b16 a[182:183], v49 offset:12288
    s_waitcnt lgkmcnt(15)
    v_mfma_f32_16x16x32_bf16 v[96:99], a[116:119], a[116:119], v[96:99]
    ds_read_b64_tr_b16 a[184:185], v48 offset:24576
    ds_read_b64_tr_b16 a[186:187], v49 offset:24576
    v_mfma_f32_16x16x32_bf16 v[100:103], a[116:119], a[68:71], v[100:103]
    ds_read_b64_tr_b16 a[188:189], v48 offset:36864
    ds_read_b64_tr_b16 a[190:191], v49 offset:36864
    v_mfma_f32_16x16x32_bf16 v[92:95], a[96:99], v[52:55], v[80:83]
    v_mfma_f32_16x16x32_bf16 v[92:95], a[100:103], v[52:55], v[92:95]
    v_mfma_f32_16x16x32_bf16 v[92:95], a[104:107], v[52:55], v[92:95]
    v_mfma_f32_16x16x32_bf16 v[92:95], a[108:111], v[52:55], v[92:95]
    s_nop 1
    v_fma_f32 v96, v100, 2.0, v96
    v_fma_f32 v97, v101, 2.0, v97
    v_mfma_f32_16x16x32_bf16 v[92:95], a[112:115], v[52:55], v[92:95]
    v_fma_f32 v98, v102, 2.0, v98
    v_fma_f32 v99, v103, 2.0, v99
    v_mfma_f32_16x16x32_bf16 v[92:95], a[116:119], v[52:55], v[92:95]
    v_cndmask_b32 v3, 0, v96, s[44:45]
    v_cndmask_b32 v3, v3, v97, s[46:47]
    v_mfma_f32_16x16x32_bf16 v[88:91], a[96:99], v[136:139], v[76:79]
    v_cndmask_b32 v3, v3, v98, s[48:49]
    v_cndmask_b32 v3, v3, v99, s[50:51]
    v_mfma_f32_16x16x32_bf16 v[88:91], a[100:103], v[140:143], v[88:91]
    s_nop 0
    s_nop 0
    v_mfma_f32_16x16x32_bf16 v[88:91], a[104:107], v[144:147], v[88:91]
    v_mfma_f32_16x16x4_f32 v[120:123], v3, v60, v[56:59]
    v_mfma_f32_16x16x32_bf16 v[88:91], a[108:111], v[148:151], v[88:91]
    v_mfma_f32_16x16x32_bf16 v[88:91], a[112:115], v[152:155], v[88:91]
    v_mfma_f32_16x16x32_bf16 v[88:91], a[116:119], v[156:159], v[88:91]
    s_waitcnt lgkmcnt(0)
    s_barrier
    v_mfma_f32_16x16x32_bf16 v[112:115], a[120:123], a[120:123], v[84:87]
    s_add_u32 m0, s42, 0
    s_add_u32 s59, s37, 245760
    buffer_load_dwordx4 v22, s[24:27], s59 offen offset:0 nt lds
    v_mfma_f32_16x16x32_bf16 v[116:119], a[120:123], a[48:51], 0
    buffer_load_dwordx4 v23, s[24:27], s59 offen offset:1024 nt lds
    v_mfma_f32_16x16x32_bf16 v[112:115], a[124:127], a[124:127], v[112:115]
    buffer_load_dwordx4 v24, s[24:27], s59 offen offset:2048 nt lds
    v_mfma_f32_16x16x32_bf16 v[116:119], a[124:127], a[52:55], v[116:119]
    buffer_load_dwordx4 v25, s[24:27], s59 offen offset:3072 nt lds
    v_fma_f32 v128, -v92, v92, v120
    v_fma_f32 v129, -v93, v93, v121
    v_mfma_f32_16x16x32_bf16 v[112:115], a[128:131], a[128:131], v[112:115]
    v_fma_f32 v130, -v94, v94, v122
    v_fma_f32 v131, -v95, v95, v123
    v_mfma_f32_16x16x32_bf16 v[116:119], a[128:131], a[56:59], v[116:119]
    v_max_f32 v128, v128, v56
    v_max_f32 v129, v129, v56
    v_mfma_f32_16x16x32_bf16 v[112:115], a[132:135], a[132:135], v[112:115]
    v_max_f32 v130, v130, v56
    v_max_f32 v131, v131, v56
    v_mfma_f32_16x16x32_bf16 v[116:119], a[132:135], a[60:63], v[116:119]
    v_rsq_f32 v128, v128
    v_mfma_f32_16x16x32_bf16 v[112:115], a[136:139], a[136:139], v[112:115]
    s_add_u32 m0, s42, 4096
    s_nop 0
    buffer_load_dwordx4 v26, s[24:27], s59 offen offset:0 nt lds
    v_rsq_f32 v129, v129
    v_mfma_f32_16x16x32_bf16 v[116:119], a[136:139], a[64:67], v[116:119]
    v_rsq_f32 v130, v130
    v_mfma_f32_16x16x32_bf16 v[112:115], a[140:143], a[140:143], v[112:115]
    v_rsq_f32 v131, v131
    v_mfma_f32_16x16x32_bf16 v[116:119], a[140:143], a[68:71], v[116:119]
    v_fma_f32 v88, -v92, v61, v88
    v_fma_f32 v89, -v93, v61, v89
    v_mfma_f32_16x16x32_bf16 v[108:111], a[120:123], v[52:55], v[80:83]
    v_fma_f32 v90, -v94, v61, v90
    v_fma_f32 v91, -v95, v61, v91
    v_mfma_f32_16x16x32_bf16 v[108:111], a[124:127], v[52:55], v[108:111]
    v_fma_f32 v88, v88, v128, v62
    v_fma_f32 v89, v89, v129, v62
    v_mfma_f32_16x16x32_bf16 v[108:111], a[128:131], v[52:55], v[108:111]
    v_fma_f32 v90, v90, v130, v62
    v_fma_f32 v91, v91, v131, v62
    v_mfma_f32_16x16x32_bf16 v[108:111], a[132:135], v[52:55], v[108:111]
    v_max3_f32 v1, v88, v89, v90
    v_max_f32 v1, v1, v91
    v_mfma_f32_16x16x32_bf16 v[108:111], a[136:139], v[52:55], v[108:111]
    v_cmp_lt_f32 vcc, s52, v1
    s_cbranch_vccnz L_site0
L_back0:
    v_mfma_f32_16x16x32_bf16 v[108:111], a[140:143], v[52:55], v[108:111]
    v_exp_f32 v96, v88
    v_mfma_f32_16x16x32_bf16 v[104:107], a[120:123], v[136:139], v[76:79]
    v_exp_f32 v97, v89
    v_mfma_f32_16x16x32_bf16 v[104:107], a[124:127], v[140:143], v[104:107]
    v_exp_f32 v98, v90
    v_mfma_f32_16x16x32_bf16 v[104:107], a[128:131], v[144:147], v[104:107]
    buffer_load_dwordx4 v27, s[24:27], s59 offen offset:1024 nt lds
    v_exp_f32 v99, v91
    v_mfma_f32_16x16x32_bf16 v[104:107], a[132:135], v[148:151], v[104:107]
    v_mul_f32 v88, v96, v128
    v_mul_f32 v89, v97, v129
    v_mfma_f32_16x16x32_bf16 v[104:107], a[136:139], v[152:155], v[104:107]
    v_mul_f32 v90, v98, v130
    v_mul_f32 v91, v99, v131
    v_mfma_f32_16x16x32_bf16 v[104:107], a[140:143], v[156:159], v[104:107]
    v_fma_f32 v112, v116, 2.0, v112
    v_fma_f32 v113, v117, 2.0, v113
    v_fma_f32 v114, v118, 2.0, v114
    v_fma_f32 v115, v119, 2.0, v115
    v_cndmask_b32 v4, 0, v112, s[44:45]
    v_cndmask_b32 v4, v4, v113, s[46:47]
    v_cndmask_b32 v4, v4, v114, s[48:49]
    v_cndmask_b32 v4, v4, v115, s[50:51]
    v_add_f32 v63, v63, v96
    v_fmac_f32 v64, v88, v92
    v_mfma_f32_16x16x4_f32 v[124:127], v4, v60, v[56:59]
    v_add_f32 v63, v63, v97
    v_fmac_f32 v64, v89, v93
    v_add_f32 v63, v63, v98
    v_fmac_f32 v64, v90, v94
    v_add_f32 v63, v63, v99
    v_fmac_f32 v64, v91, v95
    v_add_f32 v68, v68, v88
    v_add_f32 v69, v69, v89
    v_add_f32 v70, v70, v90
    v_add_f32 v71, v71, v91
    v_add_u32 v44, -49152, v44
    v_add_u32 v45, -49152, v45
    v_add_u32 v46, -49152, v46
    v_add_u32 v47, -49152, v47
    v_add_u32 v48, -49152, v48
    v_add_u32 v49, -49152, v49
    v_fma_f32 v132, -v108, v108, v124
    v_fma_f32 v133, -v109, v109, v125
    v_fma_f32 v134, -v110, v110, v126
    v_fma_f32 v135, -v111, v111, v127
    v_max_f32 v132, v132, v56
    v_max_f32 v133, v133, v56
    v_max_f32 v134, v134, v56
    v_max_f32 v135, v135, v56
    v_rsq_f32 v132, v132
    v_rsq_f32 v133, v133
    v_rsq_f32 v134, v134
    v_rsq_f32 v135, v135
    buffer_load_dwordx4 v28, s[24:27], s59 offen offset:2048 nt lds
    v_fma_f32 v104, -v108, v61, v104
    v_fma_f32 v105, -v109, v61, v105
    v_fma_f32 v106, -v110, v61, v106
    v_fma_f32 v107, -v111, v61, v107
    v_fma_f32 v104, v104, v132, v62
    v_fma_f32 v105, v105, v133, v62
    v_fma_f32 v106, v106, v134, v62
    v_fma_f32 v107, v107, v135, v62
    v_max3_f32 v1, v104, v105, v106
    v_max_f32 v1, v1, v107
    v_cmp_lt_f32 vcc, s52, v1
    s_cbranch_vccnz L_site1
L_back1:
    v_exp_f32 v112, v104
    v_exp_f32 v113, v105
    v_exp_f32 v114, v106
    v_exp_f32 v115, v107
    v_cvt_pk_bf16_f32 v72, v88, v89
    v_cvt_pk_bf16_f32 v73, v90, v91
    v_mul_f32 v104, v112, v132
    v_mul_f32 v105, v113, v133
    v_mul_f32 v106, v114, v134
    v_mul_f32 v107, v115, v135
    v_cvt_pk_bf16_f32 v74, v104, v105
    v_cvt_pk_bf16_f32 v75, v106, v107
    ds_write_b128 v237, v[72:75]
    v_add_f32 v68, v68, v104
    v_add_f32 v69, v69, v105
    v_add_f32 v70, v70, v106
    v_add_f32 v71, v71, v107
    v_cvt_pk_bf16_f32 v66, v68, v69
    v_cvt_pk_bf16_f32 v67, v70, v71
    ds_write_b64 v238, v[66:67]
    buffer_load_dwordx4 v29, s[24:27], s59 offen offset:3072 nt lds
    s_waitcnt vmcnt(20)
    s_waitcnt lgkmcnt(0)
    s_barrier
L_post3:
    ds_read_b32 v9, v254 offset:4096
    ds_read_b64 v[120:121], v254 offset:0
    ds_read_b64 v[122:123], v254 offset:512
    ds_read_b64 v[124:125], v254 offset:1024
    ds_read_b64 v[126:127], v254 offset:1536
    ds_read_b128 v[92:95], v253 offset:0
    ds_read_b128 v[96:99], v253 offset:1024
    ds_read_b128 v[100:103], v253 offset:2048
    ds_read_b128 v[116:119], v253 offset:3072
    ds_read_b128 a[48:51], v34 offset:0
    ds_read_b128 a[52:55], v35 offset:0
    ds_read_b128 a[56:59], v34 offset:128
    ds_read_b128 a[60:63], v35 offset:128
    ds_read_b128 a[64:67], v34 offset:256
    ds_read_b128 a[68:71], v35 offset:256
    s_waitcnt lgkmcnt(14)
    v_cmp_ne_u32 vcc, 0, v9
    s_cbranch_vccnz L_xt3
    s_waitcnt lgkmcnt(12)
    v_mfma_f32_16x16x32_bf16 a[0:3], a[72:75], v[120:123], a[0:3]
    v_add_f32 v63, v63, v112
    v_fma_f32 v64, v104, v108, v64
    v_mfma_f32_16x16x32_bf16 a[4:7], a[80:83], v[120:123], a[4:7]
    v_add_f32 v63, v63, v113
    v_fma_f32 v64, v105, v109, v64
    v_mfma_f32_16x16x32_bf16 a[8:11], a[88:91], v[120:123], a[8:11]
    s_add_u32 m0, s42, 8192
    s_nop 0
    buffer_load_dwordx4 v30, s[24:27], s59 offen offset:0 nt lds
    v_add_f32 v63, v63, v114
    v_fma_f32 v64, v106, v110, v64
    s_waitcnt lgkmcnt(10)
    v_mfma_f32_16x16x32_bf16 a[0:3], a[76:79], v[124:127], a[0:3]
    v_add_f32 v63, v63, v115
    v_fma_f32 v64, v107, v111, v64
    v_mfma_f32_16x16x32_bf16 a[4:7], a[84:87], v[124:127], a[4:7]
    v_mfma_f32_16x16x32_bf16 a[8:11], a[92:95], v[124:127], a[8:11]
    s_waitcnt lgkmcnt(9)
    v_mfma_f32_16x16x32_bf16 a[0:3], a[144:147], v[92:95], a[0:3]
    ds_read_b64_tr_b16 a[72:73], v36 offset:0
    ds_read_b64_tr_b16 a[74:75], v36 offset:6144
    v_mfma_f32_16x16x32_bf16 a[4:7], a[160:163], v[92:95], a[4:7]
    ds_read_b64_tr_b16 a[76:77], v36 offset:12288
    ds_read_b64_tr_b16 a[78:79], v36 offset:18432
    v_mfma_f32_16x16x32_bf16 a[8:11], a[176:179], v[92:95], a[8:11]
    ds_read_b64_tr_b16 a[80:81], v37 offset:0
    ds_read_b64_tr_b16 a[82:83], v37 offset:6144
    s_waitcnt lgkmcnt(14)
    v_mfma_f32_16x16x32_bf16 a[0:3], a[148:151], v[96:99], a[0:3]
    ds_read_b64_tr_b16 a[84:85], v37 offset:12288
    ds_read_b64_tr_b16 a[86:87], v37 offset:18432
    v_mfma_f32_16x16x32_bf16 a[4:7], a[164:167], v[96:99], a[4:7]
    ds_read_b64_tr_b16 a[88:89], v38 offset:0
    ds_read_b64_tr_b16 a[90:91], v38 offset:6144
    v_mfma_f32_16x16x32_bf16 a[8:11], a[180:183], v[96:99], a[8:11]
    ds_read_b64_tr_b16 a[92:93], v38 offset:12288
    ds_read_b64_tr_b16 a[94:95], v38 offset:18432
    s_waitcnt lgkmcnt(15)
    v_mfma_f32_16x16x32_bf16 a[0:3], a[152:155], v[100:103], a[0:3]
    v_mfma_f32_16x16x32_bf16 a[4:7], a[168:171], v[100:103], a[4:7]
    buffer_load_dwordx4 v31, s[24:27], s59 offen offset:1024 nt lds
    v_mfma_f32_16x16x32_bf16 a[8:11], a[184:187], v[100:103], a[8:11]
    v_mfma_f32_16x16x32_bf16 a[0:3], a[156:159], v[116:119], a[0:3]
    v_mfma_f32_16x16x32_bf16 a[4:7], a[172:175], v[116:119], a[4:7]
    v_mfma_f32_16x16x32_bf16 a[8:11], a[188:191], v[116:119], a[8:11]
    v_mfma_f32_16x16x32_bf16 v[84:87], a[48:51], a[48:51], 0
    v_mfma_f32_16x16x32_bf16 v[80:83], a[48:51], v[52:55], 0
    v_mfma_f32_16x16x32_bf16 v[84:87], a[52:55], a[52:55], v[84:87]
    v_mfma_f32_16x16x32_bf16 v[80:83], a[52:55], v[52:55], v[80:83]
    v_mfma_f32_16x16x32_bf16 v[84:87], a[56:59], a[56:59], v[84:87]
    v_mfma_f32_16x16x32_bf16 v[80:83], a[56:59], v[52:55], v[80:83]
    s_waitcnt lgkmcnt(14)
    v_mfma_f32_16x16x32_bf16 v[84:87], a[60:63], a[60:63], v[84:87]
    v_mfma_f32_16x16x32_bf16 v[80:83], a[60:63], v[52:55], v[80:83]
    s_waitcnt lgkmcnt(13)
    v_mfma_f32_16x16x32_bf16 v[84:87], a[64:67], a[64:67], v[84:87]
    v_mfma_f32_16x16x32_bf16 v[80:83], a[64:67], v[52:55], v[80:83]
    buffer_load_dwordx4 v32, s[24:27], s59 offen offset:2048 nt lds
    s_waitcnt lgkmcnt(12)
    v_mfma_f32_16x16x32_bf16 v[84:87], a[68:71], a[68:71], v[84:87]
    v_mfma_f32_16x16x32_bf16 v[80:83], a[68:71], v[52:55], v[80:83]
    s_waitcnt lgkmcnt(0)
    v_mfma_f32_16x16x32_bf16 v[76:79], a[48:51], v[136:139], 0
    v_mfma_f32_16x16x32_bf16 v[76:79], a[52:55], v[140:143], v[76:79]
    v_mfma_f32_16x16x32_bf16 v[76:79], a[56:59], v[144:147], v[76:79]
    v_mfma_f32_16x16x32_bf16 v[76:79], a[60:63], v[148:151], v[76:79]
    v_mfma_f32_16x16x32_bf16 v[76:79], a[64:67], v[152:155], v[76:79]
    v_mfma_f32_16x16x32_bf16 v[76:79], a[68:71], v[156:159], v[76:79]
    buffer_load_dwordx4 v33, s[24:27], s59 offen offset:3072 nt lds
    s_waitcnt vmcnt(12)
    s_barrier
    ds_read_b128 a[96:99], v40 offset:0
    ds_read_b128 a[100:103], v41 offset:0
    ds_read_b128 a[104:107], v42 offset:0
    ds_read_b128 a[108:111], v43 offset:0
    ds_read_b128 a[112:115], v40 offset:256
    ds_read_b128 a[116:119], v41 offset:256
    ds_read_b128 a[120:123], v42 offset:256
    ds_read_b128 a[124:127], v43 offset:256
    ds_read_b128 a[128:131], v40 offset:512
    ds_read_b128 a[132:135], v41 offset:512
    ds_read_b128 a[136:139], v42 offset:512
    ds_read_b128 a[140:143], v43 offset:512
    s_waitcnt lgkmcnt(11)
    v_mfma_f32_16x16x32_bf16 v[96:99], a[96:99], a[96:99], v[84:87]
    ds_read_b64_tr_b16 a[144:145], v44 offset:0
    ds_read_b64_tr_b16 a[146:147], v45 offset:0
    v_mfma_f32_16x16x32_bf16 v[100:103], a[96:99], a[48:51], 0
    ds_read_b64_tr_b16 a[148:149], v44 offset:12288
    ds_read_b64_tr_b16 a[150:151], v45 offset:12288
    s_waitcnt lgkmcnt(14)
    v_mfma_f32_16x16x32_bf16 v[96:99], a[100:103], a[100:103], v[96:99]
    ds_read_b64_tr_b16 a[152:153], v44 offset:24576
    ds_read_b64_tr_b16 a[154:155], v45 offset:24576
    v_mfma_f32_16x16x32_bf16 v[100:103], a[100:103], a[52:55], v[100:103]
    ds_read_b64_tr_b16 a[156:157], v44 offset:36864
    ds_read_b64_tr_b16 a[158:159], v45 offset:36864
    s_waitcnt lgkmcnt(15)
    v_mfma_f32_16x16x32_bf16 v[96:99], a[104:107], a[104:107], v[96:99]
    ds_read_b64_tr_b16 a[160:161], v46 offset:0
    ds_read_b64_tr_b16 a[162:163], v47 offset:0
    v_mfma_f32_16x16x32_bf16 v[100:103], a[104:107], a[56:59], v[100:103]
    ds_read_b64_tr_b16 a[164:165], v46 offset:12288
    ds_read_b64_tr_b16 a[166:167], v47 offset:12288
    v_mfma_f32_16x16x32_bf16 v[96:99], a[108:111], a[108:111], v[96:99]
    s_add_u32 m0, s40, 0
    s_add_u32 s57, s36, 49152
    buffer_load_dwordx4 v16, s[28:31], s57 offen offset:0 nt lds
    ds_read_b64_tr_b16 a[168:169], v46 offset:24576
    ds_read_b64_tr_b16 a[170:171], v47 offset:24576
    v_mfma_f32_16x16x32_bf16 v[100:103], a[108:111], a[60:63], v[100:103]
    ds_read_b64_tr_b16 a[172:173], v46 offset:36864
    ds_read_b64_tr_b16 a[174:175], v47 offset:36864
    v_mfma_f32_16x16x32_bf16 v[96:99], a[112:115], a[112:115], v[96:99]
    ds_read_b64_tr_b16 a[176:177], v48 offset:0
    ds_read_b64_tr_b16 a[178:179], v49 offset:0
    v_mfma_f32_16x16x32_bf16 v[100:103], a[112:115], a[64:67], v[100:103]
    ds_read_b64_tr_b16 a[180:181], v48 offset:12288
    ds_read_b64_tr_b16 a[182:183], v49 offset:12288
    s_waitcnt lgkmcnt(15)
    v_mfma_f32_16x16x32_bf16 v[96:99], a[116:119], a[116:119], v[96:99]
    ds_read_b64_tr_b16 a[184:185], v48 offset:24576
    ds_read_b64_tr_b16 a[186:187], v49 offset:24576
    v_mfma_f32_16x16x32_bf16 v[100:103], a[116:119], a[68:71], v[100:103]
    ds_read_b64_tr_b16 a[188:189], v48 offset:36864
    ds_read_b64_tr_b16 a[190:191], v49 offset:36864
    v_mfma_f32_16x16x32_bf16 v[92:95], a[96:99], v[52:55], v[80:83]
    v_mfma_f32_16x16x32_bf16 v[92:95], a[100:103], v[52:55], v[92:95]
    v_mfma_f32_16x16x32_bf16 v[92:95], a[104:107], v[52:55], v[92:95]
    v_mfma_f32_16x16x32_bf16 v[92:95], a[108:111], v[52:55], v[92:95]
    s_nop 1
    v_fma_f32 v96, v100, 2.0, v96
    v_fma_f32 v97, v101, 2.0, v97
    v_mfma_f32_16x16x32_bf16 v[92:95], a[112:115], v[52:55], v[92:95]
    v_fma_f32 v98, v102, 2.0, v98
    v_fma_f32 v99, v103, 2.0, v99
    v_mfma_f32_16x16x32_bf16 v[92:95], a[116:119], v[52:55], v[92:95]
    buffer_load_dwordx4 v17, s[28:31], s57 offen offset:1024 nt lds
    v_cndmask_b32 v3, 0, v96, s[44:45]
    v_cndmask_b32 v3, v3, v97, s[46:47]
    v_mfma_f32_16x16x32_bf16 v[88:91], a[96:99], v[136:139], v[76:79]
    v_cndmask_b32 v3, v3, v98, s[48:49]
    v_cndmask_b32 v3, v3, v99, s[50:51]
    v_mfma_f32_16x16x32_bf16 v[88:91], a[100:103], v[140:143], v[88:91]
    s_nop 0
    s_nop 0
    v_mfma_f32_16x16x32_bf16 v[88:91], a[104:107], v[144:147], v[88:91]
    v_mfma_f32_16x16x4_f32 v[120:123], v3, v60, v[56:59]
    v_mfma_f32_16x16x32_bf16 v[88:91], a[108:111], v[148:151], v[88:91]
    v_mfma_f32_16x16x32_bf16 v[88:91], a[112:115], v[152:155], v[88:91]
    v_mfma_f32_16x16x32_bf16 v[88:91], a[116:119], v[156:159], v[88:91]
    v_mfma_f32_16x16x32_bf16 v[112:115], a[120:123], a[120:123], v[84:87]
    v_mfma_f32_16x16x32_bf16 v[116:119], a[120:123], a[48:51], 0
    v_mfma_f32_16x16x32_bf16 v[112:115], a[124:127], a[124:127], v[112:115]
    v_mfma_f32_16x16x32_bf16 v[116:119], a[124:127], a[52:55], v[116:119]
    s_nop 2
    v_fma_f32 v128, -v92, v92, v120
    v_fma_f32 v129, -v93, v93, v121
    v_mfma_f32_16x16x32_bf16 v[112:115], a[128:131], a[128:131], v[112:115]
    v_fma_f32 v130, -v94, v94, v122
    v_fma_f32 v131, -v95, v95, v123
    v_mfma_f32_16x16x32_bf16 v[116:119], a[128:131], a[56:59], v[116:119]
    buffer_load_dwordx4 v18, s[28:31], s57 offen offset:2048 nt lds
    v_max_f32 v128, v128, v56
    v_max_f32 v129, v129, v56
    v_mfma_f32_16x16x32_bf16 v[112:115], a[132:135], a[132:135], v[112:115]
    v_max_f32 v130, v130, v56
    v_max_f32 v131, v131, v56
    v_mfma_f32_16x16x32_bf16 v[116:119], a[132:135], a[60:63], v[116:119]
    v_rsq_f32 v128, v128
    v_mfma_f32_16x16x32_bf16 v[112:115], a[136:139], a[136:139], v[112:115]
    v_rsq_f32 v129, v129
    v_mfma_f32_16x16x32_bf16 v[116:119], a[136:139], a[64:67], v[116:119]
    v_rsq_f32 v130, v130
    v_mfma_f32_16x16x32_bf16 v[112:115], a[140:143], a[140:143], v[112:115]
    v_rsq_f32 v131, v131
    v_mfma_f32_16x16x32_bf16 v[116:119], a[140:143], a[68:71], v[116:119]
    v_fma_f32 v88, -v92, v61, v88
    v_fma_f32 v89, -v93, v61, v89
    v_mfma_f32_16x16x32_bf16 v[108:111], a[120:123], v[52:55], v[80:83]
    v_fma_f32 v90, -v94, v61, v90
    v_fma_f32 v91, -v95, v61, v91
    v_mfma_f32_16x16x32_bf16 v[108:111], a[124:127], v[52:55], v[108:111]
    v_fma_f32 v88, v88, v128, v62
    v_fma_f32 v89, v89, v129, v62
    v_mfma_f32_16x16x32_bf16 v[108:111], a[128:131], v[52:55], v[108:111]
    v_fma_f32 v90, v90, v130, v62
    v_fma_f32 v91, v91, v131, v62
    v_mfma_f32_16x16x32_bf16 v[108:111], a[132:135], v[52:55], v[108:111]
    v_max3_f32 v1, v88, v89, v90
    v_max_f32 v1, v1, v91
    v_mfma_f32_16x16x32_bf16 v[108:111], a[136:139], v[52:55], v[108:111]
    v_cmp_lt_f32 vcc, s52, v1
    s_cbranch_vccnz L_site2
L_back2:
    v_mfma_f32_16x16x32_bf16 v[108:111], a[140:143], v[52:55], v[108:111]
    buffer_load_dwordx4 v19, s[28:31], s57 offen offset:3072 nt lds
    v_exp_f32 v96, v88
    v_mfma_f32_16x16x32_bf16 v[104:107], a[120:123], v[136:139], v[76:79]
    v_exp_f32 v97, v89
    v_mfma_f32_16x16x32_bf16 v[104:107], a[124:127], v[140:143], v[104:107]
    v_exp_f32 v98, v90
    v_mfma_f32_16x16x32_bf16 v[104:107], a[128:131], v[144:147], v[104:107]
    v_exp_f32 v99, v91
    v_mfma_f32_16x16x32_bf16 v[104:107], a[132:135], v[148:151], v[104:107]
    v_mul_f32 v88, v96, v128
    v_mul_f32 v89, v97, v129
    v_mfma_f32_16x16x32_bf16 v[104:107], a[136:139], v[152:155], v[104:107]
    v_mul_f32 v90, v98, v130
    v_mul_f32 v91, v99, v131
    v_mfma_f32_16x16x32_bf16 v[104:107], a[140:143], v[156:159], v[104:107]
    v_fma_f32 v112, v116, 2.0, v112
    v_fma_f32 v113, v117, 2.0, v113
    v_fma_f32 v114, v118, 2.0, v114
    v_fma_f32 v115, v119, 2.0, v115
    v_cndmask_b32 v4, 0, v112, s[44:45]
    v_cndmask_b32 v4, v4, v113, s[46:47]
    v_cndmask_b32 v4, v4, v114, s[48:49]
    v_cndmask_b32 v4, v4, v115, s[50:51]
    v_add_f32 v63, v63, v96
    v_fmac_f32 v64, v88, v92
    v_mfma_f32_16x16x4_f32 v[124:127], v4, v60, v[56:59]
    v_add_f32 v63, v63, v97
    v_fmac_f32 v64, v89, v93
    v_add_f32 v63, v63, v98
    v_fmac_f32 v64, v90, v94
    v_add_f32 v63, v63, v99
    v_fmac_f32 v64, v91, v95
    v_mov_b32 v68, v88
    v_mov_b32 v69, v89
    v_mov_b32 v70, v90
    v_mov_b32 v71, v91
    v_add_u32 v44, 49152, v44
    v_add_u32 v45, 49152, v45
    v_add_u32 v46, 49152, v46
    v_add_u32 v47, 49152, v47
    v_add_u32 v48, 49152, v48
    v_add_u32 v49, 49152, v49
    v_fma_f32 v132, -v108, v108, v124
    v_fma_f32 v133, -v109, v109, v125
    v_fma_f32 v134, -v110, v110, v126
    v_fma_f32 v135, -v111, v111, v127
    v_max_f32 v132, v132, v56
    v_max_f32 v133, v133, v56
    v_max_f32 v134, v134, v56
    v_max_f32 v135, v135, v56
    v_rsq_f32 v132, v132
    v_rsq_f32 v133, v133
    v_rsq_f32 v134, v134
    v_rsq_f32 v135, v135
    s_add_u32 m0, s40, 4096
    s_nop 0
    buffer_load_dwordx4 v20, s[28:31], s57 offen offset:0 nt lds
    v_fma_f32 v104, -v108, v61, v104
    v_fma_f32 v105, -v109, v61, v105
    v_fma_f32 v106, -v110, v61, v106
    v_fma_f32 v107, -v111, v61, v107
    v_fma_f32 v104, v104, v132, v62
    v_fma_f32 v105, v105, v133, v62
    v_fma_f32 v106, v106, v134, v62
    v_fma_f32 v107, v107, v135, v62
    v_max3_f32 v1, v104, v105, v106
    v_max_f32 v1, v1, v107
    v_cmp_lt_f32 vcc, s52, v1
    s_cbranch_vccnz L_site3
L_back3:
    v_exp_f32 v112, v104
    v_exp_f32 v113, v105
    v_exp_f32 v114, v106
    v_exp_f32 v115, v107
    v_cvt_pk_bf16_f32 v72, v88, v89
    v_cvt_pk_bf16_f32 v73, v90, v91
    v_mul_f32 v104, v112, v132
    v_mul_f32 v105, v113, v133
    v_mul_f32 v106, v114, v134
    v_mul_f32 v107, v115, v135
    v_cvt_pk_bf16_f32 v74, v104, v105
    v_cvt_pk_bf16_f32 v75, v106, v107
    ds_write_b128 v237, v[72:75]
    s_waitcnt lgkmcnt(0)
    s_barrier
L_post24:
    ds_read_b32 v9, v254 offset:4096
    ds_read_b128 v[92:95], v253 offset:0
    ds_read_b128 v[96:99], v253 offset:1024
    ds_read_b128 v[100:103], v253 offset:2048
    ds_read_b128 v[116:119], v253 offset:3072
    s_waitcnt lgkmcnt(4)
    v_cmp_ne_u32 vcc, 0, v9
    s_cbranch_vccnz L_xt24
    s_waitcnt lgkmcnt(3)
    v_mfma_f32_16x16x32_bf16 a[0:3], a[144:147], v[92:95], a[0:3]
    buffer_load_dwordx4 v21, s[28:31], s57 offen offset:1024 nt lds
    v_add_f32 v68, v68, v104
    v_add_f32 v69, v69, v105
    v_mfma_f32_16x16x32_bf16 a[4:7], a[160:163], v[92:95], a[4:7]
    buffer_load_dword v244, v245, s[32:35], 0 offen offset:128 sc1
    v_add_f32 v70, v70, v106
    v_add_f32 v71, v71, v107
    v_mfma_f32_16x16x32_bf16 a[8:11], a[176:179], v[92:95], a[8:11]
    v_add_f32 v63, v63, v112
    v_fma_f32 v64, v104, v108, v64
    s_waitcnt lgkmcnt(2)
    v_mfma_f32_16x16x32_bf16 a[0:3], a[148:151], v[96:99], a[0:3]
    v_add_f32 v63, v63, v113
    v_fma_f32 v64, v105, v109, v64
    v_mfma_f32_16x16x32_bf16 a[4:7], a[164:167], v[96:99], a[4:7]
    v_add_f32 v63, v63, v114
    v_fma_f32 v64, v106, v110, v64
    v_mfma_f32_16x16x32_bf16 a[8:11], a[180:183], v[96:99], a[8:11]
    v_add_f32 v63, v63, v115
    v_fma_f32 v64, v107, v111, v64
    s_waitcnt lgkmcnt(1)
    v_mfma_f32_16x16x32_bf16 a[0:3], a[152:155], v[100:103], a[0:3]
    v_mfma_f32_16x16x32_bf16 a[4:7], a[168:171], v[100:103], a[4:7]
    v_mfma_f32_16x16x32_bf16 a[8:11], a[184:187], v[100:103], a[8:11]
    s_waitcnt lgkmcnt(0)
    v_mfma_f32_16x16x32_bf16 a[0:3], a[156:159], v[116:119], a[0:3]
    s_add_u32 m0, s41, 0
    s_add_u32 s58, s37, 98304
    buffer_load_dwordx4 v22, s[24:27], s58 offen offset:0 nt lds
    v_mfma_f32_16x16x32_bf16 a[4:7], a[172:175], v[116:119], a[4:7]
    v_mfma_f32_16x16x32_bf16 a[8:11], a[188:191], v[116:119], a[8:11]
    buffer_load_dwordx4 v23, s[24:27], s58 offen offset:1024 nt lds
    buffer_load_dwordx4 v24, s[24:27], s58 offen offset:2048 nt lds
    buffer_load_dwordx4 v25, s[24:27], s58 offen offset:3072 nt lds
    s_add_u32 m0, s41, 4096
    s_nop 0
    buffer_load_dwordx4 v26, s[24:27], s58 offen offset:0 nt lds
    s_waitcnt vmcnt(12)
    s_barrier
    ds_read_b128 a[96:99], v40 offset:49152
    ds_read_b128 a[100:103], v41 offset:49152
    ds_read_b128 a[104:107], v42 offset:49152
    ds_read_b128 a[108:111], v43 offset:49152
    ds_read_b128 a[112:115], v40 offset:49408
    ds_read_b128 a[116:119], v41 offset:49408
    ds_read_b128 a[120:123], v42 offset:49408
    ds_read_b128 a[124:127], v43 offset:49408
    ds_read_b128 a[128:131], v40 offset:49664
    ds_read_b128 a[132:135], v41 offset:49664
    ds_read_b128 a[136:139], v42 offset:49664
    ds_read_b128 a[140:143], v43 offset:49664
    s_waitcnt lgkmcnt(11)
    v_mfma_f32_16x16x32_bf16 v[96:99], a[96:99], a[96:99], v[84:87]
    ds_read_b64_tr_b16 a[144:145], v44 offset:0
    ds_read_b64_tr_b16 a[146:147], v45 offset:0
    v_mfma_f32_16x16x32_bf16 v[100:103], a[96:99], a[48:51], 0
    ds_read_b64_tr_b16 a[148:149], v44 offset:12288
    ds_read_b64_tr_b16 a[150:151], v45 offset:12288
    s_waitcnt lgkmcnt(14)
    v_mfma_f32_16x16x32_bf16 v[96:99], a[100:103], a[100:103], v[96:99]
    ds_read_b64_tr_b16 a[152:153], v44 offset:24576
    ds_read_b64_tr_b16 a[154:155], v45 offset:24576
    v_mfma_f32_16x16x32_bf16 v[100:103], a[100:103], a[52:55], v[100:103]
    ds_read_b64_tr_b16 a[156:157], v44 offset:36864
    ds_read_b64_tr_b16 a[158:159], v45 offset:36864
    s_waitcnt lgkmcnt(15)
    v_mfma_f32_16x16x32_bf16 v[96:99], a[104:107], a[104:107], v[96:99]
    ds_read_b64_tr_b16 a[160:161], v46 offset:0
    ds_read_b64_tr_b16 a[162:163], v47 offset:0
    v_mfma_f32_16x16x32_bf16 v[100:103], a[104:107], a[56:59], v[100:103]
    ds_read_b64_tr_b16 a[164:165], v46 offset:12288
    ds_read_b64_tr_b16 a[166:167], v47 offset:12288
    v_mfma_f32_16x16x32_bf16 v[96:99], a[108:111], a[108:111], v[96:99]
    buffer_load_dwordx4 v27, s[24:27], s58 offen offset:1024 nt lds
    ds_read_b64_tr_b16 a[168:169], v46 offset:24576
    ds_read_b64_tr_b16 a[170:171], v47 offset:24576
    v_mfma_f32_16x16x32_bf16 v[100:103], a[108:111], a[60:63], v[100:103]
    ds_read_b64_tr_b16 a[172:173], v46 offset:36864
    ds_read_b64_tr_b16 a[174:175], v47 offset:36864
    v_mfma_f32_16x16x32_bf16 v[96:99], a[112:115], a[112:115], v[96:99]
    ds_read_b64_tr_b16 a[176:177], v48 offset:0
    ds_read_b64_tr_b16 a[178:179], v49 offset:0
    v_mfma_f32_16x16x32_bf16 v[100:103], a[112:115], a[64:67], v[100:103]
    ds_read_b64_tr_b16 a[180:181], v48 offset:12288
    ds_read_b64_tr_b16 a[182:183], v49 offset:12288
    s_waitcnt lgkmcnt(15)
    v_mfma_f32_16x16x32_bf16 v[96:99], a[116:119], a[116:119], v[96:99]
    ds_read_b64_tr_b16 a[184:185], v48 offset:24576
    ds_read_b64_tr_b16 a[186:187], v49 offset:24576
    v_mfma_f32_16x16x32_bf16 v[100:103], a[116:119], a[68:71], v[100:103]
    ds_read_b64_tr_b16 a[188:189], v48 offset:36864
    ds_read_b64_tr_b16 a[190:191], v49 offset:36864
    v_mfma_f32_16x16x32_bf16 v[92:95], a[96:99], v[52:55], v[80:83]
    v_mfma_f32_16x16x32_bf16 v[92:95], a[100:103], v[52:55], v[92:95]
    v_mfma_f32_16x16x32_bf16 v[92:95], a[104:107], v[52:55], v[92:95]
    v_mfma_f32_16x16x32_bf16 v[92:95], a[108:111], v[52:55], v[92:95]
    s_nop 1
    v_fma_f32 v96, v100, 2.0, v96
    v_fma_f32 v97, v101, 2.0, v97
    v_mfma_f32_16x16x32_bf16 v[92:95], a[112:115], v[52:55], v[92:95]
    v_fma_f32 v98, v102, 2.0, v98
    v_fma_f32 v99, v103, 2.0, v99
    v_mfma_f32_16x16x32_bf16 v[92:95], a[116:119], v[52:55], v[92:95]
    v_cndmask_b32 v3, 0, v96, s[44:45]
    v_cndmask_b32 v3, v3, v97, s[46:47]
    v_mfma_f32_16x16x32_bf16 v[88:91], a[96:99], v[136:139], v[76:79]
    buffer_load_dwordx4 v28, s[24:27], s58 offen offset:2048 nt lds
    v_cndmask_b32 v3, v3, v98, s[48:49]
    v_cndmask_b32 v3, v3, v99, s[50:51]
    v_mfma_f32_16x16x32_bf16 v[88:91], a[100:103], v[140:143], v[88:91]
    s_nop 0
    s_nop 0
    v_mfma_f32_16x16x32_bf16 v[88:91], a[104:107], v[144:147], v[88:91]
    v_mfma_f32_16x16x4_f32 v[120:123], v3, v60, v[56:59]
    v_mfma_f32_16x16x32_bf16 v[88:91], a[108:111], v[148:151], v[88:91]
    v_mfma_f32_16x16x32_bf16 v[88:91], a[112:115], v[152:155], v[88:91]
    v_mfma_f32_16x16x32_bf16 v[88:91], a[116:119], v[156:159], v[88:91]
    v_mfma_f32_16x16x32_bf16 v[112:115], a[120:123], a[120:123], v[84:87]
    v_mfma_f32_16x16x32_bf16 v[116:119], a[120:123], a[48:51], 0
    v_mfma_f32_16x16x32_bf16 v[112:115], a[124:127], a[124:127], v[112:115]
    v_mfma_f32_16x16x32_bf16 v[116:119], a[124:127], a[52:55], v[116:119]
    s_nop 2
    v_fma_f32 v128, -v92, v92, v120
    v_fma_f32 v129, -v93, v93, v121
    v_mfma_f32_16x16x32_bf16 v[112:115], a[128:131], a[128:131], v[112:115]
    v_fma_f32 v130, -v94, v94, v122
    v_fma_f32 v131, -v95, v95, v123
    v_mfma_f32_16x16x32_bf16 v[116:119], a[128:131], a[56:59], v[116:119]
    buffer_load_dwordx4 v29, s[24:27], s58 offen offset:3072 nt lds
    v_max_f32 v128, v128, v56
    v_max_f32 v129, v129, v56
    v_mfma_f32_16x16x32_bf16 v[112:115], a[132:135], a[132:135], v[112:115]
    v_max_f32 v130, v130, v56
    v_max_f32 v131, v131, v56
    v_mfma_f32_16x16x32_bf16 v[116:119], a[132:135], a[60:63], v[116:119]
    v_rsq_f32 v128, v128
    v_mfma_f32_16x16x32_bf16 v[112:115], a[136:139], a[136:139], v[112:115]
    v_rsq_f32 v129, v129
    v_mfma_f32_16x16x32_bf16 v[116:119], a[136:139], a[64:67], v[116:119]
    v_rsq_f32 v130, v130
    v_mfma_f32_16x16x32_bf16 v[112:115], a[140:143], a[140:143], v[112:115]
    v_rsq_f32 v131, v131
    v_mfma_f32_16x16x32_bf16 v[116:119], a[140:143], a[68:71], v[116:119]
    v_fma_f32 v88, -v92, v61, v88
    v_fma_f32 v89, -v93, v61, v89
    v_mfma_f32_16x16x32_bf16 v[108:111], a[120:123], v[52:55], v[80:83]
    v_fma_f32 v90, -v94, v61, v90
    v_fma_f32 v91, -v95, v61, v91
    v_mfma_f32_16x16x32_bf16 v[108:111], a[124:127], v[52:55], v[108:111]
    v_fma_f32 v88, v88, v128, v62
    v_fma_f32 v89, v89, v129, v62
    v_mfma_f32_16x16x32_bf16 v[108:111], a[128:131], v[52:55], v[108:111]
    v_fma_f32 v90, v90, v130, v62
    v_fma_f32 v91, v91, v131, v62
    v_mfma_f32_16x16x32_bf16 v[108:111], a[132:135], v[52:55], v[108:111]
    v_max3_f32 v1, v88, v89, v90
    v_max_f32 v1, v1, v91
    v_mfma_f32_16x16x32_bf16 v[108:111], a[136:139], v[52:55], v[108:111]
    v_cmp_lt_f32 vcc, s52, v1
    s_cbranch_vccnz L_site4
L_back4:
    v_mfma_f32_16x16x32_bf16 v[108:111], a[140:143], v[52:55], v[108:111]
    v_exp_f32 v96, v88
    v_mfma_f32_16x16x32_bf16 v[104:107], a[120:123], v[136:139], v[76:79]
    s_add_u32 m0, s41, 8192
    s_nop 0
    buffer_load_dwordx4 v30, s[24:27], s58 offen offset:0 nt lds
    v_exp_f32 v97, v89
    v_mfma_f32_16x16x32_bf16 v[104:107], a[124:127], v[140:143], v[104:107]
    v_exp_f32 v98, v90
    v_mfma_f32_16x16x32_bf16 v[104:107], a[128:131], v[144:147], v[104:107]
    v_exp_f32 v99, v91
    v_mfma_f32_16x16x32_bf16 v[104:107], a[132:135], v[148:151], v[104:107]
    v_mul_f32 v88, v96, v128
    v_mul_f32 v89, v97, v129
    v_mfma_f32_16x16x32_bf16 v[104:107], a[136:139], v[152:155], v[104:107]
    v_mul_f32 v90, v98, v130
    v_mul_f32 v91, v99, v131
    v_mfma_f32_16x16x32_bf16 v[104:107], a[140:143], v[156:159], v[104:107]
    v_fma_f32 v112, v116, 2.0, v112
    v_fma_f32 v113, v117, 2.0, v113
    v_fma_f32 v114, v118, 2.0, v114
    v_fma_f32 v115, v119, 2.0, v115
    v_cndmask_b32 v4, 0, v112, s[44:45]
    v_cndmask_b32 v4, v4, v113, s[46:47]
    v_cndmask_b32 v4, v4, v114, s[48:49]
    v_cndmask_b32 v4, v4, v115, s[50:51]
    v_add_f32 v63, v63, v96
    v_fmac_f32 v64, v88, v92
    v_mfma_f32_16x16x4_f32 v[124:127], v4, v60, v[56:59]
    v_add_f32 v63, v63, v97
    v_fmac_f32 v64, v89, v93
    v_add_f32 v63, v63, v98
    v_fmac_f32 v64, v90, v94
    v_add_f32 v63, v63, v99
    v_fmac_f32 v64, v91, v95
    v_add_f32 v68, v68, v88
    v_add_f32 v69, v69, v89
    v_add_f32 v70, v70, v90
    v_add_f32 v71, v71, v91
    v_add_u32 v44, -49152, v44
    v_add_u32 v45, -49152, v45
    v_add_u32 v46, -49152, v46
    v_add_u32 v47, -49152, v47
    v_add_u32 v48, -49152, v48
    v_add_u32 v49, -49152, v49
    v_fma_f32 v132, -v108, v108, v124
    v_fma_f32 v133, -v109, v109, v125
    v_fma_f32 v134, -v110, v110, v126
    v_fma_f32 v135, -v111, v111, v127
    v_max_f32 v132, v132, v56
    v_max_f32 v133, v133, v56
    v_max_f32 v134, v134, v56
    v_max_f32 v135, v135, v56
    v_rsq_f32 v132, v132
    v_rsq_f32 v133, v133
    v_rsq_f32 v134, v134
    v_rsq_f32 v135, v135
    buffer_load_dwordx4 v31, s[24:27], s58 offen offset:1024 nt lds
    v_fma_f32 v104, -v108, v61, v104
    v_fma_f32 v105, -v109, v61, v105
    v_fma_f32 v106, -v110, v61, v106
    v_fma_f32 v107, -v111, v61, v107
    v_fma_f32 v104, v104, v132, v62
    v_fma_f32 v105, v105, v133, v62
    v_fma_f32 v106, v106, v134, v62
    v_fma_f32 v107, v107, v135, v62
    v_max3_f32 v1, v104, v105, v106
    v_max_f32 v1, v1, v107
    v_cmp_lt_f32 vcc, s52, v1
    s_cbranch_vccnz L_site5
L_back5:
    v_exp_f32 v112, v104
    v_exp_f32 v113, v105
    v_exp_f32 v114, v106
    v_exp_f32 v115, v107
    v_cvt_pk_bf16_f32 v72, v88, v89
    v_cvt_pk_bf16_f32 v73, v90, v91
    v_mul_f32 v104, v112, v132
    v_mul_f32 v105, v113, v133
    v_mul_f32 v106, v114, v134
    v_mul_f32 v107, v115, v135
    v_cvt_pk_bf16_f32 v74, v104, v105
    v_cvt_pk_bf16_f32 v75, v106, v107
    ds_write_b128 v237, v[72:75]
    v_add_f32 v68, v68, v104
    v_add_f32 v69, v69, v105
    v_add_f32 v70, v70, v106
    v_add_f32 v71, v71, v107
    v_cvt_pk_bf16_f32 v66, v68, v69
    v_cvt_pk_bf16_f32 v67, v70, v71
    ds_write_b64 v238, v[66:67]
    buffer_load_dwordx4 v32, s[24:27], s58 offen offset:2048 nt lds
    buffer_load_dwordx4 v33, s[24:27], s58 offen offset:3072 nt lds
    s_waitcnt vmcnt(13)
    s_waitcnt vmcnt(12)
    v_cmp_ne_u32 vcc, s39, v244
    s_cbranch_vccnz L_fl_retry
L_fl_ok:
    s_waitcnt lgkmcnt(0)
    s_barrier
L_post6:
    ds_read_b32 v9, v254 offset:4096
    ds_read_b64 v[120:121], v254 offset:0
    ds_read_b64 v[122:123], v254 offset:512
    ds_read_b64 v[124:125], v254 offset:1024
    ds_read_b64 v[126:127], v254 offset:1536
    ds_read_b128 v[92:95], v253 offset:0
    ds_read_b128 v[96:99], v253 offset:1024
    ds_read_b128 v[100:103], v253 offset:2048
    ds_read_b128 v[116:119], v253 offset:3072
    ds_read_b128 a[48:51], v34 offset:0
    ds_read_b128 a[52:55], v35 offset:0
    ds_read_b128 a[56:59], v34 offset:128
    ds_read_b128 a[60:63], v35 offset:128
    ds_read_b128 a[64:67], v34 offset:256
    ds_read_b128 a[68:71], v35 offset:256
    s_waitcnt lgkmcnt(14)
    v_cmp_ne_u32 vcc, 0, v9
    s_cbranch_vccnz L_xt6
    s_waitcnt lgkmcnt(12)
    v_mfma_f32_16x16x32_bf16 a[0:3], a[72:75], v[120:123], a[0:3]
    s_add_u32 m0, s42, 0
    s_add_u32 s59, s37, 294912
    buffer_load_dwordx4 v22, s[24:27], s59 offen offset:0 nt lds
    v_add_f32 v63, v63, v112
    v_fma_f32 v64, v104, v108, v64
    v_mfma_f32_16x16x32_bf16 a[4:7], a[80:83], v[120:123], a[4:7]
    v_add_f32 v63, v63, v113
    v_fma_f32 v64, v105, v109, v64
    v_mfma_f32_16x16x32_bf16 a[8:11], a[88:91], v[120:123], a[8:11]
    v_add_f32 v63, v63, v114
    v_fma_f32 v64, v106, v110, v64
    s_waitcnt lgkmcnt(10)
    v_mfma_f32_16x16x32_bf16 a[0:3], a[76:79], v[124:127], a[0:3]
    v_add_f32 v63, v63, v115
    v_fma_f32 v64, v107, v111, v64
    v_mfma_f32_16x16x32_bf16 a[4:7], a[84:87], v[124:127], a[4:7]
    v_mfma_f32_16x16x32_bf16 a[8:11], a[92:95], v[124:127], a[8:11]
    s_waitcnt lgkmcnt(9)
    v_mfma_f32_16x16x32_bf16 a[0:3], a[144:147], v[92:95], a[0:3]
    ds_read_b64_tr_b16 a[72:73], v36 offset:0
    ds_read_b64_tr_b16 a[74:75], v36 offset:6144
    v_mfma_f32_16x16x32_bf16 a[4:7], a[160:163], v[92:95], a[4:7]
    ds_read_b64_tr_b16 a[76:77], v36 offset:12288
    ds_read_b64_tr_b16 a[78:79], v36 offset:18432
    v_mfma_f32_16x16x32_bf16 a[8:11], a[176:179], v[92:95], a[8:11]
    ds_read_b64_tr_b16 a[80:81], v37 offset:0
    ds_read_b64_tr_b16 a[82:83], v37 offset:6144
    s_waitcnt lgkmcnt(14)
    v_mfma_f32_16x16x32_bf16 a[0:3], a[148:151], v[96:99], a[0:3]
    buffer_load_dwordx4 v23, s[24:27], s59 offen offset:1024 nt lds
    ds_read_b64_tr_b16 a[84:85], v37 offset:12288
    ds_read_b64_tr_b16 a[86:87], v37 offset:18432
    v_mfma_f32_16x16x32_bf16 a[4:7], a[164:167], v[96:99], a[4:7]
    ds_read_b64_tr_b16 a[88:89], v38 offset:0
    ds_read_b64_tr_b16 a[90:91], v38 offset:6144
    v_mfma_f32_16x16x32_bf16 a[8:11], a[180:183], v[96:99], a[8:11]
    ds_read_b64_tr_b16 a[92:93], v38 offset:12288
    ds_read_b64_tr_b16 a[94:95], v38 offset:18432
    s_waitcnt lgkmcnt(15)
    v_mfma_f32_16x16x32_bf16 a[0:3], a[152:155], v[100:103], a[0:3]
    v_mfma_f32_16x16x32_bf16 a[4:7], a[168:171], v[100:103], a[4:7]
    v_mfma_f32_16x16x32_bf16 a[8:11], a[184:187], v[100:103], a[8:11]
    v_mfma_f32_16x16x32_bf16 a[0:3], a[156:159], v[116:119], a[0:3]
    v_mfma_f32_16x16x32_bf16 a[4:7], a[172:175], v[116:119], a[4:7]
    v_mfma_f32_16x16x32_bf16 a[8:11], a[188:191], v[116:119], a[8:11]
    v_mfma_f32_16x16x32_bf16 v[84:87], a[48:51], a[48:51], 0
    v_mfma_f32_16x16x32_bf16 v[80:83], a[48:51], v[52:55], 0
    v_mfma_f32_16x16x32_bf16 v[84:87], a[52:55], a[52:55], v[84:87]
    v_mfma_f32_16x16x32_bf16 v[80:83], a[52:55], v[52:55], v[80:83]
    v_mfma_f32_16x16x32_bf16 v[84:87], a[56:59], a[56:59], v[84:87]
    s_add_u32 s61, s60, 3145728
    buffer_load_dwordx4 v[160:163], v65, s[72:75], s61 offen offset:0 sc1
    v_mfma_f32_16x16x32_bf16 v[80:83], a[56:59], v[52:55], v[80:83]
    s_waitcnt lgkmcnt(14)
    v_mfma_f32_16x16x32_bf16 v[84:87], a[60:63], a[60:63], v[84:87]
    v_mfma_f32_16x16x32_bf16 v[80:83], a[60:63], v[52:55], v[80:83]
    s_waitcnt lgkmcnt(13)
    v_mfma_f32_16x16x32_bf16 v[84:87], a[64:67], a[64:67], v[84:87]
    v_mfma_f32_16x16x32_bf16 v[80:83], a[64:67], v[52:55], v[80:83]
    s_waitcnt lgkmcnt(12)
    v_mfma_f32_16x16x32_bf16 v[84:87], a[68:71], a[68:71], v[84:87]
    v_mfma_f32_16x16x32_bf16 v[80:83], a[68:71], v[52:55], v[80:83]
    s_waitcnt lgkmcnt(0)
    v_mfma_f32_16x16x32_bf16 v[76:79], a[48:51], v[136:139], 0
    v_mfma_f32_16x16x32_bf16 v[76:79], a[52:55], v[140:143], v[76:79]
    v_mfma_f32_16x16x32_bf16 v[76:79], a[56:59], v[144:147], v[76:79]
    v_mfma_f32_16x16x32_bf16 v[76:79], a[60:63], v[148:151], v[76:79]
    v_mfma_f32_16x16x32_bf16 v[76:79], a[64:67], v[152:155], v[76:79]
    v_mfma_f32_16x16x32_bf16 v[76:79], a[68:71], v[156:159], v[76:79]
    buffer_load_dwordx4 v24, s[24:27], s59 offen offset:2048 nt lds
    buffer_load_dwordx4 v25, s[24:27], s59 offen offset:3072 nt lds
    s_add_u32 m0, s42, 4096
    s_nop 0
    buffer_load_dwordx4 v26, s[24:27], s59 offen offset:0 nt lds
    buffer_load_dwordx4 v27, s[24:27], s59 offen offset:1024 nt lds
    buffer_load_dwordx4 v[164:167], v65, s[72:75], s61 offen offset:1024 sc1
    buffer_load_dwordx4 v28, s[24:27], s59 offen offset:2048 nt lds
    buffer_load_dwordx4 v29, s[24:27], s59 offen offset:3072 nt lds
    s_add_u32 m0, s42, 8192
    s_nop 0
    buffer_load_dwordx4 v30, s[24:27], s59 offen offset:0 nt lds
    buffer_load_dwordx4 v31, s[24:27], s59 offen offset:1024 nt lds
    s_waitcnt vmcnt(12)
    s_barrier
    ds_read_b128 a[96:99], v40 offset:0
    ds_read_b128 a[100:103], v41 offset:0
    ds_read_b128 a[104:107], v42 offset:0
    ds_read_b128 a[108:111], v43 offset:0
    ds_read_b128 a[112:115], v40 offset:256
    ds_read_b128 a[116:119], v41 offset:256
    ds_read_b128 a[120:123], v42 offset:256
    ds_read_b128 a[124:127], v43 offset:256
    ds_read_b128 a[128:131], v40 offset:512
    ds_read_b128 a[132:135], v41 offset:512
    ds_read_b128 a[136:139], v42 offset:512
    ds_read_b128 a[140:143], v43 offset:512
    s_waitcnt lgkmcnt(11)
    v_mfma_f32_16x16x32_bf16 v[96:99], a[96:99], a[96:99], v[84:87]
    ds_read_b64_tr_b16 a[144:145], v44 offset:0
    ds_read_b64_tr_b16 a[146:147], v45 offset:0
    v_mfma_f32_16x16x32_bf16 v[100:103], a[96:99], a[48:51], 0
    ds_read_b64_tr_b16 a[148:149], v44 offset:12288
    ds_read_b64_tr_b16 a[150:151], v45 offset:12288
    s_waitcnt lgkmcnt(14)
    v_mfma_f32_16x16x32_bf16 v[96:99], a[100:103], a[100:103], v[96:99]
    ds_read_b64_tr_b16 a[152:153], v44 offset:24576
    ds_read_b64_tr_b16 a[154:155], v45 offset:24576
    v_mfma_f32_16x16x32_bf16 v[100:103], a[100:103], a[52:55], v[100:103]
    ds_read_b64_tr_b16 a[156:157], v44 offset:36864
    ds_read_b64_tr_b16 a[158:159], v45 offset:36864
    s_waitcnt lgkmcnt(15)
    v_mfma_f32_16x16x32_bf16 v[96:99], a[104:107], a[104:107], v[96:99]
    ds_read_b64_tr_b16 a[160:161], v46 offset:0
    ds_read_b64_tr_b16 a[162:163], v47 offset:0
    v_mfma_f32_16x16x32_bf16 v[100:103], a[104:107], a[56:59], v[100:103]
    ds_read_b64_tr_b16 a[164:165], v46 offset:12288
    ds_read_b64_tr_b16 a[166:167], v47 offset:12288
    v_mfma_f32_16x16x32_bf16 v[96:99], a[108:111], a[108:111], v[96:99]
    buffer_load_dwordx4 v[168:171], v65, s[72:75], s61 offen offset:2048 sc1
    ds_read_b64_tr_b16 a[168:169], v46 offset:24576
    ds_read_b64_tr_b16 a[170:171], v47 offset:24576
    v_mfma_f32_16x16x32_bf16 v[100:103], a[108:111], a[60:63], v[100:103]
    ds_read_b64_tr_b16 a[172:173], v46 offset:36864
    ds_read_b64_tr_b16 a[174:175], v47 offset:36864
    v_mfma_f32_16x16x32_bf16 v[96:99], a[112:115], a[112:115], v[96:99]
    ds_read_b64_tr_b16 a[176:177], v48 offset:0
    ds_read_b64_tr_b16 a[178:179], v49 offset:0
    v_mfma_f32_16x16x32_bf16 v[100:103], a[112:115], a[64:67], v[100:103]
    ds_read_b64_tr_b16 a[180:181], v48 offset:12288
    ds_read_b64_tr_b16 a[182:183], v49 offset:12288
    s_waitcnt lgkmcnt(15)
    v_mfma_f32_16x16x32_bf16 v[96:99], a[116:119], a[116:119], v[96:99]
    ds_read_b64_tr_b16 a[184:185], v48 offset:24576
    ds_read_b64_tr_b16 a[186:187], v49 offset:24576
    v_mfma_f32_16x16x32_bf16 v[100:103], a[116:119], a[68:71], v[100:103]
    ds_read_b64_tr_b16 a[188:189], v48 offset:36864
    ds_read_b64_tr_b16 a[190:191], v49 offset:36864
    v_mfma_f32_16x16x32_bf16 v[92:95], a[96:99], v[52:55], v[80:83]
    v_mfma_f32_16x16x32_bf16 v[92:95], a[100:103], v[52:55], v[92:95]
    v_mfma_f32_16x16x32_bf16 v[92:95], a[104:107], v[52:55], v[92:95]
    v_mfma_f32_16x16x32_bf16 v[92:95], a[108:111], v[52:55], v[92:95]
    s_nop 1
    v_fma_f32 v96, v100, 2.0, v96
    v_fma_f32 v97, v101, 2.0, v97
    v_mfma_f32_16x16x32_bf16 v[92:95], a[112:115], v[52:55], v[92:95]
    v_fma_f32 v98, v102, 2.0, v98
    v_fma_f32 v99, v103, 2.0, v99
    v_mfma_f32_16x16x32_bf16 v[92:95], a[116:119], v[52:55], v[92:95]
    v_cndmask_b32 v3, 0, v96, s[44:45]
    v_cndmask_b32 v3, v3, v97, s[46:47]
    v_mfma_f32_16x16x32_bf16 v[88:91], a[96:99], v[136:139], v[76:79]
    buffer_load_dwordx4 v32, s[24:27], s59 offen offset:2048 nt lds
    v_cndmask_b32 v3, v3, v98, s[48:49]
    v_cndmask_b32 v3, v3, v99, s[50:51]
    v_mfma_f32_16x16x32_bf16 v[88:91], a[100:103], v[140:143], v[88:91]
    buffer_load_dwordx4 v33, s[24:27], s59 offen offset:3072 nt lds
    s_nop 0
    s_nop 0
    v_mfma_f32_16x16x32_bf16 v[88:91], a[104:107], v[144:147], v[88:91]
    v_mfma_f32_16x16x4_f32 v[120:123], v3, v60, v[56:59]
    v_mfma_f32_16x16x32_bf16 v[88:91], a[108:111], v[148:151], v[88:91]
    v_mfma_f32_16x16x32_bf16 v[88:91], a[112:115], v[152:155], v[88:91]
    v_mfma_f32_16x16x32_bf16 v[88:91], a[116:119], v[156:159], v[88:91]
    v_mfma_f32_16x16x32_bf16 v[112:115], a[120:123], a[120:123], v[84:87]
    v_mfma_f32_16x16x32_bf16 v[116:119], a[120:123], a[48:51], 0
    v_mfma_f32_16x16x32_bf16 v[112:115], a[124:127], a[124:127], v[112:115]
    v_mfma_f32_16x16x32_bf16 v[116:119], a[124:127], a[52:55], v[116:119]
    s_nop 2
    v_fma_f32 v128, -v92, v92, v120
    v_fma_f32 v129, -v93, v93, v121
    v_mfma_f32_16x16x32_bf16 v[112:115], a[128:131], a[128:131], v[112:115]
    s_add_u32 m0, s40, 0
    s_add_u32 s57, s36, 73728
    buffer_load_dwordx4 v16, s[28:31], s57 offen offset:0 nt lds
    v_fma_f32 v130, -v94, v94, v122
    v_fma_f32 v131, -v95, v95, v123
    v_mfma_f32_16x16x32_bf16 v[116:119], a[128:131], a[56:59], v[116:119]
    v_max_f32 v128, v128, v56
    v_max_f32 v129, v129, v56
    v_mfma_f32_16x16x32_bf16 v[112:115], a[132:135], a[132:135], v[112:115]
    v_max_f32 v130, v130, v56
    v_max_f32 v131, v131, v56
    v_mfma_f32_16x16x32_bf16 v[116:119], a[132:135], a[60:63], v[116:119]
    v_rsq_f32 v128, v128
    v_mfma_f32_16x16x32_bf16 v[112:115], a[136:139], a[136:139], v[112:115]
    v_rsq_f32 v129, v129
    v_mfma_f32_16x16x32_bf16 v[116:119], a[136:139], a[64:67], v[116:119]
    v_rsq_f32 v130, v130
    v_mfma_f32_16x16x32_bf16 v[112:115], a[140:143], a[140:143], v[112:115]
    v_rsq_f32 v131, v131
    v_mfma_f32_16x16x32_bf16 v[116:119], a[140:143], a[68:71], v[116:119]
    v_fma_f32 v88, -v92, v61, v88
    v_fma_f32 v89, -v93, v61, v89
    v_mfma_f32_16x16x32_bf16 v[108:111], a[120:123], v[52:55], v[80:83]
    v_fma_f32 v90, -v94, v61, v90
    v_fma_f32 v91, -v95, v61, v91
    v_mfma_f32_16x16x32_bf16 v[108:111], a[124:127], v[52:55], v[108:111]
    v_fma_f32 v88, v88, v128, v62
    v_fma_f32 v89, v89, v129, v62
    v_mfma_f32_16x16x32_bf16 v[108:111], a[128:131], v[52:55], v[108:111]
    v_fma_f32 v90, v90, v130, v62
    v_fma_f32 v91, v91, v131, v62
    v_mfma_f32_16x16x32_bf16 v[108:111], a[132:135], v[52:55], v[108:111]
    v_max3_f32 v1, v88, v89, v90
    v_max_f32 v1, v1, v91
    v_mfma_f32_16x16x32_bf16 v[108:111], a[136:139], v[52:55], v[108:111]
    buffer_load_dwordx4 v17, s[28:31], s57 offen offset:1024 nt lds
    v_cmp_lt_f32 vcc, s52, v1
    s_cbranch_vccnz L_site6
L_back6:
    v_mfma_f32_16x16x32_bf16 v[108:111], a[140:143], v[52:55], v[108:111]
    v_exp_f32 v96, v88
    v_mfma_f32_16x16x32_bf16 v[104:107], a[120:123], v[136:139], v[76:79]
    v_exp_f32 v97, v89
    v_mfma_f32_16x16x32_bf16 v[104:107], a[124:127], v[140:143], v[104:107]
    v_exp_f32 v98, v90
    v_mfma_f32_16x16x32_bf16 v[104:107], a[128:131], v[144:147], v[104:107]
    v_exp_f32 v99, v91
    v_mfma_f32_16x16x32_bf16 v[104:107], a[132:135], v[148:151], v[104:107]
    v_mul_f32 v88, v96, v128
    v_mul_f32 v89, v97, v129
    v_mfma_f32_16x16x32_bf16 v[104:107], a[136:139], v[152:155], v[104:107]
    v_mul_f32 v90, v98, v130
    v_mul_f32 v91, v99, v131
    v_mfma_f32_16x16x32_bf16 v[104:107], a[140:143], v[156:159], v[104:107]
    v_fma_f32 v112, v116, 2.0, v112
    v_fma_f32 v113, v117, 2.0, v113
    v_fma_f32 v114, v118, 2.0, v114
    v_fma_f32 v115, v119, 2.0, v115
    v_cndmask_b32 v4, 0, v112, s[44:45]
    v_cndmask_b32 v4, v4, v113, s[46:47]
    v_cndmask_b32 v4, v4, v114, s[48:49]
    v_cndmask_b32 v4, v4, v115, s[50:51]
    v_add_f32 v63, v63, v96
    v_fmac_f32 v64, v88, v92
    v_mfma_f32_16x16x4_f32 v[124:127], v4, v60, v[56:59]
    v_add_f32 v63, v63, v97
    v_fmac_f32 v64, v89, v93
    v_add_f32 v63, v63, v98
    v_fmac_f32 v64, v90, v94
    v_add_f32 v63, v63, v99
    v_fmac_f32 v64, v91, v95
    v_mov_b32 v68, v88
    v_mov_b32 v69, v89
    v_mov_b32 v70, v90
    v_mov_b32 v71, v91
    v_add_u32 v44, 49152, v44
    v_add_u32 v45, 49152, v45
    v_add_u32 v46, 49152, v46
    v_add_u32 v47, 49152, v47
    v_add_u32 v48, 49152, v48
    v_add_u32 v49, 49152, v49
    v_fma_f32 v132, -v108, v108, v124
    v_fma_f32 v133, -v109, v109, v125
    v_fma_f32 v134, -v110, v110, v126
    v_fma_f32 v135, -v111, v111, v127
    v_max_f32 v132, v132, v56
    v_max_f32 v133, v133, v56
    v_max_f32 v134, v134, v56
    v_max_f32 v135, v135, v56
    v_rsq_f32 v132, v132
    v_rsq_f32 v133, v133
    v_rsq_f32 v134, v134
    v_rsq_f32 v135, v135
    buffer_load_dwordx4 v[172:175], v65, s[72:75], s61 offen offset:3072 sc1
    v_fma_f32 v104, -v108, v61, v104
    v_fma_f32 v105, -v109, v61, v105
    v_fma_f32 v106, -v110, v61, v106
    v_fma_f32 v107, -v111, v61, v107
    v_fma_f32 v104, v104, v132, v62
    v_fma_f32 v105, v105, v133, v62
    v_fma_f32 v106, v106, v134, v62
    v_fma_f32 v107, v107, v135, v62
    v_max3_f32 v1, v104, v105, v106
    v_max_f32 v1, v1, v107
    v_cmp_lt_f32 vcc, s52, v1
    s_cbranch_vccnz L_site7
L_back7:
    v_exp_f32 v112, v104
    v_exp_f32 v113, v105
    v_exp_f32 v114, v106
    v_exp_f32 v115, v107
    v_cvt_pk_bf16_f32 v72, v88, v89
    v_cvt_pk_bf16_f32 v73, v90, v91
    v_mul_f32 v104, v112, v132
    v_mul_f32 v105, v113, v133
    v_mul_f32 v106, v114, v134
    v_mul_f32 v107, v115, v135
    v_cvt_pk_bf16_f32 v74, v104, v105
    v_cvt_pk_bf16_f32 v75, v106, v107
    ds_write_b128 v237, v[72:75]
    s_waitcnt lgkmcnt(0)
    s_barrier
L_post27:
    ds_read_b32 v9, v254 offset:4096
    ds_read_b128 v[92:95], v253 offset:0
    ds_read_b128 v[96:99], v253 offset:1024
    ds_read_b128 v[100:103], v253 offset:2048
    ds_read_b128 v[116:119], v253 offset:3072
    s_waitcnt lgkmcnt(4)
    v_cmp_ne_u32 vcc, 0, v9
    s_cbranch_vccnz L_xt27
    s_waitcnt lgkmcnt(3)
    v_mfma_f32_16x16x32_bf16 a[0:3], a[144:147], v[92:95], a[0:3]
    buffer_load_dwordx4 v18, s[28:31], s57 offen offset:2048 nt lds
    v_add_f32 v68, v68, v104
    v_add_f32 v69, v69, v105
    v_mfma_f32_16x16x32_bf16 a[4:7], a[160:163], v[92:95], a[4:7]
    buffer_load_dwordx4 v19, s[28:31], s57 offen offset:3072 nt lds
    v_add_f32 v70, v70, v106
    v_add_f32 v71, v71, v107
    v_mfma_f32_16x16x32_bf16 a[8:11], a[176:179], v[92:95], a[8:11]
    s_add_u32 m0, s40, 4096
    s_nop 0
    buffer_load_dwordx4 v20, s[28:31], s57 offen offset:0 nt lds
    v_add_f32 v63, v63, v112
    v_fma_f32 v64, v104, v108, v64
    s_waitcnt lgkmcnt(2)
    v_mfma_f32_16x16x32_bf16 a[0:3], a[148:151], v[96:99], a[0:3]
    v_add_f32 v63, v63, v113
    v_fma_f32 v64, v105, v109, v64
    v_mfma_f32_16x16x32_bf16 a[4:7], a[164:167], v[96:99], a[4:7]
    v_add_f32 v63, v63, v114
    v_fma_f32 v64, v106, v110, v64
    v_mfma_f32_16x16x32_bf16 a[8:11], a[180:183], v[96:99], a[8:11]
    v_add_f32 v63, v63, v115
    v_fma_f32 v64, v107, v111, v64
    s_waitcnt lgkmcnt(1)
    v_mfma_f32_16x16x32_bf16 a[0:3], a[152:155], v[100:103], a[0:3]
    s_add_u32 s61, s60, 3149824
    buffer_load_dwordx4 v[176:179], v65, s[72:75], s61 offen offset:0 sc1
    v_mfma_f32_16x16x32_bf16 a[4:7], a[168:171], v[100:103], a[4:7]
    v_mfma_f32_16x16x32_bf16 a[8:11], a[184:187], v[100:103], a[8:11]
    s_waitcnt lgkmcnt(0)
    v_mfma_f32_16x16x32_bf16 a[0:3], a[156:159], v[116:119], a[0:3]
    v_mfma_f32_16x16x32_bf16 a[4:7], a[172:175], v[116:119], a[4:7]
    v_mfma_f32_16x16x32_bf16 a[8:11], a[188:191], v[116:119], a[8:11]
    buffer_load_dwordx4 v21, s[28:31], s57 offen offset:1024 nt lds
    s_movk_i32 s56, 384
    v_add_u32 v1, 0, v0
    v_mul_u32_u24 v1, 2731, v1
    v_lshrrev_b32 v1, 16, v1
    v_mad_u32_u24 v16, v1, s56, v16
    v_add_u32 v1, 64, v0
    v_mul_u32_u24 v1, 2731, v1
    v_lshrrev_b32 v1, 16, v1
    v_mad_u32_u24 v17, v1, s56, v17
    v_add_u32 v1, 128, v0
    v_mul_u32_u24 v1, 2731, v1
    v_lshrrev_b32 v1, 16, v1
    v_mad_u32_u24 v18, v1, s56, v18
    v_add_u32 v1, 192, v0
    v_mul_u32_u24 v1, 2731, v1
    v_lshrrev_b32 v1, 16, v1
    v_mad_u32_u24 v19, v1, s56, v19
    v_add_u32 v1, 256, v0
    v_mul_u32_u24 v1, 2731, v1
    v_lshrrev_b32 v1, 16, v1
    v_mad_u32_u24 v20, v1, s56, v20
    v_add_u32 v1, 320, v0
    v_mul_u32_u24 v1, 2731, v1
    v_lshrrev_b32 v1, 16, v1
    v_mad_u32_u24 v21, v1, s56, v21
    s_add_u32 m0, s41, 0
    s_add_u32 s58, s37, 147456
    buffer_load_dwordx4 v22, s[24:27], s58 offen offset:0 nt lds
    buffer_load_dwordx4 v23, s[24:27], s58 offen offset:1024 nt lds
    buffer_load_dwordx4 v24, s[24:27], s58 offen offset:2048 nt lds
    buffer_load_dwordx4 v[180:183], v65, s[72:75], s61 offen offset:1024 sc1
    s_waitcnt vmcnt(12)
    s_barrier
    ds_read_b128 a[96:99], v40 offset:49152
    ds_read_b128 a[100:103], v41 offset:49152
    ds_read_b128 a[104:107], v42 offset:49152
    ds_read_b128 a[108:111], v43 offset:49152
    ds_read_b128 a[112:115], v40 offset:49408
    ds_read_b128 a[116:119], v41 offset:49408
    ds_read_b128 a[120:123], v42 offset:49408
    ds_read_b128 a[124:127], v43 offset:49408
    ds_read_b128 a[128:131], v40 offset:49664
    ds_read_b128 a[132:135], v41 offset:49664
    ds_read_b128 a[136:139], v42 offset:49664
    ds_read_b128 a[140:143], v43 offset:49664
    s_waitcnt lgkmcnt(11)
    v_mfma_f32_16x16x32_bf16 v[96:99], a[96:99], a[96:99], v[84:87]
    ds_read_b64_tr_b16 a[144:145], v44 offset:0
    ds_read_b64_tr_b16 a[146:147], v45 offset:0
    v_mfma_f32_16x16x32_bf16 v[100:103], a[96:99], a[48:51], 0
    ds_read_b64_tr_b16 a[148:149], v44 offset:12288
    ds_read_b64_tr_b16 a[150:151], v45 offset:12288
    s_waitcnt lgkmcnt(14)
    v_mfma_f32_16x16x32_bf16 v[96:99], a[100:103], a[100:103], v[96:99]
    ds_read_b64_tr_b16 a[152:153], v44 offset:24576
    ds_read_b64_tr_b16 a[154:155], v45 offset:24576
    v_mfma_f32_16x16x32_bf16 v[100:103], a[100:103], a[52:55], v[100:103]
    ds_read_b64_tr_b16 a[156:157], v44 offset:36864
    ds_read_b64_tr_b16 a[158:159], v45 offset:36864
    s_waitcnt lgkmcnt(15)
    v_mfma_f32_16x16x32_bf16 v[96:99], a[104:107], a[104:107], v[96:99]
    ds_read_b64_tr_b16 a[160:161], v46 offset:0
    ds_read_b64_tr_b16 a[162:163], v47 offset:0
    v_mfma_f32_16x16x32_bf16 v[100:103], a[104:107], a[56:59], v[100:103]
    ds_read_b64_tr_b16 a[164:165], v46 offset:12288
    ds_read_b64_tr_b16 a[166:167], v47 offset:12288
    v_mfma_f32_16x16x32_bf16 v[96:99], a[108:111], a[108:111], v[96:99]
    buffer_load_dwordx4 v25, s[24:27], s58 offen offset:3072 nt lds
    ds_read_b64_tr_b16 a[168:169], v46 offset:24576
    ds_read_b64_tr_b16 a[170:171], v47 offset:24576
    v_mfma_f32_16x16x32_bf16 v[100:103], a[108:111], a[60:63], v[100:103]
    ds_read_b64_tr_b16 a[172:173], v46 offset:36864
    ds_read_b64_tr_b16 a[174:175], v47 offset:36864
    v_mfma_f32_16x16x32_bf16 v[96:99], a[112:115], a[112:115], v[96:99]
    ds_read_b64_tr_b16 a[176:177], v48 offset:0
    ds_read_b64_tr_b16 a[178:179], v49 offset:0
    v_mfma_f32_16x16x32_bf16 v[100:103], a[112:115], a[64:67], v[100:103]
    ds_read_b64_tr_b16 a[180:181], v48 offset:12288
    ds_read_b64_tr_b16 a[182:183], v49 offset:12288
    s_waitcnt lgkmcnt(15)
    v_mfma_f32_16x16x32_bf16 v[96:99], a[116:119], a[116:119], v[96:99]
    ds_read_b64_tr_b16 a[184:185], v48 offset:24576
    ds_read_b64_tr_b16 a[186:187], v49 offset:24576
    v_mfma_f32_16x16x32_bf16 v[100:103], a[116:119], a[68:71], v[100:103]
    ds_read_b64_tr_b16 a[188:189], v48 offset:36864
    ds_read_b64_tr_b16 a[190:191], v49 offset:36864
    v_mfma_f32_16x16x32_bf16 v[92:95], a[96:99], v[52:55], v[80:83]
    v_mfma_f32_16x16x32_bf16 v[92:95], a[100:103], v[52:55], v[92:95]
    v_mfma_f32_16x16x32_bf16 v[92:95], a[104:107], v[52:55], v[92:95]
    v_mfma_f32_16x16x32_bf16 v[92:95], a[108:111], v[52:55], v[92:95]
    s_nop 1
    v_fma_f32 v96, v100, 2.0, v96
    v_fma_f32 v97, v101, 2.0, v97
    v_mfma_f32_16x16x32_bf16 v[92:95], a[112:115], v[52:55], v[92:95]
    v_fma_f32 v98, v102, 2.0, v98
    v_fma_f32 v99, v103, 2.0, v99
    v_mfma_f32_16x16x32_bf16 v[92:95], a[116:119], v[52:55], v[92:95]
    v_cndmask_b32 v3, 0, v96, s[44:45]
    v_cndmask_b32 v3, v3, v97, s[46:47]
    v_mfma_f32_16x16x32_bf16 v[88:91], a[96:99], v[136:139], v[76:79]
    s_add_u32 m0, s41, 4096
    s_nop 0
    buffer_load_dwordx4 v26, s[24:27], s58 offen offset:0 nt lds
    v_cndmask_b32 v3, v3, v98, s[48:49]
    v_cndmask_b32 v3, v3, v99, s[50:51]
    v_mfma_f32_16x16x32_bf16 v[88:91], a[100:103], v[140:143], v[88:91]
    buffer_load_dwordx4 v27, s[24:27], s58 offen offset:1024 nt lds
    s_nop 0
    s_nop 0
    v_mfma_f32_16x16x32_bf16 v[88:91], a[104:107], v[144:147], v[88:91]
    v_mfma_f32_16x16x4_f32 v[120:123], v3, v60, v[56:59]
    v_mfma_f32_16x16x32_bf16 v[88:91], a[108:111], v[148:151], v[88:91]
    v_mfma_f32_16x16x32_bf16 v[88:91], a[112:115], v[152:155], v[88:91]
    v_mfma_f32_16x16x32_bf16 v[88:91], a[116:119], v[156:159], v[88:91]
    v_mfma_f32_16x16x32_bf16 v[112:115], a[120:123], a[120:123], v[84:87]
    v_mfma_f32_16x16x32_bf16 v[116:119], a[120:123], a[48:51], 0
    v_mfma_f32_16x16x32_bf16 v[112:115], a[124:127], a[124:127], v[112:115]
    v_mfma_f32_16x16x32_bf16 v[116:119], a[124:127], a[52:55], v[116:119]
    s_nop 2
    v_fma_f32 v128, -v92, v92, v120
    v_fma_f32 v129, -v93, v93, v121
    v_mfma_f32_16x16x32_bf16 v[112:115], a[128:131], a[128:131], v[112:115]
    buffer_load_dwordx4 v28, s[24:27], s58 offen offset:2048 nt lds
    v_fma_f32 v130, -v94, v94, v122
    v_fma_f32 v131, -v95, v95, v123
    v_mfma_f32_16x16x32_bf16 v[116:119], a[128:131], a[56:59], v[116:119]
    v_max_f32 v128, v128, v56
    v_max_f32 v129, v129, v56
    v_mfma_f32_16x16x32_bf16 v[112:115], a[132:135], a[132:135], v[112:115]
    v_max_f32 v130, v130, v56
    v_max_f32 v131, v131, v56
    v_mfma_f32_16x16x32_bf16 v[116:119], a[132:135], a[60:63], v[116:119]
    v_rsq_f32 v128, v128
    v_mfma_f32_16x16x32_bf16 v[112:115], a[136:139], a[136:139], v[112:115]
    v_rsq_f32 v129, v129
    v_mfma_f32_16x16x32_bf16 v[116:119], a[136:139], a[64:67], v[116:119]
    v_rsq_f32 v130, v130
    v_mfma_f32_16x16x32_bf16 v[112:115], a[140:143], a[140:143], v[112:115]
    v_rsq_f32 v131, v131
    v_mfma_f32_16x16x32_bf16 v[116:119], a[140:143], a[68:71], v[116:119]
    v_fma_f32 v88, -v92, v61, v88
    v_fma_f32 v89, -v93, v61, v89
    v_mfma_f32_16x16x32_bf16 v[108:111], a[120:123], v[52:55], v[80:83]
    v_fma_f32 v90, -v94, v61, v90
    v_fma_f32 v91, -v95, v61, v91
    v_mfma_f32_16x16x32_bf16 v[108:111], a[124:127], v[52:55], v[108:111]
    v_fma_f32 v88, v88, v128, v62
    v_fma_f32 v89, v89, v129, v62
    v_mfma_f32_16x16x32_bf16 v[108:111], a[128:131], v[52:55], v[108:111]
    v_fma_f32 v90, v90, v130, v62
    v_fma_f32 v91, v91, v131, v62
    v_mfma_f32_16x16x32_bf16 v[108:111], a[132:135], v[52:55], v[108:111]
    v_max3_f32 v1, v88, v89, v90
    v_max_f32 v1, v1, v91
    v_mfma_f32_16x16x32_bf16 v[108:111], a[136:139], v[52:55], v[108:111]
    buffer_load_dwordx4 v[184:187], v65, s[72:75], s61 offen offset:2048 sc1
    v_cmp_lt_f32 vcc, s52, v1
    s_cbranch_vccnz L_site8
L_back8:
    v_mfma_f32_16x16x32_bf16 v[108:111], a[140:143], v[52:55], v[108:111]
    v_exp_f32 v96, v88
    v_mfma_f32_16x16x32_bf16 v[104:107], a[120:123], v[136:139], v[76:79]
    v_exp_f32 v97, v89
    v_mfma_f32_16x16x32_bf16 v[104:107], a[124:127], v[140:143], v[104:107]
    v_exp_f32 v98, v90
    v_mfma_f32_16x16x32_bf16 v[104:107], a[128:131], v[144:147], v[104:107]
    v_exp_f32 v99, v91
    v_mfma_f32_16x16x32_bf16 v[104:107], a[132:135], v[148:151], v[104:107]
    v_mul_f32 v88, v96, v128
    v_mul_f32 v89, v97, v129
    v_mfma_f32_16x16x32_bf16 v[104:107], a[136:139], v[152:155], v[104:107]
    v_mul_f32 v90, v98, v130
    v_mul_f32 v91, v99, v131
    v_mfma_f32_16x16x32_bf16 v[104:107], a[140:143], v[156:159], v[104:107]
    v_fma_f32 v112, v116, 2.0, v112
    v_fma_f32 v113, v117, 2.0, v113
    v_fma_f32 v114, v118, 2.0, v114
    v_fma_f32 v115, v119, 2.0, v115
    v_cndmask_b32 v4, 0, v112, s[44:45]
    v_cndmask_b32 v4, v4, v113, s[46:47]
    v_cndmask_b32 v4, v4, v114, s[48:49]
    v_cndmask_b32 v4, v4, v115, s[50:51]
    v_add_f32 v63, v63, v96
    v_fmac_f32 v64, v88, v92
    v_mfma_f32_16x16x4_f32 v[124:127], v4, v60, v[56:59]
    v_add_f32 v63, v63, v97
    v_fmac_f32 v64, v89, v93
    v_add_f32 v63, v63, v98
    v_fmac_f32 v64, v90, v94
    v_add_f32 v63, v63, v99
    v_fmac_f32 v64, v91, v95
    v_add_f32 v68, v68, v88
    v_add_f32 v69, v69, v89
    v_add_f32 v70, v70, v90
    v_add_f32 v71, v71, v91
    v_add_u32 v44, -49152, v44
    v_add_u32 v45, -49152, v45
    v_add_u32 v46, -49152, v46
    v_add_u32 v47, -49152, v47
    v_add_u32 v48, -49152, v48
    v_add_u32 v49, -49152, v49
    v_fma_f32 v132, -v108, v108, v124
    v_fma_f32 v133, -v109, v109, v125
    v_fma_f32 v134, -v110, v110, v126
    v_fma_f32 v135, -v111, v111, v127
    v_max_f32 v132, v132, v56
    v_max_f32 v133, v133, v56
    v_max_f32 v134, v134, v56
    v_max_f32 v135, v135, v56
    v_rsq_f32 v132, v132
    v_rsq_f32 v133, v133
    v_rsq_f32 v134, v134
    v_rsq_f32 v135, v135
    buffer_load_dwordx4 v29, s[24:27], s58 offen offset:3072 nt lds
    v_fma_f32 v104, -v108, v61, v104
    v_fma_f32 v105, -v109, v61, v105
    v_fma_f32 v106, -v110, v61, v106
    v_fma_f32 v107, -v111, v61, v107
    v_fma_f32 v104, v104, v132, v62
    v_fma_f32 v105, v105, v133, v62
    v_fma_f32 v106, v106, v134, v62
    v_fma_f32 v107, v107, v135, v62
    v_max3_f32 v1, v104, v105, v106
    v_max_f32 v1, v1, v107
    v_cmp_lt_f32 vcc, s52, v1
    s_cbranch_vccnz L_site9
L_back9:
    s_add_u32 m0, s41, 8192
    s_nop 0
    buffer_load_dwordx4 v30, s[24:27], s58 offen offset:0 nt lds
    v_exp_f32 v112, v104
    v_exp_f32 v113, v105
    v_exp_f32 v114, v106
    v_exp_f32 v115, v107
    v_cvt_pk_bf16_f32 v72, v88, v89
    v_cvt_pk_bf16_f32 v73, v90, v91
    v_mul_f32 v104, v112, v132
    v_mul_f32 v105, v113, v133
    v_mul_f32 v106, v114, v134
    v_mul_f32 v107, v115, v135
    v_cvt_pk_bf16_f32 v74, v104, v105
    v_cvt_pk_bf16_f32 v75, v106, v107
    ds_write_b128 v237, v[72:75]
    v_add_f32 v68, v68, v104
    v_add_f32 v69, v69, v105
    v_add_f32 v70, v70, v106
    v_add_f32 v71, v71, v107
    v_cvt_pk_bf16_f32 v66, v68, v69
    v_cvt_pk_bf16_f32 v67, v70, v71
    ds_write_b64 v238, v[66:67]
    s_lshl_b32 s56, s3, 13
    v_lshl_add_u32 v233, v0, 7, s56
    v_min_u32 v233, L_end - L_tail, v233
    v_add_u32 v233, L_tail - L_pc_main, v233
    global_load_dword v234, v233, s[100:101]
    s_waitcnt vmcnt(12)
    s_waitcnt lgkmcnt(0)
    s_barrier
L_post9:
    ds_read_b32 v9, v254 offset:4096
    ds_read_b64 v[120:121], v254 offset:0
    ds_read_b64 v[122:123], v254 offset:512
    ds_read_b64 v[124:125], v254 offset:1024
    ds_read_b64 v[126:127], v254 offset:1536
    ds_read_b128 v[92:95], v253 offset:0
    ds_read_b128 v[96:99], v253 offset:1024
    ds_read_b128 v[100:103], v253 offset:2048
    ds_read_b128 v[116:119], v253 offset:3072
    ds_read_b128 a[48:51], v34 offset:0
    ds_read_b128 a[52:55], v35 offset:0
    ds_read_b128 a[56:59], v34 offset:128
    ds_read_b128 a[60:63], v35 offset:128
    ds_read_b128 a[64:67], v34 offset:256
    ds_read_b128 a[68:71], v35 offset:256
    s_waitcnt lgkmcnt(14)
    v_cmp_ne_u32 vcc, 0, v9
    s_cbranch_vccnz L_xt9
    s_waitcnt lgkmcnt(12)
    v_mfma_f32_16x16x32_bf16 a[0:3], a[72:75], v[120:123], a[0:3]
    buffer_load_dwordx4 v31, s[24:27], s58 offen offset:1024 nt lds
    v_add_f32 v63, v63, v112
    v_fma_f32 v64, v104, v108, v64
    v_mfma_f32_16x16x32_bf16 a[4:7], a[80:83], v[120:123], a[4:7]
    v_add_f32 v63, v63, v113
    v_fma_f32 v64, v105, v109, v64
    v_mfma_f32_16x16x32_bf16 a[8:11], a[88:91], v[120:123], a[8:11]
    v_add_f32 v63, v63, v114
    v_fma_f32 v64, v106, v110, v64
    s_waitcnt lgkmcnt(10)
    v_mfma_f32_16x16x32_bf16 a[0:3], a[76:79], v[124:127], a[0:3]
    v_add_f32 v63, v63, v115
    v_fma_f32 v64, v107, v111, v64
    v_mfma_f32_16x16x32_bf16 a[4:7], a[84:87], v[124:127], a[4:7]
    v_mfma_f32_16x16x32_bf16 a[8:11], a[92:95], v[124:127], a[8:11]
    s_waitcnt lgkmcnt(9)
    v_mfma_f32_16x16x32_bf16 a[0:3], a[144:147], v[92:95], a[0:3]
    ds_read_b64_tr_b16 a[72:73], v36 offset:0
    ds_read_b64_tr_b16 a[74:75], v36 offset:6144
    v_mfma_f32_16x16x32_bf16 a[4:7], a[160:163], v[92:95], a[4:7]
    ds_read_b64_tr_b16 a[76:77], v36 offset:12288
    ds_read_b64_tr_b16 a[78:79], v36 offset:18432
    v_mfma_f32_16x16x32_bf16 a[8:11], a[176:179], v[92:95], a[8:11]
    buffer_load_dwordx4 v32, s[24:27], s58 offen offset:2048 nt lds
    ds_read_b64_tr_b16 a[80:81], v37 offset:0
    ds_read_b64_tr_b16 a[82:83], v37 offset:6144
    s_waitcnt lgkmcnt(14)
    v_mfma_f32_16x16x32_bf16 a[0:3], a[148:151], v[96:99], a[0:3]
    ds_read_b64_tr_b16 a[84:85], v37 offset:12288
    ds_read_b64_tr_b16 a[86:87], v37 offset:18432
    v_mfma_f32_16x16x32_bf16 a[4:7], a[164:167], v[96:99], a[4:7]
    ds_read_b64_tr_b16 a[88:89], v38 offset:0
    ds_read_b64_tr_b16 a[90:91], v38 offset:6144
    v_mfma_f32_16x16x32_bf16 a[8:11], a[180:183], v[96:99], a[8:11]
    ds_read_b64_tr_b16 a[92:93], v38 offset:12288
    ds_read_b64_tr_b16 a[94:95], v38 offset:18432
    s_waitcnt lgkmcnt(15)
    v_mfma_f32_16x16x32_bf16 a[0:3], a[152:155], v[100:103], a[0:3]
    v_mfma_f32_16x16x32_bf16 a[4:7], a[168:171], v[100:103], a[4:7]
    v_mfma_f32_16x16x32_bf16 a[8:11], a[184:187], v[100:103], a[8:11]
    v_mfma_f32_16x16x32_bf16 a[0:3], a[156:159], v[116:119], a[0:3]
    v_mfma_f32_16x16x32_bf16 a[4:7], a[172:175], v[116:119], a[4:7]
    v_mfma_f32_16x16x32_bf16 a[8:11], a[188:191], v[116:119], a[8:11]
    v_mfma_f32_16x16x32_bf16 v[84:87], a[48:51], a[48:51], 0
    v_mfma_f32_16x16x32_bf16 v[80:83], a[48:51], v[52:55], 0
    v_mfma_f32_16x16x32_bf16 v[84:87], a[52:55], a[52:55], v[84:87]
    buffer_load_dwordx4 v[188:191], v65, s[72:75], s61 offen offset:3072 sc1
    v_mfma_f32_16x16x32_bf16 v[80:83], a[52:55], v[52:55], v[80:83]
    buffer_load_dwordx4 v33, s[24:27], s58 offen offset:3072 nt lds
    v_mfma_f32_16x16x32_bf16 v[84:87], a[56:59], a[56:59], v[84:87]
    v_mfma_f32_16x16x32_bf16 v[80:83], a[56:59], v[52:55], v[80:83]
    s_waitcnt lgkmcnt(14)
    v_mfma_f32_16x16x32_bf16 v[84:87], a[60:63], a[60:63], v[84:87]
    v_mfma_f32_16x16x32_bf16 v[80:83], a[60:63], v[52:55], v[80:83]
    s_waitcnt lgkmcnt(13)
    v_mfma_f32_16x16x32_bf16 v[84:87], a[64:67], a[64:67], v[84:87]
    v_mfma_f32_16x16x32_bf16 v[80:83], a[64:67], v[52:55], v[80:83]
    s_waitcnt lgkmcnt(12)
    v_mfma_f32_16x16x32_bf16 v[84:87], a[68:71], a[68:71], v[84:87]
    v_mfma_f32_16x16x32_bf16 v[80:83], a[68:71], v[52:55], v[80:83]
    s_waitcnt lgkmcnt(0)
    v_mfma_f32_16x16x32_bf16 v[76:79], a[48:51], v[136:139], 0
    v_mfma_f32_16x16x32_bf16 v[76:79], a[52:55], v[140:143], v[76:79]
    v_mfma_f32_16x16x32_bf16 v[76:79], a[56:59], v[144:147], v[76:79]
    v_mfma_f32_16x16x32_bf16 v[76:79], a[60:63], v[148:151], v[76:79]
    v_mfma_f32_16x16x32_bf16 v[76:79], a[64:67], v[152:155], v[76:79]
    s_add_u32 m0, s42, 0
    s_add_u32 s59, s37, 344064
    buffer_load_dwordx4 v16, s[24:27], s59 offen offset:0 nt lds
    v_mfma_f32_16x16x32_bf16 v[76:79], a[68:71], v[156:159], v[76:79]
    buffer_load_dwordx4 v17, s[24:27], s59 offen offset:1024 nt lds
    buffer_load_dwordx4 v18, s[24:27], s59 offen offset:2048 nt lds
    buffer_load_dwordx4 v19, s[24:27], s59 offen offset:3072 nt lds
    s_add_u32 m0, s42, 4096
    s_nop 0
    buffer_load_dwordx4 v20, s[24:27], s59 offen offset:0 nt lds
    buffer_load_dwordx4 v21, s[24:27], s59 offen offset:1024 nt lds
    s_add_u32 m0, s42, 6144
    s_add_u32 s59, s37, 344448
    buffer_load_dwordx4 v16, s[24:27], s59 offen offset:0 nt lds
    buffer_load_dwordx4 v17, s[24:27], s59 offen offset:1024 nt lds
    buffer_load_dwordx4 v18, s[24:27], s59 offen offset:2048 nt lds
    buffer_load_dwordx4 v19, s[24:27], s59 offen offset:3072 nt lds
    s_add_u32 m0, s42, 10240
    s_nop 0
    buffer_load_dwordx4 v20, s[24:27], s59 offen offset:0 nt lds
    buffer_load_dwordx4 v21, s[24:27], s59 offen offset:1024 nt lds
    s_waitcnt vmcnt(12)
    s_barrier
    ds_read_b128 a[96:99], v40 offset:0
    ds_read_b128 a[100:103], v41 offset:0
    ds_read_b128 a[104:107], v42 offset:0
    ds_read_b128 a[108:111], v43 offset:0
    ds_read_b128 a[112:115], v40 offset:256
    ds_read_b128 a[116:119], v41 offset:256
    ds_read_b128 a[120:123], v42 offset:256
    ds_read_b128 a[124:127], v43 offset:256
    ds_read_b128 a[128:131], v40 offset:512
    ds_read_b128 a[132:135], v41 offset:512
    ds_read_b128 a[136:139], v42 offset:512
    ds_read_b128 a[140:143], v43 offset:512
    s_waitcnt lgkmcnt(11)
    v_mfma_f32_16x16x32_bf16 v[96:99], a[96:99], a[96:99], v[84:87]
    ds_read_b64_tr_b16 a[144:145], v44 offset:0
    ds_read_b64_tr_b16 a[146:147], v45 offset:0
    v_mfma_f32_16x16x32_bf16 v[100:103], a[96:99], a[48:51], 0
    ds_read_b64_tr_b16 a[148:149], v44 offset:12288
    ds_read_b64_tr_b16 a[150:151], v45 offset:12288
    s_waitcnt lgkmcnt(14)
    v_mfma_f32_16x16x32_bf16 v[96:99], a[100:103], a[100:103], v[96:99]
    ds_read_b64_tr_b16 a[152:153], v44 offset:24576
    ds_read_b64_tr_b16 a[154:155], v45 offset:24576
    v_mfma_f32_16x16x32_bf16 v[100:103], a[100:103], a[52:55], v[100:103]
    ds_read_b64_tr_b16 a[156:157], v44 offset:36864
    ds_read_b64_tr_b16 a[158:159], v45 offset:36864
    s_waitcnt lgkmcnt(15)
    v_mfma_f32_16x16x32_bf16 v[96:99], a[104:107], a[104:107], v[96:99]
    ds_read_b64_tr_b16 a[160:161], v46 offset:0
    ds_read_b64_tr_b16 a[162:163], v47 offset:0
    v_mfma_f32_16x16x32_bf16 v[100:103], a[104:107], a[56:59], v[100:103]
    ds_read_b64_tr_b16 a[164:165], v46 offset:12288
    ds_read_b64_tr_b16 a[166:167], v47 offset:12288
    v_mfma_f32_16x16x32_bf16 v[96:99], a[108:111], a[108:111], v[96:99]
    s_add_u32 s61, s60, 3153920
    buffer_load_dwordx4 v[192:195], v65, s[32:35], s61 offen offset:0 sc1
    ds_read_b64_tr_b16 a[168:169], v46 offset:24576
    ds_read_b64_tr_b16 a[170:171], v47 offset:24576
    v_mfma_f32_16x16x32_bf16 v[100:103], a[108:111], a[60:63], v[100:103]
    ds_read_b64_tr_b16 a[172:173], v46 offset:36864
    ds_read_b64_tr_b16 a[174:175], v47 offset:36864
    v_mfma_f32_16x16x32_bf16 v[96:99], a[112:115], a[112:115], v[96:99]
    ds_read_b64_tr_b16 a[176:177], v48 offset:0
    ds_read_b64_tr_b16 a[178:179], v49 offset:0
    v_mfma_f32_16x16x32_bf16 v[100:103], a[112:115], a[64:67], v[100:103]
    ds_read_b64_tr_b16 a[180:181], v48 offset:12288
    ds_read_b64_tr_b16 a[182:183], v49 offset:12288
    s_waitcnt lgkmcnt(15)
    v_mfma_f32_16x16x32_bf16 v[96:99], a[116:119], a[116:119], v[96:99]
    ds_read_b64_tr_b16 a[184:185], v48 offset:24576
    ds_read_b64_tr_b16 a[186:187], v49 offset:24576
    v_mfma_f32_16x16x32_bf16 v[100:103], a[116:119], a[68:71], v[100:103]
    ds_read_b64_tr_b16 a[188:189], v48 offset:36864
    ds_read_b64_tr_b16 a[190:191], v49 offset:36864
    v_mfma_f32_16x16x32_bf16 v[92:95], a[96:99], v[52:55], v[80:83]
    v_mfma_f32_16x16x32_bf16 v[92:95], a[100:103], v[52:55], v[92:95]
    v_mfma_f32_16x16x32_bf16 v[92:95], a[104:107], v[52:55], v[92:95]
    v_mfma_f32_16x16x32_bf16 v[92:95], a[108:111], v[52:55], v[92:95]
    s_nop 1
    v_fma_f32 v96, v100, 2.0, v96
    v_fma_f32 v97, v101, 2.0, v97
    v_mfma_f32_16x16x32_bf16 v[92:95], a[112:115], v[52:55], v[92:95]
    v_fma_f32 v98, v102, 2.0, v98
    v_fma_f32 v99, v103, 2.0, v99
    v_mfma_f32_16x16x32_bf16 v[92:95], a[116:119], v[52:55], v[92:95]
    v_cndmask_b32 v3, 0, v96, s[44:45]
    v_cndmask_b32 v3, v3, v97, s[46:47]
    v_mfma_f32_16x16x32_bf16 v[88:91], a[96:99], v[136:139], v[76:79]
    buffer_load_dwordx4 v[196:199], v65, s[32:35], s61 offen offset:1024 sc1
    v_cndmask_b32 v3, v3, v98, s[48:49]
    v_cndmask_b32 v3, v3, v99, s[50:51]
    v_mfma_f32_16x16x32_bf16 v[88:91], a[100:103], v[140:143], v[88:91]
    s_nop 0
    s_nop 0
    v_mfma_f32_16x16x32_bf16 v[88:91], a[104:107], v[144:147], v[88:91]
    v_mfma_f32_16x16x4_f32 v[120:123], v3, v60, v[56:59]
    v_mfma_f32_16x16x32_bf16 v[88:91], a[108:111], v[148:151], v[88:91]
    v_mfma_f32_16x16x32_bf16 v[88:91], a[112:115], v[152:155], v[88:91]
    v_mfma_f32_16x16x32_bf16 v[88:91], a[116:119], v[156:159], v[88:91]
    v_mfma_f32_16x16x32_bf16 v[112:115], a[120:123], a[120:123], v[84:87]
    v_mfma_f32_16x16x32_bf16 v[116:119], a[120:123], a[48:51], 0
    v_mfma_f32_16x16x32_bf16 v[112:115], a[124:127], a[124:127], v[112:115]
    v_mfma_f32_16x16x32_bf16 v[116:119], a[124:127], a[52:55], v[116:119]
    s_nop 2
    v_fma_f32 v128, -v92, v92, v120
    v_fma_f32 v129, -v93, v93, v121
    v_mfma_f32_16x16x32_bf16 v[112:115], a[128:131], a[128:131], v[112:115]
    v_fma_f32 v130, -v94, v94, v122
    v_fma_f32 v131, -v95, v95, v123
    v_mfma_f32_16x16x32_bf16 v[116:119], a[128:131], a[56:59], v[116:119]
    buffer_load_dwordx4 v[200:203], v65, s[32:35], s61 offen offset:2048 sc1
    v_max_f32 v128, v128, v56
    v_max_f32 v129, v129, v56
    v_mfma_f32_16x16x32_bf16 v[112:115], a[132:135], a[132:135], v[112:115]
    v_max_f32 v130, v130, v56
    v_max_f32 v131, v131, v56
    v_mfma_f32_16x16x32_bf16 v[116:119], a[132:135], a[60:63], v[116:119]
    v_rsq_f32 v128, v128
    v_mfma_f32_16x16x32_bf16 v[112:115], a[136:139], a[136:139], v[112:115]
    v_rsq_f32 v129, v129
    v_mfma_f32_16x16x32_bf16 v[116:119], a[136:139], a[64:67], v[116:119]
    v_rsq_f32 v130, v130
    v_mfma_f32_16x16x32_bf16 v[112:115], a[140:143], a[140:143], v[112:115]
    v_rsq_f32 v131, v131
    v_mfma_f32_16x16x32_bf16 v[116:119], a[140:143], a[68:71], v[116:119]
    v_fma_f32 v88, -v92, v61, v88
    v_fma_f32 v89, -v93, v61, v89
    v_mfma_f32_16x16x32_bf16 v[108:111], a[120:123], v[52:55], v[80:83]
    v_fma_f32 v90, -v94, v61, v90
    v_fma_f32 v91, -v95, v61, v91
    v_mfma_f32_16x16x32_bf16 v[108:111], a[124:127], v[52:55], v[108:111]
    v_fma_f32 v88, v88, v128, v62
    v_fma_f32 v89, v89, v129, v62
    v_mfma_f32_16x16x32_bf16 v[108:111], a[128:131], v[52:55], v[108:111]
    v_fma_f32 v90, v90, v130, v62
    v_fma_f32 v91, v91, v131, v62
    v_mfma_f32_16x16x32_bf16 v[108:111], a[132:135], v[52:55], v[108:111]
    v_max3_f32 v1, v88, v89, v90
    v_max_f32 v1, v1, v91
    v_mfma_f32_16x16x32_bf16 v[108:111], a[136:139], v[52:55], v[108:111]
    v_cmp_lt_f32 vcc, s52, v1
    s_cbranch_vccnz L_site10
L_back10:
    v_mfma_f32_16x16x32_bf16 v[108:111], a[140:143], v[52:55], v[108:111]
    v_exp_f32 v96, v88
    v_mfma_f32_16x16x32_bf16 v[104:107], a[120:123], v[136:139], v[76:79]
    buffer_load_dwordx4 v[204:207], v65, s[32:35], s61 offen offset:3072 sc1
    v_exp_f32 v97, v89
    v_mfma_f32_16x16x32_bf16 v[104:107], a[124:127], v[140:143], v[104:107]
    v_exp_f32 v98, v90
    v_mfma_f32_16x16x32_bf16 v[104:107], a[128:131], v[144:147], v[104:107]
    v_exp_f32 v99, v91
    v_mfma_f32_16x16x32_bf16 v[104:107], a[132:135], v[148:151], v[104:107]
    v_mul_f32 v88, v96, v128
    v_mul_f32 v89, v97, v129
    v_mfma_f32_16x16x32_bf16 v[104:107], a[136:139], v[152:155], v[104:107]
    v_mul_f32 v90, v98, v130
    v_mul_f32 v91, v99, v131
    v_mfma_f32_16x16x32_bf16 v[104:107], a[140:143], v[156:159], v[104:107]
    v_fma_f32 v112, v116, 2.0, v112
    v_fma_f32 v113, v117, 2.0, v113
    v_fma_f32 v114, v118, 2.0, v114
    v_fma_f32 v115, v119, 2.0, v115
    v_cndmask_b32 v4, 0, v112, s[44:45]
    v_cndmask_b32 v4, v4, v113, s[46:47]
    v_cndmask_b32 v4, v4, v114, s[48:49]
    v_cndmask_b32 v4, v4, v115, s[50:51]
    v_add_f32 v63, v63, v96
    v_fmac_f32 v64, v88, v92
    v_mfma_f32_16x16x4_f32 v[124:127], v4, v60, v[56:59]
    v_add_f32 v63, v63, v97
    v_fmac_f32 v64, v89, v93
    v_add_f32 v63, v63, v98
    v_fmac_f32 v64, v90, v94
    v_add_f32 v63, v63, v99
    v_fmac_f32 v64, v91, v95
    v_mov_b32 v68, v88
    v_mov_b32 v69, v89
    v_mov_b32 v70, v90
    v_mov_b32 v71, v91
    v_fma_f32 v132, -v108, v108, v124
    v_fma_f32 v133, -v109, v109, v125
    v_fma_f32 v134, -v110, v110, v126
    v_fma_f32 v135, -v111, v111, v127
    v_max_f32 v132, v132, v56
    v_max_f32 v133, v133, v56
    v_max_f32 v134, v134, v56
    v_max_f32 v135, v135, v56
    v_rsq_f32 v132, v132
    v_rsq_f32 v133, v133
    v_rsq_f32 v134, v134
    v_rsq_f32 v135, v135
    s_add_u32 s61, s60, 3158016
    buffer_load_dwordx4 v[208:211], v65, s[32:35], s61 offen offset:0 sc1
    v_fma_f32 v104, -v108, v61, v104
    v_fma_f32 v105, -v109, v61, v105
    v_fma_f32 v106, -v110, v61, v106
    v_fma_f32 v107, -v111, v61, v107
    v_fma_f32 v104, v104, v132, v62
    v_fma_f32 v105, v105, v133, v62
    v_fma_f32 v106, v106, v134, v62
    v_fma_f32 v107, v107, v135, v62
    v_max3_f32 v1, v104, v105, v106
    v_max_f32 v1, v1, v107
    v_cmp_lt_f32 vcc, s52, v1
    s_cbranch_vccnz L_site11
L_back11:
    v_exp_f32 v112, v104
    v_exp_f32 v113, v105
    v_exp_f32 v114, v106
    v_exp_f32 v115, v107
    v_cvt_pk_bf16_f32 v72, v88, v89
    v_cvt_pk_bf16_f32 v73, v90, v91
    v_mul_f32 v104, v112, v132
    v_mul_f32 v105, v113, v133
    v_mul_f32 v106, v114, v134
    v_mul_f32 v107, v115, v135
    v_cvt_pk_bf16_f32 v74, v104, v105
    v_cvt_pk_bf16_f32 v75, v106, v107
    ds_write_b128 v237, v[72:75]
    s_waitcnt lgkmcnt(0)
    s_barrier
L_post30:
    ds_read_b32 v9, v254 offset:4096
    ds_read_b128 v[92:95], v253 offset:0
    ds_read_b128 v[96:99], v253 offset:1024
    ds_read_b128 v[100:103], v253 offset:2048
    ds_read_b128 v[116:119], v253 offset:3072
    s_waitcnt lgkmcnt(4)
    v_cmp_ne_u32 vcc, 0, v9
    s_cbranch_vccnz L_xt30
    s_waitcnt lgkmcnt(3)
    v_mfma_f32_16x16x32_bf16 a[0:3], a[144:147], v[92:95], a[0:3]
    buffer_load_dwordx4 v[212:215], v65, s[32:35], s61 offen offset:1024 sc1
    v_add_f32 v68, v68, v104
    v_add_f32 v69, v69, v105
    v_mfma_f32_16x16x32_bf16 a[4:7], a[160:163], v[92:95], a[4:7]
    buffer_load_dwordx4 v[216:219], v65, s[32:35], s61 offen offset:2048 sc1
    v_add_f32 v70, v70, v106
    v_add_f32 v71, v71, v107
    v_mfma_f32_16x16x32_bf16 a[8:11], a[176:179], v[92:95], a[8:11]
    v_add_f32 v63, v63, v112
    v_fma_f32 v64, v104, v108, v64
    s_waitcnt lgkmcnt(2)
    v_mfma_f32_16x16x32_bf16 a[0:3], a[148:151], v[96:99], a[0:3]
    v_add_f32 v63, v63, v113
    v_fma_f32 v64, v105, v109, v64
    v_mfma_f32_16x16x32_bf16 a[4:7], a[164:167], v[96:99], a[4:7]
    v_add_f32 v63, v63, v114
    v_fma_f32 v64, v106, v110, v64
    v_mfma_f32_16x16x32_bf16 a[8:11], a[180:183], v[96:99], a[8:11]
    v_add_f32 v63, v63, v115
    v_fma_f32 v64, v107, v111, v64
    s_waitcnt lgkmcnt(1)
    v_mfma_f32_16x16x32_bf16 a[0:3], a[152:155], v[100:103], a[0:3]
    v_mfma_f32_16x16x32_bf16 a[4:7], a[168:171], v[100:103], a[4:7]
    v_mfma_f32_16x16x32_bf16 a[8:11], a[184:187], v[100:103], a[8:11]
    s_waitcnt lgkmcnt(0)
    v_mfma_f32_16x16x32_bf16 a[0:3], a[156:159], v[116:119], a[0:3]
    v_mfma_f32_16x16x32_bf16 a[4:7], a[172:175], v[116:119], a[4:7]
    v_mfma_f32_16x16x32_bf16 a[8:11], a[188:191], v[116:119], a[8:11]
    buffer_load_dwordx4 v[220:223], v65, s[32:35], s61 offen offset:3072 sc1
L_tail:
    s_sub_u32 s56, s42, s40
    v_add_u32 v40, s56, v34
    v_add_u32 v41, s56, v35
    v_add_u32 v44, 73728, v36
    v_add_u32 v45, 73728, v37
    v_add_u32 v46, 73728, v38
    v_accvgpr_read_b32 v16, a0
    v_accvgpr_read_b32 v17, a1
    v_accvgpr_read_b32 v18, a2
    v_accvgpr_read_b32 v19, a3
    v_accvgpr_read_b32 v20, a4
    v_accvgpr_read_b32 v21, a5
    v_accvgpr_read_b32 v22, a6
    v_accvgpr_read_b32 v23, a7
    v_accvgpr_read_b32 v24, a8
    v_accvgpr_read_b32 v25, a9
    v_accvgpr_read_b32 v26, a10
    v_accvgpr_read_b32 v27, a11
    s_waitcnt vmcnt(14)
    s_barrier
    ds_read_b128 a[96:99], v40 offset:0
    ds_read_b128 a[100:103], v41 offset:0
    ds_read_b128 a[104:107], v40 offset:128
    ds_read_b128 a[108:111], v41 offset:128
    ds_read_b128 a[112:115], v40 offset:256
    ds_read_b128 a[116:119], v41 offset:256
    s_waitcnt lgkmcnt(5)
    v_mfma_f32_16x16x32_bf16 v[96:99], a[96:99], a[96:99], v[84:87]
    s_add_u32 s61, s60, 3162112
    buffer_load_dwordx4 v[224:227], v65, s[32:35], s61 offen offset:0 sc1
    ds_read_b64_tr_b16 a[144:145], v44 offset:0
    ds_read_b64_tr_b16 a[148:149], v44 offset:12288
    v_mfma_f32_16x16x32_bf16 v[100:103], a[96:99], a[48:51], 0
    ds_read_b64_tr_b16 a[152:153], v44 offset:24576
    ds_read_b64_tr_b16 a[156:157], v44 offset:36864
    s_waitcnt lgkmcnt(8)
    v_mfma_f32_16x16x32_bf16 v[96:99], a[100:103], a[100:103], v[96:99]
    ds_read_b64_tr_b16 a[160:161], v45 offset:0
    ds_read_b64_tr_b16 a[164:165], v45 offset:12288
    v_mfma_f32_16x16x32_bf16 v[100:103], a[100:103], a[52:55], v[100:103]
    ds_read_b64_tr_b16 a[168:169], v45 offset:24576
    ds_read_b64_tr_b16 a[172:173], v45 offset:36864
    s_waitcnt lgkmcnt(11)
    v_mfma_f32_16x16x32_bf16 v[96:99], a[104:107], a[104:107], v[96:99]
    ds_read_b64_tr_b16 a[176:177], v46 offset:0
    ds_read_b64_tr_b16 a[180:181], v46 offset:12288
    v_mfma_f32_16x16x32_bf16 v[100:103], a[104:107], a[56:59], v[100:103]
    ds_read_b64_tr_b16 a[184:185], v46 offset:24576
    ds_read_b64_tr_b16 a[188:189], v46 offset:36864
    s_waitcnt lgkmcnt(14)
    v_mfma_f32_16x16x32_bf16 v[96:99], a[108:111], a[108:111], v[96:99]
    v_mfma_f32_16x16x32_bf16 v[100:103], a[108:111], a[60:63], v[100:103]
    s_waitcnt lgkmcnt(13)
    v_mfma_f32_16x16x32_bf16 v[96:99], a[112:115], a[112:115], v[96:99]
    v_mfma_f32_16x16x32_bf16 v[100:103], a[112:115], a[64:67], v[100:103]
    buffer_load_dwordx4 v[228:231], v65, s[32:35], s61 offen offset:1024 sc1
    s_waitcnt lgkmcnt(12)
    v_mfma_f32_16x16x32_bf16 v[96:99], a[116:119], a[116:119], v[96:99]
    v_mfma_f32_16x16x32_bf16 v[100:103], a[116:119], a[68:71], v[100:103]
    v_mfma_f32_16x16x32_bf16 v[92:95], a[96:99], v[52:55], v[80:83]
    v_mfma_f32_16x16x32_bf16 v[92:95], a[100:103], v[52:55], v[92:95]
    v_mfma_f32_16x16x32_bf16 v[92:95], a[104:107], v[52:55], v[92:95]
    v_mfma_f32_16x16x32_bf16 v[92:95], a[108:111], v[52:55], v[92:95]
    s_nop 3
    v_fma_f32 v96, v100, 2.0, v96
    v_fma_f32 v97, v101, 2.0, v97
    v_mfma_f32_16x16x32_bf16 v[92:95], a[112:115], v[52:55], v[92:95]
    v_fma_f32 v98, v102, 2.0, v98
    v_fma_f32 v99, v103, 2.0, v99
    v_mfma_f32_16x16x32_bf16 v[92:95], a[116:119], v[52:55], v[92:95]
    v_cndmask_b32 v3, 0, v96, s[44:45]
    v_cndmask_b32 v3, v3, v97, s[46:47]
    v_mfma_f32_16x16x32_bf16 v[88:91], a[96:99], v[136:139], v[76:79]
    v_cndmask_b32 v3, v3, v98, s[48:49]
    v_cndmask_b32 v3, v3, v99, s[50:51]
    v_mfma_f32_16x16x32_bf16 v[88:91], a[100:103], v[140:143], v[88:91]
    s_nop 0
    s_nop 0
    v_mfma_f32_16x16x32_bf16 v[88:91], a[104:107], v[144:147], v[88:91]
    v_mfma_f32_16x16x4_f32 v[120:123], v3, v60, v[56:59]
    v_mfma_f32_16x16x32_bf16 v[88:91], a[108:111], v[148:151], v[88:91]
    v_mfma_f32_16x16x32_bf16 v[88:91], a[112:115], v[152:155], v[88:91]
    v_mfma_f32_16x16x32_bf16 v[88:91], a[116:119], v[156:159], v[88:91]
    s_waitcnt vmcnt(10)
    ds_read_b128 a[120:123], v40 offset:6144
    ds_read_b128 a[124:127], v41 offset:6144
    ds_read_b128 a[128:131], v40 offset:6272
    ds_read_b128 a[132:135], v41 offset:6272
    ds_read_b128 a[136:139], v40 offset:6400
    ds_read_b128 a[140:143], v41 offset:6400
    s_mul_i32 s56, s3, 148480
    s_and_b32 s57, s2, 7
    s_lshl_b32 s57, s57, 10
    s_add_u32 s56, s56, s57
    s_bfe_u32 s57, s2, 0x30003
    s_lshl_b32 s57, s57, 7
    s_add_u32 s56, s56, s57
    s_lshr_b32 s57, s2, 6
    s_lshl_b32 s57, s57, 13
    s_add_u32 s56, s56, s57
    s_add_u32 s56, s56, 65536
    buffer_load_dword v244, v242, s[32:35], s56 offen
    s_cmp_eq_u32 s0, 1
    s_cbranch_scc0 L_nolate
    s_add_u32 s56, s60, 3145728
    buffer_load_dwordx4 v[160:163], v65, s[32:35], s56 offen offset:0 sc1
    buffer_load_dwordx4 v[164:167], v65, s[32:35], s56 offen offset:1024 sc1
    buffer_load_dwordx4 v[168:171], v65, s[32:35], s56 offen offset:2048 sc1
    buffer_load_dwordx4 v[172:175], v65, s[32:35], s56 offen offset:3072 sc1
    s_add_u32 s56, s60, 3149824
    buffer_load_dwordx4 v[176:179], v65, s[32:35], s56 offen offset:0 sc1
    buffer_load_dwordx4 v[180:183], v65, s[32:35], s56 offen offset:1024 sc1
    buffer_load_dwordx4 v[184:187], v65, s[32:35], s56 offen offset:2048 sc1
    buffer_load_dwordx4 v[188:191], v65, s[32:35], s56 offen offset:3072 sc1
L_nolate:
    v_fma_f32 v128, -v92, v92, v120
    v_fma_f32 v129, -v93, v93, v121
    v_fma_f32 v130, -v94, v94, v122
    v_fma_f32 v131, -v95, v95, v123
    v_max_f32 v128, v128, v56
    v_max_f32 v129, v129, v56
    v_max_f32 v130, v130, v56
    v_max_f32 v131, v131, v56
    s_waitcnt lgkmcnt(5)
    v_mfma_f32_16x16x32_bf16 v[112:115], a[120:123], a[120:123], v[84:87]
    v_rsq_f32 v128, v128
    v_mfma_f32_16x16x32_bf16 v[116:119], a[120:123], a[48:51], 0
    v_rsq_f32 v129, v129
    s_waitcnt lgkmcnt(4)
    v_mfma_f32_16x16x32_bf16 v[112:115], a[124:127], a[124:127], v[112:115]
    v_rsq_f32 v130, v130
    v_mfma_f32_16x16x32_bf16 v[116:119], a[124:127], a[52:55], v[116:119]
    v_rsq_f32 v131, v131
    s_waitcnt lgkmcnt(3)
    v_mfma_f32_16x16x32_bf16 v[112:115], a[128:131], a[128:131], v[112:115]
    v_fma_f32 v88, -v92, v61, v88
    v_fma_f32 v89, -v93, v61, v89
    v_mfma_f32_16x16x32_bf16 v[116:119], a[128:131], a[56:59], v[116:119]
    v_fma_f32 v90, -v94, v61, v90
    v_fma_f32 v91, -v95, v61, v91
    s_waitcnt lgkmcnt(2)
    v_mfma_f32_16x16x32_bf16 v[112:115], a[132:135], a[132:135], v[112:115]
    v_fma_f32 v88, v88, v128, v62
    v_fma_f32 v89, v89, v129, v62
    v_mfma_f32_16x16x32_bf16 v[116:119], a[132:135], a[60:63], v[116:119]
    v_fma_f32 v90, v90, v130, v62
    v_fma_f32 v91, v91, v131, v62
    s_waitcnt lgkmcnt(1)
    v_mfma_f32_16x16x32_bf16 v[112:115], a[136:139], a[136:139], v[112:115]
    v_max3_f32 v1, v88, v89, v90
    v_max_f32 v1, v1, v91
    v_mfma_f32_16x16x32_bf16 v[116:119], a[136:139], a[64:67], v[116:119]
    v_cmp_lt_f32 vcc, s52, v1
    s_cbranch_vccnz L_site12
L_back12:
    s_waitcnt lgkmcnt(0)
    v_mfma_f32_16x16x32_bf16 v[112:115], a[140:143], a[140:143], v[112:115]
    v_exp_f32 v96, v88
    v_mfma_f32_16x16x32_bf16 v[116:119], a[140:143], a[68:71], v[116:119]
    v_exp_f32 v97, v89
    v_mfma_f32_16x16x32_bf16 v[108:111], a[120:123], v[52:55], v[80:83]
    v_exp_f32 v98, v90
    v_mfma_f32_16x16x32_bf16 v[108:111], a[124:127], v[52:55], v[108:111]
    v_exp_f32 v99, v91
    v_mfma_f32_16x16x32_bf16 v[108:111], a[128:131], v[52:55], v[108:111]
    v_mul_f32 v88, v96, v128
    v_mul_f32 v89, v97, v129
    v_mfma_f32_16x16x32_bf16 v[108:111], a[132:135], v[52:55], v[108:111]
    v_mul_f32 v90, v98, v130
    v_mul_f32 v91, v99, v131
    v_mfma_f32_16x16x32_bf16 v[108:111], a[136:139], v[52:55], v[108:111]
    v_fma_f32 v112, v116, 2.0, v112
    v_fma_f32 v113, v117, 2.0, v113
    v_mfma_f32_16x16x32_bf16 v[108:111], a[140:143], v[52:55], v[108:111]
    v_fma_f32 v114, v118, 2.0, v114
    v_fma_f32 v115, v119, 2.0, v115
    v_mfma_f32_16x16x32_bf16 v[104:107], a[120:123], v[136:139], v[76:79]
    v_cndmask_b32 v4, 0, v112, s[44:45]
    v_cndmask_b32 v4, v4, v113, s[46:47]
    v_mfma_f32_16x16x32_bf16 v[104:107], a[124:127], v[140:143], v[104:107]
    v_cndmask_b32 v4, v4, v114, s[48:49]
    v_cndmask_b32 v4, v4, v115, s[50:51]
    v_mfma_f32_16x16x32_bf16 v[104:107], a[128:131], v[144:147], v[104:107]
    v_add_f32 v63, v63, v96
    v_fmac_f32 v64, v88, v92
    v_mfma_f32_16x16x32_bf16 v[104:107], a[132:135], v[148:151], v[104:107]
    v_mfma_f32_16x16x4_f32 v[124:127], v4, v60, v[56:59]
    v_mfma_f32_16x16x32_bf16 v[104:107], a[136:139], v[152:155], v[104:107]
    v_add_f32 v63, v63, v97
    v_fmac_f32 v64, v89, v93
    v_mfma_f32_16x16x32_bf16 v[104:107], a[140:143], v[156:159], v[104:107]
    v_add_f32 v63, v63, v98
    v_fmac_f32 v64, v90, v94
    v_add_f32 v63, v63, v99
    v_fmac_f32 v64, v91, v95
    v_add_f32 v68, v68, v88
    v_add_f32 v69, v69, v89
    v_add_f32 v70, v70, v90
    v_add_f32 v71, v71, v91
    v_fma_f32 v132, -v108, v108, v124
    v_fma_f32 v133, -v109, v109, v125
    v_fma_f32 v134, -v110, v110, v126
    v_fma_f32 v135, -v111, v111, v127
    v_max_f32 v132, v132, v56
    v_max_f32 v133, v133, v56
    v_max_f32 v134, v134, v56
    v_max_f32 v135, v135, v56
    v_rsq_f32 v132, v132
    v_rsq_f32 v133, v133
    v_rsq_f32 v134, v134
    v_rsq_f32 v135, v135
    v_fma_f32 v104, -v108, v61, v104
    v_fma_f32 v105, -v109, v61, v105
    v_fma_f32 v106, -v110, v61, v106
    v_fma_f32 v107, -v111, v61, v107
    v_fma_f32 v104, v104, v132, v62
    v_fma_f32 v105, v105, v133, v62
    v_fma_f32 v106, v106, v134, v62
    v_fma_f32 v107, v107, v135, v62
    v_max3_f32 v1, v104, v105, v106
    v_max_f32 v1, v1, v107
    v_cmp_lt_f32 vcc, s52, v1
    s_cbranch_vccnz L_site13
L_back13:
    v_exp_f32 v112, v104
    v_exp_f32 v113, v105
    v_exp_f32 v114, v106
    v_exp_f32 v115, v107
    v_cvt_pk_bf16_f32 v72, v88, v89
    v_cvt_pk_bf16_f32 v73, v90, v91
    v_mul_f32 v104, v112, v132
    v_mul_f32 v105, v113, v133
    v_mul_f32 v106, v114, v134
    v_mul_f32 v107, v115, v135
    v_cvt_pk_bf16_f32 v74, v104, v105
    v_cvt_pk_bf16_f32 v75, v106, v107
    ds_write_b128 v237, v[72:75]
    v_add_f32 v68, v68, v104
    v_add_f32 v69, v69, v105
    v_add_f32 v70, v70, v106
    v_add_f32 v71, v71, v107
    v_cvt_pk_bf16_f32 v66, v68, v69
    v_cvt_pk_bf16_f32 v67, v70, v71
    ds_write_b64 v238, v[66:67]
    v_add_f32 v63, v63, v112
    v_fma_f32 v64, v104, v108, v64
    v_add_f32 v63, v63, v113
    v_fma_f32 v64, v105, v109, v64
    v_add_f32 v63, v63, v114
    v_fma_f32 v64, v106, v110, v64
    v_add_f32 v10, v63, v115
    v_fma_f32 v11, v107, v111, v64
    ds_write_b64 v238, v[10:11] offset:2048
    s_mul_i32 s56, s3, 148480
    s_and_b32 s57, s2, 7
    s_lshl_b32 s57, s57, 10
    s_add_u32 s56, s56, s57
    s_bfe_u32 s57, s2, 0x30003
    s_lshl_b32 s57, s57, 7
    s_add_u32 s56, s56, s57
    s_lshr_b32 s57, s2, 6
    s_lshl_b32 s57, s57, 13
    s_add_u32 s56, s56, s57
    s_add_u32 s56, s56, 65536
    v_mov_b32 v232, 0x53800000
    s_mov_b32 s43, 1
    s_sub_u32 s58, s2, 64
    s_mul_i32 s60, s58, 37120
    s_lshl_b32 s57, s3, 13
    s_add_u32 s60, s60, s57
    s_add_u32 s60, s60, 65536
    s_add_u32 s61, s60, 4096
    s_cmp_lt_u32 s58, 64
    s_cbranch_scc0 L_nobulk
    buffer_load_dwordx4 v[76:79], v65, s[32:35], s60 offen offset:0 sc1
    buffer_load_dwordx4 v[80:83], v65, s[32:35], s60 offen offset:1024 sc1
    buffer_load_dwordx4 v[84:87], v65, s[32:35], s60 offen offset:2048 sc1
    buffer_load_dwordx4 v[108:111], v65, s[32:35], s60 offen offset:3072 sc1
    buffer_load_dwordx4 v[112:115], v65, s[32:35], s61 offen offset:0 sc1
    buffer_load_dwordx4 v[128:131], v65, s[32:35], s61 offen offset:1024 sc1
    buffer_load_dwordx4 v[132:135], v65, s[32:35], s61 offen offset:2048 sc1
    buffer_load_dwordx4 v[52:55], v65, s[32:35], s61 offen offset:3072 sc1
L_nobulk:
    s_waitcnt lgkmcnt(0)
    s_barrier
L_postx:
    ds_read_b32 v9, v254 offset:4096
    ds_read_b128 v[92:95], v253 offset:0
    ds_read_b64_tr_b16 a[146:147], v44 offset:6144
    ds_read_b64 v[136:137], v254 offset:2048
    ds_read_b64 v[138:139], v254 offset:2560
    ds_read_b64 v[140:141], v254 offset:3072
    ds_read_b64 v[142:143], v254 offset:3584
    ds_read_b128 v[96:99], v253 offset:1024
    ds_read_b64_tr_b16 a[150:151], v44 offset:18432
    ds_read_b128 v[100:103], v253 offset:2048
    ds_read_b64_tr_b16 a[154:155], v44 offset:30720
    ds_read_b128 v[116:119], v253 offset:3072
    ds_read_b64_tr_b16 a[158:159], v44 offset:43008
    s_waitcnt lgkmcnt(12)
    v_cmp_ne_u32 vcc, 0, v9
    s_cbranch_vccnz L_xlast
    s_waitcnt lgkmcnt(10)
    v_mfma_f32_16x16x32_bf16 v[16:19], a[144:147], v[92:95], v[16:19]
    ds_read_b64 v[120:121], v254 offset:0
    s_waitcnt lgkmcnt(7)
    ds_read_b64 v[122:123], v254 offset:512
    s_waitcnt lgkmcnt(6)
    v_mfma_f32_16x16x32_bf16 v[16:19], a[148:151], v[96:99], v[16:19]
    v_add_f32 v1, v136, v138
    ds_read_b64 v[124:125], v254 offset:1024
    s_waitcnt lgkmcnt(5)
    v_mfma_f32_16x16x32_bf16 v[16:19], a[152:155], v[100:103], v[16:19]
    v_add_f32 v2, v137, v139
    ds_read_b64 v[126:127], v254 offset:1536
    s_waitcnt lgkmcnt(4)
    v_mfma_f32_16x16x32_bf16 v[16:19], a[156:159], v[116:119], v[16:19]
    v_add_f32 v140, v140, v142
    ds_read_b64_tr_b16 a[162:163], v45 offset:6144
    s_waitcnt lgkmcnt(3)
    v_mfma_f32_16x16x32_bf16 v[16:19], a[72:75], v[120:123], v[16:19]
    v_add_f32 v141, v141, v143
    ds_read_b64_tr_b16 a[166:167], v45 offset:18432
    s_waitcnt lgkmcnt(2)
    v_mfma_f32_16x16x32_bf16 v[16:19], a[76:79], v[124:127], v[16:19]
    v_add_f32 v1, v1, v140
    ds_read_b64_tr_b16 a[170:171], v45 offset:30720
    s_waitcnt lgkmcnt(2)
    v_mfma_f32_16x16x32_bf16 v[20:23], a[160:163], v[92:95], v[20:23]
    v_add_f32 v2, v2, v141
    ds_read_b64_tr_b16 a[174:175], v45 offset:43008
    s_waitcnt lgkmcnt(2)
    v_mfma_f32_16x16x32_bf16 v[20:23], a[164:167], v[96:99], v[20:23]
    v_permlane32_swap_b32 v1, v2
    ds_read_b64_tr_b16 a[178:179], v46 offset:6144
    s_waitcnt lgkmcnt(2)
    v_mfma_f32_16x16x32_bf16 v[20:23], a[168:171], v[100:103], v[20:23]
    v_add_f32 v1, v1, v2
    ds_read_b64_tr_b16 a[182:183], v46 offset:18432
    s_waitcnt lgkmcnt(2)
    v_mfma_f32_16x16x32_bf16 v[20:23], a[172:175], v[116:119], v[20:23]
    v_mov_b32 v2, v1
    ds_read_b64_tr_b16 a[186:187], v46 offset:30720
    v_mfma_f32_16x16x32_bf16 v[20:23], a[80:83], v[120:123], v[20:23]
    v_permlane16_swap_b32 v1, v2
    ds_read_b64_tr_b16 a[190:191], v46 offset:43008
    v_mfma_f32_16x16x32_bf16 v[20:23], a[84:87], v[124:127], v[20:23]
    v_add_f32 v1, v1, v2
    v_mov_b32 v2, v1
    s_waitcnt lgkmcnt(3)
    v_mfma_f32_16x16x32_bf16 v[24:27], a[176:179], v[92:95], v[24:27]
    v_permlane32_swap_b32 v1, v2
    s_waitcnt lgkmcnt(2)
    v_mfma_f32_16x16x32_bf16 v[24:27], a[180:183], v[96:99], v[24:27]
    v_rcp_f32 v3, v1
    s_waitcnt lgkmcnt(1)
    v_mfma_f32_16x16x32_bf16 v[24:27], a[184:187], v[100:103], v[24:27]
    v_log_f32 v4, v1
    s_waitcnt lgkmcnt(0)
    v_mfma_f32_16x16x32_bf16 v[24:27], a[188:191], v[116:119], v[24:27]
    v_mul_f32 v5, v60, v3
    v_mul_f32 v6, v2, v3
    v_mfma_f32_16x16x32_bf16 v[24:27], a[88:91], v[120:123], v[24:27]
    v_sub_f32 v4, v4, v255
    v_fma_f32 v16, v16, v5, -v6
    v_mfma_f32_16x16x32_bf16 v[24:27], a[92:95], v[124:127], v[24:27]
    v_fma_f32 v17, v17, v5, -v6
    v_fma_f32 v18, v18, v5, -v6
    v_fma_f32 v19, v19, v5, -v6
    v_cvt_pk_bf16_f32 v66, v16, v17
    v_cvt_pk_bf16_f32 v67, v18, v19
    ds_write_b64 v236, v[66:67] offset:0
    v_fma_f32 v20, v20, v5, -v6
    v_fma_f32 v21, v21, v5, -v6
    v_fma_f32 v22, v22, v5, -v6
    v_fma_f32 v23, v23, v5, -v6
    v_cvt_pk_bf16_f32 v68, v20, v21
    v_cvt_pk_bf16_f32 v69, v22, v23
    ds_write_b64 v236, v[68:69] offset:512
    v_fma_f32 v24, v24, v5, -v6
    v_fma_f32 v25, v25, v5, -v6
    v_fma_f32 v26, v26, v5, -v6
    v_fma_f32 v27, v27, v5, -v6
    v_cvt_pk_bf16_f32 v70, v24, v25
    v_cvt_pk_bf16_f32 v71, v26, v27
    ds_write_b64 v236, v[70:71] offset:1024
    s_cmp_lt_u32 s58, 64
    s_cbranch_scc1 L_wcon
    s_waitcnt vmcnt(0)
L_wcon:
    s_waitcnt vmcnt(8)
    s_waitcnt lgkmcnt(0)
    s_barrier
    ds_read_b128 v[136:139], v241 offset:0
    ds_read_b128 v[140:143], v241 offset:1024
    ds_read_b128 v[144:147], v241 offset:2048
    ds_read_b128 v[148:151], v241 offset:3072
    ds_read_b128 v[152:155], v241 offset:4096
    ds_read_b128 v[156:159], v241 offset:5120
    s_waitcnt lgkmcnt(5)
    v_mfma_f32_16x16x32_bf16 v[16:19], v[160:163], v[136:139], 0
    v_mfma_f32_16x16x32_bf16 v[20:23], v[184:187], v[136:139], 0
    v_mfma_f32_16x16x32_bf16 v[24:27], v[208:211], v[136:139], 0
    s_waitcnt lgkmcnt(4)
    v_mfma_f32_16x16x32_bf16 v[16:19], v[164:167], v[140:143], v[16:19]
    v_mfma_f32_16x16x32_bf16 v[20:23], v[188:191], v[140:143], v[20:23]
    v_mfma_f32_16x16x32_bf16 v[24:27], v[212:215], v[140:143], v[24:27]
    s_waitcnt lgkmcnt(3)
    v_mfma_f32_16x16x32_bf16 v[16:19], v[168:171], v[144:147], v[16:19]
    v_mfma_f32_16x16x32_bf16 v[20:23], v[192:195], v[144:147], v[20:23]
    v_mfma_f32_16x16x32_bf16 v[24:27], v[216:219], v[144:147], v[24:27]
    s_waitcnt lgkmcnt(2)
    v_mfma_f32_16x16x32_bf16 v[16:19], v[172:175], v[148:151], v[16:19]
    v_mfma_f32_16x16x32_bf16 v[20:23], v[196:199], v[148:151], v[20:23]
    v_mfma_f32_16x16x32_bf16 v[24:27], v[220:223], v[148:151], v[24:27]
    s_waitcnt lgkmcnt(1)
    v_mfma_f32_16x16x32_bf16 v[16:19], v[176:179], v[152:155], v[16:19]
    v_mfma_f32_16x16x32_bf16 v[20:23], v[200:203], v[152:155], v[20:23]
    v_mfma_f32_16x16x32_bf16 v[24:27], v[224:227], v[152:155], v[24:27]
    s_waitcnt lgkmcnt(0)
    v_mfma_f32_16x16x32_bf16 v[16:19], v[180:183], v[156:159], v[16:19]
    v_mfma_f32_16x16x32_bf16 v[20:23], v[204:207], v[156:159], v[20:23]
    v_mfma_f32_16x16x32_bf16 v[24:27], v[228:231], v[156:159], v[24:27]
    v_mov_b32 v35, v4
    v_add_u32 v39, s39, v4
    s_nop 3
    v_cvt_pk_bf16_f32 v32, v16, v17
    v_cvt_pk_bf16_f32 v33, v18, v19
    v_cvt_pk_bf16_f32 v34, v20, v21
    buffer_store_dwordx4 v[32:35], v242, s[32:35], s56 offen sc1
    v_cvt_pk_bf16_f32 v36, v22, v23
    v_cvt_pk_bf16_f32 v37, v24, v25
    v_cvt_pk_bf16_f32 v38, v26, v27
    buffer_store_dwordx4 v[36:39], v243, s[32:35], s56 offen sc1
    s_cmp_lt_u32 s58, 64
    s_cbranch_scc0 L_fin
    s_mov_b32 s68, s18
    s_mov_b32 s69, s19
    s_mov_b32 s70, 6144
    s_mov_b32 s71, 0x20000
    ds_bpermute_b32 v42, v252, v4
    v_bfe_u32 v48, v0, 2, 1
    v_cmp_eq_u32 vcc, 1, v48
    v_mov_b32 v246, s39
    s_movk_i32 s26, 0x101
    v_cndmask_b32 v247, 0, v246, vcc
    v_sub_u32 v246, v246, v247
    v_sub_u32 v246, v246, v247
    v_mov_b32 v16, 0
    v_mov_b32 v17, 0
    v_mov_b32 v18, 0
    v_mov_b32 v19, 0
    v_mov_b32 v20, 0
    v_mov_b32 v21, 0
    v_mov_b32 v22, 0
    v_mov_b32 v97, 0
    s_mov_b32 s53, 0
    s_waitcnt vmcnt(2)
    v_sub_u32_dpp v136, v79, v79 row_half_mirror row_mask:0xf bank_mask:0xf
    v_sub_u32_dpp v137, v83, v83 row_half_mirror row_mask:0xf bank_mask:0xf
    v_sub_u32_dpp v138, v87, v87 row_half_mirror row_mask:0xf bank_mask:0xf
    v_sub_u32_dpp v139, v111, v111 row_half_mirror row_mask:0xf bank_mask:0xf
    v_sub_u32_dpp v140, v115, v115 row_half_mirror row_mask:0xf bank_mask:0xf
    v_sub_u32_dpp v141, v131, v131 row_half_mirror row_mask:0xf bank_mask:0xf
    v_sub_u32_dpp v142, v135, v135 row_half_mirror row_mask:0xf bank_mask:0xf
    v_sub_u32_dpp v143, v55, v55 row_half_mirror row_mask:0xf bank_mask:0xf
    v_cmp_eq_u32 s[6:7], v136, v246
    v_mov_b32 v136, 0x101
    v_cmp_eq_u32 s[8:9], v137, v246
    v_mov_b32 v137, 0x202
    v_cmp_eq_u32 s[10:11], v138, v246
    v_mov_b32 v138, 0x404
    v_cmp_eq_u32 s[12:13], v139, v246
    v_mov_b32 v139, 0x808
    v_cmp_eq_u32 s[14:15], v140, v246
    v_mov_b32 v140, 0x1010
    v_cmp_eq_u32 s[16:17], v141, v246
    v_mov_b32 v141, 0x2020
    v_cmp_eq_u32 s[36:37], v142, v246
    v_mov_b32 v142, 0x4040
    v_cmp_eq_u32 s[40:41], v143, v246
    v_mov_b32 v143, 0x8080
    v_cndmask_b32 v136, v136, 0, s[6:7]
    v_cndmask_b32 v137, v137, 0, s[8:9]
    v_cndmask_b32 v138, v138, 0, s[10:11]
    v_cndmask_b32 v139, v139, 0, s[12:13]
    v_cndmask_b32 v140, v140, 0, s[14:15]
    v_cndmask_b32 v141, v141, 0, s[16:17]
    v_cndmask_b32 v142, v142, 0, s[36:37]
    v_cndmask_b32 v143, v143, 0, s[40:41]
    v_or3_b32 v96, v136, v137, v138
    v_or3_b32 v139, v139, v140, v141
    v_or3_b32 v96, v96, v142, v143
    v_or_b32 v96, v96, v139
    v_cmp_ne_u32 s[24:25], 0, v96
    s_waitcnt lgkmcnt(0)
    v_lshrrev_b32 v48, v97, v96
    v_ffbl_b32 v48, v48
    v_add_u32 v48, v48, v97
    v_and_b32 v48, 7, v48
    v_lshl_add_u32 v51, v48, 10, v65
    v_lshlrev_b32 v88, v48, s26
    v_add_u32 v97, 1, v48
    s_mov_b64 exec, s[24:25]
    buffer_load_dwordx4 v[136:139], v51, s[32:35], s60 offen sc1
    s_mov_b64 exec, -1
    s_mov_b64 exec, s[6:7]
    v_sub_u32 v49, v79, v247
    v_sub_f32 v49, v49, v42
    v_exp_f32 v49, v49
    s_nop 0
    v_cvt_pk_bf16_f32 v49, v49, 0
    v_lshlrev_b32 v50, 16, v49
    v_dot2_f32_bf16 v16, v76, v49, v16
    v_dot2_f32_bf16 v18, v77, v49, v18
    v_dot2_f32_bf16 v20, v78, v49, v20
    v_add_f32 v22, v22, v50
    v_dot2_f32_bf16 v17, v76, v50, v17
    v_dot2_f32_bf16 v19, v77, v50, v19
    v_dot2_f32_bf16 v21, v78, v50, v21
    s_mov_b64 exec, -1
    s_mov_b64 exec, s[8:9]
    v_sub_u32 v49, v83, v247
    v_sub_f32 v49, v49, v42
    v_exp_f32 v49, v49
    s_nop 0
    v_cvt_pk_bf16_f32 v49, v49, 0
    v_lshlrev_b32 v50, 16, v49
    v_dot2_f32_bf16 v16, v80, v49, v16
    v_dot2_f32_bf16 v18, v81, v49, v18
    v_dot2_f32_bf16 v20, v82, v49, v20
    v_add_f32 v22, v22, v50
    v_dot2_f32_bf16 v17, v80, v50, v17
    v_dot2_f32_bf16 v19, v81, v50, v19
    v_dot2_f32_bf16 v21, v82, v50, v21
    s_mov_b64 exec, -1
    v_lshrrev_b32 v48, v97, v96
    v_ffbl_b32 v48, v48
    v_add_u32 v48, v48, v97
    v_and_b32 v48, 7, v48
    v_lshl_add_u32 v51, v48, 10, v65
    v_lshlrev_b32 v89, v48, s26
    v_add_u32 v97, 1, v48
    s_mov_b64 exec, s[24:25]
    buffer_load_dwordx4 v[140:143], v51, s[32:35], s60 offen sc1
    s_mov_b64 exec, -1
    s_mov_b64 exec, s[10:11]
    v_sub_u32 v49, v87, v247
    v_sub_f32 v49, v49, v42
    v_exp_f32 v49, v49
    s_nop 0
    v_cvt_pk_bf16_f32 v49, v49, 0
    v_lshlrev_b32 v50, 16, v49
    v_dot2_f32_bf16 v16, v84, v49, v16
    v_dot2_f32_bf16 v18, v85, v49, v18
    v_dot2_f32_bf16 v20, v86, v49, v20
    v_add_f32 v22, v22, v50
    v_dot2_f32_bf16 v17, v84, v50, v17
    v_dot2_f32_bf16 v19, v85, v50, v19
    v_dot2_f32_bf16 v21, v86, v50, v21
    s_mov_b64 exec, -1
    s_mov_b64 exec, s[12:13]
    v_sub_u32 v49, v111, v247
    v_sub_f32 v49, v49, v42
    v_exp_f32 v49, v49
    s_nop 0
    v_cvt_pk_bf16_f32 v49, v49, 0
    v_lshlrev_b32 v50, 16, v49
    v_dot2_f32_bf16 v16, v108, v49, v16
    v_dot2_f32_bf16 v18, v109, v49, v18
    v_dot2_f32_bf16 v20, v110, v49, v20
    v_add_f32 v22, v22, v50
    v_dot2_f32_bf16 v17, v108, v50, v17
    v_dot2_f32_bf16 v19, v109, v50, v19
    v_dot2_f32_bf16 v21, v110, v50, v21
    s_mov_b64 exec, -1
    v_lshrrev_b32 v48, v97, v96
    v_ffbl_b32 v48, v48
    v_add_u32 v48, v48, v97
    v_and_b32 v48, 7, v48
    v_lshl_add_u32 v51, v48, 10, v65
    v_lshlrev_b32 v90, v48, s26
    v_add_u32 v97, 1, v48
    s_mov_b64 exec, s[24:25]
    buffer_load_dwordx4 v[144:147], v51, s[32:35], s60 offen sc1
    s_mov_b64 exec, -1
    s_mov_b64 exec, s[14:15]
    v_sub_u32 v49, v115, v247
    v_sub_f32 v49, v49, v42
    v_exp_f32 v49, v49
    s_nop 0
    v_cvt_pk_bf16_f32 v49, v49, 0
    v_lshlrev_b32 v50, 16, v49
    v_dot2_f32_bf16 v16, v112, v49, v16
    v_dot2_f32_bf16 v18, v113, v49, v18
    v_dot2_f32_bf16 v20, v114, v49, v20
    v_add_f32 v22, v22, v50
    v_dot2_f32_bf16 v17, v112, v50, v17
    v_dot2_f32_bf16 v19, v113, v50, v19
    v_dot2_f32_bf16 v21, v114, v50, v21
    s_mov_b64 exec, -1
    s_mov_b64 exec, s[16:17]
    v_sub_u32 v49, v131, v247
    v_sub_f32 v49, v49, v42
    v_exp_f32 v49, v49
    s_nop 0
    v_cvt_pk_bf16_f32 v49, v49, 0
    v_lshlrev_b32 v50, 16, v49
    v_dot2_f32_bf16 v16, v128, v49, v16
    v_dot2_f32_bf16 v18, v129, v49, v18
    v_dot2_f32_bf16 v20, v130, v49, v20
    v_add_f32 v22, v22, v50
    v_dot2_f32_bf16 v17, v128, v50, v17
    v_dot2_f32_bf16 v19, v129, v50, v19
    v_dot2_f32_bf16 v21, v130, v50, v21
    s_mov_b64 exec, -1
    v_lshrrev_b32 v48, v97, v96
    v_ffbl_b32 v48, v48
    v_add_u32 v48, v48, v97
    v_and_b32 v48, 7, v48
    v_lshl_add_u32 v51, v48, 10, v65
    v_lshlrev_b32 v91, v48, s26
    v_add_u32 v97, 1, v48
    s_mov_b64 exec, s[24:25]
    buffer_load_dwordx4 v[148:151], v51, s[32:35], s60 offen sc1
    s_mov_b64 exec, -1
    s_mov_b64 exec, s[36:37]
    v_sub_u32 v49, v135, v247
    v_sub_f32 v49, v49, v42
    v_exp_f32 v49, v49
    s_nop 0
    v_cvt_pk_bf16_f32 v49, v49, 0
    v_lshlrev_b32 v50, 16, v49
    v_dot2_f32_bf16 v16, v132, v49, v16
    v_dot2_f32_bf16 v18, v133, v49, v18
    v_dot2_f32_bf16 v20, v134, v49, v20
    v_add_f32 v22, v22, v50
    v_dot2_f32_bf16 v17, v132, v50, v17
    v_dot2_f32_bf16 v19, v133, v50, v19
    v_dot2_f32_bf16 v21, v134, v50, v21
    s_mov_b64 exec, -1
    s_mov_b64 exec, s[40:41]
    v_sub_u32 v49, v55, v247
    v_sub_f32 v49, v49, v42
    v_exp_f32 v49, v49
    s_nop 0
    v_cvt_pk_bf16_f32 v49, v49, 0
    v_lshlrev_b32 v50, 16, v49
    v_dot2_f32_bf16 v16, v52, v49, v16
    v_dot2_f32_bf16 v18, v53, v49, v18
    v_dot2_f32_bf16 v20, v54, v49, v20
    v_add_f32 v22, v22, v50
    v_dot2_f32_bf16 v17, v52, v50, v17
    v_dot2_f32_bf16 v19, v53, v50, v19
    v_dot2_f32_bf16 v21, v54, v50, v21
    s_mov_b64 exec, -1
    s_cmp_eq_u64 s[24:25], 0
    s_cbranch_scc1 L_c_red
L_c_loop:
    s_waitcnt vmcnt(3)
    v_sub_u32_dpp v48, v139, v139 row_half_mirror row_mask:0xf bank_mask:0xf
    v_and_b32 v49, v88, v96
    v_cmp_eq_u32 vcc, v48, v246
    v_cmp_ne_u32 s[24:25], 0, v49
    s_and_b64 exec, vcc, s[24:25]
    s_cbranch_scc0 L_c_s0
    v_xor_b32 v96, v96, v88
    v_sub_u32 v49, v139, v247
    v_sub_f32 v49, v49, v42
    v_exp_f32 v49, v49
    s_nop 0
    v_cvt_pk_bf16_f32 v49, v49, 0
    v_lshlrev_b32 v50, 16, v49
    v_dot2_f32_bf16 v16, v136, v49, v16
    v_dot2_f32_bf16 v18, v137, v49, v18
    v_dot2_f32_bf16 v20, v138, v49, v20
    v_add_f32 v22, v22, v50
    v_dot2_f32_bf16 v17, v136, v50, v17
    v_dot2_f32_bf16 v19, v137, v50, v19
    v_dot2_f32_bf16 v21, v138, v50, v21
L_c_s0:
    s_mov_b64 exec, -1
    v_cmp_ne_u32 vcc, 0, v96
    v_lshrrev_b32 v48, v97, v96
    s_cbranch_vccz L_c_red
    v_ffbl_b32 v48, v48
    v_add_u32 v48, v48, v97
    v_and_b32 v48, 7, v48
    v_lshl_add_u32 v51, v48, 10, v65
    v_lshlrev_b32 v88, v48, s26
    v_add_u32 v97, 1, v48
    s_mov_b64 exec, vcc
    buffer_load_dwordx4 v[136:139], v51, s[32:35], s60 offen sc1
    s_mov_b64 exec, -1
    s_waitcnt vmcnt(3)
    v_sub_u32_dpp v48, v143, v143 row_half_mirror row_mask:0xf bank_mask:0xf
    v_and_b32 v49, v89, v96
    v_cmp_eq_u32 vcc, v48, v246
    v_cmp_ne_u32 s[24:25], 0, v49
    s_and_b64 exec, vcc, s[24:25]
    s_cbranch_scc0 L_c_s1
    v_xor_b32 v96, v96, v89
    v_sub_u32 v49, v143, v247
    v_sub_f32 v49, v49, v42
    v_exp_f32 v49, v49
    s_nop 0
    v_cvt_pk_bf16_f32 v49, v49, 0
    v_lshlrev_b32 v50, 16, v49
    v_dot2_f32_bf16 v16, v140, v49, v16
    v_dot2_f32_bf16 v18, v141, v49, v18
    v_dot2_f32_bf16 v20, v142, v49, v20
    v_add_f32 v22, v22, v50
    v_dot2_f32_bf16 v17, v140, v50, v17
    v_dot2_f32_bf16 v19, v141, v50, v19
    v_dot2_f32_bf16 v21, v142, v50, v21
L_c_s1:
    s_mov_b64 exec, -1
    v_cmp_ne_u32 vcc, 0, v96
    v_lshrrev_b32 v48, v97, v96
    s_cbranch_vccz L_c_red
    v_ffbl_b32 v48, v48
    v_add_u32 v48, v48, v97
    v_and_b32 v48, 7, v48
    v_lshl_add_u32 v51, v48, 10, v65
    v_lshlrev_b32 v89, v48, s26
    v_add_u32 v97, 1, v48
    s_mov_b64 exec, vcc
    buffer_load_dwordx4 v[140:143], v51, s[32:35], s60 offen sc1
    s_mov_b64 exec, -1
    s_waitcnt vmcnt(3)
    v_sub_u32_dpp v48, v147, v147 row_half_mirror row_mask:0xf bank_mask:0xf
    v_and_b32 v49, v90, v96
    v_cmp_eq_u32 vcc, v48, v246
    v_cmp_ne_u32 s[24:25], 0, v49
    s_and_b64 exec, vcc, s[24:25]
    s_cbranch_scc0 L_c_s2
    v_xor_b32 v96, v96, v90
    v_sub_u32 v49, v147, v247
    v_sub_f32 v49, v49, v42
    v_exp_f32 v49, v49
    s_nop 0
    v_cvt_pk_bf16_f32 v49, v49, 0
    v_lshlrev_b32 v50, 16, v49
    v_dot2_f32_bf16 v16, v144, v49, v16
    v_dot2_f32_bf16 v18, v145, v49, v18
    v_dot2_f32_bf16 v20, v146, v49, v20
    v_add_f32 v22, v22, v50
    v_dot2_f32_bf16 v17, v144, v50, v17
    v_dot2_f32_bf16 v19, v145, v50, v19
    v_dot2_f32_bf16 v21, v146, v50, v21
L_c_s2:
    s_mov_b64 exec, -1
    v_cmp_ne_u32 vcc, 0, v96
    v_lshrrev_b32 v48, v97, v96
    s_cbranch_vccz L_c_red
    v_ffbl_b32 v48, v48
    v_add_u32 v48, v48, v97
    v_and_b32 v48, 7, v48
    v_lshl_add_u32 v51, v48, 10, v65
    v_lshlrev_b32 v90, v48, s26
    v_add_u32 v97, 1, v48
    s_mov_b64 exec, vcc
    buffer_load_dwordx4 v[144:147], v51, s[32:35], s60 offen sc1
    s_mov_b64 exec, -1
    s_waitcnt vmcnt(3)
    v_sub_u32_dpp v48, v151, v151 row_half_mirror row_mask:0xf bank_mask:0xf
    v_and_b32 v49, v91, v96
    v_cmp_eq_u32 vcc, v48, v246
    v_cmp_ne_u32 s[24:25], 0, v49
    s_and_b64 exec, vcc, s[24:25]
    s_cbranch_scc0 L_c_s3
    v_xor_b32 v96, v96, v91
    v_sub_u32 v49, v151, v247
    v_sub_f32 v49, v49, v42
    v_exp_f32 v49, v49
    s_nop 0
    v_cvt_pk_bf16_f32 v49, v49, 0
    v_lshlrev_b32 v50, 16, v49
    v_dot2_f32_bf16 v16, v148, v49, v16
    v_dot2_f32_bf16 v18, v149, v49, v18
    v_dot2_f32_bf16 v20, v150, v49, v20
    v_add_f32 v22, v22, v50
    v_dot2_f32_bf16 v17, v148, v50, v17
    v_dot2_f32_bf16 v19, v149, v50, v19
    v_dot2_f32_bf16 v21, v150, v50, v21
L_c_s3:
    s_mov_b64 exec, -1
    v_cmp_ne_u32 vcc, 0, v96
    v_lshrrev_b32 v48, v97, v96
    s_cbranch_vccz L_c_red
    v_ffbl_b32 v48, v48
    v_add_u32 v48, v48, v97
    v_and_b32 v48, 7, v48
    v_lshl_add_u32 v51, v48, 10, v65
    v_lshlrev_b32 v91, v48, s26
    v_add_u32 v97, 1, v48
    s_mov_b64 exec, vcc
    buffer_load_dwordx4 v[148:151], v51, s[32:35], s60 offen sc1
    s_mov_b64 exec, -1
    s_add_u32 s53, s53, 1
    s_cmp_lt_u32 s53, 65536
    s_cbranch_scc1 L_c_loop
L_c_red:
    v_mov_b32 v23, v22
    v_permlane32_swap_b32 v16, v20
    v_permlane32_swap_b32 v17, v21
    v_permlane32_swap_b32 v18, v22
    v_permlane32_swap_b32 v19, v23
    v_add_f32 v16, v16, v20
    v_add_f32 v17, v17, v21
    v_add_f32 v18, v18, v22
    v_add_f32 v19, v19, v23
    s_nop 0
    v_permlane16_swap_b32 v16, v18
    v_permlane16_swap_b32 v17, v19
    v_add_f32 v16, v16, v18
    v_add_f32 v17, v17, v19
    s_nop 0
    v_add_f32_dpp v48, v16, v16 row_ror:8 row_mask:0xf bank_mask:0x3
    s_nop 1
    v_add_f32_dpp v48, v17, v17 row_ror:8 row_mask:0xf bank_mask:0xc
    ds_write_b32 v250, v48
    s_waitcnt lgkmcnt(0)
    s_barrier
    ds_read_b128 v[48:51], v251 offset:768
    ds_read_b128 v[52:55], v65
    v_lshlrev_b32 v18, 16, v249
    s_waitcnt lgkmcnt(1)
    v_add_f32 v48, v48, v49
    v_add_f32 v50, v50, v51
    v_add_f32 v48, v48, v50
    v_cmp_nlt_f32 vcc, v48, v232
    v_rcp_f32 v48, v48
    s_waitcnt lgkmcnt(0)
    s_cbranch_vccnz L_c_slow
L_c_out:
    s_cmp_lg_u32 s3, 0
    s_cbranch_scc1 L_fin
    v_add_f32 v52, v52, v53
    v_add_f32 v54, v54, v55
    v_add_f32 v52, v52, v54
    v_fmac_f32 v18, v52, v48
    v_cvt_pk_bf16_f32 v18, v18, v18
    buffer_store_short v18, v248, s[68:71], 0 offen
    s_cmp_lg_u32 s58, 0
    s_cbranch_scc1 L_fin
    v_mov_b32 v48, s39
    v_mov_b32 v49, 0
    s_mov_b64 exec, 1
    buffer_store_dword v48, v49, s[32:35], 0 offen offset:0 sc1
    s_mov_b64 exec, -1
L_fin:
L_end:
    s_endpgm
L_prod:
    s_cmp_lg_u32 s3, 0
    s_cbranch_scc1 L_p_noq
    s_mov_b32 m0, 147456
    s_nop 0
    buffer_load_dwordx4 v16, s[72:75], 0 offen offset:0  lds
    buffer_load_dwordx4 v17, s[72:75], 0 offen offset:1024  lds
    buffer_load_dwordx4 v18, s[72:75], 0 offen offset:2048  lds
    buffer_load_dwordx4 v19, s[72:75], 0 offen offset:3072  lds
    s_mov_b32 m0, 151552
    s_nop 0
    buffer_load_dwordx4 v20, s[72:75], 0 offen offset:0  lds
    buffer_load_dwordx4 v21, s[72:75], 0 offen offset:1024  lds
L_p_noq:
    s_mul_i32 s60, s3, 18432
    s_add_u32 m0, s60, 73728
    s_nop 0
    buffer_load_dwordx4 v16, s[64:67], s60 offen offset:0  lds
    buffer_load_dwordx4 v17, s[64:67], s60 offen offset:1024  lds
    buffer_load_dwordx4 v18, s[64:67], s60 offen offset:2048  lds
    buffer_load_dwordx4 v19, s[64:67], s60 offen offset:3072  lds
    s_add_u32 m0, s60, 77824
    s_nop 0
    buffer_load_dwordx4 v20, s[64:67], s60 offen offset:0  lds
    buffer_load_dwordx4 v21, s[64:67], s60 offen offset:1024  lds
    s_add_u32 s60, s60, 6144
    s_add_u32 m0, s60, 73728
    s_nop 0
    buffer_load_dwordx4 v16, s[64:67], s60 offen offset:0  lds
    buffer_load_dwordx4 v17, s[64:67], s60 offen offset:1024  lds
    buffer_load_dwordx4 v18, s[64:67], s60 offen offset:2048  lds
    buffer_load_dwordx4 v19, s[64:67], s60 offen offset:3072  lds
    s_add_u32 m0, s60, 77824
    s_nop 0
    buffer_load_dwordx4 v20, s[64:67], s60 offen offset:0  lds
    buffer_load_dwordx4 v21, s[64:67], s60 offen offset:1024  lds
    s_add_u32 s60, s60, 6144
    s_add_u32 m0, s60, 73728
    s_nop 0
    buffer_load_dwordx4 v16, s[64:67], s60 offen offset:0  lds
    v_mov_b32 v52, 0x3f803f80
    v_mov_b32 v56, 0x3ebcbe62
    s_mov_b32 s44, 0x100001
    s_mov_b32 s45, 0x10000100
    v_mov_b32 v53, 0x3f803f80
    v_mov_b32 v57, 0x3ebcbe62
    s_mov_b32 s46, 0x200002
    buffer_load_dwordx4 v17, s[64:67], s60 offen offset:1024  lds
    s_mov_b32 s47, 0x20000200
    v_mov_b32 v54, 0x3f803f80
    v_mov_b32 v58, 0x3ebcbe62
    s_mov_b32 s48, 0x400004
    s_mov_b32 s49, 0x40000400
    v_mov_b32 v55, 0x3f803f80
    v_mov_b32 v59, 0x3ebcbe62
    buffer_load_dwordx4 v18, s[64:67], s60 offen offset:2048  lds
    s_mov_b32 s50, 0x800008
    s_mov_b32 s51, 0x80000800
    v_mov_b32 v60, 0x43400000
    v_lshrrev_b32 v1, 5, v0
    v_lshlrev_b32 v1, 8, v1
    v_and_b32 v2, 15, v0
    v_lshl_add_u32 v1, v2, 4, v1
    buffer_load_dwordx4 v19, s[64:67], s60 offen offset:3072  lds
    v_bfe_u32 v2, v0, 4, 1
    v_lshl_add_u32 v1, v2, 3, v1
    s_mul_i32 s56, s3, 1536
    s_add_u32 s56, s56, 153600
    v_add_u32 v134, s56, v1
    v_bfe_u32 v1, v0, 4, 1
    v_lshrrev_b32 v5, 5, v0
    s_add_u32 m0, s60, 77824
    s_nop 0
    buffer_load_dwordx4 v20, s[64:67], s60 offen offset:0  lds
    v_lshl_or_b32 v1, v1, 1, v5
    v_bfe_u32 v2, v0, 2, 2
    v_lshl_add_u32 v3, v1, 3, v2
    v_mul_u32_u24 v3, 384, v3
    v_and_b32 v4, 1, v0
    v_lshl_add_u32 v3, v4, 3, v3
    v_add_u32 v3, 73728, v3
    buffer_load_dwordx4 v21, s[64:67], s60 offen offset:1024  lds
    v_and_or_b32 v2, v2, 2, v5
    v_bfe_u32 v4, v0, 1, 1
    v_xor_b32 v2, v2, v4
    s_mul_i32 s56, s3, 6
    s_add_u32 s57, s56, 0
    v_xor_b32 v4, s57, v2
    v_lshl_add_u32 v124, v4, 4, v3
    s_lshl_b32 s61, s43, 2
    s_add_u32 s61, s61, s3
    s_mul_i32 s60, s61, 6144
    s_add_u32 m0, s41, 6144
    s_nop 0
    buffer_load_dwordx4 v16, s[68:71], s60 offen offset:0  lds
    v_xor_b32 v125, 64, v124
    s_add_u32 s57, s56, 2
    v_xor_b32 v4, s57, v2
    v_lshl_add_u32 v126, v4, 4, v3
    v_xor_b32 v127, 64, v126
    s_add_u32 s57, s56, 4
    v_xor_b32 v4, s57, v2
    buffer_load_dwordx4 v17, s[68:71], s60 offen offset:1024  lds
    v_lshl_add_u32 v128, v4, 4, v3
    v_xor_b32 v129, 64, v128
    v_and_b32 v2, 15, v0
    v_bfe_u32 v3, v0, 3, 1
    v_and_or_b32 v4, v0, 6, v3
    v_xor_b32 v4, v4, v1
    v_mul_u32_u24 v2, 384, v2
    buffer_load_dwordx4 v18, s[68:71], s60 offen offset:2048  lds
    v_lshl_add_u32 v2, v4, 4, v2
    v_add_u32 v132, 147456, v2
    v_xor_b32 v133, 64, v132
    s_and_b32 s56, s3, 1
    s_lshl_b32 s56, s56, 2
    s_lshr_b32 s57, s3, 1
    s_mul_i32 s57, s57, 24576
    buffer_load_dwordx4 v19, s[68:71], s60 offen offset:3072  lds
    s_add_u32 s57, s57, 30720
    v_and_b32 v1, 11, v0
    v_or_b32 v1, s56, v1
    v_and_or_b32 v2, v1, 6, v3
    v_lshrrev_b32 v3, 4, v0
    v_xor_b32 v2, v2, v3
    v_mul_u32_u24 v1, 384, v1
    s_add_u32 m0, s41, 10240
    s_nop 0
    buffer_load_dwordx4 v20, s[68:71], s60 offen offset:0  lds
    v_lshl_add_u32 v1, v2, 4, v1
    v_bfe_u32 v2, v0, 2, 1
    v_mul_u32_u24 v2, 12288, v2
    v_add3_u32 v130, s57, v1, v2
    v_xor_b32 v131, 64, v130
    v_add_u32 v135, 153600, v65
    buffer_load_dwordx4 v21, s[68:71], s60 offen offset:1024  lds
    s_waitcnt vmcnt(24)
    s_barrier
    s_load_dword s38, s[22:23], 0
    ds_read_b128 v[136:139], v132 offset:0
    ds_read_b128 v[140:143], v133 offset:0
    ds_read_b128 v[144:147], v132 offset:128
    ds_read_b128 v[148:151], v133 offset:128
    ds_read_b128 v[152:155], v132 offset:256
    ds_read_b128 v[156:159], v133 offset:256
    s_add_u32 m0, s40, 0
    s_add_u32 s57, s36, 0
    buffer_load_dwordx4 v16, s[28:31], s57 offen offset:0 nt lds
    buffer_load_dwordx4 v17, s[28:31], s57 offen offset:1024 nt lds
    buffer_load_dwordx4 v18, s[28:31], s57 offen offset:2048 nt lds
    buffer_load_dwordx4 v19, s[28:31], s57 offen offset:3072 nt lds
    s_add_u32 m0, s40, 4096
    s_nop 0
    buffer_load_dwordx4 v20, s[28:31], s57 offen offset:0 nt lds
    buffer_load_dwordx4 v21, s[28:31], s57 offen offset:1024 nt lds
    s_waitcnt lgkmcnt(0)
    v_mfma_f32_16x16x32_bf16 v[112:115], v[136:139], v[136:139], 0
    v_mfma_f32_16x16x32_bf16 v[116:119], v[52:55], v[136:139], 0
    s_add_u32 m0, s41, 0
    s_add_u32 s58, s37, 0
    buffer_load_dwordx4 v22, s[24:27], s58 offen offset:0 nt lds
    v_mfma_f32_16x16x32_bf16 v[112:115], v[140:143], v[140:143], v[112:115]
    v_mfma_f32_16x16x32_bf16 v[116:119], v[52:55], v[140:143], v[116:119]
    buffer_load_dwordx4 v23, s[24:27], s58 offen offset:1024 nt lds
    v_mfma_f32_16x16x32_bf16 v[112:115], v[144:147], v[144:147], v[112:115]
    v_mfma_f32_16x16x32_bf16 v[116:119], v[52:55], v[144:147], v[116:119]
    buffer_load_dwordx4 v24, s[24:27], s58 offen offset:2048 nt lds
    v_mfma_f32_16x16x32_bf16 v[112:115], v[148:151], v[148:151], v[112:115]
    v_mfma_f32_16x16x32_bf16 v[116:119], v[52:55], v[148:151], v[116:119]
    v_mfma_f32_16x16x32_bf16 v[112:115], v[152:155], v[152:155], v[112:115]
    v_mfma_f32_16x16x32_bf16 v[116:119], v[52:55], v[152:155], v[116:119]
    v_mfma_f32_16x16x32_bf16 v[112:115], v[156:159], v[156:159], v[112:115]
    v_mfma_f32_16x16x32_bf16 v[116:119], v[52:55], v[156:159], v[116:119]
    s_mul_i32 s39, s38, 0x9e3779b1
    s_add_u32 s39, s39, 0x7f4a7c16
    s_or_b32 s39, s39, 1
    s_lshl_b32 s61, s61, 10
    s_add_u32 s61, s61, 16384
    s_waitcnt vmcnt(15)
    s_barrier
    ds_read_b64_tr_b16 v[160:161], v124 offset:0
    ds_read_b64_tr_b16 v[162:163], v125 offset:1536
    ds_read_b64_tr_b16 v[184:185], v126 offset:0
    ds_read_b64_tr_b16 v[186:187], v127 offset:1536
    ds_read_b64_tr_b16 v[208:209], v128 offset:0
    ds_read_b64_tr_b16 v[210:211], v129 offset:1536
    ds_read_b64_tr_b16 v[164:165], v124 offset:12288
    ds_read_b64_tr_b16 v[166:167], v125 offset:13824
    ds_read_b64_tr_b16 v[188:189], v126 offset:12288
    ds_read_b64_tr_b16 v[190:191], v127 offset:13824
    ds_read_b64_tr_b16 v[212:213], v128 offset:12288
    ds_read_b64_tr_b16 v[214:215], v129 offset:13824
    v_cndmask_b32 v3, 0, v112, s[44:45]
    v_cndmask_b32 v3, v3, v113, s[46:47]
    v_cndmask_b32 v3, v3, v114, s[48:49]
    v_cndmask_b32 v3, v3, v115, s[50:51]
    v_mul_f32 v6, 0x3baaaaab, v116
    ds_read_b64_tr_b16 v[168:169], v124 offset:24576
    ds_read_b64_tr_b16 v[170:171], v125 offset:26112
    v_mfma_f32_16x16x4_f32 v[120:123], v60, v3, v[56:59]
    s_waitcnt lgkmcnt(12)
    v_mfma_f32_16x16x32_bf16 v[88:91], v[160:163], v[136:139], 0
    ds_read_b64_tr_b16 v[192:193], v126 offset:24576
    v_mfma_f32_16x16x32_bf16 v[100:103], v[160:163], v[52:55], 0
    ds_read_b64_tr_b16 v[194:195], v127 offset:26112
    s_waitcnt lgkmcnt(12)
    v_mfma_f32_16x16x32_bf16 v[92:95], v[184:187], v[136:139], 0
    ds_read_b64_tr_b16 v[216:217], v128 offset:24576
    v_mfma_f32_16x16x32_bf16 v[104:107], v[184:187], v[52:55], 0
    ds_read_b64_tr_b16 v[218:219], v129 offset:26112
    s_waitcnt lgkmcnt(12)
    v_mfma_f32_16x16x32_bf16 v[96:99], v[208:211], v[136:139], 0
    ds_read_b64_tr_b16 v[172:173], v124 offset:36864
    v_mfma_f32_16x16x32_bf16 v[108:111], v[208:211], v[52:55], 0
    ds_read_b64_tr_b16 v[174:175], v125 offset:38400
    s_waitcnt lgkmcnt(12)
    v_mfma_f32_16x16x32_bf16 v[88:91], v[164:167], v[140:143], v[88:91]
    ds_read_b64_tr_b16 v[196:197], v126 offset:36864
    v_mfma_f32_16x16x32_bf16 v[100:103], v[164:167], v[52:55], v[100:103]
    ds_read_b64_tr_b16 v[198:199], v127 offset:38400
    s_waitcnt lgkmcnt(12)
    v_mfma_f32_16x16x32_bf16 v[92:95], v[188:191], v[140:143], v[92:95]
    ds_read_b64_tr_b16 v[220:221], v128 offset:36864
    v_mfma_f32_16x16x32_bf16 v[104:107], v[188:191], v[52:55], v[104:107]
    ds_read_b64_tr_b16 v[222:223], v129 offset:38400
    s_waitcnt lgkmcnt(12)
    v_mfma_f32_16x16x32_bf16 v[96:99], v[212:215], v[140:143], v[96:99]
    ds_read_b64_tr_b16 v[176:177], v124 offset:49152
    v_mfma_f32_16x16x32_bf16 v[108:111], v[212:215], v[52:55], v[108:111]
    ds_read_b64_tr_b16 v[178:179], v125 offset:50688
    s_waitcnt lgkmcnt(12)
    v_mfma_f32_16x16x32_bf16 v[88:91], v[168:171], v[144:147], v[88:91]
    ds_read_b64_tr_b16 v[200:201], v126 offset:49152
    v_mfma_f32_16x16x32_bf16 v[100:103], v[168:171], v[52:55], v[100:103]
    ds_read_b64_tr_b16 v[202:203], v127 offset:50688
    s_waitcnt lgkmcnt(12)
    v_mfma_f32_16x16x32_bf16 v[92:95], v[192:195], v[144:147], v[92:95]
    ds_read_b64_tr_b16 v[224:225], v128 offset:49152
    v_mfma_f32_16x16x32_bf16 v[104:107], v[192:195], v[52:55], v[104:107]
    ds_read_b64_tr_b16 v[226:227], v129 offset:50688
    s_waitcnt lgkmcnt(12)
    v_mfma_f32_16x16x32_bf16 v[96:99], v[216:219], v[144:147], v[96:99]
    ds_read_b64_tr_b16 v[180:181], v124 offset:61440
    v_mfma_f32_16x16x32_bf16 v[108:111], v[216:219], v[52:55], v[108:111]
    ds_read_b64_tr_b16 v[182:183], v125 offset:62976
    s_waitcnt lgkmcnt(12)
    v_mfma_f32_16x16x32_bf16 v[88:91], v[172:175], v[148:151], v[88:91]
    ds_read_b64_tr_b16 v[204:205], v126 offset:61440
    v_mfma_f32_16x16x32_bf16 v[100:103], v[172:175], v[52:55], v[100:103]
    ds_read_b64_tr_b16 v[206:207], v127 offset:62976
    s_waitcnt lgkmcnt(12)
    v_mfma_f32_16x16x32_bf16 v[92:95], v[196:199], v[148:151], v[92:95]
    ds_read_b64_tr_b16 v[228:229], v128 offset:61440
    v_mfma_f32_16x16x32_bf16 v[104:107], v[196:199], v[52:55], v[104:107]
    ds_read_b64_tr_b16 v[230:231], v129 offset:62976
    s_waitcnt lgkmcnt(12)
    v_mfma_f32_16x16x32_bf16 v[96:99], v[220:223], v[148:151], v[96:99]
    v_fma_f32 v5, -v116, v116, v120
    v_mfma_f32_16x16x32_bf16 v[108:111], v[220:223], v[52:55], v[108:111]
    v_max_f32 v5, v5, v56
    s_waitcnt lgkmcnt(10)
    v_mfma_f32_16x16x32_bf16 v[88:91], v[176:179], v[152:155], v[88:91]
    v_rsq_f32 v5, v5
    v_mfma_f32_16x16x32_bf16 v[100:103], v[176:179], v[52:55], v[100:103]
    v_mov_b32 v122, s39
    s_waitcnt lgkmcnt(8)
    v_mfma_f32_16x16x32_bf16 v[92:95], v[200:203], v[152:155], v[92:95]
    v_mul_f32 v5, v60, v5
    v_mfma_f32_16x16x32_bf16 v[104:107], v[200:203], v[52:55], v[104:107]
    v_mov_b32 v123, s39
    s_waitcnt lgkmcnt(6)
    v_mfma_f32_16x16x32_bf16 v[96:99], v[224:227], v[152:155], v[96:99]
    v_mfma_f32_16x16x32_bf16 v[108:111], v[224:227], v[52:55], v[108:111]
    s_waitcnt lgkmcnt(4)
    v_mfma_f32_16x16x32_bf16 v[88:91], v[180:183], v[156:159], v[88:91]
    v_mfma_f32_16x16x32_bf16 v[100:103], v[180:183], v[52:55], v[100:103]
    s_waitcnt lgkmcnt(2)
    v_mfma_f32_16x16x32_bf16 v[92:95], v[204:207], v[156:159], v[92:95]
    v_mfma_f32_16x16x32_bf16 v[104:107], v[204:207], v[52:55], v[104:107]
    s_waitcnt lgkmcnt(0)
    v_mfma_f32_16x16x32_bf16 v[96:99], v[228:231], v[156:159], v[96:99]
    v_mfma_f32_16x16x32_bf16 v[108:111], v[228:231], v[52:55], v[108:111]
    s_nop 1
    v_fma_f32 v88, -v6, v100, v88
    v_fma_f32 v89, -v6, v101, v89
    v_fma_f32 v90, -v6, v102, v90
    v_fma_f32 v91, -v6, v103, v91
    v_mul_f32 v88, v88, v5
    v_mul_f32 v89, v89, v5
    v_mul_f32 v90, v90, v5
    v_mul_f32 v91, v91, v5
    v_cvt_pk_bf16_f32 v112, v88, v89
    v_cvt_pk_bf16_f32 v113, v90, v91
    ds_write_b64 v134, v[112:113] offset:0
    v_fma_f32 v92, -v6, v104, v92
    v_fma_f32 v93, -v6, v105, v93
    v_fma_f32 v94, -v6, v106, v94
    v_fma_f32 v95, -v6, v107, v95
    v_mul_f32 v92, v92, v5
    v_mul_f32 v93, v93, v5
    v_mul_f32 v94, v94, v5
    v_mul_f32 v95, v95, v5
    v_cvt_pk_bf16_f32 v114, v92, v93
    v_cvt_pk_bf16_f32 v115, v94, v95
    ds_write_b64 v134, v[114:115] offset:512
    v_fma_f32 v96, -v6, v108, v96
    v_fma_f32 v97, -v6, v109, v97
    v_fma_f32 v98, -v6, v110, v98
    v_fma_f32 v99, -v6, v111, v99
    v_mul_f32 v96, v96, v5
    v_mul_f32 v97, v97, v5
    v_mul_f32 v98, v98, v5
    v_mul_f32 v99, v99, v5
    v_cvt_pk_bf16_f32 v116, v96, v97
    v_cvt_pk_bf16_f32 v117, v98, v99
    ds_write_b64 v134, v[116:117] offset:1024
    s_waitcnt vmcnt(9)
    s_waitcnt lgkmcnt(0)
    s_barrier
    ds_read_b128 v[136:139], v135 offset:0
    ds_read_b128 a[96:99], v130 offset:0
    ds_read_b128 v[140:143], v135 offset:1024
    ds_read_b128 a[100:103], v131 offset:0
    ds_read_b128 v[144:147], v135 offset:2048
    ds_read_b128 a[104:107], v130 offset:128
    ds_read_b128 v[148:151], v135 offset:3072
    ds_read_b128 a[108:111], v131 offset:128
    ds_read_b128 v[152:155], v135 offset:4096
    ds_read_b128 a[112:115], v130 offset:256
    ds_read_b128 v[156:159], v135 offset:5120
    ds_read_b128 a[116:119], v131 offset:256
    s_waitcnt lgkmcnt(10)
    v_mfma_f32_16x16x32_bf16 v[88:91], a[96:99], v[136:139], 0
    s_waitcnt lgkmcnt(8)
    v_mfma_f32_16x16x32_bf16 v[92:95], a[100:103], v[140:143], 0
    s_waitcnt lgkmcnt(6)
    v_mfma_f32_16x16x32_bf16 v[88:91], a[104:107], v[144:147], v[88:91]
    s_waitcnt lgkmcnt(4)
    v_mfma_f32_16x16x32_bf16 v[92:95], a[108:111], v[148:151], v[92:95]
    s_waitcnt lgkmcnt(2)
    v_mfma_f32_16x16x32_bf16 v[88:91], a[112:115], v[152:155], v[88:91]
    s_waitcnt lgkmcnt(0)
    v_mfma_f32_16x16x32_bf16 v[92:95], a[116:119], v[156:159], v[92:95]
    s_nop 7
    v_add_f32 v88, v88, v92
    v_add_f32 v89, v89, v93
    v_add_f32 v90, v90, v94
    v_add_f32 v91, v91, v95
    v_mul_f32 v88, 0x419fecaf, v88
    v_mul_f32 v89, 0x419fecaf, v89
    v_mul_f32 v90, 0x419fecaf, v90
    v_mul_f32 v91, 0x419fecaf, v91
    v_cvt_pk_bf16_f32 v120, v88, v89
    v_cvt_pk_bf16_f32 v121, v90, v91
    buffer_store_dwordx4 v[120:123], v65, s[32:35], s61 offen sc1
    buffer_load_dwordx4 v25, s[24:27], s58 offen offset:3072 nt lds
    s_add_u32 m0, s41, 4096
    s_nop 0
    buffer_load_dwordx4 v26, s[24:27], s58 offen offset:0 nt lds
    buffer_load_dwordx4 v27, s[24:27], s58 offen offset:1024 nt lds
    s_barrier
    buffer_load_dwordx4 v28, s[24:27], s58 offen offset:2048 nt lds
    buffer_load_dwordx4 v29, s[24:27], s58 offen offset:3072 nt lds
    s_add_u32 m0, s41, 8192
    s_nop 0
    buffer_load_dwordx4 v30, s[24:27], s58 offen offset:0 nt lds
    buffer_load_dwordx4 v31, s[24:27], s58 offen offset:1024 nt lds
    buffer_load_dwordx4 v32, s[24:27], s58 offen offset:2048 nt lds
    buffer_load_dwordx4 v33, s[24:27], s58 offen offset:3072 nt lds
    v_and_b32 v1, 15, v0
    v_lshrrev_b32 v6, 5, v0
    v_bfe_u32 v3, v0, 4, 1
    v_lshl_or_b32 v3, v3, 1, v6
    v_lshrrev_b32 v4, 2, v0
    v_bfe_u32 v5, v0, 1, 1
    v_lshrrev_b32 v6, 3, v1
    v_and_or_b32 v6, v1, 6, v6
    v_xor_b32 v6, v6, v3
    v_mul_u32_u24 v7, 384, v1
    v_lshl_add_u32 v6, v6, 4, v7
    v_add_u32 v34, s40, v6
    v_xor_b32 v35, 64, v34
    v_lshrrev_b32 v6, 3, v1
    v_and_b32 v7, 7, v1
    v_lshl_or_b32 v6, v7, 1, v6
    v_xor_b32 v6, v6, v3
    v_mul_u32_u24 v7, 768, v1
    v_lshl_add_u32 v6, v6, 4, v7
    v_add_u32 v40, s41, v6
    v_xor_b32 v41, 0x40, v40
    v_xor_b32 v42, 0x80, v40
    v_xor_b32 v43, 0xc0, v40
    v_and_b32 v2, 1, v0
    v_lshlrev_b32 v2, 3, v2
    s_mul_i32 s56, s3, 96
    v_lshrrev_b32 v6, 3, v4
    v_and_or_b32 v6, v4, 6, v6
    v_xor_b32 v6, v6, v5
    v_lshl_add_u32 v6, v6, 4, v2
    v_mul_u32_u24 v7, 384, v4
    s_add_u32 s57, s56, 0
    v_xad_u32 v36, v6, s57, v7
    s_add_u32 s57, s56, 32
    v_xad_u32 v37, v6, s57, v7
    s_add_u32 s57, s56, 64
    v_xad_u32 v38, v6, s57, v7
    v_lshrrev_b32 v6, 3, v4
    v_and_b32 v3, 7, v4
    v_lshl_or_b32 v6, v3, 1, v6
    v_xor_b32 v6, v6, v5
    v_lshl_add_u32 v6, v6, 4, v2
    v_lshlrev_b32 v7, 1, v7
    v_add_u32 v7, 24576, v7
    s_add_u32 s57, s56, 0
    v_xad_u32 v44, v6, s57, v7
    s_add_u32 s57, s56, 384
    v_xad_u32 v45, v6, s57, v7
    s_add_u32 s57, s56, 32
    v_xad_u32 v46, v6, s57, v7
    s_add_u32 s57, s56, 416
    v_xad_u32 v47, v6, s57, v7
    s_add_u32 s57, s56, 64
    v_xad_u32 v48, v6, s57, v7
    s_add_u32 s57, s56, 448
    v_xad_u32 v49, v6, s57, v7
    v_lshrrev_b32 v1, 5, v0
    v_lshlrev_b32 v1, 8, v1
    v_and_b32 v2, 15, v0
    v_lshl_add_u32 v1, v2, 4, v1
    v_bfe_u32 v2, v0, 4, 1
    v_lshl_add_u32 v1, v2, 3, v1
    s_mul_i32 s56, s3, 1536
    s_add_u32 s56, s56, 147456
    v_add_u32 v236, s56, v1
    s_mul_i32 s56, s3, 3072
    s_add_u32 s56, s56, 24576
    v_add_u32 v237, s56, v65
    v_add_u32 v238, s41, v65
    s_lshl_b32 s56, s3, 10
    v_add_u32 v240, 159744, v65
    v_add_u32 v239, s56, v240
    v_add_u32 v241, 147456, v65
    v_bfe_u32 v1, v0, 2, 2
    v_lshrrev_b32 v2, 4, v0
    v_lshl_or_b32 v1, v1, 4, v2
    v_mul_u32_u24 v1, 37120, v1
    v_and_b32 v2, 3, v0
    v_lshl_or_b32 v242, v2, 4, v1
    v_xor_b32 v243, 0x70, v242
    s_mul_i32 s56, s3, 3
    v_min_u32 v1, 2, v0
    v_add_u32 v1, s56, v1
    v_lshlrev_b32 v245, 7, v1
    v_lshlrev_b32 v1, 3, v0
    v_add_u32 v254, 126976, v1
    s_lshl_b32 s56, s3, 9
    v_add_u32 v238, s56, v254
    v_add_u32 v253, 122880, v65
    s_lshl_b32 s56, s3, 10
    v_add_u32 v237, s56, v253
    s_mov_b32 s52, 0x41c00000
    s_add_u32 m0, s42, 0
    s_add_u32 s59, s37, 196608
    buffer_load_dwordx4 v22, s[24:27], s59 offen offset:0 nt lds
    buffer_load_dwordx4 v23, s[24:27], s59 offen offset:1024 nt lds
    buffer_load_dwordx4 v24, s[24:27], s59 offen offset:2048 nt lds
    buffer_load_dwordx4 v25, s[24:27], s59 offen offset:3072 nt lds
    s_add_u32 m0, s42, 4096
    s_nop 0
    buffer_load_dwordx4 v26, s[24:27], s59 offen offset:0 nt lds
    buffer_load_dwordx4 v27, s[24:27], s59 offen offset:1024 nt lds
    buffer_load_dwordx4 v28, s[24:27], s59 offen offset:2048 nt lds
    buffer_load_dwordx4 v29, s[24:27], s59 offen offset:3072 nt lds
    s_add_u32 m0, s42, 8192
    s_nop 0
    buffer_load_dwordx4 v30, s[24:27], s59 offen offset:0 nt lds
    buffer_load_dwordx4 v31, s[24:27], s59 offen offset:1024 nt lds
    buffer_load_dwordx4 v32, s[24:27], s59 offen offset:2048 nt lds
    buffer_load_dwordx4 v33, s[24:27], s59 offen offset:3072 nt lds
    s_mov_b32 s43, -1
    s_branch L_join
L_vprod:
    s_mul_i32 s60, s3, 18432
    s_add_u32 m0, s60, 73728
    s_nop 0
    buffer_load_dwordx4 v16, s[64:67], s60 offen offset:0  lds
    buffer_load_dwordx4 v17, s[64:67], s60 offen offset:1024  lds
    buffer_load_dwordx4 v18, s[64:67], s60 offen offset:2048  lds
    buffer_load_dwordx4 v19, s[64:67], s60 offen offset:3072  lds
    s_add_u32 m0, s60, 77824
    s_nop 0
    buffer_load_dwordx4 v20, s[64:67], s60 offen offset:0  lds
    buffer_load_dwordx4 v21, s[64:67], s60 offen offset:1024  lds
    s_add_u32 s60, s60, 6144
    s_add_u32 m0, s60, 73728
    s_nop 0
    buffer_load_dwordx4 v16, s[64:67], s60 offen offset:0  lds
    buffer_load_dwordx4 v17, s[64:67], s60 offen offset:1024  lds
    buffer_load_dwordx4 v18, s[64:67], s60 offen offset:2048  lds
    buffer_load_dwordx4 v19, s[64:67], s60 offen offset:3072  lds
    s_add_u32 m0, s60, 77824
    s_nop 0
    buffer_load_dwordx4 v20, s[64:67], s60 offen offset:0  lds
    buffer_load_dwordx4 v21, s[64:67], s60 offen offset:1024  lds
    s_add_u32 s60, s60, 6144
    s_add_u32 m0, s60, 73728
    s_nop 0
    buffer_load_dwordx4 v16, s[64:67], s60 offen offset:0  lds
    v_lshrrev_b32 v1, 4, v0
    v_and_b32 v5, 1, v1
    v_bfe_u32 v2, v0, 2, 2
    v_lshl_add_u32 v3, v1, 3, v2
    buffer_load_dwordx4 v17, s[64:67], s60 offen offset:1024  lds
    v_mul_u32_u24 v3, 384, v3
    v_and_b32 v4, 1, v0
    v_lshl_add_u32 v3, v4, 3, v3
    v_add_u32 v3, 73728, v3
    buffer_load_dwordx4 v18, s[64:67], s60 offen offset:2048  lds
    v_and_or_b32 v2, v2, 2, v5
    v_bfe_u32 v4, v0, 1, 1
    v_xor_b32 v2, v2, v4
    s_mul_i32 s56, s3, 6
    buffer_load_dwordx4 v19, s[64:67], s60 offen offset:3072  lds
    s_add_u32 s57, s56, 0
    v_xor_b32 v4, s57, v2
    v_lshl_add_u32 v136, v4, 4, v3
    v_xor_b32 v137, 64, v136
    s_add_u32 m0, s60, 77824
    s_nop 0
    buffer_load_dwordx4 v20, s[64:67], s60 offen offset:0  lds
    s_add_u32 s57, s56, 2
    v_xor_b32 v4, s57, v2
    v_lshl_add_u32 v138, v4, 4, v3
    v_xor_b32 v139, 64, v138
    buffer_load_dwordx4 v21, s[64:67], s60 offen offset:1024  lds
    s_add_u32 s57, s56, 4
    v_xor_b32 v4, s57, v2
    v_lshl_add_u32 v140, v4, 4, v3
    v_xor_b32 v141, 64, v140
    s_lshl_b32 s61, s43, 2
    s_add_u32 s61, s61, s3
    s_mul_i32 s60, s61, 6144
    s_add_u32 m0, s41, 6144
    s_nop 0
    buffer_load_dwordx4 v16, s[68:71], s60 offen offset:0  lds
    v_bfe_u32 v1, v0, 2, 1
    v_and_b32 v2, 3, v0
    v_lshl_or_b32 v2, v1, 3, v2
    v_and_or_b32 v1, v0, 2, v1
    buffer_load_dwordx4 v17, s[68:71], s60 offen offset:1024  lds
    v_lshrrev_b32 v3, 4, v0
    v_xor_b32 v1, v1, v3
    v_mul_u32_u24 v2, 384, v2
    v_lshl_add_u32 v1, v1, 4, v2
    buffer_load_dwordx4 v18, s[68:71], s60 offen offset:2048  lds
    v_bfe_u32 v2, v0, 3, 1
    v_mul_u32_u24 v2, 12288, v2
    s_mov_b32 s56, 30720
    v_add3_u32 v142, s56, v1, v2
    buffer_load_dwordx4 v19, s[68:71], s60 offen offset:3072  lds
    v_xor_b32 v143, 64, v142
    s_add_u32 m0, s41, 10240
    s_nop 0
    buffer_load_dwordx4 v20, s[68:71], s60 offen offset:0  lds
    buffer_load_dwordx4 v21, s[68:71], s60 offen offset:1024  lds
    s_load_dword s38, s[22:23], 0
    s_barrier
    s_add_u32 m0, s40, 0
    s_add_u32 s57, s36, 0
    buffer_load_dwordx4 v16, s[28:31], s57 offen offset:0 nt lds
    buffer_load_dwordx4 v17, s[28:31], s57 offen offset:1024 nt lds
    buffer_load_dwordx4 v18, s[28:31], s57 offen offset:2048 nt lds
    buffer_load_dwordx4 v19, s[28:31], s57 offen offset:3072 nt lds
    s_add_u32 m0, s40, 4096
    s_nop 0
    buffer_load_dwordx4 v20, s[28:31], s57 offen offset:0 nt lds
    buffer_load_dwordx4 v21, s[28:31], s57 offen offset:1024 nt lds
    s_add_u32 m0, s41, 0
    s_add_u32 s58, s37, 0
    buffer_load_dwordx4 v22, s[24:27], s58 offen offset:0 nt lds
    buffer_load_dwordx4 v23, s[24:27], s58 offen offset:1024 nt lds
    buffer_load_dwordx4 v24, s[24:27], s58 offen offset:2048 nt lds
    s_waitcnt vmcnt(9)
    s_barrier
    ds_read_b128 a[96:99], v142 offset:0
    ds_read_b128 a[100:103], v143 offset:0
    ds_read_b128 a[104:107], v142 offset:128
    ds_read_b128 a[108:111], v143 offset:128
    ds_read_b128 a[112:115], v142 offset:256
    ds_read_b128 a[116:119], v143 offset:256
    ds_read_b128 a[120:123], v143 offset:1536
    ds_read_b128 a[124:127], v142 offset:1536
    ds_read_b128 a[128:131], v143 offset:1664
    ds_read_b128 a[132:135], v142 offset:1664
    ds_read_b128 a[136:139], v143 offset:1792
    ds_read_b128 a[140:143], v142 offset:1792
    ds_read_b128 a[144:147], v142 offset:24576
    ds_read_b128 a[148:151], v143 offset:24576
    ds_read_b128 a[152:155], v142 offset:24704
    ds_read_b128 a[156:159], v143 offset:24704
    ds_read_b128 a[160:163], v142 offset:24832
    ds_read_b128 a[164:167], v143 offset:24832
    ds_read_b128 a[168:171], v143 offset:26112
    ds_read_b128 a[172:175], v142 offset:26112
    ds_read_b128 a[176:179], v143 offset:26240
    ds_read_b128 a[180:183], v142 offset:26240
    ds_read_b128 a[184:187], v143 offset:26368
    ds_read_b128 a[188:191], v142 offset:26368
    ds_read_b64_tr_b16 v[160:161], v136 offset:0
    ds_read_b64_tr_b16 v[162:163], v137 offset:1536
    ds_read_b64_tr_b16 v[164:165], v136 offset:12288
    ds_read_b64_tr_b16 v[166:167], v137 offset:13824
    ds_read_b64_tr_b16 v[168:169], v136 offset:24576
    ds_read_b64_tr_b16 v[170:171], v137 offset:26112
    ds_read_b64_tr_b16 v[172:173], v136 offset:36864
    ds_read_b64_tr_b16 v[174:175], v137 offset:38400
    ds_read_b64_tr_b16 v[176:177], v136 offset:49152
    ds_read_b64_tr_b16 v[178:179], v137 offset:50688
    ds_read_b64_tr_b16 v[180:181], v136 offset:61440
    ds_read_b64_tr_b16 v[182:183], v137 offset:62976
    ds_read_b64_tr_b16 v[184:185], v138 offset:0
    ds_read_b64_tr_b16 v[186:187], v139 offset:1536
    ds_read_b64_tr_b16 v[188:189], v138 offset:12288
    ds_read_b64_tr_b16 v[190:191], v139 offset:13824
    ds_read_b64_tr_b16 v[192:193], v138 offset:24576
    ds_read_b64_tr_b16 v[194:195], v139 offset:26112
    ds_read_b64_tr_b16 v[196:197], v138 offset:36864
    ds_read_b64_tr_b16 v[198:199], v139 offset:38400
    ds_read_b64_tr_b16 v[200:201], v138 offset:49152
    ds_read_b64_tr_b16 v[202:203], v139 offset:50688
    ds_read_b64_tr_b16 v[204:205], v138 offset:61440
    ds_read_b64_tr_b16 v[206:207], v139 offset:62976
    ds_read_b64_tr_b16 v[208:209], v140 offset:0
    ds_read_b64_tr_b16 v[210:211], v141 offset:1536
    ds_read_b64_tr_b16 v[212:213], v140 offset:12288
    ds_read_b64_tr_b16 v[214:215], v141 offset:13824
    ds_read_b64_tr_b16 v[216:217], v140 offset:24576
    ds_read_b64_tr_b16 v[218:219], v141 offset:26112
    ds_read_b64_tr_b16 v[220:221], v140 offset:36864
    ds_read_b64_tr_b16 v[222:223], v141 offset:38400
    ds_read_b64_tr_b16 v[224:225], v140 offset:49152
    ds_read_b64_tr_b16 v[226:227], v141 offset:50688
    ds_read_b64_tr_b16 v[228:229], v140 offset:61440
    ds_read_b64_tr_b16 v[230:231], v141 offset:62976
    s_waitcnt lgkmcnt(0)
    s_barrier
    s_mul_i32 s60, s3, 18432
    s_lshl_b32 s61, s43, 11
    s_add_u32 s60, s60, s61
    s_add_u32 s60, s60, 3145728
    v_mfma_f32_16x16x32_bf16 v[88:91], a[96:99], v[160:163], 0
    v_mfma_f32_16x16x32_bf16 v[92:95], a[120:123], v[160:163], 0
    v_mfma_f32_16x16x32_bf16 v[96:99], a[144:147], v[160:163], 0
    v_mfma_f32_16x16x32_bf16 v[100:103], a[168:171], v[160:163], 0
    buffer_load_dwordx4 v25, s[24:27], s58 offen offset:3072 nt lds
    v_mfma_f32_16x16x32_bf16 v[88:91], a[100:103], v[164:167], v[88:91]
    v_mfma_f32_16x16x32_bf16 v[92:95], a[124:127], v[164:167], v[92:95]
    v_mfma_f32_16x16x32_bf16 v[96:99], a[148:151], v[164:167], v[96:99]
    v_mfma_f32_16x16x32_bf16 v[100:103], a[172:175], v[164:167], v[100:103]
    s_add_u32 m0, s41, 4096
    s_nop 0
    buffer_load_dwordx4 v26, s[24:27], s58 offen offset:0 nt lds
    v_mfma_f32_16x16x32_bf16 v[88:91], a[104:107], v[168:171], v[88:91]
    v_mfma_f32_16x16x32_bf16 v[92:95], a[128:131], v[168:171], v[92:95]
    v_mfma_f32_16x16x32_bf16 v[96:99], a[152:155], v[168:171], v[96:99]
    v_mfma_f32_16x16x32_bf16 v[100:103], a[176:179], v[168:171], v[100:103]
    buffer_load_dwordx4 v27, s[24:27], s58 offen offset:1024 nt lds
    v_mfma_f32_16x16x32_bf16 v[88:91], a[108:111], v[172:175], v[88:91]
    v_mfma_f32_16x16x32_bf16 v[92:95], a[132:135], v[172:175], v[92:95]
    v_mfma_f32_16x16x32_bf16 v[96:99], a[156:159], v[172:175], v[96:99]
    v_mfma_f32_16x16x32_bf16 v[100:103], a[180:183], v[172:175], v[100:103]
    buffer_load_dwordx4 v28, s[24:27], s58 offen offset:2048 nt lds
    v_mfma_f32_16x16x32_bf16 v[88:91], a[112:115], v[176:179], v[88:91]
    v_mfma_f32_16x16x32_bf16 v[92:95], a[136:139], v[176:179], v[92:95]
    v_mfma_f32_16x16x32_bf16 v[96:99], a[160:163], v[176:179], v[96:99]
    v_mfma_f32_16x16x32_bf16 v[100:103], a[184:187], v[176:179], v[100:103]
    buffer_load_dwordx4 v29, s[24:27], s58 offen offset:3072 nt lds
    v_mfma_f32_16x16x32_bf16 v[88:91], a[116:119], v[180:183], v[88:91]
    v_mfma_f32_16x16x32_bf16 v[92:95], a[140:143], v[180:183], v[92:95]
    v_mfma_f32_16x16x32_bf16 v[96:99], a[164:167], v[180:183], v[96:99]
    v_mfma_f32_16x16x32_bf16 v[100:103], a[188:191], v[180:183], v[100:103]
    v_mfma_f32_16x16x32_bf16 v[104:107], a[96:99], v[184:187], 0
    v_mfma_f32_16x16x32_bf16 v[108:111], a[120:123], v[184:187], 0
    v_mfma_f32_16x16x32_bf16 v[112:115], a[144:147], v[184:187], 0
    v_mfma_f32_16x16x32_bf16 v[116:119], a[168:171], v[184:187], 0
    s_add_u32 m0, s41, 8192
    s_nop 0
    buffer_load_dwordx4 v30, s[24:27], s58 offen offset:0 nt lds
    v_mfma_f32_16x16x32_bf16 v[104:107], a[100:103], v[188:191], v[104:107]
    v_mfma_f32_16x16x32_bf16 v[108:111], a[124:127], v[188:191], v[108:111]
    v_mfma_f32_16x16x32_bf16 v[112:115], a[148:151], v[188:191], v[112:115]
    v_mfma_f32_16x16x32_bf16 v[116:119], a[172:175], v[188:191], v[116:119]
    buffer_load_dwordx4 v31, s[24:27], s58 offen offset:1024 nt lds
    v_mfma_f32_16x16x32_bf16 v[104:107], a[104:107], v[192:195], v[104:107]
    v_mfma_f32_16x16x32_bf16 v[108:111], a[128:131], v[192:195], v[108:111]
    v_mfma_f32_16x16x32_bf16 v[112:115], a[152:155], v[192:195], v[112:115]
    v_mfma_f32_16x16x32_bf16 v[116:119], a[176:179], v[192:195], v[116:119]
    buffer_load_dwordx4 v32, s[24:27], s58 offen offset:2048 nt lds
    v_cvt_pk_bf16_f32 v144, v88, v89
    v_cvt_pk_bf16_f32 v145, v90, v91
    v_cvt_pk_bf16_f32 v146, v92, v93
    v_cvt_pk_bf16_f32 v147, v94, v95
    buffer_store_dwordx4 v[144:147], v65, s[32:35], s60 offen offset:0 sc1
    v_cvt_pk_bf16_f32 v148, v96, v97
    v_cvt_pk_bf16_f32 v149, v98, v99
    v_cvt_pk_bf16_f32 v150, v100, v101
    v_cvt_pk_bf16_f32 v151, v102, v103
    buffer_store_dwordx4 v[148:151], v65, s[32:35], s60 offen offset:1024 sc1
    s_add_u32 s60, s60, 6144
    v_mfma_f32_16x16x32_bf16 v[104:107], a[108:111], v[196:199], v[104:107]
    v_mfma_f32_16x16x32_bf16 v[108:111], a[132:135], v[196:199], v[108:111]
    v_mfma_f32_16x16x32_bf16 v[112:115], a[156:159], v[196:199], v[112:115]
    v_mfma_f32_16x16x32_bf16 v[116:119], a[180:183], v[196:199], v[116:119]
    buffer_load_dwordx4 v33, s[24:27], s58 offen offset:3072 nt lds
    v_mfma_f32_16x16x32_bf16 v[104:107], a[112:115], v[200:203], v[104:107]
    v_mfma_f32_16x16x32_bf16 v[108:111], a[136:139], v[200:203], v[108:111]
    v_mfma_f32_16x16x32_bf16 v[112:115], a[160:163], v[200:203], v[112:115]
    v_mfma_f32_16x16x32_bf16 v[116:119], a[184:187], v[200:203], v[116:119]
    s_add_u32 m0, s42, 0
    s_add_u32 s59, s37, 196608
    buffer_load_dwordx4 v22, s[24:27], s59 offen offset:0 nt lds
    v_mfma_f32_16x16x32_bf16 v[104:107], a[116:119], v[204:207], v[104:107]
    v_mfma_f32_16x16x32_bf16 v[108:111], a[140:143], v[204:207], v[108:111]
    v_mfma_f32_16x16x32_bf16 v[112:115], a[164:167], v[204:207], v[112:115]
    v_mfma_f32_16x16x32_bf16 v[116:119], a[188:191], v[204:207], v[116:119]
    v_mfma_f32_16x16x32_bf16 v[120:123], a[96:99], v[208:211], 0
    v_mfma_f32_16x16x32_bf16 v[124:127], a[120:123], v[208:211], 0
    v_mfma_f32_16x16x32_bf16 v[128:131], a[144:147], v[208:211], 0
    v_mfma_f32_16x16x32_bf16 v[132:135], a[168:171], v[208:211], 0
    buffer_load_dwordx4 v23, s[24:27], s59 offen offset:1024 nt lds
    v_mfma_f32_16x16x32_bf16 v[120:123], a[100:103], v[212:215], v[120:123]
    v_mfma_f32_16x16x32_bf16 v[124:127], a[124:127], v[212:215], v[124:127]
    v_mfma_f32_16x16x32_bf16 v[128:131], a[148:151], v[212:215], v[128:131]
    v_mfma_f32_16x16x32_bf16 v[132:135], a[172:175], v[212:215], v[132:135]
    buffer_load_dwordx4 v24, s[24:27], s59 offen offset:2048 nt lds
    v_mfma_f32_16x16x32_bf16 v[120:123], a[104:107], v[216:219], v[120:123]
    v_mfma_f32_16x16x32_bf16 v[124:127], a[128:131], v[216:219], v[124:127]
    v_mfma_f32_16x16x32_bf16 v[128:131], a[152:155], v[216:219], v[128:131]
    v_mfma_f32_16x16x32_bf16 v[132:135], a[176:179], v[216:219], v[132:135]
    buffer_load_dwordx4 v25, s[24:27], s59 offen offset:3072 nt lds
    v_cvt_pk_bf16_f32 v152, v104, v105
    v_cvt_pk_bf16_f32 v153, v106, v107
    v_cvt_pk_bf16_f32 v154, v108, v109
    v_cvt_pk_bf16_f32 v155, v110, v111
    buffer_store_dwordx4 v[152:155], v65, s[32:35], s60 offen offset:0 sc1
    v_cvt_pk_bf16_f32 v156, v112, v113
    v_cvt_pk_bf16_f32 v157, v114, v115
    v_cvt_pk_bf16_f32 v158, v116, v117
    v_cvt_pk_bf16_f32 v159, v118, v119
    buffer_store_dwordx4 v[156:159], v65, s[32:35], s60 offen offset:1024 sc1
    s_add_u32 s60, s60, 6144
    v_mfma_f32_16x16x32_bf16 v[120:123], a[108:111], v[220:223], v[120:123]
    v_mfma_f32_16x16x32_bf16 v[124:127], a[132:135], v[220:223], v[124:127]
    v_mfma_f32_16x16x32_bf16 v[128:131], a[156:159], v[220:223], v[128:131]
    v_mfma_f32_16x16x32_bf16 v[132:135], a[180:183], v[220:223], v[132:135]
    s_add_u32 m0, s42, 4096
    s_nop 0
    buffer_load_dwordx4 v26, s[24:27], s59 offen offset:0 nt lds
    v_mfma_f32_16x16x32_bf16 v[120:123], a[112:115], v[224:227], v[120:123]
    v_mfma_f32_16x16x32_bf16 v[124:127], a[136:139], v[224:227], v[124:127]
    v_mfma_f32_16x16x32_bf16 v[128:131], a[160:163], v[224:227], v[128:131]
    v_mfma_f32_16x16x32_bf16 v[132:135], a[184:187], v[224:227], v[132:135]
    buffer_load_dwordx4 v27, s[24:27], s59 offen offset:1024 nt lds
    v_mfma_f32_16x16x32_bf16 v[120:123], a[116:119], v[228:231], v[120:123]
    v_mfma_f32_16x16x32_bf16 v[124:127], a[140:143], v[228:231], v[124:127]
    v_mfma_f32_16x16x32_bf16 v[128:131], a[164:167], v[228:231], v[128:131]
    v_mfma_f32_16x16x32_bf16 v[132:135], a[188:191], v[228:231], v[132:135]
    s_nop 4
    v_cvt_pk_bf16_f32 v144, v120, v121
    v_cvt_pk_bf16_f32 v145, v122, v123
    v_cvt_pk_bf16_f32 v146, v124, v125
    v_cvt_pk_bf16_f32 v147, v126, v127
    buffer_store_dwordx4 v[144:147], v65, s[32:35], s60 offen offset:0 sc1
    v_cvt_pk_bf16_f32 v148, v128, v129
    v_cvt_pk_bf16_f32 v149, v130, v131
    v_cvt_pk_bf16_f32 v150, v132, v133
    v_cvt_pk_bf16_f32 v151, v134, v135
    buffer_store_dwordx4 v[148:151], v65, s[32:35], s60 offen offset:1024 sc1
    v_and_b32 v1, 15, v0
    v_lshrrev_b32 v6, 5, v0
    v_bfe_u32 v3, v0, 4, 1
    v_lshl_or_b32 v3, v3, 1, v6
    v_lshrrev_b32 v4, 2, v0
    v_bfe_u32 v5, v0, 1, 1
    v_lshrrev_b32 v6, 3, v1
    v_and_or_b32 v6, v1, 6, v6
    v_xor_b32 v6, v6, v3
    v_mul_u32_u24 v7, 384, v1
    v_lshl_add_u32 v6, v6, 4, v7
    v_add_u32 v34, s40, v6
    v_xor_b32 v35, 64, v34
    v_lshrrev_b32 v6, 3, v1
    v_and_b32 v7, 7, v1
    v_lshl_or_b32 v6, v7, 1, v6
    v_xor_b32 v6, v6, v3
    v_mul_u32_u24 v7, 768, v1
    v_lshl_add_u32 v6, v6, 4, v7
    v_add_u32 v40, s41, v6
    v_xor_b32 v41, 0x40, v40
    v_xor_b32 v42, 0x80, v40
    v_xor_b32 v43, 0xc0, v40
    v_and_b32 v2, 1, v0
    v_lshlrev_b32 v2, 3, v2
    s_mul_i32 s56, s3, 96
    v_lshrrev_b32 v6, 3, v4
    v_and_or_b32 v6, v4, 6, v6
    v_xor_b32 v6, v6, v5
    v_lshl_add_u32 v6, v6, 4, v2
    v_mul_u32_u24 v7, 384, v4
    s_add_u32 s57, s56, 0
    v_xad_u32 v36, v6, s57, v7
    s_add_u32 s57, s56, 32
    v_xad_u32 v37, v6, s57, v7
    s_add_u32 s57, s56, 64
    v_xad_u32 v38, v6, s57, v7
    v_lshrrev_b32 v6, 3, v4
    v_and_b32 v3, 7, v4
    v_lshl_or_b32 v6, v3, 1, v6
    v_xor_b32 v6, v6, v5
    v_lshl_add_u32 v6, v6, 4, v2
    v_lshlrev_b32 v7, 1, v7
    v_add_u32 v7, 24576, v7
    s_add_u32 s57, s56, 0
    v_xad_u32 v44, v6, s57, v7
    s_add_u32 s57, s56, 384
    v_xad_u32 v45, v6, s57, v7
    s_add_u32 s57, s56, 32
    v_xad_u32 v46, v6, s57, v7
    s_add_u32 s57, s56, 416
    v_xad_u32 v47, v6, s57, v7
    s_add_u32 s57, s56, 64
    v_xad_u32 v48, v6, s57, v7
    s_add_u32 s57, s56, 448
    v_xad_u32 v49, v6, s57, v7
    v_mov_b32 v52, 0x3f803f80
    v_mov_b32 v56, 0x3ebcbe62
    s_mov_b32 s44, 0x100001
    s_mov_b32 s45, 0x10000100
    v_mov_b32 v53, 0x3f803f80
    v_mov_b32 v57, 0x3ebcbe62
    s_mov_b32 s46, 0x200002
    s_mov_b32 s47, 0x20000200
    v_mov_b32 v54, 0x3f803f80
    v_mov_b32 v58, 0x3ebcbe62
    s_mov_b32 s48, 0x400004
    s_mov_b32 s49, 0x40000400
    v_mov_b32 v55, 0x3f803f80
    v_mov_b32 v59, 0x3ebcbe62
    s_mov_b32 s50, 0x800008
    s_mov_b32 s51, 0x80000800
    v_mov_b32 v60, 0x43400000
    v_lshrrev_b32 v1, 5, v0
    v_lshlrev_b32 v1, 8, v1
    v_and_b32 v2, 15, v0
    v_lshl_add_u32 v1, v2, 4, v1
    v_bfe_u32 v2, v0, 4, 1
    v_lshl_add_u32 v1, v2, 3, v1
    s_mul_i32 s56, s3, 1536
    s_add_u32 s56, s56, 147456
    v_add_u32 v236, s56, v1
    s_mul_i32 s56, s3, 3072
    s_add_u32 s56, s56, 24576
    v_add_u32 v237, s56, v65
    v_add_u32 v238, s41, v65
    s_lshl_b32 s56, s3, 10
    v_add_u32 v240, 159744, v65
    v_add_u32 v239, s56, v240
    v_add_u32 v241, 147456, v65
    v_bfe_u32 v1, v0, 2, 2
    v_lshrrev_b32 v2, 4, v0
    v_lshl_or_b32 v1, v1, 4, v2
    v_mul_u32_u24 v1, 37120, v1
    v_and_b32 v2, 3, v0
    v_lshl_or_b32 v242, v2, 4, v1
    v_xor_b32 v243, 0x70, v242
    s_mul_i32 s56, s3, 3
    v_min_u32 v1, 2, v0
    v_add_u32 v1, s56, v1
    v_lshlrev_b32 v245, 7, v1
    v_lshlrev_b32 v1, 3, v0
    v_add_u32 v254, 126976, v1
    s_lshl_b32 s56, s3, 9
    v_add_u32 v238, s56, v254
    v_add_u32 v253, 122880, v65
    s_lshl_b32 s56, s3, 10
    v_add_u32 v237, s56, v253
    s_mov_b32 s52, 0x41c00000
    buffer_load_dwordx4 v28, s[24:27], s59 offen offset:2048 nt lds
    buffer_load_dwordx4 v29, s[24:27], s59 offen offset:3072 nt lds
    s_add_u32 m0, s42, 8192
    s_nop 0
    buffer_load_dwordx4 v30, s[24:27], s59 offen offset:0 nt lds
    buffer_load_dwordx4 v31, s[24:27], s59 offen offset:1024 nt lds
    buffer_load_dwordx4 v32, s[24:27], s59 offen offset:2048 nt lds
    buffer_load_dwordx4 v33, s[24:27], s59 offen offset:3072 nt lds
    s_branch L_join
L_xt3:
    s_call_b64 s[54:55], L_xslow
    s_branch L_post3
L_xt24:
    s_call_b64 s[54:55], L_xslow
    s_branch L_post24
L_xt6:
    s_call_b64 s[54:55], L_xslow
    s_branch L_post6
L_xt27:
    s_call_b64 s[54:55], L_xslow
    s_branch L_post27
L_xt9:
    s_call_b64 s[54:55], L_xslow
    s_branch L_post9
L_xt30:
    s_call_b64 s[54:55], L_xslow
    s_branch L_post30
L_xslow:
    s_waitcnt lgkmcnt(0)
    ds_write_b32 v239, v62
    s_waitcnt lgkmcnt(0)
    s_barrier
    ds_read_b32 v12, v240 offset:0
    ds_read_b32 v13, v240 offset:1024
    ds_read_b32 v14, v240 offset:2048
    ds_read_b32 v15, v240 offset:3072
    v_mov_b32 v9, 0
    ds_write_b32 v254, v9 offset:4096
    s_waitcnt lgkmcnt(0)
    v_min3_f32 v1, v12, v13, v14
    v_min_f32 v1, v1, v15
    v_sub_f32 v2, v1, v255
    v_sub_f32 v12, v1, v62
    v_exp_f32 v2, v2
    v_exp_f32 v12, v12
    v_mov_b32 v62, v1
    v_mov_b32 v255, v1
    v_mul_f32 v88, v88, v12
    v_mul_f32 v89, v89, v12
    v_mul_f32 v90, v90, v12
    v_mul_f32 v91, v91, v12
    v_mul_f32 v104, v104, v12
    v_mul_f32 v105, v105, v12
    v_mul_f32 v106, v106, v12
    v_mul_f32 v107, v107, v12
    v_mul_f32 v68, v68, v12
    v_mul_f32 v69, v69, v12
    v_mul_f32 v70, v70, v12
    v_mul_f32 v71, v71, v12
    v_mul_f32 v112, v112, v12
    v_mul_f32 v113, v113, v12
    v_mul_f32 v114, v114, v12
    v_mul_f32 v115, v115, v12
    v_mul_f32 v63, v63, v12
    v_mul_f32 v64, v64, v12
    v_accvgpr_read_b32 v1, a0
    v_mul_f32 v1, v1, v2
    v_accvgpr_write_b32 a0, v1
    v_accvgpr_read_b32 v1, a1
    v_mul_f32 v1, v1, v2
    v_accvgpr_write_b32 a1, v1
    v_accvgpr_read_b32 v1, a2
    v_mul_f32 v1, v1, v2
    v_accvgpr_write_b32 a2, v1
    v_accvgpr_read_b32 v1, a3
    v_mul_f32 v1, v1, v2
    v_accvgpr_write_b32 a3, v1
    v_accvgpr_read_b32 v1, a4
    v_mul_f32 v1, v1, v2
    v_accvgpr_write_b32 a4, v1
    v_accvgpr_read_b32 v1, a5
    v_mul_f32 v1, v1, v2
    v_accvgpr_write_b32 a5, v1
    v_accvgpr_read_b32 v1, a6
    v_mul_f32 v1, v1, v2
    v_accvgpr_write_b32 a6, v1
    v_accvgpr_read_b32 v1, a7
    v_mul_f32 v1, v1, v2
    v_accvgpr_write_b32 a7, v1
    v_accvgpr_read_b32 v1, a8
    v_mul_f32 v1, v1, v2
    v_accvgpr_write_b32 a8, v1
    v_accvgpr_read_b32 v1, a9
    v_mul_f32 v1, v1, v2
    v_accvgpr_write_b32 a9, v1
    v_accvgpr_read_b32 v1, a10
    v_mul_f32 v1, v1, v2
    v_accvgpr_write_b32 a10, v1
    v_accvgpr_read_b32 v1, a11
    v_mul_f32 v1, v1, v2
    v_accvgpr_write_b32 a11, v1
    v_cvt_pk_bf16_f32 v72, v88, v89
    v_cvt_pk_bf16_f32 v73, v90, v91
    v_cvt_pk_bf16_f32 v74, v104, v105
    v_cvt_pk_bf16_f32 v75, v106, v107
    ds_write_b128 v237, v[72:75]
    v_cvt_pk_bf16_f32 v66, v68, v69
    v_cvt_pk_bf16_f32 v67, v70, v71
    ds_write_b64 v238, v[66:67]
    s_waitcnt lgkmcnt(0)
    s_barrier
    s_setpc_b64 s[54:55]
L_xlast:
    s_waitcnt lgkmcnt(0)
    ds_write_b32 v239, v62
    s_waitcnt lgkmcnt(0)
    s_barrier
    ds_read_b32 v12, v240 offset:0
    ds_read_b32 v13, v240 offset:1024
    ds_read_b32 v14, v240 offset:2048
    ds_read_b32 v15, v240 offset:3072
    v_mov_b32 v9, 0
    ds_write_b32 v254, v9 offset:4096
    s_waitcnt lgkmcnt(0)
    v_min3_f32 v1, v12, v13, v14
    v_min_f32 v1, v1, v15
    v_sub_f32 v2, v1, v255
    v_sub_f32 v12, v1, v62
    v_exp_f32 v2, v2
    v_exp_f32 v12, v12
    v_mov_b32 v62, v1
    v_mov_b32 v255, v1
    v_mul_f32 v88, v88, v12
    v_mul_f32 v89, v89, v12
    v_mul_f32 v90, v90, v12
    v_mul_f32 v91, v91, v12
    v_mul_f32 v104, v104, v12
    v_mul_f32 v105, v105, v12
    v_mul_f32 v106, v106, v12
    v_mul_f32 v107, v107, v12
    v_mul_f32 v68, v68, v12
    v_mul_f32 v69, v69, v12
    v_mul_f32 v70, v70, v12
    v_mul_f32 v71, v71, v12
    v_mul_f32 v10, v10, v12
    v_mul_f32 v11, v11, v12
    v_mul_f32 v16, v16, v2
    v_mul_f32 v17, v17, v2
    v_mul_f32 v18, v18, v2
    v_mul_f32 v19, v19, v2
    v_mul_f32 v20, v20, v2
    v_mul_f32 v21, v21, v2
    v_mul_f32 v22, v22, v2
    v_mul_f32 v23, v23, v2
    v_mul_f32 v24, v24, v2
    v_mul_f32 v25, v25, v2
    v_mul_f32 v26, v26, v2
    v_mul_f32 v27, v27, v2
    v_cvt_pk_bf16_f32 v72, v88, v89
    v_cvt_pk_bf16_f32 v73, v90, v91
    v_cvt_pk_bf16_f32 v74, v104, v105
    v_cvt_pk_bf16_f32 v75, v106, v107
    ds_write_b128 v237, v[72:75]
    v_cvt_pk_bf16_f32 v66, v68, v69
    v_cvt_pk_bf16_f32 v67, v70, v71
    ds_write_b64 v238, v[66:67]
    ds_write_b64 v238, v[10:11] offset:2048
    s_waitcnt lgkmcnt(0)
    s_barrier
    s_branch L_postx
L_c_slow:
    s_cmp_eq_u32 s43, 0
    s_cbranch_scc1 L_c_out
    s_mov_b32 s43, 0
    buffer_load_dwordx4 v[76:79], v65, s[32:35], s60 offen offset:0 sc1
    buffer_load_dwordx4 v[80:83], v65, s[32:35], s60 offen offset:1024 sc1
    buffer_load_dwordx4 v[84:87], v65, s[32:35], s60 offen offset:2048 sc1
    buffer_load_dwordx4 v[108:111], v65, s[32:35], s60 offen offset:3072 sc1
    buffer_load_dwordx4 v[112:115], v65, s[32:35], s61 offen offset:0 sc1
    buffer_load_dwordx4 v[128:131], v65, s[32:35], s61 offen offset:1024 sc1
    buffer_load_dwordx4 v[132:135], v65, s[32:35], s61 offen offset:2048 sc1
    buffer_load_dwordx4 v[52:55], v65, s[32:35], s61 offen offset:3072 sc1
    s_waitcnt vmcnt(0)
    v_sub_u32 v49, v79, v247
    v_max_f32 v42, v42, v49
    v_sub_u32 v49, v83, v247
    v_max_f32 v42, v42, v49
    v_sub_u32 v49, v87, v247
    v_max_f32 v42, v42, v49
    v_sub_u32 v49, v111, v247
    v_max_f32 v42, v42, v49
    v_sub_u32 v49, v115, v247
    v_max_f32 v42, v42, v49
    v_sub_u32 v49, v131, v247
    v_max_f32 v42, v42, v49
    v_sub_u32 v49, v135, v247
    v_max_f32 v42, v42, v49
    v_sub_u32 v49, v55, v247
    v_max_f32 v42, v42, v49
    s_nop 1
    v_max_f32_dpp v42, v42, v42 row_ror:8 row_mask:0xf bank_mask:0xf
    v_mov_b32 v48, v42
    s_nop 1
    v_permlane32_swap_b32 v42, v48
    v_max_f32 v42, v42, v48
    v_mov_b32 v48, v42
    s_nop 1
    v_permlane16_swap_b32 v42, v48
    v_max_f32 v42, v42, v48
    s_lshl_b32 s56, s3, 2
    v_add_u32 v48, s56, v251
    ds_write_b32 v48, v42 offset:1024
    s_waitcnt lgkmcnt(0)
    s_barrier
    ds_read_b128 v[48:51], v251 offset:1024
    v_mov_b32 v16, 0
    v_mov_b32 v17, 0
    v_mov_b32 v18, 0
    v_mov_b32 v19, 0
    v_mov_b32 v20, 0
    v_mov_b32 v21, 0
    v_mov_b32 v22, 0
    s_waitcnt lgkmcnt(0)
    v_max3_f32 v42, v48, v49, v50
    v_max_f32 v42, v42, v51
    v_sub_u32 v49, v79, v247
    v_sub_f32 v49, v49, v42
    v_exp_f32 v49, v49
    s_nop 0
    v_cvt_pk_bf16_f32 v49, v49, 0
    v_lshlrev_b32 v50, 16, v49
    v_dot2_f32_bf16 v16, v76, v49, v16
    v_dot2_f32_bf16 v18, v77, v49, v18
    v_dot2_f32_bf16 v20, v78, v49, v20
    v_add_f32 v22, v22, v50
    v_dot2_f32_bf16 v17, v76, v50, v17
    v_dot2_f32_bf16 v19, v77, v50, v19
    v_dot2_f32_bf16 v21, v78, v50, v21
    v_sub_u32 v49, v83, v247
    v_sub_f32 v49, v49, v42
    v_exp_f32 v49, v49
    s_nop 0
    v_cvt_pk_bf16_f32 v49, v49, 0
    v_lshlrev_b32 v50, 16, v49
    v_dot2_f32_bf16 v16, v80, v49, v16
    v_dot2_f32_bf16 v18, v81, v49, v18
    v_dot2_f32_bf16 v20, v82, v49, v20
    v_add_f32 v22, v22, v50
    v_dot2_f32_bf16 v17, v80, v50, v17
    v_dot2_f32_bf16 v19, v81, v50, v19
    v_dot2_f32_bf16 v21, v82, v50, v21
    v_sub_u32 v49, v87, v247
    v_sub_f32 v49, v49, v42
    v_exp_f32 v49, v49
    s_nop 0
    v_cvt_pk_bf16_f32 v49, v49, 0
    v_lshlrev_b32 v50, 16, v49
    v_dot2_f32_bf16 v16, v84, v49, v16
    v_dot2_f32_bf16 v18, v85, v49, v18
    v_dot2_f32_bf16 v20, v86, v49, v20
    v_add_f32 v22, v22, v50
    v_dot2_f32_bf16 v17, v84, v50, v17
    v_dot2_f32_bf16 v19, v85, v50, v19
    v_dot2_f32_bf16 v21, v86, v50, v21
    v_sub_u32 v49, v111, v247
    v_sub_f32 v49, v49, v42
    v_exp_f32 v49, v49
    s_nop 0
    v_cvt_pk_bf16_f32 v49, v49, 0
    v_lshlrev_b32 v50, 16, v49
    v_dot2_f32_bf16 v16, v108, v49, v16
    v_dot2_f32_bf16 v18, v109, v49, v18
    v_dot2_f32_bf16 v20, v110, v49, v20
    v_add_f32 v22, v22, v50
    v_dot2_f32_bf16 v17, v108, v50, v17
    v_dot2_f32_bf16 v19, v109, v50, v19
    v_dot2_f32_bf16 v21, v110, v50, v21
    v_sub_u32 v49, v115, v247
    v_sub_f32 v49, v49, v42
    v_exp_f32 v49, v49
    s_nop 0
    v_cvt_pk_bf16_f32 v49, v49, 0
    v_lshlrev_b32 v50, 16, v49
    v_dot2_f32_bf16 v16, v112, v49, v16
    v_dot2_f32_bf16 v18, v113, v49, v18
    v_dot2_f32_bf16 v20, v114, v49, v20
    v_add_f32 v22, v22, v50
    v_dot2_f32_bf16 v17, v112, v50, v17
    v_dot2_f32_bf16 v19, v113, v50, v19
    v_dot2_f32_bf16 v21, v114, v50, v21
    v_sub_u32 v49, v131, v247
    v_sub_f32 v49, v49, v42
    v_exp_f32 v49, v49
    s_nop 0
    v_cvt_pk_bf16_f32 v49, v49, 0
    v_lshlrev_b32 v50, 16, v49
    v_dot2_f32_bf16 v16, v128, v49, v16
    v_dot2_f32_bf16 v18, v129, v49, v18
    v_dot2_f32_bf16 v20, v130, v49, v20
    v_add_f32 v22, v22, v50
    v_dot2_f32_bf16 v17, v128, v50, v17
    v_dot2_f32_bf16 v19, v129, v50, v19
    v_dot2_f32_bf16 v21, v130, v50, v21
    v_sub_u32 v49, v135, v247
    v_sub_f32 v49, v49, v42
    v_exp_f32 v49, v49
    s_nop 0
    v_cvt_pk_bf16_f32 v49, v49, 0
    v_lshlrev_b32 v50, 16, v49
    v_dot2_f32_bf16 v16, v132, v49, v16
    v_dot2_f32_bf16 v18, v133, v49, v18
    v_dot2_f32_bf16 v20, v134, v49, v20
    v_add_f32 v22, v22, v50
    v_dot2_f32_bf16 v17, v132, v50, v17
    v_dot2_f32_bf16 v19, v133, v50, v19
    v_dot2_f32_bf16 v21, v134, v50, v21
    v_sub_u32 v49, v55, v247
    v_sub_f32 v49, v49, v42
    v_exp_f32 v49, v49
    s_nop 0
    v_cvt_pk_bf16_f32 v49, v49, 0
    v_lshlrev_b32 v50, 16, v49
    v_dot2_f32_bf16 v16, v52, v49, v16
    v_dot2_f32_bf16 v18, v53, v49, v18
    v_dot2_f32_bf16 v20, v54, v49, v20
    v_add_f32 v22, v22, v50
    v_dot2_f32_bf16 v17, v52, v50, v17
    v_dot2_f32_bf16 v19, v53, v50, v19
    v_dot2_f32_bf16 v21, v54, v50, v21
    s_nop 2
    s_branch L_c_red
L_qk_retry:
    s_mov_b32 s53, 0
L_qk_again:
    s_mul_i32 s56, s3, 3072
    s_add_u32 s56, s56, 16384
    buffer_load_dwordx4 v[136:139], v65, s[32:35], s56 offen offset:0 sc1
    buffer_load_dwordx4 v[140:143], v65, s[32:35], s56 offen offset:1024 sc1
    buffer_load_dwordx4 v[144:147], v65, s[32:35], s56 offen offset:2048 sc1
    s_add_u32 s53, s53, 1
    s_waitcnt vmcnt(0)
    v_xor_b32 v1, s39, v138
    v_xor_b32 v2, s39, v142
    v_xor_b32 v3, s39, v146
    v_or3_b32 v1, v1, v2, v3
    v_cmp_ne_u32 vcc, 0, v1
    s_cbranch_vccz L_qk_ok
    s_cmp_lt_u32 s53, 65536
    s_cbranch_scc1 L_qk_again
    s_branch L_qk_ok
L_fl_retry:
    s_mov_b32 s53, 0
L_fl_again:
    buffer_load_dword v244, v245, s[32:35], 0 offen offset:128 sc1
    s_add_u32 s53, s53, 1
    s_waitcnt vmcnt(0)
    v_cmp_ne_u32 vcc, s39, v244
    s_cbranch_vccz L_fl_ok
    s_cmp_lt_u32 s53, 65536
    s_cbranch_scc1 L_fl_again
    s_branch L_fl_ok
L_site0:
    s_call_b64 s[54:55], L_rare2
    s_branch L_back0
L_site1:
    s_call_b64 s[54:55], L_rare3
    s_branch L_back1
L_site2:
    s_call_b64 s[54:55], L_rare2
    s_branch L_back2
L_site3:
    s_call_b64 s[54:55], L_rare3
    s_branch L_back3
L_site4:
    s_call_b64 s[54:55], L_rare2
    s_branch L_back4
L_site5:
    s_call_b64 s[54:55], L_rare3
    s_branch L_back5
L_site6:
    s_call_b64 s[54:55], L_rare2
    s_branch L_back6
L_site7:
    s_call_b64 s[54:55], L_rare3
    s_branch L_back7
L_site8:
    s_call_b64 s[54:55], L_rare2
    s_branch L_back8
L_site9:
    s_call_b64 s[54:55], L_rare3
    s_branch L_back9
L_site10:
    s_call_b64 s[54:55], L_rare2
    s_branch L_back10
L_site11:
    s_call_b64 s[54:55], L_rare3
    s_branch L_back11
L_site12:
    s_call_b64 s[54:55], L_rare2
    s_branch L_back12
L_site13:
    s_call_b64 s[54:55], L_rare3
    s_branch L_back13
L_rare2:
    s_nop 7
    s_nop 7
    v_mov_b32 v2, v1
    s_nop 1
    v_permlane32_swap_b32 v1, v2
    v_max_f32 v1, v1, v2
    v_mov_b32 v2, v1
    s_nop 1
    v_permlane16_swap_b32 v1, v2
    v_max_f32 v1, v1, v2
    v_max_f32 v1, 0, v1
    v_sub_f32 v62, v62, v1
    v_sub_f32 v88, v88, v1
    v_sub_f32 v89, v89, v1
    v_sub_f32 v90, v90, v1
    v_sub_f32 v91, v91, v1
    v_sub_f32 v1, 0, v1
    v_exp_f32 v1, v1
    s_nop 0
    v_mul_f32 v63, v63, v1
    v_mul_f32 v64, v64, v1
    v_mul_f32 v68, v68, v1
    v_mul_f32 v69, v69, v1
    v_mul_f32 v70, v70, v1
    v_mul_f32 v71, v71, v1
    v_mov_b32 v2, 1
    ds_write_b32 v254, v2 offset:4096
    s_waitcnt lgkmcnt(0)
    s_nop 3
    s_setpc_b64 s[54:55]
L_rare3:
    s_nop 7
    s_nop 7
    v_mov_b32 v2, v1
    s_nop 1
    v_permlane32_swap_b32 v1, v2
    v_max_f32 v1, v1, v2
    v_mov_b32 v2, v1
    s_nop 1
    v_permlane16_swap_b32 v1, v2
    v_max_f32 v1, v1, v2
    v_max_f32 v1, 0, v1
    v_sub_f32 v62, v62, v1
    v_sub_f32 v104, v104, v1
    v_sub_f32 v105, v105, v1
    v_sub_f32 v106, v106, v1
    v_sub_f32 v107, v107, v1
    v_sub_f32 v1, 0, v1
    v_exp_f32 v1, v1
    s_nop 0
    v_mul_f32 v63, v63, v1
    v_mul_f32 v64, v64, v1
    v_mul_f32 v68, v68, v1
    v_mul_f32 v69, v69, v1
    v_mul_f32 v70, v70, v1
    v_mul_f32 v71, v71, v1
    v_mul_f32 v88, v88, v1
    v_mul_f32 v89, v89, v1
    v_mul_f32 v90, v90, v1
    v_mul_f32 v91, v91, v1
    v_mov_b32 v2, 1
    ds_write_b32 v254, v2 offset:4096
    s_waitcnt lgkmcnt(0)
    s_nop 3
    s_setpc_b64 s[54:55]
L_codeend:
.section .rodata,"a"
.p2align 6
.amdhsa_kernel standalone__detection_seg_dino__vision_kernel
  .amdhsa_next_free_vgpr 448
  .amdhsa_next_free_sgpr 102
  .amdhsa_accum_offset 256
  .amdhsa_group_segment_fixed_size 0
  .amdhsa_kernarg_size 80
  .amdhsa_user_sgpr_count 2
  .amdhsa_user_sgpr_kernarg_segment_ptr 1
  .amdhsa_system_sgpr_workgroup_id_x 1
  .amdhsa_float_denorm_mode_32 3
.end_amdhsa_kernel
```

```asm
; @launch grid=(256,1,1) block=(256,1,1) lds=163840
.amdgcn_target "amdgcn-amd-amdhsa--gfx950"
.text
.globl standalone__detection_seg_dino__vision_kernel
.p2align 8
.type standalone__detection_seg_dino__vision_kernel,@function
standalone__detection_seg_dino__vision_kernel:
    s_cmp_ge_u32 s2, 256
    s_cbranch_scc1 L_end
    s_load_dwordx16 s[4:19], s[0:1], 0
    s_load_dwordx4 s[20:23], s[0:1], 64
    s_getpc_b64 s[54:55]
L_pc_main:
    v_lshlrev_b32 v233, 7, v0
    v_min_u32 v233, L_codeend - L_pc_main - 4, v233
    global_load_dword v232, v233, s[54:55]
    s_mov_b64 s[100:101], s[54:55]
    v_lshrrev_b32 v1, 6, v0
    v_and_b32 v0, 63, v0
    v_readfirstlane_b32 s3, v1
    v_lshlrev_b32 v65, 4, v0
    v_lshrrev_b32 v1, 2, v0
    v_and_b32 v1, 14, v1
    s_mov_b32 s56, 0x5000
    v_bfe_u32 v2, s56, v1, 2
    v_lshlrev_b32 v2, 5, v2
    v_xor_b32 v16, v65, v2
    s_mov_b32 s56, 0xaa55
    v_bfe_u32 v2, s56, v1, 2
    v_lshlrev_b32 v2, 5, v2
    v_xor_b32 v17, v65, v2
    s_mov_b32 s56, 0xfffa
    v_bfe_u32 v2, s56, v1, 2
    v_lshlrev_b32 v2, 5, v2
    v_xor_b32 v18, v65, v2
    v_xor_b32 v19, 16, v16
    v_xor_b32 v20, 0x1010, v17
    v_xor_b32 v21, 0x1010, v18
    v_lshrrev_b32 v1, 3, v0
    v_and_b32 v1, 6, v1
    s_mov_b32 s56, 0x40
    v_bfe_u32 v2, s56, v1, 2
    v_lshlrev_b32 v2, 5, v2
    v_xor_b32 v22, v65, v2
    s_mov_b32 s56, 0xa5
    v_bfe_u32 v2, s56, v1, 2
    v_lshlrev_b32 v2, 5, v2
    v_xor_b32 v23, v65, v2
    s_mov_b32 s56, 0xfe
    v_bfe_u32 v2, s56, v1, 2
    v_lshlrev_b32 v2, 5, v2
    v_xor_b32 v24, v65, v2
    v_xor_b32 v25, 0x80, v22
    v_xor_b32 v26, 0x1080, v23
    v_xor_b32 v27, 0x1080, v24
    v_xor_b32 v28, 0x1010, v22
    v_xor_b32 v29, 0x1010, v23
    v_xor_b32 v30, 0x2010, v24
    v_xor_b32 v31, 0x2090, v22
    v_xor_b32 v32, 0x2090, v23
    v_xor_b32 v33, 0x2090, v24
    v_mov_b32 v248, 0x10000
    s_mul_i32 s36, s3, 6144
    s_mul_i32 s37, s3, 12288
    s_add_u32 s40, s36, 0
    s_add_u32 s41, s37, 24576
    s_add_u32 s42, s37, 73728
    s_mul_i32 s56, s2, 393216
    s_mul_i32 s57, s2, 98304
    s_mov_b64 s[60:61], s[56:57]
    s_mov_b32 s30, 98304
    s_mov_b32 s31, 0x20000
    s_mov_b32 s26, 393216
    s_mov_b32 s27, 0x20000
    s_mov_b32 s34, 8388608
    s_mov_b32 s35, 0x20000
    s_mov_b32 m0, s40
    s_and_b32 s56, s2, 7
    s_cmp_eq_u32 s56, 6
    s_cbranch_scc1 L_spec
    s_and_b32 s56, s2, 7
    s_cbranch_scc1 L_plain
L_spec:
    s_waitcnt lgkmcnt(0)
    s_add_u32 s28, s8, s61
    s_addc_u32 s29, s9, 0
    s_add_u32 s24, s6, s60
    s_addc_u32 s25, s7, 0
    s_mov_b64 s[32:33], s[22:23]
    s_lshr_b32 s43, s2, 3
    s_mul_i32 s57, s43, 2304
    v_min_u32 v1, 17, v0
    v_lshlrev_b32 v1, 7, v1
    s_mov_b32 s66, 73728
    s_mov_b32 s67, 0x20000
    s_mov_b32 s70, 73728
    s_mov_b32 s71, 0x20000
    s_mov_b32 s72, s4
    s_mov_b32 s73, s5
    s_mov_b32 s74, 6144
    s_mov_b32 s75, 0x20000
    s_bitcmp1_b32 s2, 2
    s_cselect_b64 s[64:65], s[16:17], s[10:11]
    s_cselect_b64 s[68:69], s[14:15], s[12:13]
    s_cmp_eq_u32 s3, 0
    s_cbranch_scc1 L_pf0
    s_cmp_eq_u32 s3, 1
    s_cbranch_scc0 L_pfdone
    s_lshl_b32 s58, s43, 8
    buffer_load_dword v234, v1, s[68:71], s57 offen
    v_min_u32 v2, 128, v1
    buffer_load_dword v235, v2, s[72:75], s58 offen
    s_branch L_pfdone
L_pf0:
    buffer_load_dword v234, v1, s[64:67], s57 offen
L_pfdone:
    s_cmp_ge_u32 s43, 3
    s_cbranch_scc1 L_nopf
    s_mov_b32 s0, 1
    s_bitcmp1_b32 s2, 2
    s_cbranch_scc0 L_prod
    s_branch L_vprod
L_plain:
    s_waitcnt lgkmcnt(0)
L_nopf:
    s_add_u32 s28, s8, s61
    s_addc_u32 s29, s9, 0
    buffer_load_dwordx4 v16, s[28:31], s36 offen offset:0 nt lds
    s_add_u32 s24, s6, s60
    s_addc_u32 s25, s7, 0
    s_mov_b64 s[32:33], s[22:23]
    s_mov_b32 s0, 0
    buffer_load_dwordx4 v17, s[28:31], s36 offen offset:1024 nt lds
    buffer_load_dwordx4 v18, s[28:31], s36 offen offset:2048 nt lds
    buffer_load_dwordx4 v19, s[28:31], s36 offen offset:3072 nt lds
    s_add_u32 m0, s40, 4096
    s_load_dword s38, s[22:23], 0
    buffer_load_dwordx4 v20, s[28:31], s36 offen offset:0 nt lds
    buffer_load_dwordx4 v21, s[28:31], s36 offen offset:1024 nt lds
    s_mov_b32 s43, -1
    s_sub_u32 s59, s2, 64
    s_cmp_ge_u32 s59, 64
    s_cbranch_scc1 L_nocs
    s_mov_b32 s64, s4
    s_mov_b32 s65, s5
    s_mov_b32 s66, 6144
    s_mov_b32 s67, 0x20000
    s_mov_b32 s68, s18
    s_mov_b32 s69, s19
    s_mov_b32 s70, 6144
    s_mov_b32 s71, 0x20000
    v_bfe_u32 v1, v0, 2, 1
    v_mul_u32_u24 v2, 7, v1
    v_xor_b32 v2, v0, v2
    v_and_b32 v2, 3, v2
    s_lshr_b32 s56, s59, 4
    s_lshl_b32 s56, s56, 2
    v_add_u32 v2, s56, v2
    v_lshlrev_b32 v252, 2, v2
    v_lshrrev_b32 v3, 4, v0
    v_mad_u32_u24 v3, v1, 3, v3
    v_lshrrev_b32 v4, 1, v3
    v_and_b32 v3, 1, v3
    v_lshlrev_b32 v3, 2, v3
    v_lshl_add_u32 v3, v4, 5, v3
    v_bfe_u32 v4, v0, 3, 1
    v_lshl_add_u32 v3, v4, 1, v3
    v_mul_u32_u24 v2, 384, v2
    s_bfe_u32 s56, s59, 0x20002
    s_mul_i32 s56, s56, 96
    s_and_b32 s57, s59, 3
    s_lshl_b32 s57, s57, 3
    s_add_u32 s56, s56, s57
    v_add3_u32 v248, s56, v2, v3
    v_cmp_gt_u32 vcc, 48, v0
    v_mov_b32 v4, 0x10000
    s_lshl_b32 s56, s3, 2
    v_cndmask_b32 v248, v4, v248, vcc
    buffer_load_ushort v249, v248, s[64:67], 0 offen
    buffer_load_ushort v246, v248, s[68:71], 0 offen
    v_add_u32 v250, s56, v65
    v_and_b32 v251, 0x70, v65
L_nocs:
    s_add_u32 m0, s41, 0
    s_add_u32 s58, s37, 0
    buffer_load_dwordx4 v22, s[24:27], s58 offen offset:0 nt lds
    buffer_load_dwordx4 v23, s[24:27], s58 offen offset:1024 nt lds
    buffer_load_dwordx4 v24, s[24:27], s58 offen offset:2048 nt lds
    buffer_load_dwordx4 v25, s[24:27], s58 offen offset:3072 nt lds
    s_add_u32 m0, s41, 4096
    s_nop 0
    buffer_load_dwordx4 v26, s[24:27], s58 offen offset:0 nt lds
    buffer_load_dwordx4 v27, s[24:27], s58 offen offset:1024 nt lds
    buffer_load_dwordx4 v28, s[24:27], s58 offen offset:2048 nt lds
    buffer_load_dwordx4 v29, s[24:27], s58 offen offset:3072 nt lds
    s_add_u32 m0, s41, 8192
    s_nop 0
    buffer_load_dwordx4 v30, s[24:27], s58 offen offset:0 nt lds
    buffer_load_dwordx4 v31, s[24:27], s58 offen offset:1024 nt lds
    buffer_load_dwordx4 v32, s[24:27], s58 offen offset:2048 nt lds
    buffer_load_dwordx4 v33, s[24:27], s58 offen offset:3072 nt lds
    s_add_u32 m0, s42, 0
    s_add_u32 s59, s37, 196608
    buffer_load_dwordx4 v22, s[24:27], s59 offen offset:0 nt lds
    buffer_load_dwordx4 v23, s[24:27], s59 offen offset:1024 nt lds
    buffer_load_dwordx4 v24, s[24:27], s59 offen offset:2048 nt lds
    buffer_load_dwordx4 v25, s[24:27], s59 offen offset:3072 nt lds
    s_add_u32 m0, s42, 4096
    s_nop 0
    buffer_load_dwordx4 v26, s[24:27], s59 offen offset:0 nt lds
    buffer_load_dwordx4 v27, s[24:27], s59 offen offset:1024 nt lds
    buffer_load_dwordx4 v28, s[24:27], s59 offen offset:2048 nt lds
    buffer_load_dwordx4 v29, s[24:27], s59 offen offset:3072 nt lds
    s_add_u32 m0, s42, 8192
    s_nop 0
    buffer_load_dwordx4 v30, s[24:27], s59 offen offset:0 nt lds
    buffer_load_dwordx4 v31, s[24:27], s59 offen offset:1024 nt lds
    buffer_load_dwordx4 v32, s[24:27], s59 offen offset:2048 nt lds
    buffer_load_dwordx4 v33, s[24:27], s59 offen offset:3072 nt lds
    v_and_b32 v1, 15, v0
    v_lshrrev_b32 v6, 5, v0
    v_bfe_u32 v3, v0, 4, 1
    v_lshl_or_b32 v3, v3, 1, v6
    v_lshrrev_b32 v4, 2, v0
    v_bfe_u32 v5, v0, 1, 1
    v_lshrrev_b32 v6, 3, v1
    v_and_or_b32 v6, v1, 6, v6
    v_xor_b32 v6, v6, v3
    v_mul_u32_u24 v7, 384, v1
    v_lshl_add_u32 v6, v6, 4, v7
    v_add_u32 v34, s40, v6
    v_xor_b32 v35, 64, v34
    v_lshrrev_b32 v6, 3, v1
    v_and_b32 v7, 7, v1
    v_lshl_or_b32 v6, v7, 1, v6
    v_xor_b32 v6, v6, v3
    v_mul_u32_u24 v7, 768, v1
    v_lshl_add_u32 v6, v6, 4, v7
    v_add_u32 v40, s41, v6
    v_xor_b32 v41, 0x40, v40
    v_xor_b32 v42, 0x80, v40
    v_xor_b32 v43, 0xc0, v40
    v_and_b32 v2, 1, v0
    v_lshlrev_b32 v2, 3, v2
    s_mul_i32 s56, s3, 96
    v_lshrrev_b32 v6, 3, v4
    v_and_or_b32 v6, v4, 6, v6
    v_xor_b32 v6, v6, v5
    v_lshl_add_u32 v6, v6, 4, v2
    v_mul_u32_u24 v7, 384, v4
    s_add_u32 s57, s56, 0
    v_xad_u32 v36, v6, s57, v7
    s_add_u32 s57, s56, 32
    v_xad_u32 v37, v6, s57, v7
    s_add_u32 s57, s56, 64
    v_xad_u32 v38, v6, s57, v7
    v_lshrrev_b32 v6, 3, v4
    v_and_b32 v3, 7, v4
    v_lshl_or_b32 v6, v3, 1, v6
    v_xor_b32 v6, v6, v5
    v_lshl_add_u32 v6, v6, 4, v2
    v_lshlrev_b32 v7, 1, v7
    v_add_u32 v7, 24576, v7
    s_add_u32 s57, s56, 0
    v_xad_u32 v44, v6, s57, v7
    s_add_u32 s57, s56, 384
    v_xad_u32 v45, v6, s57, v7
    s_add_u32 s57, s56, 32
    v_xad_u32 v46, v6, s57, v7
    s_add_u32 s57, s56, 416
    v_xad_u32 v47, v6, s57, v7
    s_add_u32 s57, s56, 64
    v_xad_u32 v48, v6, s57, v7
    s_add_u32 s57, s56, 448
    v_xad_u32 v49, v6, s57, v7
    v_mov_b32 v52, 0x3f803f80
    v_mov_b32 v56, 0x3ebcbe62
    s_mov_b32 s44, 0x100001
    s_mov_b32 s45, 0x10000100
    v_mov_b32 v53, 0x3f803f80
    v_mov_b32 v57, 0x3ebcbe62
    s_mov_b32 s46, 0x200002
    s_mov_b32 s47, 0x20000200
    v_mov_b32 v54, 0x3f803f80
    v_mov_b32 v58, 0x3ebcbe62
    s_mov_b32 s48, 0x400004
    s_mov_b32 s49, 0x40000400
    v_mov_b32 v55, 0x3f803f80
    v_mov_b32 v59, 0x3ebcbe62
    s_mov_b32 s50, 0x800008
    s_mov_b32 s51, 0x80000800
    v_mov_b32 v60, 0x43400000
    v_lshrrev_b32 v1, 5, v0
    v_lshlrev_b32 v1, 8, v1
    v_and_b32 v2, 15, v0
    v_lshl_add_u32 v1, v2, 4, v1
    v_bfe_u32 v2, v0, 4, 1
    v_lshl_add_u32 v1, v2, 3, v1
    s_mul_i32 s56, s3, 1536
    s_add_u32 s56, s56, 147456
    v_add_u32 v236, s56, v1
    s_mul_i32 s56, s3, 3072
    s_add_u32 s56, s56, 24576
    v_add_u32 v237, s56, v65
    v_add_u32 v238, s41, v65
    s_lshl_b32 s56, s3, 10
    v_add_u32 v240, 159744, v65
    v_add_u32 v239, s56, v240
    v_add_u32 v241, 147456, v65
    v_bfe_u32 v1, v0, 2, 2
    v_lshrrev_b32 v2, 4, v0
    v_lshl_or_b32 v1, v1, 4, v2
    v_mul_u32_u24 v1, 37120, v1
    v_and_b32 v2, 3, v0
    v_lshl_or_b32 v242, v2, 4, v1
    v_xor_b32 v243, 0x70, v242
    s_mul_i32 s56, s3, 3
    v_min_u32 v1, 2, v0
    v_add_u32 v1, s56, v1
    v_lshlrev_b32 v245, 7, v1
    v_lshlrev_b32 v1, 3, v0
    v_add_u32 v254, 126976, v1
    s_lshl_b32 s56, s3, 9
    v_add_u32 v238, s56, v254
    v_add_u32 v253, 122880, v65
    s_lshl_b32 s56, s3, 10
    v_add_u32 v237, s56, v253
    s_mov_b32 s52, 0x41c00000
L_join:
    s_mul_i32 s60, s3, 18432
    s_mov_b32 s72, s22
    s_mov_b32 s73, s23
    s_mov_b32 s74, 8388608
    s_mov_b32 s75, 0x20000
    s_cmp_eq_u32 s0, 1
    s_cselect_b32 s74, 0, s74
    s_waitcnt vmcnt(24)
    s_waitcnt lgkmcnt(0)
    s_barrier
    ds_read_b128 a[48:51], v34 offset:0
    ds_read_b128 a[52:55], v35 offset:0
    ds_read_b128 a[56:59], v34 offset:128
    ds_read_b128 a[60:63], v35 offset:128
    ds_read_b128 a[64:67], v34 offset:256
    ds_read_b128 a[68:71], v35 offset:256
    s_waitcnt lgkmcnt(5)
    v_mfma_f32_16x16x32_bf16 v[84:87], a[48:51], a[48:51], 0
    ds_read_b64_tr_b16 a[72:73], v36 offset:0
    ds_read_b64_tr_b16 a[74:75], v36 offset:6144
    v_mfma_f32_16x16x32_bf16 v[80:83], a[48:51], v[52:55], 0
    ds_read_b64_tr_b16 a[76:77], v36 offset:12288
    ds_read_b64_tr_b16 a[78:79], v36 offset:18432
    s_waitcnt lgkmcnt(8)
    v_mfma_f32_16x16x32_bf16 v[84:87], a[52:55], a[52:55], v[84:87]
    ds_read_b64_tr_b16 a[80:81], v37 offset:0
    ds_read_b64_tr_b16 a[82:83], v37 offset:6144
    v_mfma_f32_16x16x32_bf16 v[80:83], a[52:55], v[52:55], v[80:83]
    ds_read_b64_tr_b16 a[84:85], v37 offset:12288
    ds_read_b64_tr_b16 a[86:87], v37 offset:18432
    s_waitcnt lgkmcnt(11)
    v_mfma_f32_16x16x32_bf16 v[84:87], a[56:59], a[56:59], v[84:87]
    ds_read_b64_tr_b16 a[88:89], v38 offset:0
    ds_read_b64_tr_b16 a[90:91], v38 offset:6144
    v_mfma_f32_16x16x32_bf16 v[80:83], a[56:59], v[52:55], v[80:83]
    ds_read_b64_tr_b16 a[92:93], v38 offset:12288
    ds_read_b64_tr_b16 a[94:95], v38 offset:18432
    s_waitcnt lgkmcnt(14)
    v_mfma_f32_16x16x32_bf16 v[84:87], a[60:63], a[60:63], v[84:87]
    v_mfma_f32_16x16x32_bf16 v[80:83], a[60:63], v[52:55], v[80:83]
    s_waitcnt lgkmcnt(13)
    v_mfma_f32_16x16x32_bf16 v[84:87], a[64:67], a[64:67], v[84:87]
    v_mfma_f32_16x16x32_bf16 v[80:83], a[64:67], v[52:55], v[80:83]
    s_waitcnt lgkmcnt(12)
    v_mfma_f32_16x16x32_bf16 v[84:87], a[68:71], a[68:71], v[84:87]
    v_mfma_f32_16x16x32_bf16 v[80:83], a[68:71], v[52:55], v[80:83]
    s_waitcnt lgkmcnt(0)
    s_mul_i32 s39, s38, 0x9e3779b1
    s_add_u32 s39, s39, 0x7f4a7c16
    s_or_b32 s39, s39, 1
    s_mul_i32 s56, s3, 3072
    s_add_u32 s56, s56, 16384
    buffer_load_dwordx4 v[136:139], v65, s[32:35], s56 offen offset:0 sc1
    buffer_load_dwordx4 v[140:143], v65, s[32:35], s56 offen offset:1024 sc1
    buffer_load_dwordx4 v[144:147], v65, s[32:35], s56 offen offset:2048 sc1
    s_waitcnt vmcnt(15)
    s_barrier
    ds_read_b128 a[96:99], v40 offset:0
    ds_read_b128 a[100:103], v41 offset:0
    ds_read_b128 a[104:107], v42 offset:0
    ds_read_b128 a[108:111], v43 offset:0
    ds_read_b128 a[112:115], v40 offset:256
    ds_read_b128 a[116:119], v41 offset:256
    ds_read_b128 a[120:123], v42 offset:256
    ds_read_b128 a[124:127], v43 offset:256
    ds_read_b128 a[128:131], v40 offset:512
    ds_read_b128 a[132:135], v41 offset:512
    ds_read_b128 a[136:139], v42 offset:512
    ds_read_b128 a[140:143], v43 offset:512
    ds_read_b64_tr_b16 a[144:145], v44 offset:0
    ds_read_b64_tr_b16 a[146:147], v45 offset:0
    ds_read_b64_tr_b16 a[148:149], v44 offset:12288
    ds_read_b64_tr_b16 a[150:151], v45 offset:12288
    ds_read_b64_tr_b16 a[152:153], v44 offset:24576
    ds_read_b64_tr_b16 a[154:155], v45 offset:24576
    ds_read_b64_tr_b16 a[156:157], v44 offset:36864
    ds_read_b64_tr_b16 a[158:159], v45 offset:36864
    ds_read_b64_tr_b16 a[160:161], v46 offset:0
    ds_read_b64_tr_b16 a[162:163], v47 offset:0
    ds_read_b64_tr_b16 a[164:165], v46 offset:12288
    ds_read_b64_tr_b16 a[166:167], v47 offset:12288
    ds_read_b64_tr_b16 a[168:169], v46 offset:24576
    ds_read_b64_tr_b16 a[170:171], v47 offset:24576
    ds_read_b64_tr_b16 a[172:173], v46 offset:36864
    ds_read_b64_tr_b16 a[174:175], v47 offset:36864
    ds_read_b64_tr_b16 a[176:177], v48 offset:0
    ds_read_b64_tr_b16 a[178:179], v49 offset:0
    ds_read_b64_tr_b16 a[180:181], v48 offset:12288
    ds_read_b64_tr_b16 a[182:183], v49 offset:12288
    ds_read_b64_tr_b16 a[184:185], v48 offset:24576
    ds_read_b64_tr_b16 a[186:187], v49 offset:24576
    ds_read_b64_tr_b16 a[188:189], v48 offset:36864
    ds_read_b64_tr_b16 a[190:191], v49 offset:36864
    s_waitcnt lgkmcnt(0)
    s_barrier
    s_cmp_ge_u32 s43, 3
    s_cbranch_scc1 L_v_nofl
    s_mul_i32 s56, s3, 3
    s_add_u32 s56, s56, s43
    s_lshl_b32 s56, s56, 7
    v_mov_b32 v1, s39
    v_mov_b32 v2, 0
    s_mov_b64 exec, 1
    s_waitcnt vmcnt(9)
    buffer_store_dword v1, v2, s[32:35], s56 offen offset:128 sc1
    s_mov_b64 exec, -1
L_v_nofl:
    v_mfma_f32_16x16x32_bf16 v[96:99], a[96:99], a[96:99], v[84:87]
    s_add_u32 m0, s40, 0
    s_add_u32 s57, s36, 24576
    buffer_load_dwordx4 v16, s[28:31], s57 offen offset:0 nt lds
    v_add_u32 v44, 49152, v44
    v_add_u32 v45, 49152, v45
    v_mfma_f32_16x16x32_bf16 v[100:103], a[96:99], a[48:51], 0
    buffer_load_dwordx4 v17, s[28:31], s57 offen offset:1024 nt lds
    v_add_u32 v46, 49152, v46
    v_add_u32 v47, 49152, v47
    v_mfma_f32_16x16x32_bf16 v[96:99], a[100:103], a[100:103], v[96:99]
    buffer_load_dwordx4 v18, s[28:31], s57 offen offset:2048 nt lds
    v_add_u32 v48, 49152, v48
    v_add_u32 v49, 49152, v49
    v_mfma_f32_16x16x32_bf16 v[100:103], a[100:103], a[52:55], v[100:103]
    v_mfma_f32_16x16x32_bf16 v[96:99], a[104:107], a[104:107], v[96:99]
    v_mfma_f32_16x16x32_bf16 v[100:103], a[104:107], a[56:59], v[100:103]
    v_mfma_f32_16x16x32_bf16 v[96:99], a[108:111], a[108:111], v[96:99]
    v_mfma_f32_16x16x32_bf16 v[100:103], a[108:111], a[60:63], v[100:103]
    v_mfma_f32_16x16x32_bf16 v[96:99], a[112:115], a[112:115], v[96:99]
    v_mfma_f32_16x16x32_bf16 v[100:103], a[112:115], a[64:67], v[100:103]
    v_mfma_f32_16x16x32_bf16 v[96:99], a[116:119], a[116:119], v[96:99]
    v_mfma_f32_16x16x32_bf16 v[100:103], a[116:119], a[68:71], v[100:103]
    v_mfma_f32_16x16x32_bf16 v[92:95], a[96:99], v[52:55], v[80:83]
    v_mfma_f32_16x16x32_bf16 v[92:95], a[100:103], v[52:55], v[92:95]
    v_mfma_f32_16x16x32_bf16 v[92:95], a[104:107], v[52:55], v[92:95]
    v_mfma_f32_16x16x32_bf16 v[92:95], a[108:111], v[52:55], v[92:95]
    s_nop 3
    v_fma_f32 v96, v100, 2.0, v96
    v_fma_f32 v97, v101, 2.0, v97
    v_mfma_f32_16x16x32_bf16 v[92:95], a[112:115], v[52:55], v[92:95]
    buffer_load_dwordx4 v19, s[28:31], s57 offen offset:3072 nt lds
    v_fma_f32 v98, v102, 2.0, v98
    v_fma_f32 v99, v103, 2.0, v99
    v_mfma_f32_16x16x32_bf16 v[92:95], a[116:119], v[52:55], v[92:95]
    v_cndmask_b32 v3, 0, v96, s[44:45]
    v_cndmask_b32 v3, v3, v97, s[46:47]
    v_mfma_f32_16x16x32_bf16 v[112:115], a[120:123], a[120:123], v[84:87]
    v_cndmask_b32 v3, v3, v98, s[48:49]
    v_cndmask_b32 v3, v3, v99, s[50:51]
    v_mfma_f32_16x16x32_bf16 v[116:119], a[120:123], a[48:51], 0
    s_nop 0
    s_nop 0
    v_mfma_f32_16x16x32_bf16 v[112:115], a[124:127], a[124:127], v[112:115]
    v_mfma_f32_16x16x4_f32 v[120:123], v3, v60, v[56:59]
    v_mfma_f32_16x16x32_bf16 v[116:119], a[124:127], a[52:55], v[116:119]
    v_mfma_f32_16x16x32_bf16 v[112:115], a[128:131], a[128:131], v[112:115]
    v_mfma_f32_16x16x32_bf16 v[116:119], a[128:131], a[56:59], v[116:119]
    v_mfma_f32_16x16x32_bf16 v[112:115], a[132:135], a[132:135], v[112:115]
    s_nop 5
    v_fma_f32 v128, -v92, v92, v120
    v_fma_f32 v129, -v93, v93, v121
    v_mfma_f32_16x16x32_bf16 v[116:119], a[132:135], a[60:63], v[116:119]
    v_fma_f32 v130, -v94, v94, v122
    v_fma_f32 v131, -v95, v95, v123
    v_mfma_f32_16x16x32_bf16 v[112:115], a[136:139], a[136:139], v[112:115]
    v_max_f32 v128, v128, v56
    v_max_f32 v129, v129, v56
    v_mfma_f32_16x16x32_bf16 v[116:119], a[136:139], a[64:67], v[116:119]
    s_add_u32 m0, s40, 4096
    s_nop 0
    buffer_load_dwordx4 v20, s[28:31], s57 offen offset:0 nt lds
    v_max_f32 v130, v130, v56
    v_max_f32 v131, v131, v56
    v_mfma_f32_16x16x32_bf16 v[112:115], a[140:143], a[140:143], v[112:115]
    v_rsq_f32 v128, v128
    v_mfma_f32_16x16x32_bf16 v[116:119], a[140:143], a[68:71], v[116:119]
    v_rsq_f32 v129, v129
    v_mfma_f32_16x16x32_bf16 v[108:111], a[120:123], v[52:55], v[80:83]
    v_rsq_f32 v130, v130
    v_mfma_f32_16x16x32_bf16 v[108:111], a[124:127], v[52:55], v[108:111]
    v_rsq_f32 v131, v131
    v_mfma_f32_16x16x32_bf16 v[108:111], a[128:131], v[52:55], v[108:111]
    v_mfma_f32_16x16x32_bf16 v[108:111], a[132:135], v[52:55], v[108:111]
    v_mfma_f32_16x16x32_bf16 v[108:111], a[136:139], v[52:55], v[108:111]
    v_fma_f32 v112, v116, 2.0, v112
    v_fma_f32 v113, v117, 2.0, v113
    v_mfma_f32_16x16x32_bf16 v[108:111], a[140:143], v[52:55], v[108:111]
    v_fma_f32 v114, v118, 2.0, v114
    v_fma_f32 v115, v119, 2.0, v115
    v_cndmask_b32 v4, 0, v112, s[44:45]
    v_cndmask_b32 v4, v4, v113, s[46:47]
    v_cndmask_b32 v4, v4, v114, s[48:49]
    v_cndmask_b32 v4, v4, v115, s[50:51]
    s_nop 0
    s_nop 0
    v_mfma_f32_16x16x4_f32 v[124:127], v4, v60, v[56:59]
    s_nop 9
    v_fma_f32 v132, -v108, v108, v124
    v_fma_f32 v133, -v109, v109, v125
    v_fma_f32 v134, -v110, v110, v126
    v_fma_f32 v135, -v111, v111, v127
    v_max_f32 v132, v132, v56
    v_max_f32 v133, v133, v56
    v_max_f32 v134, v134, v56
    v_max_f32 v135, v135, v56
    v_rsq_f32 v132, v132
    v_rsq_f32 v133, v133
    v_rsq_f32 v134, v134
    v_rsq_f32 v135, v135
    s_mul_i32 s56, s3, 1536
    v_lshlrev_b32 v5, 3, v0
    v_add_u32 v5, 153600, v5
    v_add_u32 v4, s56, v5
    buffer_load_dwordx4 v21, s[28:31], s57 offen offset:1024 nt lds
    s_add_u32 m0, s41, 0
    s_add_u32 s58, s37, 49152
    buffer_load_dwordx4 v22, s[24:27], s58 offen offset:0 nt lds
    buffer_load_dwordx4 v23, s[24:27], s58 offen offset:1024 nt lds
    buffer_load_dwordx4 v24, s[24:27], s58 offen offset:2048 nt lds
    buffer_load_dwordx4 v25, s[24:27], s58 offen offset:3072 nt lds
    s_add_u32 m0, s41, 4096
    s_nop 0
    buffer_load_dwordx4 v26, s[24:27], s58 offen offset:0 nt lds
    buffer_load_dwordx4 v27, s[24:27], s58 offen offset:1024 nt lds
    s_waitcnt vmcnt(12)
    v_xor_b32 v1, s39, v138
    v_xor_b32 v2, s39, v142
    v_xor_b32 v3, s39, v146
    v_or3_b32 v1, v1, v2, v3
    v_cmp_ne_u32 vcc, 0, v1
    s_cbranch_vccnz L_qk_retry
L_qk_ok:
    ds_write_b64 v4, v[136:137] offset:0
    ds_write_b64 v4, v[140:141] offset:512
    ds_write_b64 v4, v[144:145] offset:1024
    s_waitcnt lgkmcnt(0)
    s_barrier
    ds_read2st64_b64 v[136:139], v5 offset0:0 offset1:1
    ds_read2st64_b64 v[140:143], v5 offset0:2 offset1:3
    ds_read2st64_b64 v[144:147], v5 offset0:4 offset1:5
    ds_read2st64_b64 v[148:151], v5 offset0:6 offset1:7
    ds_read2st64_b64 v[152:155], v5 offset0:8 offset1:9
    ds_read2st64_b64 v[156:159], v5 offset0:10 offset1:11
    s_waitcnt lgkmcnt(5)
    v_mfma_f32_16x16x32_bf16 v[120:123], v[52:55], v[136:139], 0
    buffer_load_dwordx4 v28, s[24:27], s58 offen offset:2048 nt lds
    v_mfma_f32_16x16x32_bf16 v[76:79], a[48:51], v[136:139], 0
    s_waitcnt lgkmcnt(4)
    v_mfma_f32_16x16x32_bf16 v[120:123], v[52:55], v[140:143], v[120:123]
    v_mfma_f32_16x16x32_bf16 v[76:79], a[52:55], v[140:143], v[76:79]
    s_waitcnt lgkmcnt(3)
    v_mfma_f32_16x16x32_bf16 v[120:123], v[52:55], v[144:147], v[120:123]
    v_mfma_f32_16x16x32_bf16 v[76:79], a[56:59], v[144:147], v[76:79]
    s_waitcnt lgkmcnt(2)
    v_mfma_f32_16x16x32_bf16 v[120:123], v[52:55], v[148:151], v[120:123]
    v_mfma_f32_16x16x32_bf16 v[76:79], a[60:63], v[148:151], v[76:79]
    s_waitcnt lgkmcnt(1)
    v_mfma_f32_16x16x32_bf16 v[120:123], v[52:55], v[152:155], v[120:123]
    buffer_load_dwordx4 v29, s[24:27], s58 offen offset:3072 nt lds
    v_mfma_f32_16x16x32_bf16 v[76:79], a[64:67], v[152:155], v[76:79]
    s_waitcnt lgkmcnt(0)
    v_mfma_f32_16x16x32_bf16 v[120:123], v[52:55], v[156:159], v[120:123]
    v_mfma_f32_16x16x32_bf16 v[76:79], a[68:71], v[156:159], v[76:79]
    s_nop 6
    v_mul_f32 v61, 0x3baaaaab, v120
    v_mfma_f32_16x16x32_bf16 v[88:91], a[96:99], v[136:139], v[76:79]
    v_mov_b32 v9, 0
    v_mfma_f32_16x16x32_bf16 v[88:91], a[100:103], v[140:143], v[88:91]
    v_mfma_f32_16x16x32_bf16 v[88:91], a[104:107], v[144:147], v[88:91]
    v_mfma_f32_16x16x32_bf16 v[88:91], a[108:111], v[148:151], v[88:91]
    v_mfma_f32_16x16x32_bf16 v[88:91], a[112:115], v[152:155], v[88:91]
    v_mfma_f32_16x16x32_bf16 v[88:91], a[116:119], v[156:159], v[88:91]
    ds_write_b32 v254, v9 offset:4096
    ds_write_b32 v254, v9 offset:4100
    v_mfma_f32_16x16x32_bf16 v[104:107], a[120:123], v[136:139], v[76:79]
    v_mfma_f32_16x16x32_bf16 v[104:107], a[124:127], v[140:143], v[104:107]
    v_mfma_f32_16x16x32_bf16 v[104:107], a[128:131], v[144:147], v[104:107]
    v_mfma_f32_16x16x32_bf16 v[104:107], a[132:135], v[148:151], v[104:107]
    s_nop 1
    v_fma_f32 v88, -v92, v61, v88
    v_fma_f32 v89, -v93, v61, v89
    v_mfma_f32_16x16x32_bf16 v[104:107], a[136:139], v[152:155], v[104:107]
    s_add_u32 m0, s41, 8192
    s_nop 0
    buffer_load_dwordx4 v30, s[24:27], s58 offen offset:0 nt lds
    v_fma_f32 v90, -v94, v61, v90
    v_fma_f32 v91, -v95, v61, v91
    v_mfma_f32_16x16x32_bf16 v[104:107], a[140:143], v[156:159], v[104:107]
    v_mul_f32 v88, v88, v128
    v_mul_f32 v89, v89, v129
    v_mul_f32 v90, v90, v130
    v_mul_f32 v91, v91, v131
    v_max3_f32 v1, v88, v89, v90
    v_max_f32 v1, v1, v91
    s_nop 1
    v_fma_f32 v104, -v108, v61, v104
    v_fma_f32 v105, -v109, v61, v105
    v_fma_f32 v106, -v110, v61, v106
    v_fma_f32 v107, -v111, v61, v107
    v_mul_f32 v104, v104, v132
    v_mul_f32 v105, v105, v133
    v_mul_f32 v106, v106, v134
    v_mul_f32 v107, v107, v135
    v_max3_f32 v1, v1, v104, v105
    v_max3_f32 v1, v1, v106, v107
    v_mov_b32 v2, v1
    s_nop 1
    v_permlane32_swap_b32 v1, v2
    v_max_f32 v1, v1, v2
    v_mov_b32 v2, v1
    s_nop 1
    v_permlane16_swap_b32 v1, v2
    v_max_f32 v1, v1, v2
    ds_write_b32 v239, v1
    s_waitcnt lgkmcnt(0)
    s_barrier
    ds_read_b32 v12, v240 offset:0
    ds_read_b32 v13, v240 offset:1024
    ds_read_b32 v14, v240 offset:2048
    ds_read_b32 v15, v240 offset:3072
    buffer_load_dwordx4 v31, s[24:27], s58 offen offset:1024 nt lds
    s_waitcnt lgkmcnt(0)
    v_max3_f32 v1, v12, v13, v14
    v_max_f32 v1, v1, v15
    v_sub_f32 v88, v88, v1
    v_sub_f32 v89, v89, v1
    v_sub_f32 v90, v90, v1
    v_sub_f32 v91, v91, v1
    v_sub_f32 v104, v104, v1
    v_sub_f32 v105, v105, v1
    v_sub_f32 v106, v106, v1
    v_sub_f32 v107, v107, v1
    v_sub_f32 v62, 0, v1
    v_sub_f32 v255, 0, v1
    v_exp_f32 v96, v88
    v_exp_f32 v97, v89
    v_exp_f32 v98, v90
    v_exp_f32 v99, v91
    v_mul_f32 v88, v96, v128
    v_mul_f32 v89, v97, v129
    v_mul_f32 v90, v98, v130
    v_mul_f32 v91, v99, v131
    v_exp_f32 v112, v104
    v_exp_f32 v113, v105
    v_exp_f32 v114, v106
    v_exp_f32 v115, v107
    v_cvt_pk_bf16_f32 v72, v88, v89
    v_cvt_pk_bf16_f32 v73, v90, v91
    v_mul_f32 v104, v112, v132
    v_mul_f32 v105, v113, v133
    v_mul_f32 v106, v114, v134
    v_mul_f32 v107, v115, v135
    v_cvt_pk_bf16_f32 v74, v104, v105
    v_cvt_pk_bf16_f32 v75, v106, v107
    ds_write_b128 v237, v[72:75] offset:0
    v_mov_b32 v63, v96
    v_mul_f32 v64, v88, v92
    v_add_f32 v63, v63, v97
    v_fmac_f32 v64, v89, v93
    v_add_f32 v63, v63, v98
    v_fmac_f32 v64, v90, v94
    v_add_f32 v63, v63, v99
    v_fmac_f32 v64, v91, v95
    v_mov_b32 v68, v88
    v_mov_b32 v69, v89
    v_mov_b32 v70, v90
    v_mov_b32 v71, v91
    s_waitcnt lgkmcnt(0)
    s_barrier
    ds_read_b128 v[92:95], v253 offset:0
    ds_read_b128 v[96:99], v253 offset:1024
    ds_read_b128 v[100:103], v253 offset:2048
    ds_read_b128 v[116:119], v253 offset:3072
    s_waitcnt lgkmcnt(3)
    v_mfma_f32_16x16x32_bf16 a[0:3], a[144:147], v[92:95], 0
    buffer_load_dwordx4 v32, s[24:27], s58 offen offset:2048 nt lds
    v_add_f32 v68, v68, v104
    v_add_f32 v69, v69, v105
    v_mfma_f32_16x16x32_bf16 a[4:7], a[160:163], v[92:95], 0
    buffer_load_dwordx4 v33, s[24:27], s58 offen offset:3072 nt lds
    v_add_f32 v70, v70, v106
    v_add_f32 v71, v71, v107
    v_mfma_f32_16x16x32_bf16 a[8:11], a[176:179], v[92:95], 0
    v_add_f32 v63, v63, v112
    v_fma_f32 v64, v104, v108, v64
    s_waitcnt lgkmcnt(2)
    v_mfma_f32_16x16x32_bf16 a[0:3], a[148:151], v[96:99], a[0:3]
    v_add_f32 v63, v63, v113
    v_fma_f32 v64, v105, v109, v64
    v_mfma_f32_16x16x32_bf16 a[4:7], a[164:167], v[96:99], a[4:7]
    v_add_f32 v63, v63, v114
    v_fma_f32 v64, v106, v110, v64
    v_mfma_f32_16x16x32_bf16 a[8:11], a[180:183], v[96:99], a[8:11]
    v_add_f32 v63, v63, v115
    v_fma_f32 v64, v107, v111, v64
    s_waitcnt lgkmcnt(1)
    v_mfma_f32_16x16x32_bf16 a[0:3], a[152:155], v[100:103], a[0:3]
    v_mfma_f32_16x16x32_bf16 a[4:7], a[168:171], v[100:103], a[4:7]
    v_mfma_f32_16x16x32_bf16 a[8:11], a[184:187], v[100:103], a[8:11]
    s_waitcnt lgkmcnt(0)
    v_mfma_f32_16x16x32_bf16 a[0:3], a[156:159], v[116:119], a[0:3]
    v_mfma_f32_16x16x32_bf16 a[4:7], a[172:175], v[116:119], a[4:7]
    v_mfma_f32_16x16x32_bf16 a[8:11], a[188:191], v[116:119], a[8:11]
    s_barrier
    ds_read_b128 a[96:99], v40 offset:49152
    ds_read_b128 a[100:103], v41 offset:49152
    ds_read_b128 a[104:107], v42 offset:49152
    ds_read_b128 a[108:111], v43 offset:49152
    ds_read_b128 a[112:115], v40 offset:49408
    ds_read_b128 a[116:119], v41 offset:49408
    ds_read_b128 a[120:123], v42 offset:49408
    ds_read_b128 a[124:127], v43 offset:49408
    ds_read_b128 a[128:131], v40 offset:49664
    ds_read_b128 a[132:135], v41 offset:49664
    ds_read_b128 a[136:139], v42 offset:49664
    ds_read_b128 a[140:143], v43 offset:49664
    s_waitcnt lgkmcnt(11)
    v_mfma_f32_16x16x32_bf16 v[96:99], a[96:99], a[96:99], v[84:87]
    ds_read_b64_tr_b16 a[144:145], v44 offset:0
    ds_read_b64_tr_b16 a[146:147], v45 offset:0
    v_mfma_f32_16x16x32_bf16 v[100:103], a[96:99], a[48:51], 0
    ds_read_b64_tr_b16 a[148:149], v44 offset:12288
    ds_read_b64_tr_b16 a[150:151], v45 offset:12288
    s_waitcnt lgkmcnt(14)
    v_mfma_f32_16x16x32_bf16 v[96:99], a[100:103], a[100:103], v[96:99]
    ds_read_b64_tr_b16 a[152:153], v44 offset:24576
    ds_read_b64_tr_b16 a[154:155], v45 offset:24576
    v_mfma_f32_16x16x32_bf16 v[100:103], a[100:103], a[52:55], v[100:103]
    ds_read_b64_tr_b16 a[156:157], v44 offset:36864
    ds_read_b64_tr_b16 a[158:159], v45 offset:36864
    s_waitcnt lgkmcnt(15)
    v_mfma_f32_16x16x32_bf16 v[96:99], a[104:107], a[104:107], v[96:99]
    ds_read_b64_tr_b16 a[160:161], v46 offset:0
    ds_read_b64_tr_b16 a[162:163], v47 offset:0
    v_mfma_f32_16x16x32_bf16 v[100:103], a[104:107], a[56:59], v[100:103]
    ds_read_b64_tr_b16 a[164:165], v46 offset:12288
    ds_read_b64_tr_b16 a[166:167], v47 offset:12288
    v_mfma_f32_16x16x32_bf16 v[96:99], a[108:111], a[108:111], v[96:99]
    ds_read_b64_tr_b16 a[168:169], v46 offset:24576
    ds_read_b64_tr_b16 a[170:171], v47 offset:24576
    v_mfma_f32_16x16x32_bf16 v[100:103], a[108:111], a[60:63], v[100:103]
    ds_read_b64_tr_b16 a[172:173], v46 offset:36864
    ds_read_b64_tr_b16 a[174:175], v47 offset:36864
    v_mfma_f32_16x16x32_bf16 v[96:99], a[112:115], a[112:115], v[96:99]
    ds_read_b64_tr_b16 a[176:177], v48 offset:0
    ds_read_b64_tr_b16 a[178:179], v49 offset:0
    v_mfma_f32_16x16x32_bf16 v[100:103], a[112:115], a[64:67], v[100:103]
    ds_read_b64_tr_b16 a[180:181], v48 offset:12288
    ds_read_b64_tr_b16 a[182:183], v49 offset:12288
    s_waitcnt lgkmcnt(15)
    v_mfma_f32_16x16x32_bf16 v[96:99], a[116:119], a[116:119], v[96:99]
    ds_read_b64_tr_b16 a[184:185], v48 offset:24576
    ds_read_b64_tr_b16 a[186:187], v49 offset:24576
    v_mfma_f32_16x16x32_bf16 v[100:103], a[116:119], a[68:71], v[100:103]
    ds_read_b64_tr_b16 a[188:189], v48 offset:36864
    ds_read_b64_tr_b16 a[190:191], v49 offset:36864
    v_mfma_f32_16x16x32_bf16 v[92:95], a[96:99], v[52:55], v[80:83]
    v_mfma_f32_16x16x32_bf16 v[92:95], a[100:103], v[52:55], v[92:95]
    v_mfma_f32_16x16x32_bf16 v[92:95], a[104:107], v[52:55], v[92:95]
    v_mfma_f32_16x16x32_bf16 v[92:95], a[108:111], v[52:55], v[92:95]
    s_nop 1
    v_fma_f32 v96, v100, 2.0, v96
    v_fma_f32 v97, v101, 2.0, v97
    v_mfma_f32_16x16x32_bf16 v[92:95], a[112:115], v[52:55], v[92:95]
    v_fma_f32 v98, v102, 2.0, v98
    v_fma_f32 v99, v103, 2.0, v99
    v_mfma_f32_16x16x32_bf16 v[92:95], a[116:119], v[52:55], v[92:95]
    v_cndmask_b32 v3, 0, v96, s[44:45]
    v_cndmask_b32 v3, v3, v97, s[46:47]
    v_mfma_f32_16x16x32_bf16 v[88:91], a[96:99], v[136:139], v[76:79]
    v_cndmask_b32 v3, v3, v98, s[48:49]
    v_cndmask_b32 v3, v3, v99, s[50:51]
    v_mfma_f32_16x16x32_bf16 v[88:91], a[100:103], v[140:143], v[88:91]
    s_nop 0
    s_nop 0
    v_mfma_f32_16x16x32_bf16 v[88:91], a[104:107], v[144:147], v[88:91]
    v_mfma_f32_16x16x4_f32 v[120:123], v3, v60, v[56:59]
    v_mfma_f32_16x16x32_bf16 v[88:91], a[108:111], v[148:151], v[88:91]
    v_mfma_f32_16x16x32_bf16 v[88:91], a[112:115], v[152:155], v[88:91]
    v_mfma_f32_16x16x32_bf16 v[88:91], a[116:119], v[156:159], v[88:91]
    s_waitcnt lgkmcnt(0)
    s_barrier
    v_mfma_f32_16x16x32_bf16 v[112:115], a[120:123], a[120:123], v[84:87]
    s_add_u32 m0, s42, 0
    s_add_u32 s59, s37, 245760
    buffer_load_dwordx4 v22, s[24:27], s59 offen offset:0 nt lds
    v_mfma_f32_16x16x32_bf16 v[116:119], a[120:123], a[48:51], 0
    buffer_load_dwordx4 v23, s[24:27], s59 offen offset:1024 nt lds
    v_mfma_f32_16x16x32_bf16 v[112:115], a[124:127], a[124:127], v[112:115]
    buffer_load_dwordx4 v24, s[24:27], s59 offen offset:2048 nt lds
    v_mfma_f32_16x16x32_bf16 v[116:119], a[124:127], a[52:55], v[116:119]
    buffer_load_dwordx4 v25, s[24:27], s59 offen offset:3072 nt lds
    v_fma_f32 v128, -v92, v92, v120
    v_fma_f32 v129, -v93, v93, v121
    v_mfma_f32_16x16x32_bf16 v[112:115], a[128:131], a[128:131], v[112:115]
    v_fma_f32 v130, -v94, v94, v122
    v_fma_f32 v131, -v95, v95, v123
    v_mfma_f32_16x16x32_bf16 v[116:119], a[128:131], a[56:59], v[116:119]
    v_max_f32 v128, v128, v56
    v_max_f32 v129, v129, v56
    v_mfma_f32_16x16x32_bf16 v[112:115], a[132:135], a[132:135], v[112:115]
    v_max_f32 v130, v130, v56
    v_max_f32 v131, v131, v56
    v_mfma_f32_16x16x32_bf16 v[116:119], a[132:135], a[60:63], v[116:119]
    s_add_u32 m0, s42, 4096
    s_nop 0
    buffer_load_dwordx4 v26, s[24:27], s59 offen offset:0 nt lds
    v_rsq_f32 v128, v128
    v_mfma_f32_16x16x32_bf16 v[112:115], a[136:139], a[136:139], v[112:115]
    v_rsq_f32 v129, v129
    v_mfma_f32_16x16x32_bf16 v[116:119], a[136:139], a[64:67], v[116:119]
    v_rsq_f32 v130, v130
    v_mfma_f32_16x16x32_bf16 v[112:115], a[140:143], a[140:143], v[112:115]
    v_rsq_f32 v131, v131
    v_mfma_f32_16x16x32_bf16 v[116:119], a[140:143], a[68:71], v[116:119]
    v_fma_f32 v88, -v92, v61, v88
    v_fma_f32 v89, -v93, v61, v89
    v_mfma_f32_16x16x32_bf16 v[108:111], a[120:123], v[52:55], v[80:83]
    v_fma_f32 v90, -v94, v61, v90
    v_fma_f32 v91, -v95, v61, v91
    v_mfma_f32_16x16x32_bf16 v[108:111], a[124:127], v[52:55], v[108:111]
    v_fma_f32 v88, v88, v128, v62
    v_fma_f32 v89, v89, v129, v62
    v_mfma_f32_16x16x32_bf16 v[108:111], a[128:131], v[52:55], v[108:111]
    v_fma_f32 v90, v90, v130, v62
    v_fma_f32 v91, v91, v131, v62
    v_mfma_f32_16x16x32_bf16 v[108:111], a[132:135], v[52:55], v[108:111]
    v_max3_f32 v1, v88, v89, v90
    v_max_f32 v1, v1, v91
    v_mfma_f32_16x16x32_bf16 v[108:111], a[136:139], v[52:55], v[108:111]
    v_cmp_lt_f32 vcc, s52, v1
    s_cbranch_vccnz L_site0
L_back0:
    v_mfma_f32_16x16x32_bf16 v[108:111], a[140:143], v[52:55], v[108:111]
    v_exp_f32 v96, v88
    v_mfma_f32_16x16x32_bf16 v[104:107], a[120:123], v[136:139], v[76:79]
    v_exp_f32 v97, v89
    v_mfma_f32_16x16x32_bf16 v[104:107], a[124:127], v[140:143], v[104:107]
    v_exp_f32 v98, v90
    v_mfma_f32_16x16x32_bf16 v[104:107], a[128:131], v[144:147], v[104:107]
    buffer_load_dwordx4 v27, s[24:27], s59 offen offset:1024 nt lds
    v_exp_f32 v99, v91
    v_mfma_f32_16x16x32_bf16 v[104:107], a[132:135], v[148:151], v[104:107]
    v_mul_f32 v88, v96, v128
    v_mul_f32 v89, v97, v129
    v_mfma_f32_16x16x32_bf16 v[104:107], a[136:139], v[152:155], v[104:107]
    v_mul_f32 v90, v98, v130
    v_mul_f32 v91, v99, v131
    v_mfma_f32_16x16x32_bf16 v[104:107], a[140:143], v[156:159], v[104:107]
    v_fma_f32 v112, v116, 2.0, v112
    v_fma_f32 v113, v117, 2.0, v113
    v_fma_f32 v114, v118, 2.0, v114
    v_fma_f32 v115, v119, 2.0, v115
    v_cndmask_b32 v4, 0, v112, s[44:45]
    v_cndmask_b32 v4, v4, v113, s[46:47]
    v_cndmask_b32 v4, v4, v114, s[48:49]
    v_cndmask_b32 v4, v4, v115, s[50:51]
    v_add_f32 v63, v63, v96
    v_fmac_f32 v64, v88, v92
    v_mfma_f32_16x16x4_f32 v[124:127], v4, v60, v[56:59]
    v_add_f32 v63, v63, v97
    v_fmac_f32 v64, v89, v93
    v_add_f32 v63, v63, v98
    v_fmac_f32 v64, v90, v94
    v_add_f32 v63, v63, v99
    v_fmac_f32 v64, v91, v95
    v_add_f32 v68, v68, v88
    v_add_f32 v69, v69, v89
    v_add_f32 v70, v70, v90
    v_add_f32 v71, v71, v91
    v_add_u32 v44, -49152, v44
    v_add_u32 v45, -49152, v45
    v_add_u32 v46, -49152, v46
    v_add_u32 v47, -49152, v47
    v_add_u32 v48, -49152, v48
    v_add_u32 v49, -49152, v49
    v_fma_f32 v132, -v108, v108, v124
    v_fma_f32 v133, -v109, v109, v125
    v_fma_f32 v134, -v110, v110, v126
    v_fma_f32 v135, -v111, v111, v127
    v_max_f32 v132, v132, v56
    v_max_f32 v133, v133, v56
    v_max_f32 v134, v134, v56
    v_max_f32 v135, v135, v56
    v_rsq_f32 v132, v132
    v_rsq_f32 v133, v133
    v_rsq_f32 v134, v134
    v_rsq_f32 v135, v135
    buffer_load_dwordx4 v28, s[24:27], s59 offen offset:2048 nt lds
    v_fma_f32 v104, -v108, v61, v104
    v_fma_f32 v105, -v109, v61, v105
    v_fma_f32 v106, -v110, v61, v106
    v_fma_f32 v107, -v111, v61, v107
    v_fma_f32 v104, v104, v132, v62
    v_fma_f32 v105, v105, v133, v62
    v_fma_f32 v106, v106, v134, v62
    v_fma_f32 v107, v107, v135, v62
    v_max3_f32 v1, v104, v105, v106
    v_max_f32 v1, v1, v107
    v_cmp_lt_f32 vcc, s52, v1
    s_cbranch_vccnz L_site1
L_back1:
    v_exp_f32 v112, v104
    v_exp_f32 v113, v105
    v_exp_f32 v114, v106
    v_exp_f32 v115, v107
    v_cvt_pk_bf16_f32 v72, v88, v89
    v_cvt_pk_bf16_f32 v73, v90, v91
    v_mul_f32 v104, v112, v132
    v_mul_f32 v105, v113, v133
    v_mul_f32 v106, v114, v134
    v_mul_f32 v107, v115, v135
    v_cvt_pk_bf16_f32 v74, v104, v105
    v_cvt_pk_bf16_f32 v75, v106, v107
    ds_write_b128 v237, v[72:75] offset:0
    v_add_f32 v68, v68, v104
    v_add_f32 v69, v69, v105
    v_add_f32 v70, v70, v106
    v_add_f32 v71, v71, v107
    v_cvt_pk_bf16_f32 v66, v68, v69
    v_cvt_pk_bf16_f32 v67, v70, v71
    ds_write_b64 v238, v[66:67]
    buffer_load_dwordx4 v29, s[24:27], s59 offen offset:3072 nt lds
    s_waitcnt vmcnt(20)
    s_waitcnt lgkmcnt(0)
    s_barrier
L_post3:
    ds_read_b32 v9, v254 offset:4096
    ds_read_b64 v[120:121], v254 offset:0
    ds_read_b64 v[122:123], v254 offset:512
    ds_read_b64 v[124:125], v254 offset:1024
    ds_read_b64 v[126:127], v254 offset:1536
    ds_read_b128 v[92:95], v253 offset:0
    ds_read_b128 v[96:99], v253 offset:1024
    ds_read_b128 v[100:103], v253 offset:2048
    ds_read_b128 v[116:119], v253 offset:3072
    ds_read_b128 a[48:51], v34 offset:0
    ds_read_b128 a[52:55], v35 offset:0
    ds_read_b128 a[56:59], v34 offset:128
    ds_read_b128 a[60:63], v35 offset:128
    ds_read_b128 a[64:67], v34 offset:256
    ds_read_b128 a[68:71], v35 offset:256
    s_waitcnt lgkmcnt(14)
    v_cmp_ne_u32 vcc, 0, v9
    s_cbranch_vccnz L_xt3
    s_waitcnt lgkmcnt(12)
    v_mfma_f32_16x16x32_bf16 a[0:3], a[72:75], v[120:123], a[0:3]
    v_add_f32 v63, v63, v112
    v_fma_f32 v64, v104, v108, v64
    v_mfma_f32_16x16x32_bf16 a[4:7], a[80:83], v[120:123], a[4:7]
    v_add_f32 v63, v63, v113
    v_fma_f32 v64, v105, v109, v64
    v_mfma_f32_16x16x32_bf16 a[8:11], a[88:91], v[120:123], a[8:11]
    s_add_u32 m0, s42, 8192
    s_nop 0
    buffer_load_dwordx4 v30, s[24:27], s59 offen offset:0 nt lds
    v_add_f32 v63, v63, v114
    v_fma_f32 v64, v106, v110, v64
    s_waitcnt lgkmcnt(10)
    v_mfma_f32_16x16x32_bf16 a[0:3], a[76:79], v[124:127], a[0:3]
    v_add_f32 v63, v63, v115
    v_fma_f32 v64, v107, v111, v64
    v_mfma_f32_16x16x32_bf16 a[4:7], a[84:87], v[124:127], a[4:7]
    v_mfma_f32_16x16x32_bf16 a[8:11], a[92:95], v[124:127], a[8:11]
    s_waitcnt lgkmcnt(9)
    v_mfma_f32_16x16x32_bf16 a[0:3], a[144:147], v[92:95], a[0:3]
    ds_read_b64_tr_b16 a[72:73], v36 offset:0
    ds_read_b64_tr_b16 a[74:75], v36 offset:6144
    v_mfma_f32_16x16x32_bf16 a[4:7], a[160:163], v[92:95], a[4:7]
    ds_read_b64_tr_b16 a[76:77], v36 offset:12288
    ds_read_b64_tr_b16 a[78:79], v36 offset:18432
    v_mfma_f32_16x16x32_bf16 a[8:11], a[176:179], v[92:95], a[8:11]
    ds_read_b64_tr_b16 a[80:81], v37 offset:0
    ds_read_b64_tr_b16 a[82:83], v37 offset:6144
    s_waitcnt lgkmcnt(14)
    v_mfma_f32_16x16x32_bf16 a[0:3], a[148:151], v[96:99], a[0:3]
    ds_read_b64_tr_b16 a[84:85], v37 offset:12288
    ds_read_b64_tr_b16 a[86:87], v37 offset:18432
    v_mfma_f32_16x16x32_bf16 a[4:7], a[164:167], v[96:99], a[4:7]
    ds_read_b64_tr_b16 a[88:89], v38 offset:0
    ds_read_b64_tr_b16 a[90:91], v38 offset:6144
    v_mfma_f32_16x16x32_bf16 a[8:11], a[180:183], v[96:99], a[8:11]
    ds_read_b64_tr_b16 a[92:93], v38 offset:12288
    ds_read_b64_tr_b16 a[94:95], v38 offset:18432
    s_waitcnt lgkmcnt(15)
    v_mfma_f32_16x16x32_bf16 a[0:3], a[152:155], v[100:103], a[0:3]
    buffer_load_dwordx4 v31, s[24:27], s59 offen offset:1024 nt lds
    v_mfma_f32_16x16x32_bf16 a[4:7], a[168:171], v[100:103], a[4:7]
    v_mfma_f32_16x16x32_bf16 a[8:11], a[184:187], v[100:103], a[8:11]
    v_mfma_f32_16x16x32_bf16 a[0:3], a[156:159], v[116:119], a[0:3]
    v_mfma_f32_16x16x32_bf16 a[4:7], a[172:175], v[116:119], a[4:7]
    v_mfma_f32_16x16x32_bf16 a[8:11], a[188:191], v[116:119], a[8:11]
    v_mfma_f32_16x16x32_bf16 v[84:87], a[48:51], a[48:51], 0
    v_mfma_f32_16x16x32_bf16 v[80:83], a[48:51], v[52:55], 0
    v_mfma_f32_16x16x32_bf16 v[84:87], a[52:55], a[52:55], v[84:87]
    v_mfma_f32_16x16x32_bf16 v[80:83], a[52:55], v[52:55], v[80:83]
    v_mfma_f32_16x16x32_bf16 v[84:87], a[56:59], a[56:59], v[84:87]
    v_mfma_f32_16x16x32_bf16 v[80:83], a[56:59], v[52:55], v[80:83]
    s_waitcnt lgkmcnt(14)
    v_mfma_f32_16x16x32_bf16 v[84:87], a[60:63], a[60:63], v[84:87]
    v_mfma_f32_16x16x32_bf16 v[80:83], a[60:63], v[52:55], v[80:83]
    s_waitcnt lgkmcnt(13)
    v_mfma_f32_16x16x32_bf16 v[84:87], a[64:67], a[64:67], v[84:87]
    buffer_load_dwordx4 v32, s[24:27], s59 offen offset:2048 nt lds
    v_mfma_f32_16x16x32_bf16 v[80:83], a[64:67], v[52:55], v[80:83]
    s_waitcnt lgkmcnt(12)
    v_mfma_f32_16x16x32_bf16 v[84:87], a[68:71], a[68:71], v[84:87]
    v_mfma_f32_16x16x32_bf16 v[80:83], a[68:71], v[52:55], v[80:83]
    s_waitcnt lgkmcnt(0)
    v_mfma_f32_16x16x32_bf16 v[76:79], a[48:51], v[136:139], 0
    v_mfma_f32_16x16x32_bf16 v[76:79], a[52:55], v[140:143], v[76:79]
    v_mfma_f32_16x16x32_bf16 v[76:79], a[56:59], v[144:147], v[76:79]
    v_mfma_f32_16x16x32_bf16 v[76:79], a[60:63], v[148:151], v[76:79]
    v_mfma_f32_16x16x32_bf16 v[76:79], a[64:67], v[152:155], v[76:79]
    v_mfma_f32_16x16x32_bf16 v[76:79], a[68:71], v[156:159], v[76:79]
    s_movk_i32 s56, 384
    v_add_u32 v1, 0, v0
    v_mul_u32_u24 v1, 2731, v1
    v_lshrrev_b32 v1, 16, v1
    v_mad_u32_u24 v224, v1, s56, v16
    v_add_u32 v1, 64, v0
    v_mul_u32_u24 v1, 2731, v1
    v_lshrrev_b32 v1, 16, v1
    v_mad_u32_u24 v225, v1, s56, v17
    v_add_u32 v1, 128, v0
    v_mul_u32_u24 v1, 2731, v1
    v_lshrrev_b32 v1, 16, v1
    v_mad_u32_u24 v226, v1, s56, v18
    v_add_u32 v1, 192, v0
    v_mul_u32_u24 v1, 2731, v1
    v_lshrrev_b32 v1, 16, v1
    v_mad_u32_u24 v227, v1, s56, v19
    v_add_u32 v1, 256, v0
    v_mul_u32_u24 v1, 2731, v1
    v_lshrrev_b32 v1, 16, v1
    v_mad_u32_u24 v228, v1, s56, v20
    v_add_u32 v1, 320, v0
    v_mul_u32_u24 v1, 2731, v1
    v_lshrrev_b32 v1, 16, v1
    v_mad_u32_u24 v229, v1, s56, v21
    buffer_load_dwordx4 v33, s[24:27], s59 offen offset:3072 nt lds
    s_waitcnt vmcnt(12)
    s_barrier
    ds_read_b128 a[96:99], v40 offset:0
    ds_read_b128 a[100:103], v41 offset:0
    ds_read_b128 a[104:107], v42 offset:0
    ds_read_b128 a[108:111], v43 offset:0
    ds_read_b128 a[112:115], v40 offset:256
    ds_read_b128 a[116:119], v41 offset:256
    ds_read_b128 a[120:123], v42 offset:256
    ds_read_b128 a[124:127], v43 offset:256
    ds_read_b128 a[128:131], v40 offset:512
    ds_read_b128 a[132:135], v41 offset:512
    ds_read_b128 a[136:139], v42 offset:512
    ds_read_b128 a[140:143], v43 offset:512
    s_waitcnt lgkmcnt(11)
    v_mfma_f32_16x16x32_bf16 v[96:99], a[96:99], a[96:99], v[84:87]
    ds_read_b64_tr_b16 a[144:145], v44 offset:0
    ds_read_b64_tr_b16 a[146:147], v45 offset:0
    v_mfma_f32_16x16x32_bf16 v[100:103], a[96:99], a[48:51], 0
    ds_read_b64_tr_b16 a[148:149], v44 offset:12288
    ds_read_b64_tr_b16 a[150:151], v45 offset:12288
    s_waitcnt lgkmcnt(14)
    v_mfma_f32_16x16x32_bf16 v[96:99], a[100:103], a[100:103], v[96:99]
    s_add_u32 m0, s40, 0
    s_add_u32 s57, s36, 49152
    buffer_load_dwordx4 v16, s[28:31], s57 offen offset:0 nt lds
    ds_read_b64_tr_b16 a[152:153], v44 offset:24576
    ds_read_b64_tr_b16 a[154:155], v45 offset:24576
    v_mfma_f32_16x16x32_bf16 v[100:103], a[100:103], a[52:55], v[100:103]
    ds_read_b64_tr_b16 a[156:157], v44 offset:36864
    ds_read_b64_tr_b16 a[158:159], v45 offset:36864
    s_waitcnt lgkmcnt(15)
    v_mfma_f32_16x16x32_bf16 v[96:99], a[104:107], a[104:107], v[96:99]
    ds_read_b64_tr_b16 a[160:161], v46 offset:0
    ds_read_b64_tr_b16 a[162:163], v47 offset:0
    v_mfma_f32_16x16x32_bf16 v[100:103], a[104:107], a[56:59], v[100:103]
    ds_read_b64_tr_b16 a[164:165], v46 offset:12288
    ds_read_b64_tr_b16 a[166:167], v47 offset:12288
    v_mfma_f32_16x16x32_bf16 v[96:99], a[108:111], a[108:111], v[96:99]
    ds_read_b64_tr_b16 a[168:169], v46 offset:24576
    ds_read_b64_tr_b16 a[170:171], v47 offset:24576
    v_mfma_f32_16x16x32_bf16 v[100:103], a[108:111], a[60:63], v[100:103]
    ds_read_b64_tr_b16 a[172:173], v46 offset:36864
    ds_read_b64_tr_b16 a[174:175], v47 offset:36864
    v_mfma_f32_16x16x32_bf16 v[96:99], a[112:115], a[112:115], v[96:99]
    ds_read_b64_tr_b16 a[176:177], v48 offset:0
    ds_read_b64_tr_b16 a[178:179], v49 offset:0
    v_mfma_f32_16x16x32_bf16 v[100:103], a[112:115], a[64:67], v[100:103]
    ds_read_b64_tr_b16 a[180:181], v48 offset:12288
    ds_read_b64_tr_b16 a[182:183], v49 offset:12288
    s_waitcnt lgkmcnt(15)
    v_mfma_f32_16x16x32_bf16 v[96:99], a[116:119], a[116:119], v[96:99]
    ds_read_b64_tr_b16 a[184:185], v48 offset:24576
    ds_read_b64_tr_b16 a[186:187], v49 offset:24576
    v_mfma_f32_16x16x32_bf16 v[100:103], a[116:119], a[68:71], v[100:103]
    ds_read_b64_tr_b16 a[188:189], v48 offset:36864
    ds_read_b64_tr_b16 a[190:191], v49 offset:36864
    v_mfma_f32_16x16x32_bf16 v[92:95], a[96:99], v[52:55], v[80:83]
    buffer_load_dwordx4 v17, s[28:31], s57 offen offset:1024 nt lds
    v_mfma_f32_16x16x32_bf16 v[92:95], a[100:103], v[52:55], v[92:95]
    v_mfma_f32_16x16x32_bf16 v[92:95], a[104:107], v[52:55], v[92:95]
    v_mfma_f32_16x16x32_bf16 v[92:95], a[108:111], v[52:55], v[92:95]
    s_nop 0
    v_fma_f32 v96, v100, 2.0, v96
    v_fma_f32 v97, v101, 2.0, v97
    v_mfma_f32_16x16x32_bf16 v[92:95], a[112:115], v[52:55], v[92:95]
    v_fma_f32 v98, v102, 2.0, v98
    v_fma_f32 v99, v103, 2.0, v99
    v_mfma_f32_16x16x32_bf16 v[92:95], a[116:119], v[52:55], v[92:95]
    v_cndmask_b32 v3, 0, v96, s[44:45]
    v_cndmask_b32 v3, v3, v97, s[46:47]
    v_mfma_f32_16x16x32_bf16 v[88:91], a[96:99], v[136:139], v[76:79]
    v_cndmask_b32 v3, v3, v98, s[48:49]
    v_cndmask_b32 v3, v3, v99, s[50:51]
    v_mfma_f32_16x16x32_bf16 v[88:91], a[100:103], v[140:143], v[88:91]
    s_nop 0
    s_nop 0
    v_mfma_f32_16x16x32_bf16 v[88:91], a[104:107], v[144:147], v[88:91]
    v_mfma_f32_16x16x4_f32 v[120:123], v3, v60, v[56:59]
    v_mfma_f32_16x16x32_bf16 v[88:91], a[108:111], v[148:151], v[88:91]
    v_mfma_f32_16x16x32_bf16 v[88:91], a[112:115], v[152:155], v[88:91]
    v_mfma_f32_16x16x32_bf16 v[88:91], a[116:119], v[156:159], v[88:91]
    buffer_load_dwordx4 v18, s[28:31], s57 offen offset:2048 nt lds
    v_mfma_f32_16x16x32_bf16 v[112:115], a[120:123], a[120:123], v[84:87]
    v_mfma_f32_16x16x32_bf16 v[116:119], a[120:123], a[48:51], 0
    v_mfma_f32_16x16x32_bf16 v[112:115], a[124:127], a[124:127], v[112:115]
    v_mfma_f32_16x16x32_bf16 v[116:119], a[124:127], a[52:55], v[116:119]
    s_nop 1
    v_fma_f32 v128, -v92, v92, v120
    v_fma_f32 v129, -v93, v93, v121
    v_mfma_f32_16x16x32_bf16 v[112:115], a[128:131], a[128:131], v[112:115]
    v_fma_f32 v130, -v94, v94, v122
    v_fma_f32 v131, -v95, v95, v123
    v_mfma_f32_16x16x32_bf16 v[116:119], a[128:131], a[56:59], v[116:119]
    v_max_f32 v128, v128, v56
    v_max_f32 v129, v129, v56
    v_mfma_f32_16x16x32_bf16 v[112:115], a[132:135], a[132:135], v[112:115]
    v_max_f32 v130, v130, v56
    v_max_f32 v131, v131, v56
    v_mfma_f32_16x16x32_bf16 v[116:119], a[132:135], a[60:63], v[116:119]
    v_rsq_f32 v128, v128
    v_mfma_f32_16x16x32_bf16 v[112:115], a[136:139], a[136:139], v[112:115]
    v_rsq_f32 v129, v129
    v_mfma_f32_16x16x32_bf16 v[116:119], a[136:139], a[64:67], v[116:119]
    v_rsq_f32 v130, v130
    v_mfma_f32_16x16x32_bf16 v[112:115], a[140:143], a[140:143], v[112:115]
    v_rsq_f32 v131, v131
    v_mfma_f32_16x16x32_bf16 v[116:119], a[140:143], a[68:71], v[116:119]
    v_fma_f32 v88, -v92, v61, v88
    v_fma_f32 v89, -v93, v61, v89
    v_mfma_f32_16x16x32_bf16 v[108:111], a[120:123], v[52:55], v[80:83]
    buffer_load_dwordx4 v19, s[28:31], s57 offen offset:3072 nt lds
    v_fma_f32 v90, -v94, v61, v90
    v_fma_f32 v91, -v95, v61, v91
    v_mfma_f32_16x16x32_bf16 v[108:111], a[124:127], v[52:55], v[108:111]
    v_fma_f32 v88, v88, v128, v62
    v_fma_f32 v89, v89, v129, v62
    v_mfma_f32_16x16x32_bf16 v[108:111], a[128:131], v[52:55], v[108:111]
    v_fma_f32 v90, v90, v130, v62
    v_fma_f32 v91, v91, v131, v62
    v_mfma_f32_16x16x32_bf16 v[108:111], a[132:135], v[52:55], v[108:111]
    v_max3_f32 v1, v88, v89, v90
    v_max_f32 v1, v1, v91
    v_mfma_f32_16x16x32_bf16 v[108:111], a[136:139], v[52:55], v[108:111]
    v_cmp_lt_f32 vcc, s52, v1
    s_cbranch_vccnz L_site2
L_back2:
    v_mfma_f32_16x16x32_bf16 v[108:111], a[140:143], v[52:55], v[108:111]
    v_exp_f32 v96, v88
    v_mfma_f32_16x16x32_bf16 v[104:107], a[120:123], v[136:139], v[76:79]
    v_exp_f32 v97, v89
    v_mfma_f32_16x16x32_bf16 v[104:107], a[124:127], v[140:143], v[104:107]
    v_exp_f32 v98, v90
    v_mfma_f32_16x16x32_bf16 v[104:107], a[128:131], v[144:147], v[104:107]
    v_exp_f32 v99, v91
    v_mfma_f32_16x16x32_bf16 v[104:107], a[132:135], v[148:151], v[104:107]
    v_mul_f32 v88, v96, v128
    v_mul_f32 v89, v97, v129
    v_mfma_f32_16x16x32_bf16 v[104:107], a[136:139], v[152:155], v[104:107]
    v_mul_f32 v90, v98, v130
    v_mul_f32 v91, v99, v131
    v_mfma_f32_16x16x32_bf16 v[104:107], a[140:143], v[156:159], v[104:107]
    v_fma_f32 v112, v116, 2.0, v112
    v_fma_f32 v113, v117, 2.0, v113
    v_fma_f32 v114, v118, 2.0, v114
    v_fma_f32 v115, v119, 2.0, v115
    v_cndmask_b32 v4, 0, v112, s[44:45]
    v_cndmask_b32 v4, v4, v113, s[46:47]
    v_cndmask_b32 v4, v4, v114, s[48:49]
    v_cndmask_b32 v4, v4, v115, s[50:51]
    v_add_f32 v63, v63, v96
    v_fmac_f32 v64, v88, v92
    v_mfma_f32_16x16x4_f32 v[124:127], v4, v60, v[56:59]
    v_add_f32 v63, v63, v97
    v_fmac_f32 v64, v89, v93
    v_add_f32 v63, v63, v98
    v_fmac_f32 v64, v90, v94
    v_add_f32 v63, v63, v99
    v_fmac_f32 v64, v91, v95
    v_mov_b32 v68, v88
    v_mov_b32 v69, v89
    v_mov_b32 v70, v90
    v_mov_b32 v71, v91
    v_add_u32 v44, 49152, v44
    v_add_u32 v45, 49152, v45
    v_add_u32 v46, 49152, v46
    v_add_u32 v47, 49152, v47
    v_add_u32 v48, 49152, v48
    v_add_u32 v49, 49152, v49
    v_fma_f32 v132, -v108, v108, v124
    v_fma_f32 v133, -v109, v109, v125
    v_fma_f32 v134, -v110, v110, v126
    v_fma_f32 v135, -v111, v111, v127
    v_max_f32 v132, v132, v56
    v_max_f32 v133, v133, v56
    v_max_f32 v134, v134, v56
    v_max_f32 v135, v135, v56
    v_rsq_f32 v132, v132
    v_rsq_f32 v133, v133
    v_rsq_f32 v134, v134
    v_rsq_f32 v135, v135
    s_add_u32 m0, s40, 4096
    s_nop 0
    buffer_load_dwordx4 v20, s[28:31], s57 offen offset:0 nt lds
    v_fma_f32 v104, -v108, v61, v104
    v_fma_f32 v105, -v109, v61, v105
    v_fma_f32 v106, -v110, v61, v106
    v_fma_f32 v107, -v111, v61, v107
    v_fma_f32 v104, v104, v132, v62
    v_fma_f32 v105, v105, v133, v62
    v_fma_f32 v106, v106, v134, v62
    v_fma_f32 v107, v107, v135, v62
    v_max3_f32 v1, v104, v105, v106
    v_max_f32 v1, v1, v107
    v_cmp_lt_f32 vcc, s52, v1
    s_cbranch_vccnz L_site3
L_back3:
    buffer_load_dwordx4 v21, s[28:31], s57 offen offset:1024 nt lds
    v_exp_f32 v112, v104
    v_exp_f32 v113, v105
    v_exp_f32 v114, v106
    v_exp_f32 v115, v107
    v_cvt_pk_bf16_f32 v72, v88, v89
    v_cvt_pk_bf16_f32 v73, v90, v91
    v_mul_f32 v104, v112, v132
    v_mul_f32 v105, v113, v133
    v_mul_f32 v106, v114, v134
    v_mul_f32 v107, v115, v135
    v_cvt_pk_bf16_f32 v74, v104, v105
    v_cvt_pk_bf16_f32 v75, v106, v107
    ds_write_b128 v237, v[72:75] offset:0
    s_waitcnt lgkmcnt(0)
    s_barrier
L_post24:
    ds_read_b32 v9, v254 offset:4096
    ds_read_b128 v[92:95], v253 offset:0
    ds_read_b128 v[96:99], v253 offset:1024
    ds_read_b128 v[100:103], v253 offset:2048
    ds_read_b128 v[116:119], v253 offset:3072
    s_waitcnt lgkmcnt(4)
    v_cmp_ne_u32 vcc, 0, v9
    s_cbranch_vccnz L_xt24
    s_waitcnt lgkmcnt(3)
    v_mfma_f32_16x16x32_bf16 a[0:3], a[144:147], v[92:95], a[0:3]
    buffer_load_dword v244, v245, s[32:35], 0 offen offset:128 sc1
    v_add_f32 v68, v68, v104
    v_add_f32 v69, v69, v105
    v_mfma_f32_16x16x32_bf16 a[4:7], a[160:163], v[92:95], a[4:7]
    v_add_f32 v70, v70, v106
    v_add_f32 v71, v71, v107
    v_mfma_f32_16x16x32_bf16 a[8:11], a[176:179], v[92:95], a[8:11]
    v_add_f32 v63, v63, v112
    v_fma_f32 v64, v104, v108, v64
    s_waitcnt lgkmcnt(2)
    v_mfma_f32_16x16x32_bf16 a[0:3], a[148:151], v[96:99], a[0:3]
    v_add_f32 v63, v63, v113
    v_fma_f32 v64, v105, v109, v64
    v_mfma_f32_16x16x32_bf16 a[4:7], a[164:167], v[96:99], a[4:7]
    s_add_u32 m0, s41, 0
    s_add_u32 s58, s37, 98304
    buffer_load_dwordx4 v22, s[24:27], s58 offen offset:0 nt lds
    v_add_f32 v63, v63, v114
    v_fma_f32 v64, v106, v110, v64
    v_mfma_f32_16x16x32_bf16 a[8:11], a[180:183], v[96:99], a[8:11]
    v_add_f32 v63, v63, v115
    v_fma_f32 v64, v107, v111, v64
    s_waitcnt lgkmcnt(1)
    v_mfma_f32_16x16x32_bf16 a[0:3], a[152:155], v[100:103], a[0:3]
    v_mfma_f32_16x16x32_bf16 a[4:7], a[168:171], v[100:103], a[4:7]
    v_mfma_f32_16x16x32_bf16 a[8:11], a[184:187], v[100:103], a[8:11]
    s_waitcnt lgkmcnt(0)
    v_mfma_f32_16x16x32_bf16 a[0:3], a[156:159], v[116:119], a[0:3]
    v_mfma_f32_16x16x32_bf16 a[4:7], a[172:175], v[116:119], a[4:7]
    v_mfma_f32_16x16x32_bf16 a[8:11], a[188:191], v[116:119], a[8:11]
    buffer_load_dwordx4 v23, s[24:27], s58 offen offset:1024 nt lds
    buffer_load_dwordx4 v24, s[24:27], s58 offen offset:2048 nt lds
    buffer_load_dwordx4 v25, s[24:27], s58 offen offset:3072 nt lds
    s_add_u32 m0, s41, 4096
    s_nop 0
    buffer_load_dwordx4 v26, s[24:27], s58 offen offset:0 nt lds
    s_waitcnt vmcnt(12)
    s_barrier
    ds_read_b128 a[96:99], v40 offset:49152
    ds_read_b128 a[100:103], v41 offset:49152
    ds_read_b128 a[104:107], v42 offset:49152
    ds_read_b128 a[108:111], v43 offset:49152
    ds_read_b128 a[112:115], v40 offset:49408
    ds_read_b128 a[116:119], v41 offset:49408
    ds_read_b128 a[120:123], v42 offset:49408
    ds_read_b128 a[124:127], v43 offset:49408
    ds_read_b128 a[128:131], v40 offset:49664
    ds_read_b128 a[132:135], v41 offset:49664
    ds_read_b128 a[136:139], v42 offset:49664
    ds_read_b128 a[140:143], v43 offset:49664
    s_waitcnt lgkmcnt(11)
    v_mfma_f32_16x16x32_bf16 v[96:99], a[96:99], a[96:99], v[84:87]
    ds_read_b64_tr_b16 a[144:145], v44 offset:0
    ds_read_b64_tr_b16 a[146:147], v45 offset:0
    v_mfma_f32_16x16x32_bf16 v[100:103], a[96:99], a[48:51], 0
    ds_read_b64_tr_b16 a[148:149], v44 offset:12288
    ds_read_b64_tr_b16 a[150:151], v45 offset:12288
    s_waitcnt lgkmcnt(14)
    v_mfma_f32_16x16x32_bf16 v[96:99], a[100:103], a[100:103], v[96:99]
    ds_read_b64_tr_b16 a[152:153], v44 offset:24576
    ds_read_b64_tr_b16 a[154:155], v45 offset:24576
    v_mfma_f32_16x16x32_bf16 v[100:103], a[100:103], a[52:55], v[100:103]
    ds_read_b64_tr_b16 a[156:157], v44 offset:36864
    ds_read_b64_tr_b16 a[158:159], v45 offset:36864
    s_waitcnt lgkmcnt(15)
    v_mfma_f32_16x16x32_bf16 v[96:99], a[104:107], a[104:107], v[96:99]
    ds_read_b64_tr_b16 a[160:161], v46 offset:0
    ds_read_b64_tr_b16 a[162:163], v47 offset:0
    v_mfma_f32_16x16x32_bf16 v[100:103], a[104:107], a[56:59], v[100:103]
    ds_read_b64_tr_b16 a[164:165], v46 offset:12288
    ds_read_b64_tr_b16 a[166:167], v47 offset:12288
    v_mfma_f32_16x16x32_bf16 v[96:99], a[108:111], a[108:111], v[96:99]
    buffer_load_dwordx4 v27, s[24:27], s58 offen offset:1024 nt lds
    ds_read_b64_tr_b16 a[168:169], v46 offset:24576
    ds_read_b64_tr_b16 a[170:171], v47 offset:24576
    v_mfma_f32_16x16x32_bf16 v[100:103], a[108:111], a[60:63], v[100:103]
    ds_read_b64_tr_b16 a[172:173], v46 offset:36864
    ds_read_b64_tr_b16 a[174:175], v47 offset:36864
    v_mfma_f32_16x16x32_bf16 v[96:99], a[112:115], a[112:115], v[96:99]
    ds_read_b64_tr_b16 a[176:177], v48 offset:0
    ds_read_b64_tr_b16 a[178:179], v49 offset:0
    v_mfma_f32_16x16x32_bf16 v[100:103], a[112:115], a[64:67], v[100:103]
    ds_read_b64_tr_b16 a[180:181], v48 offset:12288
    ds_read_b64_tr_b16 a[182:183], v49 offset:12288
    s_waitcnt lgkmcnt(15)
    v_mfma_f32_16x16x32_bf16 v[96:99], a[116:119], a[116:119], v[96:99]
    ds_read_b64_tr_b16 a[184:185], v48 offset:24576
    ds_read_b64_tr_b16 a[186:187], v49 offset:24576
    v_mfma_f32_16x16x32_bf16 v[100:103], a[116:119], a[68:71], v[100:103]
    ds_read_b64_tr_b16 a[188:189], v48 offset:36864
    ds_read_b64_tr_b16 a[190:191], v49 offset:36864
    v_mfma_f32_16x16x32_bf16 v[92:95], a[96:99], v[52:55], v[80:83]
    v_mfma_f32_16x16x32_bf16 v[92:95], a[100:103], v[52:55], v[92:95]
    v_mfma_f32_16x16x32_bf16 v[92:95], a[104:107], v[52:55], v[92:95]
    v_mfma_f32_16x16x32_bf16 v[92:95], a[108:111], v[52:55], v[92:95]
    s_nop 1
    v_fma_f32 v96, v100, 2.0, v96
    v_fma_f32 v97, v101, 2.0, v97
    v_mfma_f32_16x16x32_bf16 v[92:95], a[112:115], v[52:55], v[92:95]
    v_fma_f32 v98, v102, 2.0, v98
    v_fma_f32 v99, v103, 2.0, v99
    v_mfma_f32_16x16x32_bf16 v[92:95], a[116:119], v[52:55], v[92:95]
    v_cndmask_b32 v3, 0, v96, s[44:45]
    v_cndmask_b32 v3, v3, v97, s[46:47]
    v_mfma_f32_16x16x32_bf16 v[88:91], a[96:99], v[136:139], v[76:79]
    buffer_load_dwordx4 v28, s[24:27], s58 offen offset:2048 nt lds
    v_cndmask_b32 v3, v3, v98, s[48:49]
    v_cndmask_b32 v3, v3, v99, s[50:51]
    v_mfma_f32_16x16x32_bf16 v[88:91], a[100:103], v[140:143], v[88:91]
    s_nop 0
    s_nop 0
    v_mfma_f32_16x16x32_bf16 v[88:91], a[104:107], v[144:147], v[88:91]
    v_mfma_f32_16x16x4_f32 v[120:123], v3, v60, v[56:59]
    v_mfma_f32_16x16x32_bf16 v[88:91], a[108:111], v[148:151], v[88:91]
    v_mfma_f32_16x16x32_bf16 v[88:91], a[112:115], v[152:155], v[88:91]
    v_mfma_f32_16x16x32_bf16 v[88:91], a[116:119], v[156:159], v[88:91]
    v_mfma_f32_16x16x32_bf16 v[112:115], a[120:123], a[120:123], v[84:87]
    v_mfma_f32_16x16x32_bf16 v[116:119], a[120:123], a[48:51], 0
    v_mfma_f32_16x16x32_bf16 v[112:115], a[124:127], a[124:127], v[112:115]
    v_mfma_f32_16x16x32_bf16 v[116:119], a[124:127], a[52:55], v[116:119]
    s_nop 2
    v_fma_f32 v128, -v92, v92, v120
    v_fma_f32 v129, -v93, v93, v121
    v_mfma_f32_16x16x32_bf16 v[112:115], a[128:131], a[128:131], v[112:115]
    v_fma_f32 v130, -v94, v94, v122
    v_fma_f32 v131, -v95, v95, v123
    v_mfma_f32_16x16x32_bf16 v[116:119], a[128:131], a[56:59], v[116:119]
    buffer_load_dwordx4 v29, s[24:27], s58 offen offset:3072 nt lds
    v_max_f32 v128, v128, v56
    v_max_f32 v129, v129, v56
    v_mfma_f32_16x16x32_bf16 v[112:115], a[132:135], a[132:135], v[112:115]
    v_max_f32 v130, v130, v56
    v_max_f32 v131, v131, v56
    v_mfma_f32_16x16x32_bf16 v[116:119], a[132:135], a[60:63], v[116:119]
    v_rsq_f32 v128, v128
    v_mfma_f32_16x16x32_bf16 v[112:115], a[136:139], a[136:139], v[112:115]
    v_rsq_f32 v129, v129
    v_mfma_f32_16x16x32_bf16 v[116:119], a[136:139], a[64:67], v[116:119]
    v_rsq_f32 v130, v130
    v_mfma_f32_16x16x32_bf16 v[112:115], a[140:143], a[140:143], v[112:115]
    v_rsq_f32 v131, v131
    v_mfma_f32_16x16x32_bf16 v[116:119], a[140:143], a[68:71], v[116:119]
    v_fma_f32 v88, -v92, v61, v88
    v_fma_f32 v89, -v93, v61, v89
    v_mfma_f32_16x16x32_bf16 v[108:111], a[120:123], v[52:55], v[80:83]
    v_fma_f32 v90, -v94, v61, v90
    v_fma_f32 v91, -v95, v61, v91
    v_mfma_f32_16x16x32_bf16 v[108:111], a[124:127], v[52:55], v[108:111]
    v_fma_f32 v88, v88, v128, v62
    v_fma_f32 v89, v89, v129, v62
    v_mfma_f32_16x16x32_bf16 v[108:111], a[128:131], v[52:55], v[108:111]
    v_fma_f32 v90, v90, v130, v62
    v_fma_f32 v91, v91, v131, v62
    v_mfma_f32_16x16x32_bf16 v[108:111], a[132:135], v[52:55], v[108:111]
    v_max3_f32 v1, v88, v89, v90
    v_max_f32 v1, v1, v91
    v_mfma_f32_16x16x32_bf16 v[108:111], a[136:139], v[52:55], v[108:111]
    v_cmp_lt_f32 vcc, s52, v1
    s_cbranch_vccnz L_site4
L_back4:
    v_mfma_f32_16x16x32_bf16 v[108:111], a[140:143], v[52:55], v[108:111]
    v_exp_f32 v96, v88
    v_mfma_f32_16x16x32_bf16 v[104:107], a[120:123], v[136:139], v[76:79]
    s_add_u32 m0, s41, 8192
    s_nop 0
    buffer_load_dwordx4 v30, s[24:27], s58 offen offset:0 nt lds
    v_exp_f32 v97, v89
    v_mfma_f32_16x16x32_bf16 v[104:107], a[124:127], v[140:143], v[104:107]
    v_exp_f32 v98, v90
    v_mfma_f32_16x16x32_bf16 v[104:107], a[128:131], v[144:147], v[104:107]
    v_exp_f32 v99, v91
    v_mfma_f32_16x16x32_bf16 v[104:107], a[132:135], v[148:151], v[104:107]
    v_mul_f32 v88, v96, v128
    v_mul_f32 v89, v97, v129
    v_mfma_f32_16x16x32_bf16 v[104:107], a[136:139], v[152:155], v[104:107]
    v_mul_f32 v90, v98, v130
    v_mul_f32 v91, v99, v131
    v_mfma_f32_16x16x32_bf16 v[104:107], a[140:143], v[156:159], v[104:107]
    v_fma_f32 v112, v116, 2.0, v112
    v_fma_f32 v113, v117, 2.0, v113
    v_fma_f32 v114, v118, 2.0, v114
    v_fma_f32 v115, v119, 2.0, v115
    v_cndmask_b32 v4, 0, v112, s[44:45]
    v_cndmask_b32 v4, v4, v113, s[46:47]
    v_cndmask_b32 v4, v4, v114, s[48:49]
    v_cndmask_b32 v4, v4, v115, s[50:51]
    v_add_f32 v63, v63, v96
    v_fmac_f32 v64, v88, v92
    v_mfma_f32_16x16x4_f32 v[124:127], v4, v60, v[56:59]
    v_add_f32 v63, v63, v97
    v_fmac_f32 v64, v89, v93
    v_add_f32 v63, v63, v98
    v_fmac_f32 v64, v90, v94
    v_add_f32 v63, v63, v99
    v_fmac_f32 v64, v91, v95
    v_add_f32 v68, v68, v88
    v_add_f32 v69, v69, v89
    v_add_f32 v70, v70, v90
    v_add_f32 v71, v71, v91
    v_add_u32 v44, -49152, v44
    v_add_u32 v45, -49152, v45
    v_add_u32 v46, -49152, v46
    v_add_u32 v47, -49152, v47
    v_add_u32 v48, -49152, v48
    v_add_u32 v49, -49152, v49
    v_fma_f32 v132, -v108, v108, v124
    v_fma_f32 v133, -v109, v109, v125
    v_fma_f32 v134, -v110, v110, v126
    v_fma_f32 v135, -v111, v111, v127
    v_max_f32 v132, v132, v56
    v_max_f32 v133, v133, v56
    v_max_f32 v134, v134, v56
    v_max_f32 v135, v135, v56
    v_rsq_f32 v132, v132
    v_rsq_f32 v133, v133
    v_rsq_f32 v134, v134
    v_rsq_f32 v135, v135
    buffer_load_dwordx4 v31, s[24:27], s58 offen offset:1024 nt lds
    v_fma_f32 v104, -v108, v61, v104
    v_fma_f32 v105, -v109, v61, v105
    v_fma_f32 v106, -v110, v61, v106
    v_fma_f32 v107, -v111, v61, v107
    v_fma_f32 v104, v104, v132, v62
    v_fma_f32 v105, v105, v133, v62
    v_fma_f32 v106, v106, v134, v62
    v_fma_f32 v107, v107, v135, v62
    v_max3_f32 v1, v104, v105, v106
    v_max_f32 v1, v1, v107
    v_cmp_lt_f32 vcc, s52, v1
    s_cbranch_vccnz L_site5
L_back5:
    v_exp_f32 v112, v104
    v_exp_f32 v113, v105
    v_exp_f32 v114, v106
    v_exp_f32 v115, v107
    v_cvt_pk_bf16_f32 v72, v88, v89
    v_cvt_pk_bf16_f32 v73, v90, v91
    v_mul_f32 v104, v112, v132
    v_mul_f32 v105, v113, v133
    v_mul_f32 v106, v114, v134
    v_mul_f32 v107, v115, v135
    v_cvt_pk_bf16_f32 v74, v104, v105
    v_cvt_pk_bf16_f32 v75, v106, v107
    ds_write_b128 v237, v[72:75] offset:0
    v_add_f32 v68, v68, v104
    v_add_f32 v69, v69, v105
    v_add_f32 v70, v70, v106
    v_add_f32 v71, v71, v107
    v_cvt_pk_bf16_f32 v66, v68, v69
    v_cvt_pk_bf16_f32 v67, v70, v71
    ds_write_b64 v238, v[66:67]
    buffer_load_dwordx4 v32, s[24:27], s58 offen offset:2048 nt lds
    buffer_load_dwordx4 v33, s[24:27], s58 offen offset:3072 nt lds
    s_waitcnt vmcnt(13)
    s_waitcnt vmcnt(12)
    v_cmp_ne_u32 vcc, s39, v244
    s_cbranch_vccnz L_fl_retry
L_fl_ok:
    s_waitcnt lgkmcnt(0)
    s_barrier
L_post6:
    ds_read_b32 v9, v254 offset:4096
    ds_read_b64 v[120:121], v254 offset:0
    ds_read_b64 v[122:123], v254 offset:512
    ds_read_b64 v[124:125], v254 offset:1024
    ds_read_b64 v[126:127], v254 offset:1536
    ds_read_b128 v[92:95], v253 offset:0
    ds_read_b128 v[96:99], v253 offset:1024
    ds_read_b128 v[100:103], v253 offset:2048
    ds_read_b128 v[116:119], v253 offset:3072
    ds_read_b128 a[48:51], v34 offset:0
    ds_read_b128 a[52:55], v35 offset:0
    ds_read_b128 a[56:59], v34 offset:128
    ds_read_b128 a[60:63], v35 offset:128
    ds_read_b128 a[64:67], v34 offset:256
    ds_read_b128 a[68:71], v35 offset:256
    s_waitcnt lgkmcnt(14)
    v_cmp_ne_u32 vcc, 0, v9
    s_cbranch_vccnz L_xt6
    s_waitcnt lgkmcnt(12)
    v_mfma_f32_16x16x32_bf16 a[0:3], a[72:75], v[120:123], a[0:3]
    s_add_u32 m0, s42, 0
    s_add_u32 s59, s37, 294912
    buffer_load_dwordx4 v22, s[24:27], s59 offen offset:0 nt lds
    v_add_f32 v63, v63, v112
    v_fma_f32 v64, v104, v108, v64
    v_mfma_f32_16x16x32_bf16 a[4:7], a[80:83], v[120:123], a[4:7]
    v_add_f32 v63, v63, v113
    v_fma_f32 v64, v105, v109, v64
    v_mfma_f32_16x16x32_bf16 a[8:11], a[88:91], v[120:123], a[8:11]
    v_add_f32 v63, v63, v114
    v_fma_f32 v64, v106, v110, v64
    s_waitcnt lgkmcnt(10)
    v_mfma_f32_16x16x32_bf16 a[0:3], a[76:79], v[124:127], a[0:3]
    v_add_f32 v63, v63, v115
    v_fma_f32 v64, v107, v111, v64
    v_mfma_f32_16x16x32_bf16 a[4:7], a[84:87], v[124:127], a[4:7]
    v_mfma_f32_16x16x32_bf16 a[8:11], a[92:95], v[124:127], a[8:11]
    s_waitcnt lgkmcnt(9)
    v_mfma_f32_16x16x32_bf16 a[0:3], a[144:147], v[92:95], a[0:3]
    ds_read_b64_tr_b16 a[72:73], v36 offset:0
    ds_read_b64_tr_b16 a[74:75], v36 offset:6144
    v_mfma_f32_16x16x32_bf16 a[4:7], a[160:163], v[92:95], a[4:7]
    ds_read_b64_tr_b16 a[76:77], v36 offset:12288
    ds_read_b64_tr_b16 a[78:79], v36 offset:18432
    v_mfma_f32_16x16x32_bf16 a[8:11], a[176:179], v[92:95], a[8:11]
    ds_read_b64_tr_b16 a[80:81], v37 offset:0
    ds_read_b64_tr_b16 a[82:83], v37 offset:6144
    s_waitcnt lgkmcnt(14)
    v_mfma_f32_16x16x32_bf16 a[0:3], a[148:151], v[96:99], a[0:3]
    buffer_load_dwordx4 v23, s[24:27], s59 offen offset:1024 nt lds
    ds_read_b64_tr_b16 a[84:85], v37 offset:12288
    ds_read_b64_tr_b16 a[86:87], v37 offset:18432
    v_mfma_f32_16x16x32_bf16 a[4:7], a[164:167], v[96:99], a[4:7]
    ds_read_b64_tr_b16 a[88:89], v38 offset:0
    ds_read_b64_tr_b16 a[90:91], v38 offset:6144
    v_mfma_f32_16x16x32_bf16 a[8:11], a[180:183], v[96:99], a[8:11]
    ds_read_b64_tr_b16 a[92:93], v38 offset:12288
    ds_read_b64_tr_b16 a[94:95], v38 offset:18432
    s_waitcnt lgkmcnt(15)
    v_mfma_f32_16x16x32_bf16 a[0:3], a[152:155], v[100:103], a[0:3]
    v_mfma_f32_16x16x32_bf16 a[4:7], a[168:171], v[100:103], a[4:7]
    v_mfma_f32_16x16x32_bf16 a[8:11], a[184:187], v[100:103], a[8:11]
    v_mfma_f32_16x16x32_bf16 a[0:3], a[156:159], v[116:119], a[0:3]
    v_mfma_f32_16x16x32_bf16 a[4:7], a[172:175], v[116:119], a[4:7]
    v_mfma_f32_16x16x32_bf16 a[8:11], a[188:191], v[116:119], a[8:11]
    v_mfma_f32_16x16x32_bf16 v[84:87], a[48:51], a[48:51], 0
    v_mfma_f32_16x16x32_bf16 v[80:83], a[48:51], v[52:55], 0
    v_mfma_f32_16x16x32_bf16 v[84:87], a[52:55], a[52:55], v[84:87]
    v_mfma_f32_16x16x32_bf16 v[80:83], a[52:55], v[52:55], v[80:83]
    v_mfma_f32_16x16x32_bf16 v[84:87], a[56:59], a[56:59], v[84:87]
    s_add_u32 s61, s60, 3145728
    buffer_load_dwordx4 v[160:163], v65, s[72:75], s61 offen offset:0 sc1
    v_mfma_f32_16x16x32_bf16 v[80:83], a[56:59], v[52:55], v[80:83]
    s_waitcnt lgkmcnt(14)
    v_mfma_f32_16x16x32_bf16 v[84:87], a[60:63], a[60:63], v[84:87]
    v_mfma_f32_16x16x32_bf16 v[80:83], a[60:63], v[52:55], v[80:83]
    s_waitcnt lgkmcnt(13)
    v_mfma_f32_16x16x32_bf16 v[84:87], a[64:67], a[64:67], v[84:87]
    v_mfma_f32_16x16x32_bf16 v[80:83], a[64:67], v[52:55], v[80:83]
    s_waitcnt lgkmcnt(12)
    v_mfma_f32_16x16x32_bf16 v[84:87], a[68:71], a[68:71], v[84:87]
    v_mfma_f32_16x16x32_bf16 v[80:83], a[68:71], v[52:55], v[80:83]
    s_waitcnt lgkmcnt(0)
    v_mfma_f32_16x16x32_bf16 v[76:79], a[48:51], v[136:139], 0
    v_mfma_f32_16x16x32_bf16 v[76:79], a[52:55], v[140:143], v[76:79]
    v_mfma_f32_16x16x32_bf16 v[76:79], a[56:59], v[144:147], v[76:79]
    v_mfma_f32_16x16x32_bf16 v[76:79], a[60:63], v[148:151], v[76:79]
    v_mfma_f32_16x16x32_bf16 v[76:79], a[64:67], v[152:155], v[76:79]
    v_mfma_f32_16x16x32_bf16 v[76:79], a[68:71], v[156:159], v[76:79]
    buffer_load_dwordx4 v24, s[24:27], s59 offen offset:2048 nt lds
    buffer_load_dwordx4 v25, s[24:27], s59 offen offset:3072 nt lds
    s_add_u32 m0, s42, 4096
    s_nop 0
    buffer_load_dwordx4 v26, s[24:27], s59 offen offset:0 nt lds
    buffer_load_dwordx4 v27, s[24:27], s59 offen offset:1024 nt lds
    buffer_load_dwordx4 v[164:167], v65, s[72:75], s61 offen offset:1024 sc1
    buffer_load_dwordx4 v28, s[24:27], s59 offen offset:2048 nt lds
    buffer_load_dwordx4 v29, s[24:27], s59 offen offset:3072 nt lds
    s_add_u32 m0, s42, 8192
    s_nop 0
    buffer_load_dwordx4 v30, s[24:27], s59 offen offset:0 nt lds
    buffer_load_dwordx4 v31, s[24:27], s59 offen offset:1024 nt lds
    s_waitcnt vmcnt(12)
    s_barrier
    ds_read_b128 a[96:99], v40 offset:0
    ds_read_b128 a[100:103], v41 offset:0
    ds_read_b128 a[104:107], v42 offset:0
    ds_read_b128 a[108:111], v43 offset:0
    ds_read_b128 a[112:115], v40 offset:256
    ds_read_b128 a[116:119], v41 offset:256
    ds_read_b128 a[120:123], v42 offset:256
    ds_read_b128 a[124:127], v43 offset:256
    ds_read_b128 a[128:131], v40 offset:512
    ds_read_b128 a[132:135], v41 offset:512
    ds_read_b128 a[136:139], v42 offset:512
    ds_read_b128 a[140:143], v43 offset:512
    s_waitcnt lgkmcnt(11)
    v_mfma_f32_16x16x32_bf16 v[96:99], a[96:99], a[96:99], v[84:87]
    ds_read_b64_tr_b16 a[144:145], v44 offset:0
    ds_read_b64_tr_b16 a[146:147], v45 offset:0
    v_mfma_f32_16x16x32_bf16 v[100:103], a[96:99], a[48:51], 0
    ds_read_b64_tr_b16 a[148:149], v44 offset:12288
    ds_read_b64_tr_b16 a[150:151], v45 offset:12288
    s_waitcnt lgkmcnt(14)
    v_mfma_f32_16x16x32_bf16 v[96:99], a[100:103], a[100:103], v[96:99]
    ds_read_b64_tr_b16 a[152:153], v44 offset:24576
    ds_read_b64_tr_b16 a[154:155], v45 offset:24576
    v_mfma_f32_16x16x32_bf16 v[100:103], a[100:103], a[52:55], v[100:103]
    ds_read_b64_tr_b16 a[156:157], v44 offset:36864
    ds_read_b64_tr_b16 a[158:159], v45 offset:36864
    s_waitcnt lgkmcnt(15)
    v_mfma_f32_16x16x32_bf16 v[96:99], a[104:107], a[104:107], v[96:99]
    ds_read_b64_tr_b16 a[160:161], v46 offset:0
    ds_read_b64_tr_b16 a[162:163], v47 offset:0
    v_mfma_f32_16x16x32_bf16 v[100:103], a[104:107], a[56:59], v[100:103]
    ds_read_b64_tr_b16 a[164:165], v46 offset:12288
    ds_read_b64_tr_b16 a[166:167], v47 offset:12288
    v_mfma_f32_16x16x32_bf16 v[96:99], a[108:111], a[108:111], v[96:99]
    buffer_load_dwordx4 v[168:171], v65, s[72:75], s61 offen offset:2048 sc1
    ds_read_b64_tr_b16 a[168:169], v46 offset:24576
    ds_read_b64_tr_b16 a[170:171], v47 offset:24576
    v_mfma_f32_16x16x32_bf16 v[100:103], a[108:111], a[60:63], v[100:103]
    ds_read_b64_tr_b16 a[172:173], v46 offset:36864
    ds_read_b64_tr_b16 a[174:175], v47 offset:36864
    v_mfma_f32_16x16x32_bf16 v[96:99], a[112:115], a[112:115], v[96:99]
    ds_read_b64_tr_b16 a[176:177], v48 offset:0
    ds_read_b64_tr_b16 a[178:179], v49 offset:0
    v_mfma_f32_16x16x32_bf16 v[100:103], a[112:115], a[64:67], v[100:103]
    ds_read_b64_tr_b16 a[180:181], v48 offset:12288
    ds_read_b64_tr_b16 a[182:183], v49 offset:12288
    s_waitcnt lgkmcnt(15)
    v_mfma_f32_16x16x32_bf16 v[96:99], a[116:119], a[116:119], v[96:99]
    ds_read_b64_tr_b16 a[184:185], v48 offset:24576
    ds_read_b64_tr_b16 a[186:187], v49 offset:24576
    v_mfma_f32_16x16x32_bf16 v[100:103], a[116:119], a[68:71], v[100:103]
    ds_read_b64_tr_b16 a[188:189], v48 offset:36864
    ds_read_b64_tr_b16 a[190:191], v49 offset:36864
    v_mfma_f32_16x16x32_bf16 v[92:95], a[96:99], v[52:55], v[80:83]
    v_mfma_f32_16x16x32_bf16 v[92:95], a[100:103], v[52:55], v[92:95]
    v_mfma_f32_16x16x32_bf16 v[92:95], a[104:107], v[52:55], v[92:95]
    v_mfma_f32_16x16x32_bf16 v[92:95], a[108:111], v[52:55], v[92:95]
    s_nop 1
    v_fma_f32 v96, v100, 2.0, v96
    v_fma_f32 v97, v101, 2.0, v97
    v_mfma_f32_16x16x32_bf16 v[92:95], a[112:115], v[52:55], v[92:95]
    v_fma_f32 v98, v102, 2.0, v98
    v_fma_f32 v99, v103, 2.0, v99
    v_mfma_f32_16x16x32_bf16 v[92:95], a[116:119], v[52:55], v[92:95]
    v_cndmask_b32 v3, 0, v96, s[44:45]
    v_cndmask_b32 v3, v3, v97, s[46:47]
    v_mfma_f32_16x16x32_bf16 v[88:91], a[96:99], v[136:139], v[76:79]
    buffer_load_dwordx4 v32, s[24:27], s59 offen offset:2048 nt lds
    v_cndmask_b32 v3, v3, v98, s[48:49]
    v_cndmask_b32 v3, v3, v99, s[50:51]
    v_mfma_f32_16x16x32_bf16 v[88:91], a[100:103], v[140:143], v[88:91]
    buffer_load_dwordx4 v33, s[24:27], s59 offen offset:3072 nt lds
    s_nop 0
    s_nop 0
    v_mfma_f32_16x16x32_bf16 v[88:91], a[104:107], v[144:147], v[88:91]
    v_mfma_f32_16x16x4_f32 v[120:123], v3, v60, v[56:59]
    v_mfma_f32_16x16x32_bf16 v[88:91], a[108:111], v[148:151], v[88:91]
    v_mfma_f32_16x16x32_bf16 v[88:91], a[112:115], v[152:155], v[88:91]
    v_mfma_f32_16x16x32_bf16 v[88:91], a[116:119], v[156:159], v[88:91]
    v_mfma_f32_16x16x32_bf16 v[112:115], a[120:123], a[120:123], v[84:87]
    v_mfma_f32_16x16x32_bf16 v[116:119], a[120:123], a[48:51], 0
    v_mfma_f32_16x16x32_bf16 v[112:115], a[124:127], a[124:127], v[112:115]
    v_mfma_f32_16x16x32_bf16 v[116:119], a[124:127], a[52:55], v[116:119]
    s_nop 2
    v_fma_f32 v128, -v92, v92, v120
    v_fma_f32 v129, -v93, v93, v121
    v_mfma_f32_16x16x32_bf16 v[112:115], a[128:131], a[128:131], v[112:115]
    s_add_u32 m0, s40, 0
    s_add_u32 s57, s36, 73728
    buffer_load_dwordx4 v16, s[28:31], s57 offen offset:0 nt lds
    v_fma_f32 v130, -v94, v94, v122
    v_fma_f32 v131, -v95, v95, v123
    v_mfma_f32_16x16x32_bf16 v[116:119], a[128:131], a[56:59], v[116:119]
    v_max_f32 v128, v128, v56
    v_max_f32 v129, v129, v56
    v_mfma_f32_16x16x32_bf16 v[112:115], a[132:135], a[132:135], v[112:115]
    v_max_f32 v130, v130, v56
    v_max_f32 v131, v131, v56
    v_mfma_f32_16x16x32_bf16 v[116:119], a[132:135], a[60:63], v[116:119]
    v_rsq_f32 v128, v128
    v_mfma_f32_16x16x32_bf16 v[112:115], a[136:139], a[136:139], v[112:115]
    v_rsq_f32 v129, v129
    v_mfma_f32_16x16x32_bf16 v[116:119], a[136:139], a[64:67], v[116:119]
    v_rsq_f32 v130, v130
    v_mfma_f32_16x16x32_bf16 v[112:115], a[140:143], a[140:143], v[112:115]
    v_rsq_f32 v131, v131
    v_mfma_f32_16x16x32_bf16 v[116:119], a[140:143], a[68:71], v[116:119]
    v_fma_f32 v88, -v92, v61, v88
    v_fma_f32 v89, -v93, v61, v89
    v_mfma_f32_16x16x32_bf16 v[108:111], a[120:123], v[52:55], v[80:83]
    v_fma_f32 v90, -v94, v61, v90
    v_fma_f32 v91, -v95, v61, v91
    v_mfma_f32_16x16x32_bf16 v[108:111], a[124:127], v[52:55], v[108:111]
    v_fma_f32 v88, v88, v128, v62
    v_fma_f32 v89, v89, v129, v62
    v_mfma_f32_16x16x32_bf16 v[108:111], a[128:131], v[52:55], v[108:111]
    v_fma_f32 v90, v90, v130, v62
    v_fma_f32 v91, v91, v131, v62
    v_mfma_f32_16x16x32_bf16 v[108:111], a[132:135], v[52:55], v[108:111]
    v_max3_f32 v1, v88, v89, v90
    v_max_f32 v1, v1, v91
    v_mfma_f32_16x16x32_bf16 v[108:111], a[136:139], v[52:55], v[108:111]
    buffer_load_dwordx4 v17, s[28:31], s57 offen offset:1024 nt lds
    v_cmp_lt_f32 vcc, s52, v1
    s_cbranch_vccnz L_site6
L_back6:
    v_mfma_f32_16x16x32_bf16 v[108:111], a[140:143], v[52:55], v[108:111]
    v_exp_f32 v96, v88
    v_mfma_f32_16x16x32_bf16 v[104:107], a[120:123], v[136:139], v[76:79]
    v_exp_f32 v97, v89
    v_mfma_f32_16x16x32_bf16 v[104:107], a[124:127], v[140:143], v[104:107]
    v_exp_f32 v98, v90
    v_mfma_f32_16x16x32_bf16 v[104:107], a[128:131], v[144:147], v[104:107]
    v_exp_f32 v99, v91
    v_mfma_f32_16x16x32_bf16 v[104:107], a[132:135], v[148:151], v[104:107]
    v_mul_f32 v88, v96, v128
    v_mul_f32 v89, v97, v129
    v_mfma_f32_16x16x32_bf16 v[104:107], a[136:139], v[152:155], v[104:107]
    v_mul_f32 v90, v98, v130
    v_mul_f32 v91, v99, v131
    v_mfma_f32_16x16x32_bf16 v[104:107], a[140:143], v[156:159], v[104:107]
    v_fma_f32 v112, v116, 2.0, v112
    v_fma_f32 v113, v117, 2.0, v113
    v_fma_f32 v114, v118, 2.0, v114
    v_fma_f32 v115, v119, 2.0, v115
    v_cndmask_b32 v4, 0, v112, s[44:45]
    v_cndmask_b32 v4, v4, v113, s[46:47]
    v_cndmask_b32 v4, v4, v114, s[48:49]
    v_cndmask_b32 v4, v4, v115, s[50:51]
    v_add_f32 v63, v63, v96
    v_fmac_f32 v64, v88, v92
    v_mfma_f32_16x16x4_f32 v[124:127], v4, v60, v[56:59]
    v_add_f32 v63, v63, v97
    v_fmac_f32 v64, v89, v93
    v_add_f32 v63, v63, v98
    v_fmac_f32 v64, v90, v94
    v_add_f32 v63, v63, v99
    v_fmac_f32 v64, v91, v95
    v_mov_b32 v68, v88
    v_mov_b32 v69, v89
    v_mov_b32 v70, v90
    v_mov_b32 v71, v91
    v_add_u32 v44, 49152, v44
    v_add_u32 v45, 49152, v45
    v_add_u32 v46, 49152, v46
    v_add_u32 v47, 49152, v47
    v_add_u32 v48, 49152, v48
    v_add_u32 v49, 49152, v49
    v_fma_f32 v132, -v108, v108, v124
    v_fma_f32 v133, -v109, v109, v125
    v_fma_f32 v134, -v110, v110, v126
    v_fma_f32 v135, -v111, v111, v127
    v_max_f32 v132, v132, v56
    v_max_f32 v133, v133, v56
    v_max_f32 v134, v134, v56
    v_max_f32 v135, v135, v56
    v_rsq_f32 v132, v132
    v_rsq_f32 v133, v133
    v_rsq_f32 v134, v134
    v_rsq_f32 v135, v135
    buffer_load_dwordx4 v[172:175], v65, s[72:75], s61 offen offset:3072 sc1
    v_fma_f32 v104, -v108, v61, v104
    v_fma_f32 v105, -v109, v61, v105
    v_fma_f32 v106, -v110, v61, v106
    v_fma_f32 v107, -v111, v61, v107
    v_fma_f32 v104, v104, v132, v62
    v_fma_f32 v105, v105, v133, v62
    v_fma_f32 v106, v106, v134, v62
    v_fma_f32 v107, v107, v135, v62
    v_max3_f32 v1, v104, v105, v106
    v_max_f32 v1, v1, v107
    v_cmp_lt_f32 vcc, s52, v1
    s_cbranch_vccnz L_site7
L_back7:
    v_exp_f32 v112, v104
    v_exp_f32 v113, v105
    v_exp_f32 v114, v106
    v_exp_f32 v115, v107
    v_cvt_pk_bf16_f32 v72, v88, v89
    v_cvt_pk_bf16_f32 v73, v90, v91
    v_mul_f32 v104, v112, v132
    v_mul_f32 v105, v113, v133
    v_mul_f32 v106, v114, v134
    v_mul_f32 v107, v115, v135
    v_cvt_pk_bf16_f32 v74, v104, v105
    v_cvt_pk_bf16_f32 v75, v106, v107
    ds_write_b128 v237, v[72:75] offset:0
    s_waitcnt lgkmcnt(0)
    s_barrier
L_post27:
    ds_read_b32 v9, v254 offset:4096
    ds_read_b128 v[92:95], v253 offset:0
    ds_read_b128 v[96:99], v253 offset:1024
    ds_read_b128 v[100:103], v253 offset:2048
    ds_read_b128 v[116:119], v253 offset:3072
    s_waitcnt lgkmcnt(4)
    v_cmp_ne_u32 vcc, 0, v9
    s_cbranch_vccnz L_xt27
    s_waitcnt lgkmcnt(3)
    v_mfma_f32_16x16x32_bf16 a[0:3], a[144:147], v[92:95], a[0:3]
    buffer_load_dwordx4 v18, s[28:31], s57 offen offset:2048 nt lds
    v_add_f32 v68, v68, v104
    v_add_f32 v69, v69, v105
    v_mfma_f32_16x16x32_bf16 a[4:7], a[160:163], v[92:95], a[4:7]
    buffer_load_dwordx4 v19, s[28:31], s57 offen offset:3072 nt lds
    v_add_f32 v70, v70, v106
    v_add_f32 v71, v71, v107
    v_mfma_f32_16x16x32_bf16 a[8:11], a[176:179], v[92:95], a[8:11]
    s_add_u32 m0, s40, 4096
    s_nop 0
    buffer_load_dwordx4 v20, s[28:31], s57 offen offset:0 nt lds
    v_add_f32 v63, v63, v112
    v_fma_f32 v64, v104, v108, v64
    s_waitcnt lgkmcnt(2)
    v_mfma_f32_16x16x32_bf16 a[0:3], a[148:151], v[96:99], a[0:3]
    v_add_f32 v63, v63, v113
    v_fma_f32 v64, v105, v109, v64
    v_mfma_f32_16x16x32_bf16 a[4:7], a[164:167], v[96:99], a[4:7]
    v_add_f32 v63, v63, v114
    v_fma_f32 v64, v106, v110, v64
    v_mfma_f32_16x16x32_bf16 a[8:11], a[180:183], v[96:99], a[8:11]
    v_add_f32 v63, v63, v115
    v_fma_f32 v64, v107, v111, v64
    s_waitcnt lgkmcnt(1)
    v_mfma_f32_16x16x32_bf16 a[0:3], a[152:155], v[100:103], a[0:3]
    s_add_u32 s61, s60, 3149824
    buffer_load_dwordx4 v[176:179], v65, s[72:75], s61 offen offset:0 sc1
    v_mfma_f32_16x16x32_bf16 a[4:7], a[168:171], v[100:103], a[4:7]
    v_mfma_f32_16x16x32_bf16 a[8:11], a[184:187], v[100:103], a[8:11]
    s_waitcnt lgkmcnt(0)
    v_mfma_f32_16x16x32_bf16 a[0:3], a[156:159], v[116:119], a[0:3]
    v_mfma_f32_16x16x32_bf16 a[4:7], a[172:175], v[116:119], a[4:7]
    v_mfma_f32_16x16x32_bf16 a[8:11], a[188:191], v[116:119], a[8:11]
    buffer_load_dwordx4 v21, s[28:31], s57 offen offset:1024 nt lds
    s_add_u32 m0, s41, 0
    s_add_u32 s58, s37, 147456
    buffer_load_dwordx4 v224, s[24:27], s58 offen offset:0 nt lds
    buffer_load_dwordx4 v225, s[24:27], s58 offen offset:1024 nt lds
    buffer_load_dwordx4 v226, s[24:27], s58 offen offset:2048 nt lds
    buffer_load_dwordx4 v[180:183], v65, s[72:75], s61 offen offset:1024 sc1
    s_waitcnt vmcnt(12)
    s_barrier
    ds_read_b128 a[96:99], v40 offset:49152
    ds_read_b128 a[100:103], v41 offset:49152
    ds_read_b128 a[104:107], v42 offset:49152
    ds_read_b128 a[108:111], v43 offset:49152
    ds_read_b128 a[112:115], v40 offset:49408
    ds_read_b128 a[116:119], v41 offset:49408
    ds_read_b128 a[120:123], v42 offset:49408
    ds_read_b128 a[124:127], v43 offset:49408
    ds_read_b128 a[128:131], v40 offset:49664
    ds_read_b128 a[132:135], v41 offset:49664
    ds_read_b128 a[136:139], v42 offset:49664
    ds_read_b128 a[140:143], v43 offset:49664
    s_waitcnt lgkmcnt(11)
    v_mfma_f32_16x16x32_bf16 v[96:99], a[96:99], a[96:99], v[84:87]
    ds_read_b64_tr_b16 a[144:145], v44 offset:0
    ds_read_b64_tr_b16 a[146:147], v45 offset:0
    v_mfma_f32_16x16x32_bf16 v[100:103], a[96:99], a[48:51], 0
    ds_read_b64_tr_b16 a[148:149], v44 offset:12288
    ds_read_b64_tr_b16 a[150:151], v45 offset:12288
    s_waitcnt lgkmcnt(14)
    v_mfma_f32_16x16x32_bf16 v[96:99], a[100:103], a[100:103], v[96:99]
    ds_read_b64_tr_b16 a[152:153], v44 offset:24576
    ds_read_b64_tr_b16 a[154:155], v45 offset:24576
    v_mfma_f32_16x16x32_bf16 v[100:103], a[100:103], a[52:55], v[100:103]
    ds_read_b64_tr_b16 a[156:157], v44 offset:36864
    ds_read_b64_tr_b16 a[158:159], v45 offset:36864
    s_waitcnt lgkmcnt(15)
    v_mfma_f32_16x16x32_bf16 v[96:99], a[104:107], a[104:107], v[96:99]
    ds_read_b64_tr_b16 a[160:161], v46 offset:0
    ds_read_b64_tr_b16 a[162:163], v47 offset:0
    v_mfma_f32_16x16x32_bf16 v[100:103], a[104:107], a[56:59], v[100:103]
    ds_read_b64_tr_b16 a[164:165], v46 offset:12288
    ds_read_b64_tr_b16 a[166:167], v47 offset:12288
    v_mfma_f32_16x16x32_bf16 v[96:99], a[108:111], a[108:111], v[96:99]
    buffer_load_dwordx4 v227, s[24:27], s58 offen offset:3072 nt lds
    ds_read_b64_tr_b16 a[168:169], v46 offset:24576
    ds_read_b64_tr_b16 a[170:171], v47 offset:24576
    v_mfma_f32_16x16x32_bf16 v[100:103], a[108:111], a[60:63], v[100:103]
    ds_read_b64_tr_b16 a[172:173], v46 offset:36864
    ds_read_b64_tr_b16 a[174:175], v47 offset:36864
    v_mfma_f32_16x16x32_bf16 v[96:99], a[112:115], a[112:115], v[96:99]
    ds_read_b64_tr_b16 a[176:177], v48 offset:0
    ds_read_b64_tr_b16 a[178:179], v49 offset:0
    v_mfma_f32_16x16x32_bf16 v[100:103], a[112:115], a[64:67], v[100:103]
    ds_read_b64_tr_b16 a[180:181], v48 offset:12288
    ds_read_b64_tr_b16 a[182:183], v49 offset:12288
    s_waitcnt lgkmcnt(15)
    v_mfma_f32_16x16x32_bf16 v[96:99], a[116:119], a[116:119], v[96:99]
    ds_read_b64_tr_b16 a[184:185], v48 offset:24576
    ds_read_b64_tr_b16 a[186:187], v49 offset:24576
    v_mfma_f32_16x16x32_bf16 v[100:103], a[116:119], a[68:71], v[100:103]
    ds_read_b64_tr_b16 a[188:189], v48 offset:36864
    ds_read_b64_tr_b16 a[190:191], v49 offset:36864
    v_mfma_f32_16x16x32_bf16 v[92:95], a[96:99], v[52:55], v[80:83]
    v_mfma_f32_16x16x32_bf16 v[92:95], a[100:103], v[52:55], v[92:95]
    v_mfma_f32_16x16x32_bf16 v[92:95], a[104:107], v[52:55], v[92:95]
    v_mfma_f32_16x16x32_bf16 v[92:95], a[108:111], v[52:55], v[92:95]
    s_nop 1
    v_fma_f32 v96, v100, 2.0, v96
    v_fma_f32 v97, v101, 2.0, v97
    v_mfma_f32_16x16x32_bf16 v[92:95], a[112:115], v[52:55], v[92:95]
    v_fma_f32 v98, v102, 2.0, v98
    v_fma_f32 v99, v103, 2.0, v99
    v_mfma_f32_16x16x32_bf16 v[92:95], a[116:119], v[52:55], v[92:95]
    v_cndmask_b32 v3, 0, v96, s[44:45]
    v_cndmask_b32 v3, v3, v97, s[46:47]
    v_mfma_f32_16x16x32_bf16 v[88:91], a[96:99], v[136:139], v[76:79]
    s_add_u32 m0, s41, 4096
    s_nop 0
    buffer_load_dwordx4 v228, s[24:27], s58 offen offset:0 nt lds
    v_cndmask_b32 v3, v3, v98, s[48:49]
    v_cndmask_b32 v3, v3, v99, s[50:51]
    v_mfma_f32_16x16x32_bf16 v[88:91], a[100:103], v[140:143], v[88:91]
    buffer_load_dwordx4 v229, s[24:27], s58 offen offset:1024 nt lds
    s_nop 0
    s_nop 0
    v_mfma_f32_16x16x32_bf16 v[88:91], a[104:107], v[144:147], v[88:91]
    v_mfma_f32_16x16x4_f32 v[120:123], v3, v60, v[56:59]
    v_mfma_f32_16x16x32_bf16 v[88:91], a[108:111], v[148:151], v[88:91]
    v_mfma_f32_16x16x32_bf16 v[88:91], a[112:115], v[152:155], v[88:91]
    v_mfma_f32_16x16x32_bf16 v[88:91], a[116:119], v[156:159], v[88:91]
    v_mfma_f32_16x16x32_bf16 v[112:115], a[120:123], a[120:123], v[84:87]
    v_mfma_f32_16x16x32_bf16 v[116:119], a[120:123], a[48:51], 0
    v_mfma_f32_16x16x32_bf16 v[112:115], a[124:127], a[124:127], v[112:115]
    v_mfma_f32_16x16x32_bf16 v[116:119], a[124:127], a[52:55], v[116:119]
    s_nop 2
    v_fma_f32 v128, -v92, v92, v120
    v_fma_f32 v129, -v93, v93, v121
    v_mfma_f32_16x16x32_bf16 v[112:115], a[128:131], a[128:131], v[112:115]
    s_add_u32 m0, s41, 6144
    s_add_u32 s58, s37, 147840
    buffer_load_dwordx4 v224, s[24:27], s58 offen offset:0 nt lds
    v_fma_f32 v130, -v94, v94, v122
    v_fma_f32 v131, -v95, v95, v123
    v_mfma_f32_16x16x32_bf16 v[116:119], a[128:131], a[56:59], v[116:119]
    v_max_f32 v128, v128, v56
    v_max_f32 v129, v129, v56
    v_mfma_f32_16x16x32_bf16 v[112:115], a[132:135], a[132:135], v[112:115]
    v_max_f32 v130, v130, v56
    v_max_f32 v131, v131, v56
    v_mfma_f32_16x16x32_bf16 v[116:119], a[132:135], a[60:63], v[116:119]
    v_rsq_f32 v128, v128
    v_mfma_f32_16x16x32_bf16 v[112:115], a[136:139], a[136:139], v[112:115]
    v_rsq_f32 v129, v129
    v_mfma_f32_16x16x32_bf16 v[116:119], a[136:139], a[64:67], v[116:119]
    v_rsq_f32 v130, v130
    v_mfma_f32_16x16x32_bf16 v[112:115], a[140:143], a[140:143], v[112:115]
    v_rsq_f32 v131, v131
    v_mfma_f32_16x16x32_bf16 v[116:119], a[140:143], a[68:71], v[116:119]
    v_fma_f32 v88, -v92, v61, v88
    v_fma_f32 v89, -v93, v61, v89
    v_mfma_f32_16x16x32_bf16 v[108:111], a[120:123], v[52:55], v[80:83]
    v_fma_f32 v90, -v94, v61, v90
    v_fma_f32 v91, -v95, v61, v91
    v_mfma_f32_16x16x32_bf16 v[108:111], a[124:127], v[52:55], v[108:111]
    v_fma_f32 v88, v88, v128, v62
    v_fma_f32 v89, v89, v129, v62
    v_mfma_f32_16x16x32_bf16 v[108:111], a[128:131], v[52:55], v[108:111]
    v_fma_f32 v90, v90, v130, v62
    v_fma_f32 v91, v91, v131, v62
    v_mfma_f32_16x16x32_bf16 v[108:111], a[132:135], v[52:55], v[108:111]
    v_max3_f32 v1, v88, v89, v90
    v_max_f32 v1, v1, v91
    v_mfma_f32_16x16x32_bf16 v[108:111], a[136:139], v[52:55], v[108:111]
    buffer_load_dwordx4 v[184:187], v65, s[72:75], s61 offen offset:2048 sc1
    v_cmp_lt_f32 vcc, s52, v1
    s_cbranch_vccnz L_site8
L_back8:
    v_mfma_f32_16x16x32_bf16 v[108:111], a[140:143], v[52:55], v[108:111]
    v_exp_f32 v96, v88
    v_mfma_f32_16x16x32_bf16 v[104:107], a[120:123], v[136:139], v[76:79]
    v_exp_f32 v97, v89
    v_mfma_f32_16x16x32_bf16 v[104:107], a[124:127], v[140:143], v[104:107]
    v_exp_f32 v98, v90
    v_mfma_f32_16x16x32_bf16 v[104:107], a[128:131], v[144:147], v[104:107]
    v_exp_f32 v99, v91
    v_mfma_f32_16x16x32_bf16 v[104:107], a[132:135], v[148:151], v[104:107]
    v_mul_f32 v88, v96, v128
    v_mul_f32 v89, v97, v129
    v_mfma_f32_16x16x32_bf16 v[104:107], a[136:139], v[152:155], v[104:107]
    v_mul_f32 v90, v98, v130
    v_mul_f32 v91, v99, v131
    v_mfma_f32_16x16x32_bf16 v[104:107], a[140:143], v[156:159], v[104:107]
    v_fma_f32 v112, v116, 2.0, v112
    v_fma_f32 v113, v117, 2.0, v113
    v_fma_f32 v114, v118, 2.0, v114
    v_fma_f32 v115, v119, 2.0, v115
    v_cndmask_b32 v4, 0, v112, s[44:45]
    v_cndmask_b32 v4, v4, v113, s[46:47]
    v_cndmask_b32 v4, v4, v114, s[48:49]
    v_cndmask_b32 v4, v4, v115, s[50:51]
    v_add_f32 v63, v63, v96
    v_fmac_f32 v64, v88, v92
    v_mfma_f32_16x16x4_f32 v[124:127], v4, v60, v[56:59]
    v_add_f32 v63, v63, v97
    v_fmac_f32 v64, v89, v93
    v_add_f32 v63, v63, v98
    v_fmac_f32 v64, v90, v94
    v_add_f32 v63, v63, v99
    v_fmac_f32 v64, v91, v95
    v_add_f32 v68, v68, v88
    v_add_f32 v69, v69, v89
    v_add_f32 v70, v70, v90
    v_add_f32 v71, v71, v91
    v_add_u32 v44, -49152, v44
    v_add_u32 v45, -49152, v45
    v_add_u32 v46, -49152, v46
    v_add_u32 v47, -49152, v47
    v_add_u32 v48, -49152, v48
    v_add_u32 v49, -49152, v49
    v_fma_f32 v132, -v108, v108, v124
    v_fma_f32 v133, -v109, v109, v125
    v_fma_f32 v134, -v110, v110, v126
    v_fma_f32 v135, -v111, v111, v127
    v_max_f32 v132, v132, v56
    v_max_f32 v133, v133, v56
    v_max_f32 v134, v134, v56
    v_max_f32 v135, v135, v56
    v_rsq_f32 v132, v132
    v_rsq_f32 v133, v133
    v_rsq_f32 v134, v134
    v_rsq_f32 v135, v135
    buffer_load_dwordx4 v225, s[24:27], s58 offen offset:1024 nt lds
    v_fma_f32 v104, -v108, v61, v104
    v_fma_f32 v105, -v109, v61, v105
    v_fma_f32 v106, -v110, v61, v106
    v_fma_f32 v107, -v111, v61, v107
    v_fma_f32 v104, v104, v132, v62
    v_fma_f32 v105, v105, v133, v62
    v_fma_f32 v106, v106, v134, v62
    v_fma_f32 v107, v107, v135, v62
    v_max3_f32 v1, v104, v105, v106
    v_max_f32 v1, v1, v107
    v_cmp_lt_f32 vcc, s52, v1
    s_cbranch_vccnz L_site9
L_back9:
    buffer_load_dwordx4 v226, s[24:27], s58 offen offset:2048 nt lds
    v_exp_f32 v112, v104
    v_exp_f32 v113, v105
    v_exp_f32 v114, v106
    v_exp_f32 v115, v107
    v_cvt_pk_bf16_f32 v72, v88, v89
    v_cvt_pk_bf16_f32 v73, v90, v91
    v_mul_f32 v104, v112, v132
    v_mul_f32 v105, v113, v133
    v_mul_f32 v106, v114, v134
    v_mul_f32 v107, v115, v135
    v_cvt_pk_bf16_f32 v74, v104, v105
    v_cvt_pk_bf16_f32 v75, v106, v107
    ds_write_b128 v237, v[72:75] offset:0
    v_add_f32 v68, v68, v104
    v_add_f32 v69, v69, v105
    v_add_f32 v70, v70, v106
    v_add_f32 v71, v71, v107
    v_cvt_pk_bf16_f32 v66, v68, v69
    v_cvt_pk_bf16_f32 v67, v70, v71
    ds_write_b64 v238, v[66:67]
    s_lshl_b32 s56, s3, 13
    v_lshl_add_u32 v233, v0, 7, s56
    v_min_u32 v233, L_end - L_tail, v233
    v_add_u32 v233, L_tail - L_pc_main, v233
    global_load_dword v234, v233, s[100:101]
    s_waitcnt vmcnt(12)
    s_waitcnt lgkmcnt(0)
    s_barrier
L_post9:
    ds_read_b32 v9, v254 offset:4096
    ds_read_b64 v[120:121], v254 offset:0
    ds_read_b64 v[122:123], v254 offset:512
    ds_read_b64 v[124:125], v254 offset:1024
    ds_read_b64 v[126:127], v254 offset:1536
    ds_read_b128 v[92:95], v253 offset:0
    ds_read_b128 v[96:99], v253 offset:1024
    ds_read_b128 v[100:103], v253 offset:2048
    ds_read_b128 v[116:119], v253 offset:3072
    ds_read_b128 a[48:51], v34 offset:0
    ds_read_b128 a[52:55], v35 offset:0
    ds_read_b128 a[56:59], v34 offset:128
    ds_read_b128 a[60:63], v35 offset:128
    ds_read_b128 a[64:67], v34 offset:256
    ds_read_b128 a[68:71], v35 offset:256
    s_waitcnt lgkmcnt(14)
    v_cmp_ne_u32 vcc, 0, v9
    s_cbranch_vccnz L_xt9
    s_waitcnt lgkmcnt(12)
    v_mfma_f32_16x16x32_bf16 a[0:3], a[72:75], v[120:123], a[0:3]
    buffer_load_dwordx4 v227, s[24:27], s58 offen offset:3072 nt lds
    v_add_f32 v63, v63, v112
    v_fma_f32 v64, v104, v108, v64
    v_mfma_f32_16x16x32_bf16 a[4:7], a[80:83], v[120:123], a[4:7]
    v_add_f32 v63, v63, v113
    v_fma_f32 v64, v105, v109, v64
    v_mfma_f32_16x16x32_bf16 a[8:11], a[88:91], v[120:123], a[8:11]
    v_add_f32 v63, v63, v114
    v_fma_f32 v64, v106, v110, v64
    s_waitcnt lgkmcnt(10)
    v_mfma_f32_16x16x32_bf16 a[0:3], a[76:79], v[124:127], a[0:3]
    v_add_f32 v63, v63, v115
    v_fma_f32 v64, v107, v111, v64
    v_mfma_f32_16x16x32_bf16 a[4:7], a[84:87], v[124:127], a[4:7]
    v_mfma_f32_16x16x32_bf16 a[8:11], a[92:95], v[124:127], a[8:11]
    s_waitcnt lgkmcnt(9)
    v_mfma_f32_16x16x32_bf16 a[0:3], a[144:147], v[92:95], a[0:3]
    ds_read_b64_tr_b16 a[72:73], v36 offset:0
    ds_read_b64_tr_b16 a[74:75], v36 offset:6144
    v_mfma_f32_16x16x32_bf16 a[4:7], a[160:163], v[92:95], a[4:7]
    ds_read_b64_tr_b16 a[76:77], v36 offset:12288
    ds_read_b64_tr_b16 a[78:79], v36 offset:18432
    v_mfma_f32_16x16x32_bf16 a[8:11], a[176:179], v[92:95], a[8:11]
    s_add_u32 m0, s41, 10240
    s_nop 0
    buffer_load_dwordx4 v228, s[24:27], s58 offen offset:0 nt lds
    ds_read_b64_tr_b16 a[80:81], v37 offset:0
    ds_read_b64_tr_b16 a[82:83], v37 offset:6144
    s_waitcnt lgkmcnt(14)
    v_mfma_f32_16x16x32_bf16 a[0:3], a[148:151], v[96:99], a[0:3]
    ds_read_b64_tr_b16 a[84:85], v37 offset:12288
    ds_read_b64_tr_b16 a[86:87], v37 offset:18432
    v_mfma_f32_16x16x32_bf16 a[4:7], a[164:167], v[96:99], a[4:7]
    ds_read_b64_tr_b16 a[88:89], v38 offset:0
    ds_read_b64_tr_b16 a[90:91], v38 offset:6144
    v_mfma_f32_16x16x32_bf16 a[8:11], a[180:183], v[96:99], a[8:11]
    ds_read_b64_tr_b16 a[92:93], v38 offset:12288
    ds_read_b64_tr_b16 a[94:95], v38 offset:18432
    s_waitcnt lgkmcnt(15)
    v_mfma_f32_16x16x32_bf16 a[0:3], a[152:155], v[100:103], a[0:3]
    v_mfma_f32_16x16x32_bf16 a[4:7], a[168:171], v[100:103], a[4:7]
    v_mfma_f32_16x16x32_bf16 a[8:11], a[184:187], v[100:103], a[8:11]
    v_mfma_f32_16x16x32_bf16 a[0:3], a[156:159], v[116:119], a[0:3]
    v_mfma_f32_16x16x32_bf16 a[4:7], a[172:175], v[116:119], a[4:7]
    v_mfma_f32_16x16x32_bf16 a[8:11], a[188:191], v[116:119], a[8:11]
    v_mfma_f32_16x16x32_bf16 v[84:87], a[48:51], a[48:51], 0
    v_mfma_f32_16x16x32_bf16 v[80:83], a[48:51], v[52:55], 0
    v_mfma_f32_16x16x32_bf16 v[84:87], a[52:55], a[52:55], v[84:87]
    buffer_load_dwordx4 v[188:191], v65, s[72:75], s61 offen offset:3072 sc1
    v_mfma_f32_16x16x32_bf16 v[80:83], a[52:55], v[52:55], v[80:83]
    buffer_load_dwordx4 v229, s[24:27], s58 offen offset:1024 nt lds
    v_mfma_f32_16x16x32_bf16 v[84:87], a[56:59], a[56:59], v[84:87]
    v_mfma_f32_16x16x32_bf16 v[80:83], a[56:59], v[52:55], v[80:83]
    s_waitcnt lgkmcnt(14)
    v_mfma_f32_16x16x32_bf16 v[84:87], a[60:63], a[60:63], v[84:87]
    v_mfma_f32_16x16x32_bf16 v[80:83], a[60:63], v[52:55], v[80:83]
    s_waitcnt lgkmcnt(13)
    v_mfma_f32_16x16x32_bf16 v[84:87], a[64:67], a[64:67], v[84:87]
    v_mfma_f32_16x16x32_bf16 v[80:83], a[64:67], v[52:55], v[80:83]
    s_waitcnt lgkmcnt(12)
    v_mfma_f32_16x16x32_bf16 v[84:87], a[68:71], a[68:71], v[84:87]
    v_mfma_f32_16x16x32_bf16 v[80:83], a[68:71], v[52:55], v[80:83]
    s_waitcnt lgkmcnt(0)
    v_mfma_f32_16x16x32_bf16 v[76:79], a[48:51], v[136:139], 0
    v_mfma_f32_16x16x32_bf16 v[76:79], a[52:55], v[140:143], v[76:79]
    v_mfma_f32_16x16x32_bf16 v[76:79], a[56:59], v[144:147], v[76:79]
    v_mfma_f32_16x16x32_bf16 v[76:79], a[60:63], v[148:151], v[76:79]
    s_add_u32 m0, s42, 0
    s_add_u32 s59, s37, 344064
    buffer_load_dwordx4 v224, s[24:27], s59 offen offset:0 nt lds
    v_mfma_f32_16x16x32_bf16 v[76:79], a[64:67], v[152:155], v[76:79]
    v_mfma_f32_16x16x32_bf16 v[76:79], a[68:71], v[156:159], v[76:79]
    s_mul_i32 s28, s3, 148480
    s_and_b32 s56, s2, 7
    s_lshl_b32 s56, s56, 10
    s_add_u32 s28, s28, s56
    s_bfe_u32 s56, s2, 0x30003
    s_lshl_b32 s56, s56, 7
    s_add_u32 s28, s28, s56
    s_lshr_b32 s56, s2, 6
    s_lshl_b32 s56, s56, 13
    s_add_u32 s28, s28, s56
    s_add_u32 s28, s28, 65536
    s_sub_u32 s29, s2, 64
    s_mul_i32 s30, s29, 37120
    s_lshl_b32 s56, s3, 13
    s_add_u32 s30, s30, s56
    s_add_u32 s30, s30, 65536
    s_add_u32 s31, s30, 4096
    v_mov_b32 v232, 0x53800000
    s_mov_b32 s43, 1
    s_mov_b32 s68, s18
    s_mov_b32 s69, s19
    s_mov_b32 s70, 6144
    s_mov_b32 s71, 0x20000
L_tail:
    s_sub_u32 s56, s41, s40
    v_add_u32 v40, s56, v34
    v_add_u32 v41, s56, v35
    v_add_u32 v44, 24576, v36
    v_add_u32 v45, 24576, v37
    v_add_u32 v46, 24576, v38
    s_sub_u32 s56, s42, s40
    v_add_u32 v42, s56, v34
    v_add_u32 v43, s56, v35
    v_add_u32 v47, 73728, v36
    v_add_u32 v48, 73728, v37
    v_add_u32 v49, 73728, v38
    v_accvgpr_read_b32 v16, a0
    v_accvgpr_read_b32 v17, a1
    v_accvgpr_read_b32 v18, a2
    v_accvgpr_read_b32 v19, a3
    v_accvgpr_read_b32 v20, a4
    v_accvgpr_read_b32 v21, a5
    v_accvgpr_read_b32 v22, a6
    v_accvgpr_read_b32 v23, a7
    v_accvgpr_read_b32 v24, a8
    v_accvgpr_read_b32 v25, a9
    v_accvgpr_read_b32 v26, a10
    v_accvgpr_read_b32 v27, a11
    buffer_load_dwordx4 v225, s[24:27], s59 offen offset:1024 nt lds
    buffer_load_dwordx4 v226, s[24:27], s59 offen offset:2048 nt lds
    s_waitcnt vmcnt(12)
    s_barrier
    ds_read_b128 a[96:99], v40 offset:0
    ds_read_b128 a[100:103], v41 offset:0
    ds_read_b128 a[104:107], v40 offset:128
    ds_read_b128 a[108:111], v41 offset:128
    ds_read_b128 a[112:115], v40 offset:256
    ds_read_b128 a[116:119], v41 offset:256
    s_waitcnt lgkmcnt(5)
    v_mfma_f32_16x16x32_bf16 v[96:99], a[96:99], a[96:99], v[84:87]
    ds_read_b64_tr_b16 a[144:145], v44 offset:0
    ds_read_b64_tr_b16 a[148:149], v44 offset:12288
    v_mfma_f32_16x16x32_bf16 v[100:103], a[96:99], a[48:51], 0
    ds_read_b64_tr_b16 a[152:153], v44 offset:24576
    ds_read_b64_tr_b16 a[156:157], v44 offset:36864
    s_waitcnt lgkmcnt(8)
    v_mfma_f32_16x16x32_bf16 v[96:99], a[100:103], a[100:103], v[96:99]
    ds_read_b64_tr_b16 a[160:161], v45 offset:0
    ds_read_b64_tr_b16 a[164:165], v45 offset:12288
    v_mfma_f32_16x16x32_bf16 v[100:103], a[100:103], a[52:55], v[100:103]
    ds_read_b64_tr_b16 a[168:169], v45 offset:24576
    ds_read_b64_tr_b16 a[172:173], v45 offset:36864
    s_waitcnt lgkmcnt(11)
    v_mfma_f32_16x16x32_bf16 v[96:99], a[104:107], a[104:107], v[96:99]
    ds_read_b64_tr_b16 a[176:177], v46 offset:0
    ds_read_b64_tr_b16 a[180:181], v46 offset:12288
    v_mfma_f32_16x16x32_bf16 v[100:103], a[104:107], a[56:59], v[100:103]
    ds_read_b64_tr_b16 a[184:185], v46 offset:24576
    ds_read_b64_tr_b16 a[188:189], v46 offset:36864
    s_waitcnt lgkmcnt(14)
    v_mfma_f32_16x16x32_bf16 v[96:99], a[108:111], a[108:111], v[96:99]
    buffer_load_dwordx4 v227, s[24:27], s59 offen offset:3072 nt lds
    v_mfma_f32_16x16x32_bf16 v[100:103], a[108:111], a[60:63], v[100:103]
    s_add_u32 m0, s42, 4096
    s_nop 0
    buffer_load_dwordx4 v228, s[24:27], s59 offen offset:0 nt lds
    s_waitcnt lgkmcnt(13)
    v_mfma_f32_16x16x32_bf16 v[96:99], a[112:115], a[112:115], v[96:99]
    v_mfma_f32_16x16x32_bf16 v[100:103], a[112:115], a[64:67], v[100:103]
    s_waitcnt lgkmcnt(12)
    v_mfma_f32_16x16x32_bf16 v[96:99], a[116:119], a[116:119], v[96:99]
    v_mfma_f32_16x16x32_bf16 v[100:103], a[116:119], a[68:71], v[100:103]
    v_mfma_f32_16x16x32_bf16 v[92:95], a[96:99], v[52:55], v[80:83]
    v_mfma_f32_16x16x32_bf16 v[92:95], a[100:103], v[52:55], v[92:95]
    v_mfma_f32_16x16x32_bf16 v[92:95], a[104:107], v[52:55], v[92:95]
    v_mfma_f32_16x16x32_bf16 v[92:95], a[108:111], v[52:55], v[92:95]
    s_nop 3
    v_fma_f32 v96, v100, 2.0, v96
    v_fma_f32 v97, v101, 2.0, v97
    v_mfma_f32_16x16x32_bf16 v[92:95], a[112:115], v[52:55], v[92:95]
    v_fma_f32 v98, v102, 2.0, v98
    v_fma_f32 v99, v103, 2.0, v99
    v_mfma_f32_16x16x32_bf16 v[92:95], a[116:119], v[52:55], v[92:95]
    v_cndmask_b32 v3, 0, v96, s[44:45]
    v_cndmask_b32 v3, v3, v97, s[46:47]
    v_mfma_f32_16x16x32_bf16 v[88:91], a[96:99], v[136:139], v[76:79]
    v_cndmask_b32 v3, v3, v98, s[48:49]
    v_cndmask_b32 v3, v3, v99, s[50:51]
    v_mfma_f32_16x16x32_bf16 v[88:91], a[100:103], v[140:143], v[88:91]
    buffer_load_dwordx4 v229, s[24:27], s59 offen offset:1024 nt lds
    s_nop 0
    s_nop 0
    v_mfma_f32_16x16x32_bf16 v[88:91], a[104:107], v[144:147], v[88:91]
    v_mfma_f32_16x16x4_f32 v[120:123], v3, v60, v[56:59]
    v_mfma_f32_16x16x32_bf16 v[88:91], a[108:111], v[148:151], v[88:91]
    v_mfma_f32_16x16x32_bf16 v[88:91], a[112:115], v[152:155], v[88:91]
    v_mfma_f32_16x16x32_bf16 v[88:91], a[116:119], v[156:159], v[88:91]
    s_nop 6
    v_fma_f32 v128, -v92, v92, v120
    v_fma_f32 v129, -v93, v93, v121
    v_fma_f32 v130, -v94, v94, v122
    v_fma_f32 v131, -v95, v95, v123
    v_max_f32 v128, v128, v56
    v_max_f32 v129, v129, v56
    v_max_f32 v130, v130, v56
    v_max_f32 v131, v131, v56
    v_rsq_f32 v128, v128
    v_rsq_f32 v129, v129
    v_rsq_f32 v130, v130
    v_rsq_f32 v131, v131
    v_fma_f32 v88, -v92, v61, v88
    v_fma_f32 v89, -v93, v61, v89
    v_fma_f32 v90, -v94, v61, v90
    v_fma_f32 v91, -v95, v61, v91
    v_fma_f32 v88, v88, v128, v62
    v_fma_f32 v89, v89, v129, v62
    v_fma_f32 v90, v90, v130, v62
    v_fma_f32 v91, v91, v131, v62
    v_max3_f32 v1, v88, v89, v90
    v_max_f32 v1, v1, v91
    v_cmp_lt_f32 vcc, s52, v1
    s_cbranch_vccnz L_site10
L_back10:
    v_exp_f32 v96, v88
    s_add_u32 m0, s42, 6144
    s_add_u32 s59, s37, 344448
    buffer_load_dwordx4 v224, s[24:27], s59 offen offset:0 nt lds
    v_exp_f32 v97, v89
    v_exp_f32 v98, v90
    v_exp_f32 v99, v91
    v_mul_f32 v88, v96, v128
    v_mul_f32 v89, v97, v129
    v_mul_f32 v90, v98, v130
    buffer_load_dwordx4 v225, s[24:27], s59 offen offset:1024 nt lds
    v_mul_f32 v91, v99, v131
    v_add_f32 v63, v63, v96
    v_fmac_f32 v64, v88, v92
    v_add_f32 v63, v63, v97
    v_fmac_f32 v64, v89, v93
    v_add_f32 v63, v63, v98
    v_fmac_f32 v64, v90, v94
    v_add_f32 v63, v63, v99
    v_fmac_f32 v64, v91, v95
    v_mov_b32 v68, v88
    v_mov_b32 v69, v89
    v_mov_b32 v70, v90
    v_mov_b32 v71, v91
    buffer_load_dwordx4 v226, s[24:27], s59 offen offset:2048 nt lds
    buffer_load_dwordx4 v227, s[24:27], s59 offen offset:3072 nt lds
    s_add_u32 m0, s42, 10240
    s_nop 0
    buffer_load_dwordx4 v228, s[24:27], s59 offen offset:0 nt lds
    buffer_load_dwordx4 v229, s[24:27], s59 offen offset:1024 nt lds
    s_waitcnt vmcnt(12)
    s_waitcnt lgkmcnt(0)
    s_barrier
    ds_read_b128 a[120:123], v40 offset:6144
    ds_read_b128 a[124:127], v41 offset:6144
    ds_read_b128 a[128:131], v40 offset:6272
    ds_read_b128 a[132:135], v41 offset:6272
    ds_read_b128 a[136:139], v40 offset:6400
    ds_read_b128 a[140:143], v41 offset:6400
    s_waitcnt lgkmcnt(5)
    v_mfma_f32_16x16x32_bf16 v[112:115], a[120:123], a[120:123], v[84:87]
    ds_read_b64_tr_b16 a[146:147], v44 offset:6144
    ds_read_b64_tr_b16 a[150:151], v44 offset:18432
    v_mfma_f32_16x16x32_bf16 v[116:119], a[120:123], a[48:51], 0
    ds_read_b64_tr_b16 a[154:155], v44 offset:30720
    ds_read_b64_tr_b16 a[158:159], v44 offset:43008
    s_waitcnt lgkmcnt(8)
    v_mfma_f32_16x16x32_bf16 v[112:115], a[124:127], a[124:127], v[112:115]
    ds_read_b64_tr_b16 a[162:163], v45 offset:6144
    ds_read_b64_tr_b16 a[166:167], v45 offset:18432
    v_mfma_f32_16x16x32_bf16 v[116:119], a[124:127], a[52:55], v[116:119]
    ds_read_b64_tr_b16 a[170:171], v45 offset:30720
    ds_read_b64_tr_b16 a[174:175], v45 offset:43008
    s_waitcnt lgkmcnt(11)
    v_mfma_f32_16x16x32_bf16 v[112:115], a[128:131], a[128:131], v[112:115]
    ds_read_b64_tr_b16 a[178:179], v46 offset:6144
    ds_read_b64_tr_b16 a[182:183], v46 offset:18432
    v_mfma_f32_16x16x32_bf16 v[116:119], a[128:131], a[56:59], v[116:119]
    ds_read_b64_tr_b16 a[186:187], v46 offset:30720
    ds_read_b64_tr_b16 a[190:191], v46 offset:43008
    s_waitcnt lgkmcnt(14)
    v_mfma_f32_16x16x32_bf16 v[112:115], a[132:135], a[132:135], v[112:115]
    v_mfma_f32_16x16x32_bf16 v[116:119], a[132:135], a[60:63], v[116:119]
    s_add_u32 s61, s60, 3153920
    buffer_load_dwordx4 v[192:195], v65, s[32:35], s61 offen offset:0 sc1
    s_waitcnt lgkmcnt(13)
    v_mfma_f32_16x16x32_bf16 v[112:115], a[136:139], a[136:139], v[112:115]
    v_mfma_f32_16x16x32_bf16 v[116:119], a[136:139], a[64:67], v[116:119]
    s_waitcnt lgkmcnt(12)
    v_mfma_f32_16x16x32_bf16 v[112:115], a[140:143], a[140:143], v[112:115]
    v_mfma_f32_16x16x32_bf16 v[116:119], a[140:143], a[68:71], v[116:119]
    v_mfma_f32_16x16x32_bf16 v[108:111], a[120:123], v[52:55], v[80:83]
    v_mfma_f32_16x16x32_bf16 v[108:111], a[124:127], v[52:55], v[108:111]
    v_mfma_f32_16x16x32_bf16 v[108:111], a[128:131], v[52:55], v[108:111]
    s_nop 4
    v_fma_f32 v112, v116, 2.0, v112
    v_fma_f32 v113, v117, 2.0, v113
    v_mfma_f32_16x16x32_bf16 v[108:111], a[132:135], v[52:55], v[108:111]
    v_fma_f32 v114, v118, 2.0, v114
    v_fma_f32 v115, v119, 2.0, v115
    v_mfma_f32_16x16x32_bf16 v[108:111], a[136:139], v[52:55], v[108:111]
    v_cndmask_b32 v4, 0, v112, s[44:45]
    v_cndmask_b32 v4, v4, v113, s[46:47]
    v_mfma_f32_16x16x32_bf16 v[108:111], a[140:143], v[52:55], v[108:111]
    v_cndmask_b32 v4, v4, v114, s[48:49]
    v_cndmask_b32 v4, v4, v115, s[50:51]
    v_mfma_f32_16x16x32_bf16 v[104:107], a[120:123], v[136:139], v[76:79]
    s_nop 0
    v_mfma_f32_16x16x4_f32 v[124:127], v4, v60, v[56:59]
    v_mfma_f32_16x16x32_bf16 v[104:107], a[124:127], v[140:143], v[104:107]
    buffer_load_dwordx4 v[196:199], v65, s[32:35], s61 offen offset:1024 sc1
    s_nop 0
    v_mfma_f32_16x16x32_bf16 v[104:107], a[128:131], v[144:147], v[104:107]
    s_nop 0
    s_nop 0
    v_mfma_f32_16x16x32_bf16 v[104:107], a[132:135], v[148:151], v[104:107]
    s_nop 0
    s_nop 0
    v_mfma_f32_16x16x32_bf16 v[104:107], a[136:139], v[152:155], v[104:107]
    v_fma_f32 v132, -v108, v108, v124
    v_fma_f32 v133, -v109, v109, v125
    v_mfma_f32_16x16x32_bf16 v[104:107], a[140:143], v[156:159], v[104:107]
    v_fma_f32 v134, -v110, v110, v126
    v_fma_f32 v135, -v111, v111, v127
    v_max_f32 v132, v132, v56
    v_max_f32 v133, v133, v56
    v_max_f32 v134, v134, v56
    v_max_f32 v135, v135, v56
    v_rsq_f32 v132, v132
    v_rsq_f32 v133, v133
    v_rsq_f32 v134, v134
    v_rsq_f32 v135, v135
    v_fma_f32 v104, -v108, v61, v104
    v_fma_f32 v105, -v109, v61, v105
    v_fma_f32 v106, -v110, v61, v106
    v_fma_f32 v107, -v111, v61, v107
    v_fma_f32 v104, v104, v132, v62
    v_fma_f32 v105, v105, v133, v62
    v_fma_f32 v106, v106, v134, v62
    v_fma_f32 v107, v107, v135, v62
    v_max3_f32 v1, v104, v105, v106
    v_max_f32 v1, v1, v107
    v_cmp_lt_f32 vcc, s52, v1
    s_cbranch_vccnz L_site11
L_back11:
    v_exp_f32 v112, v104
    v_exp_f32 v113, v105
    v_exp_f32 v114, v106
    v_exp_f32 v115, v107
    v_cvt_pk_bf16_f32 v72, v88, v89
    v_cvt_pk_bf16_f32 v73, v90, v91
    v_mul_f32 v104, v112, v132
    v_mul_f32 v105, v113, v133
    v_mul_f32 v106, v114, v134
    v_mul_f32 v107, v115, v135
    v_cvt_pk_bf16_f32 v74, v104, v105
    v_cvt_pk_bf16_f32 v75, v106, v107
    ds_write_b128 v237, v[72:75] offset:12288
    buffer_load_dwordx4 v[200:203], v65, s[32:35], s61 offen offset:2048 sc1
    buffer_load_dwordx4 v[204:207], v65, s[32:35], s61 offen offset:3072 sc1
    s_add_u32 s61, s60, 3158016
    buffer_load_dwordx4 v[208:211], v65, s[32:35], s61 offen offset:0 sc1
    buffer_load_dwordx4 v[212:215], v65, s[32:35], s61 offen offset:1024 sc1
    s_waitcnt vmcnt(12)
    s_waitcnt lgkmcnt(0)
    s_barrier
L_post11:
    ds_read_b32 v9, v254 offset:4100
    ds_read_b128 a[96:99], v42 offset:0
    ds_read_b128 a[100:103], v43 offset:0
    ds_read_b128 a[104:107], v42 offset:128
    ds_read_b128 a[108:111], v43 offset:128
    ds_read_b128 a[112:115], v42 offset:256
    ds_read_b128 a[116:119], v43 offset:256
    s_waitcnt lgkmcnt(6)
    v_cmp_ne_u32 vcc, 0, v9
    s_cbranch_vccnz L_xt11
    v_add_f32 v68, v68, v104
    v_add_f32 v69, v69, v105
    v_add_f32 v70, v70, v106
    v_add_f32 v71, v71, v107
    v_add_f32 v63, v63, v112
    v_fma_f32 v64, v104, v108, v64
    v_add_f32 v63, v63, v113
    v_fma_f32 v64, v105, v109, v64
    s_waitcnt lgkmcnt(5)
    v_mfma_f32_16x16x32_bf16 v[96:99], a[96:99], a[96:99], v[84:87]
    v_add_f32 v63, v63, v114
    v_fma_f32 v64, v106, v110, v64
    v_mfma_f32_16x16x32_bf16 v[100:103], a[96:99], a[48:51], 0
    v_add_f32 v63, v63, v115
    v_fma_f32 v64, v107, v111, v64
    s_waitcnt lgkmcnt(4)
    v_mfma_f32_16x16x32_bf16 v[96:99], a[100:103], a[100:103], v[96:99]
    ds_read_b64_tr_b16 a[0:1], v47 offset:0
    v_mfma_f32_16x16x32_bf16 v[100:103], a[100:103], a[52:55], v[100:103]
    ds_read_b64_tr_b16 a[4:5], v47 offset:12288
    s_waitcnt lgkmcnt(5)
    v_mfma_f32_16x16x32_bf16 v[96:99], a[104:107], a[104:107], v[96:99]
    ds_read_b64_tr_b16 a[8:9], v47 offset:24576
    v_mfma_f32_16x16x32_bf16 v[100:103], a[104:107], a[56:59], v[100:103]
    ds_read_b64_tr_b16 a[12:13], v47 offset:36864
    s_waitcnt lgkmcnt(6)
    v_mfma_f32_16x16x32_bf16 v[96:99], a[108:111], a[108:111], v[96:99]
    ds_read_b64_tr_b16 a[16:17], v48 offset:0
    v_mfma_f32_16x16x32_bf16 v[100:103], a[108:111], a[60:63], v[100:103]
    ds_read_b64_tr_b16 a[20:21], v48 offset:12288
    s_waitcnt lgkmcnt(7)
    v_mfma_f32_16x16x32_bf16 v[96:99], a[112:115], a[112:115], v[96:99]
    ds_read_b64_tr_b16 a[24:25], v48 offset:24576
    v_mfma_f32_16x16x32_bf16 v[100:103], a[112:115], a[64:67], v[100:103]
    ds_read_b64_tr_b16 a[28:29], v48 offset:36864
    s_waitcnt lgkmcnt(8)
    v_mfma_f32_16x16x32_bf16 v[96:99], a[116:119], a[116:119], v[96:99]
    ds_read_b64_tr_b16 a[32:33], v49 offset:0
    v_mfma_f32_16x16x32_bf16 v[100:103], a[116:119], a[68:71], v[100:103]
    ds_read_b64_tr_b16 a[36:37], v49 offset:12288
    v_mfma_f32_16x16x32_bf16 v[92:95], a[96:99], v[52:55], v[80:83]
    ds_read_b64_tr_b16 a[40:41], v49 offset:24576
    ds_read_b64_tr_b16 a[44:45], v49 offset:36864
    v_mfma_f32_16x16x32_bf16 v[92:95], a[100:103], v[52:55], v[92:95]
    ds_read_b128 a[192:195], v253 offset:12288
    ds_read_b128 a[196:199], v253 offset:13312
    v_mfma_f32_16x16x32_bf16 v[92:95], a[104:107], v[52:55], v[92:95]
    v_fma_f32 v96, v100, 2.0, v96
    v_fma_f32 v97, v101, 2.0, v97
    v_mfma_f32_16x16x32_bf16 v[92:95], a[108:111], v[52:55], v[92:95]
    v_fma_f32 v98, v102, 2.0, v98
    v_fma_f32 v99, v103, 2.0, v99
    v_mfma_f32_16x16x32_bf16 v[92:95], a[112:115], v[52:55], v[92:95]
    v_cndmask_b32 v3, 0, v96, s[44:45]
    v_cndmask_b32 v3, v3, v97, s[46:47]
    v_mfma_f32_16x16x32_bf16 v[92:95], a[116:119], v[52:55], v[92:95]
    v_cndmask_b32 v3, v3, v98, s[48:49]
    v_cndmask_b32 v3, v3, v99, s[50:51]
    v_mfma_f32_16x16x32_bf16 v[88:91], a[96:99], v[136:139], v[76:79]
    ds_read_b128 a[200:203], v253 offset:14336
    ds_read_b128 a[204:207], v253 offset:15360
    v_mfma_f32_16x16x32_bf16 v[88:91], a[100:103], v[140:143], v[88:91]
    v_mfma_f32_16x16x4_f32 v[120:123], v3, v60, v[56:59]
    v_mfma_f32_16x16x32_bf16 v[88:91], a[104:107], v[144:147], v[88:91]
    buffer_load_dwordx4 v[216:219], v65, s[32:35], s61 offen offset:2048 sc1
    v_mfma_f32_16x16x32_bf16 v[88:91], a[108:111], v[148:151], v[88:91]
    buffer_load_dwordx4 v[220:223], v65, s[32:35], s61 offen offset:3072 sc1
    v_mfma_f32_16x16x32_bf16 v[88:91], a[112:115], v[152:155], v[88:91]
    v_mfma_f32_16x16x32_bf16 v[88:91], a[116:119], v[156:159], v[88:91]
    s_waitcnt lgkmcnt(3)
    v_mfma_f32_16x16x32_bf16 v[16:19], a[144:147], a[192:195], v[16:19]
    v_mfma_f32_16x16x32_bf16 v[20:23], a[160:163], a[192:195], v[20:23]
    s_nop 0
    v_fma_f32 v128, -v92, v92, v120
    v_fma_f32 v129, -v93, v93, v121
    v_fma_f32 v130, -v94, v94, v122
    v_mfma_f32_16x16x32_bf16 v[24:27], a[176:179], a[192:195], v[24:27]
    v_fma_f32 v131, -v95, v95, v123
    v_max_f32 v128, v128, v56
    v_max_f32 v129, v129, v56
    s_waitcnt lgkmcnt(2)
    v_mfma_f32_16x16x32_bf16 v[16:19], a[148:151], a[196:199], v[16:19]
    v_max_f32 v130, v130, v56
    v_max_f32 v131, v131, v56
    v_mfma_f32_16x16x32_bf16 v[20:23], a[164:167], a[196:199], v[20:23]
    v_rsq_f32 v128, v128
    v_mfma_f32_16x16x32_bf16 v[24:27], a[180:183], a[196:199], v[24:27]
    v_rsq_f32 v129, v129
    s_waitcnt lgkmcnt(1)
    v_mfma_f32_16x16x32_bf16 v[16:19], a[152:155], a[200:203], v[16:19]
    v_rsq_f32 v130, v130
    v_mfma_f32_16x16x32_bf16 v[20:23], a[168:171], a[200:203], v[20:23]
    v_rsq_f32 v131, v131
    v_fma_f32 v88, -v92, v61, v88
    s_add_u32 s61, s60, 3162112
    buffer_load_dwordx4 v[224:227], v65, s[32:35], s61 offen offset:0 sc1
    buffer_load_dwordx4 v[228:231], v65, s[32:35], s61 offen offset:1024 sc1
    s_waitcnt vmcnt(10)
    ds_read_b128 a[120:123], v42 offset:6144
    ds_read_b128 a[124:127], v43 offset:6144
    ds_read_b128 a[128:131], v42 offset:6272
    ds_read_b128 a[132:135], v43 offset:6272
    ds_read_b128 a[136:139], v42 offset:6400
    ds_read_b128 a[140:143], v43 offset:6400
    s_cmp_eq_u32 s0, 1
    s_cbranch_scc0 L_nolate
    s_add_u32 s56, s60, 3145728
    buffer_load_dwordx4 v[160:163], v65, s[32:35], s56 offen offset:0 sc1
    buffer_load_dwordx4 v[164:167], v65, s[32:35], s56 offen offset:1024 sc1
    buffer_load_dwordx4 v[168:171], v65, s[32:35], s56 offen offset:2048 sc1
    buffer_load_dwordx4 v[172:175], v65, s[32:35], s56 offen offset:3072 sc1
    s_add_u32 s56, s60, 3149824
    buffer_load_dwordx4 v[176:179], v65, s[32:35], s56 offen offset:0 sc1
    buffer_load_dwordx4 v[180:183], v65, s[32:35], s56 offen offset:1024 sc1
    buffer_load_dwordx4 v[184:187], v65, s[32:35], s56 offen offset:2048 sc1
    buffer_load_dwordx4 v[188:191], v65, s[32:35], s56 offen offset:3072 sc1
L_nolate:
    buffer_load_dword v244, v242, s[32:35], s28 offen
    v_mfma_f32_16x16x32_bf16 v[24:27], a[184:187], a[200:203], v[24:27]
    v_fma_f32 v89, -v93, v61, v89
    v_fma_f32 v90, -v94, v61, v90
    v_fma_f32 v91, -v95, v61, v91
    s_waitcnt lgkmcnt(6)
    v_mfma_f32_16x16x32_bf16 v[16:19], a[156:159], a[204:207], v[16:19]
    v_fma_f32 v88, v88, v128, v62
    v_fma_f32 v89, v89, v129, v62
    v_fma_f32 v90, v90, v130, v62
    v_mfma_f32_16x16x32_bf16 v[20:23], a[172:175], a[204:207], v[20:23]
    v_fma_f32 v91, v91, v131, v62
    v_max3_f32 v1, v88, v89, v90
    v_max_f32 v1, v1, v91
    v_mfma_f32_16x16x32_bf16 v[24:27], a[188:191], a[204:207], v[24:27]
    v_cmp_lt_f32 vcc, s52, v1
    s_cbranch_vccnz L_site12
L_back12:
    s_waitcnt lgkmcnt(5)
    v_mfma_f32_16x16x32_bf16 v[112:115], a[120:123], a[120:123], v[84:87]
    v_exp_f32 v96, v88
    v_mfma_f32_16x16x32_bf16 v[116:119], a[120:123], a[48:51], 0
    v_exp_f32 v97, v89
    s_waitcnt lgkmcnt(4)
    v_mfma_f32_16x16x32_bf16 v[112:115], a[124:127], a[124:127], v[112:115]
    v_exp_f32 v98, v90
    v_mfma_f32_16x16x32_bf16 v[116:119], a[124:127], a[52:55], v[116:119]
    v_exp_f32 v99, v91
    s_waitcnt lgkmcnt(3)
    v_mfma_f32_16x16x32_bf16 v[112:115], a[128:131], a[128:131], v[112:115]
    v_mul_f32 v88, v96, v128
    v_mul_f32 v89, v97, v129
    v_mfma_f32_16x16x32_bf16 v[116:119], a[128:131], a[56:59], v[116:119]
    v_mul_f32 v90, v98, v130
    v_mul_f32 v91, v99, v131
    s_waitcnt lgkmcnt(2)
    v_mfma_f32_16x16x32_bf16 v[112:115], a[132:135], a[132:135], v[112:115]
    v_add_f32 v63, v63, v96
    v_fmac_f32 v64, v88, v92
    v_mfma_f32_16x16x32_bf16 v[116:119], a[132:135], a[60:63], v[116:119]
    v_add_f32 v63, v63, v97
    v_fmac_f32 v64, v89, v93
    s_waitcnt lgkmcnt(1)
    v_mfma_f32_16x16x32_bf16 v[112:115], a[136:139], a[136:139], v[112:115]
    v_add_f32 v63, v63, v98
    v_fmac_f32 v64, v90, v94
    v_mfma_f32_16x16x32_bf16 v[116:119], a[136:139], a[64:67], v[116:119]
    v_add_f32 v63, v63, v99
    v_fmac_f32 v64, v91, v95
    s_waitcnt lgkmcnt(0)
    v_mfma_f32_16x16x32_bf16 v[112:115], a[140:143], a[140:143], v[112:115]
    v_mfma_f32_16x16x32_bf16 v[116:119], a[140:143], a[68:71], v[116:119]
    v_mfma_f32_16x16x32_bf16 v[108:111], a[120:123], v[52:55], v[80:83]
    v_add_f32 v68, v68, v88
    v_add_f32 v69, v69, v89
    v_mfma_f32_16x16x32_bf16 v[108:111], a[124:127], v[52:55], v[108:111]
    v_add_f32 v70, v70, v90
    v_add_f32 v71, v71, v91
    v_mfma_f32_16x16x32_bf16 v[108:111], a[128:131], v[52:55], v[108:111]
    s_nop 0
    v_fma_f32 v112, v116, 2.0, v112
    v_fma_f32 v113, v117, 2.0, v113
    v_mfma_f32_16x16x32_bf16 v[108:111], a[132:135], v[52:55], v[108:111]
    v_fma_f32 v114, v118, 2.0, v114
    v_fma_f32 v115, v119, 2.0, v115
    v_mfma_f32_16x16x32_bf16 v[108:111], a[136:139], v[52:55], v[108:111]
    v_cndmask_b32 v4, 0, v112, s[44:45]
    v_cndmask_b32 v4, v4, v113, s[46:47]
    v_mfma_f32_16x16x32_bf16 v[108:111], a[140:143], v[52:55], v[108:111]
    v_cndmask_b32 v4, v4, v114, s[48:49]
    v_cndmask_b32 v4, v4, v115, s[50:51]
    v_mfma_f32_16x16x32_bf16 v[104:107], a[120:123], v[136:139], v[76:79]
    v_cvt_pk_bf16_f32 v72, v88, v89
    v_mfma_f32_16x16x4_f32 v[124:127], v4, v60, v[56:59]
    v_mfma_f32_16x16x32_bf16 v[104:107], a[124:127], v[140:143], v[104:107]
    v_cvt_pk_bf16_f32 v73, v90, v91
    s_nop 0
    v_mfma_f32_16x16x32_bf16 v[104:107], a[128:131], v[144:147], v[104:107]
    s_nop 0
    s_nop 0
    v_mfma_f32_16x16x32_bf16 v[104:107], a[132:135], v[148:151], v[104:107]
    s_nop 0
    s_nop 0
    v_mfma_f32_16x16x32_bf16 v[104:107], a[136:139], v[152:155], v[104:107]
    v_fma_f32 v132, -v108, v108, v124
    v_fma_f32 v133, -v109, v109, v125
    v_mfma_f32_16x16x32_bf16 v[104:107], a[140:143], v[156:159], v[104:107]
    v_fma_f32 v134, -v110, v110, v126
    v_fma_f32 v135, -v111, v111, v127
    v_max_f32 v132, v132, v56
    v_max_f32 v133, v133, v56
    v_max_f32 v134, v134, v56
    v_max_f32 v135, v135, v56
    v_rsq_f32 v132, v132
    v_rsq_f32 v133, v133
    v_rsq_f32 v134, v134
    v_rsq_f32 v135, v135
    v_fma_f32 v104, -v108, v61, v104
    v_fma_f32 v105, -v109, v61, v105
    v_fma_f32 v106, -v110, v61, v106
    v_fma_f32 v107, -v111, v61, v107
    v_fma_f32 v104, v104, v132, v62
    v_fma_f32 v105, v105, v133, v62
    v_fma_f32 v106, v106, v134, v62
    v_fma_f32 v107, v107, v135, v62
    v_max3_f32 v1, v104, v105, v106
    v_max_f32 v1, v1, v107
    v_cmp_lt_f32 vcc, s52, v1
    s_cbranch_vccnz L_site13
L_back13:
    v_exp_f32 v112, v104
    v_exp_f32 v113, v105
    v_exp_f32 v114, v106
    v_exp_f32 v115, v107
    v_mul_f32 v104, v112, v132
    v_mul_f32 v105, v113, v133
    v_mul_f32 v106, v114, v134
    v_mul_f32 v107, v115, v135
    v_cvt_pk_bf16_f32 v74, v104, v105
    v_cvt_pk_bf16_f32 v75, v106, v107
    ds_write_b128 v237, v[72:75] offset:0
    v_add_f32 v68, v68, v104
    v_add_f32 v69, v69, v105
    v_add_f32 v70, v70, v106
    v_add_f32 v71, v71, v107
    v_cvt_pk_bf16_f32 v66, v68, v69
    v_cvt_pk_bf16_f32 v67, v70, v71
    ds_write_b64 v238, v[66:67]
    v_add_f32 v63, v63, v112
    v_fma_f32 v64, v104, v108, v64
    v_add_f32 v63, v63, v113
    v_fma_f32 v64, v105, v109, v64
    v_add_f32 v63, v63, v114
    v_fma_f32 v64, v106, v110, v64
    v_add_f32 v10, v63, v115
    v_fma_f32 v11, v107, v111, v64
    ds_write_b64 v238, v[10:11] offset:2048
    s_cmp_lt_u32 s29, 64
    s_cbranch_scc0 L_nobulk
    buffer_load_dwordx4 v[76:79], v65, s[32:35], s30 offen offset:0 sc1
    buffer_load_dwordx4 v[80:83], v65, s[32:35], s30 offen offset:1024 sc1
    buffer_load_dwordx4 v[84:87], v65, s[32:35], s30 offen offset:2048 sc1
    buffer_load_dwordx4 v[108:111], v65, s[32:35], s30 offen offset:3072 sc1
    buffer_load_dwordx4 v[112:115], v65, s[32:35], s31 offen offset:0 sc1
    buffer_load_dwordx4 v[128:131], v65, s[32:35], s31 offen offset:1024 sc1
    buffer_load_dwordx4 v[132:135], v65, s[32:35], s31 offen offset:2048 sc1
    buffer_load_dwordx4 v[52:55], v65, s[32:35], s31 offen offset:3072 sc1
L_nobulk:
    s_waitcnt lgkmcnt(0)
    s_barrier
L_postx:
    ds_read_b32 v9, v254 offset:4096
    ds_read_b128 v[92:95], v253 offset:0
    ds_read_b64_tr_b16 a[2:3], v47 offset:6144
    ds_read_b128 v[96:99], v253 offset:1024
    ds_read_b64_tr_b16 a[6:7], v47 offset:18432
    ds_read_b64 v[136:137], v254 offset:2048
    ds_read_b64 v[138:139], v254 offset:2560
    ds_read_b64 v[140:141], v254 offset:3072
    ds_read_b64 v[142:143], v254 offset:3584
    ds_read_b128 v[100:103], v253 offset:2048
    ds_read_b64_tr_b16 a[10:11], v47 offset:30720
    ds_read_b128 v[116:119], v253 offset:3072
    ds_read_b64_tr_b16 a[14:15], v47 offset:43008
    ds_read_b64 v[120:121], v254 offset:0
    ds_read_b64 v[122:123], v254 offset:512
    s_waitcnt lgkmcnt(14)
    v_cmp_ne_u32 vcc, 0, v9
    s_cbranch_vccnz L_xlast
    ds_read_b64 v[124:125], v254 offset:1024
    ds_read_b64 v[126:127], v254 offset:1536
    s_waitcnt lgkmcnt(14)
    v_mfma_f32_16x16x32_bf16 v[16:19], a[0:3], v[92:95], v[16:19]
    s_waitcnt lgkmcnt(12)
    v_mfma_f32_16x16x32_bf16 v[16:19], a[4:7], v[96:99], v[16:19]
    ds_read_b64_tr_b16 a[18:19], v48 offset:6144
    ds_read_b64_tr_b16 a[22:23], v48 offset:18432
    s_waitcnt lgkmcnt(8)
    v_mfma_f32_16x16x32_bf16 v[16:19], a[8:11], v[100:103], v[16:19]
    ds_read_b64_tr_b16 a[26:27], v48 offset:30720
    ds_read_b64_tr_b16 a[30:31], v48 offset:43008
    s_waitcnt lgkmcnt(8)
    v_mfma_f32_16x16x32_bf16 v[16:19], a[12:15], v[116:119], v[16:19]
    ds_read_b64_tr_b16 a[34:35], v49 offset:6144
    ds_read_b64_tr_b16 a[38:39], v49 offset:18432
    s_waitcnt lgkmcnt(8)
    v_mfma_f32_16x16x32_bf16 v[16:19], a[72:75], v[120:123], v[16:19]
    ds_read_b64_tr_b16 a[42:43], v49 offset:30720
    ds_read_b64_tr_b16 a[46:47], v49 offset:43008
    s_waitcnt lgkmcnt(8)
    v_mfma_f32_16x16x32_bf16 v[16:19], a[76:79], v[124:127], v[16:19]
    v_add_f32 v1, v136, v138
    v_add_f32 v2, v137, v139
    s_waitcnt lgkmcnt(7)
    v_mfma_f32_16x16x32_bf16 v[20:23], a[16:19], v[92:95], v[20:23]
    v_add_f32 v140, v140, v142
    v_add_f32 v141, v141, v143
    s_waitcnt lgkmcnt(6)
    v_mfma_f32_16x16x32_bf16 v[20:23], a[20:23], v[96:99], v[20:23]
    v_add_f32 v1, v1, v140
    v_add_f32 v2, v2, v141
    s_waitcnt lgkmcnt(5)
    v_mfma_f32_16x16x32_bf16 v[20:23], a[24:27], v[100:103], v[20:23]
    v_permlane32_swap_b32 v1, v2
    v_add_f32 v1, v1, v2
    s_waitcnt lgkmcnt(4)
    v_mfma_f32_16x16x32_bf16 v[20:23], a[28:31], v[116:119], v[20:23]
    v_mov_b32 v2, v1
    s_nop 1
    v_permlane16_swap_b32 v1, v2
    v_mfma_f32_16x16x32_bf16 v[20:23], a[80:83], v[120:123], v[20:23]
    v_add_f32 v1, v1, v2
    v_mov_b32 v2, v1
    v_mfma_f32_16x16x32_bf16 v[20:23], a[84:87], v[124:127], v[20:23]
    s_nop 0
    v_permlane32_swap_b32 v1, v2
    s_waitcnt lgkmcnt(3)
    v_mfma_f32_16x16x32_bf16 v[24:27], a[32:35], v[92:95], v[24:27]
    v_rcp_f32 v3, v1
    s_waitcnt lgkmcnt(2)
    v_mfma_f32_16x16x32_bf16 v[24:27], a[36:39], v[96:99], v[24:27]
    v_log_f32 v4, v1
    s_waitcnt lgkmcnt(1)
    v_mfma_f32_16x16x32_bf16 v[24:27], a[40:43], v[100:103], v[24:27]
    v_mul_f32 v5, v60, v3
    v_mul_f32 v6, v2, v3
    s_waitcnt lgkmcnt(0)
    v_mfma_f32_16x16x32_bf16 v[24:27], a[44:47], v[116:119], v[24:27]
    v_sub_f32 v4, v4, v255
    v_fma_f32 v16, v16, v5, -v6
    v_mfma_f32_16x16x32_bf16 v[24:27], a[88:91], v[120:123], v[24:27]
    v_fma_f32 v17, v17, v5, -v6
    v_fma_f32 v18, v18, v5, -v6
    v_mfma_f32_16x16x32_bf16 v[24:27], a[92:95], v[124:127], v[24:27]
    v_fma_f32 v19, v19, v5, -v6
    v_cvt_pk_bf16_f32 v66, v16, v17
    v_cvt_pk_bf16_f32 v67, v18, v19
    ds_write_b64 v236, v[66:67] offset:0
    v_fma_f32 v20, v20, v5, -v6
    v_fma_f32 v21, v21, v5, -v6
    v_fma_f32 v22, v22, v5, -v6
    v_fma_f32 v23, v23, v5, -v6
    v_cvt_pk_bf16_f32 v68, v20, v21
    v_cvt_pk_bf16_f32 v69, v22, v23
    ds_write_b64 v236, v[68:69] offset:512
    v_fma_f32 v24, v24, v5, -v6
    v_fma_f32 v25, v25, v5, -v6
    v_fma_f32 v26, v26, v5, -v6
    v_fma_f32 v27, v27, v5, -v6
    v_cvt_pk_bf16_f32 v70, v24, v25
    v_cvt_pk_bf16_f32 v71, v26, v27
    ds_write_b64 v236, v[70:71] offset:1024
    s_cmp_lt_u32 s29, 64
    s_cbranch_scc1 L_wcon
    s_waitcnt vmcnt(1)
L_wcon:
    s_waitcnt vmcnt(9)
    s_waitcnt lgkmcnt(0)
    s_barrier
    ds_read_b128 v[136:139], v241 offset:0
    ds_read_b128 v[140:143], v241 offset:1024
    ds_read_b128 v[144:147], v241 offset:2048
    ds_read_b128 v[148:151], v241 offset:3072
    ds_read_b128 v[152:155], v241 offset:4096
    ds_read_b128 v[156:159], v241 offset:5120
    v_mov_b32 v35, v4
    v_add_u32 v39, s39, v4
    s_waitcnt lgkmcnt(5)
    v_mfma_f32_16x16x32_bf16 v[16:19], v[160:163], v[136:139], 0
    v_mfma_f32_16x16x32_bf16 v[20:23], v[184:187], v[136:139], 0
    v_mfma_f32_16x16x32_bf16 v[24:27], v[208:211], v[136:139], 0
    s_waitcnt lgkmcnt(4)
    v_mfma_f32_16x16x32_bf16 v[16:19], v[164:167], v[140:143], v[16:19]
    v_mfma_f32_16x16x32_bf16 v[20:23], v[188:191], v[140:143], v[20:23]
    v_mfma_f32_16x16x32_bf16 v[24:27], v[212:215], v[140:143], v[24:27]
    s_waitcnt lgkmcnt(3)
    v_mfma_f32_16x16x32_bf16 v[16:19], v[168:171], v[144:147], v[16:19]
    v_mfma_f32_16x16x32_bf16 v[20:23], v[192:195], v[144:147], v[20:23]
    v_mfma_f32_16x16x32_bf16 v[24:27], v[216:219], v[144:147], v[24:27]
    s_waitcnt lgkmcnt(2)
    v_mfma_f32_16x16x32_bf16 v[16:19], v[172:175], v[148:151], v[16:19]
    s_waitcnt lgkmcnt(1)
    v_mfma_f32_16x16x32_bf16 v[16:19], v[176:179], v[152:155], v[16:19]
    s_waitcnt lgkmcnt(0)
    v_mfma_f32_16x16x32_bf16 v[16:19], v[180:183], v[156:159], v[16:19]
    v_mfma_f32_16x16x32_bf16 v[20:23], v[196:199], v[148:151], v[20:23]
    v_mfma_f32_16x16x32_bf16 v[20:23], v[200:203], v[152:155], v[20:23]
    v_mfma_f32_16x16x32_bf16 v[20:23], v[204:207], v[156:159], v[20:23]
    v_mfma_f32_16x16x32_bf16 v[24:27], v[220:223], v[148:151], v[24:27]
    v_mfma_f32_16x16x32_bf16 v[24:27], v[224:227], v[152:155], v[24:27]
    s_nop 2
    v_cvt_pk_bf16_f32 v32, v16, v17
    v_mfma_f32_16x16x32_bf16 v[24:27], v[228:231], v[156:159], v[24:27]
    v_cvt_pk_bf16_f32 v33, v18, v19
    v_cvt_pk_bf16_f32 v34, v20, v21
    v_cvt_pk_bf16_f32 v36, v22, v23
    buffer_store_dwordx4 v[32:35], v242, s[32:35], s28 offen sc1
    s_nop 3
    v_cvt_pk_bf16_f32 v37, v24, v25
    v_cvt_pk_bf16_f32 v38, v26, v27
    buffer_store_dwordx4 v[36:39], v243, s[32:35], s28 offen sc1
    s_cmp_lt_u32 s29, 64
    s_cbranch_scc0 L_fin
    ds_bpermute_b32 v42, v252, v4
    v_bfe_u32 v48, v0, 2, 1
    v_cmp_eq_u32 vcc, 1, v48
    v_mov_b32 v246, s39
    s_movk_i32 s26, 0x101
    v_cndmask_b32 v247, 0, v246, vcc
    v_sub_u32 v246, v246, v247
    v_sub_u32 v246, v246, v247
    v_mov_b32 v16, 0
    v_mov_b32 v17, 0
    v_mov_b32 v18, 0
    v_mov_b32 v19, 0
    v_mov_b32 v20, 0
    v_mov_b32 v21, 0
    v_mov_b32 v22, 0
    v_mov_b32 v97, 0
    s_mov_b32 s53, 0
    s_waitcnt vmcnt(2)
    v_sub_u32_dpp v136, v79, v79 row_half_mirror row_mask:0xf bank_mask:0xf
    v_sub_u32_dpp v137, v83, v83 row_half_mirror row_mask:0xf bank_mask:0xf
    v_sub_u32_dpp v138, v87, v87 row_half_mirror row_mask:0xf bank_mask:0xf
    v_sub_u32_dpp v139, v111, v111 row_half_mirror row_mask:0xf bank_mask:0xf
    v_sub_u32_dpp v140, v115, v115 row_half_mirror row_mask:0xf bank_mask:0xf
    v_sub_u32_dpp v141, v131, v131 row_half_mirror row_mask:0xf bank_mask:0xf
    v_sub_u32_dpp v142, v135, v135 row_half_mirror row_mask:0xf bank_mask:0xf
    v_sub_u32_dpp v143, v55, v55 row_half_mirror row_mask:0xf bank_mask:0xf
    v_cmp_eq_u32 s[6:7], v136, v246
    v_mov_b32 v136, 0x101
    v_cmp_eq_u32 s[8:9], v137, v246
    v_mov_b32 v137, 0x202
    v_cmp_eq_u32 s[10:11], v138, v246
    v_mov_b32 v138, 0x404
    v_cmp_eq_u32 s[12:13], v139, v246
    v_mov_b32 v139, 0x808
    v_cmp_eq_u32 s[14:15], v140, v246
    v_mov_b32 v140, 0x1010
    v_cmp_eq_u32 s[16:17], v141, v246
    v_mov_b32 v141, 0x2020
    v_cmp_eq_u32 s[36:37], v142, v246
    v_mov_b32 v142, 0x4040
    v_cmp_eq_u32 s[40:41], v143, v246
    v_mov_b32 v143, 0x8080
    v_cndmask_b32 v136, v136, 0, s[6:7]
    v_cndmask_b32 v137, v137, 0, s[8:9]
    v_cndmask_b32 v138, v138, 0, s[10:11]
    v_cndmask_b32 v139, v139, 0, s[12:13]
    v_cndmask_b32 v140, v140, 0, s[14:15]
    v_cndmask_b32 v141, v141, 0, s[16:17]
    v_cndmask_b32 v142, v142, 0, s[36:37]
    v_cndmask_b32 v143, v143, 0, s[40:41]
    v_or3_b32 v96, v136, v137, v138
    v_or3_b32 v139, v139, v140, v141
    v_or3_b32 v96, v96, v142, v143
    v_or_b32 v96, v96, v139
    v_cmp_ne_u32 s[24:25], 0, v96
    s_waitcnt lgkmcnt(0)
    v_lshrrev_b32 v48, v97, v96
    v_ffbl_b32 v48, v48
    v_add_u32 v48, v48, v97
    v_and_b32 v48, 7, v48
    v_lshl_add_u32 v51, v48, 10, v65
    v_lshlrev_b32 v88, v48, s26
    v_add_u32 v97, 1, v48
    s_mov_b64 exec, s[24:25]
    buffer_load_dwordx4 v[136:139], v51, s[32:35], s30 offen sc1
    s_mov_b64 exec, -1
    s_mov_b64 exec, s[6:7]
    v_sub_u32 v49, v79, v247
    v_sub_f32 v49, v49, v42
    v_exp_f32 v49, v49
    s_nop 0
    v_cvt_pk_bf16_f32 v49, v49, 0
    v_lshlrev_b32 v50, 16, v49
    v_dot2_f32_bf16 v16, v76, v49, v16
    v_dot2_f32_bf16 v18, v77, v49, v18
    v_dot2_f32_bf16 v20, v78, v49, v20
    v_add_f32 v22, v22, v50
    v_dot2_f32_bf16 v17, v76, v50, v17
    v_dot2_f32_bf16 v19, v77, v50, v19
    v_dot2_f32_bf16 v21, v78, v50, v21
    s_mov_b64 exec, -1
    s_mov_b64 exec, s[8:9]
    v_sub_u32 v49, v83, v247
    v_sub_f32 v49, v49, v42
    v_exp_f32 v49, v49
    s_nop 0
    v_cvt_pk_bf16_f32 v49, v49, 0
    v_lshlrev_b32 v50, 16, v49
    v_dot2_f32_bf16 v16, v80, v49, v16
    v_dot2_f32_bf16 v18, v81, v49, v18
    v_dot2_f32_bf16 v20, v82, v49, v20
    v_add_f32 v22, v22, v50
    v_dot2_f32_bf16 v17, v80, v50, v17
    v_dot2_f32_bf16 v19, v81, v50, v19
    v_dot2_f32_bf16 v21, v82, v50, v21
    s_mov_b64 exec, -1
    v_lshrrev_b32 v48, v97, v96
    v_ffbl_b32 v48, v48
    v_add_u32 v48, v48, v97
    v_and_b32 v48, 7, v48
    v_lshl_add_u32 v51, v48, 10, v65
    v_lshlrev_b32 v89, v48, s26
    v_add_u32 v97, 1, v48
    s_mov_b64 exec, s[24:25]
    buffer_load_dwordx4 v[140:143], v51, s[32:35], s30 offen sc1
    s_mov_b64 exec, -1
    s_mov_b64 exec, s[10:11]
    v_sub_u32 v49, v87, v247
    v_sub_f32 v49, v49, v42
    v_exp_f32 v49, v49
    s_nop 0
    v_cvt_pk_bf16_f32 v49, v49, 0
    v_lshlrev_b32 v50, 16, v49
    v_dot2_f32_bf16 v16, v84, v49, v16
    v_dot2_f32_bf16 v18, v85, v49, v18
    v_dot2_f32_bf16 v20, v86, v49, v20
    v_add_f32 v22, v22, v50
    v_dot2_f32_bf16 v17, v84, v50, v17
    v_dot2_f32_bf16 v19, v85, v50, v19
    v_dot2_f32_bf16 v21, v86, v50, v21
    s_mov_b64 exec, -1
    s_mov_b64 exec, s[12:13]
    v_sub_u32 v49, v111, v247
    v_sub_f32 v49, v49, v42
    v_exp_f32 v49, v49
    s_nop 0
    v_cvt_pk_bf16_f32 v49, v49, 0
    v_lshlrev_b32 v50, 16, v49
    v_dot2_f32_bf16 v16, v108, v49, v16
    v_dot2_f32_bf16 v18, v109, v49, v18
    v_dot2_f32_bf16 v20, v110, v49, v20
    v_add_f32 v22, v22, v50
    v_dot2_f32_bf16 v17, v108, v50, v17
    v_dot2_f32_bf16 v19, v109, v50, v19
    v_dot2_f32_bf16 v21, v110, v50, v21
    s_mov_b64 exec, -1
    v_lshrrev_b32 v48, v97, v96
    v_ffbl_b32 v48, v48
    v_add_u32 v48, v48, v97
    v_and_b32 v48, 7, v48
    v_lshl_add_u32 v51, v48, 10, v65
    v_lshlrev_b32 v90, v48, s26
    v_add_u32 v97, 1, v48
    s_mov_b64 exec, s[24:25]
    buffer_load_dwordx4 v[144:147], v51, s[32:35], s30 offen sc1
    s_mov_b64 exec, -1
    s_mov_b64 exec, s[14:15]
    v_sub_u32 v49, v115, v247
    v_sub_f32 v49, v49, v42
    v_exp_f32 v49, v49
    s_nop 0
    v_cvt_pk_bf16_f32 v49, v49, 0
    v_lshlrev_b32 v50, 16, v49
    v_dot2_f32_bf16 v16, v112, v49, v16
    v_dot2_f32_bf16 v18, v113, v49, v18
    v_dot2_f32_bf16 v20, v114, v49, v20
    v_add_f32 v22, v22, v50
    v_dot2_f32_bf16 v17, v112, v50, v17
    v_dot2_f32_bf16 v19, v113, v50, v19
    v_dot2_f32_bf16 v21, v114, v50, v21
    s_mov_b64 exec, -1
    s_mov_b64 exec, s[16:17]
    v_sub_u32 v49, v131, v247
    v_sub_f32 v49, v49, v42
    v_exp_f32 v49, v49
    s_nop 0
    v_cvt_pk_bf16_f32 v49, v49, 0
    v_lshlrev_b32 v50, 16, v49
    v_dot2_f32_bf16 v16, v128, v49, v16
    v_dot2_f32_bf16 v18, v129, v49, v18
    v_dot2_f32_bf16 v20, v130, v49, v20
    v_add_f32 v22, v22, v50
    v_dot2_f32_bf16 v17, v128, v50, v17
    v_dot2_f32_bf16 v19, v129, v50, v19
    v_dot2_f32_bf16 v21, v130, v50, v21
    s_mov_b64 exec, -1
    v_lshrrev_b32 v48, v97, v96
    v_ffbl_b32 v48, v48
    v_add_u32 v48, v48, v97
    v_and_b32 v48, 7, v48
    v_lshl_add_u32 v51, v48, 10, v65
    v_lshlrev_b32 v91, v48, s26
    v_add_u32 v97, 1, v48
    s_mov_b64 exec, s[24:25]
    buffer_load_dwordx4 v[148:151], v51, s[32:35], s30 offen sc1
    s_mov_b64 exec, -1
    s_mov_b64 exec, s[36:37]
    v_sub_u32 v49, v135, v247
    v_sub_f32 v49, v49, v42
    v_exp_f32 v49, v49
    s_nop 0
    v_cvt_pk_bf16_f32 v49, v49, 0
    v_lshlrev_b32 v50, 16, v49
    v_dot2_f32_bf16 v16, v132, v49, v16
    v_dot2_f32_bf16 v18, v133, v49, v18
    v_dot2_f32_bf16 v20, v134, v49, v20
    v_add_f32 v22, v22, v50
    v_dot2_f32_bf16 v17, v132, v50, v17
    v_dot2_f32_bf16 v19, v133, v50, v19
    v_dot2_f32_bf16 v21, v134, v50, v21
    s_mov_b64 exec, -1
    s_mov_b64 exec, s[40:41]
    v_sub_u32 v49, v55, v247
    v_sub_f32 v49, v49, v42
    v_exp_f32 v49, v49
    s_nop 0
    v_cvt_pk_bf16_f32 v49, v49, 0
    v_lshlrev_b32 v50, 16, v49
    v_dot2_f32_bf16 v16, v52, v49, v16
    v_dot2_f32_bf16 v18, v53, v49, v18
    v_dot2_f32_bf16 v20, v54, v49, v20
    v_add_f32 v22, v22, v50
    v_dot2_f32_bf16 v17, v52, v50, v17
    v_dot2_f32_bf16 v19, v53, v50, v19
    v_dot2_f32_bf16 v21, v54, v50, v21
    s_mov_b64 exec, -1
    s_cmp_eq_u64 s[24:25], 0
    s_cbranch_scc1 L_c_red
L_c_loop:
    s_waitcnt vmcnt(3)
    v_sub_u32_dpp v48, v139, v139 row_half_mirror row_mask:0xf bank_mask:0xf
    v_and_b32 v49, v88, v96
    v_cmp_eq_u32 vcc, v48, v246
    v_cmp_ne_u32 s[24:25], 0, v49
    s_and_b64 exec, vcc, s[24:25]
    s_cbranch_scc0 L_c_s0
    v_xor_b32 v96, v96, v88
    v_sub_u32 v49, v139, v247
    v_sub_f32 v49, v49, v42
    v_exp_f32 v49, v49
    s_nop 0
    v_cvt_pk_bf16_f32 v49, v49, 0
    v_lshlrev_b32 v50, 16, v49
    v_dot2_f32_bf16 v16, v136, v49, v16
    v_dot2_f32_bf16 v18, v137, v49, v18
    v_dot2_f32_bf16 v20, v138, v49, v20
    v_add_f32 v22, v22, v50
    v_dot2_f32_bf16 v17, v136, v50, v17
    v_dot2_f32_bf16 v19, v137, v50, v19
    v_dot2_f32_bf16 v21, v138, v50, v21
L_c_s0:
    s_mov_b64 exec, -1
    v_cmp_ne_u32 vcc, 0, v96
    v_lshrrev_b32 v48, v97, v96
    s_cbranch_vccz L_c_red
    v_ffbl_b32 v48, v48
    v_add_u32 v48, v48, v97
    v_and_b32 v48, 7, v48
    v_lshl_add_u32 v51, v48, 10, v65
    v_lshlrev_b32 v88, v48, s26
    v_add_u32 v97, 1, v48
    s_mov_b64 exec, vcc
    buffer_load_dwordx4 v[136:139], v51, s[32:35], s30 offen sc1
    s_mov_b64 exec, -1
    s_waitcnt vmcnt(3)
    v_sub_u32_dpp v48, v143, v143 row_half_mirror row_mask:0xf bank_mask:0xf
    v_and_b32 v49, v89, v96
    v_cmp_eq_u32 vcc, v48, v246
    v_cmp_ne_u32 s[24:25], 0, v49
    s_and_b64 exec, vcc, s[24:25]
    s_cbranch_scc0 L_c_s1
    v_xor_b32 v96, v96, v89
    v_sub_u32 v49, v143, v247
    v_sub_f32 v49, v49, v42
    v_exp_f32 v49, v49
    s_nop 0
    v_cvt_pk_bf16_f32 v49, v49, 0
    v_lshlrev_b32 v50, 16, v49
    v_dot2_f32_bf16 v16, v140, v49, v16
    v_dot2_f32_bf16 v18, v141, v49, v18
    v_dot2_f32_bf16 v20, v142, v49, v20
    v_add_f32 v22, v22, v50
    v_dot2_f32_bf16 v17, v140, v50, v17
    v_dot2_f32_bf16 v19, v141, v50, v19
    v_dot2_f32_bf16 v21, v142, v50, v21
L_c_s1:
    s_mov_b64 exec, -1
    v_cmp_ne_u32 vcc, 0, v96
    v_lshrrev_b32 v48, v97, v96
    s_cbranch_vccz L_c_red
    v_ffbl_b32 v48, v48
    v_add_u32 v48, v48, v97
    v_and_b32 v48, 7, v48
    v_lshl_add_u32 v51, v48, 10, v65
    v_lshlrev_b32 v89, v48, s26
    v_add_u32 v97, 1, v48
    s_mov_b64 exec, vcc
    buffer_load_dwordx4 v[140:143], v51, s[32:35], s30 offen sc1
    s_mov_b64 exec, -1
    s_waitcnt vmcnt(3)
    v_sub_u32_dpp v48, v147, v147 row_half_mirror row_mask:0xf bank_mask:0xf
    v_and_b32 v49, v90, v96
    v_cmp_eq_u32 vcc, v48, v246
    v_cmp_ne_u32 s[24:25], 0, v49
    s_and_b64 exec, vcc, s[24:25]
    s_cbranch_scc0 L_c_s2
    v_xor_b32 v96, v96, v90
    v_sub_u32 v49, v147, v247
    v_sub_f32 v49, v49, v42
    v_exp_f32 v49, v49
    s_nop 0
    v_cvt_pk_bf16_f32 v49, v49, 0
    v_lshlrev_b32 v50, 16, v49
    v_dot2_f32_bf16 v16, v144, v49, v16
    v_dot2_f32_bf16 v18, v145, v49, v18
    v_dot2_f32_bf16 v20, v146, v49, v20
    v_add_f32 v22, v22, v50
    v_dot2_f32_bf16 v17, v144, v50, v17
    v_dot2_f32_bf16 v19, v145, v50, v19
    v_dot2_f32_bf16 v21, v146, v50, v21
L_c_s2:
    s_mov_b64 exec, -1
    v_cmp_ne_u32 vcc, 0, v96
    v_lshrrev_b32 v48, v97, v96
    s_cbranch_vccz L_c_red
    v_ffbl_b32 v48, v48
    v_add_u32 v48, v48, v97
    v_and_b32 v48, 7, v48
    v_lshl_add_u32 v51, v48, 10, v65
    v_lshlrev_b32 v90, v48, s26
    v_add_u32 v97, 1, v48
    s_mov_b64 exec, vcc
    buffer_load_dwordx4 v[144:147], v51, s[32:35], s30 offen sc1
    s_mov_b64 exec, -1
    s_waitcnt vmcnt(3)
    v_sub_u32_dpp v48, v151, v151 row_half_mirror row_mask:0xf bank_mask:0xf
    v_and_b32 v49, v91, v96
    v_cmp_eq_u32 vcc, v48, v246
    v_cmp_ne_u32 s[24:25], 0, v49
    s_and_b64 exec, vcc, s[24:25]
    s_cbranch_scc0 L_c_s3
    v_xor_b32 v96, v96, v91
    v_sub_u32 v49, v151, v247
    v_sub_f32 v49, v49, v42
    v_exp_f32 v49, v49
    s_nop 0
    v_cvt_pk_bf16_f32 v49, v49, 0
    v_lshlrev_b32 v50, 16, v49
    v_dot2_f32_bf16 v16, v148, v49, v16
    v_dot2_f32_bf16 v18, v149, v49, v18
    v_dot2_f32_bf16 v20, v150, v49, v20
    v_add_f32 v22, v22, v50
    v_dot2_f32_bf16 v17, v148, v50, v17
    v_dot2_f32_bf16 v19, v149, v50, v19
    v_dot2_f32_bf16 v21, v150, v50, v21
L_c_s3:
    s_mov_b64 exec, -1
    v_cmp_ne_u32 vcc, 0, v96
    v_lshrrev_b32 v48, v97, v96
    s_cbranch_vccz L_c_red
    v_ffbl_b32 v48, v48
    v_add_u32 v48, v48, v97
    v_and_b32 v48, 7, v48
    v_lshl_add_u32 v51, v48, 10, v65
    v_lshlrev_b32 v91, v48, s26
    v_add_u32 v97, 1, v48
    s_mov_b64 exec, vcc
    buffer_load_dwordx4 v[148:151], v51, s[32:35], s30 offen sc1
    s_mov_b64 exec, -1
    s_add_u32 s53, s53, 1
    s_cmp_lt_u32 s53, 65536
    s_cbranch_scc1 L_c_loop
L_c_red:
    v_mov_b32 v23, v22
    v_permlane32_swap_b32 v16, v20
    v_permlane32_swap_b32 v17, v21
    v_permlane32_swap_b32 v18, v22
    v_permlane32_swap_b32 v19, v23
    v_add_f32 v16, v16, v20
    v_add_f32 v17, v17, v21
    v_add_f32 v18, v18, v22
    v_add_f32 v19, v19, v23
    s_nop 0
    v_permlane16_swap_b32 v16, v18
    v_permlane16_swap_b32 v17, v19
    v_add_f32 v16, v16, v18
    v_add_f32 v17, v17, v19
    s_nop 0
    v_add_f32_dpp v48, v16, v16 row_ror:8 row_mask:0xf bank_mask:0x3
    s_nop 1
    v_add_f32_dpp v48, v17, v17 row_ror:8 row_mask:0xf bank_mask:0xc
    ds_write_b32 v250, v48
    s_waitcnt lgkmcnt(0)
    s_barrier
    ds_read_b128 v[48:51], v251 offset:768
    ds_read_b128 v[52:55], v65
    v_lshlrev_b32 v18, 16, v249
    s_waitcnt lgkmcnt(1)
    v_add_f32 v48, v48, v49
    v_add_f32 v50, v50, v51
    v_add_f32 v48, v48, v50
    v_cmp_nlt_f32 vcc, v48, v232
    v_rcp_f32 v48, v48
    s_waitcnt lgkmcnt(0)
    s_cbranch_vccnz L_c_slow
L_c_out:
    s_cmp_lg_u32 s3, 0
    s_cbranch_scc1 L_fin
    v_add_f32 v52, v52, v53
    v_add_f32 v54, v54, v55
    v_add_f32 v52, v52, v54
    v_fmac_f32 v18, v52, v48
    v_cvt_pk_bf16_f32 v18, v18, v18
    buffer_store_short v18, v248, s[68:71], 0 offen
    s_cmp_lg_u32 s29, 0
    s_cbranch_scc1 L_fin
    v_mov_b32 v48, s39
    v_mov_b32 v49, 0
    s_mov_b64 exec, 1
    buffer_store_dword v48, v49, s[32:35], 0 offen offset:0 sc1
    s_mov_b64 exec, -1
L_fin:
L_end:
    s_endpgm
L_prod:
    s_cmp_lg_u32 s3, 0
    s_cbranch_scc1 L_p_noq
    s_mov_b32 m0, 147456
    s_nop 0
    buffer_load_dwordx4 v16, s[72:75], 0 offen offset:0  lds
    buffer_load_dwordx4 v17, s[72:75], 0 offen offset:1024  lds
    buffer_load_dwordx4 v18, s[72:75], 0 offen offset:2048  lds
    buffer_load_dwordx4 v19, s[72:75], 0 offen offset:3072  lds
    s_mov_b32 m0, 151552
    s_nop 0
    buffer_load_dwordx4 v20, s[72:75], 0 offen offset:0  lds
    buffer_load_dwordx4 v21, s[72:75], 0 offen offset:1024  lds
L_p_noq:
    s_mul_i32 s60, s3, 18432
    s_add_u32 m0, s60, 73728
    s_nop 0
    buffer_load_dwordx4 v16, s[64:67], s60 offen offset:0  lds
    buffer_load_dwordx4 v17, s[64:67], s60 offen offset:1024  lds
    buffer_load_dwordx4 v18, s[64:67], s60 offen offset:2048  lds
    buffer_load_dwordx4 v19, s[64:67], s60 offen offset:3072  lds
    s_add_u32 m0, s60, 77824
    s_nop 0
    buffer_load_dwordx4 v20, s[64:67], s60 offen offset:0  lds
    buffer_load_dwordx4 v21, s[64:67], s60 offen offset:1024  lds
    s_add_u32 s60, s60, 6144
    s_add_u32 m0, s60, 73728
    s_nop 0
    buffer_load_dwordx4 v16, s[64:67], s60 offen offset:0  lds
    buffer_load_dwordx4 v17, s[64:67], s60 offen offset:1024  lds
    buffer_load_dwordx4 v18, s[64:67], s60 offen offset:2048  lds
    buffer_load_dwordx4 v19, s[64:67], s60 offen offset:3072  lds
    s_add_u32 m0, s60, 77824
    s_nop 0
    buffer_load_dwordx4 v20, s[64:67], s60 offen offset:0  lds
    buffer_load_dwordx4 v21, s[64:67], s60 offen offset:1024  lds
    s_add_u32 s60, s60, 6144
    s_add_u32 m0, s60, 73728
    s_nop 0
    buffer_load_dwordx4 v16, s[64:67], s60 offen offset:0  lds
    v_mov_b32 v52, 0x3f803f80
    v_mov_b32 v56, 0x3ebcbe62
    s_mov_b32 s44, 0x100001
    s_mov_b32 s45, 0x10000100
    v_mov_b32 v53, 0x3f803f80
    v_mov_b32 v57, 0x3ebcbe62
    s_mov_b32 s46, 0x200002
    buffer_load_dwordx4 v17, s[64:67], s60 offen offset:1024  lds
    s_mov_b32 s47, 0x20000200
    v_mov_b32 v54, 0x3f803f80
    v_mov_b32 v58, 0x3ebcbe62
    s_mov_b32 s48, 0x400004
    s_mov_b32 s49, 0x40000400
    v_mov_b32 v55, 0x3f803f80
    v_mov_b32 v59, 0x3ebcbe62
    buffer_load_dwordx4 v18, s[64:67], s60 offen offset:2048  lds
    s_mov_b32 s50, 0x800008
    s_mov_b32 s51, 0x80000800
    v_mov_b32 v60, 0x43400000
    v_lshrrev_b32 v1, 5, v0
    v_lshlrev_b32 v1, 8, v1
    v_and_b32 v2, 15, v0
    v_lshl_add_u32 v1, v2, 4, v1
    buffer_load_dwordx4 v19, s[64:67], s60 offen offset:3072  lds
    v_bfe_u32 v2, v0, 4, 1
    v_lshl_add_u32 v1, v2, 3, v1
    s_mul_i32 s56, s3, 1536
    s_add_u32 s56, s56, 153600
    v_add_u32 v134, s56, v1
    v_bfe_u32 v1, v0, 4, 1
    v_lshrrev_b32 v5, 5, v0
    s_add_u32 m0, s60, 77824
    s_nop 0
    buffer_load_dwordx4 v20, s[64:67], s60 offen offset:0  lds
    v_lshl_or_b32 v1, v1, 1, v5
    v_bfe_u32 v2, v0, 2, 2
    v_lshl_add_u32 v3, v1, 3, v2
    v_mul_u32_u24 v3, 384, v3
    v_and_b32 v4, 1, v0
    v_lshl_add_u32 v3, v4, 3, v3
    v_add_u32 v3, 73728, v3
    buffer_load_dwordx4 v21, s[64:67], s60 offen offset:1024  lds
    v_and_or_b32 v2, v2, 2, v5
    v_bfe_u32 v4, v0, 1, 1
    v_xor_b32 v2, v2, v4
    s_mul_i32 s56, s3, 6
    s_add_u32 s57, s56, 0
    v_xor_b32 v4, s57, v2
    v_lshl_add_u32 v124, v4, 4, v3
    s_lshl_b32 s61, s43, 2
    s_add_u32 s61, s61, s3
    s_mul_i32 s60, s61, 6144
    s_add_u32 m0, s41, 6144
    s_nop 0
    buffer_load_dwordx4 v16, s[68:71], s60 offen offset:0  lds
    v_xor_b32 v125, 64, v124
    s_add_u32 s57, s56, 2
    v_xor_b32 v4, s57, v2
    v_lshl_add_u32 v126, v4, 4, v3
    v_xor_b32 v127, 64, v126
    s_add_u32 s57, s56, 4
    v_xor_b32 v4, s57, v2
    buffer_load_dwordx4 v17, s[68:71], s60 offen offset:1024  lds
    v_lshl_add_u32 v128, v4, 4, v3
    v_xor_b32 v129, 64, v128
    v_and_b32 v2, 15, v0
    v_bfe_u32 v3, v0, 3, 1
    v_and_or_b32 v4, v0, 6, v3
    v_xor_b32 v4, v4, v1
    v_mul_u32_u24 v2, 384, v2
    buffer_load_dwordx4 v18, s[68:71], s60 offen offset:2048  lds
    v_lshl_add_u32 v2, v4, 4, v2
    v_add_u32 v132, 147456, v2
    v_xor_b32 v133, 64, v132
    s_and_b32 s56, s3, 1
    s_lshl_b32 s56, s56, 2
    s_lshr_b32 s57, s3, 1
    s_mul_i32 s57, s57, 24576
    buffer_load_dwordx4 v19, s[68:71], s60 offen offset:3072  lds
    s_add_u32 s57, s57, 30720
    v_and_b32 v1, 11, v0
    v_or_b32 v1, s56, v1
    v_and_or_b32 v2, v1, 6, v3
    v_lshrrev_b32 v3, 4, v0
    v_xor_b32 v2, v2, v3
    v_mul_u32_u24 v1, 384, v1
    s_add_u32 m0, s41, 10240
    s_nop 0
    buffer_load_dwordx4 v20, s[68:71], s60 offen offset:0  lds
    v_lshl_add_u32 v1, v2, 4, v1
    v_bfe_u32 v2, v0, 2, 1
    v_mul_u32_u24 v2, 12288, v2
    v_add3_u32 v130, s57, v1, v2
    v_xor_b32 v131, 64, v130
    v_add_u32 v135, 153600, v65
    buffer_load_dwordx4 v21, s[68:71], s60 offen offset:1024  lds
    s_waitcnt vmcnt(24)
    s_barrier
    s_load_dword s38, s[22:23], 0
    ds_read_b128 v[136:139], v132 offset:0
    ds_read_b128 v[140:143], v133 offset:0
    ds_read_b128 v[144:147], v132 offset:128
    ds_read_b128 v[148:151], v133 offset:128
    ds_read_b128 v[152:155], v132 offset:256
    ds_read_b128 v[156:159], v133 offset:256
    s_add_u32 m0, s40, 0
    s_add_u32 s57, s36, 0
    buffer_load_dwordx4 v16, s[28:31], s57 offen offset:0 nt lds
    buffer_load_dwordx4 v17, s[28:31], s57 offen offset:1024 nt lds
    buffer_load_dwordx4 v18, s[28:31], s57 offen offset:2048 nt lds
    buffer_load_dwordx4 v19, s[28:31], s57 offen offset:3072 nt lds
    s_add_u32 m0, s40, 4096
    s_nop 0
    buffer_load_dwordx4 v20, s[28:31], s57 offen offset:0 nt lds
    buffer_load_dwordx4 v21, s[28:31], s57 offen offset:1024 nt lds
    s_waitcnt lgkmcnt(0)
    v_mfma_f32_16x16x32_bf16 v[112:115], v[136:139], v[136:139], 0
    v_mfma_f32_16x16x32_bf16 v[116:119], v[52:55], v[136:139], 0
    s_add_u32 m0, s41, 0
    s_add_u32 s58, s37, 0
    buffer_load_dwordx4 v22, s[24:27], s58 offen offset:0 nt lds
    v_mfma_f32_16x16x32_bf16 v[112:115], v[140:143], v[140:143], v[112:115]
    v_mfma_f32_16x16x32_bf16 v[116:119], v[52:55], v[140:143], v[116:119]
    buffer_load_dwordx4 v23, s[24:27], s58 offen offset:1024 nt lds
    v_mfma_f32_16x16x32_bf16 v[112:115], v[144:147], v[144:147], v[112:115]
    v_mfma_f32_16x16x32_bf16 v[116:119], v[52:55], v[144:147], v[116:119]
    buffer_load_dwordx4 v24, s[24:27], s58 offen offset:2048 nt lds
    v_mfma_f32_16x16x32_bf16 v[112:115], v[148:151], v[148:151], v[112:115]
    v_mfma_f32_16x16x32_bf16 v[116:119], v[52:55], v[148:151], v[116:119]
    v_mfma_f32_16x16x32_bf16 v[112:115], v[152:155], v[152:155], v[112:115]
    v_mfma_f32_16x16x32_bf16 v[116:119], v[52:55], v[152:155], v[116:119]
    v_mfma_f32_16x16x32_bf16 v[112:115], v[156:159], v[156:159], v[112:115]
    v_mfma_f32_16x16x32_bf16 v[116:119], v[52:55], v[156:159], v[116:119]
    s_mul_i32 s39, s38, 0x9e3779b1
    s_add_u32 s39, s39, 0x7f4a7c16
    s_or_b32 s39, s39, 1
    s_lshl_b32 s61, s61, 10
    s_add_u32 s61, s61, 16384
    s_waitcnt vmcnt(15)
    s_barrier
    ds_read_b64_tr_b16 v[160:161], v124 offset:0
    ds_read_b64_tr_b16 v[162:163], v125 offset:1536
    ds_read_b64_tr_b16 v[184:185], v126 offset:0
    ds_read_b64_tr_b16 v[186:187], v127 offset:1536
    ds_read_b64_tr_b16 v[208:209], v128 offset:0
    ds_read_b64_tr_b16 v[210:211], v129 offset:1536
    ds_read_b64_tr_b16 v[164:165], v124 offset:12288
    ds_read_b64_tr_b16 v[166:167], v125 offset:13824
    ds_read_b64_tr_b16 v[188:189], v126 offset:12288
    ds_read_b64_tr_b16 v[190:191], v127 offset:13824
    ds_read_b64_tr_b16 v[212:213], v128 offset:12288
    ds_read_b64_tr_b16 v[214:215], v129 offset:13824
    v_cndmask_b32 v3, 0, v112, s[44:45]
    v_cndmask_b32 v3, v3, v113, s[46:47]
    v_cndmask_b32 v3, v3, v114, s[48:49]
    v_cndmask_b32 v3, v3, v115, s[50:51]
    v_mul_f32 v6, 0x3baaaaab, v116
    ds_read_b64_tr_b16 v[168:169], v124 offset:24576
    ds_read_b64_tr_b16 v[170:171], v125 offset:26112
    v_mfma_f32_16x16x4_f32 v[120:123], v60, v3, v[56:59]
    s_waitcnt lgkmcnt(12)
    v_mfma_f32_16x16x32_bf16 v[88:91], v[160:163], v[136:139], 0
    ds_read_b64_tr_b16 v[192:193], v126 offset:24576
    v_mfma_f32_16x16x32_bf16 v[100:103], v[160:163], v[52:55], 0
    ds_read_b64_tr_b16 v[194:195], v127 offset:26112
    s_waitcnt lgkmcnt(12)
    v_mfma_f32_16x16x32_bf16 v[92:95], v[184:187], v[136:139], 0
    ds_read_b64_tr_b16 v[216:217], v128 offset:24576
    v_mfma_f32_16x16x32_bf16 v[104:107], v[184:187], v[52:55], 0
    ds_read_b64_tr_b16 v[218:219], v129 offset:26112
    s_waitcnt lgkmcnt(12)
    v_mfma_f32_16x16x32_bf16 v[96:99], v[208:211], v[136:139], 0
    ds_read_b64_tr_b16 v[172:173], v124 offset:36864
    v_mfma_f32_16x16x32_bf16 v[108:111], v[208:211], v[52:55], 0
    ds_read_b64_tr_b16 v[174:175], v125 offset:38400
    s_waitcnt lgkmcnt(12)
    v_mfma_f32_16x16x32_bf16 v[88:91], v[164:167], v[140:143], v[88:91]
    ds_read_b64_tr_b16 v[196:197], v126 offset:36864
    v_mfma_f32_16x16x32_bf16 v[100:103], v[164:167], v[52:55], v[100:103]
    ds_read_b64_tr_b16 v[198:199], v127 offset:38400
    s_waitcnt lgkmcnt(12)
    v_mfma_f32_16x16x32_bf16 v[92:95], v[188:191], v[140:143], v[92:95]
    ds_read_b64_tr_b16 v[220:221], v128 offset:36864
    v_mfma_f32_16x16x32_bf16 v[104:107], v[188:191], v[52:55], v[104:107]
    ds_read_b64_tr_b16 v[222:223], v129 offset:38400
    s_waitcnt lgkmcnt(12)
    v_mfma_f32_16x16x32_bf16 v[96:99], v[212:215], v[140:143], v[96:99]
    ds_read_b64_tr_b16 v[176:177], v124 offset:49152
    v_mfma_f32_16x16x32_bf16 v[108:111], v[212:215], v[52:55], v[108:111]
    ds_read_b64_tr_b16 v[178:179], v125 offset:50688
    s_waitcnt lgkmcnt(12)
    v_mfma_f32_16x16x32_bf16 v[88:91], v[168:171], v[144:147], v[88:91]
    ds_read_b64_tr_b16 v[200:201], v126 offset:49152
    v_mfma_f32_16x16x32_bf16 v[100:103], v[168:171], v[52:55], v[100:103]
    ds_read_b64_tr_b16 v[202:203], v127 offset:50688
    s_waitcnt lgkmcnt(12)
    v_mfma_f32_16x16x32_bf16 v[92:95], v[192:195], v[144:147], v[92:95]
    ds_read_b64_tr_b16 v[224:225], v128 offset:49152
    v_mfma_f32_16x16x32_bf16 v[104:107], v[192:195], v[52:55], v[104:107]
    ds_read_b64_tr_b16 v[226:227], v129 offset:50688
    s_waitcnt lgkmcnt(12)
    v_mfma_f32_16x16x32_bf16 v[96:99], v[216:219], v[144:147], v[96:99]
    ds_read_b64_tr_b16 v[180:181], v124 offset:61440
    v_mfma_f32_16x16x32_bf16 v[108:111], v[216:219], v[52:55], v[108:111]
    ds_read_b64_tr_b16 v[182:183], v125 offset:62976
    s_waitcnt lgkmcnt(12)
    v_mfma_f32_16x16x32_bf16 v[88:91], v[172:175], v[148:151], v[88:91]
    ds_read_b64_tr_b16 v[204:205], v126 offset:61440
    v_mfma_f32_16x16x32_bf16 v[100:103], v[172:175], v[52:55], v[100:103]
    ds_read_b64_tr_b16 v[206:207], v127 offset:62976
    s_waitcnt lgkmcnt(12)
    v_mfma_f32_16x16x32_bf16 v[92:95], v[196:199], v[148:151], v[92:95]
    ds_read_b64_tr_b16 v[228:229], v128 offset:61440
    v_mfma_f32_16x16x32_bf16 v[104:107], v[196:199], v[52:55], v[104:107]
    ds_read_b64_tr_b16 v[230:231], v129 offset:62976
    s_waitcnt lgkmcnt(12)
    v_mfma_f32_16x16x32_bf16 v[96:99], v[220:223], v[148:151], v[96:99]
    v_fma_f32 v5, -v116, v116, v120
    v_mfma_f32_16x16x32_bf16 v[108:111], v[220:223], v[52:55], v[108:111]
    v_max_f32 v5, v5, v56
    s_waitcnt lgkmcnt(10)
    v_mfma_f32_16x16x32_bf16 v[88:91], v[176:179], v[152:155], v[88:91]
    v_rsq_f32 v5, v5
    v_mfma_f32_16x16x32_bf16 v[100:103], v[176:179], v[52:55], v[100:103]
    v_mov_b32 v122, s39
    s_waitcnt lgkmcnt(8)
    v_mfma_f32_16x16x32_bf16 v[92:95], v[200:203], v[152:155], v[92:95]
    v_mul_f32 v5, v60, v5
    v_mfma_f32_16x16x32_bf16 v[104:107], v[200:203], v[52:55], v[104:107]
    v_mov_b32 v123, s39
    s_waitcnt lgkmcnt(6)
    v_mfma_f32_16x16x32_bf16 v[96:99], v[224:227], v[152:155], v[96:99]
    v_mfma_f32_16x16x32_bf16 v[108:111], v[224:227], v[52:55], v[108:111]
    s_waitcnt lgkmcnt(4)
    v_mfma_f32_16x16x32_bf16 v[88:91], v[180:183], v[156:159], v[88:91]
    v_mfma_f32_16x16x32_bf16 v[100:103], v[180:183], v[52:55], v[100:103]
    s_waitcnt lgkmcnt(2)
    v_mfma_f32_16x16x32_bf16 v[92:95], v[204:207], v[156:159], v[92:95]
    v_mfma_f32_16x16x32_bf16 v[104:107], v[204:207], v[52:55], v[104:107]
    s_waitcnt lgkmcnt(0)
    v_mfma_f32_16x16x32_bf16 v[96:99], v[228:231], v[156:159], v[96:99]
    v_mfma_f32_16x16x32_bf16 v[108:111], v[228:231], v[52:55], v[108:111]
    s_nop 1
    v_fma_f32 v88, -v6, v100, v88
    v_fma_f32 v89, -v6, v101, v89
    v_fma_f32 v90, -v6, v102, v90
    v_fma_f32 v91, -v6, v103, v91
    v_mul_f32 v88, v88, v5
    v_mul_f32 v89, v89, v5
    v_mul_f32 v90, v90, v5
    v_mul_f32 v91, v91, v5
    v_cvt_pk_bf16_f32 v112, v88, v89
    v_cvt_pk_bf16_f32 v113, v90, v91
    ds_write_b64 v134, v[112:113] offset:0
    v_fma_f32 v92, -v6, v104, v92
    v_fma_f32 v93, -v6, v105, v93
    v_fma_f32 v94, -v6, v106, v94
    v_fma_f32 v95, -v6, v107, v95
    v_mul_f32 v92, v92, v5
    v_mul_f32 v93, v93, v5
    v_mul_f32 v94, v94, v5
    v_mul_f32 v95, v95, v5
    v_cvt_pk_bf16_f32 v114, v92, v93
    v_cvt_pk_bf16_f32 v115, v94, v95
    ds_write_b64 v134, v[114:115] offset:512
    v_fma_f32 v96, -v6, v108, v96
    v_fma_f32 v97, -v6, v109, v97
    v_fma_f32 v98, -v6, v110, v98
    v_fma_f32 v99, -v6, v111, v99
    v_mul_f32 v96, v96, v5
    v_mul_f32 v97, v97, v5
    v_mul_f32 v98, v98, v5
    v_mul_f32 v99, v99, v5
    v_cvt_pk_bf16_f32 v116, v96, v97
    v_cvt_pk_bf16_f32 v117, v98, v99
    ds_write_b64 v134, v[116:117] offset:1024
    s_waitcnt vmcnt(9)
    s_waitcnt lgkmcnt(0)
    s_barrier
    ds_read_b128 v[136:139], v135 offset:0
    ds_read_b128 a[96:99], v130 offset:0
    ds_read_b128 v[140:143], v135 offset:1024
    ds_read_b128 a[100:103], v131 offset:0
    ds_read_b128 v[144:147], v135 offset:2048
    ds_read_b128 a[104:107], v130 offset:128
    ds_read_b128 v[148:151], v135 offset:3072
    ds_read_b128 a[108:111], v131 offset:128
    ds_read_b128 v[152:155], v135 offset:4096
    ds_read_b128 a[112:115], v130 offset:256
    ds_read_b128 v[156:159], v135 offset:5120
    ds_read_b128 a[116:119], v131 offset:256
    s_waitcnt lgkmcnt(10)
    v_mfma_f32_16x16x32_bf16 v[88:91], a[96:99], v[136:139], 0
    s_waitcnt lgkmcnt(8)
    v_mfma_f32_16x16x32_bf16 v[92:95], a[100:103], v[140:143], 0
    s_waitcnt lgkmcnt(6)
    v_mfma_f32_16x16x32_bf16 v[88:91], a[104:107], v[144:147], v[88:91]
    s_waitcnt lgkmcnt(4)
    v_mfma_f32_16x16x32_bf16 v[92:95], a[108:111], v[148:151], v[92:95]
    s_waitcnt lgkmcnt(2)
    v_mfma_f32_16x16x32_bf16 v[88:91], a[112:115], v[152:155], v[88:91]
    s_waitcnt lgkmcnt(0)
    v_mfma_f32_16x16x32_bf16 v[92:95], a[116:119], v[156:159], v[92:95]
    s_nop 7
    v_add_f32 v88, v88, v92
    v_add_f32 v89, v89, v93
    v_add_f32 v90, v90, v94
    v_add_f32 v91, v91, v95
    v_mul_f32 v88, 0x419fecaf, v88
    v_mul_f32 v89, 0x419fecaf, v89
    v_mul_f32 v90, 0x419fecaf, v90
    v_mul_f32 v91, 0x419fecaf, v91
    v_cvt_pk_bf16_f32 v120, v88, v89
    v_cvt_pk_bf16_f32 v121, v90, v91
    buffer_store_dwordx4 v[120:123], v65, s[32:35], s61 offen sc1
    buffer_load_dwordx4 v25, s[24:27], s58 offen offset:3072 nt lds
    s_add_u32 m0, s41, 4096
    s_nop 0
    buffer_load_dwordx4 v26, s[24:27], s58 offen offset:0 nt lds
    buffer_load_dwordx4 v27, s[24:27], s58 offen offset:1024 nt lds
    s_barrier
    buffer_load_dwordx4 v28, s[24:27], s58 offen offset:2048 nt lds
    buffer_load_dwordx4 v29, s[24:27], s58 offen offset:3072 nt lds
    s_add_u32 m0, s41, 8192
    s_nop 0
    buffer_load_dwordx4 v30, s[24:27], s58 offen offset:0 nt lds
    buffer_load_dwordx4 v31, s[24:27], s58 offen offset:1024 nt lds
    buffer_load_dwordx4 v32, s[24:27], s58 offen offset:2048 nt lds
    buffer_load_dwordx4 v33, s[24:27], s58 offen offset:3072 nt lds
    v_and_b32 v1, 15, v0
    v_lshrrev_b32 v6, 5, v0
    v_bfe_u32 v3, v0, 4, 1
    v_lshl_or_b32 v3, v3, 1, v6
    v_lshrrev_b32 v4, 2, v0
    v_bfe_u32 v5, v0, 1, 1
    v_lshrrev_b32 v6, 3, v1
    v_and_or_b32 v6, v1, 6, v6
    v_xor_b32 v6, v6, v3
    v_mul_u32_u24 v7, 384, v1
    v_lshl_add_u32 v6, v6, 4, v7
    v_add_u32 v34, s40, v6
    v_xor_b32 v35, 64, v34
    v_lshrrev_b32 v6, 3, v1
    v_and_b32 v7, 7, v1
    v_lshl_or_b32 v6, v7, 1, v6
    v_xor_b32 v6, v6, v3
    v_mul_u32_u24 v7, 768, v1
    v_lshl_add_u32 v6, v6, 4, v7
    v_add_u32 v40, s41, v6
    v_xor_b32 v41, 0x40, v40
    v_xor_b32 v42, 0x80, v40
    v_xor_b32 v43, 0xc0, v40
    v_and_b32 v2, 1, v0
    v_lshlrev_b32 v2, 3, v2
    s_mul_i32 s56, s3, 96
    v_lshrrev_b32 v6, 3, v4
    v_and_or_b32 v6, v4, 6, v6
    v_xor_b32 v6, v6, v5
    v_lshl_add_u32 v6, v6, 4, v2
    v_mul_u32_u24 v7, 384, v4
    s_add_u32 s57, s56, 0
    v_xad_u32 v36, v6, s57, v7
    s_add_u32 s57, s56, 32
    v_xad_u32 v37, v6, s57, v7
    s_add_u32 s57, s56, 64
    v_xad_u32 v38, v6, s57, v7
    v_lshrrev_b32 v6, 3, v4
    v_and_b32 v3, 7, v4
    v_lshl_or_b32 v6, v3, 1, v6
    v_xor_b32 v6, v6, v5
    v_lshl_add_u32 v6, v6, 4, v2
    v_lshlrev_b32 v7, 1, v7
    v_add_u32 v7, 24576, v7
    s_add_u32 s57, s56, 0
    v_xad_u32 v44, v6, s57, v7
    s_add_u32 s57, s56, 384
    v_xad_u32 v45, v6, s57, v7
    s_add_u32 s57, s56, 32
    v_xad_u32 v46, v6, s57, v7
    s_add_u32 s57, s56, 416
    v_xad_u32 v47, v6, s57, v7
    s_add_u32 s57, s56, 64
    v_xad_u32 v48, v6, s57, v7
    s_add_u32 s57, s56, 448
    v_xad_u32 v49, v6, s57, v7
    v_lshrrev_b32 v1, 5, v0
    v_lshlrev_b32 v1, 8, v1
    v_and_b32 v2, 15, v0
    v_lshl_add_u32 v1, v2, 4, v1
    v_bfe_u32 v2, v0, 4, 1
    v_lshl_add_u32 v1, v2, 3, v1
    s_mul_i32 s56, s3, 1536
    s_add_u32 s56, s56, 147456
    v_add_u32 v236, s56, v1
    s_mul_i32 s56, s3, 3072
    s_add_u32 s56, s56, 24576
    v_add_u32 v237, s56, v65
    v_add_u32 v238, s41, v65
    s_lshl_b32 s56, s3, 10
    v_add_u32 v240, 159744, v65
    v_add_u32 v239, s56, v240
    v_add_u32 v241, 147456, v65
    v_bfe_u32 v1, v0, 2, 2
    v_lshrrev_b32 v2, 4, v0
    v_lshl_or_b32 v1, v1, 4, v2
    v_mul_u32_u24 v1, 37120, v1
    v_and_b32 v2, 3, v0
    v_lshl_or_b32 v242, v2, 4, v1
    v_xor_b32 v243, 0x70, v242
    s_mul_i32 s56, s3, 3
    v_min_u32 v1, 2, v0
    v_add_u32 v1, s56, v1
    v_lshlrev_b32 v245, 7, v1
    v_lshlrev_b32 v1, 3, v0
    v_add_u32 v254, 126976, v1
    s_lshl_b32 s56, s3, 9
    v_add_u32 v238, s56, v254
    v_add_u32 v253, 122880, v65
    s_lshl_b32 s56, s3, 10
    v_add_u32 v237, s56, v253
    s_mov_b32 s52, 0x41c00000
    s_add_u32 m0, s42, 0
    s_add_u32 s59, s37, 196608
    buffer_load_dwordx4 v22, s[24:27], s59 offen offset:0 nt lds
    buffer_load_dwordx4 v23, s[24:27], s59 offen offset:1024 nt lds
    buffer_load_dwordx4 v24, s[24:27], s59 offen offset:2048 nt lds
    buffer_load_dwordx4 v25, s[24:27], s59 offen offset:3072 nt lds
    s_add_u32 m0, s42, 4096
    s_nop 0
    buffer_load_dwordx4 v26, s[24:27], s59 offen offset:0 nt lds
    buffer_load_dwordx4 v27, s[24:27], s59 offen offset:1024 nt lds
    buffer_load_dwordx4 v28, s[24:27], s59 offen offset:2048 nt lds
    buffer_load_dwordx4 v29, s[24:27], s59 offen offset:3072 nt lds
    s_add_u32 m0, s42, 8192
    s_nop 0
    buffer_load_dwordx4 v30, s[24:27], s59 offen offset:0 nt lds
    buffer_load_dwordx4 v31, s[24:27], s59 offen offset:1024 nt lds
    buffer_load_dwordx4 v32, s[24:27], s59 offen offset:2048 nt lds
    buffer_load_dwordx4 v33, s[24:27], s59 offen offset:3072 nt lds
    s_mov_b32 s43, -1
    s_branch L_join
L_vprod:
    s_mul_i32 s60, s3, 18432
    s_add_u32 m0, s60, 73728
    s_nop 0
    buffer_load_dwordx4 v16, s[64:67], s60 offen offset:0  lds
    buffer_load_dwordx4 v17, s[64:67], s60 offen offset:1024  lds
    buffer_load_dwordx4 v18, s[64:67], s60 offen offset:2048  lds
    buffer_load_dwordx4 v19, s[64:67], s60 offen offset:3072  lds
    s_add_u32 m0, s60, 77824
    s_nop 0
    buffer_load_dwordx4 v20, s[64:67], s60 offen offset:0  lds
    buffer_load_dwordx4 v21, s[64:67], s60 offen offset:1024  lds
    s_add_u32 s60, s60, 6144
    s_add_u32 m0, s60, 73728
    s_nop 0
    buffer_load_dwordx4 v16, s[64:67], s60 offen offset:0  lds
    buffer_load_dwordx4 v17, s[64:67], s60 offen offset:1024  lds
    buffer_load_dwordx4 v18, s[64:67], s60 offen offset:2048  lds
    buffer_load_dwordx4 v19, s[64:67], s60 offen offset:3072  lds
    s_add_u32 m0, s60, 77824
    s_nop 0
    buffer_load_dwordx4 v20, s[64:67], s60 offen offset:0  lds
    buffer_load_dwordx4 v21, s[64:67], s60 offen offset:1024  lds
    s_add_u32 s60, s60, 6144
    s_add_u32 m0, s60, 73728
    s_nop 0
    buffer_load_dwordx4 v16, s[64:67], s60 offen offset:0  lds
    v_lshrrev_b32 v1, 4, v0
    v_and_b32 v5, 1, v1
    v_bfe_u32 v2, v0, 2, 2
    v_lshl_add_u32 v3, v1, 3, v2
    buffer_load_dwordx4 v17, s[64:67], s60 offen offset:1024  lds
    v_mul_u32_u24 v3, 384, v3
    v_and_b32 v4, 1, v0
    v_lshl_add_u32 v3, v4, 3, v3
    v_add_u32 v3, 73728, v3
    buffer_load_dwordx4 v18, s[64:67], s60 offen offset:2048  lds
    v_and_or_b32 v2, v2, 2, v5
    v_bfe_u32 v4, v0, 1, 1
    v_xor_b32 v2, v2, v4
    s_mul_i32 s56, s3, 6
    buffer_load_dwordx4 v19, s[64:67], s60 offen offset:3072  lds
    s_add_u32 s57, s56, 0
    v_xor_b32 v4, s57, v2
    v_lshl_add_u32 v136, v4, 4, v3
    v_xor_b32 v137, 64, v136
    s_add_u32 m0, s60, 77824
    s_nop 0
    buffer_load_dwordx4 v20, s[64:67], s60 offen offset:0  lds
    s_add_u32 s57, s56, 2
    v_xor_b32 v4, s57, v2
    v_lshl_add_u32 v138, v4, 4, v3
    v_xor_b32 v139, 64, v138
    buffer_load_dwordx4 v21, s[64:67], s60 offen offset:1024  lds
    s_add_u32 s57, s56, 4
    v_xor_b32 v4, s57, v2
    v_lshl_add_u32 v140, v4, 4, v3
    v_xor_b32 v141, 64, v140
    s_lshl_b32 s61, s43, 2
    s_add_u32 s61, s61, s3
    s_mul_i32 s60, s61, 6144
    s_add_u32 m0, s41, 6144
    s_nop 0
    buffer_load_dwordx4 v16, s[68:71], s60 offen offset:0  lds
    v_bfe_u32 v1, v0, 2, 1
    v_and_b32 v2, 3, v0
    v_lshl_or_b32 v2, v1, 3, v2
    v_and_or_b32 v1, v0, 2, v1
    buffer_load_dwordx4 v17, s[68:71], s60 offen offset:1024  lds
    v_lshrrev_b32 v3, 4, v0
    v_xor_b32 v1, v1, v3
    v_mul_u32_u24 v2, 384, v2
    v_lshl_add_u32 v1, v1, 4, v2
    buffer_load_dwordx4 v18, s[68:71], s60 offen offset:2048  lds
    v_bfe_u32 v2, v0, 3, 1
    v_mul_u32_u24 v2, 12288, v2
    s_mov_b32 s56, 30720
    v_add3_u32 v142, s56, v1, v2
    buffer_load_dwordx4 v19, s[68:71], s60 offen offset:3072  lds
    v_xor_b32 v143, 64, v142
    s_add_u32 m0, s41, 10240
    s_nop 0
    buffer_load_dwordx4 v20, s[68:71], s60 offen offset:0  lds
    buffer_load_dwordx4 v21, s[68:71], s60 offen offset:1024  lds
    s_load_dword s38, s[22:23], 0
    s_barrier
    s_add_u32 m0, s40, 0
    s_add_u32 s57, s36, 0
    buffer_load_dwordx4 v16, s[28:31], s57 offen offset:0 nt lds
    buffer_load_dwordx4 v17, s[28:31], s57 offen offset:1024 nt lds
    buffer_load_dwordx4 v18, s[28:31], s57 offen offset:2048 nt lds
    buffer_load_dwordx4 v19, s[28:31], s57 offen offset:3072 nt lds
    s_add_u32 m0, s40, 4096
    s_nop 0
    buffer_load_dwordx4 v20, s[28:31], s57 offen offset:0 nt lds
    buffer_load_dwordx4 v21, s[28:31], s57 offen offset:1024 nt lds
    s_add_u32 m0, s41, 0
    s_add_u32 s58, s37, 0
    buffer_load_dwordx4 v22, s[24:27], s58 offen offset:0 nt lds
    buffer_load_dwordx4 v23, s[24:27], s58 offen offset:1024 nt lds
    buffer_load_dwordx4 v24, s[24:27], s58 offen offset:2048 nt lds
    s_waitcnt vmcnt(9)
    s_barrier
    ds_read_b128 a[96:99], v142 offset:0
    ds_read_b128 a[100:103], v143 offset:0
    ds_read_b128 a[104:107], v142 offset:128
    ds_read_b128 a[108:111], v143 offset:128
    ds_read_b128 a[112:115], v142 offset:256
    ds_read_b128 a[116:119], v143 offset:256
    ds_read_b128 a[120:123], v143 offset:1536
    ds_read_b128 a[124:127], v142 offset:1536
    ds_read_b128 a[128:131], v143 offset:1664
    ds_read_b128 a[132:135], v142 offset:1664
    ds_read_b128 a[136:139], v143 offset:1792
    ds_read_b128 a[140:143], v142 offset:1792
    ds_read_b128 a[144:147], v142 offset:24576
    ds_read_b128 a[148:151], v143 offset:24576
    ds_read_b128 a[152:155], v142 offset:24704
    ds_read_b128 a[156:159], v143 offset:24704
    ds_read_b128 a[160:163], v142 offset:24832
    ds_read_b128 a[164:167], v143 offset:24832
    ds_read_b128 a[168:171], v143 offset:26112
    ds_read_b128 a[172:175], v142 offset:26112
    ds_read_b128 a[176:179], v143 offset:26240
    ds_read_b128 a[180:183], v142 offset:26240
    ds_read_b128 a[184:187], v143 offset:26368
    ds_read_b128 a[188:191], v142 offset:26368
    ds_read_b64_tr_b16 v[160:161], v136 offset:0
    ds_read_b64_tr_b16 v[162:163], v137 offset:1536
    ds_read_b64_tr_b16 v[164:165], v136 offset:12288
    ds_read_b64_tr_b16 v[166:167], v137 offset:13824
    ds_read_b64_tr_b16 v[168:169], v136 offset:24576
    ds_read_b64_tr_b16 v[170:171], v137 offset:26112
    ds_read_b64_tr_b16 v[172:173], v136 offset:36864
    ds_read_b64_tr_b16 v[174:175], v137 offset:38400
    ds_read_b64_tr_b16 v[176:177], v136 offset:49152
    ds_read_b64_tr_b16 v[178:179], v137 offset:50688
    ds_read_b64_tr_b16 v[180:181], v136 offset:61440
    ds_read_b64_tr_b16 v[182:183], v137 offset:62976
    ds_read_b64_tr_b16 v[184:185], v138 offset:0
    ds_read_b64_tr_b16 v[186:187], v139 offset:1536
    ds_read_b64_tr_b16 v[188:189], v138 offset:12288
    ds_read_b64_tr_b16 v[190:191], v139 offset:13824
    ds_read_b64_tr_b16 v[192:193], v138 offset:24576
    ds_read_b64_tr_b16 v[194:195], v139 offset:26112
    ds_read_b64_tr_b16 v[196:197], v138 offset:36864
    ds_read_b64_tr_b16 v[198:199], v139 offset:38400
    ds_read_b64_tr_b16 v[200:201], v138 offset:49152
    ds_read_b64_tr_b16 v[202:203], v139 offset:50688
    ds_read_b64_tr_b16 v[204:205], v138 offset:61440
    ds_read_b64_tr_b16 v[206:207], v139 offset:62976
    ds_read_b64_tr_b16 v[208:209], v140 offset:0
    ds_read_b64_tr_b16 v[210:211], v141 offset:1536
    ds_read_b64_tr_b16 v[212:213], v140 offset:12288
    ds_read_b64_tr_b16 v[214:215], v141 offset:13824
    ds_read_b64_tr_b16 v[216:217], v140 offset:24576
    ds_read_b64_tr_b16 v[218:219], v141 offset:26112
    ds_read_b64_tr_b16 v[220:221], v140 offset:36864
    ds_read_b64_tr_b16 v[222:223], v141 offset:38400
    ds_read_b64_tr_b16 v[224:225], v140 offset:49152
    ds_read_b64_tr_b16 v[226:227], v141 offset:50688
    ds_read_b64_tr_b16 v[228:229], v140 offset:61440
    ds_read_b64_tr_b16 v[230:231], v141 offset:62976
    s_waitcnt lgkmcnt(0)
    s_barrier
    s_mul_i32 s60, s3, 18432
    s_lshl_b32 s61, s43, 11
    s_add_u32 s60, s60, s61
    s_add_u32 s60, s60, 3145728
    v_mfma_f32_16x16x32_bf16 v[88:91], a[96:99], v[160:163], 0
    v_mfma_f32_16x16x32_bf16 v[92:95], a[120:123], v[160:163], 0
    v_mfma_f32_16x16x32_bf16 v[96:99], a[144:147], v[160:163], 0
    v_mfma_f32_16x16x32_bf16 v[100:103], a[168:171], v[160:163], 0
    buffer_load_dwordx4 v25, s[24:27], s58 offen offset:3072 nt lds
    v_mfma_f32_16x16x32_bf16 v[88:91], a[100:103], v[164:167], v[88:91]
    v_mfma_f32_16x16x32_bf16 v[92:95], a[124:127], v[164:167], v[92:95]
    v_mfma_f32_16x16x32_bf16 v[96:99], a[148:151], v[164:167], v[96:99]
    v_mfma_f32_16x16x32_bf16 v[100:103], a[172:175], v[164:167], v[100:103]
    s_add_u32 m0, s41, 4096
    s_nop 0
    buffer_load_dwordx4 v26, s[24:27], s58 offen offset:0 nt lds
    v_mfma_f32_16x16x32_bf16 v[88:91], a[104:107], v[168:171], v[88:91]
    v_mfma_f32_16x16x32_bf16 v[92:95], a[128:131], v[168:171], v[92:95]
    v_mfma_f32_16x16x32_bf16 v[96:99], a[152:155], v[168:171], v[96:99]
    v_mfma_f32_16x16x32_bf16 v[100:103], a[176:179], v[168:171], v[100:103]
    buffer_load_dwordx4 v27, s[24:27], s58 offen offset:1024 nt lds
    v_mfma_f32_16x16x32_bf16 v[88:91], a[108:111], v[172:175], v[88:91]
    v_mfma_f32_16x16x32_bf16 v[92:95], a[132:135], v[172:175], v[92:95]
    v_mfma_f32_16x16x32_bf16 v[96:99], a[156:159], v[172:175], v[96:99]
    v_mfma_f32_16x16x32_bf16 v[100:103], a[180:183], v[172:175], v[100:103]
    buffer_load_dwordx4 v28, s[24:27], s58 offen offset:2048 nt lds
    v_mfma_f32_16x16x32_bf16 v[88:91], a[112:115], v[176:179], v[88:91]
    v_mfma_f32_16x16x32_bf16 v[92:95], a[136:139], v[176:179], v[92:95]
    v_mfma_f32_16x16x32_bf16 v[96:99], a[160:163], v[176:179], v[96:99]
    v_mfma_f32_16x16x32_bf16 v[100:103], a[184:187], v[176:179], v[100:103]
    buffer_load_dwordx4 v29, s[24:27], s58 offen offset:3072 nt lds
    v_mfma_f32_16x16x32_bf16 v[88:91], a[116:119], v[180:183], v[88:91]
    v_mfma_f32_16x16x32_bf16 v[92:95], a[140:143], v[180:183], v[92:95]
    v_mfma_f32_16x16x32_bf16 v[96:99], a[164:167], v[180:183], v[96:99]
    v_mfma_f32_16x16x32_bf16 v[100:103], a[188:191], v[180:183], v[100:103]
    v_mfma_f32_16x16x32_bf16 v[104:107], a[96:99], v[184:187], 0
    v_mfma_f32_16x16x32_bf16 v[108:111], a[120:123], v[184:187], 0
    v_mfma_f32_16x16x32_bf16 v[112:115], a[144:147], v[184:187], 0
    v_mfma_f32_16x16x32_bf16 v[116:119], a[168:171], v[184:187], 0
    s_add_u32 m0, s41, 8192
    s_nop 0
    buffer_load_dwordx4 v30, s[24:27], s58 offen offset:0 nt lds
    v_mfma_f32_16x16x32_bf16 v[104:107], a[100:103], v[188:191], v[104:107]
    v_mfma_f32_16x16x32_bf16 v[108:111], a[124:127], v[188:191], v[108:111]
    v_mfma_f32_16x16x32_bf16 v[112:115], a[148:151], v[188:191], v[112:115]
    v_mfma_f32_16x16x32_bf16 v[116:119], a[172:175], v[188:191], v[116:119]
    buffer_load_dwordx4 v31, s[24:27], s58 offen offset:1024 nt lds
    v_mfma_f32_16x16x32_bf16 v[104:107], a[104:107], v[192:195], v[104:107]
    v_mfma_f32_16x16x32_bf16 v[108:111], a[128:131], v[192:195], v[108:111]
    v_mfma_f32_16x16x32_bf16 v[112:115], a[152:155], v[192:195], v[112:115]
    v_mfma_f32_16x16x32_bf16 v[116:119], a[176:179], v[192:195], v[116:119]
    buffer_load_dwordx4 v32, s[24:27], s58 offen offset:2048 nt lds
    v_cvt_pk_bf16_f32 v144, v88, v89
    v_cvt_pk_bf16_f32 v145, v90, v91
    v_cvt_pk_bf16_f32 v146, v92, v93
    v_cvt_pk_bf16_f32 v147, v94, v95
    buffer_store_dwordx4 v[144:147], v65, s[32:35], s60 offen offset:0 sc1
    v_cvt_pk_bf16_f32 v148, v96, v97
    v_cvt_pk_bf16_f32 v149, v98, v99
    v_cvt_pk_bf16_f32 v150, v100, v101
    v_cvt_pk_bf16_f32 v151, v102, v103
    buffer_store_dwordx4 v[148:151], v65, s[32:35], s60 offen offset:1024 sc1
    s_add_u32 s60, s60, 6144
    v_mfma_f32_16x16x32_bf16 v[104:107], a[108:111], v[196:199], v[104:107]
    v_mfma_f32_16x16x32_bf16 v[108:111], a[132:135], v[196:199], v[108:111]
    v_mfma_f32_16x16x32_bf16 v[112:115], a[156:159], v[196:199], v[112:115]
    v_mfma_f32_16x16x32_bf16 v[116:119], a[180:183], v[196:199], v[116:119]
    buffer_load_dwordx4 v33, s[24:27], s58 offen offset:3072 nt lds
    v_mfma_f32_16x16x32_bf16 v[104:107], a[112:115], v[200:203], v[104:107]
    v_mfma_f32_16x16x32_bf16 v[108:111], a[136:139], v[200:203], v[108:111]
    v_mfma_f32_16x16x32_bf16 v[112:115], a[160:163], v[200:203], v[112:115]
    v_mfma_f32_16x16x32_bf16 v[116:119], a[184:187], v[200:203], v[116:119]
    s_add_u32 m0, s42, 0
    s_add_u32 s59, s37, 196608
    buffer_load_dwordx4 v22, s[24:27], s59 offen offset:0 nt lds
    v_mfma_f32_16x16x32_bf16 v[104:107], a[116:119], v[204:207], v[104:107]
    v_mfma_f32_16x16x32_bf16 v[108:111], a[140:143], v[204:207], v[108:111]
    v_mfma_f32_16x16x32_bf16 v[112:115], a[164:167], v[204:207], v[112:115]
    v_mfma_f32_16x16x32_bf16 v[116:119], a[188:191], v[204:207], v[116:119]
    v_mfma_f32_16x16x32_bf16 v[120:123], a[96:99], v[208:211], 0
    v_mfma_f32_16x16x32_bf16 v[124:127], a[120:123], v[208:211], 0
    v_mfma_f32_16x16x32_bf16 v[128:131], a[144:147], v[208:211], 0
    v_mfma_f32_16x16x32_bf16 v[132:135], a[168:171], v[208:211], 0
    buffer_load_dwordx4 v23, s[24:27], s59 offen offset:1024 nt lds
    v_mfma_f32_16x16x32_bf16 v[120:123], a[100:103], v[212:215], v[120:123]
    v_mfma_f32_16x16x32_bf16 v[124:127], a[124:127], v[212:215], v[124:127]
    v_mfma_f32_16x16x32_bf16 v[128:131], a[148:151], v[212:215], v[128:131]
    v_mfma_f32_16x16x32_bf16 v[132:135], a[172:175], v[212:215], v[132:135]
    buffer_load_dwordx4 v24, s[24:27], s59 offen offset:2048 nt lds
    v_mfma_f32_16x16x32_bf16 v[120:123], a[104:107], v[216:219], v[120:123]
    v_mfma_f32_16x16x32_bf16 v[124:127], a[128:131], v[216:219], v[124:127]
    v_mfma_f32_16x16x32_bf16 v[128:131], a[152:155], v[216:219], v[128:131]
    v_mfma_f32_16x16x32_bf16 v[132:135], a[176:179], v[216:219], v[132:135]
    buffer_load_dwordx4 v25, s[24:27], s59 offen offset:3072 nt lds
    v_cvt_pk_bf16_f32 v152, v104, v105
    v_cvt_pk_bf16_f32 v153, v106, v107
    v_cvt_pk_bf16_f32 v154, v108, v109
    v_cvt_pk_bf16_f32 v155, v110, v111
    buffer_store_dwordx4 v[152:155], v65, s[32:35], s60 offen offset:0 sc1
    v_cvt_pk_bf16_f32 v156, v112, v113
    v_cvt_pk_bf16_f32 v157, v114, v115
    v_cvt_pk_bf16_f32 v158, v116, v117
    v_cvt_pk_bf16_f32 v159, v118, v119
    buffer_store_dwordx4 v[156:159], v65, s[32:35], s60 offen offset:1024 sc1
    s_add_u32 s60, s60, 6144
    v_mfma_f32_16x16x32_bf16 v[120:123], a[108:111], v[220:223], v[120:123]
    v_mfma_f32_16x16x32_bf16 v[124:127], a[132:135], v[220:223], v[124:127]
    v_mfma_f32_16x16x32_bf16 v[128:131], a[156:159], v[220:223], v[128:131]
    v_mfma_f32_16x16x32_bf16 v[132:135], a[180:183], v[220:223], v[132:135]
    s_add_u32 m0, s42, 4096
    s_nop 0
    buffer_load_dwordx4 v26, s[24:27], s59 offen offset:0 nt lds
    v_mfma_f32_16x16x32_bf16 v[120:123], a[112:115], v[224:227], v[120:123]
    v_mfma_f32_16x16x32_bf16 v[124:127], a[136:139], v[224:227], v[124:127]
    v_mfma_f32_16x16x32_bf16 v[128:131], a[160:163], v[224:227], v[128:131]
    v_mfma_f32_16x16x32_bf16 v[132:135], a[184:187], v[224:227], v[132:135]
    buffer_load_dwordx4 v27, s[24:27], s59 offen offset:1024 nt lds
    v_mfma_f32_16x16x32_bf16 v[120:123], a[116:119], v[228:231], v[120:123]
    v_mfma_f32_16x16x32_bf16 v[124:127], a[140:143], v[228:231], v[124:127]
    v_mfma_f32_16x16x32_bf16 v[128:131], a[164:167], v[228:231], v[128:131]
    v_mfma_f32_16x16x32_bf16 v[132:135], a[188:191], v[228:231], v[132:135]
    s_nop 4
    v_cvt_pk_bf16_f32 v144, v120, v121
    v_cvt_pk_bf16_f32 v145, v122, v123
    v_cvt_pk_bf16_f32 v146, v124, v125
    v_cvt_pk_bf16_f32 v147, v126, v127
    buffer_store_dwordx4 v[144:147], v65, s[32:35], s60 offen offset:0 sc1
    v_cvt_pk_bf16_f32 v148, v128, v129
    v_cvt_pk_bf16_f32 v149, v130, v131
    v_cvt_pk_bf16_f32 v150, v132, v133
    v_cvt_pk_bf16_f32 v151, v134, v135
    buffer_store_dwordx4 v[148:151], v65, s[32:35], s60 offen offset:1024 sc1
    v_and_b32 v1, 15, v0
    v_lshrrev_b32 v6, 5, v0
    v_bfe_u32 v3, v0, 4, 1
    v_lshl_or_b32 v3, v3, 1, v6
    v_lshrrev_b32 v4, 2, v0
    v_bfe_u32 v5, v0, 1, 1
    v_lshrrev_b32 v6, 3, v1
    v_and_or_b32 v6, v1, 6, v6
    v_xor_b32 v6, v6, v3
    v_mul_u32_u24 v7, 384, v1
    v_lshl_add_u32 v6, v6, 4, v7
    v_add_u32 v34, s40, v6
    v_xor_b32 v35, 64, v34
    v_lshrrev_b32 v6, 3, v1
    v_and_b32 v7, 7, v1
    v_lshl_or_b32 v6, v7, 1, v6
    v_xor_b32 v6, v6, v3
    v_mul_u32_u24 v7, 768, v1
    v_lshl_add_u32 v6, v6, 4, v7
    v_add_u32 v40, s41, v6
    v_xor_b32 v41, 0x40, v40
    v_xor_b32 v42, 0x80, v40
    v_xor_b32 v43, 0xc0, v40
    v_and_b32 v2, 1, v0
    v_lshlrev_b32 v2, 3, v2
    s_mul_i32 s56, s3, 96
    v_lshrrev_b32 v6, 3, v4
    v_and_or_b32 v6, v4, 6, v6
    v_xor_b32 v6, v6, v5
    v_lshl_add_u32 v6, v6, 4, v2
    v_mul_u32_u24 v7, 384, v4
    s_add_u32 s57, s56, 0
    v_xad_u32 v36, v6, s57, v7
    s_add_u32 s57, s56, 32
    v_xad_u32 v37, v6, s57, v7
    s_add_u32 s57, s56, 64
    v_xad_u32 v38, v6, s57, v7
    v_lshrrev_b32 v6, 3, v4
    v_and_b32 v3, 7, v4
    v_lshl_or_b32 v6, v3, 1, v6
    v_xor_b32 v6, v6, v5
    v_lshl_add_u32 v6, v6, 4, v2
    v_lshlrev_b32 v7, 1, v7
    v_add_u32 v7, 24576, v7
    s_add_u32 s57, s56, 0
    v_xad_u32 v44, v6, s57, v7
    s_add_u32 s57, s56, 384
    v_xad_u32 v45, v6, s57, v7
    s_add_u32 s57, s56, 32
    v_xad_u32 v46, v6, s57, v7
    s_add_u32 s57, s56, 416
    v_xad_u32 v47, v6, s57, v7
    s_add_u32 s57, s56, 64
    v_xad_u32 v48, v6, s57, v7
    s_add_u32 s57, s56, 448
    v_xad_u32 v49, v6, s57, v7
    v_mov_b32 v52, 0x3f803f80
    v_mov_b32 v56, 0x3ebcbe62
    s_mov_b32 s44, 0x100001
    s_mov_b32 s45, 0x10000100
    v_mov_b32 v53, 0x3f803f80
    v_mov_b32 v57, 0x3ebcbe62
    s_mov_b32 s46, 0x200002
    s_mov_b32 s47, 0x20000200
    v_mov_b32 v54, 0x3f803f80
    v_mov_b32 v58, 0x3ebcbe62
    s_mov_b32 s48, 0x400004
    s_mov_b32 s49, 0x40000400
    v_mov_b32 v55, 0x3f803f80
    v_mov_b32 v59, 0x3ebcbe62
    s_mov_b32 s50, 0x800008
    s_mov_b32 s51, 0x80000800
    v_mov_b32 v60, 0x43400000
    v_lshrrev_b32 v1, 5, v0
    v_lshlrev_b32 v1, 8, v1
    v_and_b32 v2, 15, v0
    v_lshl_add_u32 v1, v2, 4, v1
    v_bfe_u32 v2, v0, 4, 1
    v_lshl_add_u32 v1, v2, 3, v1
    s_mul_i32 s56, s3, 1536
    s_add_u32 s56, s56, 147456
    v_add_u32 v236, s56, v1
    s_mul_i32 s56, s3, 3072
    s_add_u32 s56, s56, 24576
    v_add_u32 v237, s56, v65
    v_add_u32 v238, s41, v65
    s_lshl_b32 s56, s3, 10
    v_add_u32 v240, 159744, v65
    v_add_u32 v239, s56, v240
    v_add_u32 v241, 147456, v65
    v_bfe_u32 v1, v0, 2, 2
    v_lshrrev_b32 v2, 4, v0
    v_lshl_or_b32 v1, v1, 4, v2
    v_mul_u32_u24 v1, 37120, v1
    v_and_b32 v2, 3, v0
    v_lshl_or_b32 v242, v2, 4, v1
    v_xor_b32 v243, 0x70, v242
    s_mul_i32 s56, s3, 3
    v_min_u32 v1, 2, v0
    v_add_u32 v1, s56, v1
    v_lshlrev_b32 v245, 7, v1
    v_lshlrev_b32 v1, 3, v0
    v_add_u32 v254, 126976, v1
    s_lshl_b32 s56, s3, 9
    v_add_u32 v238, s56, v254
    v_add_u32 v253, 122880, v65
    s_lshl_b32 s56, s3, 10
    v_add_u32 v237, s56, v253
    s_mov_b32 s52, 0x41c00000
    buffer_load_dwordx4 v28, s[24:27], s59 offen offset:2048 nt lds
    buffer_load_dwordx4 v29, s[24:27], s59 offen offset:3072 nt lds
    s_add_u32 m0, s42, 8192
    s_nop 0
    buffer_load_dwordx4 v30, s[24:27], s59 offen offset:0 nt lds
    buffer_load_dwordx4 v31, s[24:27], s59 offen offset:1024 nt lds
    buffer_load_dwordx4 v32, s[24:27], s59 offen offset:2048 nt lds
    buffer_load_dwordx4 v33, s[24:27], s59 offen offset:3072 nt lds
    s_branch L_join
L_xt3:
    s_call_b64 s[54:55], L_xslow
    s_branch L_post3
L_xt24:
    s_call_b64 s[54:55], L_xslow
    s_branch L_post24
L_xt6:
    s_call_b64 s[54:55], L_xslow
    s_branch L_post6
L_xt27:
    s_call_b64 s[54:55], L_xslow
    s_branch L_post27
L_xt9:
    s_call_b64 s[54:55], L_xslow
    s_branch L_post9
L_xt11:
    s_call_b64 s[54:55], L_xalt
    s_branch L_post11
L_xslow:
    s_waitcnt lgkmcnt(0)
    ds_write_b32 v239, v62
    s_waitcnt lgkmcnt(0)
    s_barrier
    ds_read_b32 v12, v240 offset:0
    ds_read_b32 v13, v240 offset:1024
    ds_read_b32 v14, v240 offset:2048
    ds_read_b32 v15, v240 offset:3072
    v_mov_b32 v9, 0
    ds_write_b32 v254, v9 offset:4096
    s_waitcnt lgkmcnt(0)
    v_min3_f32 v1, v12, v13, v14
    v_min_f32 v1, v1, v15
    v_sub_f32 v2, v1, v255
    v_sub_f32 v12, v1, v62
    v_exp_f32 v2, v2
    v_exp_f32 v12, v12
    v_mov_b32 v62, v1
    v_mov_b32 v255, v1
    v_mul_f32 v88, v88, v12
    v_mul_f32 v89, v89, v12
    v_mul_f32 v90, v90, v12
    v_mul_f32 v91, v91, v12
    v_mul_f32 v104, v104, v12
    v_mul_f32 v105, v105, v12
    v_mul_f32 v106, v106, v12
    v_mul_f32 v107, v107, v12
    v_mul_f32 v68, v68, v12
    v_mul_f32 v69, v69, v12
    v_mul_f32 v70, v70, v12
    v_mul_f32 v71, v71, v12
    v_mul_f32 v112, v112, v12
    v_mul_f32 v113, v113, v12
    v_mul_f32 v114, v114, v12
    v_mul_f32 v115, v115, v12
    v_mul_f32 v63, v63, v12
    v_mul_f32 v64, v64, v12
    v_accvgpr_read_b32 v1, a0
    v_mul_f32 v1, v1, v2
    v_accvgpr_write_b32 a0, v1
    v_accvgpr_read_b32 v1, a1
    v_mul_f32 v1, v1, v2
    v_accvgpr_write_b32 a1, v1
    v_accvgpr_read_b32 v1, a2
    v_mul_f32 v1, v1, v2
    v_accvgpr_write_b32 a2, v1
    v_accvgpr_read_b32 v1, a3
    v_mul_f32 v1, v1, v2
    v_accvgpr_write_b32 a3, v1
    v_accvgpr_read_b32 v1, a4
    v_mul_f32 v1, v1, v2
    v_accvgpr_write_b32 a4, v1
    v_accvgpr_read_b32 v1, a5
    v_mul_f32 v1, v1, v2
    v_accvgpr_write_b32 a5, v1
    v_accvgpr_read_b32 v1, a6
    v_mul_f32 v1, v1, v2
    v_accvgpr_write_b32 a6, v1
    v_accvgpr_read_b32 v1, a7
    v_mul_f32 v1, v1, v2
    v_accvgpr_write_b32 a7, v1
    v_accvgpr_read_b32 v1, a8
    v_mul_f32 v1, v1, v2
    v_accvgpr_write_b32 a8, v1
    v_accvgpr_read_b32 v1, a9
    v_mul_f32 v1, v1, v2
    v_accvgpr_write_b32 a9, v1
    v_accvgpr_read_b32 v1, a10
    v_mul_f32 v1, v1, v2
    v_accvgpr_write_b32 a10, v1
    v_accvgpr_read_b32 v1, a11
    v_mul_f32 v1, v1, v2
    v_accvgpr_write_b32 a11, v1
    v_cvt_pk_bf16_f32 v72, v88, v89
    v_cvt_pk_bf16_f32 v73, v90, v91
    v_cvt_pk_bf16_f32 v74, v104, v105
    v_cvt_pk_bf16_f32 v75, v106, v107
    ds_write_b128 v237, v[72:75] offset:0
    v_cvt_pk_bf16_f32 v66, v68, v69
    v_cvt_pk_bf16_f32 v67, v70, v71
    ds_write_b64 v238, v[66:67]
    s_waitcnt lgkmcnt(0)
    s_barrier
    s_setpc_b64 s[54:55]
L_xlast:
    s_waitcnt lgkmcnt(0)
    ds_write_b32 v239, v62
    s_waitcnt lgkmcnt(0)
    s_barrier
    ds_read_b32 v12, v240 offset:0
    ds_read_b32 v13, v240 offset:1024
    ds_read_b32 v14, v240 offset:2048
    ds_read_b32 v15, v240 offset:3072
    v_mov_b32 v9, 0
    ds_write_b32 v254, v9 offset:4096
    s_waitcnt lgkmcnt(0)
    v_min3_f32 v1, v12, v13, v14
    v_min_f32 v1, v1, v15
    v_sub_f32 v2, v1, v255
    v_sub_f32 v12, v1, v62
    v_exp_f32 v2, v2
    v_exp_f32 v12, v12
    v_mov_b32 v62, v1
    v_mov_b32 v255, v1
    v_mul_f32 v88, v88, v12
    v_mul_f32 v89, v89, v12
    v_mul_f32 v90, v90, v12
    v_mul_f32 v91, v91, v12
    v_mul_f32 v104, v104, v12
    v_mul_f32 v105, v105, v12
    v_mul_f32 v106, v106, v12
    v_mul_f32 v107, v107, v12
    v_mul_f32 v68, v68, v12
    v_mul_f32 v69, v69, v12
    v_mul_f32 v70, v70, v12
    v_mul_f32 v71, v71, v12
    v_mul_f32 v10, v10, v12
    v_mul_f32 v11, v11, v12
    v_mul_f32 v16, v16, v2
    v_mul_f32 v17, v17, v2
    v_mul_f32 v18, v18, v2
    v_mul_f32 v19, v19, v2
    v_mul_f32 v20, v20, v2
    v_mul_f32 v21, v21, v2
    v_mul_f32 v22, v22, v2
    v_mul_f32 v23, v23, v2
    v_mul_f32 v24, v24, v2
    v_mul_f32 v25, v25, v2
    v_mul_f32 v26, v26, v2
    v_mul_f32 v27, v27, v2
    v_cvt_pk_bf16_f32 v72, v88, v89
    v_cvt_pk_bf16_f32 v73, v90, v91
    v_cvt_pk_bf16_f32 v74, v104, v105
    v_cvt_pk_bf16_f32 v75, v106, v107
    ds_write_b128 v237, v[72:75] offset:0
    v_cvt_pk_bf16_f32 v66, v68, v69
    v_cvt_pk_bf16_f32 v67, v70, v71
    ds_write_b64 v238, v[66:67]
    ds_write_b64 v238, v[10:11] offset:2048
    s_waitcnt lgkmcnt(0)
    s_barrier
    s_branch L_postx
L_xalt:
    s_waitcnt lgkmcnt(0)
    ds_write_b32 v239, v62
    s_waitcnt lgkmcnt(0)
    s_barrier
    ds_read_b32 v12, v240 offset:0
    ds_read_b32 v13, v240 offset:1024
    ds_read_b32 v14, v240 offset:2048
    ds_read_b32 v15, v240 offset:3072
    v_mov_b32 v9, 0
    ds_write_b32 v254, v9 offset:4100
    s_waitcnt lgkmcnt(0)
    v_min3_f32 v1, v12, v13, v14
    v_min_f32 v1, v1, v15
    v_sub_f32 v2, v1, v255
    v_sub_f32 v12, v1, v62
    v_exp_f32 v2, v2
    v_exp_f32 v12, v12
    v_mov_b32 v62, v1
    v_mov_b32 v255, v1
    v_mul_f32 v88, v88, v12
    v_mul_f32 v89, v89, v12
    v_mul_f32 v90, v90, v12
    v_mul_f32 v91, v91, v12
    v_mul_f32 v104, v104, v12
    v_mul_f32 v105, v105, v12
    v_mul_f32 v106, v106, v12
    v_mul_f32 v107, v107, v12
    v_mul_f32 v68, v68, v12
    v_mul_f32 v69, v69, v12
    v_mul_f32 v70, v70, v12
    v_mul_f32 v71, v71, v12
    v_mul_f32 v112, v112, v12
    v_mul_f32 v113, v113, v12
    v_mul_f32 v114, v114, v12
    v_mul_f32 v115, v115, v12
    v_mul_f32 v63, v63, v12
    v_mul_f32 v64, v64, v12
    v_mul_f32 v16, v16, v2
    v_mul_f32 v17, v17, v2
    v_mul_f32 v18, v18, v2
    v_mul_f32 v19, v19, v2
    v_mul_f32 v20, v20, v2
    v_mul_f32 v21, v21, v2
    v_mul_f32 v22, v22, v2
    v_mul_f32 v23, v23, v2
    v_mul_f32 v24, v24, v2
    v_mul_f32 v25, v25, v2
    v_mul_f32 v26, v26, v2
    v_mul_f32 v27, v27, v2
    v_cvt_pk_bf16_f32 v72, v88, v89
    v_cvt_pk_bf16_f32 v73, v90, v91
    v_cvt_pk_bf16_f32 v74, v104, v105
    v_cvt_pk_bf16_f32 v75, v106, v107
    ds_write_b128 v237, v[72:75] offset:12288
    s_waitcnt lgkmcnt(0)
    s_barrier
    s_setpc_b64 s[54:55]
L_c_slow:
    s_cmp_eq_u32 s43, 0
    s_cbranch_scc1 L_c_out
    s_mov_b32 s43, 0
    buffer_load_dwordx4 v[76:79], v65, s[32:35], s30 offen offset:0 sc1
    buffer_load_dwordx4 v[80:83], v65, s[32:35], s30 offen offset:1024 sc1
    buffer_load_dwordx4 v[84:87], v65, s[32:35], s30 offen offset:2048 sc1
    buffer_load_dwordx4 v[108:111], v65, s[32:35], s30 offen offset:3072 sc1
    buffer_load_dwordx4 v[112:115], v65, s[32:35], s31 offen offset:0 sc1
    buffer_load_dwordx4 v[128:131], v65, s[32:35], s31 offen offset:1024 sc1
    buffer_load_dwordx4 v[132:135], v65, s[32:35], s31 offen offset:2048 sc1
    buffer_load_dwordx4 v[52:55], v65, s[32:35], s31 offen offset:3072 sc1
    s_waitcnt vmcnt(0)
    v_sub_u32 v49, v79, v247
    v_max_f32 v42, v42, v49
    v_sub_u32 v49, v83, v247
    v_max_f32 v42, v42, v49
    v_sub_u32 v49, v87, v247
    v_max_f32 v42, v42, v49
    v_sub_u32 v49, v111, v247
    v_max_f32 v42, v42, v49
    v_sub_u32 v49, v115, v247
    v_max_f32 v42, v42, v49
    v_sub_u32 v49, v131, v247
    v_max_f32 v42, v42, v49
    v_sub_u32 v49, v135, v247
    v_max_f32 v42, v42, v49
    v_sub_u32 v49, v55, v247
    v_max_f32 v42, v42, v49
    s_nop 1
    v_max_f32_dpp v42, v42, v42 row_ror:8 row_mask:0xf bank_mask:0xf
    v_mov_b32 v48, v42
    s_nop 1
    v_permlane32_swap_b32 v42, v48
    v_max_f32 v42, v42, v48
    v_mov_b32 v48, v42
    s_nop 1
    v_permlane16_swap_b32 v42, v48
    v_max_f32 v42, v42, v48
    s_lshl_b32 s56, s3, 2
    v_add_u32 v48, s56, v251
    ds_write_b32 v48, v42 offset:1024
    s_waitcnt lgkmcnt(0)
    s_barrier
    ds_read_b128 v[48:51], v251 offset:1024
    v_mov_b32 v16, 0
    v_mov_b32 v17, 0
    v_mov_b32 v18, 0
    v_mov_b32 v19, 0
    v_mov_b32 v20, 0
    v_mov_b32 v21, 0
    v_mov_b32 v22, 0
    s_waitcnt lgkmcnt(0)
    v_max3_f32 v42, v48, v49, v50
    v_max_f32 v42, v42, v51
    v_sub_u32 v49, v79, v247
    v_sub_f32 v49, v49, v42
    v_exp_f32 v49, v49
    s_nop 0
    v_cvt_pk_bf16_f32 v49, v49, 0
    v_lshlrev_b32 v50, 16, v49
    v_dot2_f32_bf16 v16, v76, v49, v16
    v_dot2_f32_bf16 v18, v77, v49, v18
    v_dot2_f32_bf16 v20, v78, v49, v20
    v_add_f32 v22, v22, v50
    v_dot2_f32_bf16 v17, v76, v50, v17
    v_dot2_f32_bf16 v19, v77, v50, v19
    v_dot2_f32_bf16 v21, v78, v50, v21
    v_sub_u32 v49, v83, v247
    v_sub_f32 v49, v49, v42
    v_exp_f32 v49, v49
    s_nop 0
    v_cvt_pk_bf16_f32 v49, v49, 0
    v_lshlrev_b32 v50, 16, v49
    v_dot2_f32_bf16 v16, v80, v49, v16
    v_dot2_f32_bf16 v18, v81, v49, v18
    v_dot2_f32_bf16 v20, v82, v49, v20
    v_add_f32 v22, v22, v50
    v_dot2_f32_bf16 v17, v80, v50, v17
    v_dot2_f32_bf16 v19, v81, v50, v19
    v_dot2_f32_bf16 v21, v82, v50, v21
    v_sub_u32 v49, v87, v247
    v_sub_f32 v49, v49, v42
    v_exp_f32 v49, v49
    s_nop 0
    v_cvt_pk_bf16_f32 v49, v49, 0
    v_lshlrev_b32 v50, 16, v49
    v_dot2_f32_bf16 v16, v84, v49, v16
    v_dot2_f32_bf16 v18, v85, v49, v18
    v_dot2_f32_bf16 v20, v86, v49, v20
    v_add_f32 v22, v22, v50
    v_dot2_f32_bf16 v17, v84, v50, v17
    v_dot2_f32_bf16 v19, v85, v50, v19
    v_dot2_f32_bf16 v21, v86, v50, v21
    v_sub_u32 v49, v111, v247
    v_sub_f32 v49, v49, v42
    v_exp_f32 v49, v49
    s_nop 0
    v_cvt_pk_bf16_f32 v49, v49, 0
    v_lshlrev_b32 v50, 16, v49
    v_dot2_f32_bf16 v16, v108, v49, v16
    v_dot2_f32_bf16 v18, v109, v49, v18
    v_dot2_f32_bf16 v20, v110, v49, v20
    v_add_f32 v22, v22, v50
    v_dot2_f32_bf16 v17, v108, v50, v17
    v_dot2_f32_bf16 v19, v109, v50, v19
    v_dot2_f32_bf16 v21, v110, v50, v21
    v_sub_u32 v49, v115, v247
    v_sub_f32 v49, v49, v42
    v_exp_f32 v49, v49
    s_nop 0
    v_cvt_pk_bf16_f32 v49, v49, 0
    v_lshlrev_b32 v50, 16, v49
    v_dot2_f32_bf16 v16, v112, v49, v16
    v_dot2_f32_bf16 v18, v113, v49, v18
    v_dot2_f32_bf16 v20, v114, v49, v20
    v_add_f32 v22, v22, v50
    v_dot2_f32_bf16 v17, v112, v50, v17
    v_dot2_f32_bf16 v19, v113, v50, v19
    v_dot2_f32_bf16 v21, v114, v50, v21
    v_sub_u32 v49, v131, v247
    v_sub_f32 v49, v49, v42
    v_exp_f32 v49, v49
    s_nop 0
    v_cvt_pk_bf16_f32 v49, v49, 0
    v_lshlrev_b32 v50, 16, v49
    v_dot2_f32_bf16 v16, v128, v49, v16
    v_dot2_f32_bf16 v18, v129, v49, v18
    v_dot2_f32_bf16 v20, v130, v49, v20
    v_add_f32 v22, v22, v50
    v_dot2_f32_bf16 v17, v128, v50, v17
    v_dot2_f32_bf16 v19, v129, v50, v19
    v_dot2_f32_bf16 v21, v130, v50, v21
    v_sub_u32 v49, v135, v247
    v_sub_f32 v49, v49, v42
    v_exp_f32 v49, v49
    s_nop 0
    v_cvt_pk_bf16_f32 v49, v49, 0
    v_lshlrev_b32 v50, 16, v49
    v_dot2_f32_bf16 v16, v132, v49, v16
    v_dot2_f32_bf16 v18, v133, v49, v18
    v_dot2_f32_bf16 v20, v134, v49, v20
    v_add_f32 v22, v22, v50
    v_dot2_f32_bf16 v17, v132, v50, v17
    v_dot2_f32_bf16 v19, v133, v50, v19
    v_dot2_f32_bf16 v21, v134, v50, v21
    v_sub_u32 v49, v55, v247
    v_sub_f32 v49, v49, v42
    v_exp_f32 v49, v49
    s_nop 0
    v_cvt_pk_bf16_f32 v49, v49, 0
    v_lshlrev_b32 v50, 16, v49
    v_dot2_f32_bf16 v16, v52, v49, v16
    v_dot2_f32_bf16 v18, v53, v49, v18
    v_dot2_f32_bf16 v20, v54, v49, v20
    v_add_f32 v22, v22, v50
    v_dot2_f32_bf16 v17, v52, v50, v17
    v_dot2_f32_bf16 v19, v53, v50, v19
    v_dot2_f32_bf16 v21, v54, v50, v21
    s_nop 2
    s_branch L_c_red
L_qk_retry:
    s_mov_b32 s53, 0
L_qk_again:
    s_mul_i32 s56, s3, 3072
    s_add_u32 s56, s56, 16384
    buffer_load_dwordx4 v[136:139], v65, s[32:35], s56 offen offset:0 sc1
    buffer_load_dwordx4 v[140:143], v65, s[32:35], s56 offen offset:1024 sc1
    buffer_load_dwordx4 v[144:147], v65, s[32:35], s56 offen offset:2048 sc1
    s_add_u32 s53, s53, 1
    s_waitcnt vmcnt(0)
    v_xor_b32 v1, s39, v138
    v_xor_b32 v2, s39, v142
    v_xor_b32 v3, s39, v146
    v_or3_b32 v1, v1, v2, v3
    v_cmp_ne_u32 vcc, 0, v1
    s_cbranch_vccz L_qk_ok
    s_cmp_lt_u32 s53, 65536
    s_cbranch_scc1 L_qk_again
    s_branch L_qk_ok
L_fl_retry:
    s_mov_b32 s53, 0
L_fl_again:
    buffer_load_dword v244, v245, s[32:35], 0 offen offset:128 sc1
    s_add_u32 s53, s53, 1
    s_waitcnt vmcnt(0)
    v_cmp_ne_u32 vcc, s39, v244
    s_cbranch_vccz L_fl_ok
    s_cmp_lt_u32 s53, 65536
    s_cbranch_scc1 L_fl_again
    s_branch L_fl_ok
L_site0:
    s_call_b64 s[54:55], L_rare2
    s_branch L_back0
L_site1:
    s_call_b64 s[54:55], L_rare3
    s_branch L_back1
L_site2:
    s_call_b64 s[54:55], L_rare2
    s_branch L_back2
L_site3:
    s_call_b64 s[54:55], L_rare3
    s_branch L_back3
L_site4:
    s_call_b64 s[54:55], L_rare2
    s_branch L_back4
L_site5:
    s_call_b64 s[54:55], L_rare3
    s_branch L_back5
L_site6:
    s_call_b64 s[54:55], L_rare2
    s_branch L_back6
L_site7:
    s_call_b64 s[54:55], L_rare3
    s_branch L_back7
L_site8:
    s_call_b64 s[54:55], L_rare2
    s_branch L_back8
L_site9:
    s_call_b64 s[54:55], L_rare3
    s_branch L_back9
L_site10:
    s_call_b64 s[54:55], L_rare6
    s_branch L_back10
L_site11:
    s_call_b64 s[54:55], L_rare7
    s_branch L_back11
L_site12:
    s_call_b64 s[54:55], L_rare2
    s_branch L_back12
L_site13:
    s_call_b64 s[54:55], L_rare5
    s_branch L_back13
L_rare2:
    s_nop 7
    s_nop 7
    v_mov_b32 v2, v1
    s_nop 1
    v_permlane32_swap_b32 v1, v2
    v_max_f32 v1, v1, v2
    v_mov_b32 v2, v1
    s_nop 1
    v_permlane16_swap_b32 v1, v2
    v_max_f32 v1, v1, v2
    v_max_f32 v1, 0, v1
    v_sub_f32 v62, v62, v1
    v_sub_f32 v88, v88, v1
    v_sub_f32 v89, v89, v1
    v_sub_f32 v90, v90, v1
    v_sub_f32 v91, v91, v1
    v_sub_f32 v1, 0, v1
    v_exp_f32 v1, v1
    s_nop 0
    v_mul_f32 v63, v63, v1
    v_mul_f32 v64, v64, v1
    v_mul_f32 v68, v68, v1
    v_mul_f32 v69, v69, v1
    v_mul_f32 v70, v70, v1
    v_mul_f32 v71, v71, v1
    v_mov_b32 v2, 1
    ds_write_b32 v254, v2 offset:4096
    s_waitcnt lgkmcnt(0)
    s_nop 3
    s_setpc_b64 s[54:55]
L_rare3:
    s_nop 7
    s_nop 7
    v_mov_b32 v2, v1
    s_nop 1
    v_permlane32_swap_b32 v1, v2
    v_max_f32 v1, v1, v2
    v_mov_b32 v2, v1
    s_nop 1
    v_permlane16_swap_b32 v1, v2
    v_max_f32 v1, v1, v2
    v_max_f32 v1, 0, v1
    v_sub_f32 v62, v62, v1
    v_sub_f32 v104, v104, v1
    v_sub_f32 v105, v105, v1
    v_sub_f32 v106, v106, v1
    v_sub_f32 v107, v107, v1
    v_sub_f32 v1, 0, v1
    v_exp_f32 v1, v1
    s_nop 0
    v_mul_f32 v63, v63, v1
    v_mul_f32 v64, v64, v1
    v_mul_f32 v68, v68, v1
    v_mul_f32 v69, v69, v1
    v_mul_f32 v70, v70, v1
    v_mul_f32 v71, v71, v1
    v_mul_f32 v88, v88, v1
    v_mul_f32 v89, v89, v1
    v_mul_f32 v90, v90, v1
    v_mul_f32 v91, v91, v1
    v_mov_b32 v2, 1
    ds_write_b32 v254, v2 offset:4096
    s_waitcnt lgkmcnt(0)
    s_nop 3
    s_setpc_b64 s[54:55]
L_rare5:
    s_nop 7
    s_nop 7
    v_mov_b32 v2, v1
    s_nop 1
    v_permlane32_swap_b32 v1, v2
    v_max_f32 v1, v1, v2
    v_mov_b32 v2, v1
    s_nop 1
    v_permlane16_swap_b32 v1, v2
    v_max_f32 v1, v1, v2
    v_max_f32 v1, 0, v1
    v_sub_f32 v62, v62, v1
    v_sub_f32 v104, v104, v1
    v_sub_f32 v105, v105, v1
    v_sub_f32 v106, v106, v1
    v_sub_f32 v107, v107, v1
    v_sub_f32 v1, 0, v1
    v_exp_f32 v1, v1
    s_nop 0
    v_mul_f32 v63, v63, v1
    v_mul_f32 v64, v64, v1
    v_mul_f32 v68, v68, v1
    v_mul_f32 v69, v69, v1
    v_mul_f32 v70, v70, v1
    v_mul_f32 v71, v71, v1
    v_mul_f32 v88, v88, v1
    v_mul_f32 v89, v89, v1
    v_mul_f32 v90, v90, v1
    v_mul_f32 v91, v91, v1
    v_cvt_pk_bf16_f32 v72, v88, v89
    v_cvt_pk_bf16_f32 v73, v90, v91
    v_mov_b32 v2, 1
    ds_write_b32 v254, v2 offset:4096
    s_waitcnt lgkmcnt(0)
    s_nop 3
    s_setpc_b64 s[54:55]
L_rare6:
    s_nop 7
    s_nop 7
    v_mov_b32 v2, v1
    s_nop 1
    v_permlane32_swap_b32 v1, v2
    v_max_f32 v1, v1, v2
    v_mov_b32 v2, v1
    s_nop 1
    v_permlane16_swap_b32 v1, v2
    v_max_f32 v1, v1, v2
    v_max_f32 v1, 0, v1
    v_sub_f32 v62, v62, v1
    v_sub_f32 v88, v88, v1
    v_sub_f32 v89, v89, v1
    v_sub_f32 v90, v90, v1
    v_sub_f32 v91, v91, v1
    v_sub_f32 v1, 0, v1
    v_exp_f32 v1, v1
    s_nop 0
    v_mul_f32 v63, v63, v1
    v_mul_f32 v64, v64, v1
    v_mul_f32 v68, v68, v1
    v_mul_f32 v69, v69, v1
    v_mul_f32 v70, v70, v1
    v_mul_f32 v71, v71, v1
    v_mov_b32 v2, 1
    ds_write_b32 v254, v2 offset:4100
    s_waitcnt lgkmcnt(0)
    s_nop 3
    s_setpc_b64 s[54:55]
L_rare7:
    s_nop 7
    s_nop 7
    v_mov_b32 v2, v1
    s_nop 1
    v_permlane32_swap_b32 v1, v2
    v_max_f32 v1, v1, v2
    v_mov_b32 v2, v1
    s_nop 1
    v_permlane16_swap_b32 v1, v2
    v_max_f32 v1, v1, v2
    v_max_f32 v1, 0, v1
    v_sub_f32 v62, v62, v1
    v_sub_f32 v104, v104, v1
    v_sub_f32 v105, v105, v1
    v_sub_f32 v106, v106, v1
    v_sub_f32 v107, v107, v1
    v_sub_f32 v1, 0, v1
    v_exp_f32 v1, v1
    s_nop 0
    v_mul_f32 v63, v63, v1
    v_mul_f32 v64, v64, v1
    v_mul_f32 v68, v68, v1
    v_mul_f32 v69, v69, v1
    v_mul_f32 v70, v70, v1
    v_mul_f32 v71, v71, v1
    v_mul_f32 v88, v88, v1
    v_mul_f32 v89, v89, v1
    v_mul_f32 v90, v90, v1
    v_mul_f32 v91, v91, v1
    v_mov_b32 v2, 1
    ds_write_b32 v254, v2 offset:4100
    s_waitcnt lgkmcnt(0)
    s_nop 3
    s_setpc_b64 s[54:55]
L_codeend:
.section .rodata,"a"
.p2align 6
.amdhsa_kernel standalone__detection_seg_dino__vision_kernel
  .amdhsa_next_free_vgpr 464
  .amdhsa_next_free_sgpr 102
  .amdhsa_accum_offset 256
  .amdhsa_group_segment_fixed_size 0
  .amdhsa_kernarg_size 80
  .amdhsa_user_sgpr_count 2
  .amdhsa_user_sgpr_kernarg_segment_ptr 1
  .amdhsa_system_sgpr_workgroup_id_x 1
  .amdhsa_float_denorm_mode_32 3
.end_amdhsa_kernel
```

```asm
; @launch grid=(256,1,1) block=(256,1,1) lds=163840
.amdgcn_target "amdgcn-amd-amdhsa--gfx950"
.text
.globl standalone__detection_seg_dino__vision_kernel
.p2align 8
.type standalone__detection_seg_dino__vision_kernel,@function
standalone__detection_seg_dino__vision_kernel:
    s_cmp_ge_u32 s2, 256
    s_cbranch_scc1 L_end
    s_load_dwordx16 s[4:19], s[0:1], 0
    s_load_dwordx4 s[20:23], s[0:1], 64
    s_getpc_b64 s[54:55]
L_pc_main:
    v_lshlrev_b32 v233, 7, v0
    v_min_u32 v233, L_codeend - L_pc_main - 4, v233
    global_load_dword v232, v233, s[54:55]
    s_mov_b64 s[100:101], s[54:55]
    v_lshrrev_b32 v1, 6, v0
    v_and_b32 v0, 63, v0
    v_readfirstlane_b32 s3, v1
    v_lshlrev_b32 v65, 4, v0
    v_lshrrev_b32 v1, 2, v0
    v_and_b32 v1, 14, v1
    s_mov_b32 s56, 0x5000
    v_bfe_u32 v2, s56, v1, 2
    v_lshlrev_b32 v2, 5, v2
    v_xor_b32 v16, v65, v2
    s_mov_b32 s56, 0xaa55
    v_bfe_u32 v2, s56, v1, 2
    v_lshlrev_b32 v2, 5, v2
    v_xor_b32 v17, v65, v2
    s_mov_b32 s56, 0xfffa
    v_bfe_u32 v2, s56, v1, 2
    v_lshlrev_b32 v2, 5, v2
    v_xor_b32 v18, v65, v2
    v_xor_b32 v19, 16, v16
    v_xor_b32 v20, 0x1010, v17
    v_xor_b32 v21, 0x1010, v18
    v_lshrrev_b32 v1, 3, v0
    v_and_b32 v1, 6, v1
    s_mov_b32 s56, 0x40
    v_bfe_u32 v2, s56, v1, 2
    v_lshlrev_b32 v2, 5, v2
    v_xor_b32 v22, v65, v2
    s_mov_b32 s56, 0xa5
    v_bfe_u32 v2, s56, v1, 2
    v_lshlrev_b32 v2, 5, v2
    v_xor_b32 v23, v65, v2
    s_mov_b32 s56, 0xfe
    v_bfe_u32 v2, s56, v1, 2
    v_lshlrev_b32 v2, 5, v2
    v_xor_b32 v24, v65, v2
    v_xor_b32 v25, 0x80, v22
    v_xor_b32 v26, 0x1080, v23
    v_xor_b32 v27, 0x1080, v24
    v_xor_b32 v28, 0x1010, v22
    v_xor_b32 v29, 0x1010, v23
    v_xor_b32 v30, 0x2010, v24
    v_xor_b32 v31, 0x2090, v22
    v_xor_b32 v32, 0x2090, v23
    v_xor_b32 v33, 0x2090, v24
    v_mov_b32 v248, 0x10000
    s_mul_i32 s36, s3, 6144
    s_mul_i32 s37, s3, 12288
    s_add_u32 s40, s36, 0
    s_add_u32 s41, s37, 24576
    s_add_u32 s42, s37, 73728
    s_mul_i32 s56, s2, 393216
    s_mul_i32 s57, s2, 98304
    s_mov_b64 s[60:61], s[56:57]
    s_mov_b32 s30, 98304
    s_mov_b32 s31, 0x20000
    s_mov_b32 s26, 393216
    s_mov_b32 s27, 0x20000
    s_mov_b32 s34, 8388608
    s_mov_b32 s35, 0x20000
    s_mov_b32 m0, s40
    s_and_b32 s56, s2, 7
    s_cmp_eq_u32 s56, 6
    s_cbranch_scc1 L_spec
    s_and_b32 s56, s2, 7
    s_cbranch_scc1 L_plain
L_spec:
    s_waitcnt lgkmcnt(0)
    s_add_u32 s28, s8, s61
    s_addc_u32 s29, s9, 0
    s_add_u32 s24, s6, s60
    s_addc_u32 s25, s7, 0
    s_mov_b64 s[32:33], s[22:23]
    s_lshr_b32 s43, s2, 3
    s_mul_i32 s57, s43, 2304
    v_min_u32 v1, 17, v0
    v_lshlrev_b32 v1, 7, v1
    s_mov_b32 s66, 73728
    s_mov_b32 s67, 0x20000
    s_mov_b32 s70, 73728
    s_mov_b32 s71, 0x20000
    s_mov_b32 s72, s4
    s_mov_b32 s73, s5
    s_mov_b32 s74, 6144
    s_mov_b32 s75, 0x20000
    s_bitcmp1_b32 s2, 2
    s_cselect_b64 s[64:65], s[16:17], s[10:11]
    s_cselect_b64 s[68:69], s[14:15], s[12:13]
    s_cmp_eq_u32 s3, 0
    s_cbranch_scc1 L_pf0
    s_cmp_eq_u32 s3, 1
    s_cbranch_scc0 L_pfdone
    s_lshl_b32 s58, s43, 8
    buffer_load_dword v234, v1, s[68:71], s57 offen
    v_min_u32 v2, 128, v1
    buffer_load_dword v235, v2, s[72:75], s58 offen
    s_branch L_pfdone
L_pf0:
    buffer_load_dword v234, v1, s[64:67], s57 offen
L_pfdone:
    s_cmp_ge_u32 s43, 3
    s_cbranch_scc1 L_nopf
    s_mov_b32 s0, 1
    s_bitcmp1_b32 s2, 2
    s_cbranch_scc0 L_prod
    s_branch L_vprod
L_plain:
    s_waitcnt lgkmcnt(0)
L_nopf:
    s_add_u32 s28, s8, s61
    s_addc_u32 s29, s9, 0
    buffer_load_dwordx4 v16, s[28:31], s36 offen offset:0 nt lds
    s_add_u32 s24, s6, s60
    s_addc_u32 s25, s7, 0
    s_mov_b64 s[32:33], s[22:23]
    s_mov_b32 s0, 0
    buffer_load_dwordx4 v17, s[28:31], s36 offen offset:1024 nt lds
    buffer_load_dwordx4 v18, s[28:31], s36 offen offset:2048 nt lds
    buffer_load_dwordx4 v19, s[28:31], s36 offen offset:3072 nt lds
    s_add_u32 m0, s40, 4096
    s_load_dword s38, s[22:23], 0
    buffer_load_dwordx4 v20, s[28:31], s36 offen offset:0 nt lds
    buffer_load_dwordx4 v21, s[28:31], s36 offen offset:1024 nt lds
    s_mov_b32 s43, -1
    s_sub_u32 s59, s2, 64
    s_cmp_ge_u32 s59, 64
    s_cbranch_scc1 L_nocs
    s_mov_b32 s64, s4
    s_mov_b32 s65, s5
    s_mov_b32 s66, 6144
    s_mov_b32 s67, 0x20000
    s_mov_b32 s68, s18
    s_mov_b32 s69, s19
    s_mov_b32 s70, 6144
    s_mov_b32 s71, 0x20000
    v_bfe_u32 v1, v0, 2, 1
    v_mul_u32_u24 v2, 7, v1
    v_xor_b32 v2, v0, v2
    v_and_b32 v2, 3, v2
    s_lshr_b32 s56, s59, 4
    s_lshl_b32 s56, s56, 2
    v_add_u32 v2, s56, v2
    v_lshlrev_b32 v252, 2, v2
    v_lshrrev_b32 v3, 4, v0
    v_mad_u32_u24 v3, v1, 3, v3
    v_lshrrev_b32 v4, 1, v3
    v_and_b32 v3, 1, v3
    v_lshlrev_b32 v3, 2, v3
    v_lshl_add_u32 v3, v4, 5, v3
    v_bfe_u32 v4, v0, 3, 1
    v_lshl_add_u32 v3, v4, 1, v3
    v_mul_u32_u24 v2, 384, v2
    s_bfe_u32 s56, s59, 0x20002
    s_mul_i32 s56, s56, 96
    s_and_b32 s57, s59, 3
    s_lshl_b32 s57, s57, 3
    s_add_u32 s56, s56, s57
    v_add3_u32 v248, s56, v2, v3
    v_cmp_gt_u32 vcc, 48, v0
    v_mov_b32 v4, 0x10000
    s_lshl_b32 s56, s3, 2
    v_cndmask_b32 v248, v4, v248, vcc
    buffer_load_ushort v249, v248, s[64:67], 0 offen
    buffer_load_ushort v246, v248, s[68:71], 0 offen
    v_add_u32 v250, s56, v65
    v_and_b32 v251, 0x70, v65
L_nocs:
    s_add_u32 m0, s41, 0
    s_add_u32 s58, s37, 0
    buffer_load_dwordx4 v22, s[24:27], s58 offen offset:0 nt lds
    buffer_load_dwordx4 v23, s[24:27], s58 offen offset:1024 nt lds
    buffer_load_dwordx4 v24, s[24:27], s58 offen offset:2048 nt lds
    buffer_load_dwordx4 v25, s[24:27], s58 offen offset:3072 nt lds
    s_add_u32 m0, s41, 4096
    s_nop 0
    buffer_load_dwordx4 v26, s[24:27], s58 offen offset:0 nt lds
    buffer_load_dwordx4 v27, s[24:27], s58 offen offset:1024 nt lds
    buffer_load_dwordx4 v28, s[24:27], s58 offen offset:2048 nt lds
    buffer_load_dwordx4 v29, s[24:27], s58 offen offset:3072 nt lds
    s_add_u32 m0, s41, 8192
    s_nop 0
    buffer_load_dwordx4 v30, s[24:27], s58 offen offset:0 nt lds
    buffer_load_dwordx4 v31, s[24:27], s58 offen offset:1024 nt lds
    buffer_load_dwordx4 v32, s[24:27], s58 offen offset:2048 nt lds
    buffer_load_dwordx4 v33, s[24:27], s58 offen offset:3072 nt lds
    s_add_u32 m0, s42, 0
    s_add_u32 s59, s37, 196608
    buffer_load_dwordx4 v22, s[24:27], s59 offen offset:0 nt lds
    buffer_load_dwordx4 v23, s[24:27], s59 offen offset:1024 nt lds
    buffer_load_dwordx4 v24, s[24:27], s59 offen offset:2048 nt lds
    buffer_load_dwordx4 v25, s[24:27], s59 offen offset:3072 nt lds
    s_add_u32 m0, s42, 4096
    s_nop 0
    buffer_load_dwordx4 v26, s[24:27], s59 offen offset:0 nt lds
    buffer_load_dwordx4 v27, s[24:27], s59 offen offset:1024 nt lds
    buffer_load_dwordx4 v28, s[24:27], s59 offen offset:2048 nt lds
    buffer_load_dwordx4 v29, s[24:27], s59 offen offset:3072 nt lds
    s_add_u32 m0, s42, 8192
    s_nop 0
    buffer_load_dwordx4 v30, s[24:27], s59 offen offset:0 nt lds
    buffer_load_dwordx4 v31, s[24:27], s59 offen offset:1024 nt lds
    buffer_load_dwordx4 v32, s[24:27], s59 offen offset:2048 nt lds
    buffer_load_dwordx4 v33, s[24:27], s59 offen offset:3072 nt lds
    v_and_b32 v1, 15, v0
    v_lshrrev_b32 v6, 5, v0
    v_bfe_u32 v3, v0, 4, 1
    v_lshl_or_b32 v3, v3, 1, v6
    v_lshrrev_b32 v4, 2, v0
    v_bfe_u32 v5, v0, 1, 1
    v_lshrrev_b32 v6, 3, v1
    v_and_or_b32 v6, v1, 6, v6
    v_xor_b32 v6, v6, v3
    v_mul_u32_u24 v7, 384, v1
    v_lshl_add_u32 v6, v6, 4, v7
    v_add_u32 v34, s40, v6
    v_xor_b32 v35, 64, v34
    v_lshrrev_b32 v6, 3, v1
    v_and_b32 v7, 7, v1
    v_lshl_or_b32 v6, v7, 1, v6
    v_xor_b32 v6, v6, v3
    v_mul_u32_u24 v7, 768, v1
    v_lshl_add_u32 v6, v6, 4, v7
    v_add_u32 v40, s41, v6
    v_xor_b32 v41, 0x40, v40
    v_xor_b32 v42, 0x80, v40
    v_xor_b32 v43, 0xc0, v40
    v_and_b32 v2, 1, v0
    v_lshlrev_b32 v2, 3, v2
    s_mul_i32 s56, s3, 96
    v_lshrrev_b32 v6, 3, v4
    v_and_or_b32 v6, v4, 6, v6
    v_xor_b32 v6, v6, v5
    v_lshl_add_u32 v6, v6, 4, v2
    v_mul_u32_u24 v7, 384, v4
    s_add_u32 s57, s56, 0
    v_xad_u32 v36, v6, s57, v7
    s_add_u32 s57, s56, 32
    v_xad_u32 v37, v6, s57, v7
    s_add_u32 s57, s56, 64
    v_xad_u32 v38, v6, s57, v7
    v_lshrrev_b32 v6, 3, v4
    v_and_b32 v3, 7, v4
    v_lshl_or_b32 v6, v3, 1, v6
    v_xor_b32 v6, v6, v5
    v_lshl_add_u32 v6, v6, 4, v2
    v_lshlrev_b32 v7, 1, v7
    v_add_u32 v7, 24576, v7
    s_add_u32 s57, s56, 0
    v_xad_u32 v44, v6, s57, v7
    s_add_u32 s57, s56, 384
    v_xad_u32 v45, v6, s57, v7
    s_add_u32 s57, s56, 32
    v_xad_u32 v46, v6, s57, v7
    s_add_u32 s57, s56, 416
    v_xad_u32 v47, v6, s57, v7
    s_add_u32 s57, s56, 64
    v_xad_u32 v48, v6, s57, v7
    s_add_u32 s57, s56, 448
    v_xad_u32 v49, v6, s57, v7
    v_mov_b32 v52, 0x3f803f80
    v_mov_b32 v56, 0x3ebcbe62
    s_mov_b32 s44, 0x100001
    s_mov_b32 s45, 0x10000100
    v_mov_b32 v53, 0x3f803f80
    v_mov_b32 v57, 0x3ebcbe62
    s_mov_b32 s46, 0x200002
    s_mov_b32 s47, 0x20000200
    v_mov_b32 v54, 0x3f803f80
    v_mov_b32 v58, 0x3ebcbe62
    s_mov_b32 s48, 0x400004
    s_mov_b32 s49, 0x40000400
    v_mov_b32 v55, 0x3f803f80
    v_mov_b32 v59, 0x3ebcbe62
    s_mov_b32 s50, 0x800008
    s_mov_b32 s51, 0x80000800
    v_mov_b32 v60, 0x43400000
    v_lshrrev_b32 v1, 5, v0
    v_lshlrev_b32 v1, 8, v1
    v_and_b32 v2, 15, v0
    v_lshl_add_u32 v1, v2, 4, v1
    v_bfe_u32 v2, v0, 4, 1
    v_lshl_add_u32 v1, v2, 3, v1
    s_mul_i32 s56, s3, 1536
    s_add_u32 s56, s56, 147456
    v_add_u32 v236, s56, v1
    s_mul_i32 s56, s3, 3072
    s_add_u32 s56, s56, 24576
    v_add_u32 v237, s56, v65
    v_add_u32 v238, s41, v65
    s_lshl_b32 s56, s3, 10
    v_add_u32 v240, 159744, v65
    v_add_u32 v239, s56, v240
    v_add_u32 v241, 147456, v65
    v_bfe_u32 v1, v0, 2, 2
    v_lshrrev_b32 v2, 4, v0
    v_lshl_or_b32 v1, v1, 4, v2
    v_mul_u32_u24 v1, 37120, v1
    v_and_b32 v2, 3, v0
    v_lshl_or_b32 v242, v2, 4, v1
    v_xor_b32 v243, 0x70, v242
    s_mul_i32 s56, s3, 3
    v_min_u32 v1, 2, v0
    v_add_u32 v1, s56, v1
    v_lshlrev_b32 v245, 7, v1
    v_lshlrev_b32 v1, 3, v0
    v_add_u32 v254, 126976, v1
    s_lshl_b32 s56, s3, 9
    v_add_u32 v238, s56, v254
    v_add_u32 v253, 122880, v65
    s_lshl_b32 s56, s3, 10
    v_add_u32 v237, s56, v253
    s_mov_b32 s52, 0x41c00000
L_join:
    s_mul_i32 s60, s3, 18432
    s_mov_b32 s72, s22
    s_mov_b32 s73, s23
    s_mov_b32 s74, 8388608
    s_mov_b32 s75, 0x20000
    s_cmp_eq_u32 s0, 1
    s_cselect_b32 s74, 0, s74
    s_waitcnt vmcnt(24)
    s_waitcnt lgkmcnt(0)
    s_barrier
    ds_read_b128 a[48:51], v34 offset:0
    ds_read_b128 a[52:55], v35 offset:0
    ds_read_b128 a[56:59], v34 offset:128
    ds_read_b128 a[60:63], v35 offset:128
    ds_read_b128 a[64:67], v34 offset:256
    ds_read_b128 a[68:71], v35 offset:256
    s_waitcnt lgkmcnt(5)
    v_mfma_f32_16x16x32_bf16 v[84:87], a[48:51], a[48:51], 0
    ds_read_b64_tr_b16 a[72:73], v36 offset:0
    ds_read_b64_tr_b16 a[74:75], v36 offset:6144
    v_mfma_f32_16x16x32_bf16 v[80:83], a[48:51], v[52:55], 0
    ds_read_b64_tr_b16 a[76:77], v36 offset:12288
    ds_read_b64_tr_b16 a[78:79], v36 offset:18432
    s_waitcnt lgkmcnt(8)
    v_mfma_f32_16x16x32_bf16 v[84:87], a[52:55], a[52:55], v[84:87]
    ds_read_b64_tr_b16 a[80:81], v37 offset:0
    ds_read_b64_tr_b16 a[82:83], v37 offset:6144
    v_mfma_f32_16x16x32_bf16 v[80:83], a[52:55], v[52:55], v[80:83]
    ds_read_b64_tr_b16 a[84:85], v37 offset:12288
    ds_read_b64_tr_b16 a[86:87], v37 offset:18432
    s_waitcnt lgkmcnt(11)
    v_mfma_f32_16x16x32_bf16 v[84:87], a[56:59], a[56:59], v[84:87]
    ds_read_b64_tr_b16 a[88:89], v38 offset:0
    ds_read_b64_tr_b16 a[90:91], v38 offset:6144
    v_mfma_f32_16x16x32_bf16 v[80:83], a[56:59], v[52:55], v[80:83]
    ds_read_b64_tr_b16 a[92:93], v38 offset:12288
    ds_read_b64_tr_b16 a[94:95], v38 offset:18432
    s_waitcnt lgkmcnt(14)
    v_mfma_f32_16x16x32_bf16 v[84:87], a[60:63], a[60:63], v[84:87]
    v_mfma_f32_16x16x32_bf16 v[80:83], a[60:63], v[52:55], v[80:83]
    s_waitcnt lgkmcnt(13)
    v_mfma_f32_16x16x32_bf16 v[84:87], a[64:67], a[64:67], v[84:87]
    v_mfma_f32_16x16x32_bf16 v[80:83], a[64:67], v[52:55], v[80:83]
    s_waitcnt lgkmcnt(12)
    v_mfma_f32_16x16x32_bf16 v[84:87], a[68:71], a[68:71], v[84:87]
    v_mfma_f32_16x16x32_bf16 v[80:83], a[68:71], v[52:55], v[80:83]
    s_waitcnt lgkmcnt(0)
    s_mul_i32 s39, s38, 0x9e3779b1
    s_add_u32 s39, s39, 0x7f4a7c16
    s_or_b32 s39, s39, 1
    s_mul_i32 s56, s3, 3072
    s_add_u32 s56, s56, 16384
    buffer_load_dwordx4 v[136:139], v65, s[32:35], s56 offen offset:0 sc1
    buffer_load_dwordx4 v[140:143], v65, s[32:35], s56 offen offset:1024 sc1
    buffer_load_dwordx4 v[144:147], v65, s[32:35], s56 offen offset:2048 sc1
    s_waitcnt vmcnt(15)
    s_barrier
    ds_read_b128 a[96:99], v40 offset:0
    ds_read_b128 a[100:103], v41 offset:0
    ds_read_b128 a[104:107], v42 offset:0
    ds_read_b128 a[108:111], v43 offset:0
    ds_read_b128 a[112:115], v40 offset:256
    ds_read_b128 a[116:119], v41 offset:256
    ds_read_b128 a[120:123], v42 offset:256
    ds_read_b128 a[124:127], v43 offset:256
    ds_read_b128 a[128:131], v40 offset:512
    ds_read_b128 a[132:135], v41 offset:512
    ds_read_b128 a[136:139], v42 offset:512
    ds_read_b128 a[140:143], v43 offset:512
    ds_read_b64_tr_b16 a[144:145], v44 offset:0
    ds_read_b64_tr_b16 a[146:147], v45 offset:0
    ds_read_b64_tr_b16 a[148:149], v44 offset:12288
    ds_read_b64_tr_b16 a[150:151], v45 offset:12288
    ds_read_b64_tr_b16 a[152:153], v44 offset:24576
    ds_read_b64_tr_b16 a[154:155], v45 offset:24576
    ds_read_b64_tr_b16 a[156:157], v44 offset:36864
    ds_read_b64_tr_b16 a[158:159], v45 offset:36864
    ds_read_b64_tr_b16 a[160:161], v46 offset:0
    ds_read_b64_tr_b16 a[162:163], v47 offset:0
    ds_read_b64_tr_b16 a[164:165], v46 offset:12288
    ds_read_b64_tr_b16 a[166:167], v47 offset:12288
    ds_read_b64_tr_b16 a[168:169], v46 offset:24576
    ds_read_b64_tr_b16 a[170:171], v47 offset:24576
    ds_read_b64_tr_b16 a[172:173], v46 offset:36864
    ds_read_b64_tr_b16 a[174:175], v47 offset:36864
    ds_read_b64_tr_b16 a[176:177], v48 offset:0
    ds_read_b64_tr_b16 a[178:179], v49 offset:0
    ds_read_b64_tr_b16 a[180:181], v48 offset:12288
    ds_read_b64_tr_b16 a[182:183], v49 offset:12288
    ds_read_b64_tr_b16 a[184:185], v48 offset:24576
    ds_read_b64_tr_b16 a[186:187], v49 offset:24576
    ds_read_b64_tr_b16 a[188:189], v48 offset:36864
    ds_read_b64_tr_b16 a[190:191], v49 offset:36864
    s_waitcnt lgkmcnt(0)
    s_barrier
    s_cmp_ge_u32 s43, 3
    s_cbranch_scc1 L_v_nofl
    s_mul_i32 s56, s3, 3
    s_add_u32 s56, s56, s43
    s_lshl_b32 s56, s56, 7
    v_mov_b32 v1, s39
    v_mov_b32 v2, 0
    s_mov_b64 exec, 1
    s_waitcnt vmcnt(9)
    buffer_store_dword v1, v2, s[32:35], s56 offen offset:128 sc1
    s_mov_b64 exec, -1
L_v_nofl:
    v_mfma_f32_16x16x32_bf16 v[96:99], a[96:99], a[96:99], v[84:87]
    s_add_u32 m0, s40, 0
    s_add_u32 s57, s36, 24576
    buffer_load_dwordx4 v16, s[28:31], s57 offen offset:0 nt lds
    v_add_u32 v44, 49152, v44
    v_add_u32 v45, 49152, v45
    v_mfma_f32_16x16x32_bf16 v[100:103], a[96:99], a[48:51], 0
    buffer_load_dwordx4 v17, s[28:31], s57 offen offset:1024 nt lds
    v_add_u32 v46, 49152, v46
    v_add_u32 v47, 49152, v47
    v_mfma_f32_16x16x32_bf16 v[96:99], a[100:103], a[100:103], v[96:99]
    buffer_load_dwordx4 v18, s[28:31], s57 offen offset:2048 nt lds
    v_add_u32 v48, 49152, v48
    v_add_u32 v49, 49152, v49
    v_mfma_f32_16x16x32_bf16 v[100:103], a[100:103], a[52:55], v[100:103]
    v_mfma_f32_16x16x32_bf16 v[96:99], a[104:107], a[104:107], v[96:99]
    v_mfma_f32_16x16x32_bf16 v[100:103], a[104:107], a[56:59], v[100:103]
    v_mfma_f32_16x16x32_bf16 v[96:99], a[108:111], a[108:111], v[96:99]
    v_mfma_f32_16x16x32_bf16 v[100:103], a[108:111], a[60:63], v[100:103]
    v_mfma_f32_16x16x32_bf16 v[96:99], a[112:115], a[112:115], v[96:99]
    v_mfma_f32_16x16x32_bf16 v[100:103], a[112:115], a[64:67], v[100:103]
    v_mfma_f32_16x16x32_bf16 v[96:99], a[116:119], a[116:119], v[96:99]
    v_mfma_f32_16x16x32_bf16 v[100:103], a[116:119], a[68:71], v[100:103]
    v_mfma_f32_16x16x32_bf16 v[92:95], a[96:99], v[52:55], v[80:83]
    v_mfma_f32_16x16x32_bf16 v[92:95], a[100:103], v[52:55], v[92:95]
    v_mfma_f32_16x16x32_bf16 v[92:95], a[104:107], v[52:55], v[92:95]
    v_mfma_f32_16x16x32_bf16 v[92:95], a[108:111], v[52:55], v[92:95]
    s_nop 3
    v_fma_f32 v96, v100, 2.0, v96
    v_fma_f32 v97, v101, 2.0, v97
    v_mfma_f32_16x16x32_bf16 v[92:95], a[112:115], v[52:55], v[92:95]
    buffer_load_dwordx4 v19, s[28:31], s57 offen offset:3072 nt lds
    v_fma_f32 v98, v102, 2.0, v98
    v_fma_f32 v99, v103, 2.0, v99
    v_mfma_f32_16x16x32_bf16 v[92:95], a[116:119], v[52:55], v[92:95]
    v_cndmask_b32 v3, 0, v96, s[44:45]
    v_cndmask_b32 v3, v3, v97, s[46:47]
    v_mfma_f32_16x16x32_bf16 v[112:115], a[120:123], a[120:123], v[84:87]
    v_cndmask_b32 v3, v3, v98, s[48:49]
    v_cndmask_b32 v3, v3, v99, s[50:51]
    v_mfma_f32_16x16x32_bf16 v[116:119], a[120:123], a[48:51], 0
    s_nop 0
    s_nop 0
    v_mfma_f32_16x16x32_bf16 v[112:115], a[124:127], a[124:127], v[112:115]
    v_mfma_f32_16x16x4_f32 v[120:123], v3, v60, v[56:59]
    v_mfma_f32_16x16x32_bf16 v[116:119], a[124:127], a[52:55], v[116:119]
    v_mfma_f32_16x16x32_bf16 v[112:115], a[128:131], a[128:131], v[112:115]
    v_mfma_f32_16x16x32_bf16 v[116:119], a[128:131], a[56:59], v[116:119]
    v_mfma_f32_16x16x32_bf16 v[112:115], a[132:135], a[132:135], v[112:115]
    s_nop 5
    v_fma_f32 v128, -v92, v92, v120
    v_fma_f32 v129, -v93, v93, v121
    v_mfma_f32_16x16x32_bf16 v[116:119], a[132:135], a[60:63], v[116:119]
    v_fma_f32 v130, -v94, v94, v122
    v_fma_f32 v131, -v95, v95, v123
    v_mfma_f32_16x16x32_bf16 v[112:115], a[136:139], a[136:139], v[112:115]
    v_max_f32 v128, v128, v56
    v_max_f32 v129, v129, v56
    v_mfma_f32_16x16x32_bf16 v[116:119], a[136:139], a[64:67], v[116:119]
    s_add_u32 m0, s40, 4096
    s_nop 0
    buffer_load_dwordx4 v20, s[28:31], s57 offen offset:0 nt lds
    v_max_f32 v130, v130, v56
    v_max_f32 v131, v131, v56
    v_mfma_f32_16x16x32_bf16 v[112:115], a[140:143], a[140:143], v[112:115]
    v_rsq_f32 v128, v128
    v_mfma_f32_16x16x32_bf16 v[116:119], a[140:143], a[68:71], v[116:119]
    v_rsq_f32 v129, v129
    v_mfma_f32_16x16x32_bf16 v[108:111], a[120:123], v[52:55], v[80:83]
    v_rsq_f32 v130, v130
    v_mfma_f32_16x16x32_bf16 v[108:111], a[124:127], v[52:55], v[108:111]
    v_rsq_f32 v131, v131
    v_mfma_f32_16x16x32_bf16 v[108:111], a[128:131], v[52:55], v[108:111]
    v_mfma_f32_16x16x32_bf16 v[108:111], a[132:135], v[52:55], v[108:111]
    v_mfma_f32_16x16x32_bf16 v[108:111], a[136:139], v[52:55], v[108:111]
    v_fma_f32 v112, v116, 2.0, v112
    v_fma_f32 v113, v117, 2.0, v113
    v_mfma_f32_16x16x32_bf16 v[108:111], a[140:143], v[52:55], v[108:111]
    v_fma_f32 v114, v118, 2.0, v114
    v_fma_f32 v115, v119, 2.0, v115
    v_cndmask_b32 v4, 0, v112, s[44:45]
    v_cndmask_b32 v4, v4, v113, s[46:47]
    v_cndmask_b32 v4, v4, v114, s[48:49]
    v_cndmask_b32 v4, v4, v115, s[50:51]
    s_nop 0
    s_nop 0
    v_mfma_f32_16x16x4_f32 v[124:127], v4, v60, v[56:59]
    s_nop 9
    v_fma_f32 v132, -v108, v108, v124
    v_fma_f32 v133, -v109, v109, v125
    v_fma_f32 v134, -v110, v110, v126
    v_fma_f32 v135, -v111, v111, v127
    v_max_f32 v132, v132, v56
    v_max_f32 v133, v133, v56
    v_max_f32 v134, v134, v56
    v_max_f32 v135, v135, v56
    v_rsq_f32 v132, v132
    v_rsq_f32 v133, v133
    v_rsq_f32 v134, v134
    v_rsq_f32 v135, v135
    s_mul_i32 s56, s3, 1536
    v_lshlrev_b32 v5, 3, v0
    v_add_u32 v5, 153600, v5
    v_add_u32 v4, s56, v5
    buffer_load_dwordx4 v21, s[28:31], s57 offen offset:1024 nt lds
    s_add_u32 m0, s41, 0
    s_add_u32 s58, s37, 49152
    buffer_load_dwordx4 v22, s[24:27], s58 offen offset:0 nt lds
    buffer_load_dwordx4 v23, s[24:27], s58 offen offset:1024 nt lds
    buffer_load_dwordx4 v24, s[24:27], s58 offen offset:2048 nt lds
    buffer_load_dwordx4 v25, s[24:27], s58 offen offset:3072 nt lds
    s_add_u32 m0, s41, 4096
    s_nop 0
    buffer_load_dwordx4 v26, s[24:27], s58 offen offset:0 nt lds
    buffer_load_dwordx4 v27, s[24:27], s58 offen offset:1024 nt lds
    s_waitcnt vmcnt(12)
    v_xor_b32 v1, s39, v138
    v_xor_b32 v2, s39, v142
    v_xor_b32 v3, s39, v146
    v_or3_b32 v1, v1, v2, v3
    v_cmp_ne_u32 vcc, 0, v1
    s_cbranch_vccnz L_qk_retry
L_qk_ok:
    ds_write_b64 v4, v[136:137] offset:0
    ds_write_b64 v4, v[140:141] offset:512
    ds_write_b64 v4, v[144:145] offset:1024
    s_waitcnt lgkmcnt(0)
    s_barrier
    ds_read2st64_b64 v[136:139], v5 offset0:0 offset1:1
    ds_read2st64_b64 v[140:143], v5 offset0:2 offset1:3
    ds_read2st64_b64 v[144:147], v5 offset0:4 offset1:5
    ds_read2st64_b64 v[148:151], v5 offset0:6 offset1:7
    ds_read2st64_b64 v[152:155], v5 offset0:8 offset1:9
    ds_read2st64_b64 v[156:159], v5 offset0:10 offset1:11
    s_waitcnt lgkmcnt(5)
    v_mfma_f32_16x16x32_bf16 v[120:123], v[52:55], v[136:139], 0
    buffer_load_dwordx4 v28, s[24:27], s58 offen offset:2048 nt lds
    v_mfma_f32_16x16x32_bf16 v[76:79], a[48:51], v[136:139], 0
    s_waitcnt lgkmcnt(4)
    v_mfma_f32_16x16x32_bf16 v[120:123], v[52:55], v[140:143], v[120:123]
    v_mfma_f32_16x16x32_bf16 v[76:79], a[52:55], v[140:143], v[76:79]
    s_waitcnt lgkmcnt(3)
    v_mfma_f32_16x16x32_bf16 v[120:123], v[52:55], v[144:147], v[120:123]
    v_mfma_f32_16x16x32_bf16 v[76:79], a[56:59], v[144:147], v[76:79]
    s_waitcnt lgkmcnt(2)
    v_mfma_f32_16x16x32_bf16 v[120:123], v[52:55], v[148:151], v[120:123]
    v_mfma_f32_16x16x32_bf16 v[76:79], a[60:63], v[148:151], v[76:79]
    s_waitcnt lgkmcnt(1)
    v_mfma_f32_16x16x32_bf16 v[120:123], v[52:55], v[152:155], v[120:123]
    buffer_load_dwordx4 v29, s[24:27], s58 offen offset:3072 nt lds
    v_mfma_f32_16x16x32_bf16 v[76:79], a[64:67], v[152:155], v[76:79]
    s_waitcnt lgkmcnt(0)
    v_mfma_f32_16x16x32_bf16 v[120:123], v[52:55], v[156:159], v[120:123]
    v_mfma_f32_16x16x32_bf16 v[76:79], a[68:71], v[156:159], v[76:79]
    s_nop 6
    v_mul_f32 v61, 0x3baaaaab, v120
    v_mfma_f32_16x16x32_bf16 v[88:91], a[96:99], v[136:139], v[76:79]
    v_mov_b32 v9, 0
    v_mfma_f32_16x16x32_bf16 v[88:91], a[100:103], v[140:143], v[88:91]
    v_mfma_f32_16x16x32_bf16 v[88:91], a[104:107], v[144:147], v[88:91]
    v_mfma_f32_16x16x32_bf16 v[88:91], a[108:111], v[148:151], v[88:91]
    v_mfma_f32_16x16x32_bf16 v[88:91], a[112:115], v[152:155], v[88:91]
    v_mfma_f32_16x16x32_bf16 v[88:91], a[116:119], v[156:159], v[88:91]
    ds_write_b32 v254, v9 offset:4096
    ds_write_b32 v254, v9 offset:4100
    v_mfma_f32_16x16x32_bf16 v[104:107], a[120:123], v[136:139], v[76:79]
    v_mfma_f32_16x16x32_bf16 v[104:107], a[124:127], v[140:143], v[104:107]
    v_mfma_f32_16x16x32_bf16 v[104:107], a[128:131], v[144:147], v[104:107]
    v_mfma_f32_16x16x32_bf16 v[104:107], a[132:135], v[148:151], v[104:107]
    s_nop 1
    v_fma_f32 v88, -v92, v61, v88
    v_fma_f32 v89, -v93, v61, v89
    v_mfma_f32_16x16x32_bf16 v[104:107], a[136:139], v[152:155], v[104:107]
    s_add_u32 m0, s41, 8192
    s_nop 0
    buffer_load_dwordx4 v30, s[24:27], s58 offen offset:0 nt lds
    v_fma_f32 v90, -v94, v61, v90
    v_fma_f32 v91, -v95, v61, v91
    v_mfma_f32_16x16x32_bf16 v[104:107], a[140:143], v[156:159], v[104:107]
    v_mul_f32 v88, v88, v128
    v_mul_f32 v89, v89, v129
    v_mul_f32 v90, v90, v130
    v_mul_f32 v91, v91, v131
    v_max3_f32 v1, v88, v89, v90
    v_max_f32 v1, v1, v91
    s_nop 1
    v_fma_f32 v104, -v108, v61, v104
    v_fma_f32 v105, -v109, v61, v105
    v_fma_f32 v106, -v110, v61, v106
    v_fma_f32 v107, -v111, v61, v107
    v_mul_f32 v104, v104, v132
    v_mul_f32 v105, v105, v133
    v_mul_f32 v106, v106, v134
    v_mul_f32 v107, v107, v135
    v_max3_f32 v1, v1, v104, v105
    v_max3_f32 v1, v1, v106, v107
    v_mov_b32 v2, v1
    s_nop 1
    v_permlane32_swap_b32 v1, v2
    v_max_f32 v1, v1, v2
    v_mov_b32 v2, v1
    s_nop 1
    v_permlane16_swap_b32 v1, v2
    v_max_f32 v1, v1, v2
    ds_write_b32 v239, v1
    s_waitcnt lgkmcnt(0)
    s_barrier
    ds_read_b32 v12, v240 offset:0
    ds_read_b32 v13, v240 offset:1024
    ds_read_b32 v14, v240 offset:2048
    ds_read_b32 v15, v240 offset:3072
    buffer_load_dwordx4 v31, s[24:27], s58 offen offset:1024 nt lds
    s_waitcnt lgkmcnt(0)
    v_max3_f32 v1, v12, v13, v14
    v_max_f32 v1, v1, v15
    v_sub_f32 v88, v88, v1
    v_sub_f32 v89, v89, v1
    v_sub_f32 v90, v90, v1
    v_sub_f32 v91, v91, v1
    v_sub_f32 v104, v104, v1
    v_sub_f32 v105, v105, v1
    v_sub_f32 v106, v106, v1
    v_sub_f32 v107, v107, v1
    v_sub_f32 v62, 0, v1
    v_sub_f32 v255, 0, v1
    v_exp_f32 v96, v88
    v_exp_f32 v97, v89
    v_exp_f32 v98, v90
    v_exp_f32 v99, v91
    v_mul_f32 v88, v96, v128
    v_mul_f32 v89, v97, v129
    v_mul_f32 v90, v98, v130
    v_mul_f32 v91, v99, v131
    v_exp_f32 v112, v104
    v_exp_f32 v113, v105
    v_exp_f32 v114, v106
    v_exp_f32 v115, v107
    v_cvt_pk_bf16_f32 v72, v88, v89
    v_cvt_pk_bf16_f32 v73, v90, v91
    v_mul_f32 v104, v112, v132
    v_mul_f32 v105, v113, v133
    v_mul_f32 v106, v114, v134
    v_mul_f32 v107, v115, v135
    v_cvt_pk_bf16_f32 v74, v104, v105
    v_cvt_pk_bf16_f32 v75, v106, v107
    ds_write_b128 v237, v[72:75] offset:0
    v_mov_b32 v63, v96
    v_mul_f32 v64, v88, v92
    v_add_f32 v63, v63, v97
    v_fmac_f32 v64, v89, v93
    v_add_f32 v63, v63, v98
    v_fmac_f32 v64, v90, v94
    v_add_f32 v63, v63, v99
    v_fmac_f32 v64, v91, v95
    v_mov_b32 v68, v88
    v_mov_b32 v69, v89
    v_mov_b32 v70, v90
    v_mov_b32 v71, v91
    s_waitcnt lgkmcnt(0)
    s_barrier
    ds_read_b128 v[92:95], v253 offset:0
    ds_read_b128 v[96:99], v253 offset:1024
    ds_read_b128 v[100:103], v253 offset:2048
    ds_read_b128 v[116:119], v253 offset:3072
    s_waitcnt lgkmcnt(3)
    v_mfma_f32_16x16x32_bf16 a[0:3], a[144:147], v[92:95], 0
    buffer_load_dwordx4 v32, s[24:27], s58 offen offset:2048 nt lds
    v_add_f32 v68, v68, v104
    v_add_f32 v69, v69, v105
    v_mfma_f32_16x16x32_bf16 a[4:7], a[160:163], v[92:95], 0
    buffer_load_dwordx4 v33, s[24:27], s58 offen offset:3072 nt lds
    v_add_f32 v70, v70, v106
    v_add_f32 v71, v71, v107
    v_mfma_f32_16x16x32_bf16 a[8:11], a[176:179], v[92:95], 0
    v_add_f32 v63, v63, v112
    v_fma_f32 v64, v104, v108, v64
    s_waitcnt lgkmcnt(2)
    v_mfma_f32_16x16x32_bf16 a[0:3], a[148:151], v[96:99], a[0:3]
    v_add_f32 v63, v63, v113
    v_fma_f32 v64, v105, v109, v64
    v_mfma_f32_16x16x32_bf16 a[4:7], a[164:167], v[96:99], a[4:7]
    v_add_f32 v63, v63, v114
    v_fma_f32 v64, v106, v110, v64
    v_mfma_f32_16x16x32_bf16 a[8:11], a[180:183], v[96:99], a[8:11]
    v_add_f32 v63, v63, v115
    v_fma_f32 v64, v107, v111, v64
    s_waitcnt lgkmcnt(1)
    v_mfma_f32_16x16x32_bf16 a[0:3], a[152:155], v[100:103], a[0:3]
    v_mfma_f32_16x16x32_bf16 a[4:7], a[168:171], v[100:103], a[4:7]
    v_mfma_f32_16x16x32_bf16 a[8:11], a[184:187], v[100:103], a[8:11]
    s_waitcnt lgkmcnt(0)
    v_mfma_f32_16x16x32_bf16 a[0:3], a[156:159], v[116:119], a[0:3]
    v_mfma_f32_16x16x32_bf16 a[4:7], a[172:175], v[116:119], a[4:7]
    v_mfma_f32_16x16x32_bf16 a[8:11], a[188:191], v[116:119], a[8:11]
    s_barrier
    ds_read_b128 a[96:99], v40 offset:49152
    ds_read_b128 a[100:103], v41 offset:49152
    ds_read_b128 a[104:107], v42 offset:49152
    ds_read_b128 a[108:111], v43 offset:49152
    ds_read_b128 a[112:115], v40 offset:49408
    ds_read_b128 a[116:119], v41 offset:49408
    ds_read_b128 a[120:123], v42 offset:49408
    ds_read_b128 a[124:127], v43 offset:49408
    ds_read_b128 a[128:131], v40 offset:49664
    ds_read_b128 a[132:135], v41 offset:49664
    ds_read_b128 a[136:139], v42 offset:49664
    ds_read_b128 a[140:143], v43 offset:49664
    s_waitcnt lgkmcnt(11)
    v_mfma_f32_16x16x32_bf16 v[96:99], a[96:99], a[96:99], v[84:87]
    ds_read_b64_tr_b16 a[144:145], v44 offset:0
    ds_read_b64_tr_b16 a[146:147], v45 offset:0
    v_mfma_f32_16x16x32_bf16 v[100:103], a[96:99], a[48:51], 0
    ds_read_b64_tr_b16 a[148:149], v44 offset:12288
    ds_read_b64_tr_b16 a[150:151], v45 offset:12288
    s_waitcnt lgkmcnt(14)
    v_mfma_f32_16x16x32_bf16 v[96:99], a[100:103], a[100:103], v[96:99]
    ds_read_b64_tr_b16 a[152:153], v44 offset:24576
    ds_read_b64_tr_b16 a[154:155], v45 offset:24576
    v_mfma_f32_16x16x32_bf16 v[100:103], a[100:103], a[52:55], v[100:103]
    ds_read_b64_tr_b16 a[156:157], v44 offset:36864
    ds_read_b64_tr_b16 a[158:159], v45 offset:36864
    s_waitcnt lgkmcnt(15)
    v_mfma_f32_16x16x32_bf16 v[96:99], a[104:107], a[104:107], v[96:99]
    ds_read_b64_tr_b16 a[160:161], v46 offset:0
    ds_read_b64_tr_b16 a[162:163], v47 offset:0
    v_mfma_f32_16x16x32_bf16 v[100:103], a[104:107], a[56:59], v[100:103]
    ds_read_b64_tr_b16 a[164:165], v46 offset:12288
    ds_read_b64_tr_b16 a[166:167], v47 offset:12288
    v_mfma_f32_16x16x32_bf16 v[96:99], a[108:111], a[108:111], v[96:99]
    ds_read_b64_tr_b16 a[168:169], v46 offset:24576
    ds_read_b64_tr_b16 a[170:171], v47 offset:24576
    v_mfma_f32_16x16x32_bf16 v[100:103], a[108:111], a[60:63], v[100:103]
    ds_read_b64_tr_b16 a[172:173], v46 offset:36864
    ds_read_b64_tr_b16 a[174:175], v47 offset:36864
    v_mfma_f32_16x16x32_bf16 v[96:99], a[112:115], a[112:115], v[96:99]
    ds_read_b64_tr_b16 a[176:177], v48 offset:0
    ds_read_b64_tr_b16 a[178:179], v49 offset:0
    v_mfma_f32_16x16x32_bf16 v[100:103], a[112:115], a[64:67], v[100:103]
    ds_read_b64_tr_b16 a[180:181], v48 offset:12288
    ds_read_b64_tr_b16 a[182:183], v49 offset:12288
    s_waitcnt lgkmcnt(15)
    v_mfma_f32_16x16x32_bf16 v[96:99], a[116:119], a[116:119], v[96:99]
    ds_read_b64_tr_b16 a[184:185], v48 offset:24576
    ds_read_b64_tr_b16 a[186:187], v49 offset:24576
    v_mfma_f32_16x16x32_bf16 v[100:103], a[116:119], a[68:71], v[100:103]
    ds_read_b64_tr_b16 a[188:189], v48 offset:36864
    ds_read_b64_tr_b16 a[190:191], v49 offset:36864
    v_mfma_f32_16x16x32_bf16 v[92:95], a[96:99], v[52:55], v[80:83]
    v_mfma_f32_16x16x32_bf16 v[92:95], a[100:103], v[52:55], v[92:95]
    v_mfma_f32_16x16x32_bf16 v[92:95], a[104:107], v[52:55], v[92:95]
    v_mfma_f32_16x16x32_bf16 v[92:95], a[108:111], v[52:55], v[92:95]
    s_nop 1
    v_fma_f32 v96, v100, 2.0, v96
    v_fma_f32 v97, v101, 2.0, v97
    v_mfma_f32_16x16x32_bf16 v[92:95], a[112:115], v[52:55], v[92:95]
    v_fma_f32 v98, v102, 2.0, v98
    v_fma_f32 v99, v103, 2.0, v99
    v_mfma_f32_16x16x32_bf16 v[92:95], a[116:119], v[52:55], v[92:95]
    v_cndmask_b32 v3, 0, v96, s[44:45]
    v_cndmask_b32 v3, v3, v97, s[46:47]
    v_mfma_f32_16x16x32_bf16 v[88:91], a[96:99], v[136:139], v[76:79]
    v_cndmask_b32 v3, v3, v98, s[48:49]
    v_cndmask_b32 v3, v3, v99, s[50:51]
    v_mfma_f32_16x16x32_bf16 v[88:91], a[100:103], v[140:143], v[88:91]
    s_nop 0
    s_nop 0
    v_mfma_f32_16x16x32_bf16 v[88:91], a[104:107], v[144:147], v[88:91]
    v_mfma_f32_16x16x4_f32 v[120:123], v3, v60, v[56:59]
    v_mfma_f32_16x16x32_bf16 v[88:91], a[108:111], v[148:151], v[88:91]
    v_mfma_f32_16x16x32_bf16 v[88:91], a[112:115], v[152:155], v[88:91]
    v_mfma_f32_16x16x32_bf16 v[88:91], a[116:119], v[156:159], v[88:91]
    s_waitcnt lgkmcnt(0)
    s_barrier
    v_mfma_f32_16x16x32_bf16 v[112:115], a[120:123], a[120:123], v[84:87]
    s_add_u32 m0, s42, 0
    s_add_u32 s59, s37, 245760
    buffer_load_dwordx4 v22, s[24:27], s59 offen offset:0 nt lds
    v_mfma_f32_16x16x32_bf16 v[116:119], a[120:123], a[48:51], 0
    buffer_load_dwordx4 v23, s[24:27], s59 offen offset:1024 nt lds
    v_mfma_f32_16x16x32_bf16 v[112:115], a[124:127], a[124:127], v[112:115]
    buffer_load_dwordx4 v24, s[24:27], s59 offen offset:2048 nt lds
    v_mfma_f32_16x16x32_bf16 v[116:119], a[124:127], a[52:55], v[116:119]
    buffer_load_dwordx4 v25, s[24:27], s59 offen offset:3072 nt lds
    v_fma_f32 v128, -v92, v92, v120
    v_fma_f32 v129, -v93, v93, v121
    v_mfma_f32_16x16x32_bf16 v[112:115], a[128:131], a[128:131], v[112:115]
    v_fma_f32 v130, -v94, v94, v122
    v_fma_f32 v131, -v95, v95, v123
    v_mfma_f32_16x16x32_bf16 v[116:119], a[128:131], a[56:59], v[116:119]
    v_max_f32 v128, v128, v56
    v_max_f32 v129, v129, v56
    v_mfma_f32_16x16x32_bf16 v[112:115], a[132:135], a[132:135], v[112:115]
    v_max_f32 v130, v130, v56
    v_max_f32 v131, v131, v56
    v_mfma_f32_16x16x32_bf16 v[116:119], a[132:135], a[60:63], v[116:119]
    s_add_u32 m0, s42, 4096
    s_nop 0
    buffer_load_dwordx4 v26, s[24:27], s59 offen offset:0 nt lds
    v_rsq_f32 v128, v128
    v_mfma_f32_16x16x32_bf16 v[112:115], a[136:139], a[136:139], v[112:115]
    v_rsq_f32 v129, v129
    v_mfma_f32_16x16x32_bf16 v[116:119], a[136:139], a[64:67], v[116:119]
    v_rsq_f32 v130, v130
    v_mfma_f32_16x16x32_bf16 v[112:115], a[140:143], a[140:143], v[112:115]
    v_rsq_f32 v131, v131
    v_mfma_f32_16x16x32_bf16 v[116:119], a[140:143], a[68:71], v[116:119]
    v_fma_f32 v88, -v92, v61, v88
    v_fma_f32 v89, -v93, v61, v89
    v_mfma_f32_16x16x32_bf16 v[108:111], a[120:123], v[52:55], v[80:83]
    v_fma_f32 v90, -v94, v61, v90
    v_fma_f32 v91, -v95, v61, v91
    v_mfma_f32_16x16x32_bf16 v[108:111], a[124:127], v[52:55], v[108:111]
    v_fma_f32 v88, v88, v128, v62
    v_fma_f32 v89, v89, v129, v62
    v_mfma_f32_16x16x32_bf16 v[108:111], a[128:131], v[52:55], v[108:111]
    v_fma_f32 v90, v90, v130, v62
    v_fma_f32 v91, v91, v131, v62
    v_mfma_f32_16x16x32_bf16 v[108:111], a[132:135], v[52:55], v[108:111]
    v_max3_f32 v1, v88, v89, v90
    v_max_f32 v1, v1, v91
    v_mfma_f32_16x16x32_bf16 v[108:111], a[136:139], v[52:55], v[108:111]
    v_cmp_lt_f32 vcc, s52, v1
    s_cbranch_vccnz L_site0
L_back0:
    v_mfma_f32_16x16x32_bf16 v[108:111], a[140:143], v[52:55], v[108:111]
    v_exp_f32 v96, v88
    v_mfma_f32_16x16x32_bf16 v[104:107], a[120:123], v[136:139], v[76:79]
    v_exp_f32 v97, v89
    v_mfma_f32_16x16x32_bf16 v[104:107], a[124:127], v[140:143], v[104:107]
    v_exp_f32 v98, v90
    v_mfma_f32_16x16x32_bf16 v[104:107], a[128:131], v[144:147], v[104:107]
    buffer_load_dwordx4 v27, s[24:27], s59 offen offset:1024 nt lds
    v_exp_f32 v99, v91
    v_mfma_f32_16x16x32_bf16 v[104:107], a[132:135], v[148:151], v[104:107]
    v_mul_f32 v88, v96, v128
    v_mul_f32 v89, v97, v129
    v_mfma_f32_16x16x32_bf16 v[104:107], a[136:139], v[152:155], v[104:107]
    v_mul_f32 v90, v98, v130
    v_mul_f32 v91, v99, v131
    v_mfma_f32_16x16x32_bf16 v[104:107], a[140:143], v[156:159], v[104:107]
    v_fma_f32 v112, v116, 2.0, v112
    v_fma_f32 v113, v117, 2.0, v113
    v_fma_f32 v114, v118, 2.0, v114
    v_fma_f32 v115, v119, 2.0, v115
    v_cndmask_b32 v4, 0, v112, s[44:45]
    v_cndmask_b32 v4, v4, v113, s[46:47]
    v_cndmask_b32 v4, v4, v114, s[48:49]
    v_cndmask_b32 v4, v4, v115, s[50:51]
    v_add_f32 v63, v63, v96
    v_fmac_f32 v64, v88, v92
    v_mfma_f32_16x16x4_f32 v[124:127], v4, v60, v[56:59]
    v_add_f32 v63, v63, v97
    v_fmac_f32 v64, v89, v93
    v_add_f32 v63, v63, v98
    v_fmac_f32 v64, v90, v94
    v_add_f32 v63, v63, v99
    v_fmac_f32 v64, v91, v95
    v_add_f32 v68, v68, v88
    v_add_f32 v69, v69, v89
    v_add_f32 v70, v70, v90
    v_add_f32 v71, v71, v91
    v_add_u32 v44, -49152, v44
    v_add_u32 v45, -49152, v45
    v_add_u32 v46, -49152, v46
    v_add_u32 v47, -49152, v47
    v_add_u32 v48, -49152, v48
    v_add_u32 v49, -49152, v49
    v_fma_f32 v132, -v108, v108, v124
    v_fma_f32 v133, -v109, v109, v125
    v_fma_f32 v134, -v110, v110, v126
    v_fma_f32 v135, -v111, v111, v127
    v_max_f32 v132, v132, v56
    v_max_f32 v133, v133, v56
    v_max_f32 v134, v134, v56
    v_max_f32 v135, v135, v56
    v_rsq_f32 v132, v132
    v_rsq_f32 v133, v133
    v_rsq_f32 v134, v134
    v_rsq_f32 v135, v135
    buffer_load_dwordx4 v28, s[24:27], s59 offen offset:2048 nt lds
    v_fma_f32 v104, -v108, v61, v104
    v_fma_f32 v105, -v109, v61, v105
    v_fma_f32 v106, -v110, v61, v106
    v_fma_f32 v107, -v111, v61, v107
    v_fma_f32 v104, v104, v132, v62
    v_fma_f32 v105, v105, v133, v62
    v_fma_f32 v106, v106, v134, v62
    v_fma_f32 v107, v107, v135, v62
    v_max3_f32 v1, v104, v105, v106
    v_max_f32 v1, v1, v107
    v_cmp_lt_f32 vcc, s52, v1
    s_cbranch_vccnz L_site1
L_back1:
    v_exp_f32 v112, v104
    v_exp_f32 v113, v105
    v_exp_f32 v114, v106
    v_exp_f32 v115, v107
    v_cvt_pk_bf16_f32 v72, v88, v89
    v_cvt_pk_bf16_f32 v73, v90, v91
    v_mul_f32 v104, v112, v132
    v_mul_f32 v105, v113, v133
    v_mul_f32 v106, v114, v134
    v_mul_f32 v107, v115, v135
    v_cvt_pk_bf16_f32 v74, v104, v105
    v_cvt_pk_bf16_f32 v75, v106, v107
    ds_write_b128 v237, v[72:75] offset:0
    v_add_f32 v68, v68, v104
    v_add_f32 v69, v69, v105
    v_add_f32 v70, v70, v106
    v_add_f32 v71, v71, v107
    v_cvt_pk_bf16_f32 v66, v68, v69
    v_cvt_pk_bf16_f32 v67, v70, v71
    ds_write_b64 v238, v[66:67]
    buffer_load_dwordx4 v29, s[24:27], s59 offen offset:3072 nt lds
    s_waitcnt vmcnt(20)
    s_waitcnt lgkmcnt(0)
    s_barrier
L_post3:
    ds_read_b32 v9, v254 offset:4096
    ds_read_b64 v[120:121], v254 offset:0
    ds_read_b64 v[122:123], v254 offset:512
    ds_read_b64 v[124:125], v254 offset:1024
    ds_read_b64 v[126:127], v254 offset:1536
    ds_read_b128 v[92:95], v253 offset:0
    ds_read_b128 v[96:99], v253 offset:1024
    ds_read_b128 v[100:103], v253 offset:2048
    ds_read_b128 v[116:119], v253 offset:3072
    ds_read_b128 a[48:51], v34 offset:0
    ds_read_b128 a[52:55], v35 offset:0
    ds_read_b128 a[56:59], v34 offset:128
    ds_read_b128 a[60:63], v35 offset:128
    ds_read_b128 a[64:67], v34 offset:256
    ds_read_b128 a[68:71], v35 offset:256
    s_waitcnt lgkmcnt(14)
    v_cmp_ne_u32 vcc, 0, v9
    s_cbranch_vccnz L_xt3
    s_waitcnt lgkmcnt(12)
    v_mfma_f32_16x16x32_bf16 a[0:3], a[72:75], v[120:123], a[0:3]
    v_add_f32 v63, v63, v112
    v_fma_f32 v64, v104, v108, v64
    v_mfma_f32_16x16x32_bf16 a[4:7], a[80:83], v[120:123], a[4:7]
    v_add_f32 v63, v63, v113
    v_fma_f32 v64, v105, v109, v64
    v_mfma_f32_16x16x32_bf16 a[8:11], a[88:91], v[120:123], a[8:11]
    s_add_u32 m0, s42, 8192
    s_nop 0
    buffer_load_dwordx4 v30, s[24:27], s59 offen offset:0 nt lds
    v_add_f32 v63, v63, v114
    v_fma_f32 v64, v106, v110, v64
    s_waitcnt lgkmcnt(10)
    v_mfma_f32_16x16x32_bf16 a[0:3], a[76:79], v[124:127], a[0:3]
    v_add_f32 v63, v63, v115
    v_fma_f32 v64, v107, v111, v64
    v_mfma_f32_16x16x32_bf16 a[4:7], a[84:87], v[124:127], a[4:7]
    v_mfma_f32_16x16x32_bf16 a[8:11], a[92:95], v[124:127], a[8:11]
    s_waitcnt lgkmcnt(9)
    v_mfma_f32_16x16x32_bf16 a[0:3], a[144:147], v[92:95], a[0:3]
    ds_read_b64_tr_b16 a[72:73], v36 offset:0
    ds_read_b64_tr_b16 a[74:75], v36 offset:6144
    v_mfma_f32_16x16x32_bf16 a[4:7], a[160:163], v[92:95], a[4:7]
    ds_read_b64_tr_b16 a[76:77], v36 offset:12288
    ds_read_b64_tr_b16 a[78:79], v36 offset:18432
    v_mfma_f32_16x16x32_bf16 a[8:11], a[176:179], v[92:95], a[8:11]
    ds_read_b64_tr_b16 a[80:81], v37 offset:0
    ds_read_b64_tr_b16 a[82:83], v37 offset:6144
    s_waitcnt lgkmcnt(14)
    v_mfma_f32_16x16x32_bf16 a[0:3], a[148:151], v[96:99], a[0:3]
    ds_read_b64_tr_b16 a[84:85], v37 offset:12288
    ds_read_b64_tr_b16 a[86:87], v37 offset:18432
    v_mfma_f32_16x16x32_bf16 a[4:7], a[164:167], v[96:99], a[4:7]
    ds_read_b64_tr_b16 a[88:89], v38 offset:0
    ds_read_b64_tr_b16 a[90:91], v38 offset:6144
    v_mfma_f32_16x16x32_bf16 a[8:11], a[180:183], v[96:99], a[8:11]
    ds_read_b64_tr_b16 a[92:93], v38 offset:12288
    ds_read_b64_tr_b16 a[94:95], v38 offset:18432
    s_waitcnt lgkmcnt(15)
    v_mfma_f32_16x16x32_bf16 a[0:3], a[152:155], v[100:103], a[0:3]
    buffer_load_dwordx4 v31, s[24:27], s59 offen offset:1024 nt lds
    v_mfma_f32_16x16x32_bf16 a[4:7], a[168:171], v[100:103], a[4:7]
    v_mfma_f32_16x16x32_bf16 a[8:11], a[184:187], v[100:103], a[8:11]
    v_mfma_f32_16x16x32_bf16 a[0:3], a[156:159], v[116:119], a[0:3]
    v_mfma_f32_16x16x32_bf16 a[4:7], a[172:175], v[116:119], a[4:7]
    v_mfma_f32_16x16x32_bf16 a[8:11], a[188:191], v[116:119], a[8:11]
    v_mfma_f32_16x16x32_bf16 v[84:87], a[48:51], a[48:51], 0
    v_mfma_f32_16x16x32_bf16 v[80:83], a[48:51], v[52:55], 0
    v_mfma_f32_16x16x32_bf16 v[84:87], a[52:55], a[52:55], v[84:87]
    v_mfma_f32_16x16x32_bf16 v[80:83], a[52:55], v[52:55], v[80:83]
    v_mfma_f32_16x16x32_bf16 v[84:87], a[56:59], a[56:59], v[84:87]
    v_mfma_f32_16x16x32_bf16 v[80:83], a[56:59], v[52:55], v[80:83]
    s_waitcnt lgkmcnt(14)
    v_mfma_f32_16x16x32_bf16 v[84:87], a[60:63], a[60:63], v[84:87]
    v_mfma_f32_16x16x32_bf16 v[80:83], a[60:63], v[52:55], v[80:83]
    s_waitcnt lgkmcnt(13)
    v_mfma_f32_16x16x32_bf16 v[84:87], a[64:67], a[64:67], v[84:87]
    buffer_load_dwordx4 v32, s[24:27], s59 offen offset:2048 nt lds
    v_mfma_f32_16x16x32_bf16 v[80:83], a[64:67], v[52:55], v[80:83]
    s_waitcnt lgkmcnt(12)
    v_mfma_f32_16x16x32_bf16 v[84:87], a[68:71], a[68:71], v[84:87]
    v_mfma_f32_16x16x32_bf16 v[80:83], a[68:71], v[52:55], v[80:83]
    s_waitcnt lgkmcnt(0)
    v_mfma_f32_16x16x32_bf16 v[76:79], a[48:51], v[136:139], 0
    v_mfma_f32_16x16x32_bf16 v[76:79], a[52:55], v[140:143], v[76:79]
    v_mfma_f32_16x16x32_bf16 v[76:79], a[56:59], v[144:147], v[76:79]
    v_mfma_f32_16x16x32_bf16 v[76:79], a[60:63], v[148:151], v[76:79]
    v_mfma_f32_16x16x32_bf16 v[76:79], a[64:67], v[152:155], v[76:79]
    v_mfma_f32_16x16x32_bf16 v[76:79], a[68:71], v[156:159], v[76:79]
    v_lshrrev_b32 v1, 3, v0
    v_and_b32 v2, 6, v1
    v_xor_b32 v2, v0, v2
    v_and_b32 v2, 7, v2
    v_mul_u32_u24 v1, 768, v1
    v_lshl_add_u32 v224, v2, 4, v1
    v_xor_b32 v225, 16, v224
    v_add_u32 v225, 5120, v225
    buffer_load_dwordx4 v33, s[24:27], s59 offen offset:3072 nt lds
    s_waitcnt vmcnt(12)
    s_barrier
    ds_read_b128 a[96:99], v40 offset:0
    ds_read_b128 a[100:103], v41 offset:0
    ds_read_b128 a[104:107], v42 offset:0
    ds_read_b128 a[108:111], v43 offset:0
    ds_read_b128 a[112:115], v40 offset:256
    ds_read_b128 a[116:119], v41 offset:256
    ds_read_b128 a[120:123], v42 offset:256
    ds_read_b128 a[124:127], v43 offset:256
    ds_read_b128 a[128:131], v40 offset:512
    ds_read_b128 a[132:135], v41 offset:512
    ds_read_b128 a[136:139], v42 offset:512
    ds_read_b128 a[140:143], v43 offset:512
    s_waitcnt lgkmcnt(11)
    v_mfma_f32_16x16x32_bf16 v[96:99], a[96:99], a[96:99], v[84:87]
    ds_read_b64_tr_b16 a[144:145], v44 offset:0
    ds_read_b64_tr_b16 a[146:147], v45 offset:0
    v_mfma_f32_16x16x32_bf16 v[100:103], a[96:99], a[48:51], 0
    ds_read_b64_tr_b16 a[148:149], v44 offset:12288
    ds_read_b64_tr_b16 a[150:151], v45 offset:12288
    s_waitcnt lgkmcnt(14)
    v_mfma_f32_16x16x32_bf16 v[96:99], a[100:103], a[100:103], v[96:99]
    ds_read_b64_tr_b16 a[152:153], v44 offset:24576
    ds_read_b64_tr_b16 a[154:155], v45 offset:24576
    v_mfma_f32_16x16x32_bf16 v[100:103], a[100:103], a[52:55], v[100:103]
    ds_read_b64_tr_b16 a[156:157], v44 offset:36864
    ds_read_b64_tr_b16 a[158:159], v45 offset:36864
    s_waitcnt lgkmcnt(15)
    v_mfma_f32_16x16x32_bf16 v[96:99], a[104:107], a[104:107], v[96:99]
    ds_read_b64_tr_b16 a[160:161], v46 offset:0
    ds_read_b64_tr_b16 a[162:163], v47 offset:0
    v_mfma_f32_16x16x32_bf16 v[100:103], a[104:107], a[56:59], v[100:103]
    s_add_u32 m0, s40, 0
    s_add_u32 s57, s36, 49152
    buffer_load_dwordx4 v16, s[28:31], s57 offen offset:0 nt lds
    ds_read_b64_tr_b16 a[164:165], v46 offset:12288
    ds_read_b64_tr_b16 a[166:167], v47 offset:12288
    v_mfma_f32_16x16x32_bf16 v[96:99], a[108:111], a[108:111], v[96:99]
    ds_read_b64_tr_b16 a[168:169], v46 offset:24576
    ds_read_b64_tr_b16 a[170:171], v47 offset:24576
    v_mfma_f32_16x16x32_bf16 v[100:103], a[108:111], a[60:63], v[100:103]
    ds_read_b64_tr_b16 a[172:173], v46 offset:36864
    ds_read_b64_tr_b16 a[174:175], v47 offset:36864
    v_mfma_f32_16x16x32_bf16 v[96:99], a[112:115], a[112:115], v[96:99]
    ds_read_b64_tr_b16 a[176:177], v48 offset:0
    ds_read_b64_tr_b16 a[178:179], v49 offset:0
    v_mfma_f32_16x16x32_bf16 v[100:103], a[112:115], a[64:67], v[100:103]
    ds_read_b64_tr_b16 a[180:181], v48 offset:12288
    ds_read_b64_tr_b16 a[182:183], v49 offset:12288
    s_waitcnt lgkmcnt(15)
    v_mfma_f32_16x16x32_bf16 v[96:99], a[116:119], a[116:119], v[96:99]
    ds_read_b64_tr_b16 a[184:185], v48 offset:24576
    ds_read_b64_tr_b16 a[186:187], v49 offset:24576
    v_mfma_f32_16x16x32_bf16 v[100:103], a[116:119], a[68:71], v[100:103]
    ds_read_b64_tr_b16 a[188:189], v48 offset:36864
    ds_read_b64_tr_b16 a[190:191], v49 offset:36864
    v_mfma_f32_16x16x32_bf16 v[92:95], a[96:99], v[52:55], v[80:83]
    v_mfma_f32_16x16x32_bf16 v[92:95], a[100:103], v[52:55], v[92:95]
    v_mfma_f32_16x16x32_bf16 v[92:95], a[104:107], v[52:55], v[92:95]
    v_mfma_f32_16x16x32_bf16 v[92:95], a[108:111], v[52:55], v[92:95]
    s_nop 1
    v_fma_f32 v96, v100, 2.0, v96
    v_fma_f32 v97, v101, 2.0, v97
    v_mfma_f32_16x16x32_bf16 v[92:95], a[112:115], v[52:55], v[92:95]
    buffer_load_dwordx4 v17, s[28:31], s57 offen offset:1024 nt lds
    v_fma_f32 v98, v102, 2.0, v98
    v_fma_f32 v99, v103, 2.0, v99
    v_mfma_f32_16x16x32_bf16 v[92:95], a[116:119], v[52:55], v[92:95]
    v_cndmask_b32 v3, 0, v96, s[44:45]
    v_cndmask_b32 v3, v3, v97, s[46:47]
    v_mfma_f32_16x16x32_bf16 v[88:91], a[96:99], v[136:139], v[76:79]
    v_cndmask_b32 v3, v3, v98, s[48:49]
    v_cndmask_b32 v3, v3, v99, s[50:51]
    v_mfma_f32_16x16x32_bf16 v[88:91], a[100:103], v[140:143], v[88:91]
    s_nop 0
    s_nop 0
    v_mfma_f32_16x16x32_bf16 v[88:91], a[104:107], v[144:147], v[88:91]
    v_mfma_f32_16x16x4_f32 v[120:123], v3, v60, v[56:59]
    v_mfma_f32_16x16x32_bf16 v[88:91], a[108:111], v[148:151], v[88:91]
    v_mfma_f32_16x16x32_bf16 v[88:91], a[112:115], v[152:155], v[88:91]
    v_mfma_f32_16x16x32_bf16 v[88:91], a[116:119], v[156:159], v[88:91]
    v_mfma_f32_16x16x32_bf16 v[112:115], a[120:123], a[120:123], v[84:87]
    v_mfma_f32_16x16x32_bf16 v[116:119], a[120:123], a[48:51], 0
    v_mfma_f32_16x16x32_bf16 v[112:115], a[124:127], a[124:127], v[112:115]
    v_mfma_f32_16x16x32_bf16 v[116:119], a[124:127], a[52:55], v[116:119]
    buffer_load_dwordx4 v18, s[28:31], s57 offen offset:2048 nt lds
    s_nop 1
    v_fma_f32 v128, -v92, v92, v120
    v_fma_f32 v129, -v93, v93, v121
    v_mfma_f32_16x16x32_bf16 v[112:115], a[128:131], a[128:131], v[112:115]
    v_fma_f32 v130, -v94, v94, v122
    v_fma_f32 v131, -v95, v95, v123
    v_mfma_f32_16x16x32_bf16 v[116:119], a[128:131], a[56:59], v[116:119]
    v_max_f32 v128, v128, v56
    v_max_f32 v129, v129, v56
    v_mfma_f32_16x16x32_bf16 v[112:115], a[132:135], a[132:135], v[112:115]
    v_max_f32 v130, v130, v56
    v_max_f32 v131, v131, v56
    v_mfma_f32_16x16x32_bf16 v[116:119], a[132:135], a[60:63], v[116:119]
    v_rsq_f32 v128, v128
    v_mfma_f32_16x16x32_bf16 v[112:115], a[136:139], a[136:139], v[112:115]
    v_rsq_f32 v129, v129
    v_mfma_f32_16x16x32_bf16 v[116:119], a[136:139], a[64:67], v[116:119]
    v_rsq_f32 v130, v130
    v_mfma_f32_16x16x32_bf16 v[112:115], a[140:143], a[140:143], v[112:115]
    v_rsq_f32 v131, v131
    v_mfma_f32_16x16x32_bf16 v[116:119], a[140:143], a[68:71], v[116:119]
    v_fma_f32 v88, -v92, v61, v88
    v_fma_f32 v89, -v93, v61, v89
    v_mfma_f32_16x16x32_bf16 v[108:111], a[120:123], v[52:55], v[80:83]
    v_fma_f32 v90, -v94, v61, v90
    v_fma_f32 v91, -v95, v61, v91
    v_mfma_f32_16x16x32_bf16 v[108:111], a[124:127], v[52:55], v[108:111]
    v_fma_f32 v88, v88, v128, v62
    v_fma_f32 v89, v89, v129, v62
    v_mfma_f32_16x16x32_bf16 v[108:111], a[128:131], v[52:55], v[108:111]
    v_fma_f32 v90, v90, v130, v62
    v_fma_f32 v91, v91, v131, v62
    v_mfma_f32_16x16x32_bf16 v[108:111], a[132:135], v[52:55], v[108:111]
    v_max3_f32 v1, v88, v89, v90
    v_max_f32 v1, v1, v91
    v_mfma_f32_16x16x32_bf16 v[108:111], a[136:139], v[52:55], v[108:111]
    buffer_load_dwordx4 v19, s[28:31], s57 offen offset:3072 nt lds
    v_cmp_lt_f32 vcc, s52, v1
    s_cbranch_vccnz L_site2
L_back2:
    v_mfma_f32_16x16x32_bf16 v[108:111], a[140:143], v[52:55], v[108:111]
    v_exp_f32 v96, v88
    v_mfma_f32_16x16x32_bf16 v[104:107], a[120:123], v[136:139], v[76:79]
    v_exp_f32 v97, v89
    v_mfma_f32_16x16x32_bf16 v[104:107], a[124:127], v[140:143], v[104:107]
    v_exp_f32 v98, v90
    v_mfma_f32_16x16x32_bf16 v[104:107], a[128:131], v[144:147], v[104:107]
    v_exp_f32 v99, v91
    v_mfma_f32_16x16x32_bf16 v[104:107], a[132:135], v[148:151], v[104:107]
    v_mul_f32 v88, v96, v128
    v_mul_f32 v89, v97, v129
    v_mfma_f32_16x16x32_bf16 v[104:107], a[136:139], v[152:155], v[104:107]
    v_mul_f32 v90, v98, v130
    v_mul_f32 v91, v99, v131
    v_mfma_f32_16x16x32_bf16 v[104:107], a[140:143], v[156:159], v[104:107]
    v_fma_f32 v112, v116, 2.0, v112
    v_fma_f32 v113, v117, 2.0, v113
    v_fma_f32 v114, v118, 2.0, v114
    v_fma_f32 v115, v119, 2.0, v115
    v_cndmask_b32 v4, 0, v112, s[44:45]
    v_cndmask_b32 v4, v4, v113, s[46:47]
    v_cndmask_b32 v4, v4, v114, s[48:49]
    v_cndmask_b32 v4, v4, v115, s[50:51]
    v_add_f32 v63, v63, v96
    v_fmac_f32 v64, v88, v92
    v_mfma_f32_16x16x4_f32 v[124:127], v4, v60, v[56:59]
    v_add_f32 v63, v63, v97
    v_fmac_f32 v64, v89, v93
    v_add_f32 v63, v63, v98
    v_fmac_f32 v64, v90, v94
    v_add_f32 v63, v63, v99
    v_fmac_f32 v64, v91, v95
    v_mov_b32 v68, v88
    v_mov_b32 v69, v89
    v_mov_b32 v70, v90
    v_mov_b32 v71, v91
    v_add_u32 v44, 49152, v44
    v_add_u32 v45, 49152, v45
    v_add_u32 v46, 49152, v46
    v_add_u32 v47, 49152, v47
    v_add_u32 v48, 49152, v48
    v_add_u32 v49, 49152, v49
    v_fma_f32 v132, -v108, v108, v124
    v_fma_f32 v133, -v109, v109, v125
    v_fma_f32 v134, -v110, v110, v126
    v_fma_f32 v135, -v111, v111, v127
    v_max_f32 v132, v132, v56
    v_max_f32 v133, v133, v56
    v_max_f32 v134, v134, v56
    v_max_f32 v135, v135, v56
    v_rsq_f32 v132, v132
    v_rsq_f32 v133, v133
    v_rsq_f32 v134, v134
    v_rsq_f32 v135, v135
    s_add_u32 m0, s40, 4096
    s_nop 0
    buffer_load_dwordx4 v20, s[28:31], s57 offen offset:0 nt lds
    v_fma_f32 v104, -v108, v61, v104
    v_fma_f32 v105, -v109, v61, v105
    v_fma_f32 v106, -v110, v61, v106
    v_fma_f32 v107, -v111, v61, v107
    v_fma_f32 v104, v104, v132, v62
    v_fma_f32 v105, v105, v133, v62
    v_fma_f32 v106, v106, v134, v62
    v_fma_f32 v107, v107, v135, v62
    v_max3_f32 v1, v104, v105, v106
    v_max_f32 v1, v1, v107
    v_cmp_lt_f32 vcc, s52, v1
    s_cbranch_vccnz L_site3
L_back3:
    v_exp_f32 v112, v104
    v_exp_f32 v113, v105
    v_exp_f32 v114, v106
    v_exp_f32 v115, v107
    v_cvt_pk_bf16_f32 v72, v88, v89
    v_cvt_pk_bf16_f32 v73, v90, v91
    v_mul_f32 v104, v112, v132
    v_mul_f32 v105, v113, v133
    v_mul_f32 v106, v114, v134
    v_mul_f32 v107, v115, v135
    v_cvt_pk_bf16_f32 v74, v104, v105
    v_cvt_pk_bf16_f32 v75, v106, v107
    ds_write_b128 v237, v[72:75] offset:0
    s_waitcnt lgkmcnt(0)
    s_barrier
L_post24:
    ds_read_b32 v9, v254 offset:4096
    ds_read_b128 v[92:95], v253 offset:0
    ds_read_b128 v[96:99], v253 offset:1024
    ds_read_b128 v[100:103], v253 offset:2048
    ds_read_b128 v[116:119], v253 offset:3072
    s_waitcnt lgkmcnt(4)
    v_cmp_ne_u32 vcc, 0, v9
    s_cbranch_vccnz L_xt24
    s_waitcnt lgkmcnt(3)
    v_mfma_f32_16x16x32_bf16 a[0:3], a[144:147], v[92:95], a[0:3]
    buffer_load_dwordx4 v21, s[28:31], s57 offen offset:1024 nt lds
    v_add_f32 v68, v68, v104
    v_add_f32 v69, v69, v105
    v_mfma_f32_16x16x32_bf16 a[4:7], a[160:163], v[92:95], a[4:7]
    buffer_load_dword v244, v245, s[32:35], 0 offen offset:128 sc1
    v_add_f32 v70, v70, v106
    v_add_f32 v71, v71, v107
    v_mfma_f32_16x16x32_bf16 a[8:11], a[176:179], v[92:95], a[8:11]
    v_add_f32 v63, v63, v112
    v_fma_f32 v64, v104, v108, v64
    s_waitcnt lgkmcnt(2)
    v_mfma_f32_16x16x32_bf16 a[0:3], a[148:151], v[96:99], a[0:3]
    v_add_f32 v63, v63, v113
    v_fma_f32 v64, v105, v109, v64
    v_mfma_f32_16x16x32_bf16 a[4:7], a[164:167], v[96:99], a[4:7]
    v_add_f32 v63, v63, v114
    v_fma_f32 v64, v106, v110, v64
    v_mfma_f32_16x16x32_bf16 a[8:11], a[180:183], v[96:99], a[8:11]
    v_add_f32 v63, v63, v115
    v_fma_f32 v64, v107, v111, v64
    s_waitcnt lgkmcnt(1)
    v_mfma_f32_16x16x32_bf16 a[0:3], a[152:155], v[100:103], a[0:3]
    v_mfma_f32_16x16x32_bf16 a[4:7], a[168:171], v[100:103], a[4:7]
    s_add_u32 m0, s41, 0
    s_add_u32 s58, s37, 98304
    buffer_load_dwordx4 v22, s[24:27], s58 offen offset:0 nt lds
    v_mfma_f32_16x16x32_bf16 a[8:11], a[184:187], v[100:103], a[8:11]
    s_waitcnt lgkmcnt(0)
    v_mfma_f32_16x16x32_bf16 a[0:3], a[156:159], v[116:119], a[0:3]
    v_mfma_f32_16x16x32_bf16 a[4:7], a[172:175], v[116:119], a[4:7]
    v_mfma_f32_16x16x32_bf16 a[8:11], a[188:191], v[116:119], a[8:11]
    buffer_load_dwordx4 v23, s[24:27], s58 offen offset:1024 nt lds
    buffer_load_dwordx4 v24, s[24:27], s58 offen offset:2048 nt lds
    buffer_load_dwordx4 v25, s[24:27], s58 offen offset:3072 nt lds
    s_add_u32 m0, s41, 4096
    s_nop 0
    buffer_load_dwordx4 v26, s[24:27], s58 offen offset:0 nt lds
    s_waitcnt vmcnt(12)
    s_barrier
    ds_read_b128 a[96:99], v40 offset:49152
    ds_read_b128 a[100:103], v41 offset:49152
    ds_read_b128 a[104:107], v42 offset:49152
    ds_read_b128 a[108:111], v43 offset:49152
    ds_read_b128 a[112:115], v40 offset:49408
    ds_read_b128 a[116:119], v41 offset:49408
    ds_read_b128 a[120:123], v42 offset:49408
    ds_read_b128 a[124:127], v43 offset:49408
    ds_read_b128 a[128:131], v40 offset:49664
    ds_read_b128 a[132:135], v41 offset:49664
    ds_read_b128 a[136:139], v42 offset:49664
    ds_read_b128 a[140:143], v43 offset:49664
    s_waitcnt lgkmcnt(11)
    v_mfma_f32_16x16x32_bf16 v[96:99], a[96:99], a[96:99], v[84:87]
    ds_read_b64_tr_b16 a[144:145], v44 offset:0
    ds_read_b64_tr_b16 a[146:147], v45 offset:0
    v_mfma_f32_16x16x32_bf16 v[100:103], a[96:99], a[48:51], 0
    ds_read_b64_tr_b16 a[148:149], v44 offset:12288
    ds_read_b64_tr_b16 a[150:151], v45 offset:12288
    s_waitcnt lgkmcnt(14)
    v_mfma_f32_16x16x32_bf16 v[96:99], a[100:103], a[100:103], v[96:99]
    ds_read_b64_tr_b16 a[152:153], v44 offset:24576
    ds_read_b64_tr_b16 a[154:155], v45 offset:24576
    v_mfma_f32_16x16x32_bf16 v[100:103], a[100:103], a[52:55], v[100:103]
    ds_read_b64_tr_b16 a[156:157], v44 offset:36864
    ds_read_b64_tr_b16 a[158:159], v45 offset:36864
    s_waitcnt lgkmcnt(15)
    v_mfma_f32_16x16x32_bf16 v[96:99], a[104:107], a[104:107], v[96:99]
    ds_read_b64_tr_b16 a[160:161], v46 offset:0
    ds_read_b64_tr_b16 a[162:163], v47 offset:0
    v_mfma_f32_16x16x32_bf16 v[100:103], a[104:107], a[56:59], v[100:103]
    ds_read_b64_tr_b16 a[164:165], v46 offset:12288
    ds_read_b64_tr_b16 a[166:167], v47 offset:12288
    v_mfma_f32_16x16x32_bf16 v[96:99], a[108:111], a[108:111], v[96:99]
    buffer_load_dwordx4 v27, s[24:27], s58 offen offset:1024 nt lds
    ds_read_b64_tr_b16 a[168:169], v46 offset:24576
    ds_read_b64_tr_b16 a[170:171], v47 offset:24576
    v_mfma_f32_16x16x32_bf16 v[100:103], a[108:111], a[60:63], v[100:103]
    ds_read_b64_tr_b16 a[172:173], v46 offset:36864
    ds_read_b64_tr_b16 a[174:175], v47 offset:36864
    v_mfma_f32_16x16x32_bf16 v[96:99], a[112:115], a[112:115], v[96:99]
    ds_read_b64_tr_b16 a[176:177], v48 offset:0
    ds_read_b64_tr_b16 a[178:179], v49 offset:0
    v_mfma_f32_16x16x32_bf16 v[100:103], a[112:115], a[64:67], v[100:103]
    ds_read_b64_tr_b16 a[180:181], v48 offset:12288
    ds_read_b64_tr_b16 a[182:183], v49 offset:12288
    s_waitcnt lgkmcnt(15)
    v_mfma_f32_16x16x32_bf16 v[96:99], a[116:119], a[116:119], v[96:99]
    ds_read_b64_tr_b16 a[184:185], v48 offset:24576
    ds_read_b64_tr_b16 a[186:187], v49 offset:24576
    v_mfma_f32_16x16x32_bf16 v[100:103], a[116:119], a[68:71], v[100:103]
    ds_read_b64_tr_b16 a[188:189], v48 offset:36864
    ds_read_b64_tr_b16 a[190:191], v49 offset:36864
    v_mfma_f32_16x16x32_bf16 v[92:95], a[96:99], v[52:55], v[80:83]
    v_mfma_f32_16x16x32_bf16 v[92:95], a[100:103], v[52:55], v[92:95]
    v_mfma_f32_16x16x32_bf16 v[92:95], a[104:107], v[52:55], v[92:95]
    v_mfma_f32_16x16x32_bf16 v[92:95], a[108:111], v[52:55], v[92:95]
    s_nop 1
    v_fma_f32 v96, v100, 2.0, v96
    v_fma_f32 v97, v101, 2.0, v97
    v_mfma_f32_16x16x32_bf16 v[92:95], a[112:115], v[52:55], v[92:95]
    v_fma_f32 v98, v102, 2.0, v98
    v_fma_f32 v99, v103, 2.0, v99
    v_mfma_f32_16x16x32_bf16 v[92:95], a[116:119], v[52:55], v[92:95]
    v_cndmask_b32 v3, 0, v96, s[44:45]
    v_cndmask_b32 v3, v3, v97, s[46:47]
    v_mfma_f32_16x16x32_bf16 v[88:91], a[96:99], v[136:139], v[76:79]
    buffer_load_dwordx4 v28, s[24:27], s58 offen offset:2048 nt lds
    v_cndmask_b32 v3, v3, v98, s[48:49]
    v_cndmask_b32 v3, v3, v99, s[50:51]
    v_mfma_f32_16x16x32_bf16 v[88:91], a[100:103], v[140:143], v[88:91]
    s_nop 0
    s_nop 0
    v_mfma_f32_16x16x32_bf16 v[88:91], a[104:107], v[144:147], v[88:91]
    v_mfma_f32_16x16x4_f32 v[120:123], v3, v60, v[56:59]
    v_mfma_f32_16x16x32_bf16 v[88:91], a[108:111], v[148:151], v[88:91]
    v_mfma_f32_16x16x32_bf16 v[88:91], a[112:115], v[152:155], v[88:91]
    v_mfma_f32_16x16x32_bf16 v[88:91], a[116:119], v[156:159], v[88:91]
    v_mfma_f32_16x16x32_bf16 v[112:115], a[120:123], a[120:123], v[84:87]
    v_mfma_f32_16x16x32_bf16 v[116:119], a[120:123], a[48:51], 0
    v_mfma_f32_16x16x32_bf16 v[112:115], a[124:127], a[124:127], v[112:115]
    v_mfma_f32_16x16x32_bf16 v[116:119], a[124:127], a[52:55], v[116:119]
    s_nop 2
    v_fma_f32 v128, -v92, v92, v120
    v_fma_f32 v129, -v93, v93, v121
    v_mfma_f32_16x16x32_bf16 v[112:115], a[128:131], a[128:131], v[112:115]
    v_fma_f32 v130, -v94, v94, v122
    v_fma_f32 v131, -v95, v95, v123
    v_mfma_f32_16x16x32_bf16 v[116:119], a[128:131], a[56:59], v[116:119]
    buffer_load_dwordx4 v29, s[24:27], s58 offen offset:3072 nt lds
    v_max_f32 v128, v128, v56
    v_max_f32 v129, v129, v56
    v_mfma_f32_16x16x32_bf16 v[112:115], a[132:135], a[132:135], v[112:115]
    v_max_f32 v130, v130, v56
    v_max_f32 v131, v131, v56
    v_mfma_f32_16x16x32_bf16 v[116:119], a[132:135], a[60:63], v[116:119]
    v_rsq_f32 v128, v128
    v_mfma_f32_16x16x32_bf16 v[112:115], a[136:139], a[136:139], v[112:115]
    v_rsq_f32 v129, v129
    v_mfma_f32_16x16x32_bf16 v[116:119], a[136:139], a[64:67], v[116:119]
    v_rsq_f32 v130, v130
    v_mfma_f32_16x16x32_bf16 v[112:115], a[140:143], a[140:143], v[112:115]
    v_rsq_f32 v131, v131
    v_mfma_f32_16x16x32_bf16 v[116:119], a[140:143], a[68:71], v[116:119]
    v_fma_f32 v88, -v92, v61, v88
    v_fma_f32 v89, -v93, v61, v89
    v_mfma_f32_16x16x32_bf16 v[108:111], a[120:123], v[52:55], v[80:83]
    v_fma_f32 v90, -v94, v61, v90
    v_fma_f32 v91, -v95, v61, v91
    v_mfma_f32_16x16x32_bf16 v[108:111], a[124:127], v[52:55], v[108:111]
    v_fma_f32 v88, v88, v128, v62
    v_fma_f32 v89, v89, v129, v62
    v_mfma_f32_16x16x32_bf16 v[108:111], a[128:131], v[52:55], v[108:111]
    v_fma_f32 v90, v90, v130, v62
    v_fma_f32 v91, v91, v131, v62
    v_mfma_f32_16x16x32_bf16 v[108:111], a[132:135], v[52:55], v[108:111]
    v_max3_f32 v1, v88, v89, v90
    v_max_f32 v1, v1, v91
    v_mfma_f32_16x16x32_bf16 v[108:111], a[136:139], v[52:55], v[108:111]
    v_cmp_lt_f32 vcc, s52, v1
    s_cbranch_vccnz L_site4
L_back4:
    v_mfma_f32_16x16x32_bf16 v[108:111], a[140:143], v[52:55], v[108:111]
    v_exp_f32 v96, v88
    v_mfma_f32_16x16x32_bf16 v[104:107], a[120:123], v[136:139], v[76:79]
    s_add_u32 m0, s41, 8192
    s_nop 0
    buffer_load_dwordx4 v30, s[24:27], s58 offen offset:0 nt lds
    v_exp_f32 v97, v89
    v_mfma_f32_16x16x32_bf16 v[104:107], a[124:127], v[140:143], v[104:107]
    v_exp_f32 v98, v90
    v_mfma_f32_16x16x32_bf16 v[104:107], a[128:131], v[144:147], v[104:107]
    v_exp_f32 v99, v91
    v_mfma_f32_16x16x32_bf16 v[104:107], a[132:135], v[148:151], v[104:107]
    v_mul_f32 v88, v96, v128
    v_mul_f32 v89, v97, v129
    v_mfma_f32_16x16x32_bf16 v[104:107], a[136:139], v[152:155], v[104:107]
    v_mul_f32 v90, v98, v130
    v_mul_f32 v91, v99, v131
    v_mfma_f32_16x16x32_bf16 v[104:107], a[140:143], v[156:159], v[104:107]
    v_fma_f32 v112, v116, 2.0, v112
    v_fma_f32 v113, v117, 2.0, v113
    v_fma_f32 v114, v118, 2.0, v114
    v_fma_f32 v115, v119, 2.0, v115
    v_cndmask_b32 v4, 0, v112, s[44:45]
    v_cndmask_b32 v4, v4, v113, s[46:47]
    v_cndmask_b32 v4, v4, v114, s[48:49]
    v_cndmask_b32 v4, v4, v115, s[50:51]
    v_add_f32 v63, v63, v96
    v_fmac_f32 v64, v88, v92
    v_mfma_f32_16x16x4_f32 v[124:127], v4, v60, v[56:59]
    v_add_f32 v63, v63, v97
    v_fmac_f32 v64, v89, v93
    v_add_f32 v63, v63, v98
    v_fmac_f32 v64, v90, v94
    v_add_f32 v63, v63, v99
    v_fmac_f32 v64, v91, v95
    v_add_f32 v68, v68, v88
    v_add_f32 v69, v69, v89
    v_add_f32 v70, v70, v90
    v_add_f32 v71, v71, v91
    v_add_u32 v44, -49152, v44
    v_add_u32 v45, -49152, v45
    v_add_u32 v46, -49152, v46
    v_add_u32 v47, -49152, v47
    v_add_u32 v48, -49152, v48
    v_add_u32 v49, -49152, v49
    v_fma_f32 v132, -v108, v108, v124
    v_fma_f32 v133, -v109, v109, v125
    v_fma_f32 v134, -v110, v110, v126
    v_fma_f32 v135, -v111, v111, v127
    v_max_f32 v132, v132, v56
    v_max_f32 v133, v133, v56
    v_max_f32 v134, v134, v56
    v_max_f32 v135, v135, v56
    v_rsq_f32 v132, v132
    v_rsq_f32 v133, v133
    v_rsq_f32 v134, v134
    v_rsq_f32 v135, v135
    buffer_load_dwordx4 v31, s[24:27], s58 offen offset:1024 nt lds
    v_fma_f32 v104, -v108, v61, v104
    v_fma_f32 v105, -v109, v61, v105
    v_fma_f32 v106, -v110, v61, v106
    v_fma_f32 v107, -v111, v61, v107
    v_fma_f32 v104, v104, v132, v62
    v_fma_f32 v105, v105, v133, v62
    v_fma_f32 v106, v106, v134, v62
    v_fma_f32 v107, v107, v135, v62
    v_max3_f32 v1, v104, v105, v106
    v_max_f32 v1, v1, v107
    v_cmp_lt_f32 vcc, s52, v1
    s_cbranch_vccnz L_site5
L_back5:
    v_exp_f32 v112, v104
    v_exp_f32 v113, v105
    v_exp_f32 v114, v106
    v_exp_f32 v115, v107
    v_cvt_pk_bf16_f32 v72, v88, v89
    v_cvt_pk_bf16_f32 v73, v90, v91
    v_mul_f32 v104, v112, v132
    v_mul_f32 v105, v113, v133
    v_mul_f32 v106, v114, v134
    v_mul_f32 v107, v115, v135
    v_cvt_pk_bf16_f32 v74, v104, v105
    v_cvt_pk_bf16_f32 v75, v106, v107
    ds_write_b128 v237, v[72:75] offset:0
    v_add_f32 v68, v68, v104
    v_add_f32 v69, v69, v105
    v_add_f32 v70, v70, v106
    v_add_f32 v71, v71, v107
    v_cvt_pk_bf16_f32 v66, v68, v69
    v_cvt_pk_bf16_f32 v67, v70, v71
    ds_write_b64 v238, v[66:67]
    buffer_load_dwordx4 v32, s[24:27], s58 offen offset:2048 nt lds
    buffer_load_dwordx4 v33, s[24:27], s58 offen offset:3072 nt lds
    s_waitcnt vmcnt(13)
    s_waitcnt vmcnt(12)
    v_cmp_ne_u32 vcc, s39, v244
    s_cbranch_vccnz L_fl_retry
L_fl_ok:
    s_waitcnt lgkmcnt(0)
    s_barrier
L_post6:
    ds_read_b32 v9, v254 offset:4096
    ds_read_b64 v[120:121], v254 offset:0
    ds_read_b64 v[122:123], v254 offset:512
    ds_read_b64 v[124:125], v254 offset:1024
    ds_read_b64 v[126:127], v254 offset:1536
    ds_read_b128 v[92:95], v253 offset:0
    ds_read_b128 v[96:99], v253 offset:1024
    ds_read_b128 v[100:103], v253 offset:2048
    ds_read_b128 v[116:119], v253 offset:3072
    ds_read_b128 a[48:51], v34 offset:0
    ds_read_b128 a[52:55], v35 offset:0
    ds_read_b128 a[56:59], v34 offset:128
    ds_read_b128 a[60:63], v35 offset:128
    ds_read_b128 a[64:67], v34 offset:256
    ds_read_b128 a[68:71], v35 offset:256
    s_waitcnt lgkmcnt(14)
    v_cmp_ne_u32 vcc, 0, v9
    s_cbranch_vccnz L_xt6
    s_waitcnt lgkmcnt(12)
    v_mfma_f32_16x16x32_bf16 a[0:3], a[72:75], v[120:123], a[0:3]
    s_add_u32 m0, s42, 0
    s_add_u32 s59, s37, 294912
    buffer_load_dwordx4 v22, s[24:27], s59 offen offset:0 nt lds
    v_add_f32 v63, v63, v112
    v_fma_f32 v64, v104, v108, v64
    v_mfma_f32_16x16x32_bf16 a[4:7], a[80:83], v[120:123], a[4:7]
    v_add_f32 v63, v63, v113
    v_fma_f32 v64, v105, v109, v64
    v_mfma_f32_16x16x32_bf16 a[8:11], a[88:91], v[120:123], a[8:11]
    v_add_f32 v63, v63, v114
    v_fma_f32 v64, v106, v110, v64
    s_waitcnt lgkmcnt(10)
    v_mfma_f32_16x16x32_bf16 a[0:3], a[76:79], v[124:127], a[0:3]
    v_add_f32 v63, v63, v115
    v_fma_f32 v64, v107, v111, v64
    v_mfma_f32_16x16x32_bf16 a[4:7], a[84:87], v[124:127], a[4:7]
    v_mfma_f32_16x16x32_bf16 a[8:11], a[92:95], v[124:127], a[8:11]
    s_waitcnt lgkmcnt(9)
    v_mfma_f32_16x16x32_bf16 a[0:3], a[144:147], v[92:95], a[0:3]
    ds_read_b64_tr_b16 a[72:73], v36 offset:0
    ds_read_b64_tr_b16 a[74:75], v36 offset:6144
    v_mfma_f32_16x16x32_bf16 a[4:7], a[160:163], v[92:95], a[4:7]
    ds_read_b64_tr_b16 a[76:77], v36 offset:12288
    ds_read_b64_tr_b16 a[78:79], v36 offset:18432
    v_mfma_f32_16x16x32_bf16 a[8:11], a[176:179], v[92:95], a[8:11]
    ds_read_b64_tr_b16 a[80:81], v37 offset:0
    ds_read_b64_tr_b16 a[82:83], v37 offset:6144
    s_waitcnt lgkmcnt(14)
    v_mfma_f32_16x16x32_bf16 a[0:3], a[148:151], v[96:99], a[0:3]
    buffer_load_dwordx4 v23, s[24:27], s59 offen offset:1024 nt lds
    ds_read_b64_tr_b16 a[84:85], v37 offset:12288
    ds_read_b64_tr_b16 a[86:87], v37 offset:18432
    v_mfma_f32_16x16x32_bf16 a[4:7], a[164:167], v[96:99], a[4:7]
    ds_read_b64_tr_b16 a[88:89], v38 offset:0
    ds_read_b64_tr_b16 a[90:91], v38 offset:6144
    v_mfma_f32_16x16x32_bf16 a[8:11], a[180:183], v[96:99], a[8:11]
    ds_read_b64_tr_b16 a[92:93], v38 offset:12288
    ds_read_b64_tr_b16 a[94:95], v38 offset:18432
    s_waitcnt lgkmcnt(15)
    v_mfma_f32_16x16x32_bf16 a[0:3], a[152:155], v[100:103], a[0:3]
    v_mfma_f32_16x16x32_bf16 a[4:7], a[168:171], v[100:103], a[4:7]
    v_mfma_f32_16x16x32_bf16 a[8:11], a[184:187], v[100:103], a[8:11]
    v_mfma_f32_16x16x32_bf16 a[0:3], a[156:159], v[116:119], a[0:3]
    v_mfma_f32_16x16x32_bf16 a[4:7], a[172:175], v[116:119], a[4:7]
    v_mfma_f32_16x16x32_bf16 a[8:11], a[188:191], v[116:119], a[8:11]
    v_mfma_f32_16x16x32_bf16 v[84:87], a[48:51], a[48:51], 0
    v_mfma_f32_16x16x32_bf16 v[80:83], a[48:51], v[52:55], 0
    v_mfma_f32_16x16x32_bf16 v[84:87], a[52:55], a[52:55], v[84:87]
    v_mfma_f32_16x16x32_bf16 v[80:83], a[52:55], v[52:55], v[80:83]
    v_mfma_f32_16x16x32_bf16 v[84:87], a[56:59], a[56:59], v[84:87]
    s_add_u32 s61, s60, 3145728
    buffer_load_dwordx4 v[160:163], v65, s[72:75], s61 offen offset:0 sc1
    v_mfma_f32_16x16x32_bf16 v[80:83], a[56:59], v[52:55], v[80:83]
    s_waitcnt lgkmcnt(14)
    v_mfma_f32_16x16x32_bf16 v[84:87], a[60:63], a[60:63], v[84:87]
    v_mfma_f32_16x16x32_bf16 v[80:83], a[60:63], v[52:55], v[80:83]
    s_waitcnt lgkmcnt(13)
    v_mfma_f32_16x16x32_bf16 v[84:87], a[64:67], a[64:67], v[84:87]
    v_mfma_f32_16x16x32_bf16 v[80:83], a[64:67], v[52:55], v[80:83]
    s_waitcnt lgkmcnt(12)
    v_mfma_f32_16x16x32_bf16 v[84:87], a[68:71], a[68:71], v[84:87]
    v_mfma_f32_16x16x32_bf16 v[80:83], a[68:71], v[52:55], v[80:83]
    s_waitcnt lgkmcnt(0)
    v_mfma_f32_16x16x32_bf16 v[76:79], a[48:51], v[136:139], 0
    v_mfma_f32_16x16x32_bf16 v[76:79], a[52:55], v[140:143], v[76:79]
    v_mfma_f32_16x16x32_bf16 v[76:79], a[56:59], v[144:147], v[76:79]
    v_mfma_f32_16x16x32_bf16 v[76:79], a[60:63], v[148:151], v[76:79]
    v_mfma_f32_16x16x32_bf16 v[76:79], a[64:67], v[152:155], v[76:79]
    v_mfma_f32_16x16x32_bf16 v[76:79], a[68:71], v[156:159], v[76:79]
    buffer_load_dwordx4 v24, s[24:27], s59 offen offset:2048 nt lds
    buffer_load_dwordx4 v25, s[24:27], s59 offen offset:3072 nt lds
    s_add_u32 m0, s42, 4096
    s_nop 0
    buffer_load_dwordx4 v26, s[24:27], s59 offen offset:0 nt lds
    buffer_load_dwordx4 v27, s[24:27], s59 offen offset:1024 nt lds
    buffer_load_dwordx4 v[164:167], v65, s[72:75], s61 offen offset:1024 sc1
    buffer_load_dwordx4 v28, s[24:27], s59 offen offset:2048 nt lds
    buffer_load_dwordx4 v29, s[24:27], s59 offen offset:3072 nt lds
    s_add_u32 m0, s42, 8192
    s_nop 0
    buffer_load_dwordx4 v30, s[24:27], s59 offen offset:0 nt lds
    buffer_load_dwordx4 v31, s[24:27], s59 offen offset:1024 nt lds
    s_waitcnt vmcnt(12)
    s_barrier
    ds_read_b128 a[96:99], v40 offset:0
    ds_read_b128 a[100:103], v41 offset:0
    ds_read_b128 a[104:107], v42 offset:0
    ds_read_b128 a[108:111], v43 offset:0
    ds_read_b128 a[112:115], v40 offset:256
    ds_read_b128 a[116:119], v41 offset:256
    ds_read_b128 a[120:123], v42 offset:256
    ds_read_b128 a[124:127], v43 offset:256
    ds_read_b128 a[128:131], v40 offset:512
    ds_read_b128 a[132:135], v41 offset:512
    ds_read_b128 a[136:139], v42 offset:512
    ds_read_b128 a[140:143], v43 offset:512
    s_waitcnt lgkmcnt(11)
    v_mfma_f32_16x16x32_bf16 v[96:99], a[96:99], a[96:99], v[84:87]
    ds_read_b64_tr_b16 a[144:145], v44 offset:0
    ds_read_b64_tr_b16 a[146:147], v45 offset:0
    v_mfma_f32_16x16x32_bf16 v[100:103], a[96:99], a[48:51], 0
    ds_read_b64_tr_b16 a[148:149], v44 offset:12288
    ds_read_b64_tr_b16 a[150:151], v45 offset:12288
    s_waitcnt lgkmcnt(14)
    v_mfma_f32_16x16x32_bf16 v[96:99], a[100:103], a[100:103], v[96:99]
    ds_read_b64_tr_b16 a[152:153], v44 offset:24576
    ds_read_b64_tr_b16 a[154:155], v45 offset:24576
    v_mfma_f32_16x16x32_bf16 v[100:103], a[100:103], a[52:55], v[100:103]
    ds_read_b64_tr_b16 a[156:157], v44 offset:36864
    ds_read_b64_tr_b16 a[158:159], v45 offset:36864
    s_waitcnt lgkmcnt(15)
    v_mfma_f32_16x16x32_bf16 v[96:99], a[104:107], a[104:107], v[96:99]
    ds_read_b64_tr_b16 a[160:161], v46 offset:0
    ds_read_b64_tr_b16 a[162:163], v47 offset:0
    v_mfma_f32_16x16x32_bf16 v[100:103], a[104:107], a[56:59], v[100:103]
    ds_read_b64_tr_b16 a[164:165], v46 offset:12288
    ds_read_b64_tr_b16 a[166:167], v47 offset:12288
    v_mfma_f32_16x16x32_bf16 v[96:99], a[108:111], a[108:111], v[96:99]
    buffer_load_dwordx4 v[168:171], v65, s[72:75], s61 offen offset:2048 sc1
    ds_read_b64_tr_b16 a[168:169], v46 offset:24576
    ds_read_b64_tr_b16 a[170:171], v47 offset:24576
    v_mfma_f32_16x16x32_bf16 v[100:103], a[108:111], a[60:63], v[100:103]
    ds_read_b64_tr_b16 a[172:173], v46 offset:36864
    ds_read_b64_tr_b16 a[174:175], v47 offset:36864
    v_mfma_f32_16x16x32_bf16 v[96:99], a[112:115], a[112:115], v[96:99]
    ds_read_b64_tr_b16 a[176:177], v48 offset:0
    ds_read_b64_tr_b16 a[178:179], v49 offset:0
    v_mfma_f32_16x16x32_bf16 v[100:103], a[112:115], a[64:67], v[100:103]
    ds_read_b64_tr_b16 a[180:181], v48 offset:12288
    ds_read_b64_tr_b16 a[182:183], v49 offset:12288
    s_waitcnt lgkmcnt(15)
    v_mfma_f32_16x16x32_bf16 v[96:99], a[116:119], a[116:119], v[96:99]
    ds_read_b64_tr_b16 a[184:185], v48 offset:24576
    ds_read_b64_tr_b16 a[186:187], v49 offset:24576
    v_mfma_f32_16x16x32_bf16 v[100:103], a[116:119], a[68:71], v[100:103]
    ds_read_b64_tr_b16 a[188:189], v48 offset:36864
    ds_read_b64_tr_b16 a[190:191], v49 offset:36864
    v_mfma_f32_16x16x32_bf16 v[92:95], a[96:99], v[52:55], v[80:83]
    v_mfma_f32_16x16x32_bf16 v[92:95], a[100:103], v[52:55], v[92:95]
    v_mfma_f32_16x16x32_bf16 v[92:95], a[104:107], v[52:55], v[92:95]
    v_mfma_f32_16x16x32_bf16 v[92:95], a[108:111], v[52:55], v[92:95]
    s_nop 1
    v_fma_f32 v96, v100, 2.0, v96
    v_fma_f32 v97, v101, 2.0, v97
    v_mfma_f32_16x16x32_bf16 v[92:95], a[112:115], v[52:55], v[92:95]
    v_fma_f32 v98, v102, 2.0, v98
    v_fma_f32 v99, v103, 2.0, v99
    v_mfma_f32_16x16x32_bf16 v[92:95], a[116:119], v[52:55], v[92:95]
    v_cndmask_b32 v3, 0, v96, s[44:45]
    v_cndmask_b32 v3, v3, v97, s[46:47]
    v_mfma_f32_16x16x32_bf16 v[88:91], a[96:99], v[136:139], v[76:79]
    buffer_load_dwordx4 v32, s[24:27], s59 offen offset:2048 nt lds
    v_cndmask_b32 v3, v3, v98, s[48:49]
    v_cndmask_b32 v3, v3, v99, s[50:51]
    v_mfma_f32_16x16x32_bf16 v[88:91], a[100:103], v[140:143], v[88:91]
    buffer_load_dwordx4 v33, s[24:27], s59 offen offset:3072 nt lds
    s_nop 0
    s_nop 0
    v_mfma_f32_16x16x32_bf16 v[88:91], a[104:107], v[144:147], v[88:91]
    v_mfma_f32_16x16x4_f32 v[120:123], v3, v60, v[56:59]
    v_mfma_f32_16x16x32_bf16 v[88:91], a[108:111], v[148:151], v[88:91]
    v_mfma_f32_16x16x32_bf16 v[88:91], a[112:115], v[152:155], v[88:91]
    v_mfma_f32_16x16x32_bf16 v[88:91], a[116:119], v[156:159], v[88:91]
    v_mfma_f32_16x16x32_bf16 v[112:115], a[120:123], a[120:123], v[84:87]
    v_mfma_f32_16x16x32_bf16 v[116:119], a[120:123], a[48:51], 0
    v_mfma_f32_16x16x32_bf16 v[112:115], a[124:127], a[124:127], v[112:115]
    v_mfma_f32_16x16x32_bf16 v[116:119], a[124:127], a[52:55], v[116:119]
    s_nop 2
    v_fma_f32 v128, -v92, v92, v120
    v_fma_f32 v129, -v93, v93, v121
    v_mfma_f32_16x16x32_bf16 v[112:115], a[128:131], a[128:131], v[112:115]
    s_add_u32 m0, s40, 0
    s_add_u32 s57, s36, 73728
    buffer_load_dwordx4 v16, s[28:31], s57 offen offset:0 nt lds
    v_fma_f32 v130, -v94, v94, v122
    v_fma_f32 v131, -v95, v95, v123
    v_mfma_f32_16x16x32_bf16 v[116:119], a[128:131], a[56:59], v[116:119]
    v_max_f32 v128, v128, v56
    v_max_f32 v129, v129, v56
    v_mfma_f32_16x16x32_bf16 v[112:115], a[132:135], a[132:135], v[112:115]
    v_max_f32 v130, v130, v56
    v_max_f32 v131, v131, v56
    v_mfma_f32_16x16x32_bf16 v[116:119], a[132:135], a[60:63], v[116:119]
    v_rsq_f32 v128, v128
    v_mfma_f32_16x16x32_bf16 v[112:115], a[136:139], a[136:139], v[112:115]
    v_rsq_f32 v129, v129
    v_mfma_f32_16x16x32_bf16 v[116:119], a[136:139], a[64:67], v[116:119]
    v_rsq_f32 v130, v130
    v_mfma_f32_16x16x32_bf16 v[112:115], a[140:143], a[140:143], v[112:115]
    v_rsq_f32 v131, v131
    v_mfma_f32_16x16x32_bf16 v[116:119], a[140:143], a[68:71], v[116:119]
    v_fma_f32 v88, -v92, v61, v88
    v_fma_f32 v89, -v93, v61, v89
    v_mfma_f32_16x16x32_bf16 v[108:111], a[120:123], v[52:55], v[80:83]
    v_fma_f32 v90, -v94, v61, v90
    v_fma_f32 v91, -v95, v61, v91
    v_mfma_f32_16x16x32_bf16 v[108:111], a[124:127], v[52:55], v[108:111]
    v_fma_f32 v88, v88, v128, v62
    v_fma_f32 v89, v89, v129, v62
    v_mfma_f32_16x16x32_bf16 v[108:111], a[128:131], v[52:55], v[108:111]
    v_fma_f32 v90, v90, v130, v62
    v_fma_f32 v91, v91, v131, v62
    v_mfma_f32_16x16x32_bf16 v[108:111], a[132:135], v[52:55], v[108:111]
    v_max3_f32 v1, v88, v89, v90
    v_max_f32 v1, v1, v91
    v_mfma_f32_16x16x32_bf16 v[108:111], a[136:139], v[52:55], v[108:111]
    buffer_load_dwordx4 v17, s[28:31], s57 offen offset:1024 nt lds
    v_cmp_lt_f32 vcc, s52, v1
    s_cbranch_vccnz L_site6
L_back6:
    v_mfma_f32_16x16x32_bf16 v[108:111], a[140:143], v[52:55], v[108:111]
    v_exp_f32 v96, v88
    v_mfma_f32_16x16x32_bf16 v[104:107], a[120:123], v[136:139], v[76:79]
    v_exp_f32 v97, v89
    v_mfma_f32_16x16x32_bf16 v[104:107], a[124:127], v[140:143], v[104:107]
    v_exp_f32 v98, v90
    v_mfma_f32_16x16x32_bf16 v[104:107], a[128:131], v[144:147], v[104:107]
    v_exp_f32 v99, v91
    v_mfma_f32_16x16x32_bf16 v[104:107], a[132:135], v[148:151], v[104:107]
    v_mul_f32 v88, v96, v128
    v_mul_f32 v89, v97, v129
    v_mfma_f32_16x16x32_bf16 v[104:107], a[136:139], v[152:155], v[104:107]
    v_mul_f32 v90, v98, v130
    v_mul_f32 v91, v99, v131
    v_mfma_f32_16x16x32_bf16 v[104:107], a[140:143], v[156:159], v[104:107]
    v_fma_f32 v112, v116, 2.0, v112
    v_fma_f32 v113, v117, 2.0, v113
    v_fma_f32 v114, v118, 2.0, v114
    v_fma_f32 v115, v119, 2.0, v115
    v_cndmask_b32 v4, 0, v112, s[44:45]
    v_cndmask_b32 v4, v4, v113, s[46:47]
    v_cndmask_b32 v4, v4, v114, s[48:49]
    v_cndmask_b32 v4, v4, v115, s[50:51]
    v_add_f32 v63, v63, v96
    v_fmac_f32 v64, v88, v92
    v_mfma_f32_16x16x4_f32 v[124:127], v4, v60, v[56:59]
    v_add_f32 v63, v63, v97
    v_fmac_f32 v64, v89, v93
    v_add_f32 v63, v63, v98
    v_fmac_f32 v64, v90, v94
    v_add_f32 v63, v63, v99
    v_fmac_f32 v64, v91, v95
    v_mov_b32 v68, v88
    v_mov_b32 v69, v89
    v_mov_b32 v70, v90
    v_mov_b32 v71, v91
    v_add_u32 v44, 49152, v44
    v_add_u32 v45, 49152, v45
    v_add_u32 v46, 49152, v46
    v_add_u32 v47, 49152, v47
    v_add_u32 v48, 49152, v48
    v_add_u32 v49, 49152, v49
    v_fma_f32 v132, -v108, v108, v124
    v_fma_f32 v133, -v109, v109, v125
    v_fma_f32 v134, -v110, v110, v126
    v_fma_f32 v135, -v111, v111, v127
    v_max_f32 v132, v132, v56
    v_max_f32 v133, v133, v56
    v_max_f32 v134, v134, v56
    v_max_f32 v135, v135, v56
    v_rsq_f32 v132, v132
    v_rsq_f32 v133, v133
    v_rsq_f32 v134, v134
    v_rsq_f32 v135, v135
    buffer_load_dwordx4 v[172:175], v65, s[72:75], s61 offen offset:3072 sc1
    v_fma_f32 v104, -v108, v61, v104
    v_fma_f32 v105, -v109, v61, v105
    v_fma_f32 v106, -v110, v61, v106
    v_fma_f32 v107, -v111, v61, v107
    v_fma_f32 v104, v104, v132, v62
    v_fma_f32 v105, v105, v133, v62
    v_fma_f32 v106, v106, v134, v62
    v_fma_f32 v107, v107, v135, v62
    v_max3_f32 v1, v104, v105, v106
    v_max_f32 v1, v1, v107
    v_cmp_lt_f32 vcc, s52, v1
    s_cbranch_vccnz L_site7
L_back7:
    v_exp_f32 v112, v104
    v_exp_f32 v113, v105
    v_exp_f32 v114, v106
    v_exp_f32 v115, v107
    v_cvt_pk_bf16_f32 v72, v88, v89
    v_cvt_pk_bf16_f32 v73, v90, v91
    v_mul_f32 v104, v112, v132
    v_mul_f32 v105, v113, v133
    v_mul_f32 v106, v114, v134
    v_mul_f32 v107, v115, v135
    v_cvt_pk_bf16_f32 v74, v104, v105
    v_cvt_pk_bf16_f32 v75, v106, v107
    ds_write_b128 v237, v[72:75] offset:0
    s_waitcnt lgkmcnt(0)
    s_barrier
L_post27:
    ds_read_b32 v9, v254 offset:4096
    ds_read_b128 v[92:95], v253 offset:0
    ds_read_b128 v[96:99], v253 offset:1024
    ds_read_b128 v[100:103], v253 offset:2048
    ds_read_b128 v[116:119], v253 offset:3072
    s_waitcnt lgkmcnt(4)
    v_cmp_ne_u32 vcc, 0, v9
    s_cbranch_vccnz L_xt27
    s_waitcnt lgkmcnt(3)
    v_mfma_f32_16x16x32_bf16 a[0:3], a[144:147], v[92:95], a[0:3]
    buffer_load_dwordx4 v18, s[28:31], s57 offen offset:2048 nt lds
    v_add_f32 v68, v68, v104
    v_add_f32 v69, v69, v105
    v_mfma_f32_16x16x32_bf16 a[4:7], a[160:163], v[92:95], a[4:7]
    buffer_load_dwordx4 v19, s[28:31], s57 offen offset:3072 nt lds
    v_add_f32 v70, v70, v106
    v_add_f32 v71, v71, v107
    v_mfma_f32_16x16x32_bf16 a[8:11], a[176:179], v[92:95], a[8:11]
    s_add_u32 m0, s40, 4096
    s_nop 0
    buffer_load_dwordx4 v20, s[28:31], s57 offen offset:0 nt lds
    v_add_f32 v63, v63, v112
    v_fma_f32 v64, v104, v108, v64
    s_waitcnt lgkmcnt(2)
    v_mfma_f32_16x16x32_bf16 a[0:3], a[148:151], v[96:99], a[0:3]
    v_add_f32 v63, v63, v113
    v_fma_f32 v64, v105, v109, v64
    v_mfma_f32_16x16x32_bf16 a[4:7], a[164:167], v[96:99], a[4:7]
    v_add_f32 v63, v63, v114
    v_fma_f32 v64, v106, v110, v64
    v_mfma_f32_16x16x32_bf16 a[8:11], a[180:183], v[96:99], a[8:11]
    v_add_f32 v63, v63, v115
    v_fma_f32 v64, v107, v111, v64
    s_waitcnt lgkmcnt(1)
    v_mfma_f32_16x16x32_bf16 a[0:3], a[152:155], v[100:103], a[0:3]
    s_add_u32 s61, s60, 3149824
    buffer_load_dwordx4 v[176:179], v65, s[72:75], s61 offen offset:0 sc1
    v_mfma_f32_16x16x32_bf16 a[4:7], a[168:171], v[100:103], a[4:7]
    v_mfma_f32_16x16x32_bf16 a[8:11], a[184:187], v[100:103], a[8:11]
    s_waitcnt lgkmcnt(0)
    v_mfma_f32_16x16x32_bf16 a[0:3], a[156:159], v[116:119], a[0:3]
    v_mfma_f32_16x16x32_bf16 a[4:7], a[172:175], v[116:119], a[4:7]
    v_mfma_f32_16x16x32_bf16 a[8:11], a[188:191], v[116:119], a[8:11]
    buffer_load_dwordx4 v21, s[28:31], s57 offen offset:1024 nt lds
    s_add_u32 m0, s41, 0
    s_add_u32 s58, s37, 147456
    buffer_load_dwordx4 v224, s[24:27], s58 offen offset:0 nt lds
    buffer_load_dwordx4 v225, s[24:27], s58 offen offset:1024 nt lds
    s_add_u32 m0, s41, 2048
    s_add_u32 s58, s37, 147584
    buffer_load_dwordx4 v224, s[24:27], s58 offen offset:0 nt lds
    buffer_load_dwordx4 v[180:183], v65, s[72:75], s61 offen offset:1024 sc1
    s_waitcnt vmcnt(12)
    s_barrier
    ds_read_b128 a[96:99], v40 offset:49152
    ds_read_b128 a[100:103], v41 offset:49152
    ds_read_b128 a[104:107], v42 offset:49152
    ds_read_b128 a[108:111], v43 offset:49152
    ds_read_b128 a[112:115], v40 offset:49408
    ds_read_b128 a[116:119], v41 offset:49408
    ds_read_b128 a[120:123], v42 offset:49408
    ds_read_b128 a[124:127], v43 offset:49408
    ds_read_b128 a[128:131], v40 offset:49664
    ds_read_b128 a[132:135], v41 offset:49664
    ds_read_b128 a[136:139], v42 offset:49664
    ds_read_b128 a[140:143], v43 offset:49664
    s_waitcnt lgkmcnt(11)
    v_mfma_f32_16x16x32_bf16 v[96:99], a[96:99], a[96:99], v[84:87]
    ds_read_b64_tr_b16 a[144:145], v44 offset:0
    ds_read_b64_tr_b16 a[146:147], v45 offset:0
    v_mfma_f32_16x16x32_bf16 v[100:103], a[96:99], a[48:51], 0
    ds_read_b64_tr_b16 a[148:149], v44 offset:12288
    ds_read_b64_tr_b16 a[150:151], v45 offset:12288
    s_waitcnt lgkmcnt(14)
    v_mfma_f32_16x16x32_bf16 v[96:99], a[100:103], a[100:103], v[96:99]
    ds_read_b64_tr_b16 a[152:153], v44 offset:24576
    ds_read_b64_tr_b16 a[154:155], v45 offset:24576
    v_mfma_f32_16x16x32_bf16 v[100:103], a[100:103], a[52:55], v[100:103]
    ds_read_b64_tr_b16 a[156:157], v44 offset:36864
    ds_read_b64_tr_b16 a[158:159], v45 offset:36864
    s_waitcnt lgkmcnt(15)
    v_mfma_f32_16x16x32_bf16 v[96:99], a[104:107], a[104:107], v[96:99]
    ds_read_b64_tr_b16 a[160:161], v46 offset:0
    ds_read_b64_tr_b16 a[162:163], v47 offset:0
    v_mfma_f32_16x16x32_bf16 v[100:103], a[104:107], a[56:59], v[100:103]
    ds_read_b64_tr_b16 a[164:165], v46 offset:12288
    ds_read_b64_tr_b16 a[166:167], v47 offset:12288
    v_mfma_f32_16x16x32_bf16 v[96:99], a[108:111], a[108:111], v[96:99]
    buffer_load_dwordx4 v225, s[24:27], s58 offen offset:1024 nt lds
    ds_read_b64_tr_b16 a[168:169], v46 offset:24576
    ds_read_b64_tr_b16 a[170:171], v47 offset:24576
    v_mfma_f32_16x16x32_bf16 v[100:103], a[108:111], a[60:63], v[100:103]
    ds_read_b64_tr_b16 a[172:173], v46 offset:36864
    ds_read_b64_tr_b16 a[174:175], v47 offset:36864
    v_mfma_f32_16x16x32_bf16 v[96:99], a[112:115], a[112:115], v[96:99]
    ds_read_b64_tr_b16 a[176:177], v48 offset:0
    ds_read_b64_tr_b16 a[178:179], v49 offset:0
    v_mfma_f32_16x16x32_bf16 v[100:103], a[112:115], a[64:67], v[100:103]
    ds_read_b64_tr_b16 a[180:181], v48 offset:12288
    ds_read_b64_tr_b16 a[182:183], v49 offset:12288
    s_waitcnt lgkmcnt(15)
    v_mfma_f32_16x16x32_bf16 v[96:99], a[116:119], a[116:119], v[96:99]
    ds_read_b64_tr_b16 a[184:185], v48 offset:24576
    ds_read_b64_tr_b16 a[186:187], v49 offset:24576
    v_mfma_f32_16x16x32_bf16 v[100:103], a[116:119], a[68:71], v[100:103]
    ds_read_b64_tr_b16 a[188:189], v48 offset:36864
    ds_read_b64_tr_b16 a[190:191], v49 offset:36864
    v_mfma_f32_16x16x32_bf16 v[92:95], a[96:99], v[52:55], v[80:83]
    v_mfma_f32_16x16x32_bf16 v[92:95], a[100:103], v[52:55], v[92:95]
    v_mfma_f32_16x16x32_bf16 v[92:95], a[104:107], v[52:55], v[92:95]
    v_mfma_f32_16x16x32_bf16 v[92:95], a[108:111], v[52:55], v[92:95]
    s_nop 1
    v_fma_f32 v96, v100, 2.0, v96
    v_fma_f32 v97, v101, 2.0, v97
    v_mfma_f32_16x16x32_bf16 v[92:95], a[112:115], v[52:55], v[92:95]
    v_fma_f32 v98, v102, 2.0, v98
    v_fma_f32 v99, v103, 2.0, v99
    v_mfma_f32_16x16x32_bf16 v[92:95], a[116:119], v[52:55], v[92:95]
    v_cndmask_b32 v3, 0, v96, s[44:45]
    v_cndmask_b32 v3, v3, v97, s[46:47]
    v_mfma_f32_16x16x32_bf16 v[88:91], a[96:99], v[136:139], v[76:79]
    s_add_u32 m0, s41, 4096
    s_add_u32 s58, s37, 147712
    buffer_load_dwordx4 v224, s[24:27], s58 offen offset:0 nt lds
    v_cndmask_b32 v3, v3, v98, s[48:49]
    v_cndmask_b32 v3, v3, v99, s[50:51]
    v_mfma_f32_16x16x32_bf16 v[88:91], a[100:103], v[140:143], v[88:91]
    buffer_load_dwordx4 v225, s[24:27], s58 offen offset:1024 nt lds
    s_nop 0
    s_nop 0
    v_mfma_f32_16x16x32_bf16 v[88:91], a[104:107], v[144:147], v[88:91]
    v_mfma_f32_16x16x4_f32 v[120:123], v3, v60, v[56:59]
    v_mfma_f32_16x16x32_bf16 v[88:91], a[108:111], v[148:151], v[88:91]
    v_mfma_f32_16x16x32_bf16 v[88:91], a[112:115], v[152:155], v[88:91]
    v_mfma_f32_16x16x32_bf16 v[88:91], a[116:119], v[156:159], v[88:91]
    v_mfma_f32_16x16x32_bf16 v[112:115], a[120:123], a[120:123], v[84:87]
    v_mfma_f32_16x16x32_bf16 v[116:119], a[120:123], a[48:51], 0
    v_mfma_f32_16x16x32_bf16 v[112:115], a[124:127], a[124:127], v[112:115]
    v_mfma_f32_16x16x32_bf16 v[116:119], a[124:127], a[52:55], v[116:119]
    s_add_u32 m0, s41, 6144
    s_add_u32 s58, s37, 147840
    buffer_load_dwordx4 v224, s[24:27], s58 offen offset:0 nt lds
    v_fma_f32 v128, -v92, v92, v120
    v_fma_f32 v129, -v93, v93, v121
    v_mfma_f32_16x16x32_bf16 v[112:115], a[128:131], a[128:131], v[112:115]
    v_fma_f32 v130, -v94, v94, v122
    v_fma_f32 v131, -v95, v95, v123
    v_mfma_f32_16x16x32_bf16 v[116:119], a[128:131], a[56:59], v[116:119]
    v_max_f32 v128, v128, v56
    v_max_f32 v129, v129, v56
    v_mfma_f32_16x16x32_bf16 v[112:115], a[132:135], a[132:135], v[112:115]
    v_max_f32 v130, v130, v56
    v_max_f32 v131, v131, v56
    v_mfma_f32_16x16x32_bf16 v[116:119], a[132:135], a[60:63], v[116:119]
    v_rsq_f32 v128, v128
    v_mfma_f32_16x16x32_bf16 v[112:115], a[136:139], a[136:139], v[112:115]
    v_rsq_f32 v129, v129
    v_mfma_f32_16x16x32_bf16 v[116:119], a[136:139], a[64:67], v[116:119]
    v_rsq_f32 v130, v130
    v_mfma_f32_16x16x32_bf16 v[112:115], a[140:143], a[140:143], v[112:115]
    v_rsq_f32 v131, v131
    v_mfma_f32_16x16x32_bf16 v[116:119], a[140:143], a[68:71], v[116:119]
    v_fma_f32 v88, -v92, v61, v88
    v_fma_f32 v89, -v93, v61, v89
    v_mfma_f32_16x16x32_bf16 v[108:111], a[120:123], v[52:55], v[80:83]
    v_fma_f32 v90, -v94, v61, v90
    v_fma_f32 v91, -v95, v61, v91
    v_mfma_f32_16x16x32_bf16 v[108:111], a[124:127], v[52:55], v[108:111]
    v_fma_f32 v88, v88, v128, v62
    v_fma_f32 v89, v89, v129, v62
    v_mfma_f32_16x16x32_bf16 v[108:111], a[128:131], v[52:55], v[108:111]
    v_fma_f32 v90, v90, v130, v62
    v_fma_f32 v91, v91, v131, v62
    v_mfma_f32_16x16x32_bf16 v[108:111], a[132:135], v[52:55], v[108:111]
    v_max3_f32 v1, v88, v89, v90
    v_max_f32 v1, v1, v91
    v_mfma_f32_16x16x32_bf16 v[108:111], a[136:139], v[52:55], v[108:111]
    buffer_load_dwordx4 v[184:187], v65, s[72:75], s61 offen offset:2048 sc1
    v_cmp_lt_f32 vcc, s52, v1
    s_cbranch_vccnz L_site8
L_back8:
    v_mfma_f32_16x16x32_bf16 v[108:111], a[140:143], v[52:55], v[108:111]
    v_exp_f32 v96, v88
    v_mfma_f32_16x16x32_bf16 v[104:107], a[120:123], v[136:139], v[76:79]
    v_exp_f32 v97, v89
    v_mfma_f32_16x16x32_bf16 v[104:107], a[124:127], v[140:143], v[104:107]
    v_exp_f32 v98, v90
    v_mfma_f32_16x16x32_bf16 v[104:107], a[128:131], v[144:147], v[104:107]
    v_exp_f32 v99, v91
    v_mfma_f32_16x16x32_bf16 v[104:107], a[132:135], v[148:151], v[104:107]
    v_mul_f32 v88, v96, v128
    v_mul_f32 v89, v97, v129
    v_mfma_f32_16x16x32_bf16 v[104:107], a[136:139], v[152:155], v[104:107]
    v_mul_f32 v90, v98, v130
    v_mul_f32 v91, v99, v131
    v_mfma_f32_16x16x32_bf16 v[104:107], a[140:143], v[156:159], v[104:107]
    v_fma_f32 v112, v116, 2.0, v112
    v_fma_f32 v113, v117, 2.0, v113
    v_fma_f32 v114, v118, 2.0, v114
    v_fma_f32 v115, v119, 2.0, v115
    v_cndmask_b32 v4, 0, v112, s[44:45]
    v_cndmask_b32 v4, v4, v113, s[46:47]
    v_cndmask_b32 v4, v4, v114, s[48:49]
    v_cndmask_b32 v4, v4, v115, s[50:51]
    v_add_f32 v63, v63, v96
    v_fmac_f32 v64, v88, v92
    v_mfma_f32_16x16x4_f32 v[124:127], v4, v60, v[56:59]
    v_add_f32 v63, v63, v97
    v_fmac_f32 v64, v89, v93
    v_add_f32 v63, v63, v98
    v_fmac_f32 v64, v90, v94
    v_add_f32 v63, v63, v99
    v_fmac_f32 v64, v91, v95
    v_add_f32 v68, v68, v88
    v_add_f32 v69, v69, v89
    v_add_f32 v70, v70, v90
    v_add_f32 v71, v71, v91
    v_add_u32 v44, -49152, v44
    v_add_u32 v45, -49152, v45
    v_add_u32 v46, -49152, v46
    v_add_u32 v47, -49152, v47
    v_add_u32 v48, -49152, v48
    v_add_u32 v49, -49152, v49
    v_fma_f32 v132, -v108, v108, v124
    v_fma_f32 v133, -v109, v109, v125
    v_fma_f32 v134, -v110, v110, v126
    v_fma_f32 v135, -v111, v111, v127
    v_max_f32 v132, v132, v56
    v_max_f32 v133, v133, v56
    v_max_f32 v134, v134, v56
    v_max_f32 v135, v135, v56
    v_rsq_f32 v132, v132
    v_rsq_f32 v133, v133
    v_rsq_f32 v134, v134
    v_rsq_f32 v135, v135
    buffer_load_dwordx4 v225, s[24:27], s58 offen offset:1024 nt lds
    v_fma_f32 v104, -v108, v61, v104
    v_fma_f32 v105, -v109, v61, v105
    v_fma_f32 v106, -v110, v61, v106
    v_fma_f32 v107, -v111, v61, v107
    v_fma_f32 v104, v104, v132, v62
    v_fma_f32 v105, v105, v133, v62
    v_fma_f32 v106, v106, v134, v62
    v_fma_f32 v107, v107, v135, v62
    v_max3_f32 v1, v104, v105, v106
    v_max_f32 v1, v1, v107
    v_cmp_lt_f32 vcc, s52, v1
    s_cbranch_vccnz L_site9
L_back9:
    s_add_u32 m0, s41, 8192
    s_add_u32 s58, s37, 147968
    buffer_load_dwordx4 v224, s[24:27], s58 offen offset:0 nt lds
    v_exp_f32 v112, v104
    v_exp_f32 v113, v105
    v_exp_f32 v114, v106
    v_exp_f32 v115, v107
    v_cvt_pk_bf16_f32 v72, v88, v89
    v_cvt_pk_bf16_f32 v73, v90, v91
    v_mul_f32 v104, v112, v132
    v_mul_f32 v105, v113, v133
    v_mul_f32 v106, v114, v134
    v_mul_f32 v107, v115, v135
    v_cvt_pk_bf16_f32 v74, v104, v105
    v_cvt_pk_bf16_f32 v75, v106, v107
    ds_write_b128 v237, v[72:75] offset:0
    v_add_f32 v68, v68, v104
    v_add_f32 v69, v69, v105
    v_add_f32 v70, v70, v106
    v_add_f32 v71, v71, v107
    v_cvt_pk_bf16_f32 v66, v68, v69
    v_cvt_pk_bf16_f32 v67, v70, v71
    ds_write_b64 v238, v[66:67]
    s_lshl_b32 s56, s3, 13
    v_lshl_add_u32 v233, v0, 7, s56
    v_min_u32 v233, L_hot - L_tail, v233
    v_add_u32 v233, L_tail - L_pc_main, v233
    global_load_dword v234, v233, s[100:101]
    s_waitcnt vmcnt(12)
    s_waitcnt lgkmcnt(0)
    s_barrier
L_post9:
    ds_read_b32 v9, v254 offset:4096
    ds_read_b64 v[120:121], v254 offset:0
    ds_read_b64 v[122:123], v254 offset:512
    ds_read_b64 v[124:125], v254 offset:1024
    ds_read_b64 v[126:127], v254 offset:1536
    ds_read_b128 v[92:95], v253 offset:0
    ds_read_b128 v[96:99], v253 offset:1024
    ds_read_b128 v[100:103], v253 offset:2048
    ds_read_b128 v[116:119], v253 offset:3072
    ds_read_b128 a[48:51], v34 offset:0
    ds_read_b128 a[52:55], v35 offset:0
    ds_read_b128 a[56:59], v34 offset:128
    ds_read_b128 a[60:63], v35 offset:128
    ds_read_b128 a[64:67], v34 offset:256
    ds_read_b128 a[68:71], v35 offset:256
    s_waitcnt lgkmcnt(14)
    v_cmp_ne_u32 vcc, 0, v9
    s_cbranch_vccnz L_xt9
    s_waitcnt lgkmcnt(12)
    v_mfma_f32_16x16x32_bf16 a[0:3], a[72:75], v[120:123], a[0:3]
    buffer_load_dwordx4 v225, s[24:27], s58 offen offset:1024 nt lds
    v_add_f32 v63, v63, v112
    v_fma_f32 v64, v104, v108, v64
    v_mfma_f32_16x16x32_bf16 a[4:7], a[80:83], v[120:123], a[4:7]
    v_add_f32 v63, v63, v113
    v_fma_f32 v64, v105, v109, v64
    v_mfma_f32_16x16x32_bf16 a[8:11], a[88:91], v[120:123], a[8:11]
    v_add_f32 v63, v63, v114
    v_fma_f32 v64, v106, v110, v64
    s_waitcnt lgkmcnt(10)
    v_mfma_f32_16x16x32_bf16 a[0:3], a[76:79], v[124:127], a[0:3]
    v_add_f32 v63, v63, v115
    v_fma_f32 v64, v107, v111, v64
    v_mfma_f32_16x16x32_bf16 a[4:7], a[84:87], v[124:127], a[4:7]
    v_mfma_f32_16x16x32_bf16 a[8:11], a[92:95], v[124:127], a[8:11]
    s_waitcnt lgkmcnt(9)
    v_mfma_f32_16x16x32_bf16 a[0:3], a[144:147], v[92:95], a[0:3]
    ds_read_b64_tr_b16 a[72:73], v36 offset:0
    ds_read_b64_tr_b16 a[74:75], v36 offset:6144
    v_mfma_f32_16x16x32_bf16 a[4:7], a[160:163], v[92:95], a[4:7]
    ds_read_b64_tr_b16 a[76:77], v36 offset:12288
    ds_read_b64_tr_b16 a[78:79], v36 offset:18432
    v_mfma_f32_16x16x32_bf16 a[8:11], a[176:179], v[92:95], a[8:11]
    s_add_u32 m0, s41, 10240
    s_add_u32 s58, s37, 148096
    buffer_load_dwordx4 v224, s[24:27], s58 offen offset:0 nt lds
    ds_read_b64_tr_b16 a[80:81], v37 offset:0
    ds_read_b64_tr_b16 a[82:83], v37 offset:6144
    s_waitcnt lgkmcnt(14)
    v_mfma_f32_16x16x32_bf16 a[0:3], a[148:151], v[96:99], a[0:3]
    ds_read_b64_tr_b16 a[84:85], v37 offset:12288
    ds_read_b64_tr_b16 a[86:87], v37 offset:18432
    v_mfma_f32_16x16x32_bf16 a[4:7], a[164:167], v[96:99], a[4:7]
    ds_read_b64_tr_b16 a[88:89], v38 offset:0
    ds_read_b64_tr_b16 a[90:91], v38 offset:6144
    v_mfma_f32_16x16x32_bf16 a[8:11], a[180:183], v[96:99], a[8:11]
    ds_read_b64_tr_b16 a[92:93], v38 offset:12288
    ds_read_b64_tr_b16 a[94:95], v38 offset:18432
    s_waitcnt lgkmcnt(15)
    v_mfma_f32_16x16x32_bf16 a[0:3], a[152:155], v[100:103], a[0:3]
    v_mfma_f32_16x16x32_bf16 a[4:7], a[168:171], v[100:103], a[4:7]
    v_mfma_f32_16x16x32_bf16 a[8:11], a[184:187], v[100:103], a[8:11]
    v_mfma_f32_16x16x32_bf16 a[0:3], a[156:159], v[116:119], a[0:3]
    v_mfma_f32_16x16x32_bf16 a[4:7], a[172:175], v[116:119], a[4:7]
    v_mfma_f32_16x16x32_bf16 a[8:11], a[188:191], v[116:119], a[8:11]
    v_mfma_f32_16x16x32_bf16 v[84:87], a[48:51], a[48:51], 0
    v_mfma_f32_16x16x32_bf16 v[80:83], a[48:51], v[52:55], 0
    buffer_load_dwordx4 v[188:191], v65, s[72:75], s61 offen offset:3072 sc1
    v_mfma_f32_16x16x32_bf16 v[84:87], a[52:55], a[52:55], v[84:87]
    buffer_load_dwordx4 v225, s[24:27], s58 offen offset:1024 nt lds
    v_mfma_f32_16x16x32_bf16 v[80:83], a[52:55], v[52:55], v[80:83]
    v_mfma_f32_16x16x32_bf16 v[84:87], a[56:59], a[56:59], v[84:87]
    v_mfma_f32_16x16x32_bf16 v[80:83], a[56:59], v[52:55], v[80:83]
    s_waitcnt lgkmcnt(14)
    v_mfma_f32_16x16x32_bf16 v[84:87], a[60:63], a[60:63], v[84:87]
    v_mfma_f32_16x16x32_bf16 v[80:83], a[60:63], v[52:55], v[80:83]
    s_waitcnt lgkmcnt(13)
    v_mfma_f32_16x16x32_bf16 v[84:87], a[64:67], a[64:67], v[84:87]
    v_mfma_f32_16x16x32_bf16 v[80:83], a[64:67], v[52:55], v[80:83]
    s_waitcnt lgkmcnt(12)
    v_mfma_f32_16x16x32_bf16 v[84:87], a[68:71], a[68:71], v[84:87]
    v_mfma_f32_16x16x32_bf16 v[80:83], a[68:71], v[52:55], v[80:83]
    s_waitcnt lgkmcnt(0)
    v_mfma_f32_16x16x32_bf16 v[76:79], a[48:51], v[136:139], 0
    v_mfma_f32_16x16x32_bf16 v[76:79], a[52:55], v[140:143], v[76:79]
    v_mfma_f32_16x16x32_bf16 v[76:79], a[56:59], v[144:147], v[76:79]
    s_add_u32 m0, s42, 0
    s_add_u32 s59, s37, 344064
    buffer_load_dwordx4 v224, s[24:27], s59 offen offset:0 nt lds
    v_mfma_f32_16x16x32_bf16 v[76:79], a[60:63], v[148:151], v[76:79]
    v_mfma_f32_16x16x32_bf16 v[76:79], a[64:67], v[152:155], v[76:79]
    v_mfma_f32_16x16x32_bf16 v[76:79], a[68:71], v[156:159], v[76:79]
    s_mul_i32 s28, s3, 148480
    s_and_b32 s56, s2, 7
    s_lshl_b32 s56, s56, 10
    s_add_u32 s28, s28, s56
    s_bfe_u32 s56, s2, 0x30003
    s_lshl_b32 s56, s56, 7
    s_add_u32 s28, s28, s56
    s_lshr_b32 s56, s2, 6
    s_lshl_b32 s56, s56, 13
    s_add_u32 s28, s28, s56
    s_add_u32 s28, s28, 65536
    s_sub_u32 s29, s2, 64
    s_mul_i32 s30, s29, 37120
    s_lshl_b32 s56, s3, 13
    s_add_u32 s30, s30, s56
    s_add_u32 s30, s30, 65536
    s_add_u32 s31, s30, 4096
    v_mov_b32 v232, 0x53800000
    s_mov_b32 s43, 1
    s_mov_b32 s68, s18
    s_mov_b32 s69, s19
    s_mov_b32 s70, 6144
    s_mov_b32 s71, 0x20000
L_tail:
    v_and_b32 v1, 15, v0
    v_lshlrev_b32 v1, 8, v1
    v_sub_u32 v1, v34, v1
    v_lshrrev_b32 v2, 2, v0
    v_lshlrev_b32 v2, 8, v2
    s_sub_u32 s56, s41, s40
    v_add_u32 v40, s56, v1
    v_xor_b32 v41, 64, v40
    s_sub_u32 s56, s42, s40
    v_add_u32 v42, s56, v1
    v_xor_b32 v43, 64, v42
    s_mul_i32 s56, s3, 3
    s_add_u32 s57, s56, 0
    s_lshr_b32 s57, s57, 2
    s_mul_i32 s57, s57, 1920
    s_add_u32 s57, s57, 24576
    v_sub_u32 v44, v36, v2
    v_add_u32 v44, s57, v44
    v_add_u32 v47, 49152, v44
    s_add_u32 s57, s56, 1
    s_lshr_b32 s57, s57, 2
    s_mul_i32 s57, s57, 1920
    s_add_u32 s57, s57, 24576
    v_sub_u32 v45, v37, v2
    v_add_u32 v45, s57, v45
    v_add_u32 v48, 49152, v45
    s_add_u32 s57, s56, 2
    s_lshr_b32 s57, s57, 2
    s_mul_i32 s57, s57, 1920
    s_add_u32 s57, s57, 24576
    v_sub_u32 v46, v38, v2
    v_add_u32 v46, s57, v46
    v_add_u32 v49, 49152, v46
    v_accvgpr_read_b32 v16, a0
    v_accvgpr_read_b32 v17, a1
    v_accvgpr_read_b32 v18, a2
    v_accvgpr_read_b32 v19, a3
    v_accvgpr_read_b32 v20, a4
    v_accvgpr_read_b32 v21, a5
    v_accvgpr_read_b32 v22, a6
    v_accvgpr_read_b32 v23, a7
    v_accvgpr_read_b32 v24, a8
    v_accvgpr_read_b32 v25, a9
    v_accvgpr_read_b32 v26, a10
    v_accvgpr_read_b32 v27, a11
    buffer_load_dwordx4 v225, s[24:27], s59 offen offset:1024 nt lds
    s_add_u32 m0, s42, 2048
    s_add_u32 s59, s37, 344192
    buffer_load_dwordx4 v224, s[24:27], s59 offen offset:0 nt lds
    s_waitcnt vmcnt(12)
    s_barrier
    ds_read_b128 a[96:99], v40 offset:0
    ds_read_b128 a[100:103], v41 offset:0
    ds_read_b128 a[104:107], v40 offset:2048
    ds_read_b128 a[108:111], v41 offset:2048
    ds_read_b128 a[112:115], v40 offset:4096
    ds_read_b128 a[116:119], v41 offset:4096
    s_waitcnt lgkmcnt(5)
    v_mfma_f32_16x16x32_bf16 v[96:99], a[96:99], a[96:99], v[84:87]
    ds_read_b64_tr_b16 a[144:145], v44 offset:0
    ds_read_b64_tr_b16 a[148:149], v44 offset:12288
    v_mfma_f32_16x16x32_bf16 v[100:103], a[96:99], a[48:51], 0
    ds_read_b64_tr_b16 a[152:153], v44 offset:24576
    ds_read_b64_tr_b16 a[156:157], v44 offset:36864
    s_waitcnt lgkmcnt(8)
    v_mfma_f32_16x16x32_bf16 v[96:99], a[100:103], a[100:103], v[96:99]
    ds_read_b64_tr_b16 a[160:161], v45 offset:0
    ds_read_b64_tr_b16 a[164:165], v45 offset:12288
    v_mfma_f32_16x16x32_bf16 v[100:103], a[100:103], a[52:55], v[100:103]
    ds_read_b64_tr_b16 a[168:169], v45 offset:24576
    ds_read_b64_tr_b16 a[172:173], v45 offset:36864
    s_waitcnt lgkmcnt(11)
    v_mfma_f32_16x16x32_bf16 v[96:99], a[104:107], a[104:107], v[96:99]
    ds_read_b64_tr_b16 a[176:177], v46 offset:0
    ds_read_b64_tr_b16 a[180:181], v46 offset:12288
    v_mfma_f32_16x16x32_bf16 v[100:103], a[104:107], a[56:59], v[100:103]
    ds_read_b64_tr_b16 a[184:185], v46 offset:24576
    ds_read_b64_tr_b16 a[188:189], v46 offset:36864
    s_waitcnt lgkmcnt(14)
    v_mfma_f32_16x16x32_bf16 v[96:99], a[108:111], a[108:111], v[96:99]
    buffer_load_dwordx4 v225, s[24:27], s59 offen offset:1024 nt lds
    v_mfma_f32_16x16x32_bf16 v[100:103], a[108:111], a[60:63], v[100:103]
    s_add_u32 m0, s42, 4096
    s_add_u32 s59, s37, 344320
    buffer_load_dwordx4 v224, s[24:27], s59 offen offset:0 nt lds
    s_waitcnt lgkmcnt(13)
    v_mfma_f32_16x16x32_bf16 v[96:99], a[112:115], a[112:115], v[96:99]
    v_mfma_f32_16x16x32_bf16 v[100:103], a[112:115], a[64:67], v[100:103]
    s_waitcnt lgkmcnt(12)
    v_mfma_f32_16x16x32_bf16 v[96:99], a[116:119], a[116:119], v[96:99]
    v_mfma_f32_16x16x32_bf16 v[100:103], a[116:119], a[68:71], v[100:103]
    v_mfma_f32_16x16x32_bf16 v[92:95], a[96:99], v[52:55], v[80:83]
    v_mfma_f32_16x16x32_bf16 v[92:95], a[100:103], v[52:55], v[92:95]
    v_mfma_f32_16x16x32_bf16 v[92:95], a[104:107], v[52:55], v[92:95]
    v_mfma_f32_16x16x32_bf16 v[92:95], a[108:111], v[52:55], v[92:95]
    s_nop 3
    v_fma_f32 v96, v100, 2.0, v96
    v_fma_f32 v97, v101, 2.0, v97
    v_mfma_f32_16x16x32_bf16 v[92:95], a[112:115], v[52:55], v[92:95]
    v_fma_f32 v98, v102, 2.0, v98
    v_fma_f32 v99, v103, 2.0, v99
    v_mfma_f32_16x16x32_bf16 v[92:95], a[116:119], v[52:55], v[92:95]
    v_cndmask_b32 v3, 0, v96, s[44:45]
    v_cndmask_b32 v3, v3, v97, s[46:47]
    v_mfma_f32_16x16x32_bf16 v[88:91], a[96:99], v[136:139], v[76:79]
    buffer_load_dwordx4 v225, s[24:27], s59 offen offset:1024 nt lds
    v_cndmask_b32 v3, v3, v98, s[48:49]
    v_cndmask_b32 v3, v3, v99, s[50:51]
    v_mfma_f32_16x16x32_bf16 v[88:91], a[100:103], v[140:143], v[88:91]
    s_nop 0
    s_nop 0
    v_mfma_f32_16x16x32_bf16 v[88:91], a[104:107], v[144:147], v[88:91]
    v_mfma_f32_16x16x4_f32 v[120:123], v3, v60, v[56:59]
    v_mfma_f32_16x16x32_bf16 v[88:91], a[108:111], v[148:151], v[88:91]
    v_mfma_f32_16x16x32_bf16 v[88:91], a[112:115], v[152:155], v[88:91]
    v_mfma_f32_16x16x32_bf16 v[88:91], a[116:119], v[156:159], v[88:91]
    s_nop 6
    v_fma_f32 v128, -v92, v92, v120
    v_fma_f32 v129, -v93, v93, v121
    v_fma_f32 v130, -v94, v94, v122
    v_fma_f32 v131, -v95, v95, v123
    v_max_f32 v128, v128, v56
    v_max_f32 v129, v129, v56
    v_max_f32 v130, v130, v56
    v_max_f32 v131, v131, v56
    v_rsq_f32 v128, v128
    v_rsq_f32 v129, v129
    v_rsq_f32 v130, v130
    v_rsq_f32 v131, v131
    v_fma_f32 v88, -v92, v61, v88
    v_fma_f32 v89, -v93, v61, v89
    v_fma_f32 v90, -v94, v61, v90
    v_fma_f32 v91, -v95, v61, v91
    v_fma_f32 v88, v88, v128, v62
    v_fma_f32 v89, v89, v129, v62
    s_add_u32 m0, s42, 6144
    s_add_u32 s59, s37, 344448
    buffer_load_dwordx4 v224, s[24:27], s59 offen offset:0 nt lds
    v_fma_f32 v90, v90, v130, v62
    v_fma_f32 v91, v91, v131, v62
    v_max3_f32 v1, v88, v89, v90
    v_max_f32 v1, v1, v91
    v_cmp_lt_f32 vcc, s52, v1
    s_cbranch_vccnz L_site10
L_back10:
    v_exp_f32 v96, v88
    buffer_load_dwordx4 v225, s[24:27], s59 offen offset:1024 nt lds
    v_exp_f32 v97, v89
    v_exp_f32 v98, v90
    v_exp_f32 v99, v91
    v_mul_f32 v88, v96, v128
    v_mul_f32 v89, v97, v129
    v_mul_f32 v90, v98, v130
    v_mul_f32 v91, v99, v131
    v_add_f32 v63, v63, v96
    v_fmac_f32 v64, v88, v92
    v_add_f32 v63, v63, v97
    v_fmac_f32 v64, v89, v93
    v_add_f32 v63, v63, v98
    v_fmac_f32 v64, v90, v94
    v_add_f32 v63, v63, v99
    v_fmac_f32 v64, v91, v95
    v_mov_b32 v68, v88
    v_mov_b32 v69, v89
    v_mov_b32 v70, v90
    v_mov_b32 v71, v91
    s_waitcnt vmcnt(14)
    ds_read_b128 a[120:123], v40 offset:6144
    ds_read_b128 a[124:127], v41 offset:6144
    s_waitcnt lgkmcnt(1)
    v_mfma_f32_16x16x32_bf16 v[112:115], a[120:123], a[120:123], v[84:87]
    s_add_u32 m0, s42, 8192
    s_add_u32 s59, s37, 344576
    buffer_load_dwordx4 v224, s[24:27], s59 offen offset:0 nt lds
    v_mfma_f32_16x16x32_bf16 v[116:119], a[120:123], a[48:51], 0
    s_waitcnt lgkmcnt(0)
    v_mfma_f32_16x16x32_bf16 v[112:115], a[124:127], a[124:127], v[112:115]
    v_mfma_f32_16x16x32_bf16 v[116:119], a[124:127], a[52:55], v[116:119]
    s_waitcnt vmcnt(12)
    ds_read_b128 a[128:131], v40 offset:8192
    ds_read_b128 a[132:135], v41 offset:8192
    v_mfma_f32_16x16x32_bf16 v[108:111], a[120:123], v[52:55], v[80:83]
    v_mfma_f32_16x16x32_bf16 v[104:107], a[120:123], v[136:139], v[76:79]
    v_mfma_f32_16x16x32_bf16 v[108:111], a[124:127], v[52:55], v[108:111]
    v_mfma_f32_16x16x32_bf16 v[104:107], a[124:127], v[140:143], v[104:107]
    s_waitcnt lgkmcnt(1)
    v_mfma_f32_16x16x32_bf16 v[112:115], a[128:131], a[128:131], v[112:115]
    buffer_load_dwordx4 v225, s[24:27], s59 offen offset:1024 nt lds
    v_mfma_f32_16x16x32_bf16 v[116:119], a[128:131], a[56:59], v[116:119]
    s_add_u32 m0, s42, 10240
    s_add_u32 s59, s37, 344704
    buffer_load_dwordx4 v224, s[24:27], s59 offen offset:0 nt lds
    s_waitcnt lgkmcnt(0)
    v_mfma_f32_16x16x32_bf16 v[112:115], a[132:135], a[132:135], v[112:115]
    v_mfma_f32_16x16x32_bf16 v[116:119], a[132:135], a[60:63], v[116:119]
    buffer_load_dwordx4 v225, s[24:27], s59 offen offset:1024 nt lds
    s_waitcnt vmcnt(12)
    ds_read_b128 a[136:139], v40 offset:10240
    ds_read_b128 a[140:143], v41 offset:10240
    s_barrier
    s_add_u32 s61, s60, 3153920
    buffer_load_dwordx4 v[192:195], v65, s[32:35], s61 offen offset:0 sc1
    v_mfma_f32_16x16x32_bf16 v[108:111], a[128:131], v[52:55], v[108:111]
    ds_read_b64_tr_b16 a[146:147], v44 offset:6144
    v_mfma_f32_16x16x32_bf16 v[104:107], a[128:131], v[144:147], v[104:107]
    ds_read_b64_tr_b16 a[150:151], v44 offset:18432
    v_mfma_f32_16x16x32_bf16 v[108:111], a[132:135], v[52:55], v[108:111]
    ds_read_b64_tr_b16 a[154:155], v44 offset:30720
    v_mfma_f32_16x16x32_bf16 v[104:107], a[132:135], v[148:151], v[104:107]
    ds_read_b64_tr_b16 a[158:159], v44 offset:43008
    s_waitcnt lgkmcnt(5)
    v_mfma_f32_16x16x32_bf16 v[112:115], a[136:139], a[136:139], v[112:115]
    ds_read_b64_tr_b16 a[162:163], v45 offset:6144
    v_mfma_f32_16x16x32_bf16 v[116:119], a[136:139], a[64:67], v[116:119]
    ds_read_b64_tr_b16 a[166:167], v45 offset:18432
    s_waitcnt lgkmcnt(6)
    v_mfma_f32_16x16x32_bf16 v[112:115], a[140:143], a[140:143], v[112:115]
    ds_read_b64_tr_b16 a[170:171], v45 offset:30720
    v_mfma_f32_16x16x32_bf16 v[116:119], a[140:143], a[68:71], v[116:119]
    ds_read_b64_tr_b16 a[174:175], v45 offset:43008
    v_mfma_f32_16x16x32_bf16 v[108:111], a[136:139], v[52:55], v[108:111]
    ds_read_b64_tr_b16 a[178:179], v46 offset:6144
    v_mfma_f32_16x16x32_bf16 v[108:111], a[140:143], v[52:55], v[108:111]
    ds_read_b64_tr_b16 a[182:183], v46 offset:18432
    s_nop 2
    v_fma_f32 v112, v116, 2.0, v112
    v_fma_f32 v113, v117, 2.0, v113
    v_fma_f32 v114, v118, 2.0, v114
    v_fma_f32 v115, v119, 2.0, v115
    v_cndmask_b32 v4, 0, v112, s[44:45]
    v_cndmask_b32 v4, v4, v113, s[46:47]
    v_cndmask_b32 v4, v4, v114, s[48:49]
    v_cndmask_b32 v4, v4, v115, s[50:51]
    ds_read_b64_tr_b16 a[186:187], v46 offset:30720
    ds_read_b64_tr_b16 a[190:191], v46 offset:43008
    v_mfma_f32_16x16x4_f32 v[124:127], v4, v60, v[56:59]
    buffer_load_dwordx4 v[196:199], v65, s[32:35], s61 offen offset:1024 sc1
    s_nop 7
    v_mfma_f32_16x16x32_bf16 v[104:107], a[136:139], v[152:155], v[104:107]
    v_fma_f32 v132, -v108, v108, v124
    v_fma_f32 v133, -v109, v109, v125
    v_mfma_f32_16x16x32_bf16 v[104:107], a[140:143], v[156:159], v[104:107]
    v_fma_f32 v134, -v110, v110, v126
    v_fma_f32 v135, -v111, v111, v127
    v_max_f32 v132, v132, v56
    v_max_f32 v133, v133, v56
    v_max_f32 v134, v134, v56
    v_max_f32 v135, v135, v56
    v_rsq_f32 v132, v132
    v_rsq_f32 v133, v133
    v_rsq_f32 v134, v134
    v_rsq_f32 v135, v135
    v_pk_fma_f32 v[104:105], v[108:109], v[60:61], v[104:105] op_sel:[0,1,0] neg_lo:[1,0,0] neg_hi:[1,0,0]
    v_pk_fma_f32 v[106:107], v[110:111], v[60:61], v[106:107] op_sel:[0,1,0] neg_lo:[1,0,0] neg_hi:[1,0,0]
    v_pk_fma_f32 v[104:105], v[104:105], v[132:133], v[62:63] op_sel_hi:[1,1,0]
    v_pk_fma_f32 v[106:107], v[106:107], v[134:135], v[62:63] op_sel_hi:[1,1,0]
L_back11:
    v_max3_f32 v1, v104, v105, v106
    v_max_f32 v1, v1, v107
    v_cmp_lt_f32 vcc, s52, v1
    v_exp_f32 v112, v104
    v_exp_f32 v113, v105
    v_exp_f32 v114, v106
    v_exp_f32 v115, v107
    s_cbranch_vccnz L_site11
    v_cvt_pk_bf16_f32 v72, v88, v89
    v_cvt_pk_bf16_f32 v73, v90, v91
    v_pk_mul_f32 v[104:105], v[112:113], v[132:133]
    v_pk_mul_f32 v[106:107], v[114:115], v[134:135]
    v_cvt_pk_bf16_f32 v74, v104, v105
    v_cvt_pk_bf16_f32 v75, v106, v107
    ds_write_b128 v237, v[72:75] offset:12288
    s_waitcnt lgkmcnt(0)
    s_barrier
    ds_read_b32 v9, v254 offset:4100
    ds_read_b128 a[192:195], v253 offset:12288
    ds_read_b128 a[196:199], v253 offset:13312
    ds_read_b128 a[200:203], v253 offset:14336
    ds_read_b128 a[204:207], v253 offset:15360
    buffer_load_dwordx4 v[200:203], v65, s[32:35], s61 offen offset:2048 sc1
    buffer_load_dwordx4 v[204:207], v65, s[32:35], s61 offen offset:3072 sc1
    s_waitcnt lgkmcnt(4)
    v_cmp_ne_u32 vcc, 0, v9
    s_cbranch_vccnz L_xt11
L_post11:
    s_waitcnt lgkmcnt(3)
    v_mfma_f32_16x16x32_bf16 v[16:19], a[144:147], a[192:195], v[16:19]
    v_add_f32 v68, v68, v104
    v_add_f32 v69, v69, v105
    v_mfma_f32_16x16x32_bf16 v[20:23], a[160:163], a[192:195], v[20:23]
    v_add_f32 v70, v70, v106
    v_add_f32 v71, v71, v107
    v_mfma_f32_16x16x32_bf16 v[24:27], a[176:179], a[192:195], v[24:27]
    v_add_f32 v63, v63, v112
    v_fma_f32 v64, v104, v108, v64
    s_waitcnt lgkmcnt(2)
    v_mfma_f32_16x16x32_bf16 v[16:19], a[148:151], a[196:199], v[16:19]
    s_waitcnt vmcnt(14)
    ds_read_b128 a[96:99], v42 offset:0
    ds_read_b128 a[100:103], v43 offset:0
    v_mfma_f32_16x16x32_bf16 v[20:23], a[164:167], a[196:199], v[20:23]
    v_add_f32 v63, v63, v113
    v_fma_f32 v64, v105, v109, v64
    v_mfma_f32_16x16x32_bf16 v[24:27], a[180:183], a[196:199], v[24:27]
    v_add_f32 v63, v63, v114
    v_fma_f32 v64, v106, v110, v64
    s_waitcnt lgkmcnt(3)
    v_mfma_f32_16x16x32_bf16 v[16:19], a[152:155], a[200:203], v[16:19]
    v_add_f32 v63, v63, v115
    v_fma_f32 v64, v107, v111, v64
    v_mfma_f32_16x16x32_bf16 v[20:23], a[168:171], a[200:203], v[20:23]
    s_waitcnt vmcnt(12)
    ds_read_b128 a[104:107], v42 offset:2048
    ds_read_b128 a[108:111], v43 offset:2048
    v_mfma_f32_16x16x32_bf16 v[24:27], a[184:187], a[200:203], v[24:27]
    s_waitcnt lgkmcnt(4)
    v_mfma_f32_16x16x32_bf16 v[16:19], a[156:159], a[204:207], v[16:19]
    v_mfma_f32_16x16x32_bf16 v[20:23], a[172:175], a[204:207], v[20:23]
    v_mfma_f32_16x16x32_bf16 v[24:27], a[188:191], a[204:207], v[24:27]
    s_waitcnt lgkmcnt(3)
    v_mfma_f32_16x16x32_bf16 v[96:99], a[96:99], a[96:99], v[84:87]
    v_mfma_f32_16x16x32_bf16 v[100:103], a[96:99], a[48:51], 0
    s_waitcnt lgkmcnt(2)
    v_mfma_f32_16x16x32_bf16 v[96:99], a[100:103], a[100:103], v[96:99]
    v_mfma_f32_16x16x32_bf16 v[100:103], a[100:103], a[52:55], v[100:103]
    s_waitcnt vmcnt(10)
    ds_read_b128 a[112:115], v42 offset:4096
    ds_read_b128 a[116:119], v43 offset:4096
    s_barrier
    v_mfma_f32_16x16x32_bf16 v[92:95], a[96:99], v[52:55], v[80:83]
    s_add_u32 s61, s60, 3158016
    buffer_load_dwordx4 v[208:211], v65, s[32:35], s61 offen offset:0 sc1
    ds_read_b64_tr_b16 a[0:1], v47 offset:0
    v_mfma_f32_16x16x32_bf16 v[88:91], a[96:99], v[136:139], v[76:79]
    ds_read_b64_tr_b16 a[4:5], v47 offset:12288
    v_mfma_f32_16x16x32_bf16 v[92:95], a[100:103], v[52:55], v[92:95]
    ds_read_b64_tr_b16 a[8:9], v47 offset:24576
    v_mfma_f32_16x16x32_bf16 v[88:91], a[100:103], v[140:143], v[88:91]
    ds_read_b64_tr_b16 a[12:13], v47 offset:36864
    s_waitcnt lgkmcnt(7)
    v_mfma_f32_16x16x32_bf16 v[96:99], a[104:107], a[104:107], v[96:99]
    buffer_load_dwordx4 v[212:215], v65, s[32:35], s61 offen offset:1024 sc1
    ds_read_b64_tr_b16 a[16:17], v48 offset:0
    v_mfma_f32_16x16x32_bf16 v[100:103], a[104:107], a[56:59], v[100:103]
    ds_read_b64_tr_b16 a[20:21], v48 offset:12288
    s_waitcnt lgkmcnt(8)
    v_mfma_f32_16x16x32_bf16 v[96:99], a[108:111], a[108:111], v[96:99]
    ds_read_b64_tr_b16 a[24:25], v48 offset:24576
    v_mfma_f32_16x16x32_bf16 v[100:103], a[108:111], a[60:63], v[100:103]
    ds_read_b64_tr_b16 a[28:29], v48 offset:36864
    v_mfma_f32_16x16x32_bf16 v[92:95], a[104:107], v[52:55], v[92:95]
    buffer_load_dwordx4 v[216:219], v65, s[32:35], s61 offen offset:2048 sc1
    ds_read_b64_tr_b16 a[32:33], v49 offset:0
    v_mfma_f32_16x16x32_bf16 v[88:91], a[104:107], v[144:147], v[88:91]
    ds_read_b64_tr_b16 a[36:37], v49 offset:12288
    v_mfma_f32_16x16x32_bf16 v[92:95], a[108:111], v[52:55], v[92:95]
    ds_read_b64_tr_b16 a[40:41], v49 offset:24576
    v_mfma_f32_16x16x32_bf16 v[88:91], a[108:111], v[148:151], v[88:91]
    ds_read_b64_tr_b16 a[44:45], v49 offset:36864
    s_waitcnt lgkmcnt(13)
    v_mfma_f32_16x16x32_bf16 v[96:99], a[112:115], a[112:115], v[96:99]
    v_mfma_f32_16x16x32_bf16 v[100:103], a[112:115], a[64:67], v[100:103]
    s_waitcnt lgkmcnt(12)
    v_mfma_f32_16x16x32_bf16 v[96:99], a[116:119], a[116:119], v[96:99]
    v_mfma_f32_16x16x32_bf16 v[100:103], a[116:119], a[68:71], v[100:103]
    s_waitcnt vmcnt(11)
    ds_read_b128 a[120:123], v42 offset:6144
    ds_read_b128 a[124:127], v43 offset:6144
    buffer_load_dwordx4 v[220:223], v65, s[32:35], s61 offen offset:3072 sc1
    v_mfma_f32_16x16x32_bf16 v[92:95], a[112:115], v[52:55], v[92:95]
    v_mfma_f32_16x16x32_bf16 v[92:95], a[116:119], v[52:55], v[92:95]
    s_nop 1
    v_fma_f32 v96, v100, 2.0, v96
    v_fma_f32 v97, v101, 2.0, v97
    v_mfma_f32_16x16x32_bf16 v[88:91], a[112:115], v[152:155], v[88:91]
    v_fma_f32 v98, v102, 2.0, v98
    v_fma_f32 v99, v103, 2.0, v99
    v_mfma_f32_16x16x32_bf16 v[88:91], a[116:119], v[156:159], v[88:91]
    v_cndmask_b32 v3, 0, v96, s[44:45]
    v_cndmask_b32 v3, v3, v97, s[46:47]
    v_cndmask_b32 v3, v3, v98, s[48:49]
    v_cndmask_b32 v3, v3, v99, s[50:51]
    s_nop 0
    s_nop 0
    v_mfma_f32_16x16x4_f32 v[120:123], v3, v60, v[56:59]
    s_waitcnt lgkmcnt(1)
    v_mfma_f32_16x16x32_bf16 v[112:115], a[120:123], a[120:123], v[84:87]
    v_mfma_f32_16x16x32_bf16 v[116:119], a[120:123], a[48:51], 0
    s_waitcnt vmcnt(10)
    ds_read_b128 a[128:131], v42 offset:8192
    ds_read_b128 a[132:135], v43 offset:8192
    s_add_u32 s61, s60, 3162112
    buffer_load_dwordx4 v[224:227], v65, s[32:35], s61 offen offset:0 sc1
    s_waitcnt lgkmcnt(2)
    v_mfma_f32_16x16x32_bf16 v[112:115], a[124:127], a[124:127], v[112:115]
    v_fma_f32 v128, -v92, v92, v120
    v_fma_f32 v129, -v93, v93, v121
    v_fma_f32 v130, -v94, v94, v122
    v_mfma_f32_16x16x32_bf16 v[116:119], a[124:127], a[52:55], v[116:119]
    v_fma_f32 v131, -v95, v95, v123
    v_max_f32 v128, v128, v56
    v_max_f32 v129, v129, v56
    v_mfma_f32_16x16x32_bf16 v[108:111], a[120:123], v[52:55], v[80:83]
    v_max_f32 v130, v130, v56
    v_max_f32 v131, v131, v56
    v_mfma_f32_16x16x32_bf16 v[104:107], a[120:123], v[136:139], v[76:79]
    v_rsq_f32 v128, v128
    v_mfma_f32_16x16x32_bf16 v[108:111], a[124:127], v[52:55], v[108:111]
    v_rsq_f32 v129, v129
    v_mfma_f32_16x16x32_bf16 v[104:107], a[124:127], v[140:143], v[104:107]
    v_rsq_f32 v130, v130
    s_waitcnt lgkmcnt(1)
    v_mfma_f32_16x16x32_bf16 v[112:115], a[128:131], a[128:131], v[112:115]
    v_rsq_f32 v131, v131
    v_fma_f32 v88, -v92, v61, v88
    v_mfma_f32_16x16x32_bf16 v[116:119], a[128:131], a[56:59], v[116:119]
    v_fma_f32 v89, -v93, v61, v89
    v_fma_f32 v90, -v94, v61, v90
    v_fma_f32 v91, -v95, v61, v91
    s_waitcnt lgkmcnt(0)
    v_mfma_f32_16x16x32_bf16 v[112:115], a[132:135], a[132:135], v[112:115]
    v_fma_f32 v88, v88, v128, v62
    v_fma_f32 v89, v89, v129, v62
    v_fma_f32 v90, v90, v130, v62
    v_mfma_f32_16x16x32_bf16 v[116:119], a[132:135], a[60:63], v[116:119]
    s_waitcnt vmcnt(9)
    ds_read_b128 a[136:139], v42 offset:10240
    ds_read_b128 a[140:143], v43 offset:10240
    s_barrier
    buffer_load_dwordx4 v[228:231], v65, s[32:35], s61 offen offset:1024 sc1
    s_cmp_eq_u32 s0, 1
    s_cbranch_scc0 L_nolate
    s_add_u32 s56, s60, 3145728
    buffer_load_dwordx4 v[160:163], v65, s[32:35], s56 offen offset:0 sc1
    buffer_load_dwordx4 v[164:167], v65, s[32:35], s56 offen offset:1024 sc1
    buffer_load_dwordx4 v[168:171], v65, s[32:35], s56 offen offset:2048 sc1
    buffer_load_dwordx4 v[172:175], v65, s[32:35], s56 offen offset:3072 sc1
    s_add_u32 s56, s60, 3149824
    buffer_load_dwordx4 v[176:179], v65, s[32:35], s56 offen offset:0 sc1
    buffer_load_dwordx4 v[180:183], v65, s[32:35], s56 offen offset:1024 sc1
    buffer_load_dwordx4 v[184:187], v65, s[32:35], s56 offen offset:2048 sc1
    buffer_load_dwordx4 v[188:191], v65, s[32:35], s56 offen offset:3072 sc1
L_nolate:
    buffer_load_dword v244, v242, s[32:35], s28 offen
    v_mfma_f32_16x16x32_bf16 v[108:111], a[128:131], v[52:55], v[108:111]
    ds_read_b64_tr_b16 a[2:3], v47 offset:6144
    v_fma_f32 v91, v91, v131, v62
    v_max3_f32 v1, v88, v89, v90
    v_mfma_f32_16x16x32_bf16 v[104:107], a[128:131], v[144:147], v[104:107]
    ds_read_b64_tr_b16 a[6:7], v47 offset:18432
    v_max_f32 v1, v1, v91
    v_mfma_f32_16x16x32_bf16 v[108:111], a[132:135], v[52:55], v[108:111]
    ds_read_b64_tr_b16 a[10:11], v47 offset:30720
    v_cmp_lt_f32 vcc, s52, v1
    s_cbranch_vccnz L_site12
L_back12:
    v_mfma_f32_16x16x32_bf16 v[104:107], a[132:135], v[148:151], v[104:107]
    ds_read_b64_tr_b16 a[14:15], v47 offset:43008
    v_exp_f32 v96, v88
    s_waitcnt lgkmcnt(5)
    v_mfma_f32_16x16x32_bf16 v[112:115], a[136:139], a[136:139], v[112:115]
    ds_read_b64_tr_b16 a[18:19], v48 offset:6144
    v_exp_f32 v97, v89
    v_mfma_f32_16x16x32_bf16 v[116:119], a[136:139], a[64:67], v[116:119]
    ds_read_b64_tr_b16 a[22:23], v48 offset:18432
    v_exp_f32 v98, v90
    s_waitcnt lgkmcnt(6)
    v_mfma_f32_16x16x32_bf16 v[112:115], a[140:143], a[140:143], v[112:115]
    ds_read_b64_tr_b16 a[26:27], v48 offset:30720
    v_exp_f32 v99, v91
    v_mfma_f32_16x16x32_bf16 v[116:119], a[140:143], a[68:71], v[116:119]
    ds_read_b64_tr_b16 a[30:31], v48 offset:43008
    v_mul_f32 v88, v96, v128
    v_mul_f32 v89, v97, v129
    v_mfma_f32_16x16x32_bf16 v[108:111], a[136:139], v[52:55], v[108:111]
    ds_read_b64_tr_b16 a[34:35], v49 offset:6144
    v_mul_f32 v90, v98, v130
    v_mul_f32 v91, v99, v131
    v_mfma_f32_16x16x32_bf16 v[108:111], a[140:143], v[52:55], v[108:111]
    ds_read_b64_tr_b16 a[38:39], v49 offset:18432
    v_add_f32 v63, v63, v96
    v_fmac_f32 v64, v88, v92
    v_add_f32 v63, v63, v97
    v_fmac_f32 v64, v89, v93
    v_add_f32 v63, v63, v98
    v_fma_f32 v112, v116, 2.0, v112
    v_fma_f32 v113, v117, 2.0, v113
    v_fma_f32 v114, v118, 2.0, v114
    v_fma_f32 v115, v119, 2.0, v115
    v_cndmask_b32 v4, 0, v112, s[44:45]
    v_cndmask_b32 v4, v4, v113, s[46:47]
    v_cndmask_b32 v4, v4, v114, s[48:49]
    v_cndmask_b32 v4, v4, v115, s[50:51]
    ds_read_b64_tr_b16 a[42:43], v49 offset:30720
    ds_read_b64_tr_b16 a[46:47], v49 offset:43008
    v_mfma_f32_16x16x4_f32 v[124:127], v4, v60, v[56:59]
    v_fmac_f32 v64, v90, v94
    v_add_f32 v63, v63, v99
    v_fmac_f32 v64, v91, v95
    v_add_f32 v68, v68, v88
    v_add_f32 v69, v69, v89
    v_add_f32 v70, v70, v90
    v_add_f32 v71, v71, v91
    v_cvt_pk_bf16_f32 v72, v88, v89
    v_cvt_pk_bf16_f32 v73, v90, v91
    v_mfma_f32_16x16x32_bf16 v[104:107], a[136:139], v[152:155], v[104:107]
    v_fma_f32 v132, -v108, v108, v124
    v_fma_f32 v133, -v109, v109, v125
    v_mfma_f32_16x16x32_bf16 v[104:107], a[140:143], v[156:159], v[104:107]
    v_fma_f32 v134, -v110, v110, v126
    v_fma_f32 v135, -v111, v111, v127
    v_max_f32 v132, v132, v56
    v_max_f32 v133, v133, v56
    v_max_f32 v134, v134, v56
    v_max_f32 v135, v135, v56
    v_rsq_f32 v132, v132
    v_rsq_f32 v133, v133
    v_rsq_f32 v134, v134
    v_rsq_f32 v135, v135
    v_pk_fma_f32 v[104:105], v[108:109], v[60:61], v[104:105] op_sel:[0,1,0] neg_lo:[1,0,0] neg_hi:[1,0,0]
    v_pk_fma_f32 v[106:107], v[110:111], v[60:61], v[106:107] op_sel:[0,1,0] neg_lo:[1,0,0] neg_hi:[1,0,0]
    v_pk_fma_f32 v[104:105], v[104:105], v[132:133], v[62:63] op_sel_hi:[1,1,0]
    v_pk_fma_f32 v[106:107], v[106:107], v[134:135], v[62:63] op_sel_hi:[1,1,0]
L_back13:
    v_max3_f32 v1, v104, v105, v106
    v_max_f32 v1, v1, v107
    v_cmp_lt_f32 vcc, s52, v1
    v_exp_f32 v112, v104
    v_exp_f32 v113, v105
    v_exp_f32 v114, v106
    v_exp_f32 v115, v107
    s_cbranch_vccnz L_site13
    v_pk_mul_f32 v[104:105], v[112:113], v[132:133]
    v_pk_mul_f32 v[106:107], v[114:115], v[134:135]
    v_cvt_pk_bf16_f32 v74, v104, v105
    v_cvt_pk_bf16_f32 v75, v106, v107
    ds_write_b128 v237, v[72:75] offset:0
    v_pk_add_f32 v[68:69], v[68:69], v[104:105]
    v_pk_add_f32 v[70:71], v[70:71], v[106:107]
    v_pk_add_f32 v[112:113], v[112:113], v[114:115]
    v_cvt_pk_bf16_f32 v66, v68, v69
    v_cvt_pk_bf16_f32 v67, v70, v71
    ds_write_b64 v238, v[66:67]
    v_pk_mul_f32 v[114:115], v[104:105], v[108:109]
    v_add_f32 v63, v63, v112
    v_pk_fma_f32 v[114:115], v[106:107], v[110:111], v[114:115]
    v_add_f32 v10, v63, v113
    v_add_f32 v64, v64, v114
    v_add_f32 v11, v64, v115
    ds_write_b64 v238, v[10:11] offset:2048
L_merge:
    s_waitcnt lgkmcnt(0)
    s_barrier
L_postx:
    ds_read_b32 v9, v254 offset:4096
    ds_read_b128 v[92:95], v253 offset:0
    ds_read_b128 v[96:99], v253 offset:1024
    ds_read_b128 v[100:103], v253 offset:2048
    ds_read_b64 v[136:137], v254 offset:2048
    ds_read_b64 v[138:139], v254 offset:2560
    ds_read_b64 v[140:141], v254 offset:3072
    ds_read_b64 v[142:143], v254 offset:3584
    ds_read_b128 v[116:119], v253 offset:3072
    ds_read_b64 v[120:121], v254 offset:0
    ds_read_b64 v[122:123], v254 offset:512
    s_waitcnt lgkmcnt(10)
    v_cmp_ne_u32 vcc, 0, v9
    s_cbranch_vccnz L_xlast
    s_waitcnt lgkmcnt(9)
    v_mfma_f32_16x16x32_bf16 v[16:19], a[0:3], v[92:95], v[16:19]
    ds_read_b64 v[124:125], v254 offset:1024
    v_mfma_f32_16x16x32_bf16 v[20:23], a[16:19], v[92:95], v[20:23]
    ds_read_b64 v[126:127], v254 offset:1536
    v_mfma_f32_16x16x32_bf16 v[24:27], a[32:35], v[92:95], v[24:27]
    s_waitcnt lgkmcnt(10)
    v_mfma_f32_16x16x32_bf16 v[16:19], a[4:7], v[96:99], v[16:19]
    v_mfma_f32_16x16x32_bf16 v[20:23], a[20:23], v[96:99], v[20:23]
    v_mfma_f32_16x16x32_bf16 v[24:27], a[36:39], v[96:99], v[24:27]
    s_waitcnt lgkmcnt(9)
    v_mfma_f32_16x16x32_bf16 v[16:19], a[8:11], v[100:103], v[16:19]
    s_waitcnt lgkmcnt(5)
    v_add_f32 v1, v136, v138
    v_add_f32 v2, v137, v139
    v_add_f32 v140, v140, v142
    v_mfma_f32_16x16x32_bf16 v[20:23], a[24:27], v[100:103], v[20:23]
    v_add_f32 v141, v141, v143
    v_add_f32 v1, v1, v140
    v_add_f32 v2, v2, v141
    v_mfma_f32_16x16x32_bf16 v[24:27], a[40:43], v[100:103], v[24:27]
    s_nop 0
    v_permlane32_swap_b32 v1, v2
    v_add_f32 v1, v1, v2
    v_mov_b32 v2, v1
    s_waitcnt lgkmcnt(4)
    v_mfma_f32_16x16x32_bf16 v[16:19], a[12:15], v[116:119], v[16:19]
    v_permlane16_swap_b32 v1, v2
    v_add_f32 v1, v1, v2
    v_mov_b32 v2, v1
    s_waitcnt lgkmcnt(2)
    v_mfma_f32_16x16x32_bf16 v[16:19], a[72:75], v[120:123], v[16:19]
    v_permlane32_swap_b32 v1, v2
    v_rcp_f32 v3, v1
    s_waitcnt lgkmcnt(0)
    v_mfma_f32_16x16x32_bf16 v[16:19], a[76:79], v[124:127], v[16:19]
    v_log_f32 v4, v1
    v_mul_f32 v5, v60, v3
    v_mfma_f32_16x16x32_bf16 v[20:23], a[28:31], v[116:119], v[20:23]
    v_mul_f32 v6, v2, v3
    v_sub_f32 v4, v4, v255
    v_mfma_f32_16x16x32_bf16 v[20:23], a[80:83], v[120:123], v[20:23]
    v_mfma_f32_16x16x32_bf16 v[20:23], a[84:87], v[124:127], v[20:23]
    v_mfma_f32_16x16x32_bf16 v[24:27], a[44:47], v[116:119], v[24:27]
    v_fma_f32 v16, v16, v5, -v6
    v_fma_f32 v17, v17, v5, -v6
    v_mfma_f32_16x16x32_bf16 v[24:27], a[88:91], v[120:123], v[24:27]
    v_fma_f32 v18, v18, v5, -v6
    v_fma_f32 v19, v19, v5, -v6
    v_mfma_f32_16x16x32_bf16 v[24:27], a[92:95], v[124:127], v[24:27]
    v_cvt_pk_bf16_f32 v66, v16, v17
    v_cvt_pk_bf16_f32 v67, v18, v19
    ds_write_b64 v236, v[66:67] offset:0
    v_pk_fma_f32 v[20:21], v[20:21], v[4:5], v[6:7] op_sel:[0,1,0] op_sel_hi:[1,1,0] neg_lo:[0,0,1] neg_hi:[0,0,1]
    v_pk_fma_f32 v[22:23], v[22:23], v[4:5], v[6:7] op_sel:[0,1,0] op_sel_hi:[1,1,0] neg_lo:[0,0,1] neg_hi:[0,0,1]
    v_cvt_pk_bf16_f32 v68, v20, v21
    v_cvt_pk_bf16_f32 v69, v22, v23
    ds_write_b64 v236, v[68:69] offset:512
    v_pk_fma_f32 v[24:25], v[24:25], v[4:5], v[6:7] op_sel:[0,1,0] op_sel_hi:[1,1,0] neg_lo:[0,0,1] neg_hi:[0,0,1]
    v_pk_fma_f32 v[26:27], v[26:27], v[4:5], v[6:7] op_sel:[0,1,0] op_sel_hi:[1,1,0] neg_lo:[0,0,1] neg_hi:[0,0,1]
    v_cvt_pk_bf16_f32 v70, v24, v25
    v_cvt_pk_bf16_f32 v71, v26, v27
    ds_write_b64 v236, v[70:71] offset:1024
    s_waitcnt lgkmcnt(0)
    s_barrier
    ds_read_b128 v[136:139], v241 offset:0
    ds_read_b128 v[140:143], v241 offset:1024
    ds_read_b128 v[144:147], v241 offset:2048
    ds_read_b128 v[148:151], v241 offset:3072
    ds_read_b128 v[152:155], v241 offset:4096
    ds_read_b128 v[156:159], v241 offset:5120
    s_waitcnt vmcnt(1)
    v_mov_b32 v35, v4
    v_add_u32 v39, s39, v4
    s_waitcnt lgkmcnt(5)
    v_mfma_f32_16x16x32_bf16 v[16:19], v[160:163], v[136:139], 0
    v_mfma_f32_16x16x32_bf16 v[20:23], v[184:187], v[136:139], 0
    v_mfma_f32_16x16x32_bf16 v[24:27], v[208:211], v[136:139], 0
    s_waitcnt lgkmcnt(4)
    v_mfma_f32_16x16x32_bf16 v[16:19], v[164:167], v[140:143], v[16:19]
    v_mfma_f32_16x16x32_bf16 v[20:23], v[188:191], v[140:143], v[20:23]
    v_mfma_f32_16x16x32_bf16 v[24:27], v[212:215], v[140:143], v[24:27]
    s_waitcnt lgkmcnt(3)
    v_mfma_f32_16x16x32_bf16 v[16:19], v[168:171], v[144:147], v[16:19]
    v_mfma_f32_16x16x32_bf16 v[20:23], v[192:195], v[144:147], v[20:23]
    v_mfma_f32_16x16x32_bf16 v[24:27], v[216:219], v[144:147], v[24:27]
    s_waitcnt lgkmcnt(2)
    v_mfma_f32_16x16x32_bf16 v[16:19], v[172:175], v[148:151], v[16:19]
    s_waitcnt lgkmcnt(1)
    v_mfma_f32_16x16x32_bf16 v[16:19], v[176:179], v[152:155], v[16:19]
    s_waitcnt lgkmcnt(0)
    v_mfma_f32_16x16x32_bf16 v[16:19], v[180:183], v[156:159], v[16:19]
    v_mfma_f32_16x16x32_bf16 v[20:23], v[196:199], v[148:151], v[20:23]
    v_mfma_f32_16x16x32_bf16 v[20:23], v[200:203], v[152:155], v[20:23]
    v_mfma_f32_16x16x32_bf16 v[20:23], v[204:207], v[156:159], v[20:23]
    v_mfma_f32_16x16x32_bf16 v[24:27], v[220:223], v[148:151], v[24:27]
    v_mfma_f32_16x16x32_bf16 v[24:27], v[224:227], v[152:155], v[24:27]
    s_nop 2
    v_cvt_pk_bf16_f32 v32, v16, v17
    v_mfma_f32_16x16x32_bf16 v[24:27], v[228:231], v[156:159], v[24:27]
    v_cvt_pk_bf16_f32 v33, v18, v19
    v_cvt_pk_bf16_f32 v34, v20, v21
    v_cvt_pk_bf16_f32 v36, v22, v23
    buffer_store_dwordx4 v[32:35], v242, s[32:35], s28 offen sc1
    s_nop 3
    v_cvt_pk_bf16_f32 v37, v24, v25
    v_cvt_pk_bf16_f32 v38, v26, v27
    buffer_store_dwordx4 v[36:39], v243, s[32:35], s28 offen sc1
    s_cmp_lt_u32 s29, 64
    s_cbranch_scc0 L_fin
    buffer_load_dwordx4 v[76:79], v65, s[32:35], s30 offen offset:0 sc1
    buffer_load_dwordx4 v[80:83], v65, s[32:35], s30 offen offset:1024 sc1
    buffer_load_dwordx4 v[84:87], v65, s[32:35], s30 offen offset:2048 sc1
    buffer_load_dwordx4 v[108:111], v65, s[32:35], s30 offen offset:3072 sc1
    buffer_load_dwordx4 v[112:115], v65, s[32:35], s31 offen offset:0 sc1
    buffer_load_dwordx4 v[128:131], v65, s[32:35], s31 offen offset:1024 sc1
    buffer_load_dwordx4 v[132:135], v65, s[32:35], s31 offen offset:2048 sc1
    buffer_load_dwordx4 v[52:55], v65, s[32:35], s31 offen offset:3072 sc1
    ds_bpermute_b32 v42, v252, v4
    v_bfe_u32 v48, v0, 2, 1
    v_cmp_eq_u32 vcc, 1, v48
    v_mov_b32 v246, s39
    s_movk_i32 s26, 0x101
    v_cndmask_b32 v247, 0, v246, vcc
    v_sub_u32 v246, v246, v247
    v_sub_u32 v246, v246, v247
    v_mov_b32 v16, 0
    v_mov_b32 v17, 0
    v_mov_b32 v18, 0
    v_mov_b32 v19, 0
    v_mov_b32 v20, 0
    v_mov_b32 v21, 0
    v_mov_b32 v22, 0
    v_mov_b32 v97, 0
    s_mov_b32 s53, 0
    s_waitcnt vmcnt(0)
    v_sub_u32_dpp v136, v79, v79 row_half_mirror row_mask:0xf bank_mask:0xf
    v_sub_u32_dpp v137, v83, v83 row_half_mirror row_mask:0xf bank_mask:0xf
    v_sub_u32_dpp v138, v87, v87 row_half_mirror row_mask:0xf bank_mask:0xf
    v_sub_u32_dpp v139, v111, v111 row_half_mirror row_mask:0xf bank_mask:0xf
    v_sub_u32_dpp v140, v115, v115 row_half_mirror row_mask:0xf bank_mask:0xf
    v_sub_u32_dpp v141, v131, v131 row_half_mirror row_mask:0xf bank_mask:0xf
    v_sub_u32_dpp v142, v135, v135 row_half_mirror row_mask:0xf bank_mask:0xf
    v_sub_u32_dpp v143, v55, v55 row_half_mirror row_mask:0xf bank_mask:0xf
    v_cmp_eq_u32 s[6:7], v136, v246
    v_mov_b32 v136, 0x101
    v_cmp_eq_u32 s[8:9], v137, v246
    v_mov_b32 v137, 0x202
    v_cmp_eq_u32 s[10:11], v138, v246
    v_mov_b32 v138, 0x404
    v_cmp_eq_u32 s[12:13], v139, v246
    v_mov_b32 v139, 0x808
    v_cmp_eq_u32 s[14:15], v140, v246
    v_mov_b32 v140, 0x1010
    v_cmp_eq_u32 s[16:17], v141, v246
    v_mov_b32 v141, 0x2020
    v_cmp_eq_u32 s[36:37], v142, v246
    v_mov_b32 v142, 0x4040
    v_cmp_eq_u32 s[40:41], v143, v246
    v_mov_b32 v143, 0x8080
    v_cndmask_b32 v136, v136, 0, s[6:7]
    v_cndmask_b32 v137, v137, 0, s[8:9]
    v_cndmask_b32 v138, v138, 0, s[10:11]
    v_cndmask_b32 v139, v139, 0, s[12:13]
    v_cndmask_b32 v140, v140, 0, s[14:15]
    v_cndmask_b32 v141, v141, 0, s[16:17]
    v_cndmask_b32 v142, v142, 0, s[36:37]
    v_cndmask_b32 v143, v143, 0, s[40:41]
    v_or3_b32 v96, v136, v137, v138
    v_or3_b32 v139, v139, v140, v141
    v_or3_b32 v96, v96, v142, v143
    v_or_b32 v96, v96, v139
    v_cmp_ne_u32 s[24:25], 0, v96
    s_waitcnt lgkmcnt(0)
    v_lshrrev_b32 v48, v97, v96
    v_ffbl_b32 v48, v48
    v_add_u32 v48, v48, v97
    v_and_b32 v48, 7, v48
    v_lshl_add_u32 v51, v48, 10, v65
    v_lshlrev_b32 v88, v48, s26
    v_add_u32 v97, 1, v48
    s_mov_b64 exec, s[24:25]
    buffer_load_dwordx4 v[136:139], v51, s[32:35], s30 offen sc1
    s_mov_b64 exec, -1
    s_mov_b64 exec, s[6:7]
    v_sub_u32 v49, v79, v247
    v_sub_f32 v49, v49, v42
    v_exp_f32 v49, v49
    s_nop 0
    v_cvt_pk_bf16_f32 v49, v49, 0
    v_lshlrev_b32 v50, 16, v49
    v_dot2_f32_bf16 v16, v76, v49, v16
    v_dot2_f32_bf16 v18, v77, v49, v18
    v_dot2_f32_bf16 v20, v78, v49, v20
    v_add_f32 v22, v22, v50
    v_dot2_f32_bf16 v17, v76, v50, v17
    v_dot2_f32_bf16 v19, v77, v50, v19
    v_dot2_f32_bf16 v21, v78, v50, v21
    s_mov_b64 exec, -1
    s_mov_b64 exec, s[8:9]
    v_sub_u32 v49, v83, v247
    v_sub_f32 v49, v49, v42
    v_exp_f32 v49, v49
    s_nop 0
    v_cvt_pk_bf16_f32 v49, v49, 0
    v_lshlrev_b32 v50, 16, v49
    v_dot2_f32_bf16 v16, v80, v49, v16
    v_dot2_f32_bf16 v18, v81, v49, v18
    v_dot2_f32_bf16 v20, v82, v49, v20
    v_add_f32 v22, v22, v50
    v_dot2_f32_bf16 v17, v80, v50, v17
    v_dot2_f32_bf16 v19, v81, v50, v19
    v_dot2_f32_bf16 v21, v82, v50, v21
    s_mov_b64 exec, -1
    v_lshrrev_b32 v48, v97, v96
    v_ffbl_b32 v48, v48
    v_add_u32 v48, v48, v97
    v_and_b32 v48, 7, v48
    v_lshl_add_u32 v51, v48, 10, v65
    v_lshlrev_b32 v89, v48, s26
    v_add_u32 v97, 1, v48
    s_mov_b64 exec, s[24:25]
    buffer_load_dwordx4 v[140:143], v51, s[32:35], s30 offen sc1
    s_mov_b64 exec, -1
    s_mov_b64 exec, s[10:11]
    v_sub_u32 v49, v87, v247
    v_sub_f32 v49, v49, v42
    v_exp_f32 v49, v49
    s_nop 0
    v_cvt_pk_bf16_f32 v49, v49, 0
    v_lshlrev_b32 v50, 16, v49
    v_dot2_f32_bf16 v16, v84, v49, v16
    v_dot2_f32_bf16 v18, v85, v49, v18
    v_dot2_f32_bf16 v20, v86, v49, v20
    v_add_f32 v22, v22, v50
    v_dot2_f32_bf16 v17, v84, v50, v17
    v_dot2_f32_bf16 v19, v85, v50, v19
    v_dot2_f32_bf16 v21, v86, v50, v21
    s_mov_b64 exec, -1
    s_mov_b64 exec, s[12:13]
    v_sub_u32 v49, v111, v247
    v_sub_f32 v49, v49, v42
    v_exp_f32 v49, v49
    s_nop 0
    v_cvt_pk_bf16_f32 v49, v49, 0
    v_lshlrev_b32 v50, 16, v49
    v_dot2_f32_bf16 v16, v108, v49, v16
    v_dot2_f32_bf16 v18, v109, v49, v18
    v_dot2_f32_bf16 v20, v110, v49, v20
    v_add_f32 v22, v22, v50
    v_dot2_f32_bf16 v17, v108, v50, v17
    v_dot2_f32_bf16 v19, v109, v50, v19
    v_dot2_f32_bf16 v21, v110, v50, v21
    s_mov_b64 exec, -1
    v_lshrrev_b32 v48, v97, v96
    v_ffbl_b32 v48, v48
    v_add_u32 v48, v48, v97
    v_and_b32 v48, 7, v48
    v_lshl_add_u32 v51, v48, 10, v65
    v_lshlrev_b32 v90, v48, s26
    v_add_u32 v97, 1, v48
    s_mov_b64 exec, s[24:25]
    buffer_load_dwordx4 v[144:147], v51, s[32:35], s30 offen sc1
    s_mov_b64 exec, -1
    s_mov_b64 exec, s[14:15]
    v_sub_u32 v49, v115, v247
    v_sub_f32 v49, v49, v42
    v_exp_f32 v49, v49
    s_nop 0
    v_cvt_pk_bf16_f32 v49, v49, 0
    v_lshlrev_b32 v50, 16, v49
    v_dot2_f32_bf16 v16, v112, v49, v16
    v_dot2_f32_bf16 v18, v113, v49, v18
    v_dot2_f32_bf16 v20, v114, v49, v20
    v_add_f32 v22, v22, v50
    v_dot2_f32_bf16 v17, v112, v50, v17
    v_dot2_f32_bf16 v19, v113, v50, v19
    v_dot2_f32_bf16 v21, v114, v50, v21
    s_mov_b64 exec, -1
    s_mov_b64 exec, s[16:17]
    v_sub_u32 v49, v131, v247
    v_sub_f32 v49, v49, v42
    v_exp_f32 v49, v49
    s_nop 0
    v_cvt_pk_bf16_f32 v49, v49, 0
    v_lshlrev_b32 v50, 16, v49
    v_dot2_f32_bf16 v16, v128, v49, v16
    v_dot2_f32_bf16 v18, v129, v49, v18
    v_dot2_f32_bf16 v20, v130, v49, v20
    v_add_f32 v22, v22, v50
    v_dot2_f32_bf16 v17, v128, v50, v17
    v_dot2_f32_bf16 v19, v129, v50, v19
    v_dot2_f32_bf16 v21, v130, v50, v21
    s_mov_b64 exec, -1
    v_lshrrev_b32 v48, v97, v96
    v_ffbl_b32 v48, v48
    v_add_u32 v48, v48, v97
    v_and_b32 v48, 7, v48
    v_lshl_add_u32 v51, v48, 10, v65
    v_lshlrev_b32 v91, v48, s26
    v_add_u32 v97, 1, v48
    s_mov_b64 exec, s[24:25]
    buffer_load_dwordx4 v[148:151], v51, s[32:35], s30 offen sc1
    s_mov_b64 exec, -1
    s_mov_b64 exec, s[36:37]
    v_sub_u32 v49, v135, v247
    v_sub_f32 v49, v49, v42
    v_exp_f32 v49, v49
    s_nop 0
    v_cvt_pk_bf16_f32 v49, v49, 0
    v_lshlrev_b32 v50, 16, v49
    v_dot2_f32_bf16 v16, v132, v49, v16
    v_dot2_f32_bf16 v18, v133, v49, v18
    v_dot2_f32_bf16 v20, v134, v49, v20
    v_add_f32 v22, v22, v50
    v_dot2_f32_bf16 v17, v132, v50, v17
    v_dot2_f32_bf16 v19, v133, v50, v19
    v_dot2_f32_bf16 v21, v134, v50, v21
    s_mov_b64 exec, -1
    s_mov_b64 exec, s[40:41]
    v_sub_u32 v49, v55, v247
    v_sub_f32 v49, v49, v42
    v_exp_f32 v49, v49
    s_nop 0
    v_cvt_pk_bf16_f32 v49, v49, 0
    v_lshlrev_b32 v50, 16, v49
    v_dot2_f32_bf16 v16, v52, v49, v16
    v_dot2_f32_bf16 v18, v53, v49, v18
    v_dot2_f32_bf16 v20, v54, v49, v20
    v_add_f32 v22, v22, v50
    v_dot2_f32_bf16 v17, v52, v50, v17
    v_dot2_f32_bf16 v19, v53, v50, v19
    v_dot2_f32_bf16 v21, v54, v50, v21
    s_mov_b64 exec, -1
    s_cmp_eq_u64 s[24:25], 0
    s_cbranch_scc1 L_c_red
L_c_loop:
    s_waitcnt vmcnt(3)
    v_sub_u32_dpp v48, v139, v139 row_half_mirror row_mask:0xf bank_mask:0xf
    v_and_b32 v49, v88, v96
    v_cmp_eq_u32 vcc, v48, v246
    v_cmp_ne_u32 s[24:25], 0, v49
    s_and_b64 exec, vcc, s[24:25]
    s_cbranch_scc0 L_c_s0
    v_xor_b32 v96, v96, v88
    v_sub_u32 v49, v139, v247
    v_sub_f32 v49, v49, v42
    v_exp_f32 v49, v49
    s_nop 0
    v_cvt_pk_bf16_f32 v49, v49, 0
    v_lshlrev_b32 v50, 16, v49
    v_dot2_f32_bf16 v16, v136, v49, v16
    v_dot2_f32_bf16 v18, v137, v49, v18
    v_dot2_f32_bf16 v20, v138, v49, v20
    v_add_f32 v22, v22, v50
    v_dot2_f32_bf16 v17, v136, v50, v17
    v_dot2_f32_bf16 v19, v137, v50, v19
    v_dot2_f32_bf16 v21, v138, v50, v21
L_c_s0:
    s_mov_b64 exec, -1
    v_cmp_ne_u32 vcc, 0, v96
    v_lshrrev_b32 v48, v97, v96
    s_cbranch_vccz L_c_red
    v_ffbl_b32 v48, v48
    v_add_u32 v48, v48, v97
    v_and_b32 v48, 7, v48
    v_lshl_add_u32 v51, v48, 10, v65
    v_lshlrev_b32 v88, v48, s26
    v_add_u32 v97, 1, v48
    s_mov_b64 exec, vcc
    buffer_load_dwordx4 v[136:139], v51, s[32:35], s30 offen sc1
    s_mov_b64 exec, -1
    s_waitcnt vmcnt(3)
    v_sub_u32_dpp v48, v143, v143 row_half_mirror row_mask:0xf bank_mask:0xf
    v_and_b32 v49, v89, v96
    v_cmp_eq_u32 vcc, v48, v246
    v_cmp_ne_u32 s[24:25], 0, v49
    s_and_b64 exec, vcc, s[24:25]
    s_cbranch_scc0 L_c_s1
    v_xor_b32 v96, v96, v89
    v_sub_u32 v49, v143, v247
    v_sub_f32 v49, v49, v42
    v_exp_f32 v49, v49
    s_nop 0
    v_cvt_pk_bf16_f32 v49, v49, 0
    v_lshlrev_b32 v50, 16, v49
    v_dot2_f32_bf16 v16, v140, v49, v16
    v_dot2_f32_bf16 v18, v141, v49, v18
    v_dot2_f32_bf16 v20, v142, v49, v20
    v_add_f32 v22, v22, v50
    v_dot2_f32_bf16 v17, v140, v50, v17
    v_dot2_f32_bf16 v19, v141, v50, v19
    v_dot2_f32_bf16 v21, v142, v50, v21
L_c_s1:
    s_mov_b64 exec, -1
    v_cmp_ne_u32 vcc, 0, v96
    v_lshrrev_b32 v48, v97, v96
    s_cbranch_vccz L_c_red
    v_ffbl_b32 v48, v48
    v_add_u32 v48, v48, v97
    v_and_b32 v48, 7, v48
    v_lshl_add_u32 v51, v48, 10, v65
    v_lshlrev_b32 v89, v48, s26
    v_add_u32 v97, 1, v48
    s_mov_b64 exec, vcc
    buffer_load_dwordx4 v[140:143], v51, s[32:35], s30 offen sc1
    s_mov_b64 exec, -1
    s_waitcnt vmcnt(3)
    v_sub_u32_dpp v48, v147, v147 row_half_mirror row_mask:0xf bank_mask:0xf
    v_and_b32 v49, v90, v96
    v_cmp_eq_u32 vcc, v48, v246
    v_cmp_ne_u32 s[24:25], 0, v49
    s_and_b64 exec, vcc, s[24:25]
    s_cbranch_scc0 L_c_s2
    v_xor_b32 v96, v96, v90
    v_sub_u32 v49, v147, v247
    v_sub_f32 v49, v49, v42
    v_exp_f32 v49, v49
    s_nop 0
    v_cvt_pk_bf16_f32 v49, v49, 0
    v_lshlrev_b32 v50, 16, v49
    v_dot2_f32_bf16 v16, v144, v49, v16
    v_dot2_f32_bf16 v18, v145, v49, v18
    v_dot2_f32_bf16 v20, v146, v49, v20
    v_add_f32 v22, v22, v50
    v_dot2_f32_bf16 v17, v144, v50, v17
    v_dot2_f32_bf16 v19, v145, v50, v19
    v_dot2_f32_bf16 v21, v146, v50, v21
L_c_s2:
    s_mov_b64 exec, -1
    v_cmp_ne_u32 vcc, 0, v96
    v_lshrrev_b32 v48, v97, v96
    s_cbranch_vccz L_c_red
    v_ffbl_b32 v48, v48
    v_add_u32 v48, v48, v97
    v_and_b32 v48, 7, v48
    v_lshl_add_u32 v51, v48, 10, v65
    v_lshlrev_b32 v90, v48, s26
    v_add_u32 v97, 1, v48
    s_mov_b64 exec, vcc
    buffer_load_dwordx4 v[144:147], v51, s[32:35], s30 offen sc1
    s_mov_b64 exec, -1
    s_waitcnt vmcnt(3)
    v_sub_u32_dpp v48, v151, v151 row_half_mirror row_mask:0xf bank_mask:0xf
    v_and_b32 v49, v91, v96
    v_cmp_eq_u32 vcc, v48, v246
    v_cmp_ne_u32 s[24:25], 0, v49
    s_and_b64 exec, vcc, s[24:25]
    s_cbranch_scc0 L_c_s3
    v_xor_b32 v96, v96, v91
    v_sub_u32 v49, v151, v247
    v_sub_f32 v49, v49, v42
    v_exp_f32 v49, v49
    s_nop 0
    v_cvt_pk_bf16_f32 v49, v49, 0
    v_lshlrev_b32 v50, 16, v49
    v_dot2_f32_bf16 v16, v148, v49, v16
    v_dot2_f32_bf16 v18, v149, v49, v18
    v_dot2_f32_bf16 v20, v150, v49, v20
    v_add_f32 v22, v22, v50
    v_dot2_f32_bf16 v17, v148, v50, v17
    v_dot2_f32_bf16 v19, v149, v50, v19
    v_dot2_f32_bf16 v21, v150, v50, v21
L_c_s3:
    s_mov_b64 exec, -1
    v_cmp_ne_u32 vcc, 0, v96
    v_lshrrev_b32 v48, v97, v96
    s_cbranch_vccz L_c_red
    v_ffbl_b32 v48, v48
    v_add_u32 v48, v48, v97
    v_and_b32 v48, 7, v48
    v_lshl_add_u32 v51, v48, 10, v65
    v_lshlrev_b32 v91, v48, s26
    v_add_u32 v97, 1, v48
    s_mov_b64 exec, vcc
    buffer_load_dwordx4 v[148:151], v51, s[32:35], s30 offen sc1
    s_mov_b64 exec, -1
    s_add_u32 s53, s53, 1
    s_cmp_lt_u32 s53, 65536
    s_cbranch_scc1 L_c_loop
L_c_red:
    v_mov_b32 v23, v22
    v_permlane32_swap_b32 v16, v20
    v_permlane32_swap_b32 v17, v21
    v_permlane32_swap_b32 v18, v22
    v_permlane32_swap_b32 v19, v23
    v_add_f32 v16, v16, v20
    v_add_f32 v17, v17, v21
    v_add_f32 v18, v18, v22
    v_add_f32 v19, v19, v23
    s_nop 0
    v_permlane16_swap_b32 v16, v18
    v_permlane16_swap_b32 v17, v19
    v_add_f32 v16, v16, v18
    v_add_f32 v17, v17, v19
    s_nop 0
    v_add_f32_dpp v48, v16, v16 row_ror:8 row_mask:0xf bank_mask:0x3
    s_nop 1
    v_add_f32_dpp v48, v17, v17 row_ror:8 row_mask:0xf bank_mask:0xc
    ds_write_b32 v250, v48
    s_waitcnt lgkmcnt(0)
    s_barrier
    ds_read_b128 v[48:51], v251 offset:768
    ds_read_b128 v[52:55], v65
    v_lshlrev_b32 v18, 16, v249
    s_waitcnt lgkmcnt(1)
    v_add_f32 v48, v48, v49
    v_add_f32 v50, v50, v51
    v_add_f32 v48, v48, v50
    v_cmp_nlt_f32 vcc, v48, v232
    v_rcp_f32 v48, v48
    s_waitcnt lgkmcnt(0)
    s_cbranch_vccnz L_c_slow
L_c_out:
    s_cmp_lg_u32 s3, 0
    s_cbranch_scc1 L_fin
    v_add_f32 v52, v52, v53
    v_add_f32 v54, v54, v55
    v_add_f32 v52, v52, v54
    v_fmac_f32 v18, v52, v48
    v_cvt_pk_bf16_f32 v18, v18, v18
    buffer_store_short v18, v248, s[68:71], 0 offen
    s_cmp_lg_u32 s29, 0
    s_cbranch_scc1 L_fin
    v_mov_b32 v48, s39
    v_mov_b32 v49, 0
    s_mov_b64 exec, 1
    buffer_store_dword v48, v49, s[32:35], 0 offen offset:0 sc1
    s_mov_b64 exec, -1
L_fin:
L_end:
    s_endpgm
L_hot:
L_prod:
    s_cmp_lg_u32 s3, 0
    s_cbranch_scc1 L_p_noq
    s_mov_b32 m0, 147456
    s_nop 0
    buffer_load_dwordx4 v16, s[72:75], 0 offen offset:0  lds
    buffer_load_dwordx4 v17, s[72:75], 0 offen offset:1024  lds
    buffer_load_dwordx4 v18, s[72:75], 0 offen offset:2048  lds
    buffer_load_dwordx4 v19, s[72:75], 0 offen offset:3072  lds
    s_mov_b32 m0, 151552
    s_nop 0
    buffer_load_dwordx4 v20, s[72:75], 0 offen offset:0  lds
    buffer_load_dwordx4 v21, s[72:75], 0 offen offset:1024  lds
L_p_noq:
    s_mul_i32 s60, s3, 18432
    s_add_u32 m0, s60, 73728
    s_nop 0
    buffer_load_dwordx4 v16, s[64:67], s60 offen offset:0  lds
    buffer_load_dwordx4 v17, s[64:67], s60 offen offset:1024  lds
    buffer_load_dwordx4 v18, s[64:67], s60 offen offset:2048  lds
    buffer_load_dwordx4 v19, s[64:67], s60 offen offset:3072  lds
    s_add_u32 m0, s60, 77824
    s_nop 0
    buffer_load_dwordx4 v20, s[64:67], s60 offen offset:0  lds
    buffer_load_dwordx4 v21, s[64:67], s60 offen offset:1024  lds
    s_add_u32 s60, s60, 6144
    s_add_u32 m0, s60, 73728
    s_nop 0
    buffer_load_dwordx4 v16, s[64:67], s60 offen offset:0  lds
    buffer_load_dwordx4 v17, s[64:67], s60 offen offset:1024  lds
    buffer_load_dwordx4 v18, s[64:67], s60 offen offset:2048  lds
    buffer_load_dwordx4 v19, s[64:67], s60 offen offset:3072  lds
    s_add_u32 m0, s60, 77824
    s_nop 0
    buffer_load_dwordx4 v20, s[64:67], s60 offen offset:0  lds
    buffer_load_dwordx4 v21, s[64:67], s60 offen offset:1024  lds
    s_add_u32 s60, s60, 6144
    s_add_u32 m0, s60, 73728
    s_nop 0
    buffer_load_dwordx4 v16, s[64:67], s60 offen offset:0  lds
    v_mov_b32 v52, 0x3f803f80
    v_mov_b32 v56, 0x3ebcbe62
    s_mov_b32 s44, 0x100001
    s_mov_b32 s45, 0x10000100
    v_mov_b32 v53, 0x3f803f80
    v_mov_b32 v57, 0x3ebcbe62
    s_mov_b32 s46, 0x200002
    buffer_load_dwordx4 v17, s[64:67], s60 offen offset:1024  lds
    s_mov_b32 s47, 0x20000200
    v_mov_b32 v54, 0x3f803f80
    v_mov_b32 v58, 0x3ebcbe62
    s_mov_b32 s48, 0x400004
    s_mov_b32 s49, 0x40000400
    v_mov_b32 v55, 0x3f803f80
    v_mov_b32 v59, 0x3ebcbe62
    buffer_load_dwordx4 v18, s[64:67], s60 offen offset:2048  lds
    s_mov_b32 s50, 0x800008
    s_mov_b32 s51, 0x80000800
    v_mov_b32 v60, 0x43400000
    v_lshrrev_b32 v1, 5, v0
    v_lshlrev_b32 v1, 8, v1
    v_and_b32 v2, 15, v0
    v_lshl_add_u32 v1, v2, 4, v1
    buffer_load_dwordx4 v19, s[64:67], s60 offen offset:3072  lds
    v_bfe_u32 v2, v0, 4, 1
    v_lshl_add_u32 v1, v2, 3, v1
    s_mul_i32 s56, s3, 1536
    s_add_u32 s56, s56, 153600
    v_add_u32 v134, s56, v1
    v_bfe_u32 v1, v0, 4, 1
    v_lshrrev_b32 v5, 5, v0
    s_add_u32 m0, s60, 77824
    s_nop 0
    buffer_load_dwordx4 v20, s[64:67], s60 offen offset:0  lds
    v_lshl_or_b32 v1, v1, 1, v5
    v_bfe_u32 v2, v0, 2, 2
    v_lshl_add_u32 v3, v1, 3, v2
    v_mul_u32_u24 v3, 384, v3
    v_and_b32 v4, 1, v0
    v_lshl_add_u32 v3, v4, 3, v3
    v_add_u32 v3, 73728, v3
    buffer_load_dwordx4 v21, s[64:67], s60 offen offset:1024  lds
    v_and_or_b32 v2, v2, 2, v5
    v_bfe_u32 v4, v0, 1, 1
    v_xor_b32 v2, v2, v4
    s_mul_i32 s56, s3, 6
    s_add_u32 s57, s56, 0
    v_xor_b32 v4, s57, v2
    v_lshl_add_u32 v124, v4, 4, v3
    s_lshl_b32 s61, s43, 2
    s_add_u32 s61, s61, s3
    s_mul_i32 s60, s61, 6144
    s_add_u32 m0, s41, 6144
    s_nop 0
    buffer_load_dwordx4 v16, s[68:71], s60 offen offset:0  lds
    v_xor_b32 v125, 64, v124
    s_add_u32 s57, s56, 2
    v_xor_b32 v4, s57, v2
    v_lshl_add_u32 v126, v4, 4, v3
    v_xor_b32 v127, 64, v126
    s_add_u32 s57, s56, 4
    v_xor_b32 v4, s57, v2
    buffer_load_dwordx4 v17, s[68:71], s60 offen offset:1024  lds
    v_lshl_add_u32 v128, v4, 4, v3
    v_xor_b32 v129, 64, v128
    v_and_b32 v2, 15, v0
    v_bfe_u32 v3, v0, 3, 1
    v_and_or_b32 v4, v0, 6, v3
    v_xor_b32 v4, v4, v1
    v_mul_u32_u24 v2, 384, v2
    buffer_load_dwordx4 v18, s[68:71], s60 offen offset:2048  lds
    v_lshl_add_u32 v2, v4, 4, v2
    v_add_u32 v132, 147456, v2
    v_xor_b32 v133, 64, v132
    s_and_b32 s56, s3, 1
    s_lshl_b32 s56, s56, 2
    s_lshr_b32 s57, s3, 1
    s_mul_i32 s57, s57, 24576
    buffer_load_dwordx4 v19, s[68:71], s60 offen offset:3072  lds
    s_add_u32 s57, s57, 30720
    v_and_b32 v1, 11, v0
    v_or_b32 v1, s56, v1
    v_and_or_b32 v2, v1, 6, v3
    v_lshrrev_b32 v3, 4, v0
    v_xor_b32 v2, v2, v3
    v_mul_u32_u24 v1, 384, v1
    s_add_u32 m0, s41, 10240
    s_nop 0
    buffer_load_dwordx4 v20, s[68:71], s60 offen offset:0  lds
    v_lshl_add_u32 v1, v2, 4, v1
    v_bfe_u32 v2, v0, 2, 1
    v_mul_u32_u24 v2, 12288, v2
    v_add3_u32 v130, s57, v1, v2
    v_xor_b32 v131, 64, v130
    v_add_u32 v135, 153600, v65
    buffer_load_dwordx4 v21, s[68:71], s60 offen offset:1024  lds
    s_waitcnt vmcnt(24)
    s_barrier
    s_load_dword s38, s[22:23], 0
    ds_read_b128 v[136:139], v132 offset:0
    ds_read_b128 v[140:143], v133 offset:0
    ds_read_b128 v[144:147], v132 offset:128
    ds_read_b128 v[148:151], v133 offset:128
    ds_read_b128 v[152:155], v132 offset:256
    ds_read_b128 v[156:159], v133 offset:256
    s_add_u32 m0, s40, 0
    s_add_u32 s57, s36, 0
    buffer_load_dwordx4 v16, s[28:31], s57 offen offset:0 nt lds
    buffer_load_dwordx4 v17, s[28:31], s57 offen offset:1024 nt lds
    buffer_load_dwordx4 v18, s[28:31], s57 offen offset:2048 nt lds
    buffer_load_dwordx4 v19, s[28:31], s57 offen offset:3072 nt lds
    s_add_u32 m0, s40, 4096
    s_nop 0
    buffer_load_dwordx4 v20, s[28:31], s57 offen offset:0 nt lds
    buffer_load_dwordx4 v21, s[28:31], s57 offen offset:1024 nt lds
    s_waitcnt lgkmcnt(0)
    v_mfma_f32_16x16x32_bf16 v[112:115], v[136:139], v[136:139], 0
    v_mfma_f32_16x16x32_bf16 v[116:119], v[52:55], v[136:139], 0
    s_add_u32 m0, s41, 0
    s_add_u32 s58, s37, 0
    buffer_load_dwordx4 v22, s[24:27], s58 offen offset:0 nt lds
    v_mfma_f32_16x16x32_bf16 v[112:115], v[140:143], v[140:143], v[112:115]
    v_mfma_f32_16x16x32_bf16 v[116:119], v[52:55], v[140:143], v[116:119]
    buffer_load_dwordx4 v23, s[24:27], s58 offen offset:1024 nt lds
    v_mfma_f32_16x16x32_bf16 v[112:115], v[144:147], v[144:147], v[112:115]
    v_mfma_f32_16x16x32_bf16 v[116:119], v[52:55], v[144:147], v[116:119]
    buffer_load_dwordx4 v24, s[24:27], s58 offen offset:2048 nt lds
    v_mfma_f32_16x16x32_bf16 v[112:115], v[148:151], v[148:151], v[112:115]
    v_mfma_f32_16x16x32_bf16 v[116:119], v[52:55], v[148:151], v[116:119]
    v_mfma_f32_16x16x32_bf16 v[112:115], v[152:155], v[152:155], v[112:115]
    v_mfma_f32_16x16x32_bf16 v[116:119], v[52:55], v[152:155], v[116:119]
    v_mfma_f32_16x16x32_bf16 v[112:115], v[156:159], v[156:159], v[112:115]
    v_mfma_f32_16x16x32_bf16 v[116:119], v[52:55], v[156:159], v[116:119]
    s_mul_i32 s39, s38, 0x9e3779b1
    s_add_u32 s39, s39, 0x7f4a7c16
    s_or_b32 s39, s39, 1
    s_lshl_b32 s61, s61, 10
    s_add_u32 s61, s61, 16384
    s_waitcnt vmcnt(15)
    s_barrier
    ds_read_b64_tr_b16 v[160:161], v124 offset:0
    ds_read_b64_tr_b16 v[162:163], v125 offset:1536
    ds_read_b64_tr_b16 v[184:185], v126 offset:0
    ds_read_b64_tr_b16 v[186:187], v127 offset:1536
    ds_read_b64_tr_b16 v[208:209], v128 offset:0
    ds_read_b64_tr_b16 v[210:211], v129 offset:1536
    ds_read_b64_tr_b16 v[164:165], v124 offset:12288
    ds_read_b64_tr_b16 v[166:167], v125 offset:13824
    ds_read_b64_tr_b16 v[188:189], v126 offset:12288
    ds_read_b64_tr_b16 v[190:191], v127 offset:13824
    ds_read_b64_tr_b16 v[212:213], v128 offset:12288
    ds_read_b64_tr_b16 v[214:215], v129 offset:13824
    v_cndmask_b32 v3, 0, v112, s[44:45]
    v_cndmask_b32 v3, v3, v113, s[46:47]
    v_cndmask_b32 v3, v3, v114, s[48:49]
    v_cndmask_b32 v3, v3, v115, s[50:51]
    v_mul_f32 v6, 0x3baaaaab, v116
    ds_read_b64_tr_b16 v[168:169], v124 offset:24576
    ds_read_b64_tr_b16 v[170:171], v125 offset:26112
    v_mfma_f32_16x16x4_f32 v[120:123], v60, v3, v[56:59]
    s_waitcnt lgkmcnt(12)
    v_mfma_f32_16x16x32_bf16 v[88:91], v[160:163], v[136:139], 0
    ds_read_b64_tr_b16 v[192:193], v126 offset:24576
    v_mfma_f32_16x16x32_bf16 v[100:103], v[160:163], v[52:55], 0
    ds_read_b64_tr_b16 v[194:195], v127 offset:26112
    s_waitcnt lgkmcnt(12)
    v_mfma_f32_16x16x32_bf16 v[92:95], v[184:187], v[136:139], 0
    ds_read_b64_tr_b16 v[216:217], v128 offset:24576
    v_mfma_f32_16x16x32_bf16 v[104:107], v[184:187], v[52:55], 0
    ds_read_b64_tr_b16 v[218:219], v129 offset:26112
    s_waitcnt lgkmcnt(12)
    v_mfma_f32_16x16x32_bf16 v[96:99], v[208:211], v[136:139], 0
    ds_read_b64_tr_b16 v[172:173], v124 offset:36864
    v_mfma_f32_16x16x32_bf16 v[108:111], v[208:211], v[52:55], 0
    ds_read_b64_tr_b16 v[174:175], v125 offset:38400
    s_waitcnt lgkmcnt(12)
    v_mfma_f32_16x16x32_bf16 v[88:91], v[164:167], v[140:143], v[88:91]
    ds_read_b64_tr_b16 v[196:197], v126 offset:36864
    v_mfma_f32_16x16x32_bf16 v[100:103], v[164:167], v[52:55], v[100:103]
    ds_read_b64_tr_b16 v[198:199], v127 offset:38400
    s_waitcnt lgkmcnt(12)
    v_mfma_f32_16x16x32_bf16 v[92:95], v[188:191], v[140:143], v[92:95]
    ds_read_b64_tr_b16 v[220:221], v128 offset:36864
    v_mfma_f32_16x16x32_bf16 v[104:107], v[188:191], v[52:55], v[104:107]
    ds_read_b64_tr_b16 v[222:223], v129 offset:38400
    s_waitcnt lgkmcnt(12)
    v_mfma_f32_16x16x32_bf16 v[96:99], v[212:215], v[140:143], v[96:99]
    ds_read_b64_tr_b16 v[176:177], v124 offset:49152
    v_mfma_f32_16x16x32_bf16 v[108:111], v[212:215], v[52:55], v[108:111]
    ds_read_b64_tr_b16 v[178:179], v125 offset:50688
    s_waitcnt lgkmcnt(12)
    v_mfma_f32_16x16x32_bf16 v[88:91], v[168:171], v[144:147], v[88:91]
    ds_read_b64_tr_b16 v[200:201], v126 offset:49152
    v_mfma_f32_16x16x32_bf16 v[100:103], v[168:171], v[52:55], v[100:103]
    ds_read_b64_tr_b16 v[202:203], v127 offset:50688
    s_waitcnt lgkmcnt(12)
    v_mfma_f32_16x16x32_bf16 v[92:95], v[192:195], v[144:147], v[92:95]
    ds_read_b64_tr_b16 v[224:225], v128 offset:49152
    v_mfma_f32_16x16x32_bf16 v[104:107], v[192:195], v[52:55], v[104:107]
    ds_read_b64_tr_b16 v[226:227], v129 offset:50688
    s_waitcnt lgkmcnt(12)
    v_mfma_f32_16x16x32_bf16 v[96:99], v[216:219], v[144:147], v[96:99]
    ds_read_b64_tr_b16 v[180:181], v124 offset:61440
    v_mfma_f32_16x16x32_bf16 v[108:111], v[216:219], v[52:55], v[108:111]
    ds_read_b64_tr_b16 v[182:183], v125 offset:62976
    s_waitcnt lgkmcnt(12)
    v_mfma_f32_16x16x32_bf16 v[88:91], v[172:175], v[148:151], v[88:91]
    ds_read_b64_tr_b16 v[204:205], v126 offset:61440
    v_mfma_f32_16x16x32_bf16 v[100:103], v[172:175], v[52:55], v[100:103]
    ds_read_b64_tr_b16 v[206:207], v127 offset:62976
    s_waitcnt lgkmcnt(12)
    v_mfma_f32_16x16x32_bf16 v[92:95], v[196:199], v[148:151], v[92:95]
    ds_read_b64_tr_b16 v[228:229], v128 offset:61440
    v_mfma_f32_16x16x32_bf16 v[104:107], v[196:199], v[52:55], v[104:107]
    ds_read_b64_tr_b16 v[230:231], v129 offset:62976
    s_waitcnt lgkmcnt(12)
    v_mfma_f32_16x16x32_bf16 v[96:99], v[220:223], v[148:151], v[96:99]
    v_fma_f32 v5, -v116, v116, v120
    v_mfma_f32_16x16x32_bf16 v[108:111], v[220:223], v[52:55], v[108:111]
    v_max_f32 v5, v5, v56
    s_waitcnt lgkmcnt(10)
    v_mfma_f32_16x16x32_bf16 v[88:91], v[176:179], v[152:155], v[88:91]
    v_rsq_f32 v5, v5
    v_mfma_f32_16x16x32_bf16 v[100:103], v[176:179], v[52:55], v[100:103]
    v_mov_b32 v122, s39
    s_waitcnt lgkmcnt(8)
    v_mfma_f32_16x16x32_bf16 v[92:95], v[200:203], v[152:155], v[92:95]
    v_mul_f32 v5, v60, v5
    v_mfma_f32_16x16x32_bf16 v[104:107], v[200:203], v[52:55], v[104:107]
    v_mov_b32 v123, s39
    s_waitcnt lgkmcnt(6)
    v_mfma_f32_16x16x32_bf16 v[96:99], v[224:227], v[152:155], v[96:99]
    v_mfma_f32_16x16x32_bf16 v[108:111], v[224:227], v[52:55], v[108:111]
    s_waitcnt lgkmcnt(4)
    v_mfma_f32_16x16x32_bf16 v[88:91], v[180:183], v[156:159], v[88:91]
    v_mfma_f32_16x16x32_bf16 v[100:103], v[180:183], v[52:55], v[100:103]
    s_waitcnt lgkmcnt(2)
    v_mfma_f32_16x16x32_bf16 v[92:95], v[204:207], v[156:159], v[92:95]
    v_mfma_f32_16x16x32_bf16 v[104:107], v[204:207], v[52:55], v[104:107]
    s_waitcnt lgkmcnt(0)
    v_mfma_f32_16x16x32_bf16 v[96:99], v[228:231], v[156:159], v[96:99]
    v_mfma_f32_16x16x32_bf16 v[108:111], v[228:231], v[52:55], v[108:111]
    s_nop 1
    v_fma_f32 v88, -v6, v100, v88
    v_fma_f32 v89, -v6, v101, v89
    v_fma_f32 v90, -v6, v102, v90
    v_fma_f32 v91, -v6, v103, v91
    v_mul_f32 v88, v88, v5
    v_mul_f32 v89, v89, v5
    v_mul_f32 v90, v90, v5
    v_mul_f32 v91, v91, v5
    v_cvt_pk_bf16_f32 v112, v88, v89
    v_cvt_pk_bf16_f32 v113, v90, v91
    ds_write_b64 v134, v[112:113] offset:0
    v_fma_f32 v92, -v6, v104, v92
    v_fma_f32 v93, -v6, v105, v93
    v_fma_f32 v94, -v6, v106, v94
    v_fma_f32 v95, -v6, v107, v95
    v_mul_f32 v92, v92, v5
    v_mul_f32 v93, v93, v5
    v_mul_f32 v94, v94, v5
    v_mul_f32 v95, v95, v5
    v_cvt_pk_bf16_f32 v114, v92, v93
    v_cvt_pk_bf16_f32 v115, v94, v95
    ds_write_b64 v134, v[114:115] offset:512
    v_fma_f32 v96, -v6, v108, v96
    v_fma_f32 v97, -v6, v109, v97
    v_fma_f32 v98, -v6, v110, v98
    v_fma_f32 v99, -v6, v111, v99
    v_mul_f32 v96, v96, v5
    v_mul_f32 v97, v97, v5
    v_mul_f32 v98, v98, v5
    v_mul_f32 v99, v99, v5
    v_cvt_pk_bf16_f32 v116, v96, v97
    v_cvt_pk_bf16_f32 v117, v98, v99
    ds_write_b64 v134, v[116:117] offset:1024
    s_waitcnt vmcnt(9)
    s_waitcnt lgkmcnt(0)
    s_barrier
    ds_read_b128 v[136:139], v135 offset:0
    ds_read_b128 a[96:99], v130 offset:0
    ds_read_b128 v[140:143], v135 offset:1024
    ds_read_b128 a[100:103], v131 offset:0
    ds_read_b128 v[144:147], v135 offset:2048
    ds_read_b128 a[104:107], v130 offset:128
    ds_read_b128 v[148:151], v135 offset:3072
    ds_read_b128 a[108:111], v131 offset:128
    ds_read_b128 v[152:155], v135 offset:4096
    ds_read_b128 a[112:115], v130 offset:256
    ds_read_b128 v[156:159], v135 offset:5120
    ds_read_b128 a[116:119], v131 offset:256
    s_waitcnt lgkmcnt(10)
    v_mfma_f32_16x16x32_bf16 v[88:91], a[96:99], v[136:139], 0
    s_waitcnt lgkmcnt(8)
    v_mfma_f32_16x16x32_bf16 v[92:95], a[100:103], v[140:143], 0
    s_waitcnt lgkmcnt(6)
    v_mfma_f32_16x16x32_bf16 v[88:91], a[104:107], v[144:147], v[88:91]
    s_waitcnt lgkmcnt(4)
    v_mfma_f32_16x16x32_bf16 v[92:95], a[108:111], v[148:151], v[92:95]
    s_waitcnt lgkmcnt(2)
    v_mfma_f32_16x16x32_bf16 v[88:91], a[112:115], v[152:155], v[88:91]
    s_waitcnt lgkmcnt(0)
    v_mfma_f32_16x16x32_bf16 v[92:95], a[116:119], v[156:159], v[92:95]
    s_nop 7
    v_add_f32 v88, v88, v92
    v_add_f32 v89, v89, v93
    v_add_f32 v90, v90, v94
    v_add_f32 v91, v91, v95
    v_mul_f32 v88, 0x419fecaf, v88
    v_mul_f32 v89, 0x419fecaf, v89
    v_mul_f32 v90, 0x419fecaf, v90
    v_mul_f32 v91, 0x419fecaf, v91
    v_cvt_pk_bf16_f32 v120, v88, v89
    v_cvt_pk_bf16_f32 v121, v90, v91
    buffer_store_dwordx4 v[120:123], v65, s[32:35], s61 offen sc1
    buffer_load_dwordx4 v25, s[24:27], s58 offen offset:3072 nt lds
    s_add_u32 m0, s41, 4096
    s_nop 0
    buffer_load_dwordx4 v26, s[24:27], s58 offen offset:0 nt lds
    buffer_load_dwordx4 v27, s[24:27], s58 offen offset:1024 nt lds
    s_barrier
    buffer_load_dwordx4 v28, s[24:27], s58 offen offset:2048 nt lds
    buffer_load_dwordx4 v29, s[24:27], s58 offen offset:3072 nt lds
    s_add_u32 m0, s41, 8192
    s_nop 0
    buffer_load_dwordx4 v30, s[24:27], s58 offen offset:0 nt lds
    buffer_load_dwordx4 v31, s[24:27], s58 offen offset:1024 nt lds
    buffer_load_dwordx4 v32, s[24:27], s58 offen offset:2048 nt lds
    buffer_load_dwordx4 v33, s[24:27], s58 offen offset:3072 nt lds
    v_and_b32 v1, 15, v0
    v_lshrrev_b32 v6, 5, v0
    v_bfe_u32 v3, v0, 4, 1
    v_lshl_or_b32 v3, v3, 1, v6
    v_lshrrev_b32 v4, 2, v0
    v_bfe_u32 v5, v0, 1, 1
    v_lshrrev_b32 v6, 3, v1
    v_and_or_b32 v6, v1, 6, v6
    v_xor_b32 v6, v6, v3
    v_mul_u32_u24 v7, 384, v1
    v_lshl_add_u32 v6, v6, 4, v7
    v_add_u32 v34, s40, v6
    v_xor_b32 v35, 64, v34
    v_lshrrev_b32 v6, 3, v1
    v_and_b32 v7, 7, v1
    v_lshl_or_b32 v6, v7, 1, v6
    v_xor_b32 v6, v6, v3
    v_mul_u32_u24 v7, 768, v1
    v_lshl_add_u32 v6, v6, 4, v7
    v_add_u32 v40, s41, v6
    v_xor_b32 v41, 0x40, v40
    v_xor_b32 v42, 0x80, v40
    v_xor_b32 v43, 0xc0, v40
    v_and_b32 v2, 1, v0
    v_lshlrev_b32 v2, 3, v2
    s_mul_i32 s56, s3, 96
    v_lshrrev_b32 v6, 3, v4
    v_and_or_b32 v6, v4, 6, v6
    v_xor_b32 v6, v6, v5
    v_lshl_add_u32 v6, v6, 4, v2
    v_mul_u32_u24 v7, 384, v4
    s_add_u32 s57, s56, 0
    v_xad_u32 v36, v6, s57, v7
    s_add_u32 s57, s56, 32
    v_xad_u32 v37, v6, s57, v7
    s_add_u32 s57, s56, 64
    v_xad_u32 v38, v6, s57, v7
    v_lshrrev_b32 v6, 3, v4
    v_and_b32 v3, 7, v4
    v_lshl_or_b32 v6, v3, 1, v6
    v_xor_b32 v6, v6, v5
    v_lshl_add_u32 v6, v6, 4, v2
    v_lshlrev_b32 v7, 1, v7
    v_add_u32 v7, 24576, v7
    s_add_u32 s57, s56, 0
    v_xad_u32 v44, v6, s57, v7
    s_add_u32 s57, s56, 384
    v_xad_u32 v45, v6, s57, v7
    s_add_u32 s57, s56, 32
    v_xad_u32 v46, v6, s57, v7
    s_add_u32 s57, s56, 416
    v_xad_u32 v47, v6, s57, v7
    s_add_u32 s57, s56, 64
    v_xad_u32 v48, v6, s57, v7
    s_add_u32 s57, s56, 448
    v_xad_u32 v49, v6, s57, v7
    v_lshrrev_b32 v1, 5, v0
    v_lshlrev_b32 v1, 8, v1
    v_and_b32 v2, 15, v0
    v_lshl_add_u32 v1, v2, 4, v1
    v_bfe_u32 v2, v0, 4, 1
    v_lshl_add_u32 v1, v2, 3, v1
    s_mul_i32 s56, s3, 1536
    s_add_u32 s56, s56, 147456
    v_add_u32 v236, s56, v1
    s_mul_i32 s56, s3, 3072
    s_add_u32 s56, s56, 24576
    v_add_u32 v237, s56, v65
    v_add_u32 v238, s41, v65
    s_lshl_b32 s56, s3, 10
    v_add_u32 v240, 159744, v65
    v_add_u32 v239, s56, v240
    v_add_u32 v241, 147456, v65
    v_bfe_u32 v1, v0, 2, 2
    v_lshrrev_b32 v2, 4, v0
    v_lshl_or_b32 v1, v1, 4, v2
    v_mul_u32_u24 v1, 37120, v1
    v_and_b32 v2, 3, v0
    v_lshl_or_b32 v242, v2, 4, v1
    v_xor_b32 v243, 0x70, v242
    s_mul_i32 s56, s3, 3
    v_min_u32 v1, 2, v0
    v_add_u32 v1, s56, v1
    v_lshlrev_b32 v245, 7, v1
    v_lshlrev_b32 v1, 3, v0
    v_add_u32 v254, 126976, v1
    s_lshl_b32 s56, s3, 9
    v_add_u32 v238, s56, v254
    v_add_u32 v253, 122880, v65
    s_lshl_b32 s56, s3, 10
    v_add_u32 v237, s56, v253
    s_mov_b32 s52, 0x41c00000
    s_add_u32 m0, s42, 0
    s_add_u32 s59, s37, 196608
    buffer_load_dwordx4 v22, s[24:27], s59 offen offset:0 nt lds
    buffer_load_dwordx4 v23, s[24:27], s59 offen offset:1024 nt lds
    buffer_load_dwordx4 v24, s[24:27], s59 offen offset:2048 nt lds
    buffer_load_dwordx4 v25, s[24:27], s59 offen offset:3072 nt lds
    s_add_u32 m0, s42, 4096
    s_nop 0
    buffer_load_dwordx4 v26, s[24:27], s59 offen offset:0 nt lds
    buffer_load_dwordx4 v27, s[24:27], s59 offen offset:1024 nt lds
    buffer_load_dwordx4 v28, s[24:27], s59 offen offset:2048 nt lds
    buffer_load_dwordx4 v29, s[24:27], s59 offen offset:3072 nt lds
    s_add_u32 m0, s42, 8192
    s_nop 0
    buffer_load_dwordx4 v30, s[24:27], s59 offen offset:0 nt lds
    buffer_load_dwordx4 v31, s[24:27], s59 offen offset:1024 nt lds
    buffer_load_dwordx4 v32, s[24:27], s59 offen offset:2048 nt lds
    buffer_load_dwordx4 v33, s[24:27], s59 offen offset:3072 nt lds
    s_mov_b32 s43, -1
    s_branch L_join
L_vprod:
    s_mul_i32 s60, s3, 18432
    s_add_u32 m0, s60, 73728
    s_nop 0
    buffer_load_dwordx4 v16, s[64:67], s60 offen offset:0  lds
    buffer_load_dwordx4 v17, s[64:67], s60 offen offset:1024  lds
    buffer_load_dwordx4 v18, s[64:67], s60 offen offset:2048  lds
    buffer_load_dwordx4 v19, s[64:67], s60 offen offset:3072  lds
    s_add_u32 m0, s60, 77824
    s_nop 0
    buffer_load_dwordx4 v20, s[64:67], s60 offen offset:0  lds
    buffer_load_dwordx4 v21, s[64:67], s60 offen offset:1024  lds
    s_add_u32 s60, s60, 6144
    s_add_u32 m0, s60, 73728
    s_nop 0
    buffer_load_dwordx4 v16, s[64:67], s60 offen offset:0  lds
    buffer_load_dwordx4 v17, s[64:67], s60 offen offset:1024  lds
    buffer_load_dwordx4 v18, s[64:67], s60 offen offset:2048  lds
    buffer_load_dwordx4 v19, s[64:67], s60 offen offset:3072  lds
    s_add_u32 m0, s60, 77824
    s_nop 0
    buffer_load_dwordx4 v20, s[64:67], s60 offen offset:0  lds
    buffer_load_dwordx4 v21, s[64:67], s60 offen offset:1024  lds
    s_add_u32 s60, s60, 6144
    s_add_u32 m0, s60, 73728
    s_nop 0
    buffer_load_dwordx4 v16, s[64:67], s60 offen offset:0  lds
    v_lshrrev_b32 v1, 4, v0
    v_and_b32 v5, 1, v1
    v_bfe_u32 v2, v0, 2, 2
    v_lshl_add_u32 v3, v1, 3, v2
    buffer_load_dwordx4 v17, s[64:67], s60 offen offset:1024  lds
    v_mul_u32_u24 v3, 384, v3
    v_and_b32 v4, 1, v0
    v_lshl_add_u32 v3, v4, 3, v3
    v_add_u32 v3, 73728, v3
    buffer_load_dwordx4 v18, s[64:67], s60 offen offset:2048  lds
    v_and_or_b32 v2, v2, 2, v5
    v_bfe_u32 v4, v0, 1, 1
    v_xor_b32 v2, v2, v4
    s_mul_i32 s56, s3, 6
    buffer_load_dwordx4 v19, s[64:67], s60 offen offset:3072  lds
    s_add_u32 s57, s56, 0
    v_xor_b32 v4, s57, v2
    v_lshl_add_u32 v136, v4, 4, v3
    v_xor_b32 v137, 64, v136
    s_add_u32 m0, s60, 77824
    s_nop 0
    buffer_load_dwordx4 v20, s[64:67], s60 offen offset:0  lds
    s_add_u32 s57, s56, 2
    v_xor_b32 v4, s57, v2
    v_lshl_add_u32 v138, v4, 4, v3
    v_xor_b32 v139, 64, v138
    buffer_load_dwordx4 v21, s[64:67], s60 offen offset:1024  lds
    s_add_u32 s57, s56, 4
    v_xor_b32 v4, s57, v2
    v_lshl_add_u32 v140, v4, 4, v3
    v_xor_b32 v141, 64, v140
    s_lshl_b32 s61, s43, 2
    s_add_u32 s61, s61, s3
    s_mul_i32 s60, s61, 6144
    s_add_u32 m0, s41, 6144
    s_nop 0
    buffer_load_dwordx4 v16, s[68:71], s60 offen offset:0  lds
    v_bfe_u32 v1, v0, 2, 1
    v_and_b32 v2, 3, v0
    v_lshl_or_b32 v2, v1, 3, v2
    v_and_or_b32 v1, v0, 2, v1
    buffer_load_dwordx4 v17, s[68:71], s60 offen offset:1024  lds
    v_lshrrev_b32 v3, 4, v0
    v_xor_b32 v1, v1, v3
    v_mul_u32_u24 v2, 384, v2
    v_lshl_add_u32 v1, v1, 4, v2
    buffer_load_dwordx4 v18, s[68:71], s60 offen offset:2048  lds
    v_bfe_u32 v2, v0, 3, 1
    v_mul_u32_u24 v2, 12288, v2
    s_mov_b32 s56, 30720
    v_add3_u32 v142, s56, v1, v2
    buffer_load_dwordx4 v19, s[68:71], s60 offen offset:3072  lds
    v_xor_b32 v143, 64, v142
    s_add_u32 m0, s41, 10240
    s_nop 0
    buffer_load_dwordx4 v20, s[68:71], s60 offen offset:0  lds
    buffer_load_dwordx4 v21, s[68:71], s60 offen offset:1024  lds
    s_load_dword s38, s[22:23], 0
    s_barrier
    s_add_u32 m0, s40, 0
    s_add_u32 s57, s36, 0
    buffer_load_dwordx4 v16, s[28:31], s57 offen offset:0 nt lds
    buffer_load_dwordx4 v17, s[28:31], s57 offen offset:1024 nt lds
    buffer_load_dwordx4 v18, s[28:31], s57 offen offset:2048 nt lds
    buffer_load_dwordx4 v19, s[28:31], s57 offen offset:3072 nt lds
    s_add_u32 m0, s40, 4096
    s_nop 0
    buffer_load_dwordx4 v20, s[28:31], s57 offen offset:0 nt lds
    buffer_load_dwordx4 v21, s[28:31], s57 offen offset:1024 nt lds
    s_add_u32 m0, s41, 0
    s_add_u32 s58, s37, 0
    buffer_load_dwordx4 v22, s[24:27], s58 offen offset:0 nt lds
    buffer_load_dwordx4 v23, s[24:27], s58 offen offset:1024 nt lds
    buffer_load_dwordx4 v24, s[24:27], s58 offen offset:2048 nt lds
    s_waitcnt vmcnt(9)
    s_barrier
    ds_read_b128 a[96:99], v142 offset:0
    ds_read_b128 a[100:103], v143 offset:0
    ds_read_b128 a[104:107], v142 offset:128
    ds_read_b128 a[108:111], v143 offset:128
    ds_read_b128 a[112:115], v142 offset:256
    ds_read_b128 a[116:119], v143 offset:256
    ds_read_b128 a[120:123], v143 offset:1536
    ds_read_b128 a[124:127], v142 offset:1536
    ds_read_b128 a[128:131], v143 offset:1664
    ds_read_b128 a[132:135], v142 offset:1664
    ds_read_b128 a[136:139], v143 offset:1792
    ds_read_b128 a[140:143], v142 offset:1792
    ds_read_b128 a[144:147], v142 offset:24576
    ds_read_b128 a[148:151], v143 offset:24576
    ds_read_b128 a[152:155], v142 offset:24704
    ds_read_b128 a[156:159], v143 offset:24704
    ds_read_b128 a[160:163], v142 offset:24832
    ds_read_b128 a[164:167], v143 offset:24832
    ds_read_b128 a[168:171], v143 offset:26112
    ds_read_b128 a[172:175], v142 offset:26112
    ds_read_b128 a[176:179], v143 offset:26240
    ds_read_b128 a[180:183], v142 offset:26240
    ds_read_b128 a[184:187], v143 offset:26368
    ds_read_b128 a[188:191], v142 offset:26368
    ds_read_b64_tr_b16 v[160:161], v136 offset:0
    ds_read_b64_tr_b16 v[162:163], v137 offset:1536
    ds_read_b64_tr_b16 v[164:165], v136 offset:12288
    ds_read_b64_tr_b16 v[166:167], v137 offset:13824
    ds_read_b64_tr_b16 v[168:169], v136 offset:24576
    ds_read_b64_tr_b16 v[170:171], v137 offset:26112
    ds_read_b64_tr_b16 v[172:173], v136 offset:36864
    ds_read_b64_tr_b16 v[174:175], v137 offset:38400
    ds_read_b64_tr_b16 v[176:177], v136 offset:49152
    ds_read_b64_tr_b16 v[178:179], v137 offset:50688
    ds_read_b64_tr_b16 v[180:181], v136 offset:61440
    ds_read_b64_tr_b16 v[182:183], v137 offset:62976
    ds_read_b64_tr_b16 v[184:185], v138 offset:0
    ds_read_b64_tr_b16 v[186:187], v139 offset:1536
    ds_read_b64_tr_b16 v[188:189], v138 offset:12288
    ds_read_b64_tr_b16 v[190:191], v139 offset:13824
    ds_read_b64_tr_b16 v[192:193], v138 offset:24576
    ds_read_b64_tr_b16 v[194:195], v139 offset:26112
    ds_read_b64_tr_b16 v[196:197], v138 offset:36864
    ds_read_b64_tr_b16 v[198:199], v139 offset:38400
    ds_read_b64_tr_b16 v[200:201], v138 offset:49152
    ds_read_b64_tr_b16 v[202:203], v139 offset:50688
    ds_read_b64_tr_b16 v[204:205], v138 offset:61440
    ds_read_b64_tr_b16 v[206:207], v139 offset:62976
    ds_read_b64_tr_b16 v[208:209], v140 offset:0
    ds_read_b64_tr_b16 v[210:211], v141 offset:1536
    ds_read_b64_tr_b16 v[212:213], v140 offset:12288
    ds_read_b64_tr_b16 v[214:215], v141 offset:13824
    ds_read_b64_tr_b16 v[216:217], v140 offset:24576
    ds_read_b64_tr_b16 v[218:219], v141 offset:26112
    ds_read_b64_tr_b16 v[220:221], v140 offset:36864
    ds_read_b64_tr_b16 v[222:223], v141 offset:38400
    ds_read_b64_tr_b16 v[224:225], v140 offset:49152
    ds_read_b64_tr_b16 v[226:227], v141 offset:50688
    ds_read_b64_tr_b16 v[228:229], v140 offset:61440
    ds_read_b64_tr_b16 v[230:231], v141 offset:62976
    s_waitcnt lgkmcnt(0)
    s_barrier
    s_mul_i32 s60, s3, 18432
    s_lshl_b32 s61, s43, 11
    s_add_u32 s60, s60, s61
    s_add_u32 s60, s60, 3145728
    v_mfma_f32_16x16x32_bf16 v[88:91], a[96:99], v[160:163], 0
    v_mfma_f32_16x16x32_bf16 v[92:95], a[120:123], v[160:163], 0
    v_mfma_f32_16x16x32_bf16 v[96:99], a[144:147], v[160:163], 0
    v_mfma_f32_16x16x32_bf16 v[100:103], a[168:171], v[160:163], 0
    buffer_load_dwordx4 v25, s[24:27], s58 offen offset:3072 nt lds
    v_mfma_f32_16x16x32_bf16 v[88:91], a[100:103], v[164:167], v[88:91]
    v_mfma_f32_16x16x32_bf16 v[92:95], a[124:127], v[164:167], v[92:95]
    v_mfma_f32_16x16x32_bf16 v[96:99], a[148:151], v[164:167], v[96:99]
    v_mfma_f32_16x16x32_bf16 v[100:103], a[172:175], v[164:167], v[100:103]
    s_add_u32 m0, s41, 4096
    s_nop 0
    buffer_load_dwordx4 v26, s[24:27], s58 offen offset:0 nt lds
    v_mfma_f32_16x16x32_bf16 v[88:91], a[104:107], v[168:171], v[88:91]
    v_mfma_f32_16x16x32_bf16 v[92:95], a[128:131], v[168:171], v[92:95]
    v_mfma_f32_16x16x32_bf16 v[96:99], a[152:155], v[168:171], v[96:99]
    v_mfma_f32_16x16x32_bf16 v[100:103], a[176:179], v[168:171], v[100:103]
    buffer_load_dwordx4 v27, s[24:27], s58 offen offset:1024 nt lds
    v_mfma_f32_16x16x32_bf16 v[88:91], a[108:111], v[172:175], v[88:91]
    v_mfma_f32_16x16x32_bf16 v[92:95], a[132:135], v[172:175], v[92:95]
    v_mfma_f32_16x16x32_bf16 v[96:99], a[156:159], v[172:175], v[96:99]
    v_mfma_f32_16x16x32_bf16 v[100:103], a[180:183], v[172:175], v[100:103]
    buffer_load_dwordx4 v28, s[24:27], s58 offen offset:2048 nt lds
    v_mfma_f32_16x16x32_bf16 v[88:91], a[112:115], v[176:179], v[88:91]
    v_mfma_f32_16x16x32_bf16 v[92:95], a[136:139], v[176:179], v[92:95]
    v_mfma_f32_16x16x32_bf16 v[96:99], a[160:163], v[176:179], v[96:99]
    v_mfma_f32_16x16x32_bf16 v[100:103], a[184:187], v[176:179], v[100:103]
    buffer_load_dwordx4 v29, s[24:27], s58 offen offset:3072 nt lds
    v_mfma_f32_16x16x32_bf16 v[88:91], a[116:119], v[180:183], v[88:91]
    v_mfma_f32_16x16x32_bf16 v[92:95], a[140:143], v[180:183], v[92:95]
    v_mfma_f32_16x16x32_bf16 v[96:99], a[164:167], v[180:183], v[96:99]
    v_mfma_f32_16x16x32_bf16 v[100:103], a[188:191], v[180:183], v[100:103]
    v_mfma_f32_16x16x32_bf16 v[104:107], a[96:99], v[184:187], 0
    v_mfma_f32_16x16x32_bf16 v[108:111], a[120:123], v[184:187], 0
    v_mfma_f32_16x16x32_bf16 v[112:115], a[144:147], v[184:187], 0
    v_mfma_f32_16x16x32_bf16 v[116:119], a[168:171], v[184:187], 0
    s_add_u32 m0, s41, 8192
    s_nop 0
    buffer_load_dwordx4 v30, s[24:27], s58 offen offset:0 nt lds
    v_mfma_f32_16x16x32_bf16 v[104:107], a[100:103], v[188:191], v[104:107]
    v_mfma_f32_16x16x32_bf16 v[108:111], a[124:127], v[188:191], v[108:111]
    v_mfma_f32_16x16x32_bf16 v[112:115], a[148:151], v[188:191], v[112:115]
    v_mfma_f32_16x16x32_bf16 v[116:119], a[172:175], v[188:191], v[116:119]
    buffer_load_dwordx4 v31, s[24:27], s58 offen offset:1024 nt lds
    v_mfma_f32_16x16x32_bf16 v[104:107], a[104:107], v[192:195], v[104:107]
    v_mfma_f32_16x16x32_bf16 v[108:111], a[128:131], v[192:195], v[108:111]
    v_mfma_f32_16x16x32_bf16 v[112:115], a[152:155], v[192:195], v[112:115]
    v_mfma_f32_16x16x32_bf16 v[116:119], a[176:179], v[192:195], v[116:119]
    buffer_load_dwordx4 v32, s[24:27], s58 offen offset:2048 nt lds
    v_cvt_pk_bf16_f32 v144, v88, v89
    v_cvt_pk_bf16_f32 v145, v90, v91
    v_cvt_pk_bf16_f32 v146, v92, v93
    v_cvt_pk_bf16_f32 v147, v94, v95
    buffer_store_dwordx4 v[144:147], v65, s[32:35], s60 offen offset:0 sc1
    v_cvt_pk_bf16_f32 v148, v96, v97
    v_cvt_pk_bf16_f32 v149, v98, v99
    v_cvt_pk_bf16_f32 v150, v100, v101
    v_cvt_pk_bf16_f32 v151, v102, v103
    buffer_store_dwordx4 v[148:151], v65, s[32:35], s60 offen offset:1024 sc1
    s_add_u32 s60, s60, 6144
    v_mfma_f32_16x16x32_bf16 v[104:107], a[108:111], v[196:199], v[104:107]
    v_mfma_f32_16x16x32_bf16 v[108:111], a[132:135], v[196:199], v[108:111]
    v_mfma_f32_16x16x32_bf16 v[112:115], a[156:159], v[196:199], v[112:115]
    v_mfma_f32_16x16x32_bf16 v[116:119], a[180:183], v[196:199], v[116:119]
    buffer_load_dwordx4 v33, s[24:27], s58 offen offset:3072 nt lds
    v_mfma_f32_16x16x32_bf16 v[104:107], a[112:115], v[200:203], v[104:107]
    v_mfma_f32_16x16x32_bf16 v[108:111], a[136:139], v[200:203], v[108:111]
    v_mfma_f32_16x16x32_bf16 v[112:115], a[160:163], v[200:203], v[112:115]
    v_mfma_f32_16x16x32_bf16 v[116:119], a[184:187], v[200:203], v[116:119]
    s_add_u32 m0, s42, 0
    s_add_u32 s59, s37, 196608
    buffer_load_dwordx4 v22, s[24:27], s59 offen offset:0 nt lds
    v_mfma_f32_16x16x32_bf16 v[104:107], a[116:119], v[204:207], v[104:107]
    v_mfma_f32_16x16x32_bf16 v[108:111], a[140:143], v[204:207], v[108:111]
    v_mfma_f32_16x16x32_bf16 v[112:115], a[164:167], v[204:207], v[112:115]
    v_mfma_f32_16x16x32_bf16 v[116:119], a[188:191], v[204:207], v[116:119]
    v_mfma_f32_16x16x32_bf16 v[120:123], a[96:99], v[208:211], 0
    v_mfma_f32_16x16x32_bf16 v[124:127], a[120:123], v[208:211], 0
    v_mfma_f32_16x16x32_bf16 v[128:131], a[144:147], v[208:211], 0
    v_mfma_f32_16x16x32_bf16 v[132:135], a[168:171], v[208:211], 0
    buffer_load_dwordx4 v23, s[24:27], s59 offen offset:1024 nt lds
    v_mfma_f32_16x16x32_bf16 v[120:123], a[100:103], v[212:215], v[120:123]
    v_mfma_f32_16x16x32_bf16 v[124:127], a[124:127], v[212:215], v[124:127]
    v_mfma_f32_16x16x32_bf16 v[128:131], a[148:151], v[212:215], v[128:131]
    v_mfma_f32_16x16x32_bf16 v[132:135], a[172:175], v[212:215], v[132:135]
    buffer_load_dwordx4 v24, s[24:27], s59 offen offset:2048 nt lds
    v_mfma_f32_16x16x32_bf16 v[120:123], a[104:107], v[216:219], v[120:123]
    v_mfma_f32_16x16x32_bf16 v[124:127], a[128:131], v[216:219], v[124:127]
    v_mfma_f32_16x16x32_bf16 v[128:131], a[152:155], v[216:219], v[128:131]
    v_mfma_f32_16x16x32_bf16 v[132:135], a[176:179], v[216:219], v[132:135]
    buffer_load_dwordx4 v25, s[24:27], s59 offen offset:3072 nt lds
    v_cvt_pk_bf16_f32 v152, v104, v105
    v_cvt_pk_bf16_f32 v153, v106, v107
    v_cvt_pk_bf16_f32 v154, v108, v109
    v_cvt_pk_bf16_f32 v155, v110, v111
    buffer_store_dwordx4 v[152:155], v65, s[32:35], s60 offen offset:0 sc1
    v_cvt_pk_bf16_f32 v156, v112, v113
    v_cvt_pk_bf16_f32 v157, v114, v115
    v_cvt_pk_bf16_f32 v158, v116, v117
    v_cvt_pk_bf16_f32 v159, v118, v119
    buffer_store_dwordx4 v[156:159], v65, s[32:35], s60 offen offset:1024 sc1
    s_add_u32 s60, s60, 6144
    v_mfma_f32_16x16x32_bf16 v[120:123], a[108:111], v[220:223], v[120:123]
    v_mfma_f32_16x16x32_bf16 v[124:127], a[132:135], v[220:223], v[124:127]
    v_mfma_f32_16x16x32_bf16 v[128:131], a[156:159], v[220:223], v[128:131]
    v_mfma_f32_16x16x32_bf16 v[132:135], a[180:183], v[220:223], v[132:135]
    s_add_u32 m0, s42, 4096
    s_nop 0
    buffer_load_dwordx4 v26, s[24:27], s59 offen offset:0 nt lds
    v_mfma_f32_16x16x32_bf16 v[120:123], a[112:115], v[224:227], v[120:123]
    v_mfma_f32_16x16x32_bf16 v[124:127], a[136:139], v[224:227], v[124:127]
    v_mfma_f32_16x16x32_bf16 v[128:131], a[160:163], v[224:227], v[128:131]
    v_mfma_f32_16x16x32_bf16 v[132:135], a[184:187], v[224:227], v[132:135]
    buffer_load_dwordx4 v27, s[24:27], s59 offen offset:1024 nt lds
    v_mfma_f32_16x16x32_bf16 v[120:123], a[116:119], v[228:231], v[120:123]
    v_mfma_f32_16x16x32_bf16 v[124:127], a[140:143], v[228:231], v[124:127]
    v_mfma_f32_16x16x32_bf16 v[128:131], a[164:167], v[228:231], v[128:131]
    v_mfma_f32_16x16x32_bf16 v[132:135], a[188:191], v[228:231], v[132:135]
    s_nop 4
    v_cvt_pk_bf16_f32 v144, v120, v121
    v_cvt_pk_bf16_f32 v145, v122, v123
    v_cvt_pk_bf16_f32 v146, v124, v125
    v_cvt_pk_bf16_f32 v147, v126, v127
    buffer_store_dwordx4 v[144:147], v65, s[32:35], s60 offen offset:0 sc1
    v_cvt_pk_bf16_f32 v148, v128, v129
    v_cvt_pk_bf16_f32 v149, v130, v131
    v_cvt_pk_bf16_f32 v150, v132, v133
    v_cvt_pk_bf16_f32 v151, v134, v135
    buffer_store_dwordx4 v[148:151], v65, s[32:35], s60 offen offset:1024 sc1
    v_and_b32 v1, 15, v0
    v_lshrrev_b32 v6, 5, v0
    v_bfe_u32 v3, v0, 4, 1
    v_lshl_or_b32 v3, v3, 1, v6
    v_lshrrev_b32 v4, 2, v0
    v_bfe_u32 v5, v0, 1, 1
    v_lshrrev_b32 v6, 3, v1
    v_and_or_b32 v6, v1, 6, v6
    v_xor_b32 v6, v6, v3
    v_mul_u32_u24 v7, 384, v1
    v_lshl_add_u32 v6, v6, 4, v7
    v_add_u32 v34, s40, v6
    v_xor_b32 v35, 64, v34
    v_lshrrev_b32 v6, 3, v1
    v_and_b32 v7, 7, v1
    v_lshl_or_b32 v6, v7, 1, v6
    v_xor_b32 v6, v6, v3
    v_mul_u32_u24 v7, 768, v1
    v_lshl_add_u32 v6, v6, 4, v7
    v_add_u32 v40, s41, v6
    v_xor_b32 v41, 0x40, v40
    v_xor_b32 v42, 0x80, v40
    v_xor_b32 v43, 0xc0, v40
    v_and_b32 v2, 1, v0
    v_lshlrev_b32 v2, 3, v2
    s_mul_i32 s56, s3, 96
    v_lshrrev_b32 v6, 3, v4
    v_and_or_b32 v6, v4, 6, v6
    v_xor_b32 v6, v6, v5
    v_lshl_add_u32 v6, v6, 4, v2
    v_mul_u32_u24 v7, 384, v4
    s_add_u32 s57, s56, 0
    v_xad_u32 v36, v6, s57, v7
    s_add_u32 s57, s56, 32
    v_xad_u32 v37, v6, s57, v7
    s_add_u32 s57, s56, 64
    v_xad_u32 v38, v6, s57, v7
    v_lshrrev_b32 v6, 3, v4
    v_and_b32 v3, 7, v4
    v_lshl_or_b32 v6, v3, 1, v6
    v_xor_b32 v6, v6, v5
    v_lshl_add_u32 v6, v6, 4, v2
    v_lshlrev_b32 v7, 1, v7
    v_add_u32 v7, 24576, v7
    s_add_u32 s57, s56, 0
    v_xad_u32 v44, v6, s57, v7
    s_add_u32 s57, s56, 384
    v_xad_u32 v45, v6, s57, v7
    s_add_u32 s57, s56, 32
    v_xad_u32 v46, v6, s57, v7
    s_add_u32 s57, s56, 416
    v_xad_u32 v47, v6, s57, v7
    s_add_u32 s57, s56, 64
    v_xad_u32 v48, v6, s57, v7
    s_add_u32 s57, s56, 448
    v_xad_u32 v49, v6, s57, v7
    v_mov_b32 v52, 0x3f803f80
    v_mov_b32 v56, 0x3ebcbe62
    s_mov_b32 s44, 0x100001
    s_mov_b32 s45, 0x10000100
    v_mov_b32 v53, 0x3f803f80
    v_mov_b32 v57, 0x3ebcbe62
    s_mov_b32 s46, 0x200002
    s_mov_b32 s47, 0x20000200
    v_mov_b32 v54, 0x3f803f80
    v_mov_b32 v58, 0x3ebcbe62
    s_mov_b32 s48, 0x400004
    s_mov_b32 s49, 0x40000400
    v_mov_b32 v55, 0x3f803f80
    v_mov_b32 v59, 0x3ebcbe62
    s_mov_b32 s50, 0x800008
    s_mov_b32 s51, 0x80000800
    v_mov_b32 v60, 0x43400000
    v_lshrrev_b32 v1, 5, v0
    v_lshlrev_b32 v1, 8, v1
    v_and_b32 v2, 15, v0
    v_lshl_add_u32 v1, v2, 4, v1
    v_bfe_u32 v2, v0, 4, 1
    v_lshl_add_u32 v1, v2, 3, v1
    s_mul_i32 s56, s3, 1536
    s_add_u32 s56, s56, 147456
    v_add_u32 v236, s56, v1
    s_mul_i32 s56, s3, 3072
    s_add_u32 s56, s56, 24576
    v_add_u32 v237, s56, v65
    v_add_u32 v238, s41, v65
    s_lshl_b32 s56, s3, 10
    v_add_u32 v240, 159744, v65
    v_add_u32 v239, s56, v240
    v_add_u32 v241, 147456, v65
    v_bfe_u32 v1, v0, 2, 2
    v_lshrrev_b32 v2, 4, v0
    v_lshl_or_b32 v1, v1, 4, v2
    v_mul_u32_u24 v1, 37120, v1
    v_and_b32 v2, 3, v0
    v_lshl_or_b32 v242, v2, 4, v1
    v_xor_b32 v243, 0x70, v242
    s_mul_i32 s56, s3, 3
    v_min_u32 v1, 2, v0
    v_add_u32 v1, s56, v1
    v_lshlrev_b32 v245, 7, v1
    v_lshlrev_b32 v1, 3, v0
    v_add_u32 v254, 126976, v1
    s_lshl_b32 s56, s3, 9
    v_add_u32 v238, s56, v254
    v_add_u32 v253, 122880, v65
    s_lshl_b32 s56, s3, 10
    v_add_u32 v237, s56, v253
    s_mov_b32 s52, 0x41c00000
    buffer_load_dwordx4 v28, s[24:27], s59 offen offset:2048 nt lds
    buffer_load_dwordx4 v29, s[24:27], s59 offen offset:3072 nt lds
    s_add_u32 m0, s42, 8192
    s_nop 0
    buffer_load_dwordx4 v30, s[24:27], s59 offen offset:0 nt lds
    buffer_load_dwordx4 v31, s[24:27], s59 offen offset:1024 nt lds
    buffer_load_dwordx4 v32, s[24:27], s59 offen offset:2048 nt lds
    buffer_load_dwordx4 v33, s[24:27], s59 offen offset:3072 nt lds
    s_branch L_join
L_xt3:
    s_call_b64 s[54:55], L_xslow
    s_branch L_post3
L_xt24:
    s_call_b64 s[54:55], L_xslow
    s_branch L_post24
L_xt6:
    s_call_b64 s[54:55], L_xslow
    s_branch L_post6
L_xt27:
    s_call_b64 s[54:55], L_xslow
    s_branch L_post27
L_xt9:
    s_call_b64 s[54:55], L_xslow
    s_branch L_post9
L_xt11:
    s_call_b64 s[54:55], L_xalt
    ds_read_b128 a[192:195], v253 offset:12288
    ds_read_b128 a[196:199], v253 offset:13312
    ds_read_b128 a[200:203], v253 offset:14336
    ds_read_b128 a[204:207], v253 offset:15360
    s_waitcnt lgkmcnt(0)
    s_branch L_post11
L_xslow:
    s_waitcnt lgkmcnt(0)
    ds_write_b32 v239, v62
    s_waitcnt lgkmcnt(0)
    s_barrier
    ds_read_b32 v12, v240 offset:0
    ds_read_b32 v13, v240 offset:1024
    ds_read_b32 v14, v240 offset:2048
    ds_read_b32 v15, v240 offset:3072
    v_mov_b32 v9, 0
    ds_write_b32 v254, v9 offset:4096
    s_waitcnt lgkmcnt(0)
    v_min3_f32 v1, v12, v13, v14
    v_min_f32 v1, v1, v15
    v_sub_f32 v2, v1, v255
    v_sub_f32 v12, v1, v62
    v_exp_f32 v2, v2
    v_exp_f32 v12, v12
    v_mov_b32 v62, v1
    v_mov_b32 v255, v1
    v_mul_f32 v88, v88, v12
    v_mul_f32 v89, v89, v12
    v_mul_f32 v90, v90, v12
    v_mul_f32 v91, v91, v12
    v_mul_f32 v104, v104, v12
    v_mul_f32 v105, v105, v12
    v_mul_f32 v106, v106, v12
    v_mul_f32 v107, v107, v12
    v_mul_f32 v68, v68, v12
    v_mul_f32 v69, v69, v12
    v_mul_f32 v70, v70, v12
    v_mul_f32 v71, v71, v12
    v_mul_f32 v112, v112, v12
    v_mul_f32 v113, v113, v12
    v_mul_f32 v114, v114, v12
    v_mul_f32 v115, v115, v12
    v_mul_f32 v63, v63, v12
    v_mul_f32 v64, v64, v12
    v_accvgpr_read_b32 v1, a0
    v_mul_f32 v1, v1, v2
    v_accvgpr_write_b32 a0, v1
    v_accvgpr_read_b32 v1, a1
    v_mul_f32 v1, v1, v2
    v_accvgpr_write_b32 a1, v1
    v_accvgpr_read_b32 v1, a2
    v_mul_f32 v1, v1, v2
    v_accvgpr_write_b32 a2, v1
    v_accvgpr_read_b32 v1, a3
    v_mul_f32 v1, v1, v2
    v_accvgpr_write_b32 a3, v1
    v_accvgpr_read_b32 v1, a4
    v_mul_f32 v1, v1, v2
    v_accvgpr_write_b32 a4, v1
    v_accvgpr_read_b32 v1, a5
    v_mul_f32 v1, v1, v2
    v_accvgpr_write_b32 a5, v1
    v_accvgpr_read_b32 v1, a6
    v_mul_f32 v1, v1, v2
    v_accvgpr_write_b32 a6, v1
    v_accvgpr_read_b32 v1, a7
    v_mul_f32 v1, v1, v2
    v_accvgpr_write_b32 a7, v1
    v_accvgpr_read_b32 v1, a8
    v_mul_f32 v1, v1, v2
    v_accvgpr_write_b32 a8, v1
    v_accvgpr_read_b32 v1, a9
    v_mul_f32 v1, v1, v2
    v_accvgpr_write_b32 a9, v1
    v_accvgpr_read_b32 v1, a10
    v_mul_f32 v1, v1, v2
    v_accvgpr_write_b32 a10, v1
    v_accvgpr_read_b32 v1, a11
    v_mul_f32 v1, v1, v2
    v_accvgpr_write_b32 a11, v1
    v_cvt_pk_bf16_f32 v72, v88, v89
    v_cvt_pk_bf16_f32 v73, v90, v91
    v_cvt_pk_bf16_f32 v74, v104, v105
    v_cvt_pk_bf16_f32 v75, v106, v107
    ds_write_b128 v237, v[72:75] offset:0
    v_cvt_pk_bf16_f32 v66, v68, v69
    v_cvt_pk_bf16_f32 v67, v70, v71
    ds_write_b64 v238, v[66:67]
    s_waitcnt lgkmcnt(0)
    s_barrier
    s_setpc_b64 s[54:55]
L_xlast:
    s_waitcnt lgkmcnt(0)
    ds_write_b32 v239, v62
    s_waitcnt lgkmcnt(0)
    s_barrier
    ds_read_b32 v12, v240 offset:0
    ds_read_b32 v13, v240 offset:1024
    ds_read_b32 v14, v240 offset:2048
    ds_read_b32 v15, v240 offset:3072
    v_mov_b32 v9, 0
    ds_write_b32 v254, v9 offset:4096
    s_waitcnt lgkmcnt(0)
    v_min3_f32 v1, v12, v13, v14
    v_min_f32 v1, v1, v15
    v_sub_f32 v2, v1, v255
    v_sub_f32 v12, v1, v62
    v_exp_f32 v2, v2
    v_exp_f32 v12, v12
    v_mov_b32 v62, v1
    v_mov_b32 v255, v1
    v_mul_f32 v88, v88, v12
    v_mul_f32 v89, v89, v12
    v_mul_f32 v90, v90, v12
    v_mul_f32 v91, v91, v12
    v_mul_f32 v104, v104, v12
    v_mul_f32 v105, v105, v12
    v_mul_f32 v106, v106, v12
    v_mul_f32 v107, v107, v12
    v_mul_f32 v68, v68, v12
    v_mul_f32 v69, v69, v12
    v_mul_f32 v70, v70, v12
    v_mul_f32 v71, v71, v12
    v_mul_f32 v10, v10, v12
    v_mul_f32 v11, v11, v12
    v_mul_f32 v16, v16, v2
    v_mul_f32 v17, v17, v2
    v_mul_f32 v18, v18, v2
    v_mul_f32 v19, v19, v2
    v_mul_f32 v20, v20, v2
    v_mul_f32 v21, v21, v2
    v_mul_f32 v22, v22, v2
    v_mul_f32 v23, v23, v2
    v_mul_f32 v24, v24, v2
    v_mul_f32 v25, v25, v2
    v_mul_f32 v26, v26, v2
    v_mul_f32 v27, v27, v2
    v_cvt_pk_bf16_f32 v72, v88, v89
    v_cvt_pk_bf16_f32 v73, v90, v91
    v_cvt_pk_bf16_f32 v74, v104, v105
    v_cvt_pk_bf16_f32 v75, v106, v107
    ds_write_b128 v237, v[72:75] offset:0
    v_cvt_pk_bf16_f32 v66, v68, v69
    v_cvt_pk_bf16_f32 v67, v70, v71
    ds_write_b64 v238, v[66:67]
    ds_write_b64 v238, v[10:11] offset:2048
    s_waitcnt lgkmcnt(0)
    s_barrier
    s_branch L_postx
L_xalt:
    s_waitcnt lgkmcnt(0)
    ds_write_b32 v239, v62
    s_waitcnt lgkmcnt(0)
    s_barrier
    ds_read_b32 v12, v240 offset:0
    ds_read_b32 v13, v240 offset:1024
    ds_read_b32 v14, v240 offset:2048
    ds_read_b32 v15, v240 offset:3072
    v_mov_b32 v9, 0
    ds_write_b32 v254, v9 offset:4100
    s_waitcnt lgkmcnt(0)
    v_min3_f32 v1, v12, v13, v14
    v_min_f32 v1, v1, v15
    v_sub_f32 v2, v1, v255
    v_sub_f32 v12, v1, v62
    v_exp_f32 v2, v2
    v_exp_f32 v12, v12
    v_mov_b32 v62, v1
    v_mov_b32 v255, v1
    v_mul_f32 v88, v88, v12
    v_mul_f32 v89, v89, v12
    v_mul_f32 v90, v90, v12
    v_mul_f32 v91, v91, v12
    v_mul_f32 v104, v104, v12
    v_mul_f32 v105, v105, v12
    v_mul_f32 v106, v106, v12
    v_mul_f32 v107, v107, v12
    v_mul_f32 v68, v68, v12
    v_mul_f32 v69, v69, v12
    v_mul_f32 v70, v70, v12
    v_mul_f32 v71, v71, v12
    v_mul_f32 v112, v112, v12
    v_mul_f32 v113, v113, v12
    v_mul_f32 v114, v114, v12
    v_mul_f32 v115, v115, v12
    v_mul_f32 v63, v63, v12
    v_mul_f32 v64, v64, v12
    v_mul_f32 v16, v16, v2
    v_mul_f32 v17, v17, v2
    v_mul_f32 v18, v18, v2
    v_mul_f32 v19, v19, v2
    v_mul_f32 v20, v20, v2
    v_mul_f32 v21, v21, v2
    v_mul_f32 v22, v22, v2
    v_mul_f32 v23, v23, v2
    v_mul_f32 v24, v24, v2
    v_mul_f32 v25, v25, v2
    v_mul_f32 v26, v26, v2
    v_mul_f32 v27, v27, v2
    v_cvt_pk_bf16_f32 v72, v88, v89
    v_cvt_pk_bf16_f32 v73, v90, v91
    v_cvt_pk_bf16_f32 v74, v104, v105
    v_cvt_pk_bf16_f32 v75, v106, v107
    ds_write_b128 v237, v[72:75] offset:12288
    s_waitcnt lgkmcnt(0)
    s_barrier
    s_setpc_b64 s[54:55]
L_c_slow:
    s_cmp_eq_u32 s43, 0
    s_cbranch_scc1 L_c_out
    s_mov_b32 s43, 0
    buffer_load_dwordx4 v[76:79], v65, s[32:35], s30 offen offset:0 sc1
    buffer_load_dwordx4 v[80:83], v65, s[32:35], s30 offen offset:1024 sc1
    buffer_load_dwordx4 v[84:87], v65, s[32:35], s30 offen offset:2048 sc1
    buffer_load_dwordx4 v[108:111], v65, s[32:35], s30 offen offset:3072 sc1
    buffer_load_dwordx4 v[112:115], v65, s[32:35], s31 offen offset:0 sc1
    buffer_load_dwordx4 v[128:131], v65, s[32:35], s31 offen offset:1024 sc1
    buffer_load_dwordx4 v[132:135], v65, s[32:35], s31 offen offset:2048 sc1
    buffer_load_dwordx4 v[52:55], v65, s[32:35], s31 offen offset:3072 sc1
    s_waitcnt vmcnt(0)
    v_sub_u32 v49, v79, v247
    v_max_f32 v42, v42, v49
    v_sub_u32 v49, v83, v247
    v_max_f32 v42, v42, v49
    v_sub_u32 v49, v87, v247
    v_max_f32 v42, v42, v49
    v_sub_u32 v49, v111, v247
    v_max_f32 v42, v42, v49
    v_sub_u32 v49, v115, v247
    v_max_f32 v42, v42, v49
    v_sub_u32 v49, v131, v247
    v_max_f32 v42, v42, v49
    v_sub_u32 v49, v135, v247
    v_max_f32 v42, v42, v49
    v_sub_u32 v49, v55, v247
    v_max_f32 v42, v42, v49
    s_nop 1
    v_max_f32_dpp v42, v42, v42 row_ror:8 row_mask:0xf bank_mask:0xf
    v_mov_b32 v48, v42
    s_nop 1
    v_permlane32_swap_b32 v42, v48
    v_max_f32 v42, v42, v48
    v_mov_b32 v48, v42
    s_nop 1
    v_permlane16_swap_b32 v42, v48
    v_max_f32 v42, v42, v48
    s_lshl_b32 s56, s3, 2
    v_add_u32 v48, s56, v251
    ds_write_b32 v48, v42 offset:1024
    s_waitcnt lgkmcnt(0)
    s_barrier
    ds_read_b128 v[48:51], v251 offset:1024
    v_mov_b32 v16, 0
    v_mov_b32 v17, 0
    v_mov_b32 v18, 0
    v_mov_b32 v19, 0
    v_mov_b32 v20, 0
    v_mov_b32 v21, 0
    v_mov_b32 v22, 0
    s_waitcnt lgkmcnt(0)
    v_max3_f32 v42, v48, v49, v50
    v_max_f32 v42, v42, v51
    v_sub_u32 v49, v79, v247
    v_sub_f32 v49, v49, v42
    v_exp_f32 v49, v49
    s_nop 0
    v_cvt_pk_bf16_f32 v49, v49, 0
    v_lshlrev_b32 v50, 16, v49
    v_dot2_f32_bf16 v16, v76, v49, v16
    v_dot2_f32_bf16 v18, v77, v49, v18
    v_dot2_f32_bf16 v20, v78, v49, v20
    v_add_f32 v22, v22, v50
    v_dot2_f32_bf16 v17, v76, v50, v17
    v_dot2_f32_bf16 v19, v77, v50, v19
    v_dot2_f32_bf16 v21, v78, v50, v21
    v_sub_u32 v49, v83, v247
    v_sub_f32 v49, v49, v42
    v_exp_f32 v49, v49
    s_nop 0
    v_cvt_pk_bf16_f32 v49, v49, 0
    v_lshlrev_b32 v50, 16, v49
    v_dot2_f32_bf16 v16, v80, v49, v16
    v_dot2_f32_bf16 v18, v81, v49, v18
    v_dot2_f32_bf16 v20, v82, v49, v20
    v_add_f32 v22, v22, v50
    v_dot2_f32_bf16 v17, v80, v50, v17
    v_dot2_f32_bf16 v19, v81, v50, v19
    v_dot2_f32_bf16 v21, v82, v50, v21
    v_sub_u32 v49, v87, v247
    v_sub_f32 v49, v49, v42
    v_exp_f32 v49, v49
    s_nop 0
    v_cvt_pk_bf16_f32 v49, v49, 0
    v_lshlrev_b32 v50, 16, v49
    v_dot2_f32_bf16 v16, v84, v49, v16
    v_dot2_f32_bf16 v18, v85, v49, v18
    v_dot2_f32_bf16 v20, v86, v49, v20
    v_add_f32 v22, v22, v50
    v_dot2_f32_bf16 v17, v84, v50, v17
    v_dot2_f32_bf16 v19, v85, v50, v19
    v_dot2_f32_bf16 v21, v86, v50, v21
    v_sub_u32 v49, v111, v247
    v_sub_f32 v49, v49, v42
    v_exp_f32 v49, v49
    s_nop 0
    v_cvt_pk_bf16_f32 v49, v49, 0
    v_lshlrev_b32 v50, 16, v49
    v_dot2_f32_bf16 v16, v108, v49, v16
    v_dot2_f32_bf16 v18, v109, v49, v18
    v_dot2_f32_bf16 v20, v110, v49, v20
    v_add_f32 v22, v22, v50
    v_dot2_f32_bf16 v17, v108, v50, v17
    v_dot2_f32_bf16 v19, v109, v50, v19
    v_dot2_f32_bf16 v21, v110, v50, v21
    v_sub_u32 v49, v115, v247
    v_sub_f32 v49, v49, v42
    v_exp_f32 v49, v49
    s_nop 0
    v_cvt_pk_bf16_f32 v49, v49, 0
    v_lshlrev_b32 v50, 16, v49
    v_dot2_f32_bf16 v16, v112, v49, v16
    v_dot2_f32_bf16 v18, v113, v49, v18
    v_dot2_f32_bf16 v20, v114, v49, v20
    v_add_f32 v22, v22, v50
    v_dot2_f32_bf16 v17, v112, v50, v17
    v_dot2_f32_bf16 v19, v113, v50, v19
    v_dot2_f32_bf16 v21, v114, v50, v21
    v_sub_u32 v49, v131, v247
    v_sub_f32 v49, v49, v42
    v_exp_f32 v49, v49
    s_nop 0
    v_cvt_pk_bf16_f32 v49, v49, 0
    v_lshlrev_b32 v50, 16, v49
    v_dot2_f32_bf16 v16, v128, v49, v16
    v_dot2_f32_bf16 v18, v129, v49, v18
    v_dot2_f32_bf16 v20, v130, v49, v20
    v_add_f32 v22, v22, v50
    v_dot2_f32_bf16 v17, v128, v50, v17
    v_dot2_f32_bf16 v19, v129, v50, v19
    v_dot2_f32_bf16 v21, v130, v50, v21
    v_sub_u32 v49, v135, v247
    v_sub_f32 v49, v49, v42
    v_exp_f32 v49, v49
    s_nop 0
    v_cvt_pk_bf16_f32 v49, v49, 0
    v_lshlrev_b32 v50, 16, v49
    v_dot2_f32_bf16 v16, v132, v49, v16
    v_dot2_f32_bf16 v18, v133, v49, v18
    v_dot2_f32_bf16 v20, v134, v49, v20
    v_add_f32 v22, v22, v50
    v_dot2_f32_bf16 v17, v132, v50, v17
    v_dot2_f32_bf16 v19, v133, v50, v19
    v_dot2_f32_bf16 v21, v134, v50, v21
    v_sub_u32 v49, v55, v247
    v_sub_f32 v49, v49, v42
    v_exp_f32 v49, v49
    s_nop 0
    v_cvt_pk_bf16_f32 v49, v49, 0
    v_lshlrev_b32 v50, 16, v49
    v_dot2_f32_bf16 v16, v52, v49, v16
    v_dot2_f32_bf16 v18, v53, v49, v18
    v_dot2_f32_bf16 v20, v54, v49, v20
    v_add_f32 v22, v22, v50
    v_dot2_f32_bf16 v17, v52, v50, v17
    v_dot2_f32_bf16 v19, v53, v50, v19
    v_dot2_f32_bf16 v21, v54, v50, v21
    s_nop 2
    s_branch L_c_red
L_qk_retry:
    s_mov_b32 s53, 0
L_qk_again:
    s_mul_i32 s56, s3, 3072
    s_add_u32 s56, s56, 16384
    buffer_load_dwordx4 v[136:139], v65, s[32:35], s56 offen offset:0 sc1
    buffer_load_dwordx4 v[140:143], v65, s[32:35], s56 offen offset:1024 sc1
    buffer_load_dwordx4 v[144:147], v65, s[32:35], s56 offen offset:2048 sc1
    s_add_u32 s53, s53, 1
    s_waitcnt vmcnt(0)
    v_xor_b32 v1, s39, v138
    v_xor_b32 v2, s39, v142
    v_xor_b32 v3, s39, v146
    v_or3_b32 v1, v1, v2, v3
    v_cmp_ne_u32 vcc, 0, v1
    s_cbranch_vccz L_qk_ok
    s_cmp_lt_u32 s53, 65536
    s_cbranch_scc1 L_qk_again
    s_branch L_qk_ok
L_fl_retry:
    s_mov_b32 s53, 0
L_fl_again:
    buffer_load_dword v244, v245, s[32:35], 0 offen offset:128 sc1
    s_add_u32 s53, s53, 1
    s_waitcnt vmcnt(0)
    v_cmp_ne_u32 vcc, s39, v244
    s_cbranch_vccz L_fl_ok
    s_cmp_lt_u32 s53, 65536
    s_cbranch_scc1 L_fl_again
    s_branch L_fl_ok
L_site0:
    s_call_b64 s[54:55], L_rare2
    s_branch L_back0
L_site1:
    s_call_b64 s[54:55], L_rare3
    s_branch L_back1
L_site2:
    s_call_b64 s[54:55], L_rare2
    s_branch L_back2
L_site3:
    s_call_b64 s[54:55], L_rare3
    s_branch L_back3
L_site4:
    s_call_b64 s[54:55], L_rare2
    s_branch L_back4
L_site5:
    s_call_b64 s[54:55], L_rare3
    s_branch L_back5
L_site6:
    s_call_b64 s[54:55], L_rare2
    s_branch L_back6
L_site7:
    s_call_b64 s[54:55], L_rare3
    s_branch L_back7
L_site8:
    s_call_b64 s[54:55], L_rare2
    s_branch L_back8
L_site9:
    s_call_b64 s[54:55], L_rare3
    s_branch L_back9
L_site10:
    s_call_b64 s[54:55], L_rare6
    s_branch L_back10
L_site11:
    s_call_b64 s[54:55], L_rare7
    s_branch L_back11
L_site12:
    s_call_b64 s[54:55], L_rare2
    s_branch L_back12
L_site13:
    s_call_b64 s[54:55], L_rare5
    s_branch L_back13
L_rare2:
    s_nop 7
    s_nop 7
    v_mov_b32 v2, v1
    s_nop 1
    v_permlane32_swap_b32 v1, v2
    v_max_f32 v1, v1, v2
    v_mov_b32 v2, v1
    s_nop 1
    v_permlane16_swap_b32 v1, v2
    v_max_f32 v1, v1, v2
    v_max_f32 v1, 0, v1
    v_sub_f32 v62, v62, v1
    v_sub_f32 v88, v88, v1
    v_sub_f32 v89, v89, v1
    v_sub_f32 v90, v90, v1
    v_sub_f32 v91, v91, v1
    v_sub_f32 v1, 0, v1
    v_exp_f32 v1, v1
    s_nop 0
    v_mul_f32 v63, v63, v1
    v_mul_f32 v64, v64, v1
    v_mul_f32 v68, v68, v1
    v_mul_f32 v69, v69, v1
    v_mul_f32 v70, v70, v1
    v_mul_f32 v71, v71, v1
    v_mov_b32 v2, 1
    ds_write_b32 v254, v2 offset:4096
    s_waitcnt lgkmcnt(0)
    s_nop 3
    s_setpc_b64 s[54:55]
L_rare3:
    s_nop 7
    s_nop 7
    v_mov_b32 v2, v1
    s_nop 1
    v_permlane32_swap_b32 v1, v2
    v_max_f32 v1, v1, v2
    v_mov_b32 v2, v1
    s_nop 1
    v_permlane16_swap_b32 v1, v2
    v_max_f32 v1, v1, v2
    v_max_f32 v1, 0, v1
    v_sub_f32 v62, v62, v1
    v_sub_f32 v104, v104, v1
    v_sub_f32 v105, v105, v1
    v_sub_f32 v106, v106, v1
    v_sub_f32 v107, v107, v1
    v_sub_f32 v1, 0, v1
    v_exp_f32 v1, v1
    s_nop 0
    v_mul_f32 v63, v63, v1
    v_mul_f32 v64, v64, v1
    v_mul_f32 v68, v68, v1
    v_mul_f32 v69, v69, v1
    v_mul_f32 v70, v70, v1
    v_mul_f32 v71, v71, v1
    v_mul_f32 v88, v88, v1
    v_mul_f32 v89, v89, v1
    v_mul_f32 v90, v90, v1
    v_mul_f32 v91, v91, v1
    v_mov_b32 v2, 1
    ds_write_b32 v254, v2 offset:4096
    s_waitcnt lgkmcnt(0)
    s_nop 3
    s_setpc_b64 s[54:55]
L_rare5:
    s_nop 7
    s_nop 7
    v_mov_b32 v2, v1
    s_nop 1
    v_permlane32_swap_b32 v1, v2
    v_max_f32 v1, v1, v2
    v_mov_b32 v2, v1
    s_nop 1
    v_permlane16_swap_b32 v1, v2
    v_max_f32 v1, v1, v2
    v_max_f32 v1, 0, v1
    v_sub_f32 v62, v62, v1
    v_sub_f32 v104, v104, v1
    v_sub_f32 v105, v105, v1
    v_sub_f32 v106, v106, v1
    v_sub_f32 v107, v107, v1
    v_sub_f32 v1, 0, v1
    v_exp_f32 v1, v1
    s_nop 0
    v_mul_f32 v63, v63, v1
    v_mul_f32 v64, v64, v1
    v_mul_f32 v68, v68, v1
    v_mul_f32 v69, v69, v1
    v_mul_f32 v70, v70, v1
    v_mul_f32 v71, v71, v1
    v_mul_f32 v88, v88, v1
    v_mul_f32 v89, v89, v1
    v_mul_f32 v90, v90, v1
    v_mul_f32 v91, v91, v1
    v_cvt_pk_bf16_f32 v72, v88, v89
    v_cvt_pk_bf16_f32 v73, v90, v91
    v_mov_b32 v2, 1
    ds_write_b32 v254, v2 offset:4096
    s_waitcnt lgkmcnt(0)
    s_nop 3
    s_setpc_b64 s[54:55]
L_rare6:
    s_nop 7
    s_nop 7
    v_mov_b32 v2, v1
    s_nop 1
    v_permlane32_swap_b32 v1, v2
    v_max_f32 v1, v1, v2
    v_mov_b32 v2, v1
    s_nop 1
    v_permlane16_swap_b32 v1, v2
    v_max_f32 v1, v1, v2
    v_max_f32 v1, 0, v1
    v_sub_f32 v62, v62, v1
    v_sub_f32 v88, v88, v1
    v_sub_f32 v89, v89, v1
    v_sub_f32 v90, v90, v1
    v_sub_f32 v91, v91, v1
    v_sub_f32 v1, 0, v1
    v_exp_f32 v1, v1
    s_nop 0
    v_mul_f32 v63, v63, v1
    v_mul_f32 v64, v64, v1
    v_mul_f32 v68, v68, v1
    v_mul_f32 v69, v69, v1
    v_mul_f32 v70, v70, v1
    v_mul_f32 v71, v71, v1
    v_mov_b32 v2, 1
    ds_write_b32 v254, v2 offset:4100
    s_waitcnt lgkmcnt(0)
    s_nop 3
    s_setpc_b64 s[54:55]
L_rare7:
    s_nop 7
    s_nop 7
    v_mov_b32 v2, v1
    s_nop 1
    v_permlane32_swap_b32 v1, v2
    v_max_f32 v1, v1, v2
    v_mov_b32 v2, v1
    s_nop 1
    v_permlane16_swap_b32 v1, v2
    v_max_f32 v1, v1, v2
    v_max_f32 v1, 0, v1
    v_sub_f32 v62, v62, v1
    v_sub_f32 v104, v104, v1
    v_sub_f32 v105, v105, v1
    v_sub_f32 v106, v106, v1
    v_sub_f32 v107, v107, v1
    v_sub_f32 v1, 0, v1
    v_exp_f32 v1, v1
    s_nop 0
    v_mul_f32 v63, v63, v1
    v_mul_f32 v64, v64, v1
    v_mul_f32 v68, v68, v1
    v_mul_f32 v69, v69, v1
    v_mul_f32 v70, v70, v1
    v_mul_f32 v71, v71, v1
    v_mul_f32 v88, v88, v1
    v_mul_f32 v89, v89, v1
    v_mul_f32 v90, v90, v1
    v_mul_f32 v91, v91, v1
    v_mov_b32 v2, 1
    ds_write_b32 v254, v2 offset:4100
    s_waitcnt lgkmcnt(0)
    s_nop 3
    s_setpc_b64 s[54:55]
L_codeend:
.section .rodata,"a"
.p2align 6
.amdhsa_kernel standalone__detection_seg_dino__vision_kernel
  .amdhsa_next_free_vgpr 464
  .amdhsa_next_free_sgpr 102
  .amdhsa_accum_offset 256
  .amdhsa_group_segment_fixed_size 0
  .amdhsa_kernarg_size 80
  .amdhsa_user_sgpr_count 2
  .amdhsa_user_sgpr_kernarg_segment_ptr 1
  .amdhsa_system_sgpr_workgroup_id_x 1
  .amdhsa_float_denorm_mode_32 3
.end_amdhsa_kernel
```

```asm
; @launch grid=(256,1,1) block=(256,1,1) lds=163840
.amdgcn_target "amdgcn-amd-amdhsa--gfx950"
.text
.globl standalone__detection_seg_dino__vision_kernel
.p2align 8
.type standalone__detection_seg_dino__vision_kernel,@function
standalone__detection_seg_dino__vision_kernel:
    s_cmp_ge_u32 s2, 256
    s_cbranch_scc1 L_end
    s_load_dwordx16 s[4:19], s[0:1], 0
    s_load_dwordx4 s[20:23], s[0:1], 64
    s_getpc_b64 s[54:55]
L_pc_main:
    v_lshlrev_b32 v233, 7, v0
    v_min_u32 v233, L_codeend - L_pc_main - 4, v233
    global_load_dword v232, v233, s[54:55]
    s_mov_b64 s[100:101], s[54:55]
    v_lshrrev_b32 v1, 6, v0
    v_and_b32 v0, 63, v0
    v_readfirstlane_b32 s3, v1
    v_lshlrev_b32 v65, 4, v0
    v_lshrrev_b32 v1, 2, v0
    v_and_b32 v1, 14, v1
    s_mov_b32 s56, 0x5000
    v_bfe_u32 v2, s56, v1, 2
    v_lshlrev_b32 v2, 5, v2
    v_xor_b32 v16, v65, v2
    s_mov_b32 s56, 0xaa55
    v_bfe_u32 v2, s56, v1, 2
    v_lshlrev_b32 v2, 5, v2
    v_xor_b32 v17, v65, v2
    s_mov_b32 s56, 0xfffa
    v_bfe_u32 v2, s56, v1, 2
    v_lshlrev_b32 v2, 5, v2
    v_xor_b32 v18, v65, v2
    v_xor_b32 v19, 16, v16
    v_xor_b32 v20, 0x1010, v17
    v_xor_b32 v21, 0x1010, v18
    v_lshrrev_b32 v1, 3, v0
    v_and_b32 v1, 6, v1
    s_mov_b32 s56, 0x40
    v_bfe_u32 v2, s56, v1, 2
    v_lshlrev_b32 v2, 5, v2
    v_xor_b32 v22, v65, v2
    s_mov_b32 s56, 0xa5
    v_bfe_u32 v2, s56, v1, 2
    v_lshlrev_b32 v2, 5, v2
    v_xor_b32 v23, v65, v2
    s_mov_b32 s56, 0xfe
    v_bfe_u32 v2, s56, v1, 2
    v_lshlrev_b32 v2, 5, v2
    v_xor_b32 v24, v65, v2
    v_xor_b32 v25, 0x80, v22
    v_xor_b32 v26, 0x1080, v23
    v_xor_b32 v27, 0x1080, v24
    v_xor_b32 v28, 0x1010, v22
    v_xor_b32 v29, 0x1010, v23
    v_xor_b32 v30, 0x2010, v24
    v_xor_b32 v31, 0x2090, v22
    v_xor_b32 v32, 0x2090, v23
    v_xor_b32 v33, 0x2090, v24
    v_mov_b32 v248, 0x10000
    s_mul_i32 s36, s3, 6144
    s_mul_i32 s37, s3, 12288
    s_add_u32 s40, s36, 0
    s_add_u32 s41, s37, 24576
    s_add_u32 s42, s37, 73728
    s_mul_i32 s56, s2, 393216
    s_mul_i32 s57, s2, 98304
    s_mov_b64 s[60:61], s[56:57]
    s_mov_b32 s30, 98304
    s_mov_b32 s31, 0x20000
    s_mov_b32 s26, 393216
    s_mov_b32 s27, 0x20000
    s_mov_b32 s34, 8388608
    s_mov_b32 s35, 0x20000
    s_mov_b32 m0, s40
    s_and_b32 s56, s2, 7
    s_cmp_eq_u32 s56, 6
    s_cbranch_scc1 L_spec
    s_and_b32 s56, s2, 7
    s_cbranch_scc1 L_plain
L_spec:
    s_waitcnt lgkmcnt(0)
    s_add_u32 s28, s8, s61
    s_addc_u32 s29, s9, 0
    s_add_u32 s24, s6, s60
    s_addc_u32 s25, s7, 0
    s_mov_b64 s[32:33], s[22:23]
    s_lshr_b32 s43, s2, 3
    s_mul_i32 s57, s43, 2304
    v_min_u32 v1, 17, v0
    v_lshlrev_b32 v1, 7, v1
    s_mov_b32 s66, 73728
    s_mov_b32 s67, 0x20000
    s_mov_b32 s70, 73728
    s_mov_b32 s71, 0x20000
    s_mov_b32 s72, s4
    s_mov_b32 s73, s5
    s_mov_b32 s74, 6144
    s_mov_b32 s75, 0x20000
    s_bitcmp1_b32 s2, 2
    s_cselect_b64 s[64:65], s[16:17], s[10:11]
    s_cselect_b64 s[68:69], s[14:15], s[12:13]
    s_cmp_eq_u32 s3, 0
    s_cbranch_scc1 L_pf0
    s_cmp_eq_u32 s3, 1
    s_cbranch_scc0 L_pfdone
    s_lshl_b32 s58, s43, 8
    buffer_load_dword v234, v1, s[68:71], s57 offen
    v_min_u32 v2, 128, v1
    buffer_load_dword v235, v2, s[72:75], s58 offen
    s_branch L_pfdone
L_pf0:
    buffer_load_dword v234, v1, s[64:67], s57 offen
L_pfdone:
    s_cmp_ge_u32 s43, 3
    s_cbranch_scc1 L_nopf
    s_mov_b32 s0, 1
    s_bitcmp1_b32 s2, 2
    s_cbranch_scc0 L_prod
    s_branch L_vprod
L_plain:
    s_waitcnt lgkmcnt(0)
L_nopf:
    s_add_u32 s28, s8, s61
    s_addc_u32 s29, s9, 0
    buffer_load_dwordx4 v16, s[28:31], s36 offen offset:0 nt lds
    s_add_u32 s24, s6, s60
    s_addc_u32 s25, s7, 0
    s_mov_b64 s[32:33], s[22:23]
    s_mov_b32 s0, 0
    buffer_load_dwordx4 v17, s[28:31], s36 offen offset:1024 nt lds
    buffer_load_dwordx4 v18, s[28:31], s36 offen offset:2048 nt lds
    buffer_load_dwordx4 v19, s[28:31], s36 offen offset:3072 nt lds
    s_add_u32 m0, s40, 4096
    s_load_dword s38, s[22:23], 0
    buffer_load_dwordx4 v20, s[28:31], s36 offen offset:0 nt lds
    buffer_load_dwordx4 v21, s[28:31], s36 offen offset:1024 nt lds
    s_mov_b32 s43, -1
    s_sub_u32 s59, s2, 64
    s_cmp_ge_u32 s59, 64
    s_cbranch_scc1 L_nocs
    s_mov_b32 s64, s4
    s_mov_b32 s65, s5
    s_mov_b32 s66, 6144
    s_mov_b32 s67, 0x20000
    s_mov_b32 s68, s18
    s_mov_b32 s69, s19
    s_mov_b32 s70, 6144
    s_mov_b32 s71, 0x20000
    v_bfe_u32 v1, v0, 2, 1
    v_mul_u32_u24 v2, 7, v1
    v_xor_b32 v2, v0, v2
    v_and_b32 v2, 3, v2
    s_lshr_b32 s56, s59, 4
    s_lshl_b32 s56, s56, 2
    v_add_u32 v2, s56, v2
    v_lshlrev_b32 v252, 2, v2
    v_lshrrev_b32 v3, 4, v0
    v_mad_u32_u24 v3, v1, 3, v3
    v_lshrrev_b32 v4, 1, v3
    v_and_b32 v3, 1, v3
    v_lshlrev_b32 v3, 2, v3
    v_lshl_add_u32 v3, v4, 5, v3
    v_bfe_u32 v4, v0, 3, 1
    v_lshl_add_u32 v3, v4, 1, v3
    v_mul_u32_u24 v2, 384, v2
    s_bfe_u32 s56, s59, 0x20002
    s_mul_i32 s56, s56, 96
    s_and_b32 s57, s59, 3
    s_lshl_b32 s57, s57, 3
    s_add_u32 s56, s56, s57
    v_add3_u32 v248, s56, v2, v3
    v_cmp_gt_u32 vcc, 48, v0
    v_mov_b32 v4, 0x10000
    s_lshl_b32 s56, s3, 2
    v_cndmask_b32 v248, v4, v248, vcc
    buffer_load_ushort v249, v248, s[64:67], 0 offen
    buffer_load_ushort v246, v248, s[68:71], 0 offen
    v_add_u32 v250, s56, v65
    v_and_b32 v251, 0x70, v65
L_nocs:
    s_add_u32 m0, s41, 0
    s_add_u32 s58, s37, 0
    buffer_load_dwordx4 v22, s[24:27], s58 offen offset:0 nt lds
    buffer_load_dwordx4 v23, s[24:27], s58 offen offset:1024 nt lds
    buffer_load_dwordx4 v24, s[24:27], s58 offen offset:2048 nt lds
    buffer_load_dwordx4 v25, s[24:27], s58 offen offset:3072 nt lds
    s_add_u32 m0, s41, 4096
    s_nop 0
    buffer_load_dwordx4 v26, s[24:27], s58 offen offset:0 nt lds
    buffer_load_dwordx4 v27, s[24:27], s58 offen offset:1024 nt lds
    buffer_load_dwordx4 v28, s[24:27], s58 offen offset:2048 nt lds
    buffer_load_dwordx4 v29, s[24:27], s58 offen offset:3072 nt lds
    s_add_u32 m0, s41, 8192
    s_nop 0
    buffer_load_dwordx4 v30, s[24:27], s58 offen offset:0 nt lds
    buffer_load_dwordx4 v31, s[24:27], s58 offen offset:1024 nt lds
    buffer_load_dwordx4 v32, s[24:27], s58 offen offset:2048 nt lds
    buffer_load_dwordx4 v33, s[24:27], s58 offen offset:3072 nt lds
    s_add_u32 m0, s42, 0
    s_add_u32 s59, s37, 196608
    buffer_load_dwordx4 v22, s[24:27], s59 offen offset:0 nt lds
    buffer_load_dwordx4 v23, s[24:27], s59 offen offset:1024 nt lds
    buffer_load_dwordx4 v24, s[24:27], s59 offen offset:2048 nt lds
    buffer_load_dwordx4 v25, s[24:27], s59 offen offset:3072 nt lds
    s_add_u32 m0, s42, 4096
    s_nop 0
    buffer_load_dwordx4 v26, s[24:27], s59 offen offset:0 nt lds
    buffer_load_dwordx4 v27, s[24:27], s59 offen offset:1024 nt lds
    buffer_load_dwordx4 v28, s[24:27], s59 offen offset:2048 nt lds
    buffer_load_dwordx4 v29, s[24:27], s59 offen offset:3072 nt lds
    s_add_u32 m0, s42, 8192
    s_nop 0
    buffer_load_dwordx4 v30, s[24:27], s59 offen offset:0 nt lds
    buffer_load_dwordx4 v31, s[24:27], s59 offen offset:1024 nt lds
    buffer_load_dwordx4 v32, s[24:27], s59 offen offset:2048 nt lds
    buffer_load_dwordx4 v33, s[24:27], s59 offen offset:3072 nt lds
    v_and_b32 v1, 15, v0
    v_lshrrev_b32 v6, 5, v0
    v_bfe_u32 v3, v0, 4, 1
    v_lshl_or_b32 v3, v3, 1, v6
    v_lshrrev_b32 v4, 2, v0
    v_bfe_u32 v5, v0, 1, 1
    v_lshrrev_b32 v6, 3, v1
    v_and_or_b32 v6, v1, 6, v6
    v_xor_b32 v6, v6, v3
    v_mul_u32_u24 v7, 384, v1
    v_lshl_add_u32 v6, v6, 4, v7
    v_add_u32 v34, s40, v6
    v_xor_b32 v35, 64, v34
    v_lshrrev_b32 v6, 3, v1
    v_and_b32 v7, 7, v1
    v_lshl_or_b32 v6, v7, 1, v6
    v_xor_b32 v6, v6, v3
    v_mul_u32_u24 v7, 768, v1
    v_lshl_add_u32 v6, v6, 4, v7
    v_add_u32 v40, s41, v6
    v_xor_b32 v41, 0x40, v40
    v_xor_b32 v42, 0x80, v40
    v_xor_b32 v43, 0xc0, v40
    v_and_b32 v2, 1, v0
    v_lshlrev_b32 v2, 3, v2
    s_mul_i32 s56, s3, 96
    v_lshrrev_b32 v6, 3, v4
    v_and_or_b32 v6, v4, 6, v6
    v_xor_b32 v6, v6, v5
    v_lshl_add_u32 v6, v6, 4, v2
    v_mul_u32_u24 v7, 384, v4
    s_add_u32 s57, s56, 0
    v_xad_u32 v36, v6, s57, v7
    s_add_u32 s57, s56, 32
    v_xad_u32 v37, v6, s57, v7
    s_add_u32 s57, s56, 64
    v_xad_u32 v38, v6, s57, v7
    v_lshrrev_b32 v6, 3, v4
    v_and_b32 v3, 7, v4
    v_lshl_or_b32 v6, v3, 1, v6
    v_xor_b32 v6, v6, v5
    v_lshl_add_u32 v6, v6, 4, v2
    v_lshlrev_b32 v7, 1, v7
    v_add_u32 v7, 24576, v7
    s_add_u32 s57, s56, 0
    v_xad_u32 v44, v6, s57, v7
    s_add_u32 s57, s56, 384
    v_xad_u32 v45, v6, s57, v7
    s_add_u32 s57, s56, 32
    v_xad_u32 v46, v6, s57, v7
    s_add_u32 s57, s56, 416
    v_xad_u32 v47, v6, s57, v7
    s_add_u32 s57, s56, 64
    v_xad_u32 v48, v6, s57, v7
    s_add_u32 s57, s56, 448
    v_xad_u32 v49, v6, s57, v7
    v_mov_b32 v52, 0x3f803f80
    v_mov_b32 v56, 0x3ebcbe62
    s_mov_b32 s44, 0x100001
    s_mov_b32 s45, 0x10000100
    v_mov_b32 v53, 0x3f803f80
    v_mov_b32 v57, 0x3ebcbe62
    s_mov_b32 s46, 0x200002
    s_mov_b32 s47, 0x20000200
    v_mov_b32 v54, 0x3f803f80
    v_mov_b32 v58, 0x3ebcbe62
    s_mov_b32 s48, 0x400004
    s_mov_b32 s49, 0x40000400
    v_mov_b32 v55, 0x3f803f80
    v_mov_b32 v59, 0x3ebcbe62
    s_mov_b32 s50, 0x800008
    s_mov_b32 s51, 0x80000800
    v_mov_b32 v60, 0x43400000
    v_lshrrev_b32 v1, 5, v0
    v_lshlrev_b32 v1, 8, v1
    v_and_b32 v2, 15, v0
    v_lshl_add_u32 v1, v2, 4, v1
    v_bfe_u32 v2, v0, 4, 1
    v_lshl_add_u32 v1, v2, 3, v1
    s_mul_i32 s56, s3, 1536
    s_add_u32 s56, s56, 147456
    v_add_u32 v236, s56, v1
    s_mul_i32 s56, s3, 3072
    s_add_u32 s56, s56, 24576
    v_add_u32 v237, s56, v65
    v_add_u32 v238, s41, v65
    s_lshl_b32 s56, s3, 10
    v_add_u32 v240, 159744, v65
    v_add_u32 v239, s56, v240
    v_add_u32 v241, 147456, v65
    v_bfe_u32 v1, v0, 2, 2
    v_lshrrev_b32 v2, 4, v0
    v_lshl_or_b32 v1, v1, 4, v2
    v_mul_u32_u24 v1, 32768, v1
    v_and_b32 v2, 3, v0
    v_lshl_or_b32 v242, v2, 4, v1
    v_xor_b32 v243, 0x70, v242
    s_mul_i32 s56, s3, 3
    v_min_u32 v1, 2, v0
    v_add_u32 v1, s56, v1
    v_lshlrev_b32 v245, 7, v1
    v_lshlrev_b32 v1, 3, v0
    v_add_u32 v254, 126976, v1
    s_lshl_b32 s56, s3, 9
    v_add_u32 v238, s56, v254
    v_add_u32 v253, 122880, v65
    s_lshl_b32 s56, s3, 10
    v_add_u32 v237, s56, v253
    s_mov_b32 s52, 0x41c00000
L_join:
    s_mul_i32 s60, s3, 18432
    s_mov_b32 s72, s22
    s_mov_b32 s73, s23
    s_mov_b32 s74, 8388608
    s_mov_b32 s75, 0x20000
    s_cmp_eq_u32 s0, 1
    s_cselect_b32 s74, 0, s74
    s_waitcnt vmcnt(24)
    s_waitcnt lgkmcnt(0)
    s_barrier
    ds_read_b128 a[48:51], v34 offset:0
    ds_read_b128 a[52:55], v35 offset:0
    ds_read_b128 a[56:59], v34 offset:128
    ds_read_b128 a[60:63], v35 offset:128
    ds_read_b128 a[64:67], v34 offset:256
    ds_read_b128 a[68:71], v35 offset:256
    s_waitcnt lgkmcnt(5)
    v_mfma_f32_16x16x32_bf16 v[84:87], a[48:51], a[48:51], 0
    ds_read_b64_tr_b16 a[72:73], v36 offset:0
    ds_read_b64_tr_b16 a[74:75], v36 offset:6144
    v_mfma_f32_16x16x32_bf16 v[80:83], a[48:51], v[52:55], 0
    ds_read_b64_tr_b16 a[76:77], v36 offset:12288
    ds_read_b64_tr_b16 a[78:79], v36 offset:18432
    s_waitcnt lgkmcnt(8)
    v_mfma_f32_16x16x32_bf16 v[84:87], a[52:55], a[52:55], v[84:87]
    ds_read_b64_tr_b16 a[80:81], v37 offset:0
    ds_read_b64_tr_b16 a[82:83], v37 offset:6144
    v_mfma_f32_16x16x32_bf16 v[80:83], a[52:55], v[52:55], v[80:83]
    ds_read_b64_tr_b16 a[84:85], v37 offset:12288
    ds_read_b64_tr_b16 a[86:87], v37 offset:18432
    s_waitcnt lgkmcnt(11)
    v_mfma_f32_16x16x32_bf16 v[84:87], a[56:59], a[56:59], v[84:87]
    ds_read_b64_tr_b16 a[88:89], v38 offset:0
    ds_read_b64_tr_b16 a[90:91], v38 offset:6144
    v_mfma_f32_16x16x32_bf16 v[80:83], a[56:59], v[52:55], v[80:83]
    ds_read_b64_tr_b16 a[92:93], v38 offset:12288
    ds_read_b64_tr_b16 a[94:95], v38 offset:18432
    s_waitcnt lgkmcnt(14)
    v_mfma_f32_16x16x32_bf16 v[84:87], a[60:63], a[60:63], v[84:87]
    v_mfma_f32_16x16x32_bf16 v[80:83], a[60:63], v[52:55], v[80:83]
    s_waitcnt lgkmcnt(13)
    v_mfma_f32_16x16x32_bf16 v[84:87], a[64:67], a[64:67], v[84:87]
    v_mfma_f32_16x16x32_bf16 v[80:83], a[64:67], v[52:55], v[80:83]
    s_waitcnt lgkmcnt(12)
    v_mfma_f32_16x16x32_bf16 v[84:87], a[68:71], a[68:71], v[84:87]
    v_mfma_f32_16x16x32_bf16 v[80:83], a[68:71], v[52:55], v[80:83]
    s_waitcnt lgkmcnt(0)
    s_mul_i32 s39, s38, 0x9e3779b1
    s_add_u32 s39, s39, 0x7f4a7c16
    s_or_b32 s39, s39, 1
    s_mul_i32 s56, s3, 3072
    s_add_u32 s56, s56, 16384
    buffer_load_dwordx4 v[136:139], v65, s[32:35], s56 offen offset:0 sc1
    buffer_load_dwordx4 v[140:143], v65, s[32:35], s56 offen offset:1024 sc1
    buffer_load_dwordx4 v[144:147], v65, s[32:35], s56 offen offset:2048 sc1
    s_waitcnt vmcnt(15)
    s_barrier
    ds_read_b128 a[96:99], v40 offset:0
    ds_read_b128 a[100:103], v41 offset:0
    ds_read_b128 a[104:107], v42 offset:0
    ds_read_b128 a[108:111], v43 offset:0
    ds_read_b128 a[112:115], v40 offset:256
    ds_read_b128 a[116:119], v41 offset:256
    ds_read_b128 a[120:123], v42 offset:256
    ds_read_b128 a[124:127], v43 offset:256
    ds_read_b128 a[128:131], v40 offset:512
    ds_read_b128 a[132:135], v41 offset:512
    ds_read_b128 a[136:139], v42 offset:512
    ds_read_b128 a[140:143], v43 offset:512
    ds_read_b64_tr_b16 a[144:145], v44 offset:0
    ds_read_b64_tr_b16 a[146:147], v45 offset:0
    ds_read_b64_tr_b16 a[148:149], v44 offset:12288
    ds_read_b64_tr_b16 a[150:151], v45 offset:12288
    ds_read_b64_tr_b16 a[152:153], v44 offset:24576
    ds_read_b64_tr_b16 a[154:155], v45 offset:24576
    ds_read_b64_tr_b16 a[156:157], v44 offset:36864
    ds_read_b64_tr_b16 a[158:159], v45 offset:36864
    ds_read_b64_tr_b16 a[160:161], v46 offset:0
    ds_read_b64_tr_b16 a[162:163], v47 offset:0
    ds_read_b64_tr_b16 a[164:165], v46 offset:12288
    ds_read_b64_tr_b16 a[166:167], v47 offset:12288
    ds_read_b64_tr_b16 a[168:169], v46 offset:24576
    ds_read_b64_tr_b16 a[170:171], v47 offset:24576
    ds_read_b64_tr_b16 a[172:173], v46 offset:36864
    ds_read_b64_tr_b16 a[174:175], v47 offset:36864
    ds_read_b64_tr_b16 a[176:177], v48 offset:0
    ds_read_b64_tr_b16 a[178:179], v49 offset:0
    ds_read_b64_tr_b16 a[180:181], v48 offset:12288
    ds_read_b64_tr_b16 a[182:183], v49 offset:12288
    ds_read_b64_tr_b16 a[184:185], v48 offset:24576
    ds_read_b64_tr_b16 a[186:187], v49 offset:24576
    ds_read_b64_tr_b16 a[188:189], v48 offset:36864
    ds_read_b64_tr_b16 a[190:191], v49 offset:36864
    s_waitcnt lgkmcnt(0)
    s_barrier
    s_cmp_ge_u32 s43, 3
    s_cbranch_scc1 L_v_nofl
    s_mul_i32 s56, s3, 3
    s_add_u32 s56, s56, s43
    s_lshl_b32 s56, s56, 7
    v_mov_b32 v1, s39
    v_mov_b32 v2, 0
    s_mov_b64 exec, 1
    s_waitcnt vmcnt(9)
    buffer_store_dword v1, v2, s[32:35], s56 offen offset:128 sc1
    s_mov_b64 exec, -1
L_v_nofl:
    v_mfma_f32_16x16x32_bf16 v[96:99], a[96:99], a[96:99], v[84:87]
    s_add_u32 m0, s40, 0
    s_add_u32 s57, s36, 24576
    buffer_load_dwordx4 v16, s[28:31], s57 offen offset:0 nt lds
    v_add_u32 v44, 49152, v44
    v_add_u32 v45, 49152, v45
    v_mfma_f32_16x16x32_bf16 v[100:103], a[96:99], a[48:51], 0
    buffer_load_dwordx4 v17, s[28:31], s57 offen offset:1024 nt lds
    v_add_u32 v46, 49152, v46
    v_add_u32 v47, 49152, v47
    v_mfma_f32_16x16x32_bf16 v[96:99], a[100:103], a[100:103], v[96:99]
    buffer_load_dwordx4 v18, s[28:31], s57 offen offset:2048 nt lds
    v_add_u32 v48, 49152, v48
    v_add_u32 v49, 49152, v49
    v_mfma_f32_16x16x32_bf16 v[100:103], a[100:103], a[52:55], v[100:103]
    v_mfma_f32_16x16x32_bf16 v[96:99], a[104:107], a[104:107], v[96:99]
    v_mfma_f32_16x16x32_bf16 v[100:103], a[104:107], a[56:59], v[100:103]
    v_mfma_f32_16x16x32_bf16 v[96:99], a[108:111], a[108:111], v[96:99]
    v_mfma_f32_16x16x32_bf16 v[100:103], a[108:111], a[60:63], v[100:103]
    v_mfma_f32_16x16x32_bf16 v[96:99], a[112:115], a[112:115], v[96:99]
    v_mfma_f32_16x16x32_bf16 v[100:103], a[112:115], a[64:67], v[100:103]
    v_mfma_f32_16x16x32_bf16 v[96:99], a[116:119], a[116:119], v[96:99]
    v_mfma_f32_16x16x32_bf16 v[100:103], a[116:119], a[68:71], v[100:103]
    v_mfma_f32_16x16x32_bf16 v[92:95], a[96:99], v[52:55], v[80:83]
    v_mfma_f32_16x16x32_bf16 v[92:95], a[100:103], v[52:55], v[92:95]
    v_mfma_f32_16x16x32_bf16 v[92:95], a[104:107], v[52:55], v[92:95]
    v_mfma_f32_16x16x32_bf16 v[92:95], a[108:111], v[52:55], v[92:95]
    s_nop 3
    v_fma_f32 v96, v100, 2.0, v96
    v_fma_f32 v97, v101, 2.0, v97
    v_mfma_f32_16x16x32_bf16 v[92:95], a[112:115], v[52:55], v[92:95]
    buffer_load_dwordx4 v19, s[28:31], s57 offen offset:3072 nt lds
    v_fma_f32 v98, v102, 2.0, v98
    v_fma_f32 v99, v103, 2.0, v99
    v_mfma_f32_16x16x32_bf16 v[92:95], a[116:119], v[52:55], v[92:95]
    v_cndmask_b32 v3, 0, v96, s[44:45]
    v_cndmask_b32 v3, v3, v97, s[46:47]
    v_mfma_f32_16x16x32_bf16 v[112:115], a[120:123], a[120:123], v[84:87]
    v_cndmask_b32 v3, v3, v98, s[48:49]
    v_cndmask_b32 v3, v3, v99, s[50:51]
    v_mfma_f32_16x16x32_bf16 v[116:119], a[120:123], a[48:51], 0
    s_nop 0
    s_nop 0
    v_mfma_f32_16x16x32_bf16 v[112:115], a[124:127], a[124:127], v[112:115]
    v_mfma_f32_16x16x4_f32 v[120:123], v3, v60, v[56:59]
    v_mfma_f32_16x16x32_bf16 v[116:119], a[124:127], a[52:55], v[116:119]
    v_mfma_f32_16x16x32_bf16 v[112:115], a[128:131], a[128:131], v[112:115]
    v_mfma_f32_16x16x32_bf16 v[116:119], a[128:131], a[56:59], v[116:119]
    v_mfma_f32_16x16x32_bf16 v[112:115], a[132:135], a[132:135], v[112:115]
    s_nop 5
    v_fma_f32 v128, -v92, v92, v120
    v_fma_f32 v129, -v93, v93, v121
    v_mfma_f32_16x16x32_bf16 v[116:119], a[132:135], a[60:63], v[116:119]
    v_fma_f32 v130, -v94, v94, v122
    v_fma_f32 v131, -v95, v95, v123
    v_mfma_f32_16x16x32_bf16 v[112:115], a[136:139], a[136:139], v[112:115]
    v_max_f32 v128, v128, v56
    v_max_f32 v129, v129, v56
    v_mfma_f32_16x16x32_bf16 v[116:119], a[136:139], a[64:67], v[116:119]
    s_add_u32 m0, s40, 4096
    s_nop 0
    buffer_load_dwordx4 v20, s[28:31], s57 offen offset:0 nt lds
    v_max_f32 v130, v130, v56
    v_max_f32 v131, v131, v56
    v_mfma_f32_16x16x32_bf16 v[112:115], a[140:143], a[140:143], v[112:115]
    v_rsq_f32 v128, v128
    v_mfma_f32_16x16x32_bf16 v[116:119], a[140:143], a[68:71], v[116:119]
    v_rsq_f32 v129, v129
    v_mfma_f32_16x16x32_bf16 v[108:111], a[120:123], v[52:55], v[80:83]
    v_rsq_f32 v130, v130
    v_mfma_f32_16x16x32_bf16 v[108:111], a[124:127], v[52:55], v[108:111]
    v_rsq_f32 v131, v131
    v_mfma_f32_16x16x32_bf16 v[108:111], a[128:131], v[52:55], v[108:111]
    v_mfma_f32_16x16x32_bf16 v[108:111], a[132:135], v[52:55], v[108:111]
    v_mfma_f32_16x16x32_bf16 v[108:111], a[136:139], v[52:55], v[108:111]
    v_fma_f32 v112, v116, 2.0, v112
    v_fma_f32 v113, v117, 2.0, v113
    v_mfma_f32_16x16x32_bf16 v[108:111], a[140:143], v[52:55], v[108:111]
    v_fma_f32 v114, v118, 2.0, v114
    v_fma_f32 v115, v119, 2.0, v115
    v_cndmask_b32 v4, 0, v112, s[44:45]
    v_cndmask_b32 v4, v4, v113, s[46:47]
    v_cndmask_b32 v4, v4, v114, s[48:49]
    v_cndmask_b32 v4, v4, v115, s[50:51]
    s_nop 0
    s_nop 0
    v_mfma_f32_16x16x4_f32 v[124:127], v4, v60, v[56:59]
    s_nop 9
    v_fma_f32 v132, -v108, v108, v124
    v_fma_f32 v133, -v109, v109, v125
    v_fma_f32 v134, -v110, v110, v126
    v_fma_f32 v135, -v111, v111, v127
    v_max_f32 v132, v132, v56
    v_max_f32 v133, v133, v56
    v_max_f32 v134, v134, v56
    v_max_f32 v135, v135, v56
    v_rsq_f32 v132, v132
    v_rsq_f32 v133, v133
    v_rsq_f32 v134, v134
    v_rsq_f32 v135, v135
    s_mul_i32 s56, s3, 1536
    v_lshlrev_b32 v5, 3, v0
    v_add_u32 v5, 153600, v5
    v_add_u32 v4, s56, v5
    buffer_load_dwordx4 v21, s[28:31], s57 offen offset:1024 nt lds
    s_add_u32 m0, s41, 0
    s_add_u32 s58, s37, 49152
    buffer_load_dwordx4 v22, s[24:27], s58 offen offset:0 nt lds
    buffer_load_dwordx4 v23, s[24:27], s58 offen offset:1024 nt lds
    buffer_load_dwordx4 v24, s[24:27], s58 offen offset:2048 nt lds
    buffer_load_dwordx4 v25, s[24:27], s58 offen offset:3072 nt lds
    s_add_u32 m0, s41, 4096
    s_nop 0
    buffer_load_dwordx4 v26, s[24:27], s58 offen offset:0 nt lds
    buffer_load_dwordx4 v27, s[24:27], s58 offen offset:1024 nt lds
    s_waitcnt vmcnt(12)
    v_xor_b32 v1, s39, v138
    v_xor_b32 v2, s39, v142
    v_xor_b32 v3, s39, v146
    v_or3_b32 v1, v1, v2, v3
    v_cmp_ne_u32 vcc, 0, v1
    s_cbranch_vccnz L_qk_retry
L_qk_ok:
    ds_write_b64 v4, v[136:137] offset:0
    ds_write_b64 v4, v[140:141] offset:512
    ds_write_b64 v4, v[144:145] offset:1024
    s_waitcnt lgkmcnt(0)
    s_barrier
    ds_read2st64_b64 v[136:139], v5 offset0:0 offset1:1
    ds_read2st64_b64 v[140:143], v5 offset0:2 offset1:3
    ds_read2st64_b64 v[144:147], v5 offset0:4 offset1:5
    ds_read2st64_b64 v[148:151], v5 offset0:6 offset1:7
    ds_read2st64_b64 v[152:155], v5 offset0:8 offset1:9
    ds_read2st64_b64 v[156:159], v5 offset0:10 offset1:11
    s_waitcnt lgkmcnt(5)
    v_mfma_f32_16x16x32_bf16 v[120:123], v[52:55], v[136:139], 0
    buffer_load_dwordx4 v28, s[24:27], s58 offen offset:2048 nt lds
    v_mfma_f32_16x16x32_bf16 v[76:79], a[48:51], v[136:139], 0
    s_waitcnt lgkmcnt(4)
    v_mfma_f32_16x16x32_bf16 v[120:123], v[52:55], v[140:143], v[120:123]
    v_mfma_f32_16x16x32_bf16 v[76:79], a[52:55], v[140:143], v[76:79]
    s_waitcnt lgkmcnt(3)
    v_mfma_f32_16x16x32_bf16 v[120:123], v[52:55], v[144:147], v[120:123]
    v_mfma_f32_16x16x32_bf16 v[76:79], a[56:59], v[144:147], v[76:79]
    s_waitcnt lgkmcnt(2)
    v_mfma_f32_16x16x32_bf16 v[120:123], v[52:55], v[148:151], v[120:123]
    v_mfma_f32_16x16x32_bf16 v[76:79], a[60:63], v[148:151], v[76:79]
    s_waitcnt lgkmcnt(1)
    v_mfma_f32_16x16x32_bf16 v[120:123], v[52:55], v[152:155], v[120:123]
    buffer_load_dwordx4 v29, s[24:27], s58 offen offset:3072 nt lds
    v_mfma_f32_16x16x32_bf16 v[76:79], a[64:67], v[152:155], v[76:79]
    s_waitcnt lgkmcnt(0)
    v_mfma_f32_16x16x32_bf16 v[120:123], v[52:55], v[156:159], v[120:123]
    v_mfma_f32_16x16x32_bf16 v[76:79], a[68:71], v[156:159], v[76:79]
    s_nop 6
    v_mul_f32 v61, 0x3baaaaab, v120
    v_mfma_f32_16x16x32_bf16 v[88:91], a[96:99], v[136:139], v[76:79]
    v_mov_b32 v9, 0
    v_mfma_f32_16x16x32_bf16 v[88:91], a[100:103], v[140:143], v[88:91]
    v_mfma_f32_16x16x32_bf16 v[88:91], a[104:107], v[144:147], v[88:91]
    v_mfma_f32_16x16x32_bf16 v[88:91], a[108:111], v[148:151], v[88:91]
    v_mfma_f32_16x16x32_bf16 v[88:91], a[112:115], v[152:155], v[88:91]
    v_mfma_f32_16x16x32_bf16 v[88:91], a[116:119], v[156:159], v[88:91]
    ds_write_b32 v254, v9 offset:4096
    ds_write_b32 v254, v9 offset:4100
    v_mfma_f32_16x16x32_bf16 v[104:107], a[120:123], v[136:139], v[76:79]
    v_mfma_f32_16x16x32_bf16 v[104:107], a[124:127], v[140:143], v[104:107]
    v_mfma_f32_16x16x32_bf16 v[104:107], a[128:131], v[144:147], v[104:107]
    v_mfma_f32_16x16x32_bf16 v[104:107], a[132:135], v[148:151], v[104:107]
    s_nop 1
    v_fma_f32 v88, -v92, v61, v88
    v_fma_f32 v89, -v93, v61, v89
    v_mfma_f32_16x16x32_bf16 v[104:107], a[136:139], v[152:155], v[104:107]
    s_add_u32 m0, s41, 8192
    s_nop 0
    buffer_load_dwordx4 v30, s[24:27], s58 offen offset:0 nt lds
    v_fma_f32 v90, -v94, v61, v90
    v_fma_f32 v91, -v95, v61, v91
    v_mfma_f32_16x16x32_bf16 v[104:107], a[140:143], v[156:159], v[104:107]
    v_mul_f32 v88, v88, v128
    v_mul_f32 v89, v89, v129
    v_mul_f32 v90, v90, v130
    v_mul_f32 v91, v91, v131
    v_max3_f32 v1, v88, v89, v90
    v_max_f32 v1, v1, v91
    s_nop 1
    v_fma_f32 v104, -v108, v61, v104
    v_fma_f32 v105, -v109, v61, v105
    v_fma_f32 v106, -v110, v61, v106
    v_fma_f32 v107, -v111, v61, v107
    v_mul_f32 v104, v104, v132
    v_mul_f32 v105, v105, v133
    v_mul_f32 v106, v106, v134
    v_mul_f32 v107, v107, v135
    v_max3_f32 v1, v1, v104, v105
    v_max3_f32 v1, v1, v106, v107
    v_mov_b32 v2, v1
    s_nop 1
    v_permlane32_swap_b32 v1, v2
    v_max_f32 v1, v1, v2
    v_mov_b32 v2, v1
    s_nop 1
    v_permlane16_swap_b32 v1, v2
    v_max_f32 v1, v1, v2
    ds_write_b32 v239, v1
    s_waitcnt lgkmcnt(0)
    s_barrier
    ds_read_b32 v12, v240 offset:0
    ds_read_b32 v13, v240 offset:1024
    ds_read_b32 v14, v240 offset:2048
    ds_read_b32 v15, v240 offset:3072
    buffer_load_dwordx4 v31, s[24:27], s58 offen offset:1024 nt lds
    s_waitcnt lgkmcnt(0)
    v_max3_f32 v1, v12, v13, v14
    v_max_f32 v1, v1, v15
    v_sub_f32 v88, v88, v1
    v_sub_f32 v89, v89, v1
    v_sub_f32 v90, v90, v1
    v_sub_f32 v91, v91, v1
    v_sub_f32 v104, v104, v1
    v_sub_f32 v105, v105, v1
    v_sub_f32 v106, v106, v1
    v_sub_f32 v107, v107, v1
    v_sub_f32 v62, 0, v1
    v_sub_f32 v255, 0, v1
    v_exp_f32 v96, v88
    v_exp_f32 v97, v89
    v_exp_f32 v98, v90
    v_exp_f32 v99, v91
    v_mul_f32 v88, v96, v128
    v_mul_f32 v89, v97, v129
    v_mul_f32 v90, v98, v130
    v_mul_f32 v91, v99, v131
    v_exp_f32 v112, v104
    v_exp_f32 v113, v105
    v_exp_f32 v114, v106
    v_exp_f32 v115, v107
    v_cvt_pk_bf16_f32 v72, v88, v89
    v_cvt_pk_bf16_f32 v73, v90, v91
    v_mul_f32 v104, v112, v132
    v_mul_f32 v105, v113, v133
    v_mul_f32 v106, v114, v134
    v_mul_f32 v107, v115, v135
    v_cvt_pk_bf16_f32 v74, v104, v105
    v_cvt_pk_bf16_f32 v75, v106, v107
    ds_write_b128 v237, v[72:75] offset:0
    v_mov_b32 v63, v96
    v_mul_f32 v64, v88, v92
    v_add_f32 v63, v63, v97
    v_fmac_f32 v64, v89, v93
    v_add_f32 v63, v63, v98
    v_fmac_f32 v64, v90, v94
    v_add_f32 v63, v63, v99
    v_fmac_f32 v64, v91, v95
    v_mov_b32 v68, v88
    v_mov_b32 v69, v89
    v_mov_b32 v70, v90
    v_mov_b32 v71, v91
    s_waitcnt lgkmcnt(0)
    s_barrier
    ds_read_b128 v[92:95], v253 offset:0
    ds_read_b128 v[96:99], v253 offset:1024
    ds_read_b128 v[100:103], v253 offset:2048
    ds_read_b128 v[116:119], v253 offset:3072
    s_waitcnt lgkmcnt(3)
    v_mfma_f32_16x16x32_bf16 a[0:3], a[144:147], v[92:95], 0
    buffer_load_dwordx4 v32, s[24:27], s58 offen offset:2048 nt lds
    v_add_f32 v68, v68, v104
    v_add_f32 v69, v69, v105
    v_mfma_f32_16x16x32_bf16 a[4:7], a[160:163], v[92:95], 0
    buffer_load_dwordx4 v33, s[24:27], s58 offen offset:3072 nt lds
    v_add_f32 v70, v70, v106
    v_add_f32 v71, v71, v107
    v_mfma_f32_16x16x32_bf16 a[8:11], a[176:179], v[92:95], 0
    v_add_f32 v63, v63, v112
    v_fma_f32 v64, v104, v108, v64
    s_waitcnt lgkmcnt(2)
    v_mfma_f32_16x16x32_bf16 a[0:3], a[148:151], v[96:99], a[0:3]
    v_add_f32 v63, v63, v113
    v_fma_f32 v64, v105, v109, v64
    v_mfma_f32_16x16x32_bf16 a[4:7], a[164:167], v[96:99], a[4:7]
    v_add_f32 v63, v63, v114
    v_fma_f32 v64, v106, v110, v64
    v_mfma_f32_16x16x32_bf16 a[8:11], a[180:183], v[96:99], a[8:11]
    v_add_f32 v63, v63, v115
    v_fma_f32 v64, v107, v111, v64
    s_waitcnt lgkmcnt(1)
    v_mfma_f32_16x16x32_bf16 a[0:3], a[152:155], v[100:103], a[0:3]
    v_mfma_f32_16x16x32_bf16 a[4:7], a[168:171], v[100:103], a[4:7]
    v_mfma_f32_16x16x32_bf16 a[8:11], a[184:187], v[100:103], a[8:11]
    s_waitcnt lgkmcnt(0)
    v_mfma_f32_16x16x32_bf16 a[0:3], a[156:159], v[116:119], a[0:3]
    v_mfma_f32_16x16x32_bf16 a[4:7], a[172:175], v[116:119], a[4:7]
    v_mfma_f32_16x16x32_bf16 a[8:11], a[188:191], v[116:119], a[8:11]
    s_barrier
    ds_read_b128 a[96:99], v40 offset:49152
    ds_read_b128 a[100:103], v41 offset:49152
    ds_read_b128 a[104:107], v42 offset:49152
    ds_read_b128 a[108:111], v43 offset:49152
    ds_read_b128 a[112:115], v40 offset:49408
    ds_read_b128 a[116:119], v41 offset:49408
    ds_read_b128 a[120:123], v42 offset:49408
    ds_read_b128 a[124:127], v43 offset:49408
    ds_read_b128 a[128:131], v40 offset:49664
    ds_read_b128 a[132:135], v41 offset:49664
    ds_read_b128 a[136:139], v42 offset:49664
    ds_read_b128 a[140:143], v43 offset:49664
    s_waitcnt lgkmcnt(11)
    v_mfma_f32_16x16x32_bf16 v[96:99], a[96:99], a[96:99], v[84:87]
    ds_read_b64_tr_b16 a[144:145], v44 offset:0
    ds_read_b64_tr_b16 a[146:147], v45 offset:0
    v_mfma_f32_16x16x32_bf16 v[100:103], a[96:99], a[48:51], 0
    ds_read_b64_tr_b16 a[148:149], v44 offset:12288
    ds_read_b64_tr_b16 a[150:151], v45 offset:12288
    s_waitcnt lgkmcnt(14)
    v_mfma_f32_16x16x32_bf16 v[96:99], a[100:103], a[100:103], v[96:99]
    ds_read_b64_tr_b16 a[152:153], v44 offset:24576
    ds_read_b64_tr_b16 a[154:155], v45 offset:24576
    v_mfma_f32_16x16x32_bf16 v[100:103], a[100:103], a[52:55], v[100:103]
    ds_read_b64_tr_b16 a[156:157], v44 offset:36864
    ds_read_b64_tr_b16 a[158:159], v45 offset:36864
    s_waitcnt lgkmcnt(15)
    v_mfma_f32_16x16x32_bf16 v[96:99], a[104:107], a[104:107], v[96:99]
    ds_read_b64_tr_b16 a[160:161], v46 offset:0
    ds_read_b64_tr_b16 a[162:163], v47 offset:0
    v_mfma_f32_16x16x32_bf16 v[100:103], a[104:107], a[56:59], v[100:103]
    ds_read_b64_tr_b16 a[164:165], v46 offset:12288
    ds_read_b64_tr_b16 a[166:167], v47 offset:12288
    v_mfma_f32_16x16x32_bf16 v[96:99], a[108:111], a[108:111], v[96:99]
    ds_read_b64_tr_b16 a[168:169], v46 offset:24576
    ds_read_b64_tr_b16 a[170:171], v47 offset:24576
    v_mfma_f32_16x16x32_bf16 v[100:103], a[108:111], a[60:63], v[100:103]
    ds_read_b64_tr_b16 a[172:173], v46 offset:36864
    ds_read_b64_tr_b16 a[174:175], v47 offset:36864
    v_mfma_f32_16x16x32_bf16 v[96:99], a[112:115], a[112:115], v[96:99]
    ds_read_b64_tr_b16 a[176:177], v48 offset:0
    ds_read_b64_tr_b16 a[178:179], v49 offset:0
    v_mfma_f32_16x16x32_bf16 v[100:103], a[112:115], a[64:67], v[100:103]
    ds_read_b64_tr_b16 a[180:181], v48 offset:12288
    ds_read_b64_tr_b16 a[182:183], v49 offset:12288
    s_waitcnt lgkmcnt(15)
    v_mfma_f32_16x16x32_bf16 v[96:99], a[116:119], a[116:119], v[96:99]
    ds_read_b64_tr_b16 a[184:185], v48 offset:24576
    ds_read_b64_tr_b16 a[186:187], v49 offset:24576
    v_mfma_f32_16x16x32_bf16 v[100:103], a[116:119], a[68:71], v[100:103]
    ds_read_b64_tr_b16 a[188:189], v48 offset:36864
    ds_read_b64_tr_b16 a[190:191], v49 offset:36864
    v_mfma_f32_16x16x32_bf16 v[92:95], a[96:99], v[52:55], v[80:83]
    v_mfma_f32_16x16x32_bf16 v[92:95], a[100:103], v[52:55], v[92:95]
    v_mfma_f32_16x16x32_bf16 v[92:95], a[104:107], v[52:55], v[92:95]
    v_mfma_f32_16x16x32_bf16 v[92:95], a[108:111], v[52:55], v[92:95]
    s_nop 1
    v_fma_f32 v96, v100, 2.0, v96
    v_fma_f32 v97, v101, 2.0, v97
    v_mfma_f32_16x16x32_bf16 v[92:95], a[112:115], v[52:55], v[92:95]
    v_fma_f32 v98, v102, 2.0, v98
    v_fma_f32 v99, v103, 2.0, v99
    v_mfma_f32_16x16x32_bf16 v[92:95], a[116:119], v[52:55], v[92:95]
    v_cndmask_b32 v3, 0, v96, s[44:45]
    v_cndmask_b32 v3, v3, v97, s[46:47]
    v_mfma_f32_16x16x32_bf16 v[88:91], a[96:99], v[136:139], v[76:79]
    v_cndmask_b32 v3, v3, v98, s[48:49]
    v_cndmask_b32 v3, v3, v99, s[50:51]
    v_mfma_f32_16x16x32_bf16 v[88:91], a[100:103], v[140:143], v[88:91]
    s_nop 0
    s_nop 0
    v_mfma_f32_16x16x32_bf16 v[88:91], a[104:107], v[144:147], v[88:91]
    v_mfma_f32_16x16x4_f32 v[120:123], v3, v60, v[56:59]
    v_mfma_f32_16x16x32_bf16 v[88:91], a[108:111], v[148:151], v[88:91]
    v_mfma_f32_16x16x32_bf16 v[88:91], a[112:115], v[152:155], v[88:91]
    v_mfma_f32_16x16x32_bf16 v[88:91], a[116:119], v[156:159], v[88:91]
    s_waitcnt lgkmcnt(0)
    s_barrier
    v_mfma_f32_16x16x32_bf16 v[112:115], a[120:123], a[120:123], v[84:87]
    s_add_u32 m0, s42, 0
    s_add_u32 s59, s37, 245760
    buffer_load_dwordx4 v22, s[24:27], s59 offen offset:0 nt lds
    v_mfma_f32_16x16x32_bf16 v[116:119], a[120:123], a[48:51], 0
    buffer_load_dwordx4 v23, s[24:27], s59 offen offset:1024 nt lds
    v_mfma_f32_16x16x32_bf16 v[112:115], a[124:127], a[124:127], v[112:115]
    buffer_load_dwordx4 v24, s[24:27], s59 offen offset:2048 nt lds
    v_mfma_f32_16x16x32_bf16 v[116:119], a[124:127], a[52:55], v[116:119]
    buffer_load_dwordx4 v25, s[24:27], s59 offen offset:3072 nt lds
    v_fma_f32 v128, -v92, v92, v120
    v_fma_f32 v129, -v93, v93, v121
    v_mfma_f32_16x16x32_bf16 v[112:115], a[128:131], a[128:131], v[112:115]
    v_fma_f32 v130, -v94, v94, v122
    v_fma_f32 v131, -v95, v95, v123
    v_mfma_f32_16x16x32_bf16 v[116:119], a[128:131], a[56:59], v[116:119]
    v_max_f32 v128, v128, v56
    v_max_f32 v129, v129, v56
    v_mfma_f32_16x16x32_bf16 v[112:115], a[132:135], a[132:135], v[112:115]
    v_max_f32 v130, v130, v56
    v_max_f32 v131, v131, v56
    v_mfma_f32_16x16x32_bf16 v[116:119], a[132:135], a[60:63], v[116:119]
    s_add_u32 m0, s42, 4096
    s_nop 0
    buffer_load_dwordx4 v26, s[24:27], s59 offen offset:0 nt lds
    v_rsq_f32 v128, v128
    v_mfma_f32_16x16x32_bf16 v[112:115], a[136:139], a[136:139], v[112:115]
    v_rsq_f32 v129, v129
    v_mfma_f32_16x16x32_bf16 v[116:119], a[136:139], a[64:67], v[116:119]
    v_rsq_f32 v130, v130
    v_mfma_f32_16x16x32_bf16 v[112:115], a[140:143], a[140:143], v[112:115]
    v_rsq_f32 v131, v131
    v_mfma_f32_16x16x32_bf16 v[116:119], a[140:143], a[68:71], v[116:119]
    v_fma_f32 v88, -v92, v61, v88
    v_fma_f32 v89, -v93, v61, v89
    v_mfma_f32_16x16x32_bf16 v[108:111], a[120:123], v[52:55], v[80:83]
    v_fma_f32 v90, -v94, v61, v90
    v_fma_f32 v91, -v95, v61, v91
    v_mfma_f32_16x16x32_bf16 v[108:111], a[124:127], v[52:55], v[108:111]
    v_fma_f32 v88, v88, v128, v62
    v_fma_f32 v89, v89, v129, v62
    v_mfma_f32_16x16x32_bf16 v[108:111], a[128:131], v[52:55], v[108:111]
    v_fma_f32 v90, v90, v130, v62
    v_fma_f32 v91, v91, v131, v62
    v_mfma_f32_16x16x32_bf16 v[108:111], a[132:135], v[52:55], v[108:111]
    v_max3_f32 v1, v88, v89, v90
    v_max_f32 v1, v1, v91
    v_mfma_f32_16x16x32_bf16 v[108:111], a[136:139], v[52:55], v[108:111]
    v_cmp_lt_f32 vcc, s52, v1
    s_cbranch_vccnz L_site0
L_back0:
    v_mfma_f32_16x16x32_bf16 v[108:111], a[140:143], v[52:55], v[108:111]
    v_exp_f32 v96, v88
    v_mfma_f32_16x16x32_bf16 v[104:107], a[120:123], v[136:139], v[76:79]
    v_exp_f32 v97, v89
    v_mfma_f32_16x16x32_bf16 v[104:107], a[124:127], v[140:143], v[104:107]
    v_exp_f32 v98, v90
    v_mfma_f32_16x16x32_bf16 v[104:107], a[128:131], v[144:147], v[104:107]
    buffer_load_dwordx4 v27, s[24:27], s59 offen offset:1024 nt lds
    v_exp_f32 v99, v91
    v_mfma_f32_16x16x32_bf16 v[104:107], a[132:135], v[148:151], v[104:107]
    v_mul_f32 v88, v96, v128
    v_mul_f32 v89, v97, v129
    v_mfma_f32_16x16x32_bf16 v[104:107], a[136:139], v[152:155], v[104:107]
    v_mul_f32 v90, v98, v130
    v_mul_f32 v91, v99, v131
    v_mfma_f32_16x16x32_bf16 v[104:107], a[140:143], v[156:159], v[104:107]
    v_fma_f32 v112, v116, 2.0, v112
    v_fma_f32 v113, v117, 2.0, v113
    v_fma_f32 v114, v118, 2.0, v114
    v_fma_f32 v115, v119, 2.0, v115
    v_cndmask_b32 v4, 0, v112, s[44:45]
    v_cndmask_b32 v4, v4, v113, s[46:47]
    v_cndmask_b32 v4, v4, v114, s[48:49]
    v_cndmask_b32 v4, v4, v115, s[50:51]
    v_add_f32 v63, v63, v96
    v_fmac_f32 v64, v88, v92
    v_mfma_f32_16x16x4_f32 v[124:127], v4, v60, v[56:59]
    v_add_f32 v63, v63, v97
    v_fmac_f32 v64, v89, v93
    v_add_f32 v63, v63, v98
    v_fmac_f32 v64, v90, v94
    v_add_f32 v63, v63, v99
    v_fmac_f32 v64, v91, v95
    v_add_f32 v68, v68, v88
    v_add_f32 v69, v69, v89
    v_add_f32 v70, v70, v90
    v_add_f32 v71, v71, v91
    v_add_u32 v44, -49152, v44
    v_add_u32 v45, -49152, v45
    v_add_u32 v46, -49152, v46
    v_add_u32 v47, -49152, v47
    v_add_u32 v48, -49152, v48
    v_add_u32 v49, -49152, v49
    v_fma_f32 v132, -v108, v108, v124
    v_fma_f32 v133, -v109, v109, v125
    v_fma_f32 v134, -v110, v110, v126
    v_fma_f32 v135, -v111, v111, v127
    v_max_f32 v132, v132, v56
    v_max_f32 v133, v133, v56
    v_max_f32 v134, v134, v56
    v_max_f32 v135, v135, v56
    v_rsq_f32 v132, v132
    v_rsq_f32 v133, v133
    v_rsq_f32 v134, v134
    v_rsq_f32 v135, v135
    buffer_load_dwordx4 v28, s[24:27], s59 offen offset:2048 nt lds
    v_fma_f32 v104, -v108, v61, v104
    v_fma_f32 v105, -v109, v61, v105
    v_fma_f32 v106, -v110, v61, v106
    v_fma_f32 v107, -v111, v61, v107
    v_fma_f32 v104, v104, v132, v62
    v_fma_f32 v105, v105, v133, v62
    v_fma_f32 v106, v106, v134, v62
    v_fma_f32 v107, v107, v135, v62
    v_max3_f32 v1, v104, v105, v106
    v_max_f32 v1, v1, v107
    v_cmp_lt_f32 vcc, s52, v1
    s_cbranch_vccnz L_site1
L_back1:
    v_exp_f32 v112, v104
    v_exp_f32 v113, v105
    v_exp_f32 v114, v106
    v_exp_f32 v115, v107
    v_cvt_pk_bf16_f32 v72, v88, v89
    v_cvt_pk_bf16_f32 v73, v90, v91
    v_mul_f32 v104, v112, v132
    v_mul_f32 v105, v113, v133
    v_mul_f32 v106, v114, v134
    v_mul_f32 v107, v115, v135
    v_cvt_pk_bf16_f32 v74, v104, v105
    v_cvt_pk_bf16_f32 v75, v106, v107
    ds_write_b128 v237, v[72:75] offset:0
    v_add_f32 v68, v68, v104
    v_add_f32 v69, v69, v105
    v_add_f32 v70, v70, v106
    v_add_f32 v71, v71, v107
    v_cvt_pk_bf16_f32 v66, v68, v69
    v_cvt_pk_bf16_f32 v67, v70, v71
    ds_write_b64 v238, v[66:67]
    buffer_load_dwordx4 v29, s[24:27], s59 offen offset:3072 nt lds
    s_waitcnt vmcnt(20)
    s_waitcnt lgkmcnt(0)
    s_barrier
L_post3:
    ds_read_b32 v9, v254 offset:4096
    ds_read_b64 v[120:121], v254 offset:0
    ds_read_b64 v[122:123], v254 offset:512
    ds_read_b64 v[124:125], v254 offset:1024
    ds_read_b64 v[126:127], v254 offset:1536
    ds_read_b128 v[92:95], v253 offset:0
    ds_read_b128 v[96:99], v253 offset:1024
    ds_read_b128 v[100:103], v253 offset:2048
    ds_read_b128 v[116:119], v253 offset:3072
    ds_read_b128 a[48:51], v34 offset:0
    ds_read_b128 a[52:55], v35 offset:0
    ds_read_b128 a[56:59], v34 offset:128
    ds_read_b128 a[60:63], v35 offset:128
    ds_read_b128 a[64:67], v34 offset:256
    ds_read_b128 a[68:71], v35 offset:256
    s_waitcnt lgkmcnt(14)
    v_cmp_ne_u32 vcc, 0, v9
    s_cbranch_vccnz L_xt3
    s_waitcnt lgkmcnt(12)
    v_mfma_f32_16x16x32_bf16 a[0:3], a[72:75], v[120:123], a[0:3]
    v_add_f32 v63, v63, v112
    v_fma_f32 v64, v104, v108, v64
    v_mfma_f32_16x16x32_bf16 a[4:7], a[80:83], v[120:123], a[4:7]
    v_add_f32 v63, v63, v113
    v_fma_f32 v64, v105, v109, v64
    v_mfma_f32_16x16x32_bf16 a[8:11], a[88:91], v[120:123], a[8:11]
    s_add_u32 m0, s42, 8192
    s_nop 0
    buffer_load_dwordx4 v30, s[24:27], s59 offen offset:0 nt lds
    v_add_f32 v63, v63, v114
    v_fma_f32 v64, v106, v110, v64
    s_waitcnt lgkmcnt(10)
    v_mfma_f32_16x16x32_bf16 a[0:3], a[76:79], v[124:127], a[0:3]
    v_add_f32 v63, v63, v115
    v_fma_f32 v64, v107, v111, v64
    v_mfma_f32_16x16x32_bf16 a[4:7], a[84:87], v[124:127], a[4:7]
    v_mfma_f32_16x16x32_bf16 a[8:11], a[92:95], v[124:127], a[8:11]
    s_waitcnt lgkmcnt(9)
    v_mfma_f32_16x16x32_bf16 a[0:3], a[144:147], v[92:95], a[0:3]
    ds_read_b64_tr_b16 a[72:73], v36 offset:0
    ds_read_b64_tr_b16 a[74:75], v36 offset:6144
    v_mfma_f32_16x16x32_bf16 a[4:7], a[160:163], v[92:95], a[4:7]
    ds_read_b64_tr_b16 a[76:77], v36 offset:12288
    ds_read_b64_tr_b16 a[78:79], v36 offset:18432
    v_mfma_f32_16x16x32_bf16 a[8:11], a[176:179], v[92:95], a[8:11]
    ds_read_b64_tr_b16 a[80:81], v37 offset:0
    ds_read_b64_tr_b16 a[82:83], v37 offset:6144
    s_waitcnt lgkmcnt(14)
    v_mfma_f32_16x16x32_bf16 a[0:3], a[148:151], v[96:99], a[0:3]
    ds_read_b64_tr_b16 a[84:85], v37 offset:12288
    ds_read_b64_tr_b16 a[86:87], v37 offset:18432
    v_mfma_f32_16x16x32_bf16 a[4:7], a[164:167], v[96:99], a[4:7]
    ds_read_b64_tr_b16 a[88:89], v38 offset:0
    ds_read_b64_tr_b16 a[90:91], v38 offset:6144
    v_mfma_f32_16x16x32_bf16 a[8:11], a[180:183], v[96:99], a[8:11]
    ds_read_b64_tr_b16 a[92:93], v38 offset:12288
    ds_read_b64_tr_b16 a[94:95], v38 offset:18432
    s_waitcnt lgkmcnt(15)
    v_mfma_f32_16x16x32_bf16 a[0:3], a[152:155], v[100:103], a[0:3]
    buffer_load_dwordx4 v31, s[24:27], s59 offen offset:1024 nt lds
    v_mfma_f32_16x16x32_bf16 a[4:7], a[168:171], v[100:103], a[4:7]
    v_mfma_f32_16x16x32_bf16 a[8:11], a[184:187], v[100:103], a[8:11]
    v_mfma_f32_16x16x32_bf16 a[0:3], a[156:159], v[116:119], a[0:3]
    v_mfma_f32_16x16x32_bf16 a[4:7], a[172:175], v[116:119], a[4:7]
    v_mfma_f32_16x16x32_bf16 a[8:11], a[188:191], v[116:119], a[8:11]
    v_mfma_f32_16x16x32_bf16 v[84:87], a[48:51], a[48:51], 0
    v_mfma_f32_16x16x32_bf16 v[80:83], a[48:51], v[52:55], 0
    v_mfma_f32_16x16x32_bf16 v[84:87], a[52:55], a[52:55], v[84:87]
    v_mfma_f32_16x16x32_bf16 v[80:83], a[52:55], v[52:55], v[80:83]
    v_mfma_f32_16x16x32_bf16 v[84:87], a[56:59], a[56:59], v[84:87]
    v_mfma_f32_16x16x32_bf16 v[80:83], a[56:59], v[52:55], v[80:83]
    s_waitcnt lgkmcnt(14)
    v_mfma_f32_16x16x32_bf16 v[84:87], a[60:63], a[60:63], v[84:87]
    v_mfma_f32_16x16x32_bf16 v[80:83], a[60:63], v[52:55], v[80:83]
    s_waitcnt lgkmcnt(13)
    v_mfma_f32_16x16x32_bf16 v[84:87], a[64:67], a[64:67], v[84:87]
    buffer_load_dwordx4 v32, s[24:27], s59 offen offset:2048 nt lds
    v_mfma_f32_16x16x32_bf16 v[80:83], a[64:67], v[52:55], v[80:83]
    s_waitcnt lgkmcnt(12)
    v_mfma_f32_16x16x32_bf16 v[84:87], a[68:71], a[68:71], v[84:87]
    v_mfma_f32_16x16x32_bf16 v[80:83], a[68:71], v[52:55], v[80:83]
    s_waitcnt lgkmcnt(0)
    v_mfma_f32_16x16x32_bf16 v[76:79], a[48:51], v[136:139], 0
    v_mfma_f32_16x16x32_bf16 v[76:79], a[52:55], v[140:143], v[76:79]
    v_mfma_f32_16x16x32_bf16 v[76:79], a[56:59], v[144:147], v[76:79]
    v_mfma_f32_16x16x32_bf16 v[76:79], a[60:63], v[148:151], v[76:79]
    v_mfma_f32_16x16x32_bf16 v[76:79], a[64:67], v[152:155], v[76:79]
    v_mfma_f32_16x16x32_bf16 v[76:79], a[68:71], v[156:159], v[76:79]
    v_lshrrev_b32 v1, 3, v0
    v_and_b32 v2, 6, v1
    v_xor_b32 v2, v0, v2
    v_and_b32 v2, 7, v2
    v_mul_u32_u24 v1, 768, v1
    v_lshl_add_u32 v224, v2, 4, v1
    v_xor_b32 v225, 16, v224
    v_add_u32 v225, 5120, v225
    buffer_load_dwordx4 v33, s[24:27], s59 offen offset:3072 nt lds
    s_waitcnt vmcnt(12)
    s_barrier
    ds_read_b128 a[96:99], v40 offset:0
    ds_read_b128 a[100:103], v41 offset:0
    ds_read_b128 a[104:107], v42 offset:0
    ds_read_b128 a[108:111], v43 offset:0
    ds_read_b128 a[112:115], v40 offset:256
    ds_read_b128 a[116:119], v41 offset:256
    ds_read_b128 a[120:123], v42 offset:256
    ds_read_b128 a[124:127], v43 offset:256
    ds_read_b128 a[128:131], v40 offset:512
    ds_read_b128 a[132:135], v41 offset:512
    ds_read_b128 a[136:139], v42 offset:512
    ds_read_b128 a[140:143], v43 offset:512
    s_waitcnt lgkmcnt(11)
    v_mfma_f32_16x16x32_bf16 v[96:99], a[96:99], a[96:99], v[84:87]
    ds_read_b64_tr_b16 a[144:145], v44 offset:0
    ds_read_b64_tr_b16 a[146:147], v45 offset:0
    v_mfma_f32_16x16x32_bf16 v[100:103], a[96:99], a[48:51], 0
    ds_read_b64_tr_b16 a[148:149], v44 offset:12288
    ds_read_b64_tr_b16 a[150:151], v45 offset:12288
    s_waitcnt lgkmcnt(14)
    v_mfma_f32_16x16x32_bf16 v[96:99], a[100:103], a[100:103], v[96:99]
    ds_read_b64_tr_b16 a[152:153], v44 offset:24576
    ds_read_b64_tr_b16 a[154:155], v45 offset:24576
    v_mfma_f32_16x16x32_bf16 v[100:103], a[100:103], a[52:55], v[100:103]
    ds_read_b64_tr_b16 a[156:157], v44 offset:36864
    ds_read_b64_tr_b16 a[158:159], v45 offset:36864
    s_waitcnt lgkmcnt(15)
    v_mfma_f32_16x16x32_bf16 v[96:99], a[104:107], a[104:107], v[96:99]
    ds_read_b64_tr_b16 a[160:161], v46 offset:0
    ds_read_b64_tr_b16 a[162:163], v47 offset:0
    v_mfma_f32_16x16x32_bf16 v[100:103], a[104:107], a[56:59], v[100:103]
    s_add_u32 m0, s40, 0
    s_add_u32 s57, s36, 49152
    buffer_load_dwordx4 v16, s[28:31], s57 offen offset:0 nt lds
    ds_read_b64_tr_b16 a[164:165], v46 offset:12288
    ds_read_b64_tr_b16 a[166:167], v47 offset:12288
    v_mfma_f32_16x16x32_bf16 v[96:99], a[108:111], a[108:111], v[96:99]
    ds_read_b64_tr_b16 a[168:169], v46 offset:24576
    ds_read_b64_tr_b16 a[170:171], v47 offset:24576
    v_mfma_f32_16x16x32_bf16 v[100:103], a[108:111], a[60:63], v[100:103]
    ds_read_b64_tr_b16 a[172:173], v46 offset:36864
    ds_read_b64_tr_b16 a[174:175], v47 offset:36864
    v_mfma_f32_16x16x32_bf16 v[96:99], a[112:115], a[112:115], v[96:99]
    ds_read_b64_tr_b16 a[176:177], v48 offset:0
    ds_read_b64_tr_b16 a[178:179], v49 offset:0
    v_mfma_f32_16x16x32_bf16 v[100:103], a[112:115], a[64:67], v[100:103]
    ds_read_b64_tr_b16 a[180:181], v48 offset:12288
    ds_read_b64_tr_b16 a[182:183], v49 offset:12288
    s_waitcnt lgkmcnt(15)
    v_mfma_f32_16x16x32_bf16 v[96:99], a[116:119], a[116:119], v[96:99]
    ds_read_b64_tr_b16 a[184:185], v48 offset:24576
    ds_read_b64_tr_b16 a[186:187], v49 offset:24576
    v_mfma_f32_16x16x32_bf16 v[100:103], a[116:119], a[68:71], v[100:103]
    ds_read_b64_tr_b16 a[188:189], v48 offset:36864
    ds_read_b64_tr_b16 a[190:191], v49 offset:36864
    v_mfma_f32_16x16x32_bf16 v[92:95], a[96:99], v[52:55], v[80:83]
    v_mfma_f32_16x16x32_bf16 v[92:95], a[100:103], v[52:55], v[92:95]
    v_mfma_f32_16x16x32_bf16 v[92:95], a[104:107], v[52:55], v[92:95]
    v_mfma_f32_16x16x32_bf16 v[92:95], a[108:111], v[52:55], v[92:95]
    s_nop 1
    v_fma_f32 v96, v100, 2.0, v96
    v_fma_f32 v97, v101, 2.0, v97
    v_mfma_f32_16x16x32_bf16 v[92:95], a[112:115], v[52:55], v[92:95]
    buffer_load_dwordx4 v17, s[28:31], s57 offen offset:1024 nt lds
    v_fma_f32 v98, v102, 2.0, v98
    v_fma_f32 v99, v103, 2.0, v99
    v_mfma_f32_16x16x32_bf16 v[92:95], a[116:119], v[52:55], v[92:95]
    v_cndmask_b32 v3, 0, v96, s[44:45]
    v_cndmask_b32 v3, v3, v97, s[46:47]
    v_mfma_f32_16x16x32_bf16 v[88:91], a[96:99], v[136:139], v[76:79]
    v_cndmask_b32 v3, v3, v98, s[48:49]
    v_cndmask_b32 v3, v3, v99, s[50:51]
    v_mfma_f32_16x16x32_bf16 v[88:91], a[100:103], v[140:143], v[88:91]
    s_nop 0
    s_nop 0
    v_mfma_f32_16x16x32_bf16 v[88:91], a[104:107], v[144:147], v[88:91]
    v_mfma_f32_16x16x4_f32 v[120:123], v3, v60, v[56:59]
    v_mfma_f32_16x16x32_bf16 v[88:91], a[108:111], v[148:151], v[88:91]
    v_mfma_f32_16x16x32_bf16 v[88:91], a[112:115], v[152:155], v[88:91]
    v_mfma_f32_16x16x32_bf16 v[88:91], a[116:119], v[156:159], v[88:91]
    v_mfma_f32_16x16x32_bf16 v[112:115], a[120:123], a[120:123], v[84:87]
    v_mfma_f32_16x16x32_bf16 v[116:119], a[120:123], a[48:51], 0
    v_mfma_f32_16x16x32_bf16 v[112:115], a[124:127], a[124:127], v[112:115]
    v_mfma_f32_16x16x32_bf16 v[116:119], a[124:127], a[52:55], v[116:119]
    buffer_load_dwordx4 v18, s[28:31], s57 offen offset:2048 nt lds
    s_nop 1
    v_fma_f32 v128, -v92, v92, v120
    v_fma_f32 v129, -v93, v93, v121
    v_mfma_f32_16x16x32_bf16 v[112:115], a[128:131], a[128:131], v[112:115]
    v_fma_f32 v130, -v94, v94, v122
    v_fma_f32 v131, -v95, v95, v123
    v_mfma_f32_16x16x32_bf16 v[116:119], a[128:131], a[56:59], v[116:119]
    v_max_f32 v128, v128, v56
    v_max_f32 v129, v129, v56
    v_mfma_f32_16x16x32_bf16 v[112:115], a[132:135], a[132:135], v[112:115]
    v_max_f32 v130, v130, v56
    v_max_f32 v131, v131, v56
    v_mfma_f32_16x16x32_bf16 v[116:119], a[132:135], a[60:63], v[116:119]
    v_rsq_f32 v128, v128
    v_mfma_f32_16x16x32_bf16 v[112:115], a[136:139], a[136:139], v[112:115]
    v_rsq_f32 v129, v129
    v_mfma_f32_16x16x32_bf16 v[116:119], a[136:139], a[64:67], v[116:119]
    v_rsq_f32 v130, v130
    v_mfma_f32_16x16x32_bf16 v[112:115], a[140:143], a[140:143], v[112:115]
    v_rsq_f32 v131, v131
    v_mfma_f32_16x16x32_bf16 v[116:119], a[140:143], a[68:71], v[116:119]
    v_fma_f32 v88, -v92, v61, v88
    v_fma_f32 v89, -v93, v61, v89
    v_mfma_f32_16x16x32_bf16 v[108:111], a[120:123], v[52:55], v[80:83]
    v_fma_f32 v90, -v94, v61, v90
    v_fma_f32 v91, -v95, v61, v91
    v_mfma_f32_16x16x32_bf16 v[108:111], a[124:127], v[52:55], v[108:111]
    v_fma_f32 v88, v88, v128, v62
    v_fma_f32 v89, v89, v129, v62
    v_mfma_f32_16x16x32_bf16 v[108:111], a[128:131], v[52:55], v[108:111]
    v_fma_f32 v90, v90, v130, v62
    v_fma_f32 v91, v91, v131, v62
    v_mfma_f32_16x16x32_bf16 v[108:111], a[132:135], v[52:55], v[108:111]
    v_max3_f32 v1, v88, v89, v90
    v_max_f32 v1, v1, v91
    v_mfma_f32_16x16x32_bf16 v[108:111], a[136:139], v[52:55], v[108:111]
    buffer_load_dwordx4 v19, s[28:31], s57 offen offset:3072 nt lds
    v_cmp_lt_f32 vcc, s52, v1
    s_cbranch_vccnz L_site2
L_back2:
    v_mfma_f32_16x16x32_bf16 v[108:111], a[140:143], v[52:55], v[108:111]
    v_exp_f32 v96, v88
    v_mfma_f32_16x16x32_bf16 v[104:107], a[120:123], v[136:139], v[76:79]
    v_exp_f32 v97, v89
    v_mfma_f32_16x16x32_bf16 v[104:107], a[124:127], v[140:143], v[104:107]
    v_exp_f32 v98, v90
    v_mfma_f32_16x16x32_bf16 v[104:107], a[128:131], v[144:147], v[104:107]
    v_exp_f32 v99, v91
    v_mfma_f32_16x16x32_bf16 v[104:107], a[132:135], v[148:151], v[104:107]
    v_mul_f32 v88, v96, v128
    v_mul_f32 v89, v97, v129
    v_mfma_f32_16x16x32_bf16 v[104:107], a[136:139], v[152:155], v[104:107]
    v_mul_f32 v90, v98, v130
    v_mul_f32 v91, v99, v131
    v_mfma_f32_16x16x32_bf16 v[104:107], a[140:143], v[156:159], v[104:107]
    v_fma_f32 v112, v116, 2.0, v112
    v_fma_f32 v113, v117, 2.0, v113
    v_fma_f32 v114, v118, 2.0, v114
    v_fma_f32 v115, v119, 2.0, v115
    v_cndmask_b32 v4, 0, v112, s[44:45]
    v_cndmask_b32 v4, v4, v113, s[46:47]
    v_cndmask_b32 v4, v4, v114, s[48:49]
    v_cndmask_b32 v4, v4, v115, s[50:51]
    v_add_f32 v63, v63, v96
    v_fmac_f32 v64, v88, v92
    v_mfma_f32_16x16x4_f32 v[124:127], v4, v60, v[56:59]
    v_add_f32 v63, v63, v97
    v_fmac_f32 v64, v89, v93
    v_add_f32 v63, v63, v98
    v_fmac_f32 v64, v90, v94
    v_add_f32 v63, v63, v99
    v_fmac_f32 v64, v91, v95
    v_mov_b32 v68, v88
    v_mov_b32 v69, v89
    v_mov_b32 v70, v90
    v_mov_b32 v71, v91
    v_add_u32 v44, 49152, v44
    v_add_u32 v45, 49152, v45
    v_add_u32 v46, 49152, v46
    v_add_u32 v47, 49152, v47
    v_add_u32 v48, 49152, v48
    v_add_u32 v49, 49152, v49
    v_fma_f32 v132, -v108, v108, v124
    v_fma_f32 v133, -v109, v109, v125
    v_fma_f32 v134, -v110, v110, v126
    v_fma_f32 v135, -v111, v111, v127
    v_max_f32 v132, v132, v56
    v_max_f32 v133, v133, v56
    v_max_f32 v134, v134, v56
    v_max_f32 v135, v135, v56
    v_rsq_f32 v132, v132
    v_rsq_f32 v133, v133
    v_rsq_f32 v134, v134
    v_rsq_f32 v135, v135
    s_add_u32 m0, s40, 4096
    s_nop 0
    buffer_load_dwordx4 v20, s[28:31], s57 offen offset:0 nt lds
    v_fma_f32 v104, -v108, v61, v104
    v_fma_f32 v105, -v109, v61, v105
    v_fma_f32 v106, -v110, v61, v106
    v_fma_f32 v107, -v111, v61, v107
    v_fma_f32 v104, v104, v132, v62
    v_fma_f32 v105, v105, v133, v62
    v_fma_f32 v106, v106, v134, v62
    v_fma_f32 v107, v107, v135, v62
    v_max3_f32 v1, v104, v105, v106
    v_max_f32 v1, v1, v107
    v_cmp_lt_f32 vcc, s52, v1
    s_cbranch_vccnz L_site3
L_back3:
    v_exp_f32 v112, v104
    v_exp_f32 v113, v105
    v_exp_f32 v114, v106
    v_exp_f32 v115, v107
    v_cvt_pk_bf16_f32 v72, v88, v89
    v_cvt_pk_bf16_f32 v73, v90, v91
    v_mul_f32 v104, v112, v132
    v_mul_f32 v105, v113, v133
    v_mul_f32 v106, v114, v134
    v_mul_f32 v107, v115, v135
    v_cvt_pk_bf16_f32 v74, v104, v105
    v_cvt_pk_bf16_f32 v75, v106, v107
    ds_write_b128 v237, v[72:75] offset:0
    s_waitcnt lgkmcnt(0)
    s_barrier
L_post24:
    ds_read_b32 v9, v254 offset:4096
    ds_read_b128 v[92:95], v253 offset:0
    ds_read_b128 v[96:99], v253 offset:1024
    ds_read_b128 v[100:103], v253 offset:2048
    ds_read_b128 v[116:119], v253 offset:3072
    s_waitcnt lgkmcnt(4)
    v_cmp_ne_u32 vcc, 0, v9
    s_cbranch_vccnz L_xt24
    s_waitcnt lgkmcnt(3)
    v_mfma_f32_16x16x32_bf16 a[0:3], a[144:147], v[92:95], a[0:3]
    buffer_load_dwordx4 v21, s[28:31], s57 offen offset:1024 nt lds
    v_add_f32 v68, v68, v104
    v_add_f32 v69, v69, v105
    v_mfma_f32_16x16x32_bf16 a[4:7], a[160:163], v[92:95], a[4:7]
    buffer_load_dword v244, v245, s[32:35], 0 offen offset:128 sc1
    v_add_f32 v70, v70, v106
    v_add_f32 v71, v71, v107
    v_mfma_f32_16x16x32_bf16 a[8:11], a[176:179], v[92:95], a[8:11]
    v_add_f32 v63, v63, v112
    v_fma_f32 v64, v104, v108, v64
    s_waitcnt lgkmcnt(2)
    v_mfma_f32_16x16x32_bf16 a[0:3], a[148:151], v[96:99], a[0:3]
    v_add_f32 v63, v63, v113
    v_fma_f32 v64, v105, v109, v64
    v_mfma_f32_16x16x32_bf16 a[4:7], a[164:167], v[96:99], a[4:7]
    v_add_f32 v63, v63, v114
    v_fma_f32 v64, v106, v110, v64
    v_mfma_f32_16x16x32_bf16 a[8:11], a[180:183], v[96:99], a[8:11]
    v_add_f32 v63, v63, v115
    v_fma_f32 v64, v107, v111, v64
    s_waitcnt lgkmcnt(1)
    v_mfma_f32_16x16x32_bf16 a[0:3], a[152:155], v[100:103], a[0:3]
    v_mfma_f32_16x16x32_bf16 a[4:7], a[168:171], v[100:103], a[4:7]
    s_add_u32 m0, s41, 0
    s_add_u32 s58, s37, 98304
    buffer_load_dwordx4 v22, s[24:27], s58 offen offset:0 nt lds
    v_mfma_f32_16x16x32_bf16 a[8:11], a[184:187], v[100:103], a[8:11]
    s_waitcnt lgkmcnt(0)
    v_mfma_f32_16x16x32_bf16 a[0:3], a[156:159], v[116:119], a[0:3]
    v_mfma_f32_16x16x32_bf16 a[4:7], a[172:175], v[116:119], a[4:7]
    v_mfma_f32_16x16x32_bf16 a[8:11], a[188:191], v[116:119], a[8:11]
    buffer_load_dwordx4 v23, s[24:27], s58 offen offset:1024 nt lds
    buffer_load_dwordx4 v24, s[24:27], s58 offen offset:2048 nt lds
    buffer_load_dwordx4 v25, s[24:27], s58 offen offset:3072 nt lds
    s_add_u32 m0, s41, 4096
    s_nop 0
    buffer_load_dwordx4 v26, s[24:27], s58 offen offset:0 nt lds
    s_waitcnt vmcnt(12)
    s_barrier
    ds_read_b128 a[96:99], v40 offset:49152
    ds_read_b128 a[100:103], v41 offset:49152
    ds_read_b128 a[104:107], v42 offset:49152
    ds_read_b128 a[108:111], v43 offset:49152
    ds_read_b128 a[112:115], v40 offset:49408
    ds_read_b128 a[116:119], v41 offset:49408
    ds_read_b128 a[120:123], v42 offset:49408
    ds_read_b128 a[124:127], v43 offset:49408
    ds_read_b128 a[128:131], v40 offset:49664
    ds_read_b128 a[132:135], v41 offset:49664
    ds_read_b128 a[136:139], v42 offset:49664
    ds_read_b128 a[140:143], v43 offset:49664
    s_waitcnt lgkmcnt(11)
    v_mfma_f32_16x16x32_bf16 v[96:99], a[96:99], a[96:99], v[84:87]
    ds_read_b64_tr_b16 a[144:145], v44 offset:0
    ds_read_b64_tr_b16 a[146:147], v45 offset:0
    v_mfma_f32_16x16x32_bf16 v[100:103], a[96:99], a[48:51], 0
    ds_read_b64_tr_b16 a[148:149], v44 offset:12288
    ds_read_b64_tr_b16 a[150:151], v45 offset:12288
    s_waitcnt lgkmcnt(14)
    v_mfma_f32_16x16x32_bf16 v[96:99], a[100:103], a[100:103], v[96:99]
    ds_read_b64_tr_b16 a[152:153], v44 offset:24576
    ds_read_b64_tr_b16 a[154:155], v45 offset:24576
    v_mfma_f32_16x16x32_bf16 v[100:103], a[100:103], a[52:55], v[100:103]
    ds_read_b64_tr_b16 a[156:157], v44 offset:36864
    ds_read_b64_tr_b16 a[158:159], v45 offset:36864
    s_waitcnt lgkmcnt(15)
    v_mfma_f32_16x16x32_bf16 v[96:99], a[104:107], a[104:107], v[96:99]
    ds_read_b64_tr_b16 a[160:161], v46 offset:0
    ds_read_b64_tr_b16 a[162:163], v47 offset:0
    v_mfma_f32_16x16x32_bf16 v[100:103], a[104:107], a[56:59], v[100:103]
    ds_read_b64_tr_b16 a[164:165], v46 offset:12288
    ds_read_b64_tr_b16 a[166:167], v47 offset:12288
    v_mfma_f32_16x16x32_bf16 v[96:99], a[108:111], a[108:111], v[96:99]
    buffer_load_dwordx4 v27, s[24:27], s58 offen offset:1024 nt lds
    ds_read_b64_tr_b16 a[168:169], v46 offset:24576
    ds_read_b64_tr_b16 a[170:171], v47 offset:24576
    v_mfma_f32_16x16x32_bf16 v[100:103], a[108:111], a[60:63], v[100:103]
    ds_read_b64_tr_b16 a[172:173], v46 offset:36864
    ds_read_b64_tr_b16 a[174:175], v47 offset:36864
    v_mfma_f32_16x16x32_bf16 v[96:99], a[112:115], a[112:115], v[96:99]
    ds_read_b64_tr_b16 a[176:177], v48 offset:0
    ds_read_b64_tr_b16 a[178:179], v49 offset:0
    v_mfma_f32_16x16x32_bf16 v[100:103], a[112:115], a[64:67], v[100:103]
    ds_read_b64_tr_b16 a[180:181], v48 offset:12288
    ds_read_b64_tr_b16 a[182:183], v49 offset:12288
    s_waitcnt lgkmcnt(15)
    v_mfma_f32_16x16x32_bf16 v[96:99], a[116:119], a[116:119], v[96:99]
    ds_read_b64_tr_b16 a[184:185], v48 offset:24576
    ds_read_b64_tr_b16 a[186:187], v49 offset:24576
    v_mfma_f32_16x16x32_bf16 v[100:103], a[116:119], a[68:71], v[100:103]
    ds_read_b64_tr_b16 a[188:189], v48 offset:36864
    ds_read_b64_tr_b16 a[190:191], v49 offset:36864
    v_mfma_f32_16x16x32_bf16 v[92:95], a[96:99], v[52:55], v[80:83]
    v_mfma_f32_16x16x32_bf16 v[92:95], a[100:103], v[52:55], v[92:95]
    v_mfma_f32_16x16x32_bf16 v[92:95], a[104:107], v[52:55], v[92:95]
    v_mfma_f32_16x16x32_bf16 v[92:95], a[108:111], v[52:55], v[92:95]
    s_nop 1
    v_fma_f32 v96, v100, 2.0, v96
    v_fma_f32 v97, v101, 2.0, v97
    v_mfma_f32_16x16x32_bf16 v[92:95], a[112:115], v[52:55], v[92:95]
    v_fma_f32 v98, v102, 2.0, v98
    v_fma_f32 v99, v103, 2.0, v99
    v_mfma_f32_16x16x32_bf16 v[92:95], a[116:119], v[52:55], v[92:95]
    v_cndmask_b32 v3, 0, v96, s[44:45]
    v_cndmask_b32 v3, v3, v97, s[46:47]
    v_mfma_f32_16x16x32_bf16 v[88:91], a[96:99], v[136:139], v[76:79]
    buffer_load_dwordx4 v28, s[24:27], s58 offen offset:2048 nt lds
    v_cndmask_b32 v3, v3, v98, s[48:49]
    v_cndmask_b32 v3, v3, v99, s[50:51]
    v_mfma_f32_16x16x32_bf16 v[88:91], a[100:103], v[140:143], v[88:91]
    s_nop 0
    s_nop 0
    v_mfma_f32_16x16x32_bf16 v[88:91], a[104:107], v[144:147], v[88:91]
    v_mfma_f32_16x16x4_f32 v[120:123], v3, v60, v[56:59]
    v_mfma_f32_16x16x32_bf16 v[88:91], a[108:111], v[148:151], v[88:91]
    v_mfma_f32_16x16x32_bf16 v[88:91], a[112:115], v[152:155], v[88:91]
    v_mfma_f32_16x16x32_bf16 v[88:91], a[116:119], v[156:159], v[88:91]
    v_mfma_f32_16x16x32_bf16 v[112:115], a[120:123], a[120:123], v[84:87]
    v_mfma_f32_16x16x32_bf16 v[116:119], a[120:123], a[48:51], 0
    v_mfma_f32_16x16x32_bf16 v[112:115], a[124:127], a[124:127], v[112:115]
    v_mfma_f32_16x16x32_bf16 v[116:119], a[124:127], a[52:55], v[116:119]
    s_nop 2
    v_fma_f32 v128, -v92, v92, v120
    v_fma_f32 v129, -v93, v93, v121
    v_mfma_f32_16x16x32_bf16 v[112:115], a[128:131], a[128:131], v[112:115]
    v_fma_f32 v130, -v94, v94, v122
    v_fma_f32 v131, -v95, v95, v123
    v_mfma_f32_16x16x32_bf16 v[116:119], a[128:131], a[56:59], v[116:119]
    buffer_load_dwordx4 v29, s[24:27], s58 offen offset:3072 nt lds
    v_max_f32 v128, v128, v56
    v_max_f32 v129, v129, v56
    v_mfma_f32_16x16x32_bf16 v[112:115], a[132:135], a[132:135], v[112:115]
    v_max_f32 v130, v130, v56
    v_max_f32 v131, v131, v56
    v_mfma_f32_16x16x32_bf16 v[116:119], a[132:135], a[60:63], v[116:119]
    v_rsq_f32 v128, v128
    v_mfma_f32_16x16x32_bf16 v[112:115], a[136:139], a[136:139], v[112:115]
    v_rsq_f32 v129, v129
    v_mfma_f32_16x16x32_bf16 v[116:119], a[136:139], a[64:67], v[116:119]
    v_rsq_f32 v130, v130
    v_mfma_f32_16x16x32_bf16 v[112:115], a[140:143], a[140:143], v[112:115]
    v_rsq_f32 v131, v131
    v_mfma_f32_16x16x32_bf16 v[116:119], a[140:143], a[68:71], v[116:119]
    v_fma_f32 v88, -v92, v61, v88
    v_fma_f32 v89, -v93, v61, v89
    v_mfma_f32_16x16x32_bf16 v[108:111], a[120:123], v[52:55], v[80:83]
    v_fma_f32 v90, -v94, v61, v90
    v_fma_f32 v91, -v95, v61, v91
    v_mfma_f32_16x16x32_bf16 v[108:111], a[124:127], v[52:55], v[108:111]
    v_fma_f32 v88, v88, v128, v62
    v_fma_f32 v89, v89, v129, v62
    v_mfma_f32_16x16x32_bf16 v[108:111], a[128:131], v[52:55], v[108:111]
    v_fma_f32 v90, v90, v130, v62
    v_fma_f32 v91, v91, v131, v62
    v_mfma_f32_16x16x32_bf16 v[108:111], a[132:135], v[52:55], v[108:111]
    v_max3_f32 v1, v88, v89, v90
    v_max_f32 v1, v1, v91
    v_mfma_f32_16x16x32_bf16 v[108:111], a[136:139], v[52:55], v[108:111]
    v_cmp_lt_f32 vcc, s52, v1
    s_cbranch_vccnz L_site4
L_back4:
    v_mfma_f32_16x16x32_bf16 v[108:111], a[140:143], v[52:55], v[108:111]
    v_exp_f32 v96, v88
    v_mfma_f32_16x16x32_bf16 v[104:107], a[120:123], v[136:139], v[76:79]
    s_add_u32 m0, s41, 8192
    s_nop 0
    buffer_load_dwordx4 v30, s[24:27], s58 offen offset:0 nt lds
    v_exp_f32 v97, v89
    v_mfma_f32_16x16x32_bf16 v[104:107], a[124:127], v[140:143], v[104:107]
    v_exp_f32 v98, v90
    v_mfma_f32_16x16x32_bf16 v[104:107], a[128:131], v[144:147], v[104:107]
    v_exp_f32 v99, v91
    v_mfma_f32_16x16x32_bf16 v[104:107], a[132:135], v[148:151], v[104:107]
    v_mul_f32 v88, v96, v128
    v_mul_f32 v89, v97, v129
    v_mfma_f32_16x16x32_bf16 v[104:107], a[136:139], v[152:155], v[104:107]
    v_mul_f32 v90, v98, v130
    v_mul_f32 v91, v99, v131
    v_mfma_f32_16x16x32_bf16 v[104:107], a[140:143], v[156:159], v[104:107]
    v_fma_f32 v112, v116, 2.0, v112
    v_fma_f32 v113, v117, 2.0, v113
    v_fma_f32 v114, v118, 2.0, v114
    v_fma_f32 v115, v119, 2.0, v115
    v_cndmask_b32 v4, 0, v112, s[44:45]
    v_cndmask_b32 v4, v4, v113, s[46:47]
    v_cndmask_b32 v4, v4, v114, s[48:49]
    v_cndmask_b32 v4, v4, v115, s[50:51]
    v_add_f32 v63, v63, v96
    v_fmac_f32 v64, v88, v92
    v_mfma_f32_16x16x4_f32 v[124:127], v4, v60, v[56:59]
    v_add_f32 v63, v63, v97
    v_fmac_f32 v64, v89, v93
    v_add_f32 v63, v63, v98
    v_fmac_f32 v64, v90, v94
    v_add_f32 v63, v63, v99
    v_fmac_f32 v64, v91, v95
    v_add_f32 v68, v68, v88
    v_add_f32 v69, v69, v89
    v_add_f32 v70, v70, v90
    v_add_f32 v71, v71, v91
    v_add_u32 v44, -49152, v44
    v_add_u32 v45, -49152, v45
    v_add_u32 v46, -49152, v46
    v_add_u32 v47, -49152, v47
    v_add_u32 v48, -49152, v48
    v_add_u32 v49, -49152, v49
    v_fma_f32 v132, -v108, v108, v124
    v_fma_f32 v133, -v109, v109, v125
    v_fma_f32 v134, -v110, v110, v126
    v_fma_f32 v135, -v111, v111, v127
    v_max_f32 v132, v132, v56
    v_max_f32 v133, v133, v56
    v_max_f32 v134, v134, v56
    v_max_f32 v135, v135, v56
    v_rsq_f32 v132, v132
    v_rsq_f32 v133, v133
    v_rsq_f32 v134, v134
    v_rsq_f32 v135, v135
    buffer_load_dwordx4 v31, s[24:27], s58 offen offset:1024 nt lds
    v_fma_f32 v104, -v108, v61, v104
    v_fma_f32 v105, -v109, v61, v105
    v_fma_f32 v106, -v110, v61, v106
    v_fma_f32 v107, -v111, v61, v107
    v_fma_f32 v104, v104, v132, v62
    v_fma_f32 v105, v105, v133, v62
    v_fma_f32 v106, v106, v134, v62
    v_fma_f32 v107, v107, v135, v62
    v_max3_f32 v1, v104, v105, v106
    v_max_f32 v1, v1, v107
    v_cmp_lt_f32 vcc, s52, v1
    s_cbranch_vccnz L_site5
L_back5:
    v_exp_f32 v112, v104
    v_exp_f32 v113, v105
    v_exp_f32 v114, v106
    v_exp_f32 v115, v107
    v_cvt_pk_bf16_f32 v72, v88, v89
    v_cvt_pk_bf16_f32 v73, v90, v91
    v_mul_f32 v104, v112, v132
    v_mul_f32 v105, v113, v133
    v_mul_f32 v106, v114, v134
    v_mul_f32 v107, v115, v135
    v_cvt_pk_bf16_f32 v74, v104, v105
    v_cvt_pk_bf16_f32 v75, v106, v107
    ds_write_b128 v237, v[72:75] offset:0
    v_add_f32 v68, v68, v104
    v_add_f32 v69, v69, v105
    v_add_f32 v70, v70, v106
    v_add_f32 v71, v71, v107
    v_cvt_pk_bf16_f32 v66, v68, v69
    v_cvt_pk_bf16_f32 v67, v70, v71
    ds_write_b64 v238, v[66:67]
    buffer_load_dwordx4 v32, s[24:27], s58 offen offset:2048 nt lds
    buffer_load_dwordx4 v33, s[24:27], s58 offen offset:3072 nt lds
    s_waitcnt vmcnt(13)
    s_waitcnt vmcnt(12)
    v_cmp_ne_u32 vcc, s39, v244
    s_cbranch_vccnz L_fl_retry
L_fl_ok:
    s_waitcnt lgkmcnt(0)
    s_barrier
L_post6:
    ds_read_b32 v9, v254 offset:4096
    ds_read_b64 v[120:121], v254 offset:0
    ds_read_b64 v[122:123], v254 offset:512
    ds_read_b64 v[124:125], v254 offset:1024
    ds_read_b64 v[126:127], v254 offset:1536
    ds_read_b128 v[92:95], v253 offset:0
    ds_read_b128 v[96:99], v253 offset:1024
    ds_read_b128 v[100:103], v253 offset:2048
    ds_read_b128 v[116:119], v253 offset:3072
    ds_read_b128 a[48:51], v34 offset:0
    ds_read_b128 a[52:55], v35 offset:0
    ds_read_b128 a[56:59], v34 offset:128
    ds_read_b128 a[60:63], v35 offset:128
    ds_read_b128 a[64:67], v34 offset:256
    ds_read_b128 a[68:71], v35 offset:256
    s_waitcnt lgkmcnt(14)
    v_cmp_ne_u32 vcc, 0, v9
    s_cbranch_vccnz L_xt6
    s_waitcnt lgkmcnt(12)
    v_mfma_f32_16x16x32_bf16 a[0:3], a[72:75], v[120:123], a[0:3]
    s_add_u32 m0, s42, 0
    s_add_u32 s59, s37, 294912
    buffer_load_dwordx4 v22, s[24:27], s59 offen offset:0 nt lds
    v_add_f32 v63, v63, v112
    v_fma_f32 v64, v104, v108, v64
    v_mfma_f32_16x16x32_bf16 a[4:7], a[80:83], v[120:123], a[4:7]
    v_add_f32 v63, v63, v113
    v_fma_f32 v64, v105, v109, v64
    v_mfma_f32_16x16x32_bf16 a[8:11], a[88:91], v[120:123], a[8:11]
    v_add_f32 v63, v63, v114
    v_fma_f32 v64, v106, v110, v64
    s_waitcnt lgkmcnt(10)
    v_mfma_f32_16x16x32_bf16 a[0:3], a[76:79], v[124:127], a[0:3]
    v_add_f32 v63, v63, v115
    v_fma_f32 v64, v107, v111, v64
    v_mfma_f32_16x16x32_bf16 a[4:7], a[84:87], v[124:127], a[4:7]
    v_mfma_f32_16x16x32_bf16 a[8:11], a[92:95], v[124:127], a[8:11]
    s_waitcnt lgkmcnt(9)
    v_mfma_f32_16x16x32_bf16 a[0:3], a[144:147], v[92:95], a[0:3]
    ds_read_b64_tr_b16 a[72:73], v36 offset:0
    ds_read_b64_tr_b16 a[74:75], v36 offset:6144
    v_mfma_f32_16x16x32_bf16 a[4:7], a[160:163], v[92:95], a[4:7]
    ds_read_b64_tr_b16 a[76:77], v36 offset:12288
    ds_read_b64_tr_b16 a[78:79], v36 offset:18432
    v_mfma_f32_16x16x32_bf16 a[8:11], a[176:179], v[92:95], a[8:11]
    ds_read_b64_tr_b16 a[80:81], v37 offset:0
    ds_read_b64_tr_b16 a[82:83], v37 offset:6144
    s_waitcnt lgkmcnt(14)
    v_mfma_f32_16x16x32_bf16 a[0:3], a[148:151], v[96:99], a[0:3]
    buffer_load_dwordx4 v23, s[24:27], s59 offen offset:1024 nt lds
    ds_read_b64_tr_b16 a[84:85], v37 offset:12288
    ds_read_b64_tr_b16 a[86:87], v37 offset:18432
    v_mfma_f32_16x16x32_bf16 a[4:7], a[164:167], v[96:99], a[4:7]
    ds_read_b64_tr_b16 a[88:89], v38 offset:0
    ds_read_b64_tr_b16 a[90:91], v38 offset:6144
    v_mfma_f32_16x16x32_bf16 a[8:11], a[180:183], v[96:99], a[8:11]
    ds_read_b64_tr_b16 a[92:93], v38 offset:12288
    ds_read_b64_tr_b16 a[94:95], v38 offset:18432
    s_waitcnt lgkmcnt(15)
    v_mfma_f32_16x16x32_bf16 a[0:3], a[152:155], v[100:103], a[0:3]
    v_mfma_f32_16x16x32_bf16 a[4:7], a[168:171], v[100:103], a[4:7]
    v_mfma_f32_16x16x32_bf16 a[8:11], a[184:187], v[100:103], a[8:11]
    v_mfma_f32_16x16x32_bf16 a[0:3], a[156:159], v[116:119], a[0:3]
    v_mfma_f32_16x16x32_bf16 a[4:7], a[172:175], v[116:119], a[4:7]
    v_mfma_f32_16x16x32_bf16 a[8:11], a[188:191], v[116:119], a[8:11]
    v_mfma_f32_16x16x32_bf16 v[84:87], a[48:51], a[48:51], 0
    v_mfma_f32_16x16x32_bf16 v[80:83], a[48:51], v[52:55], 0
    v_mfma_f32_16x16x32_bf16 v[84:87], a[52:55], a[52:55], v[84:87]
    v_mfma_f32_16x16x32_bf16 v[80:83], a[52:55], v[52:55], v[80:83]
    v_mfma_f32_16x16x32_bf16 v[84:87], a[56:59], a[56:59], v[84:87]
    s_add_u32 s61, s60, 3145728
    buffer_load_dwordx4 v[160:163], v65, s[72:75], s61 offen offset:0 sc1
    v_mfma_f32_16x16x32_bf16 v[80:83], a[56:59], v[52:55], v[80:83]
    s_waitcnt lgkmcnt(14)
    v_mfma_f32_16x16x32_bf16 v[84:87], a[60:63], a[60:63], v[84:87]
    v_mfma_f32_16x16x32_bf16 v[80:83], a[60:63], v[52:55], v[80:83]
    s_waitcnt lgkmcnt(13)
    v_mfma_f32_16x16x32_bf16 v[84:87], a[64:67], a[64:67], v[84:87]
    v_mfma_f32_16x16x32_bf16 v[80:83], a[64:67], v[52:55], v[80:83]
    s_waitcnt lgkmcnt(12)
    v_mfma_f32_16x16x32_bf16 v[84:87], a[68:71], a[68:71], v[84:87]
    v_mfma_f32_16x16x32_bf16 v[80:83], a[68:71], v[52:55], v[80:83]
    s_waitcnt lgkmcnt(0)
    v_mfma_f32_16x16x32_bf16 v[76:79], a[48:51], v[136:139], 0
    v_mfma_f32_16x16x32_bf16 v[76:79], a[52:55], v[140:143], v[76:79]
    v_mfma_f32_16x16x32_bf16 v[76:79], a[56:59], v[144:147], v[76:79]
    v_mfma_f32_16x16x32_bf16 v[76:79], a[60:63], v[148:151], v[76:79]
    v_mfma_f32_16x16x32_bf16 v[76:79], a[64:67], v[152:155], v[76:79]
    v_mfma_f32_16x16x32_bf16 v[76:79], a[68:71], v[156:159], v[76:79]
    buffer_load_dwordx4 v24, s[24:27], s59 offen offset:2048 nt lds
    buffer_load_dwordx4 v25, s[24:27], s59 offen offset:3072 nt lds
    s_add_u32 m0, s42, 4096
    s_nop 0
    buffer_load_dwordx4 v26, s[24:27], s59 offen offset:0 nt lds
    buffer_load_dwordx4 v27, s[24:27], s59 offen offset:1024 nt lds
    buffer_load_dwordx4 v[164:167], v65, s[72:75], s61 offen offset:1024 sc1
    buffer_load_dwordx4 v28, s[24:27], s59 offen offset:2048 nt lds
    buffer_load_dwordx4 v29, s[24:27], s59 offen offset:3072 nt lds
    s_add_u32 m0, s42, 8192
    s_nop 0
    buffer_load_dwordx4 v30, s[24:27], s59 offen offset:0 nt lds
    buffer_load_dwordx4 v31, s[24:27], s59 offen offset:1024 nt lds
    s_waitcnt vmcnt(12)
    s_barrier
    ds_read_b128 a[96:99], v40 offset:0
    ds_read_b128 a[100:103], v41 offset:0
    ds_read_b128 a[104:107], v42 offset:0
    ds_read_b128 a[108:111], v43 offset:0
    ds_read_b128 a[112:115], v40 offset:256
    ds_read_b128 a[116:119], v41 offset:256
    ds_read_b128 a[120:123], v42 offset:256
    ds_read_b128 a[124:127], v43 offset:256
    ds_read_b128 a[128:131], v40 offset:512
    ds_read_b128 a[132:135], v41 offset:512
    ds_read_b128 a[136:139], v42 offset:512
    ds_read_b128 a[140:143], v43 offset:512
    s_waitcnt lgkmcnt(11)
    v_mfma_f32_16x16x32_bf16 v[96:99], a[96:99], a[96:99], v[84:87]
    ds_read_b64_tr_b16 a[144:145], v44 offset:0
    ds_read_b64_tr_b16 a[146:147], v45 offset:0
    v_mfma_f32_16x16x32_bf16 v[100:103], a[96:99], a[48:51], 0
    ds_read_b64_tr_b16 a[148:149], v44 offset:12288
    ds_read_b64_tr_b16 a[150:151], v45 offset:12288
    s_waitcnt lgkmcnt(14)
    v_mfma_f32_16x16x32_bf16 v[96:99], a[100:103], a[100:103], v[96:99]
    ds_read_b64_tr_b16 a[152:153], v44 offset:24576
    ds_read_b64_tr_b16 a[154:155], v45 offset:24576
    v_mfma_f32_16x16x32_bf16 v[100:103], a[100:103], a[52:55], v[100:103]
    ds_read_b64_tr_b16 a[156:157], v44 offset:36864
    ds_read_b64_tr_b16 a[158:159], v45 offset:36864
    s_waitcnt lgkmcnt(15)
    v_mfma_f32_16x16x32_bf16 v[96:99], a[104:107], a[104:107], v[96:99]
    ds_read_b64_tr_b16 a[160:161], v46 offset:0
    ds_read_b64_tr_b16 a[162:163], v47 offset:0
    v_mfma_f32_16x16x32_bf16 v[100:103], a[104:107], a[56:59], v[100:103]
    ds_read_b64_tr_b16 a[164:165], v46 offset:12288
    ds_read_b64_tr_b16 a[166:167], v47 offset:12288
    v_mfma_f32_16x16x32_bf16 v[96:99], a[108:111], a[108:111], v[96:99]
    buffer_load_dwordx4 v[168:171], v65, s[72:75], s61 offen offset:2048 sc1
    ds_read_b64_tr_b16 a[168:169], v46 offset:24576
    ds_read_b64_tr_b16 a[170:171], v47 offset:24576
    v_mfma_f32_16x16x32_bf16 v[100:103], a[108:111], a[60:63], v[100:103]
    ds_read_b64_tr_b16 a[172:173], v46 offset:36864
    ds_read_b64_tr_b16 a[174:175], v47 offset:36864
    v_mfma_f32_16x16x32_bf16 v[96:99], a[112:115], a[112:115], v[96:99]
    ds_read_b64_tr_b16 a[176:177], v48 offset:0
    ds_read_b64_tr_b16 a[178:179], v49 offset:0
    v_mfma_f32_16x16x32_bf16 v[100:103], a[112:115], a[64:67], v[100:103]
    ds_read_b64_tr_b16 a[180:181], v48 offset:12288
    ds_read_b64_tr_b16 a[182:183], v49 offset:12288
    s_waitcnt lgkmcnt(15)
    v_mfma_f32_16x16x32_bf16 v[96:99], a[116:119], a[116:119], v[96:99]
    ds_read_b64_tr_b16 a[184:185], v48 offset:24576
    ds_read_b64_tr_b16 a[186:187], v49 offset:24576
    v_mfma_f32_16x16x32_bf16 v[100:103], a[116:119], a[68:71], v[100:103]
    ds_read_b64_tr_b16 a[188:189], v48 offset:36864
    ds_read_b64_tr_b16 a[190:191], v49 offset:36864
    v_mfma_f32_16x16x32_bf16 v[92:95], a[96:99], v[52:55], v[80:83]
    v_mfma_f32_16x16x32_bf16 v[92:95], a[100:103], v[52:55], v[92:95]
    v_mfma_f32_16x16x32_bf16 v[92:95], a[104:107], v[52:55], v[92:95]
    v_mfma_f32_16x16x32_bf16 v[92:95], a[108:111], v[52:55], v[92:95]
    s_nop 1
    v_fma_f32 v96, v100, 2.0, v96
    v_fma_f32 v97, v101, 2.0, v97
    v_mfma_f32_16x16x32_bf16 v[92:95], a[112:115], v[52:55], v[92:95]
    v_fma_f32 v98, v102, 2.0, v98
    v_fma_f32 v99, v103, 2.0, v99
    v_mfma_f32_16x16x32_bf16 v[92:95], a[116:119], v[52:55], v[92:95]
    v_cndmask_b32 v3, 0, v96, s[44:45]
    v_cndmask_b32 v3, v3, v97, s[46:47]
    v_mfma_f32_16x16x32_bf16 v[88:91], a[96:99], v[136:139], v[76:79]
    buffer_load_dwordx4 v32, s[24:27], s59 offen offset:2048 nt lds
    v_cndmask_b32 v3, v3, v98, s[48:49]
    v_cndmask_b32 v3, v3, v99, s[50:51]
    v_mfma_f32_16x16x32_bf16 v[88:91], a[100:103], v[140:143], v[88:91]
    buffer_load_dwordx4 v33, s[24:27], s59 offen offset:3072 nt lds
    s_nop 0
    s_nop 0
    v_mfma_f32_16x16x32_bf16 v[88:91], a[104:107], v[144:147], v[88:91]
    v_mfma_f32_16x16x4_f32 v[120:123], v3, v60, v[56:59]
    v_mfma_f32_16x16x32_bf16 v[88:91], a[108:111], v[148:151], v[88:91]
    v_mfma_f32_16x16x32_bf16 v[88:91], a[112:115], v[152:155], v[88:91]
    v_mfma_f32_16x16x32_bf16 v[88:91], a[116:119], v[156:159], v[88:91]
    v_mfma_f32_16x16x32_bf16 v[112:115], a[120:123], a[120:123], v[84:87]
    v_mfma_f32_16x16x32_bf16 v[116:119], a[120:123], a[48:51], 0
    v_mfma_f32_16x16x32_bf16 v[112:115], a[124:127], a[124:127], v[112:115]
    v_mfma_f32_16x16x32_bf16 v[116:119], a[124:127], a[52:55], v[116:119]
    s_nop 2
    v_fma_f32 v128, -v92, v92, v120
    v_fma_f32 v129, -v93, v93, v121
    v_mfma_f32_16x16x32_bf16 v[112:115], a[128:131], a[128:131], v[112:115]
    s_add_u32 m0, s40, 0
    s_add_u32 s57, s36, 73728
    buffer_load_dwordx4 v16, s[28:31], s57 offen offset:0 nt lds
    v_fma_f32 v130, -v94, v94, v122
    v_fma_f32 v131, -v95, v95, v123
    v_mfma_f32_16x16x32_bf16 v[116:119], a[128:131], a[56:59], v[116:119]
    v_max_f32 v128, v128, v56
    v_max_f32 v129, v129, v56
    v_mfma_f32_16x16x32_bf16 v[112:115], a[132:135], a[132:135], v[112:115]
    v_max_f32 v130, v130, v56
    v_max_f32 v131, v131, v56
    v_mfma_f32_16x16x32_bf16 v[116:119], a[132:135], a[60:63], v[116:119]
    v_rsq_f32 v128, v128
    v_mfma_f32_16x16x32_bf16 v[112:115], a[136:139], a[136:139], v[112:115]
    v_rsq_f32 v129, v129
    v_mfma_f32_16x16x32_bf16 v[116:119], a[136:139], a[64:67], v[116:119]
    v_rsq_f32 v130, v130
    v_mfma_f32_16x16x32_bf16 v[112:115], a[140:143], a[140:143], v[112:115]
    v_rsq_f32 v131, v131
    v_mfma_f32_16x16x32_bf16 v[116:119], a[140:143], a[68:71], v[116:119]
    v_fma_f32 v88, -v92, v61, v88
    v_fma_f32 v89, -v93, v61, v89
    v_mfma_f32_16x16x32_bf16 v[108:111], a[120:123], v[52:55], v[80:83]
    v_fma_f32 v90, -v94, v61, v90
    v_fma_f32 v91, -v95, v61, v91
    v_mfma_f32_16x16x32_bf16 v[108:111], a[124:127], v[52:55], v[108:111]
    v_fma_f32 v88, v88, v128, v62
    v_fma_f32 v89, v89, v129, v62
    v_mfma_f32_16x16x32_bf16 v[108:111], a[128:131], v[52:55], v[108:111]
    v_fma_f32 v90, v90, v130, v62
    v_fma_f32 v91, v91, v131, v62
    v_mfma_f32_16x16x32_bf16 v[108:111], a[132:135], v[52:55], v[108:111]
    v_max3_f32 v1, v88, v89, v90
    v_max_f32 v1, v1, v91
    v_mfma_f32_16x16x32_bf16 v[108:111], a[136:139], v[52:55], v[108:111]
    buffer_load_dwordx4 v17, s[28:31], s57 offen offset:1024 nt lds
    v_cmp_lt_f32 vcc, s52, v1
    s_cbranch_vccnz L_site6
L_back6:
    v_mfma_f32_16x16x32_bf16 v[108:111], a[140:143], v[52:55], v[108:111]
    v_exp_f32 v96, v88
    v_mfma_f32_16x16x32_bf16 v[104:107], a[120:123], v[136:139], v[76:79]
    v_exp_f32 v97, v89
    v_mfma_f32_16x16x32_bf16 v[104:107], a[124:127], v[140:143], v[104:107]
    v_exp_f32 v98, v90
    v_mfma_f32_16x16x32_bf16 v[104:107], a[128:131], v[144:147], v[104:107]
    v_exp_f32 v99, v91
    v_mfma_f32_16x16x32_bf16 v[104:107], a[132:135], v[148:151], v[104:107]
    v_mul_f32 v88, v96, v128
    v_mul_f32 v89, v97, v129
    v_mfma_f32_16x16x32_bf16 v[104:107], a[136:139], v[152:155], v[104:107]
    v_mul_f32 v90, v98, v130
    v_mul_f32 v91, v99, v131
    v_mfma_f32_16x16x32_bf16 v[104:107], a[140:143], v[156:159], v[104:107]
    v_fma_f32 v112, v116, 2.0, v112
    v_fma_f32 v113, v117, 2.0, v113
    v_fma_f32 v114, v118, 2.0, v114
    v_fma_f32 v115, v119, 2.0, v115
    v_cndmask_b32 v4, 0, v112, s[44:45]
    v_cndmask_b32 v4, v4, v113, s[46:47]
    v_cndmask_b32 v4, v4, v114, s[48:49]
    v_cndmask_b32 v4, v4, v115, s[50:51]
    v_add_f32 v63, v63, v96
    v_fmac_f32 v64, v88, v92
    v_mfma_f32_16x16x4_f32 v[124:127], v4, v60, v[56:59]
    v_add_f32 v63, v63, v97
    v_fmac_f32 v64, v89, v93
    v_add_f32 v63, v63, v98
    v_fmac_f32 v64, v90, v94
    v_add_f32 v63, v63, v99
    v_fmac_f32 v64, v91, v95
    v_mov_b32 v68, v88
    v_mov_b32 v69, v89
    v_mov_b32 v70, v90
    v_mov_b32 v71, v91
    v_add_u32 v44, 49152, v44
    v_add_u32 v45, 49152, v45
    v_add_u32 v46, 49152, v46
    v_add_u32 v47, 49152, v47
    v_add_u32 v48, 49152, v48
    v_add_u32 v49, 49152, v49
    v_fma_f32 v132, -v108, v108, v124
    v_fma_f32 v133, -v109, v109, v125
    v_fma_f32 v134, -v110, v110, v126
    v_fma_f32 v135, -v111, v111, v127
    v_max_f32 v132, v132, v56
    v_max_f32 v133, v133, v56
    v_max_f32 v134, v134, v56
    v_max_f32 v135, v135, v56
    v_rsq_f32 v132, v132
    v_rsq_f32 v133, v133
    v_rsq_f32 v134, v134
    v_rsq_f32 v135, v135
    buffer_load_dwordx4 v[172:175], v65, s[72:75], s61 offen offset:3072 sc1
    v_fma_f32 v104, -v108, v61, v104
    v_fma_f32 v105, -v109, v61, v105
    v_fma_f32 v106, -v110, v61, v106
    v_fma_f32 v107, -v111, v61, v107
    v_fma_f32 v104, v104, v132, v62
    v_fma_f32 v105, v105, v133, v62
    v_fma_f32 v106, v106, v134, v62
    v_fma_f32 v107, v107, v135, v62
    v_max3_f32 v1, v104, v105, v106
    v_max_f32 v1, v1, v107
    v_cmp_lt_f32 vcc, s52, v1
    s_cbranch_vccnz L_site7
L_back7:
    v_exp_f32 v112, v104
    v_exp_f32 v113, v105
    v_exp_f32 v114, v106
    v_exp_f32 v115, v107
    v_cvt_pk_bf16_f32 v72, v88, v89
    v_cvt_pk_bf16_f32 v73, v90, v91
    v_mul_f32 v104, v112, v132
    v_mul_f32 v105, v113, v133
    v_mul_f32 v106, v114, v134
    v_mul_f32 v107, v115, v135
    v_cvt_pk_bf16_f32 v74, v104, v105
    v_cvt_pk_bf16_f32 v75, v106, v107
    ds_write_b128 v237, v[72:75] offset:0
    s_waitcnt lgkmcnt(0)
    s_barrier
L_post27:
    ds_read_b32 v9, v254 offset:4096
    ds_read_b128 v[92:95], v253 offset:0
    ds_read_b128 v[96:99], v253 offset:1024
    ds_read_b128 v[100:103], v253 offset:2048
    ds_read_b128 v[116:119], v253 offset:3072
    s_waitcnt lgkmcnt(4)
    v_cmp_ne_u32 vcc, 0, v9
    s_cbranch_vccnz L_xt27
    s_waitcnt lgkmcnt(3)
    v_mfma_f32_16x16x32_bf16 a[0:3], a[144:147], v[92:95], a[0:3]
    buffer_load_dwordx4 v18, s[28:31], s57 offen offset:2048 nt lds
    v_add_f32 v68, v68, v104
    v_add_f32 v69, v69, v105
    v_mfma_f32_16x16x32_bf16 a[4:7], a[160:163], v[92:95], a[4:7]
    buffer_load_dwordx4 v19, s[28:31], s57 offen offset:3072 nt lds
    v_add_f32 v70, v70, v106
    v_add_f32 v71, v71, v107
    v_mfma_f32_16x16x32_bf16 a[8:11], a[176:179], v[92:95], a[8:11]
    s_add_u32 m0, s40, 4096
    s_nop 0
    buffer_load_dwordx4 v20, s[28:31], s57 offen offset:0 nt lds
    v_add_f32 v63, v63, v112
    v_fma_f32 v64, v104, v108, v64
    s_waitcnt lgkmcnt(2)
    v_mfma_f32_16x16x32_bf16 a[0:3], a[148:151], v[96:99], a[0:3]
    v_add_f32 v63, v63, v113
    v_fma_f32 v64, v105, v109, v64
    v_mfma_f32_16x16x32_bf16 a[4:7], a[164:167], v[96:99], a[4:7]
    v_add_f32 v63, v63, v114
    v_fma_f32 v64, v106, v110, v64
    v_mfma_f32_16x16x32_bf16 a[8:11], a[180:183], v[96:99], a[8:11]
    v_add_f32 v63, v63, v115
    v_fma_f32 v64, v107, v111, v64
    s_waitcnt lgkmcnt(1)
    v_mfma_f32_16x16x32_bf16 a[0:3], a[152:155], v[100:103], a[0:3]
    s_add_u32 s61, s60, 3149824
    buffer_load_dwordx4 v[176:179], v65, s[72:75], s61 offen offset:0 sc1
    v_mfma_f32_16x16x32_bf16 a[4:7], a[168:171], v[100:103], a[4:7]
    v_mfma_f32_16x16x32_bf16 a[8:11], a[184:187], v[100:103], a[8:11]
    s_waitcnt lgkmcnt(0)
    v_mfma_f32_16x16x32_bf16 a[0:3], a[156:159], v[116:119], a[0:3]
    v_mfma_f32_16x16x32_bf16 a[4:7], a[172:175], v[116:119], a[4:7]
    v_mfma_f32_16x16x32_bf16 a[8:11], a[188:191], v[116:119], a[8:11]
    buffer_load_dwordx4 v21, s[28:31], s57 offen offset:1024 nt lds
    s_add_u32 m0, s41, 0
    s_add_u32 s58, s37, 147456
    buffer_load_dwordx4 v224, s[24:27], s58 offen offset:0 nt lds
    buffer_load_dwordx4 v225, s[24:27], s58 offen offset:1024 nt lds
    s_add_u32 m0, s41, 2048
    s_add_u32 s58, s37, 147584
    buffer_load_dwordx4 v224, s[24:27], s58 offen offset:0 nt lds
    buffer_load_dwordx4 v[180:183], v65, s[72:75], s61 offen offset:1024 sc1
    s_waitcnt vmcnt(12)
    s_barrier
    ds_read_b128 a[96:99], v40 offset:49152
    ds_read_b128 a[100:103], v41 offset:49152
    ds_read_b128 a[104:107], v42 offset:49152
    ds_read_b128 a[108:111], v43 offset:49152
    ds_read_b128 a[112:115], v40 offset:49408
    ds_read_b128 a[116:119], v41 offset:49408
    ds_read_b128 a[120:123], v42 offset:49408
    ds_read_b128 a[124:127], v43 offset:49408
    ds_read_b128 a[128:131], v40 offset:49664
    ds_read_b128 a[132:135], v41 offset:49664
    ds_read_b128 a[136:139], v42 offset:49664
    ds_read_b128 a[140:143], v43 offset:49664
    s_waitcnt lgkmcnt(11)
    v_mfma_f32_16x16x32_bf16 v[96:99], a[96:99], a[96:99], v[84:87]
    ds_read_b64_tr_b16 a[144:145], v44 offset:0
    ds_read_b64_tr_b16 a[146:147], v45 offset:0
    v_mfma_f32_16x16x32_bf16 v[100:103], a[96:99], a[48:51], 0
    ds_read_b64_tr_b16 a[148:149], v44 offset:12288
    ds_read_b64_tr_b16 a[150:151], v45 offset:12288
    s_waitcnt lgkmcnt(14)
    v_mfma_f32_16x16x32_bf16 v[96:99], a[100:103], a[100:103], v[96:99]
    ds_read_b64_tr_b16 a[152:153], v44 offset:24576
    ds_read_b64_tr_b16 a[154:155], v45 offset:24576
    v_mfma_f32_16x16x32_bf16 v[100:103], a[100:103], a[52:55], v[100:103]
    ds_read_b64_tr_b16 a[156:157], v44 offset:36864
    ds_read_b64_tr_b16 a[158:159], v45 offset:36864
    s_waitcnt lgkmcnt(15)
    v_mfma_f32_16x16x32_bf16 v[96:99], a[104:107], a[104:107], v[96:99]
    ds_read_b64_tr_b16 a[160:161], v46 offset:0
    ds_read_b64_tr_b16 a[162:163], v47 offset:0
    v_mfma_f32_16x16x32_bf16 v[100:103], a[104:107], a[56:59], v[100:103]
    ds_read_b64_tr_b16 a[164:165], v46 offset:12288
    ds_read_b64_tr_b16 a[166:167], v47 offset:12288
    v_mfma_f32_16x16x32_bf16 v[96:99], a[108:111], a[108:111], v[96:99]
    buffer_load_dwordx4 v225, s[24:27], s58 offen offset:1024 nt lds
    ds_read_b64_tr_b16 a[168:169], v46 offset:24576
    ds_read_b64_tr_b16 a[170:171], v47 offset:24576
    v_mfma_f32_16x16x32_bf16 v[100:103], a[108:111], a[60:63], v[100:103]
    ds_read_b64_tr_b16 a[172:173], v46 offset:36864
    ds_read_b64_tr_b16 a[174:175], v47 offset:36864
    v_mfma_f32_16x16x32_bf16 v[96:99], a[112:115], a[112:115], v[96:99]
    ds_read_b64_tr_b16 a[176:177], v48 offset:0
    ds_read_b64_tr_b16 a[178:179], v49 offset:0
    v_mfma_f32_16x16x32_bf16 v[100:103], a[112:115], a[64:67], v[100:103]
    ds_read_b64_tr_b16 a[180:181], v48 offset:12288
    ds_read_b64_tr_b16 a[182:183], v49 offset:12288
    s_waitcnt lgkmcnt(15)
    v_mfma_f32_16x16x32_bf16 v[96:99], a[116:119], a[116:119], v[96:99]
    ds_read_b64_tr_b16 a[184:185], v48 offset:24576
    ds_read_b64_tr_b16 a[186:187], v49 offset:24576
    v_mfma_f32_16x16x32_bf16 v[100:103], a[116:119], a[68:71], v[100:103]
    ds_read_b64_tr_b16 a[188:189], v48 offset:36864
    ds_read_b64_tr_b16 a[190:191], v49 offset:36864
    v_mfma_f32_16x16x32_bf16 v[92:95], a[96:99], v[52:55], v[80:83]
    v_mfma_f32_16x16x32_bf16 v[92:95], a[100:103], v[52:55], v[92:95]
    v_mfma_f32_16x16x32_bf16 v[92:95], a[104:107], v[52:55], v[92:95]
    v_mfma_f32_16x16x32_bf16 v[92:95], a[108:111], v[52:55], v[92:95]
    s_nop 1
    v_fma_f32 v96, v100, 2.0, v96
    v_fma_f32 v97, v101, 2.0, v97
    v_mfma_f32_16x16x32_bf16 v[92:95], a[112:115], v[52:55], v[92:95]
    v_fma_f32 v98, v102, 2.0, v98
    v_fma_f32 v99, v103, 2.0, v99
    v_mfma_f32_16x16x32_bf16 v[92:95], a[116:119], v[52:55], v[92:95]
    v_cndmask_b32 v3, 0, v96, s[44:45]
    v_cndmask_b32 v3, v3, v97, s[46:47]
    v_mfma_f32_16x16x32_bf16 v[88:91], a[96:99], v[136:139], v[76:79]
    s_add_u32 m0, s41, 4096
    s_add_u32 s58, s37, 147712
    buffer_load_dwordx4 v224, s[24:27], s58 offen offset:0 nt lds
    v_cndmask_b32 v3, v3, v98, s[48:49]
    v_cndmask_b32 v3, v3, v99, s[50:51]
    v_mfma_f32_16x16x32_bf16 v[88:91], a[100:103], v[140:143], v[88:91]
    buffer_load_dwordx4 v225, s[24:27], s58 offen offset:1024 nt lds
    s_nop 0
    s_nop 0
    v_mfma_f32_16x16x32_bf16 v[88:91], a[104:107], v[144:147], v[88:91]
    v_mfma_f32_16x16x4_f32 v[120:123], v3, v60, v[56:59]
    v_mfma_f32_16x16x32_bf16 v[88:91], a[108:111], v[148:151], v[88:91]
    v_mfma_f32_16x16x32_bf16 v[88:91], a[112:115], v[152:155], v[88:91]
    v_mfma_f32_16x16x32_bf16 v[88:91], a[116:119], v[156:159], v[88:91]
    v_mfma_f32_16x16x32_bf16 v[112:115], a[120:123], a[120:123], v[84:87]
    v_mfma_f32_16x16x32_bf16 v[116:119], a[120:123], a[48:51], 0
    v_mfma_f32_16x16x32_bf16 v[112:115], a[124:127], a[124:127], v[112:115]
    v_mfma_f32_16x16x32_bf16 v[116:119], a[124:127], a[52:55], v[116:119]
    s_add_u32 m0, s41, 6144
    s_add_u32 s58, s37, 147840
    buffer_load_dwordx4 v224, s[24:27], s58 offen offset:0 nt lds
    v_fma_f32 v128, -v92, v92, v120
    v_fma_f32 v129, -v93, v93, v121
    v_mfma_f32_16x16x32_bf16 v[112:115], a[128:131], a[128:131], v[112:115]
    v_fma_f32 v130, -v94, v94, v122
    v_fma_f32 v131, -v95, v95, v123
    v_mfma_f32_16x16x32_bf16 v[116:119], a[128:131], a[56:59], v[116:119]
    v_max_f32 v128, v128, v56
    v_max_f32 v129, v129, v56
    v_mfma_f32_16x16x32_bf16 v[112:115], a[132:135], a[132:135], v[112:115]
    v_max_f32 v130, v130, v56
    v_max_f32 v131, v131, v56
    v_mfma_f32_16x16x32_bf16 v[116:119], a[132:135], a[60:63], v[116:119]
    v_rsq_f32 v128, v128
    v_mfma_f32_16x16x32_bf16 v[112:115], a[136:139], a[136:139], v[112:115]
    v_rsq_f32 v129, v129
    v_mfma_f32_16x16x32_bf16 v[116:119], a[136:139], a[64:67], v[116:119]
    v_rsq_f32 v130, v130
    v_mfma_f32_16x16x32_bf16 v[112:115], a[140:143], a[140:143], v[112:115]
    v_rsq_f32 v131, v131
    v_mfma_f32_16x16x32_bf16 v[116:119], a[140:143], a[68:71], v[116:119]
    v_fma_f32 v88, -v92, v61, v88
    v_fma_f32 v89, -v93, v61, v89
    v_mfma_f32_16x16x32_bf16 v[108:111], a[120:123], v[52:55], v[80:83]
    v_fma_f32 v90, -v94, v61, v90
    v_fma_f32 v91, -v95, v61, v91
    v_mfma_f32_16x16x32_bf16 v[108:111], a[124:127], v[52:55], v[108:111]
    v_fma_f32 v88, v88, v128, v62
    v_fma_f32 v89, v89, v129, v62
    v_mfma_f32_16x16x32_bf16 v[108:111], a[128:131], v[52:55], v[108:111]
    v_fma_f32 v90, v90, v130, v62
    v_fma_f32 v91, v91, v131, v62
    v_mfma_f32_16x16x32_bf16 v[108:111], a[132:135], v[52:55], v[108:111]
    v_max3_f32 v1, v88, v89, v90
    v_max_f32 v1, v1, v91
    v_mfma_f32_16x16x32_bf16 v[108:111], a[136:139], v[52:55], v[108:111]
    buffer_load_dwordx4 v[184:187], v65, s[72:75], s61 offen offset:2048 sc1
    v_cmp_lt_f32 vcc, s52, v1
    s_cbranch_vccnz L_site8
L_back8:
    v_mfma_f32_16x16x32_bf16 v[108:111], a[140:143], v[52:55], v[108:111]
    v_exp_f32 v96, v88
    v_mfma_f32_16x16x32_bf16 v[104:107], a[120:123], v[136:139], v[76:79]
    v_exp_f32 v97, v89
    v_mfma_f32_16x16x32_bf16 v[104:107], a[124:127], v[140:143], v[104:107]
    v_exp_f32 v98, v90
    v_mfma_f32_16x16x32_bf16 v[104:107], a[128:131], v[144:147], v[104:107]
    v_exp_f32 v99, v91
    v_mfma_f32_16x16x32_bf16 v[104:107], a[132:135], v[148:151], v[104:107]
    v_mul_f32 v88, v96, v128
    v_mul_f32 v89, v97, v129
    v_mfma_f32_16x16x32_bf16 v[104:107], a[136:139], v[152:155], v[104:107]
    v_mul_f32 v90, v98, v130
    v_mul_f32 v91, v99, v131
    v_mfma_f32_16x16x32_bf16 v[104:107], a[140:143], v[156:159], v[104:107]
    v_fma_f32 v112, v116, 2.0, v112
    v_fma_f32 v113, v117, 2.0, v113
    v_fma_f32 v114, v118, 2.0, v114
    v_fma_f32 v115, v119, 2.0, v115
    v_cndmask_b32 v4, 0, v112, s[44:45]
    v_cndmask_b32 v4, v4, v113, s[46:47]
    v_cndmask_b32 v4, v4, v114, s[48:49]
    v_cndmask_b32 v4, v4, v115, s[50:51]
    v_add_f32 v63, v63, v96
    v_fmac_f32 v64, v88, v92
    v_mfma_f32_16x16x4_f32 v[124:127], v4, v60, v[56:59]
    v_add_f32 v63, v63, v97
    v_fmac_f32 v64, v89, v93
    v_add_f32 v63, v63, v98
    v_fmac_f32 v64, v90, v94
    v_add_f32 v63, v63, v99
    v_fmac_f32 v64, v91, v95
    v_add_f32 v68, v68, v88
    v_add_f32 v69, v69, v89
    v_add_f32 v70, v70, v90
    v_add_f32 v71, v71, v91
    v_add_u32 v44, -49152, v44
    v_add_u32 v45, -49152, v45
    v_add_u32 v46, -49152, v46
    v_add_u32 v47, -49152, v47
    v_add_u32 v48, -49152, v48
    v_add_u32 v49, -49152, v49
    v_fma_f32 v132, -v108, v108, v124
    v_fma_f32 v133, -v109, v109, v125
    v_fma_f32 v134, -v110, v110, v126
    v_fma_f32 v135, -v111, v111, v127
    v_max_f32 v132, v132, v56
    v_max_f32 v133, v133, v56
    v_max_f32 v134, v134, v56
    v_max_f32 v135, v135, v56
    v_rsq_f32 v132, v132
    v_rsq_f32 v133, v133
    v_rsq_f32 v134, v134
    v_rsq_f32 v135, v135
    buffer_load_dwordx4 v225, s[24:27], s58 offen offset:1024 nt lds
    v_fma_f32 v104, -v108, v61, v104
    v_fma_f32 v105, -v109, v61, v105
    v_fma_f32 v106, -v110, v61, v106
    v_fma_f32 v107, -v111, v61, v107
    v_fma_f32 v104, v104, v132, v62
    v_fma_f32 v105, v105, v133, v62
    v_fma_f32 v106, v106, v134, v62
    v_fma_f32 v107, v107, v135, v62
    v_max3_f32 v1, v104, v105, v106
    v_max_f32 v1, v1, v107
    v_cmp_lt_f32 vcc, s52, v1
    s_cbranch_vccnz L_site9
L_back9:
    s_add_u32 m0, s41, 8192
    s_add_u32 s58, s37, 147968
    buffer_load_dwordx4 v224, s[24:27], s58 offen offset:0 nt lds
    v_exp_f32 v112, v104
    v_exp_f32 v113, v105
    v_exp_f32 v114, v106
    v_exp_f32 v115, v107
    v_cvt_pk_bf16_f32 v72, v88, v89
    v_cvt_pk_bf16_f32 v73, v90, v91
    v_mul_f32 v104, v112, v132
    v_mul_f32 v105, v113, v133
    v_mul_f32 v106, v114, v134
    v_mul_f32 v107, v115, v135
    v_cvt_pk_bf16_f32 v74, v104, v105
    v_cvt_pk_bf16_f32 v75, v106, v107
    ds_write_b128 v237, v[72:75] offset:0
    v_add_f32 v68, v68, v104
    v_add_f32 v69, v69, v105
    v_add_f32 v70, v70, v106
    v_add_f32 v71, v71, v107
    v_cvt_pk_bf16_f32 v66, v68, v69
    v_cvt_pk_bf16_f32 v67, v70, v71
    ds_write_b64 v238, v[66:67]
    s_lshl_b32 s56, s3, 13
    v_lshl_add_u32 v233, v0, 7, s56
    v_min_u32 v233, L_hot - L_tail, v233
    v_add_u32 v233, L_tail - L_pc_main, v233
    global_load_dword v234, v233, s[100:101]
    s_waitcnt vmcnt(12)
    s_waitcnt lgkmcnt(0)
    s_barrier
L_post9:
    ds_read_b32 v9, v254 offset:4096
    ds_read_b64 v[120:121], v254 offset:0
    ds_read_b64 v[122:123], v254 offset:512
    ds_read_b64 v[124:125], v254 offset:1024
    ds_read_b64 v[126:127], v254 offset:1536
    ds_read_b128 v[92:95], v253 offset:0
    ds_read_b128 v[96:99], v253 offset:1024
    ds_read_b128 v[100:103], v253 offset:2048
    ds_read_b128 v[116:119], v253 offset:3072
    ds_read_b128 a[48:51], v34 offset:0
    ds_read_b128 a[52:55], v35 offset:0
    ds_read_b128 a[56:59], v34 offset:128
    ds_read_b128 a[60:63], v35 offset:128
    ds_read_b128 a[64:67], v34 offset:256
    ds_read_b128 a[68:71], v35 offset:256
    s_waitcnt lgkmcnt(14)
    v_cmp_ne_u32 vcc, 0, v9
    s_cbranch_vccnz L_xt9
    s_waitcnt lgkmcnt(12)
    v_mfma_f32_16x16x32_bf16 a[0:3], a[72:75], v[120:123], a[0:3]
    buffer_load_dwordx4 v225, s[24:27], s58 offen offset:1024 nt lds
    v_add_f32 v63, v63, v112
    v_fma_f32 v64, v104, v108, v64
    v_mfma_f32_16x16x32_bf16 a[4:7], a[80:83], v[120:123], a[4:7]
    v_add_f32 v63, v63, v113
    v_fma_f32 v64, v105, v109, v64
    v_mfma_f32_16x16x32_bf16 a[8:11], a[88:91], v[120:123], a[8:11]
    v_add_f32 v63, v63, v114
    v_fma_f32 v64, v106, v110, v64
    s_waitcnt lgkmcnt(10)
    v_mfma_f32_16x16x32_bf16 a[0:3], a[76:79], v[124:127], a[0:3]
    v_add_f32 v63, v63, v115
    v_fma_f32 v64, v107, v111, v64
    v_mfma_f32_16x16x32_bf16 a[4:7], a[84:87], v[124:127], a[4:7]
    v_mfma_f32_16x16x32_bf16 a[8:11], a[92:95], v[124:127], a[8:11]
    s_waitcnt lgkmcnt(9)
    v_mfma_f32_16x16x32_bf16 a[0:3], a[144:147], v[92:95], a[0:3]
    ds_read_b64_tr_b16 a[72:73], v36 offset:0
    ds_read_b64_tr_b16 a[74:75], v36 offset:6144
    v_mfma_f32_16x16x32_bf16 a[4:7], a[160:163], v[92:95], a[4:7]
    ds_read_b64_tr_b16 a[76:77], v36 offset:12288
    ds_read_b64_tr_b16 a[78:79], v36 offset:18432
    v_mfma_f32_16x16x32_bf16 a[8:11], a[176:179], v[92:95], a[8:11]
    s_add_u32 m0, s41, 10240
    s_add_u32 s58, s37, 148096
    buffer_load_dwordx4 v224, s[24:27], s58 offen offset:0 nt lds
    ds_read_b64_tr_b16 a[80:81], v37 offset:0
    ds_read_b64_tr_b16 a[82:83], v37 offset:6144
    s_waitcnt lgkmcnt(14)
    v_mfma_f32_16x16x32_bf16 a[0:3], a[148:151], v[96:99], a[0:3]
    ds_read_b64_tr_b16 a[84:85], v37 offset:12288
    ds_read_b64_tr_b16 a[86:87], v37 offset:18432
    v_mfma_f32_16x16x32_bf16 a[4:7], a[164:167], v[96:99], a[4:7]
    ds_read_b64_tr_b16 a[88:89], v38 offset:0
    ds_read_b64_tr_b16 a[90:91], v38 offset:6144
    v_mfma_f32_16x16x32_bf16 a[8:11], a[180:183], v[96:99], a[8:11]
    ds_read_b64_tr_b16 a[92:93], v38 offset:12288
    ds_read_b64_tr_b16 a[94:95], v38 offset:18432
    s_waitcnt lgkmcnt(15)
    v_mfma_f32_16x16x32_bf16 a[0:3], a[152:155], v[100:103], a[0:3]
    v_mfma_f32_16x16x32_bf16 a[4:7], a[168:171], v[100:103], a[4:7]
    v_mfma_f32_16x16x32_bf16 a[8:11], a[184:187], v[100:103], a[8:11]
    v_mfma_f32_16x16x32_bf16 a[0:3], a[156:159], v[116:119], a[0:3]
    v_mfma_f32_16x16x32_bf16 a[4:7], a[172:175], v[116:119], a[4:7]
    v_mfma_f32_16x16x32_bf16 a[8:11], a[188:191], v[116:119], a[8:11]
    v_mfma_f32_16x16x32_bf16 v[84:87], a[48:51], a[48:51], 0
    v_mfma_f32_16x16x32_bf16 v[80:83], a[48:51], v[52:55], 0
    buffer_load_dwordx4 v[188:191], v65, s[72:75], s61 offen offset:3072 sc1
    v_mfma_f32_16x16x32_bf16 v[84:87], a[52:55], a[52:55], v[84:87]
    buffer_load_dwordx4 v225, s[24:27], s58 offen offset:1024 nt lds
    v_mfma_f32_16x16x32_bf16 v[80:83], a[52:55], v[52:55], v[80:83]
    v_mfma_f32_16x16x32_bf16 v[84:87], a[56:59], a[56:59], v[84:87]
    v_mfma_f32_16x16x32_bf16 v[80:83], a[56:59], v[52:55], v[80:83]
    s_waitcnt lgkmcnt(14)
    v_mfma_f32_16x16x32_bf16 v[84:87], a[60:63], a[60:63], v[84:87]
    v_mfma_f32_16x16x32_bf16 v[80:83], a[60:63], v[52:55], v[80:83]
    s_waitcnt lgkmcnt(13)
    v_mfma_f32_16x16x32_bf16 v[84:87], a[64:67], a[64:67], v[84:87]
    v_mfma_f32_16x16x32_bf16 v[80:83], a[64:67], v[52:55], v[80:83]
    s_waitcnt lgkmcnt(12)
    v_mfma_f32_16x16x32_bf16 v[84:87], a[68:71], a[68:71], v[84:87]
    v_mfma_f32_16x16x32_bf16 v[80:83], a[68:71], v[52:55], v[80:83]
    s_waitcnt lgkmcnt(0)
    v_mfma_f32_16x16x32_bf16 v[76:79], a[48:51], v[136:139], 0
    v_mfma_f32_16x16x32_bf16 v[76:79], a[52:55], v[140:143], v[76:79]
    v_mfma_f32_16x16x32_bf16 v[76:79], a[56:59], v[144:147], v[76:79]
    s_add_u32 m0, s42, 0
    s_add_u32 s59, s37, 344064
    buffer_load_dwordx4 v224, s[24:27], s59 offen offset:0 nt lds
    v_mfma_f32_16x16x32_bf16 v[76:79], a[60:63], v[148:151], v[76:79]
    v_mfma_f32_16x16x32_bf16 v[76:79], a[64:67], v[152:155], v[76:79]
    v_mfma_f32_16x16x32_bf16 v[76:79], a[68:71], v[156:159], v[76:79]
    s_mul_i32 s28, s3, 131072
    s_and_b32 s56, s2, 7
    s_lshl_b32 s56, s56, 10
    s_add_u32 s28, s28, s56
    s_bfe_u32 s56, s2, 0x30003
    s_lshl_b32 s56, s56, 7
    s_add_u32 s28, s28, s56
    s_lshr_b32 s56, s2, 6
    s_lshl_b32 s56, s56, 13
    s_add_u32 s28, s28, s56
    s_add_u32 s28, s28, 65536
    s_sub_u32 s29, s2, 64
    s_mul_i32 s30, s29, 32768
    s_lshl_b32 s56, s3, 13
    s_add_u32 s30, s30, s56
    s_add_u32 s30, s30, 65536
    s_add_u32 s31, s30, 4096
    v_mov_b32 v28, v242
    v_bfe_u32 v1, v0, 4, 1
    v_mul_u32_u24 v2, 32768, v1
    v_mul_u32_u24 v1, 0x70, v1
    v_xor_b32 v242, v242, v1
    v_sub_u32 v242, v242, v2
    v_add_u32 v243, 32768, v242
    v_mov_b32 v232, 0x53800000
    s_mov_b32 s43, 1
    s_mov_b32 s68, s18
    s_mov_b32 s69, s19
    s_mov_b32 s70, 6144
    s_mov_b32 s71, 0x20000
L_tail:
    v_and_b32 v1, 15, v0
    v_lshlrev_b32 v1, 8, v1
    v_sub_u32 v1, v34, v1
    v_lshrrev_b32 v2, 2, v0
    v_lshlrev_b32 v2, 8, v2
    s_sub_u32 s56, s41, s40
    v_add_u32 v40, s56, v1
    v_xor_b32 v41, 64, v40
    s_sub_u32 s56, s42, s40
    v_add_u32 v42, s56, v1
    v_xor_b32 v43, 64, v42
    s_mul_i32 s56, s3, 3
    s_add_u32 s57, s56, 0
    s_lshr_b32 s57, s57, 2
    s_mul_i32 s57, s57, 1920
    s_add_u32 s57, s57, 24576
    v_sub_u32 v44, v36, v2
    v_add_u32 v44, s57, v44
    v_add_u32 v47, 49152, v44
    s_add_u32 s57, s56, 1
    s_lshr_b32 s57, s57, 2
    s_mul_i32 s57, s57, 1920
    s_add_u32 s57, s57, 24576
    v_sub_u32 v45, v37, v2
    v_add_u32 v45, s57, v45
    v_add_u32 v48, 49152, v45
    s_add_u32 s57, s56, 2
    s_lshr_b32 s57, s57, 2
    s_mul_i32 s57, s57, 1920
    s_add_u32 s57, s57, 24576
    v_sub_u32 v46, v38, v2
    v_add_u32 v46, s57, v46
    v_add_u32 v49, 49152, v46
    v_accvgpr_read_b32 v16, a0
    v_accvgpr_read_b32 v17, a1
    v_accvgpr_read_b32 v18, a2
    v_accvgpr_read_b32 v19, a3
    v_accvgpr_read_b32 v20, a4
    v_accvgpr_read_b32 v21, a5
    v_accvgpr_read_b32 v22, a6
    v_accvgpr_read_b32 v23, a7
    v_accvgpr_read_b32 v24, a8
    v_accvgpr_read_b32 v25, a9
    v_accvgpr_read_b32 v26, a10
    v_accvgpr_read_b32 v27, a11
    buffer_load_dwordx4 v225, s[24:27], s59 offen offset:1024 nt lds
    s_add_u32 m0, s42, 2048
    s_add_u32 s59, s37, 344192
    buffer_load_dwordx4 v224, s[24:27], s59 offen offset:0 nt lds
    s_waitcnt vmcnt(12)
    s_barrier
    ds_read_b128 a[96:99], v40 offset:0
    ds_read_b128 a[100:103], v41 offset:0
    ds_read_b128 a[104:107], v40 offset:2048
    ds_read_b128 a[108:111], v41 offset:2048
    ds_read_b128 a[112:115], v40 offset:4096
    ds_read_b128 a[116:119], v41 offset:4096
    s_waitcnt lgkmcnt(5)
    v_mfma_f32_16x16x32_bf16 v[96:99], a[96:99], a[96:99], v[84:87]
    ds_read_b64_tr_b16 a[144:145], v44 offset:0
    ds_read_b64_tr_b16 a[148:149], v44 offset:12288
    v_mfma_f32_16x16x32_bf16 v[100:103], a[96:99], a[48:51], 0
    ds_read_b64_tr_b16 a[152:153], v44 offset:24576
    ds_read_b64_tr_b16 a[156:157], v44 offset:36864
    s_waitcnt lgkmcnt(8)
    v_mfma_f32_16x16x32_bf16 v[96:99], a[100:103], a[100:103], v[96:99]
    ds_read_b64_tr_b16 a[160:161], v45 offset:0
    ds_read_b64_tr_b16 a[164:165], v45 offset:12288
    v_mfma_f32_16x16x32_bf16 v[100:103], a[100:103], a[52:55], v[100:103]
    ds_read_b64_tr_b16 a[168:169], v45 offset:24576
    ds_read_b64_tr_b16 a[172:173], v45 offset:36864
    s_waitcnt lgkmcnt(11)
    v_mfma_f32_16x16x32_bf16 v[96:99], a[104:107], a[104:107], v[96:99]
    buffer_load_dwordx4 v225, s[24:27], s59 offen offset:1024 nt lds
    ds_read_b64_tr_b16 a[176:177], v46 offset:0
    ds_read_b64_tr_b16 a[180:181], v46 offset:12288
    v_mfma_f32_16x16x32_bf16 v[100:103], a[104:107], a[56:59], v[100:103]
    s_add_u32 m0, s42, 4096
    s_add_u32 s59, s37, 344320
    buffer_load_dwordx4 v224, s[24:27], s59 offen offset:0 nt lds
    ds_read_b64_tr_b16 a[184:185], v46 offset:24576
    ds_read_b64_tr_b16 a[188:189], v46 offset:36864
    s_waitcnt lgkmcnt(14)
    v_mfma_f32_16x16x32_bf16 v[96:99], a[108:111], a[108:111], v[96:99]
    v_mfma_f32_16x16x32_bf16 v[100:103], a[108:111], a[60:63], v[100:103]
    s_waitcnt lgkmcnt(13)
    v_mfma_f32_16x16x32_bf16 v[96:99], a[112:115], a[112:115], v[96:99]
    v_mfma_f32_16x16x32_bf16 v[100:103], a[112:115], a[64:67], v[100:103]
    s_waitcnt lgkmcnt(12)
    v_mfma_f32_16x16x32_bf16 v[96:99], a[116:119], a[116:119], v[96:99]
    v_mfma_f32_16x16x32_bf16 v[100:103], a[116:119], a[68:71], v[100:103]
    v_mfma_f32_16x16x32_bf16 v[92:95], a[96:99], v[52:55], v[80:83]
    v_mfma_f32_16x16x32_bf16 v[92:95], a[100:103], v[52:55], v[92:95]
    v_mfma_f32_16x16x32_bf16 v[92:95], a[104:107], v[52:55], v[92:95]
    v_mfma_f32_16x16x32_bf16 v[92:95], a[108:111], v[52:55], v[92:95]
    buffer_load_dwordx4 v225, s[24:27], s59 offen offset:1024 nt lds
    s_nop 2
    v_fma_f32 v96, v100, 2.0, v96
    v_fma_f32 v97, v101, 2.0, v97
    v_mfma_f32_16x16x32_bf16 v[92:95], a[112:115], v[52:55], v[92:95]
    v_fma_f32 v98, v102, 2.0, v98
    v_fma_f32 v99, v103, 2.0, v99
    v_mfma_f32_16x16x32_bf16 v[92:95], a[116:119], v[52:55], v[92:95]
    v_cndmask_b32 v3, 0, v96, s[44:45]
    v_cndmask_b32 v3, v3, v97, s[46:47]
    v_mfma_f32_16x16x32_bf16 v[88:91], a[96:99], v[136:139], v[76:79]
    v_cndmask_b32 v3, v3, v98, s[48:49]
    v_cndmask_b32 v3, v3, v99, s[50:51]
    v_mfma_f32_16x16x32_bf16 v[88:91], a[100:103], v[140:143], v[88:91]
    s_nop 0
    s_nop 0
    v_mfma_f32_16x16x32_bf16 v[88:91], a[104:107], v[144:147], v[88:91]
    v_mfma_f32_16x16x4_f32 v[120:123], v3, v60, v[56:59]
    v_mfma_f32_16x16x32_bf16 v[88:91], a[108:111], v[148:151], v[88:91]
    v_mfma_f32_16x16x32_bf16 v[88:91], a[112:115], v[152:155], v[88:91]
    v_mfma_f32_16x16x32_bf16 v[88:91], a[116:119], v[156:159], v[88:91]
    s_nop 6
    v_fma_f32 v128, -v92, v92, v120
    v_fma_f32 v129, -v93, v93, v121
    v_fma_f32 v130, -v94, v94, v122
    v_fma_f32 v131, -v95, v95, v123
    v_max_f32 v128, v128, v56
    v_max_f32 v129, v129, v56
    v_max_f32 v130, v130, v56
    v_max_f32 v131, v131, v56
    v_rsq_f32 v128, v128
    v_rsq_f32 v129, v129
    v_rsq_f32 v130, v130
    v_rsq_f32 v131, v131
    s_add_u32 m0, s42, 6144
    s_add_u32 s59, s37, 344448
    buffer_load_dwordx4 v224, s[24:27], s59 offen offset:0 nt lds
    v_fma_f32 v88, -v92, v61, v88
    v_fma_f32 v89, -v93, v61, v89
    v_fma_f32 v90, -v94, v61, v90
    v_fma_f32 v91, -v95, v61, v91
    v_fma_f32 v88, v88, v128, v62
    v_fma_f32 v89, v89, v129, v62
    buffer_load_dwordx4 v225, s[24:27], s59 offen offset:1024 nt lds
    v_fma_f32 v90, v90, v130, v62
    v_fma_f32 v91, v91, v131, v62
    v_max3_f32 v1, v88, v89, v90
    v_max_f32 v1, v1, v91
    v_cmp_lt_f32 vcc, s52, v1
    s_cbranch_vccnz L_site10
L_back10:
    v_exp_f32 v96, v88
    v_exp_f32 v97, v89
    v_exp_f32 v98, v90
    v_exp_f32 v99, v91
    v_mul_f32 v88, v96, v128
    v_mul_f32 v89, v97, v129
    v_mul_f32 v90, v98, v130
    v_mul_f32 v91, v99, v131
    v_add_f32 v63, v63, v96
    v_fmac_f32 v64, v88, v92
    v_add_f32 v63, v63, v97
    v_fmac_f32 v64, v89, v93
    v_add_f32 v63, v63, v98
    v_fmac_f32 v64, v90, v94
    v_add_f32 v63, v63, v99
    v_fmac_f32 v64, v91, v95
    v_mov_b32 v68, v88
    v_mov_b32 v69, v89
    v_mov_b32 v70, v90
    v_mov_b32 v71, v91
    s_waitcnt vmcnt(14)
    ds_read_b128 a[120:123], v40 offset:6144
    ds_read_b128 a[124:127], v41 offset:6144
    s_waitcnt lgkmcnt(1)
    v_mfma_f32_16x16x32_bf16 v[112:115], a[120:123], a[120:123], v[84:87]
    s_add_u32 m0, s42, 8192
    s_add_u32 s59, s37, 344576
    buffer_load_dwordx4 v224, s[24:27], s59 offen offset:0 nt lds
    v_mfma_f32_16x16x32_bf16 v[116:119], a[120:123], a[48:51], 0
    s_waitcnt lgkmcnt(0)
    v_mfma_f32_16x16x32_bf16 v[112:115], a[124:127], a[124:127], v[112:115]
    v_mfma_f32_16x16x32_bf16 v[116:119], a[124:127], a[52:55], v[116:119]
    v_mfma_f32_16x16x32_bf16 v[108:111], a[120:123], v[52:55], v[80:83]
    v_mfma_f32_16x16x32_bf16 v[104:107], a[120:123], v[136:139], v[76:79]
    s_waitcnt vmcnt(12)
    ds_read_b128 a[128:131], v40 offset:8192
    ds_read_b128 a[132:135], v41 offset:8192
    v_mfma_f32_16x16x32_bf16 v[108:111], a[124:127], v[52:55], v[108:111]
    buffer_load_dwordx4 v225, s[24:27], s59 offen offset:1024 nt lds
    v_mfma_f32_16x16x32_bf16 v[104:107], a[124:127], v[140:143], v[104:107]
    s_add_u32 m0, s42, 10240
    s_add_u32 s59, s37, 344704
    buffer_load_dwordx4 v224, s[24:27], s59 offen offset:0 nt lds
    s_waitcnt lgkmcnt(1)
    v_mfma_f32_16x16x32_bf16 v[112:115], a[128:131], a[128:131], v[112:115]
    v_mfma_f32_16x16x32_bf16 v[116:119], a[128:131], a[56:59], v[116:119]
    s_waitcnt lgkmcnt(0)
    v_mfma_f32_16x16x32_bf16 v[112:115], a[132:135], a[132:135], v[112:115]
    v_mfma_f32_16x16x32_bf16 v[116:119], a[132:135], a[60:63], v[116:119]
    v_mfma_f32_16x16x32_bf16 v[108:111], a[128:131], v[52:55], v[108:111]
    v_mfma_f32_16x16x32_bf16 v[104:107], a[128:131], v[144:147], v[104:107]
    buffer_load_dwordx4 v225, s[24:27], s59 offen offset:1024 nt lds
    s_waitcnt vmcnt(12)
    ds_read_b128 a[136:139], v40 offset:10240
    ds_read_b128 a[140:143], v41 offset:10240
    s_barrier
    s_add_u32 s61, s60, 3153920
    buffer_load_dwordx4 v[192:195], v65, s[32:35], s61 offen offset:0 sc1
    v_mfma_f32_16x16x32_bf16 v[108:111], a[132:135], v[52:55], v[108:111]
    ds_read_b64_tr_b16 a[146:147], v44 offset:6144
    v_mfma_f32_16x16x32_bf16 v[104:107], a[132:135], v[148:151], v[104:107]
    ds_read_b64_tr_b16 a[150:151], v44 offset:18432
    s_waitcnt lgkmcnt(3)
    v_mfma_f32_16x16x32_bf16 v[112:115], a[136:139], a[136:139], v[112:115]
    ds_read_b64_tr_b16 a[154:155], v44 offset:30720
    v_mfma_f32_16x16x32_bf16 v[116:119], a[136:139], a[64:67], v[116:119]
    ds_read_b64_tr_b16 a[158:159], v44 offset:43008
    s_waitcnt lgkmcnt(4)
    v_mfma_f32_16x16x32_bf16 v[112:115], a[140:143], a[140:143], v[112:115]
    ds_read_b64_tr_b16 a[162:163], v45 offset:6144
    v_mfma_f32_16x16x32_bf16 v[116:119], a[140:143], a[68:71], v[116:119]
    ds_read_b64_tr_b16 a[166:167], v45 offset:18432
    v_mfma_f32_16x16x32_bf16 v[108:111], a[136:139], v[52:55], v[108:111]
    ds_read_b64_tr_b16 a[170:171], v45 offset:30720
    v_mfma_f32_16x16x32_bf16 v[108:111], a[140:143], v[52:55], v[108:111]
    ds_read_b64_tr_b16 a[174:175], v45 offset:43008
    s_nop 2
    v_fma_f32 v112, v116, 2.0, v112
    v_fma_f32 v113, v117, 2.0, v113
    v_fma_f32 v114, v118, 2.0, v114
    v_fma_f32 v115, v119, 2.0, v115
    v_cndmask_b32 v4, 0, v112, s[44:45]
    v_cndmask_b32 v4, v4, v113, s[46:47]
    v_cndmask_b32 v4, v4, v114, s[48:49]
    v_cndmask_b32 v4, v4, v115, s[50:51]
    ds_read_b64_tr_b16 a[178:179], v46 offset:6144
    ds_read_b64_tr_b16 a[182:183], v46 offset:18432
    v_mfma_f32_16x16x4_f32 v[124:127], v4, v60, v[56:59]
    ds_read_b64_tr_b16 a[186:187], v46 offset:30720
    ds_read_b64_tr_b16 a[190:191], v46 offset:43008
    buffer_load_dwordx4 v[196:199], v65, s[32:35], s61 offen offset:1024 sc1
    s_nop 5
    v_mfma_f32_16x16x32_bf16 v[104:107], a[136:139], v[152:155], v[104:107]
    v_fma_f32 v132, -v108, v108, v124
    v_fma_f32 v133, -v109, v109, v125
    v_mfma_f32_16x16x32_bf16 v[104:107], a[140:143], v[156:159], v[104:107]
    v_fma_f32 v134, -v110, v110, v126
    v_fma_f32 v135, -v111, v111, v127
    v_max_f32 v132, v132, v56
    v_max_f32 v133, v133, v56
    v_max_f32 v134, v134, v56
    v_max_f32 v135, v135, v56
    v_rsq_f32 v132, v132
    v_rsq_f32 v133, v133
    v_rsq_f32 v134, v134
    v_rsq_f32 v135, v135
    v_pk_fma_f32 v[104:105], v[108:109], v[60:61], v[104:105] op_sel:[0,1,0] neg_lo:[1,0,0] neg_hi:[1,0,0]
    v_pk_fma_f32 v[106:107], v[110:111], v[60:61], v[106:107] op_sel:[0,1,0] neg_lo:[1,0,0] neg_hi:[1,0,0]
    v_pk_fma_f32 v[104:105], v[104:105], v[132:133], v[62:63] op_sel_hi:[1,1,0]
    v_pk_fma_f32 v[106:107], v[106:107], v[134:135], v[62:63] op_sel_hi:[1,1,0]
L_back11:
    v_max3_f32 v1, v104, v105, v106
    v_max_f32 v1, v1, v107
    v_cmp_lt_f32 vcc, s52, v1
    v_exp_f32 v112, v104
    v_exp_f32 v113, v105
    v_exp_f32 v114, v106
    v_exp_f32 v115, v107
    s_cbranch_vccnz L_site11
    v_cvt_pk_bf16_f32 v72, v88, v89
    v_cvt_pk_bf16_f32 v73, v90, v91
    v_pk_mul_f32 v[104:105], v[112:113], v[132:133]
    v_pk_mul_f32 v[106:107], v[114:115], v[134:135]
    v_cvt_pk_bf16_f32 v74, v104, v105
    v_cvt_pk_bf16_f32 v75, v106, v107
    ds_write_b128 v237, v[72:75] offset:12288
    s_waitcnt lgkmcnt(0)
    s_barrier
    ds_read_b32 v9, v254 offset:4100
    ds_read_b128 a[192:195], v253 offset:12288
    ds_read_b128 a[196:199], v253 offset:13312
    ds_read_b128 a[200:203], v253 offset:14336
    ds_read_b128 a[204:207], v253 offset:15360
    buffer_load_dwordx4 v[200:203], v65, s[32:35], s61 offen offset:2048 sc1
    buffer_load_dwordx4 v[204:207], v65, s[32:35], s61 offen offset:3072 sc1
    s_waitcnt lgkmcnt(4)
    v_cmp_ne_u32 vcc, 0, v9
    s_cbranch_vccnz L_xt11
L_post11:
    s_waitcnt lgkmcnt(3)
    v_mfma_f32_16x16x32_bf16 v[16:19], a[144:147], a[192:195], v[16:19]
    v_add_f32 v68, v68, v104
    v_add_f32 v69, v69, v105
    v_mfma_f32_16x16x32_bf16 v[20:23], a[160:163], a[192:195], v[20:23]
    v_add_f32 v70, v70, v106
    v_add_f32 v71, v71, v107
    v_mfma_f32_16x16x32_bf16 v[24:27], a[176:179], a[192:195], v[24:27]
    v_add_f32 v63, v63, v112
    v_fma_f32 v64, v104, v108, v64
    s_waitcnt lgkmcnt(2)
    v_mfma_f32_16x16x32_bf16 v[16:19], a[148:151], a[196:199], v[16:19]
    s_waitcnt vmcnt(14)
    ds_read_b128 a[96:99], v42 offset:0
    ds_read_b128 a[100:103], v43 offset:0
    v_mfma_f32_16x16x32_bf16 v[20:23], a[164:167], a[196:199], v[20:23]
    v_add_f32 v63, v63, v113
    v_fma_f32 v64, v105, v109, v64
    v_mfma_f32_16x16x32_bf16 v[24:27], a[180:183], a[196:199], v[24:27]
    v_add_f32 v63, v63, v114
    v_fma_f32 v64, v106, v110, v64
    s_waitcnt lgkmcnt(3)
    v_mfma_f32_16x16x32_bf16 v[16:19], a[152:155], a[200:203], v[16:19]
    v_add_f32 v63, v63, v115
    v_fma_f32 v64, v107, v111, v64
    v_mfma_f32_16x16x32_bf16 v[20:23], a[168:171], a[200:203], v[20:23]
    s_waitcnt vmcnt(12)
    ds_read_b128 a[104:107], v42 offset:2048
    ds_read_b128 a[108:111], v43 offset:2048
    v_mfma_f32_16x16x32_bf16 v[24:27], a[184:187], a[200:203], v[24:27]
    s_waitcnt lgkmcnt(4)
    v_mfma_f32_16x16x32_bf16 v[16:19], a[156:159], a[204:207], v[16:19]
    v_mfma_f32_16x16x32_bf16 v[20:23], a[172:175], a[204:207], v[20:23]
    v_mfma_f32_16x16x32_bf16 v[24:27], a[188:191], a[204:207], v[24:27]
    s_waitcnt lgkmcnt(3)
    v_mfma_f32_16x16x32_bf16 v[96:99], a[96:99], a[96:99], v[84:87]
    v_mfma_f32_16x16x32_bf16 v[100:103], a[96:99], a[48:51], 0
    s_waitcnt lgkmcnt(2)
    v_mfma_f32_16x16x32_bf16 v[96:99], a[100:103], a[100:103], v[96:99]
    v_mfma_f32_16x16x32_bf16 v[100:103], a[100:103], a[52:55], v[100:103]
    s_waitcnt vmcnt(10)
    ds_read_b128 a[112:115], v42 offset:4096
    ds_read_b128 a[116:119], v43 offset:4096
    s_barrier
    v_mfma_f32_16x16x32_bf16 v[92:95], a[96:99], v[52:55], v[80:83]
    s_add_u32 s61, s60, 3158016
    buffer_load_dwordx4 v[208:211], v65, s[32:35], s61 offen offset:0 sc1
    ds_read_b64_tr_b16 a[0:1], v47 offset:0
    v_mfma_f32_16x16x32_bf16 v[88:91], a[96:99], v[136:139], v[76:79]
    ds_read_b64_tr_b16 a[4:5], v47 offset:12288
    v_mfma_f32_16x16x32_bf16 v[92:95], a[100:103], v[52:55], v[92:95]
    ds_read_b64_tr_b16 a[8:9], v47 offset:24576
    v_mfma_f32_16x16x32_bf16 v[88:91], a[100:103], v[140:143], v[88:91]
    ds_read_b64_tr_b16 a[12:13], v47 offset:36864
    s_waitcnt lgkmcnt(7)
    v_mfma_f32_16x16x32_bf16 v[96:99], a[104:107], a[104:107], v[96:99]
    buffer_load_dwordx4 v[212:215], v65, s[32:35], s61 offen offset:1024 sc1
    ds_read_b64_tr_b16 a[16:17], v48 offset:0
    v_mfma_f32_16x16x32_bf16 v[100:103], a[104:107], a[56:59], v[100:103]
    ds_read_b64_tr_b16 a[20:21], v48 offset:12288
    s_waitcnt lgkmcnt(8)
    v_mfma_f32_16x16x32_bf16 v[96:99], a[108:111], a[108:111], v[96:99]
    ds_read_b64_tr_b16 a[24:25], v48 offset:24576
    v_mfma_f32_16x16x32_bf16 v[100:103], a[108:111], a[60:63], v[100:103]
    ds_read_b64_tr_b16 a[28:29], v48 offset:36864
    v_mfma_f32_16x16x32_bf16 v[92:95], a[104:107], v[52:55], v[92:95]
    buffer_load_dwordx4 v[216:219], v65, s[32:35], s61 offen offset:2048 sc1
    ds_read_b64_tr_b16 a[32:33], v49 offset:0
    v_mfma_f32_16x16x32_bf16 v[88:91], a[104:107], v[144:147], v[88:91]
    ds_read_b64_tr_b16 a[36:37], v49 offset:12288
    v_mfma_f32_16x16x32_bf16 v[92:95], a[108:111], v[52:55], v[92:95]
    ds_read_b64_tr_b16 a[40:41], v49 offset:24576
    v_mfma_f32_16x16x32_bf16 v[88:91], a[108:111], v[148:151], v[88:91]
    ds_read_b64_tr_b16 a[44:45], v49 offset:36864
    s_waitcnt lgkmcnt(13)
    v_mfma_f32_16x16x32_bf16 v[96:99], a[112:115], a[112:115], v[96:99]
    v_mfma_f32_16x16x32_bf16 v[100:103], a[112:115], a[64:67], v[100:103]
    s_waitcnt lgkmcnt(12)
    v_mfma_f32_16x16x32_bf16 v[96:99], a[116:119], a[116:119], v[96:99]
    v_mfma_f32_16x16x32_bf16 v[100:103], a[116:119], a[68:71], v[100:103]
    s_waitcnt vmcnt(11)
    ds_read_b128 a[120:123], v42 offset:6144
    ds_read_b128 a[124:127], v43 offset:6144
    buffer_load_dwordx4 v[220:223], v65, s[32:35], s61 offen offset:3072 sc1
    v_mfma_f32_16x16x32_bf16 v[92:95], a[112:115], v[52:55], v[92:95]
    v_mfma_f32_16x16x32_bf16 v[92:95], a[116:119], v[52:55], v[92:95]
    s_nop 1
    v_fma_f32 v96, v100, 2.0, v96
    v_fma_f32 v97, v101, 2.0, v97
    v_mfma_f32_16x16x32_bf16 v[88:91], a[112:115], v[152:155], v[88:91]
    v_fma_f32 v98, v102, 2.0, v98
    v_fma_f32 v99, v103, 2.0, v99
    v_mfma_f32_16x16x32_bf16 v[88:91], a[116:119], v[156:159], v[88:91]
    v_cndmask_b32 v3, 0, v96, s[44:45]
    v_cndmask_b32 v3, v3, v97, s[46:47]
    v_cndmask_b32 v3, v3, v98, s[48:49]
    v_cndmask_b32 v3, v3, v99, s[50:51]
    s_nop 0
    s_nop 0
    v_mfma_f32_16x16x4_f32 v[120:123], v3, v60, v[56:59]
    s_waitcnt lgkmcnt(1)
    v_mfma_f32_16x16x32_bf16 v[112:115], a[120:123], a[120:123], v[84:87]
    v_mfma_f32_16x16x32_bf16 v[116:119], a[120:123], a[48:51], 0
    s_waitcnt vmcnt(10)
    ds_read_b128 a[128:131], v42 offset:8192
    ds_read_b128 a[132:135], v43 offset:8192
    s_add_u32 s61, s60, 3162112
    buffer_load_dwordx4 v[224:227], v65, s[32:35], s61 offen offset:0 sc1
    s_waitcnt lgkmcnt(2)
    v_mfma_f32_16x16x32_bf16 v[112:115], a[124:127], a[124:127], v[112:115]
    v_fma_f32 v128, -v92, v92, v120
    v_fma_f32 v129, -v93, v93, v121
    v_fma_f32 v130, -v94, v94, v122
    v_mfma_f32_16x16x32_bf16 v[116:119], a[124:127], a[52:55], v[116:119]
    v_fma_f32 v131, -v95, v95, v123
    v_max_f32 v128, v128, v56
    v_max_f32 v129, v129, v56
    v_mfma_f32_16x16x32_bf16 v[108:111], a[120:123], v[52:55], v[80:83]
    v_max_f32 v130, v130, v56
    v_max_f32 v131, v131, v56
    v_mfma_f32_16x16x32_bf16 v[104:107], a[120:123], v[136:139], v[76:79]
    v_rsq_f32 v128, v128
    v_mfma_f32_16x16x32_bf16 v[108:111], a[124:127], v[52:55], v[108:111]
    v_rsq_f32 v129, v129
    v_mfma_f32_16x16x32_bf16 v[104:107], a[124:127], v[140:143], v[104:107]
    v_rsq_f32 v130, v130
    s_waitcnt lgkmcnt(1)
    v_mfma_f32_16x16x32_bf16 v[112:115], a[128:131], a[128:131], v[112:115]
    v_rsq_f32 v131, v131
    v_fma_f32 v88, -v92, v61, v88
    v_mfma_f32_16x16x32_bf16 v[116:119], a[128:131], a[56:59], v[116:119]
    v_fma_f32 v89, -v93, v61, v89
    v_fma_f32 v90, -v94, v61, v90
    v_fma_f32 v91, -v95, v61, v91
    s_waitcnt lgkmcnt(0)
    v_mfma_f32_16x16x32_bf16 v[112:115], a[132:135], a[132:135], v[112:115]
    v_fma_f32 v88, v88, v128, v62
    v_fma_f32 v89, v89, v129, v62
    v_fma_f32 v90, v90, v130, v62
    v_mfma_f32_16x16x32_bf16 v[116:119], a[132:135], a[60:63], v[116:119]
    v_fma_f32 v91, v91, v131, v62
    v_max3_f32 v1, v88, v89, v90
    v_max_f32 v1, v1, v91
    v_mfma_f32_16x16x32_bf16 v[108:111], a[128:131], v[52:55], v[108:111]
    v_cmp_lt_f32 vcc, s52, v1
    s_cbranch_vccnz L_site12
L_back12:
    v_mfma_f32_16x16x32_bf16 v[104:107], a[128:131], v[144:147], v[104:107]
    s_waitcnt vmcnt(9)
    ds_read_b128 a[136:139], v42 offset:10240
    ds_read_b128 a[140:143], v43 offset:10240
    s_barrier
    buffer_load_dwordx4 v[228:231], v65, s[32:35], s61 offen offset:1024 sc1
    s_cmp_eq_u32 s0, 1
    s_cbranch_scc0 L_nolate
    s_add_u32 s56, s60, 3145728
    buffer_load_dwordx4 v[160:163], v65, s[32:35], s56 offen offset:0 sc1
    buffer_load_dwordx4 v[164:167], v65, s[32:35], s56 offen offset:1024 sc1
    buffer_load_dwordx4 v[168:171], v65, s[32:35], s56 offen offset:2048 sc1
    buffer_load_dwordx4 v[172:175], v65, s[32:35], s56 offen offset:3072 sc1
    s_add_u32 s56, s60, 3149824
    buffer_load_dwordx4 v[176:179], v65, s[32:35], s56 offen offset:0 sc1
    buffer_load_dwordx4 v[180:183], v65, s[32:35], s56 offen offset:1024 sc1
    buffer_load_dwordx4 v[184:187], v65, s[32:35], s56 offen offset:2048 sc1
    buffer_load_dwordx4 v[188:191], v65, s[32:35], s56 offen offset:3072 sc1
L_nolate:
    buffer_load_dword v244, v28, s[32:35], s28 offen
    v_mfma_f32_16x16x32_bf16 v[108:111], a[132:135], v[52:55], v[108:111]
    ds_read_b64_tr_b16 a[2:3], v47 offset:6144
    v_exp_f32 v96, v88
    v_mfma_f32_16x16x32_bf16 v[104:107], a[132:135], v[148:151], v[104:107]
    ds_read_b64_tr_b16 a[6:7], v47 offset:18432
    v_exp_f32 v97, v89
    s_waitcnt lgkmcnt(3)
    v_mfma_f32_16x16x32_bf16 v[112:115], a[136:139], a[136:139], v[112:115]
    ds_read_b64_tr_b16 a[10:11], v47 offset:30720
    v_exp_f32 v98, v90
    v_mfma_f32_16x16x32_bf16 v[116:119], a[136:139], a[64:67], v[116:119]
    ds_read_b64_tr_b16 a[14:15], v47 offset:43008
    v_exp_f32 v99, v91
    s_waitcnt lgkmcnt(4)
    v_mfma_f32_16x16x32_bf16 v[112:115], a[140:143], a[140:143], v[112:115]
    ds_read_b64_tr_b16 a[18:19], v48 offset:6144
    v_mul_f32 v88, v96, v128
    v_mul_f32 v89, v97, v129
    v_mfma_f32_16x16x32_bf16 v[116:119], a[140:143], a[68:71], v[116:119]
    ds_read_b64_tr_b16 a[22:23], v48 offset:18432
    v_mul_f32 v90, v98, v130
    v_mul_f32 v91, v99, v131
    v_mfma_f32_16x16x32_bf16 v[108:111], a[136:139], v[52:55], v[108:111]
    ds_read_b64_tr_b16 a[26:27], v48 offset:30720
    v_add_f32 v63, v63, v96
    v_fmac_f32 v64, v88, v92
    v_mfma_f32_16x16x32_bf16 v[108:111], a[140:143], v[52:55], v[108:111]
    ds_read_b64_tr_b16 a[30:31], v48 offset:43008
    v_add_f32 v63, v63, v97
    v_fmac_f32 v64, v89, v93
    v_add_f32 v63, v63, v98
    v_fma_f32 v112, v116, 2.0, v112
    v_fma_f32 v113, v117, 2.0, v113
    v_fma_f32 v114, v118, 2.0, v114
    v_fma_f32 v115, v119, 2.0, v115
    v_cndmask_b32 v4, 0, v112, s[44:45]
    v_cndmask_b32 v4, v4, v113, s[46:47]
    v_cndmask_b32 v4, v4, v114, s[48:49]
    v_cndmask_b32 v4, v4, v115, s[50:51]
    ds_read_b64_tr_b16 a[34:35], v49 offset:6144
    ds_read_b64_tr_b16 a[38:39], v49 offset:18432
    v_mfma_f32_16x16x4_f32 v[124:127], v4, v60, v[56:59]
    ds_read_b64_tr_b16 a[42:43], v49 offset:30720
    ds_read_b64_tr_b16 a[46:47], v49 offset:43008
    v_fmac_f32 v64, v90, v94
    v_add_f32 v63, v63, v99
    v_fmac_f32 v64, v91, v95
    v_add_f32 v68, v68, v88
    v_add_f32 v69, v69, v89
    v_add_f32 v70, v70, v90
    v_add_f32 v71, v71, v91
    v_mfma_f32_16x16x32_bf16 v[104:107], a[136:139], v[152:155], v[104:107]
    v_cvt_pk_bf16_f32 v72, v88, v89
    v_cvt_pk_bf16_f32 v73, v90, v91
    v_mfma_f32_16x16x32_bf16 v[104:107], a[140:143], v[156:159], v[104:107]
    v_fma_f32 v132, -v108, v108, v124
    v_fma_f32 v133, -v109, v109, v125
    v_fma_f32 v134, -v110, v110, v126
    v_fma_f32 v135, -v111, v111, v127
    v_max_f32 v132, v132, v56
    v_max_f32 v133, v133, v56
    v_max_f32 v134, v134, v56
    v_max_f32 v135, v135, v56
    v_rsq_f32 v132, v132
    v_rsq_f32 v133, v133
    v_rsq_f32 v134, v134
    v_rsq_f32 v135, v135
    v_pk_fma_f32 v[104:105], v[108:109], v[60:61], v[104:105] op_sel:[0,1,0] neg_lo:[1,0,0] neg_hi:[1,0,0]
    v_pk_fma_f32 v[106:107], v[110:111], v[60:61], v[106:107] op_sel:[0,1,0] neg_lo:[1,0,0] neg_hi:[1,0,0]
    v_pk_fma_f32 v[104:105], v[104:105], v[132:133], v[62:63] op_sel_hi:[1,1,0]
    v_pk_fma_f32 v[106:107], v[106:107], v[134:135], v[62:63] op_sel_hi:[1,1,0]
L_back13:
    v_max3_f32 v1, v104, v105, v106
    v_max_f32 v1, v1, v107
    v_cmp_lt_f32 vcc, s52, v1
    v_exp_f32 v112, v104
    v_exp_f32 v113, v105
    v_exp_f32 v114, v106
    v_exp_f32 v115, v107
    s_cbranch_vccnz L_site13
    v_pk_mul_f32 v[104:105], v[112:113], v[132:133]
    v_pk_mul_f32 v[106:107], v[114:115], v[134:135]
    v_cvt_pk_bf16_f32 v74, v104, v105
    v_cvt_pk_bf16_f32 v75, v106, v107
    ds_write_b128 v237, v[72:75] offset:0
    v_pk_add_f32 v[68:69], v[68:69], v[104:105]
    v_pk_add_f32 v[70:71], v[70:71], v[106:107]
    v_pk_add_f32 v[112:113], v[112:113], v[114:115]
    v_cvt_pk_bf16_f32 v66, v68, v69
    v_cvt_pk_bf16_f32 v67, v70, v71
    ds_write_b64 v238, v[66:67]
    v_pk_mul_f32 v[114:115], v[104:105], v[108:109]
    v_add_f32 v63, v63, v112
    v_pk_fma_f32 v[114:115], v[106:107], v[110:111], v[114:115]
    v_add_f32 v10, v63, v113
    v_add_f32 v64, v64, v114
    v_add_f32 v11, v64, v115
    ds_write_b64 v238, v[10:11] offset:2048
L_merge:
    s_waitcnt lgkmcnt(0)
    s_barrier
L_postx:
    ds_read_b32 v9, v254 offset:4096
    ds_read_b128 v[92:95], v253 offset:0
    ds_read_b128 v[96:99], v253 offset:1024
    ds_read_b128 v[100:103], v253 offset:2048
    ds_read_b64 v[136:137], v254 offset:2048
    ds_read_b64 v[138:139], v254 offset:2560
    ds_read_b64 v[140:141], v254 offset:3072
    ds_read_b64 v[142:143], v254 offset:3584
    ds_read_b128 v[116:119], v253 offset:3072
    ds_read_b64 v[120:121], v254 offset:0
    ds_read_b64 v[122:123], v254 offset:512
    s_waitcnt lgkmcnt(10)
    v_cmp_ne_u32 vcc, 0, v9
    s_cbranch_vccnz L_xlast
    s_waitcnt lgkmcnt(9)
    v_mfma_f32_16x16x32_bf16 v[16:19], a[0:3], v[92:95], v[16:19]
    ds_read_b64 v[124:125], v254 offset:1024
    v_mfma_f32_16x16x32_bf16 v[20:23], a[16:19], v[92:95], v[20:23]
    ds_read_b64 v[126:127], v254 offset:1536
    v_mfma_f32_16x16x32_bf16 v[24:27], a[32:35], v[92:95], v[24:27]
    s_waitcnt lgkmcnt(10)
    v_mfma_f32_16x16x32_bf16 v[16:19], a[4:7], v[96:99], v[16:19]
    v_mfma_f32_16x16x32_bf16 v[20:23], a[20:23], v[96:99], v[20:23]
    v_mfma_f32_16x16x32_bf16 v[24:27], a[36:39], v[96:99], v[24:27]
    s_waitcnt lgkmcnt(9)
    v_mfma_f32_16x16x32_bf16 v[16:19], a[8:11], v[100:103], v[16:19]
    s_waitcnt lgkmcnt(5)
    v_add_f32 v1, v136, v138
    v_add_f32 v2, v137, v139
    v_add_f32 v140, v140, v142
    v_mfma_f32_16x16x32_bf16 v[20:23], a[24:27], v[100:103], v[20:23]
    v_add_f32 v141, v141, v143
    v_add_f32 v1, v1, v140
    v_add_f32 v2, v2, v141
    v_mfma_f32_16x16x32_bf16 v[24:27], a[40:43], v[100:103], v[24:27]
    s_nop 0
    v_permlane32_swap_b32 v1, v2
    v_add_f32 v1, v1, v2
    v_mov_b32 v2, v1
    s_waitcnt lgkmcnt(4)
    v_mfma_f32_16x16x32_bf16 v[16:19], a[12:15], v[116:119], v[16:19]
    v_permlane16_swap_b32 v1, v2
    v_add_f32 v1, v1, v2
    v_mov_b32 v2, v1
    s_waitcnt lgkmcnt(2)
    v_mfma_f32_16x16x32_bf16 v[16:19], a[72:75], v[120:123], v[16:19]
    v_permlane32_swap_b32 v1, v2
    v_rcp_f32 v3, v1
    s_waitcnt lgkmcnt(0)
    v_mfma_f32_16x16x32_bf16 v[16:19], a[76:79], v[124:127], v[16:19]
    v_log_f32 v4, v1
    v_mul_f32 v5, v60, v3
    v_mfma_f32_16x16x32_bf16 v[20:23], a[28:31], v[116:119], v[20:23]
    v_mul_f32 v6, v2, v3
    v_sub_f32 v4, v4, v255
    v_mfma_f32_16x16x32_bf16 v[20:23], a[80:83], v[120:123], v[20:23]
    v_mfma_f32_16x16x32_bf16 v[20:23], a[84:87], v[124:127], v[20:23]
    v_mfma_f32_16x16x32_bf16 v[24:27], a[44:47], v[116:119], v[24:27]
    v_fma_f32 v16, v16, v5, -v6
    v_fma_f32 v17, v17, v5, -v6
    v_mfma_f32_16x16x32_bf16 v[24:27], a[88:91], v[120:123], v[24:27]
    v_fma_f32 v18, v18, v5, -v6
    v_fma_f32 v19, v19, v5, -v6
    v_mfma_f32_16x16x32_bf16 v[24:27], a[92:95], v[124:127], v[24:27]
    v_cvt_pk_bf16_f32 v66, v16, v17
    v_cvt_pk_bf16_f32 v67, v18, v19
    ds_write_b64 v236, v[66:67] offset:0
    v_pk_fma_f32 v[20:21], v[20:21], v[4:5], v[6:7] op_sel:[0,1,0] op_sel_hi:[1,1,0] neg_lo:[0,0,1] neg_hi:[0,0,1]
    v_pk_fma_f32 v[22:23], v[22:23], v[4:5], v[6:7] op_sel:[0,1,0] op_sel_hi:[1,1,0] neg_lo:[0,0,1] neg_hi:[0,0,1]
    v_cvt_pk_bf16_f32 v68, v20, v21
    v_cvt_pk_bf16_f32 v69, v22, v23
    ds_write_b64 v236, v[68:69] offset:512
    v_pk_fma_f32 v[24:25], v[24:25], v[4:5], v[6:7] op_sel:[0,1,0] op_sel_hi:[1,1,0] neg_lo:[0,0,1] neg_hi:[0,0,1]
    v_pk_fma_f32 v[26:27], v[26:27], v[4:5], v[6:7] op_sel:[0,1,0] op_sel_hi:[1,1,0] neg_lo:[0,0,1] neg_hi:[0,0,1]
    v_cvt_pk_bf16_f32 v70, v24, v25
    v_cvt_pk_bf16_f32 v71, v26, v27
    ds_write_b64 v236, v[70:71] offset:1024
    s_waitcnt lgkmcnt(0)
    s_barrier
    ds_read_b128 v[136:139], v241 offset:0
    ds_read_b128 v[140:143], v241 offset:1024
    ds_read_b128 v[144:147], v241 offset:2048
    ds_read_b128 v[148:151], v241 offset:3072
    ds_read_b128 v[152:155], v241 offset:4096
    ds_read_b128 v[156:159], v241 offset:5120
    s_waitcnt vmcnt(1)
    v_mov_b32 v35, v4
    v_add_u32 v39, s39, v4
    s_waitcnt lgkmcnt(5)
    v_mfma_f32_16x16x32_bf16 v[16:19], v[160:163], v[136:139], 0
    v_mfma_f32_16x16x32_bf16 v[20:23], v[184:187], v[136:139], 0
    v_mfma_f32_16x16x32_bf16 v[24:27], v[208:211], v[136:139], 0
    s_waitcnt lgkmcnt(4)
    v_mfma_f32_16x16x32_bf16 v[16:19], v[164:167], v[140:143], v[16:19]
    v_mfma_f32_16x16x32_bf16 v[20:23], v[188:191], v[140:143], v[20:23]
    v_mfma_f32_16x16x32_bf16 v[24:27], v[212:215], v[140:143], v[24:27]
    s_waitcnt lgkmcnt(3)
    v_mfma_f32_16x16x32_bf16 v[16:19], v[168:171], v[144:147], v[16:19]
    v_mfma_f32_16x16x32_bf16 v[20:23], v[192:195], v[144:147], v[20:23]
    v_mfma_f32_16x16x32_bf16 v[24:27], v[216:219], v[144:147], v[24:27]
    s_waitcnt lgkmcnt(2)
    v_mfma_f32_16x16x32_bf16 v[16:19], v[172:175], v[148:151], v[16:19]
    s_waitcnt lgkmcnt(1)
    v_mfma_f32_16x16x32_bf16 v[16:19], v[176:179], v[152:155], v[16:19]
    s_waitcnt lgkmcnt(0)
    v_mfma_f32_16x16x32_bf16 v[16:19], v[180:183], v[156:159], v[16:19]
    v_mfma_f32_16x16x32_bf16 v[20:23], v[196:199], v[148:151], v[20:23]
    v_mfma_f32_16x16x32_bf16 v[20:23], v[200:203], v[152:155], v[20:23]
    v_mfma_f32_16x16x32_bf16 v[20:23], v[204:207], v[156:159], v[20:23]
    v_mfma_f32_16x16x32_bf16 v[24:27], v[220:223], v[148:151], v[24:27]
    v_mfma_f32_16x16x32_bf16 v[24:27], v[224:227], v[152:155], v[24:27]
    s_nop 2
    v_cvt_pk_bf16_f32 v32, v16, v17
    v_mfma_f32_16x16x32_bf16 v[24:27], v[228:231], v[156:159], v[24:27]
    v_cvt_pk_bf16_f32 v33, v18, v19
    v_cvt_pk_bf16_f32 v34, v20, v21
    v_cvt_pk_bf16_f32 v36, v22, v23
    v_permlane16_swap_b32 v35, v39
    s_nop 0
    v_permlane16_swap_b32 v32, v36
    s_nop 1
    v_cvt_pk_bf16_f32 v37, v24, v25
    v_cvt_pk_bf16_f32 v38, v26, v27
    s_nop 0
    v_permlane16_swap_b32 v33, v37
    v_permlane16_swap_b32 v34, v38
    buffer_store_dwordx4 v[32:35], v242, s[32:35], s28 offen sc1
    buffer_store_dwordx4 v[36:39], v243, s[32:35], s28 offen sc1
    s_cmp_lt_u32 s29, 64
    s_cbranch_scc0 L_fin
    buffer_load_dwordx4 v[76:79], v65, s[32:35], s30 offen offset:0 sc1
    buffer_load_dwordx4 v[80:83], v65, s[32:35], s30 offen offset:1024 sc1
    buffer_load_dwordx4 v[84:87], v65, s[32:35], s30 offen offset:2048 sc1
    buffer_load_dwordx4 v[108:111], v65, s[32:35], s30 offen offset:3072 sc1
    buffer_load_dwordx4 v[112:115], v65, s[32:35], s31 offen offset:0 sc1
    buffer_load_dwordx4 v[128:131], v65, s[32:35], s31 offen offset:1024 sc1
    buffer_load_dwordx4 v[132:135], v65, s[32:35], s31 offen offset:2048 sc1
    buffer_load_dwordx4 v[52:55], v65, s[32:35], s31 offen offset:3072 sc1
    ds_bpermute_b32 v42, v252, v4
    v_bfe_u32 v48, v0, 2, 1
    v_cmp_eq_u32 vcc, 1, v48
    v_mov_b32 v246, s39
    s_movk_i32 s26, 0x101
    v_cndmask_b32 v247, 0, v246, vcc
    v_sub_u32 v246, v246, v247
    v_sub_u32 v246, v246, v247
    v_mov_b32 v16, 0
    v_mov_b32 v17, 0
    v_mov_b32 v18, 0
    v_mov_b32 v19, 0
    v_mov_b32 v20, 0
    v_mov_b32 v21, 0
    v_mov_b32 v22, 0
    v_mov_b32 v97, 0
    s_mov_b32 s53, 0
    s_waitcnt vmcnt(0)
    v_sub_u32_dpp v136, v79, v79 row_half_mirror row_mask:0xf bank_mask:0xf
    v_sub_u32_dpp v137, v83, v83 row_half_mirror row_mask:0xf bank_mask:0xf
    v_sub_u32_dpp v138, v87, v87 row_half_mirror row_mask:0xf bank_mask:0xf
    v_sub_u32_dpp v139, v111, v111 row_half_mirror row_mask:0xf bank_mask:0xf
    v_sub_u32_dpp v140, v115, v115 row_half_mirror row_mask:0xf bank_mask:0xf
    v_sub_u32_dpp v141, v131, v131 row_half_mirror row_mask:0xf bank_mask:0xf
    v_sub_u32_dpp v142, v135, v135 row_half_mirror row_mask:0xf bank_mask:0xf
    v_sub_u32_dpp v143, v55, v55 row_half_mirror row_mask:0xf bank_mask:0xf
    v_cmp_eq_u32 s[6:7], v136, v246
    v_mov_b32 v136, 0x101
    v_cmp_eq_u32 s[8:9], v137, v246
    v_mov_b32 v137, 0x202
    v_cmp_eq_u32 s[10:11], v138, v246
    v_mov_b32 v138, 0x404
    v_cmp_eq_u32 s[12:13], v139, v246
    v_mov_b32 v139, 0x808
    v_cmp_eq_u32 s[14:15], v140, v246
    v_mov_b32 v140, 0x1010
    v_cmp_eq_u32 s[16:17], v141, v246
    v_mov_b32 v141, 0x2020
    v_cmp_eq_u32 s[36:37], v142, v246
    v_mov_b32 v142, 0x4040
    v_cmp_eq_u32 s[40:41], v143, v246
    v_mov_b32 v143, 0x8080
    v_cndmask_b32 v136, v136, 0, s[6:7]
    v_cndmask_b32 v137, v137, 0, s[8:9]
    v_cndmask_b32 v138, v138, 0, s[10:11]
    v_cndmask_b32 v139, v139, 0, s[12:13]
    v_cndmask_b32 v140, v140, 0, s[14:15]
    v_cndmask_b32 v141, v141, 0, s[16:17]
    v_cndmask_b32 v142, v142, 0, s[36:37]
    v_cndmask_b32 v143, v143, 0, s[40:41]
    v_or3_b32 v96, v136, v137, v138
    v_or3_b32 v139, v139, v140, v141
    v_or3_b32 v96, v96, v142, v143
    v_or_b32 v96, v96, v139
    v_cmp_ne_u32 s[24:25], 0, v96
    s_waitcnt lgkmcnt(0)
    v_lshrrev_b32 v48, v97, v96
    v_ffbl_b32 v48, v48
    v_add_u32 v48, v48, v97
    v_and_b32 v48, 7, v48
    v_lshl_add_u32 v51, v48, 10, v65
    v_lshlrev_b32 v88, v48, s26
    v_add_u32 v97, 1, v48
    s_mov_b64 exec, s[24:25]
    buffer_load_dwordx4 v[136:139], v51, s[32:35], s30 offen sc1
    s_mov_b64 exec, -1
    s_mov_b64 exec, s[6:7]
    v_sub_u32 v49, v79, v247
    v_sub_f32 v49, v49, v42
    v_exp_f32 v49, v49
    s_nop 0
    v_cvt_pk_bf16_f32 v49, v49, 0
    v_lshlrev_b32 v50, 16, v49
    v_dot2_f32_bf16 v16, v76, v49, v16
    v_dot2_f32_bf16 v18, v77, v49, v18
    v_dot2_f32_bf16 v20, v78, v49, v20
    v_add_f32 v22, v22, v50
    v_dot2_f32_bf16 v17, v76, v50, v17
    v_dot2_f32_bf16 v19, v77, v50, v19
    v_dot2_f32_bf16 v21, v78, v50, v21
    s_mov_b64 exec, -1
    s_mov_b64 exec, s[8:9]
    v_sub_u32 v49, v83, v247
    v_sub_f32 v49, v49, v42
    v_exp_f32 v49, v49
    s_nop 0
    v_cvt_pk_bf16_f32 v49, v49, 0
    v_lshlrev_b32 v50, 16, v49
    v_dot2_f32_bf16 v16, v80, v49, v16
    v_dot2_f32_bf16 v18, v81, v49, v18
    v_dot2_f32_bf16 v20, v82, v49, v20
    v_add_f32 v22, v22, v50
    v_dot2_f32_bf16 v17, v80, v50, v17
    v_dot2_f32_bf16 v19, v81, v50, v19
    v_dot2_f32_bf16 v21, v82, v50, v21
    s_mov_b64 exec, -1
    v_lshrrev_b32 v48, v97, v96
    v_ffbl_b32 v48, v48
    v_add_u32 v48, v48, v97
    v_and_b32 v48, 7, v48
    v_lshl_add_u32 v51, v48, 10, v65
    v_lshlrev_b32 v89, v48, s26
    v_add_u32 v97, 1, v48
    s_mov_b64 exec, s[24:25]
    buffer_load_dwordx4 v[140:143], v51, s[32:35], s30 offen sc1
    s_mov_b64 exec, -1
    s_mov_b64 exec, s[10:11]
    v_sub_u32 v49, v87, v247
    v_sub_f32 v49, v49, v42
    v_exp_f32 v49, v49
    s_nop 0
    v_cvt_pk_bf16_f32 v49, v49, 0
    v_lshlrev_b32 v50, 16, v49
    v_dot2_f32_bf16 v16, v84, v49, v16
    v_dot2_f32_bf16 v18, v85, v49, v18
    v_dot2_f32_bf16 v20, v86, v49, v20
    v_add_f32 v22, v22, v50
    v_dot2_f32_bf16 v17, v84, v50, v17
    v_dot2_f32_bf16 v19, v85, v50, v19
    v_dot2_f32_bf16 v21, v86, v50, v21
    s_mov_b64 exec, -1
    s_mov_b64 exec, s[12:13]
    v_sub_u32 v49, v111, v247
    v_sub_f32 v49, v49, v42
    v_exp_f32 v49, v49
    s_nop 0
    v_cvt_pk_bf16_f32 v49, v49, 0
    v_lshlrev_b32 v50, 16, v49
    v_dot2_f32_bf16 v16, v108, v49, v16
    v_dot2_f32_bf16 v18, v109, v49, v18
    v_dot2_f32_bf16 v20, v110, v49, v20
    v_add_f32 v22, v22, v50
    v_dot2_f32_bf16 v17, v108, v50, v17
    v_dot2_f32_bf16 v19, v109, v50, v19
    v_dot2_f32_bf16 v21, v110, v50, v21
    s_mov_b64 exec, -1
    v_lshrrev_b32 v48, v97, v96
    v_ffbl_b32 v48, v48
    v_add_u32 v48, v48, v97
    v_and_b32 v48, 7, v48
    v_lshl_add_u32 v51, v48, 10, v65
    v_lshlrev_b32 v90, v48, s26
    v_add_u32 v97, 1, v48
    s_mov_b64 exec, s[24:25]
    buffer_load_dwordx4 v[144:147], v51, s[32:35], s30 offen sc1
    s_mov_b64 exec, -1
    s_mov_b64 exec, s[14:15]
    v_sub_u32 v49, v115, v247
    v_sub_f32 v49, v49, v42
    v_exp_f32 v49, v49
    s_nop 0
    v_cvt_pk_bf16_f32 v49, v49, 0
    v_lshlrev_b32 v50, 16, v49
    v_dot2_f32_bf16 v16, v112, v49, v16
    v_dot2_f32_bf16 v18, v113, v49, v18
    v_dot2_f32_bf16 v20, v114, v49, v20
    v_add_f32 v22, v22, v50
    v_dot2_f32_bf16 v17, v112, v50, v17
    v_dot2_f32_bf16 v19, v113, v50, v19
    v_dot2_f32_bf16 v21, v114, v50, v21
    s_mov_b64 exec, -1
    s_mov_b64 exec, s[16:17]
    v_sub_u32 v49, v131, v247
    v_sub_f32 v49, v49, v42
    v_exp_f32 v49, v49
    s_nop 0
    v_cvt_pk_bf16_f32 v49, v49, 0
    v_lshlrev_b32 v50, 16, v49
    v_dot2_f32_bf16 v16, v128, v49, v16
    v_dot2_f32_bf16 v18, v129, v49, v18
    v_dot2_f32_bf16 v20, v130, v49, v20
    v_add_f32 v22, v22, v50
    v_dot2_f32_bf16 v17, v128, v50, v17
    v_dot2_f32_bf16 v19, v129, v50, v19
    v_dot2_f32_bf16 v21, v130, v50, v21
    s_mov_b64 exec, -1
    v_lshrrev_b32 v48, v97, v96
    v_ffbl_b32 v48, v48
    v_add_u32 v48, v48, v97
    v_and_b32 v48, 7, v48
    v_lshl_add_u32 v51, v48, 10, v65
    v_lshlrev_b32 v91, v48, s26
    v_add_u32 v97, 1, v48
    s_mov_b64 exec, s[24:25]
    buffer_load_dwordx4 v[148:151], v51, s[32:35], s30 offen sc1
    s_mov_b64 exec, -1
    s_mov_b64 exec, s[36:37]
    v_sub_u32 v49, v135, v247
    v_sub_f32 v49, v49, v42
    v_exp_f32 v49, v49
    s_nop 0
    v_cvt_pk_bf16_f32 v49, v49, 0
    v_lshlrev_b32 v50, 16, v49
    v_dot2_f32_bf16 v16, v132, v49, v16
    v_dot2_f32_bf16 v18, v133, v49, v18
    v_dot2_f32_bf16 v20, v134, v49, v20
    v_add_f32 v22, v22, v50
    v_dot2_f32_bf16 v17, v132, v50, v17
    v_dot2_f32_bf16 v19, v133, v50, v19
    v_dot2_f32_bf16 v21, v134, v50, v21
    s_mov_b64 exec, -1
    s_mov_b64 exec, s[40:41]
    v_sub_u32 v49, v55, v247
    v_sub_f32 v49, v49, v42
    v_exp_f32 v49, v49
    s_nop 0
    v_cvt_pk_bf16_f32 v49, v49, 0
    v_lshlrev_b32 v50, 16, v49
    v_dot2_f32_bf16 v16, v52, v49, v16
    v_dot2_f32_bf16 v18, v53, v49, v18
    v_dot2_f32_bf16 v20, v54, v49, v20
    v_add_f32 v22, v22, v50
    v_dot2_f32_bf16 v17, v52, v50, v17
    v_dot2_f32_bf16 v19, v53, v50, v19
    v_dot2_f32_bf16 v21, v54, v50, v21
    s_mov_b64 exec, -1
    s_cmp_eq_u64 s[24:25], 0
    s_cbranch_scc1 L_c_red
L_c_loop:
    s_waitcnt vmcnt(3)
    v_sub_u32_dpp v48, v139, v139 row_half_mirror row_mask:0xf bank_mask:0xf
    v_and_b32 v49, v88, v96
    v_cmp_eq_u32 vcc, v48, v246
    v_cmp_ne_u32 s[24:25], 0, v49
    s_and_b64 exec, vcc, s[24:25]
    s_cbranch_scc0 L_c_s0
    v_xor_b32 v96, v96, v88
    v_sub_u32 v49, v139, v247
    v_sub_f32 v49, v49, v42
    v_exp_f32 v49, v49
    s_nop 0
    v_cvt_pk_bf16_f32 v49, v49, 0
    v_lshlrev_b32 v50, 16, v49
    v_dot2_f32_bf16 v16, v136, v49, v16
    v_dot2_f32_bf16 v18, v137, v49, v18
    v_dot2_f32_bf16 v20, v138, v49, v20
    v_add_f32 v22, v22, v50
    v_dot2_f32_bf16 v17, v136, v50, v17
    v_dot2_f32_bf16 v19, v137, v50, v19
    v_dot2_f32_bf16 v21, v138, v50, v21
L_c_s0:
    s_mov_b64 exec, -1
    v_cmp_ne_u32 vcc, 0, v96
    v_lshrrev_b32 v48, v97, v96
    s_cbranch_vccz L_c_red
    v_ffbl_b32 v48, v48
    v_add_u32 v48, v48, v97
    v_and_b32 v48, 7, v48
    v_lshl_add_u32 v51, v48, 10, v65
    v_lshlrev_b32 v88, v48, s26
    v_add_u32 v97, 1, v48
    s_mov_b64 exec, vcc
    buffer_load_dwordx4 v[136:139], v51, s[32:35], s30 offen sc1
    s_mov_b64 exec, -1
    s_waitcnt vmcnt(3)
    v_sub_u32_dpp v48, v143, v143 row_half_mirror row_mask:0xf bank_mask:0xf
    v_and_b32 v49, v89, v96
    v_cmp_eq_u32 vcc, v48, v246
    v_cmp_ne_u32 s[24:25], 0, v49
    s_and_b64 exec, vcc, s[24:25]
    s_cbranch_scc0 L_c_s1
    v_xor_b32 v96, v96, v89
    v_sub_u32 v49, v143, v247
    v_sub_f32 v49, v49, v42
    v_exp_f32 v49, v49
    s_nop 0
    v_cvt_pk_bf16_f32 v49, v49, 0
    v_lshlrev_b32 v50, 16, v49
    v_dot2_f32_bf16 v16, v140, v49, v16
    v_dot2_f32_bf16 v18, v141, v49, v18
    v_dot2_f32_bf16 v20, v142, v49, v20
    v_add_f32 v22, v22, v50
    v_dot2_f32_bf16 v17, v140, v50, v17
    v_dot2_f32_bf16 v19, v141, v50, v19
    v_dot2_f32_bf16 v21, v142, v50, v21
L_c_s1:
    s_mov_b64 exec, -1
    v_cmp_ne_u32 vcc, 0, v96
    v_lshrrev_b32 v48, v97, v96
    s_cbranch_vccz L_c_red
    v_ffbl_b32 v48, v48
    v_add_u32 v48, v48, v97
    v_and_b32 v48, 7, v48
    v_lshl_add_u32 v51, v48, 10, v65
    v_lshlrev_b32 v89, v48, s26
    v_add_u32 v97, 1, v48
    s_mov_b64 exec, vcc
    buffer_load_dwordx4 v[140:143], v51, s[32:35], s30 offen sc1
    s_mov_b64 exec, -1
    s_waitcnt vmcnt(3)
    v_sub_u32_dpp v48, v147, v147 row_half_mirror row_mask:0xf bank_mask:0xf
    v_and_b32 v49, v90, v96
    v_cmp_eq_u32 vcc, v48, v246
    v_cmp_ne_u32 s[24:25], 0, v49
    s_and_b64 exec, vcc, s[24:25]
    s_cbranch_scc0 L_c_s2
    v_xor_b32 v96, v96, v90
    v_sub_u32 v49, v147, v247
    v_sub_f32 v49, v49, v42
    v_exp_f32 v49, v49
    s_nop 0
    v_cvt_pk_bf16_f32 v49, v49, 0
    v_lshlrev_b32 v50, 16, v49
    v_dot2_f32_bf16 v16, v144, v49, v16
    v_dot2_f32_bf16 v18, v145, v49, v18
    v_dot2_f32_bf16 v20, v146, v49, v20
    v_add_f32 v22, v22, v50
    v_dot2_f32_bf16 v17, v144, v50, v17
    v_dot2_f32_bf16 v19, v145, v50, v19
    v_dot2_f32_bf16 v21, v146, v50, v21
L_c_s2:
    s_mov_b64 exec, -1
    v_cmp_ne_u32 vcc, 0, v96
    v_lshrrev_b32 v48, v97, v96
    s_cbranch_vccz L_c_red
    v_ffbl_b32 v48, v48
    v_add_u32 v48, v48, v97
    v_and_b32 v48, 7, v48
    v_lshl_add_u32 v51, v48, 10, v65
    v_lshlrev_b32 v90, v48, s26
    v_add_u32 v97, 1, v48
    s_mov_b64 exec, vcc
    buffer_load_dwordx4 v[144:147], v51, s[32:35], s30 offen sc1
    s_mov_b64 exec, -1
    s_waitcnt vmcnt(3)
    v_sub_u32_dpp v48, v151, v151 row_half_mirror row_mask:0xf bank_mask:0xf
    v_and_b32 v49, v91, v96
    v_cmp_eq_u32 vcc, v48, v246
    v_cmp_ne_u32 s[24:25], 0, v49
    s_and_b64 exec, vcc, s[24:25]
    s_cbranch_scc0 L_c_s3
    v_xor_b32 v96, v96, v91
    v_sub_u32 v49, v151, v247
    v_sub_f32 v49, v49, v42
    v_exp_f32 v49, v49
    s_nop 0
    v_cvt_pk_bf16_f32 v49, v49, 0
    v_lshlrev_b32 v50, 16, v49
    v_dot2_f32_bf16 v16, v148, v49, v16
    v_dot2_f32_bf16 v18, v149, v49, v18
    v_dot2_f32_bf16 v20, v150, v49, v20
    v_add_f32 v22, v22, v50
    v_dot2_f32_bf16 v17, v148, v50, v17
    v_dot2_f32_bf16 v19, v149, v50, v19
    v_dot2_f32_bf16 v21, v150, v50, v21
L_c_s3:
    s_mov_b64 exec, -1
    v_cmp_ne_u32 vcc, 0, v96
    v_lshrrev_b32 v48, v97, v96
    s_cbranch_vccz L_c_red
    v_ffbl_b32 v48, v48
    v_add_u32 v48, v48, v97
    v_and_b32 v48, 7, v48
    v_lshl_add_u32 v51, v48, 10, v65
    v_lshlrev_b32 v91, v48, s26
    v_add_u32 v97, 1, v48
    s_mov_b64 exec, vcc
    buffer_load_dwordx4 v[148:151], v51, s[32:35], s30 offen sc1
    s_mov_b64 exec, -1
    s_add_u32 s53, s53, 1
    s_cmp_lt_u32 s53, 65536
    s_cbranch_scc1 L_c_loop
L_c_red:
    v_mov_b32 v23, v22
    v_permlane32_swap_b32 v16, v20
    v_permlane32_swap_b32 v17, v21
    v_permlane32_swap_b32 v18, v22
    v_permlane32_swap_b32 v19, v23
    v_add_f32 v16, v16, v20
    v_add_f32 v17, v17, v21
    v_add_f32 v18, v18, v22
    v_add_f32 v19, v19, v23
    s_nop 0
    v_permlane16_swap_b32 v16, v18
    v_permlane16_swap_b32 v17, v19
    v_add_f32 v16, v16, v18
    v_add_f32 v17, v17, v19
    s_nop 0
    v_add_f32_dpp v48, v16, v16 row_ror:8 row_mask:0xf bank_mask:0x3
    s_nop 1
    v_add_f32_dpp v48, v17, v17 row_ror:8 row_mask:0xf bank_mask:0xc
    ds_write_b32 v250, v48
    s_waitcnt lgkmcnt(0)
    s_barrier
    ds_read_b128 v[48:51], v251 offset:768
    ds_read_b128 v[52:55], v65
    v_lshlrev_b32 v18, 16, v249
    s_waitcnt lgkmcnt(1)
    v_add_f32 v48, v48, v49
    v_add_f32 v50, v50, v51
    v_add_f32 v48, v48, v50
    v_cmp_nlt_f32 vcc, v48, v232
    v_rcp_f32 v48, v48
    s_waitcnt lgkmcnt(0)
    s_cbranch_vccnz L_c_slow
L_c_out:
    s_cmp_lg_u32 s3, 0
    s_cbranch_scc1 L_fin
    v_add_f32 v52, v52, v53
    v_add_f32 v54, v54, v55
    v_add_f32 v52, v52, v54
    v_fmac_f32 v18, v52, v48
    v_cvt_pk_bf16_f32 v18, v18, v18
    buffer_store_short v18, v248, s[68:71], 0 offen
    s_cmp_lg_u32 s29, 0
    s_cbranch_scc1 L_fin
    v_mov_b32 v48, s39
    v_mov_b32 v49, 0
    s_mov_b64 exec, 1
    buffer_store_dword v48, v49, s[32:35], 0 offen offset:0 sc1
    s_mov_b64 exec, -1
L_fin:
L_end:
    s_endpgm
L_hot:
L_prod:
    s_cmp_lg_u32 s3, 0
    s_cbranch_scc1 L_p_noq
    s_mov_b32 m0, 147456
    s_nop 0
    buffer_load_dwordx4 v16, s[72:75], 0 offen offset:0  lds
    buffer_load_dwordx4 v17, s[72:75], 0 offen offset:1024  lds
    buffer_load_dwordx4 v18, s[72:75], 0 offen offset:2048  lds
    buffer_load_dwordx4 v19, s[72:75], 0 offen offset:3072  lds
    s_mov_b32 m0, 151552
    s_nop 0
    buffer_load_dwordx4 v20, s[72:75], 0 offen offset:0  lds
    buffer_load_dwordx4 v21, s[72:75], 0 offen offset:1024  lds
L_p_noq:
    s_mul_i32 s60, s3, 18432
    s_add_u32 m0, s60, 73728
    s_nop 0
    buffer_load_dwordx4 v16, s[64:67], s60 offen offset:0  lds
    buffer_load_dwordx4 v17, s[64:67], s60 offen offset:1024  lds
    buffer_load_dwordx4 v18, s[64:67], s60 offen offset:2048  lds
    buffer_load_dwordx4 v19, s[64:67], s60 offen offset:3072  lds
    s_add_u32 m0, s60, 77824
    s_nop 0
    buffer_load_dwordx4 v20, s[64:67], s60 offen offset:0  lds
    buffer_load_dwordx4 v21, s[64:67], s60 offen offset:1024  lds
    s_add_u32 s60, s60, 6144
    s_add_u32 m0, s60, 73728
    s_nop 0
    buffer_load_dwordx4 v16, s[64:67], s60 offen offset:0  lds
    buffer_load_dwordx4 v17, s[64:67], s60 offen offset:1024  lds
    buffer_load_dwordx4 v18, s[64:67], s60 offen offset:2048  lds
    buffer_load_dwordx4 v19, s[64:67], s60 offen offset:3072  lds
    s_add_u32 m0, s60, 77824
    s_nop 0
    buffer_load_dwordx4 v20, s[64:67], s60 offen offset:0  lds
    buffer_load_dwordx4 v21, s[64:67], s60 offen offset:1024  lds
    s_add_u32 s60, s60, 6144
    s_add_u32 m0, s60, 73728
    s_nop 0
    buffer_load_dwordx4 v16, s[64:67], s60 offen offset:0  lds
    v_mov_b32 v52, 0x3f803f80
    v_mov_b32 v56, 0x3ebcbe62
    s_mov_b32 s44, 0x100001
    s_mov_b32 s45, 0x10000100
    v_mov_b32 v53, 0x3f803f80
    v_mov_b32 v57, 0x3ebcbe62
    s_mov_b32 s46, 0x200002
    buffer_load_dwordx4 v17, s[64:67], s60 offen offset:1024  lds
    s_mov_b32 s47, 0x20000200
    v_mov_b32 v54, 0x3f803f80
    v_mov_b32 v58, 0x3ebcbe62
    s_mov_b32 s48, 0x400004
    s_mov_b32 s49, 0x40000400
    v_mov_b32 v55, 0x3f803f80
    v_mov_b32 v59, 0x3ebcbe62
    buffer_load_dwordx4 v18, s[64:67], s60 offen offset:2048  lds
    s_mov_b32 s50, 0x800008
    s_mov_b32 s51, 0x80000800
    v_mov_b32 v60, 0x43400000
    v_lshrrev_b32 v1, 5, v0
    v_lshlrev_b32 v1, 8, v1
    v_and_b32 v2, 15, v0
    v_lshl_add_u32 v1, v2, 4, v1
    buffer_load_dwordx4 v19, s[64:67], s60 offen offset:3072  lds
    v_bfe_u32 v2, v0, 4, 1
    v_lshl_add_u32 v1, v2, 3, v1
    s_mul_i32 s56, s3, 1536
    s_add_u32 s56, s56, 153600
    v_add_u32 v134, s56, v1
    v_bfe_u32 v1, v0, 4, 1
    v_lshrrev_b32 v5, 5, v0
    s_add_u32 m0, s60, 77824
    s_nop 0
    buffer_load_dwordx4 v20, s[64:67], s60 offen offset:0  lds
    v_lshl_or_b32 v1, v1, 1, v5
    v_bfe_u32 v2, v0, 2, 2
    v_lshl_add_u32 v3, v1, 3, v2
    v_mul_u32_u24 v3, 384, v3
    v_and_b32 v4, 1, v0
    v_lshl_add_u32 v3, v4, 3, v3
    v_add_u32 v3, 73728, v3
    buffer_load_dwordx4 v21, s[64:67], s60 offen offset:1024  lds
    v_and_or_b32 v2, v2, 2, v5
    v_bfe_u32 v4, v0, 1, 1
    v_xor_b32 v2, v2, v4
    s_mul_i32 s56, s3, 6
    s_add_u32 s57, s56, 0
    v_xor_b32 v4, s57, v2
    v_lshl_add_u32 v124, v4, 4, v3
    s_lshl_b32 s61, s43, 2
    s_add_u32 s61, s61, s3
    s_mul_i32 s60, s61, 6144
    s_add_u32 m0, s41, 6144
    s_nop 0
    buffer_load_dwordx4 v16, s[68:71], s60 offen offset:0  lds
    v_xor_b32 v125, 64, v124
    s_add_u32 s57, s56, 2
    v_xor_b32 v4, s57, v2
    v_lshl_add_u32 v126, v4, 4, v3
    v_xor_b32 v127, 64, v126
    s_add_u32 s57, s56, 4
    v_xor_b32 v4, s57, v2
    buffer_load_dwordx4 v17, s[68:71], s60 offen offset:1024  lds
    v_lshl_add_u32 v128, v4, 4, v3
    v_xor_b32 v129, 64, v128
    v_and_b32 v2, 15, v0
    v_bfe_u32 v3, v0, 3, 1
    v_and_or_b32 v4, v0, 6, v3
    v_xor_b32 v4, v4, v1
    v_mul_u32_u24 v2, 384, v2
    buffer_load_dwordx4 v18, s[68:71], s60 offen offset:2048  lds
    v_lshl_add_u32 v2, v4, 4, v2
    v_add_u32 v132, 147456, v2
    v_xor_b32 v133, 64, v132
    s_and_b32 s56, s3, 1
    s_lshl_b32 s56, s56, 2
    s_lshr_b32 s57, s3, 1
    s_mul_i32 s57, s57, 24576
    buffer_load_dwordx4 v19, s[68:71], s60 offen offset:3072  lds
    s_add_u32 s57, s57, 30720
    v_and_b32 v1, 11, v0
    v_or_b32 v1, s56, v1
    v_and_or_b32 v2, v1, 6, v3
    v_lshrrev_b32 v3, 4, v0
    v_xor_b32 v2, v2, v3
    v_mul_u32_u24 v1, 384, v1
    s_add_u32 m0, s41, 10240
    s_nop 0
    buffer_load_dwordx4 v20, s[68:71], s60 offen offset:0  lds
    v_lshl_add_u32 v1, v2, 4, v1
    v_bfe_u32 v2, v0, 2, 1
    v_mul_u32_u24 v2, 12288, v2
    v_add3_u32 v130, s57, v1, v2
    v_xor_b32 v131, 64, v130
    v_add_u32 v135, 153600, v65
    buffer_load_dwordx4 v21, s[68:71], s60 offen offset:1024  lds
    s_waitcnt vmcnt(24)
    s_barrier
    s_load_dword s38, s[22:23], 0
    ds_read_b128 v[136:139], v132 offset:0
    ds_read_b128 v[140:143], v133 offset:0
    ds_read_b128 v[144:147], v132 offset:128
    ds_read_b128 v[148:151], v133 offset:128
    ds_read_b128 v[152:155], v132 offset:256
    ds_read_b128 v[156:159], v133 offset:256
    s_add_u32 m0, s40, 0
    s_add_u32 s57, s36, 0
    buffer_load_dwordx4 v16, s[28:31], s57 offen offset:0 nt lds
    buffer_load_dwordx4 v17, s[28:31], s57 offen offset:1024 nt lds
    buffer_load_dwordx4 v18, s[28:31], s57 offen offset:2048 nt lds
    buffer_load_dwordx4 v19, s[28:31], s57 offen offset:3072 nt lds
    s_add_u32 m0, s40, 4096
    s_nop 0
    buffer_load_dwordx4 v20, s[28:31], s57 offen offset:0 nt lds
    buffer_load_dwordx4 v21, s[28:31], s57 offen offset:1024 nt lds
    s_waitcnt lgkmcnt(0)
    v_mfma_f32_16x16x32_bf16 v[112:115], v[136:139], v[136:139], 0
    v_mfma_f32_16x16x32_bf16 v[116:119], v[52:55], v[136:139], 0
    s_add_u32 m0, s41, 0
    s_add_u32 s58, s37, 0
    buffer_load_dwordx4 v22, s[24:27], s58 offen offset:0 nt lds
    v_mfma_f32_16x16x32_bf16 v[112:115], v[140:143], v[140:143], v[112:115]
    v_mfma_f32_16x16x32_bf16 v[116:119], v[52:55], v[140:143], v[116:119]
    buffer_load_dwordx4 v23, s[24:27], s58 offen offset:1024 nt lds
    v_mfma_f32_16x16x32_bf16 v[112:115], v[144:147], v[144:147], v[112:115]
    v_mfma_f32_16x16x32_bf16 v[116:119], v[52:55], v[144:147], v[116:119]
    buffer_load_dwordx4 v24, s[24:27], s58 offen offset:2048 nt lds
    v_mfma_f32_16x16x32_bf16 v[112:115], v[148:151], v[148:151], v[112:115]
    v_mfma_f32_16x16x32_bf16 v[116:119], v[52:55], v[148:151], v[116:119]
    v_mfma_f32_16x16x32_bf16 v[112:115], v[152:155], v[152:155], v[112:115]
    v_mfma_f32_16x16x32_bf16 v[116:119], v[52:55], v[152:155], v[116:119]
    v_mfma_f32_16x16x32_bf16 v[112:115], v[156:159], v[156:159], v[112:115]
    v_mfma_f32_16x16x32_bf16 v[116:119], v[52:55], v[156:159], v[116:119]
    s_mul_i32 s39, s38, 0x9e3779b1
    s_add_u32 s39, s39, 0x7f4a7c16
    s_or_b32 s39, s39, 1
    s_lshl_b32 s61, s61, 10
    s_add_u32 s61, s61, 16384
    s_waitcnt vmcnt(15)
    s_barrier
    ds_read_b64_tr_b16 v[160:161], v124 offset:0
    ds_read_b64_tr_b16 v[162:163], v125 offset:1536
    ds_read_b64_tr_b16 v[184:185], v126 offset:0
    ds_read_b64_tr_b16 v[186:187], v127 offset:1536
    ds_read_b64_tr_b16 v[208:209], v128 offset:0
    ds_read_b64_tr_b16 v[210:211], v129 offset:1536
    ds_read_b64_tr_b16 v[164:165], v124 offset:12288
    ds_read_b64_tr_b16 v[166:167], v125 offset:13824
    ds_read_b64_tr_b16 v[188:189], v126 offset:12288
    ds_read_b64_tr_b16 v[190:191], v127 offset:13824
    ds_read_b64_tr_b16 v[212:213], v128 offset:12288
    ds_read_b64_tr_b16 v[214:215], v129 offset:13824
    v_cndmask_b32 v3, 0, v112, s[44:45]
    v_cndmask_b32 v3, v3, v113, s[46:47]
    v_cndmask_b32 v3, v3, v114, s[48:49]
    v_cndmask_b32 v3, v3, v115, s[50:51]
    v_mul_f32 v6, 0x3baaaaab, v116
    ds_read_b64_tr_b16 v[168:169], v124 offset:24576
    ds_read_b64_tr_b16 v[170:171], v125 offset:26112
    v_mfma_f32_16x16x4_f32 v[120:123], v60, v3, v[56:59]
    s_waitcnt lgkmcnt(12)
    v_mfma_f32_16x16x32_bf16 v[88:91], v[160:163], v[136:139], 0
    ds_read_b64_tr_b16 v[192:193], v126 offset:24576
    v_mfma_f32_16x16x32_bf16 v[100:103], v[160:163], v[52:55], 0
    ds_read_b64_tr_b16 v[194:195], v127 offset:26112
    s_waitcnt lgkmcnt(12)
    v_mfma_f32_16x16x32_bf16 v[92:95], v[184:187], v[136:139], 0
    ds_read_b64_tr_b16 v[216:217], v128 offset:24576
    v_mfma_f32_16x16x32_bf16 v[104:107], v[184:187], v[52:55], 0
    ds_read_b64_tr_b16 v[218:219], v129 offset:26112
    s_waitcnt lgkmcnt(12)
    v_mfma_f32_16x16x32_bf16 v[96:99], v[208:211], v[136:139], 0
    ds_read_b64_tr_b16 v[172:173], v124 offset:36864
    v_mfma_f32_16x16x32_bf16 v[108:111], v[208:211], v[52:55], 0
    ds_read_b64_tr_b16 v[174:175], v125 offset:38400
    s_waitcnt lgkmcnt(12)
    v_mfma_f32_16x16x32_bf16 v[88:91], v[164:167], v[140:143], v[88:91]
    ds_read_b64_tr_b16 v[196:197], v126 offset:36864
    v_mfma_f32_16x16x32_bf16 v[100:103], v[164:167], v[52:55], v[100:103]
    ds_read_b64_tr_b16 v[198:199], v127 offset:38400
    s_waitcnt lgkmcnt(12)
    v_mfma_f32_16x16x32_bf16 v[92:95], v[188:191], v[140:143], v[92:95]
    ds_read_b64_tr_b16 v[220:221], v128 offset:36864
    v_mfma_f32_16x16x32_bf16 v[104:107], v[188:191], v[52:55], v[104:107]
    ds_read_b64_tr_b16 v[222:223], v129 offset:38400
    s_waitcnt lgkmcnt(12)
    v_mfma_f32_16x16x32_bf16 v[96:99], v[212:215], v[140:143], v[96:99]
    ds_read_b64_tr_b16 v[176:177], v124 offset:49152
    v_mfma_f32_16x16x32_bf16 v[108:111], v[212:215], v[52:55], v[108:111]
    ds_read_b64_tr_b16 v[178:179], v125 offset:50688
    s_waitcnt lgkmcnt(12)
    v_mfma_f32_16x16x32_bf16 v[88:91], v[168:171], v[144:147], v[88:91]
    ds_read_b64_tr_b16 v[200:201], v126 offset:49152
    v_mfma_f32_16x16x32_bf16 v[100:103], v[168:171], v[52:55], v[100:103]
    ds_read_b64_tr_b16 v[202:203], v127 offset:50688
    s_waitcnt lgkmcnt(12)
    v_mfma_f32_16x16x32_bf16 v[92:95], v[192:195], v[144:147], v[92:95]
    ds_read_b64_tr_b16 v[224:225], v128 offset:49152
    v_mfma_f32_16x16x32_bf16 v[104:107], v[192:195], v[52:55], v[104:107]
    ds_read_b64_tr_b16 v[226:227], v129 offset:50688
    s_waitcnt lgkmcnt(12)
    v_mfma_f32_16x16x32_bf16 v[96:99], v[216:219], v[144:147], v[96:99]
    ds_read_b64_tr_b16 v[180:181], v124 offset:61440
    v_mfma_f32_16x16x32_bf16 v[108:111], v[216:219], v[52:55], v[108:111]
    ds_read_b64_tr_b16 v[182:183], v125 offset:62976
    s_waitcnt lgkmcnt(12)
    v_mfma_f32_16x16x32_bf16 v[88:91], v[172:175], v[148:151], v[88:91]
    ds_read_b64_tr_b16 v[204:205], v126 offset:61440
    v_mfma_f32_16x16x32_bf16 v[100:103], v[172:175], v[52:55], v[100:103]
    ds_read_b64_tr_b16 v[206:207], v127 offset:62976
    s_waitcnt lgkmcnt(12)
    v_mfma_f32_16x16x32_bf16 v[92:95], v[196:199], v[148:151], v[92:95]
    ds_read_b64_tr_b16 v[228:229], v128 offset:61440
    v_mfma_f32_16x16x32_bf16 v[104:107], v[196:199], v[52:55], v[104:107]
    ds_read_b64_tr_b16 v[230:231], v129 offset:62976
    s_waitcnt lgkmcnt(12)
    v_mfma_f32_16x16x32_bf16 v[96:99], v[220:223], v[148:151], v[96:99]
    v_fma_f32 v5, -v116, v116, v120
    v_mfma_f32_16x16x32_bf16 v[108:111], v[220:223], v[52:55], v[108:111]
    v_max_f32 v5, v5, v56
    s_waitcnt lgkmcnt(10)
    v_mfma_f32_16x16x32_bf16 v[88:91], v[176:179], v[152:155], v[88:91]
    v_rsq_f32 v5, v5
    v_mfma_f32_16x16x32_bf16 v[100:103], v[176:179], v[52:55], v[100:103]
    v_mov_b32 v122, s39
    s_waitcnt lgkmcnt(8)
    v_mfma_f32_16x16x32_bf16 v[92:95], v[200:203], v[152:155], v[92:95]
    v_mul_f32 v5, v60, v5
    v_mfma_f32_16x16x32_bf16 v[104:107], v[200:203], v[52:55], v[104:107]
    v_mov_b32 v123, s39
    s_waitcnt lgkmcnt(6)
    v_mfma_f32_16x16x32_bf16 v[96:99], v[224:227], v[152:155], v[96:99]
    v_mfma_f32_16x16x32_bf16 v[108:111], v[224:227], v[52:55], v[108:111]
    s_waitcnt lgkmcnt(4)
    v_mfma_f32_16x16x32_bf16 v[88:91], v[180:183], v[156:159], v[88:91]
    v_mfma_f32_16x16x32_bf16 v[100:103], v[180:183], v[52:55], v[100:103]
    s_waitcnt lgkmcnt(2)
    v_mfma_f32_16x16x32_bf16 v[92:95], v[204:207], v[156:159], v[92:95]
    v_mfma_f32_16x16x32_bf16 v[104:107], v[204:207], v[52:55], v[104:107]
    s_waitcnt lgkmcnt(0)
    v_mfma_f32_16x16x32_bf16 v[96:99], v[228:231], v[156:159], v[96:99]
    v_mfma_f32_16x16x32_bf16 v[108:111], v[228:231], v[52:55], v[108:111]
    s_nop 1
    v_fma_f32 v88, -v6, v100, v88
    v_fma_f32 v89, -v6, v101, v89
    v_fma_f32 v90, -v6, v102, v90
    v_fma_f32 v91, -v6, v103, v91
    v_mul_f32 v88, v88, v5
    v_mul_f32 v89, v89, v5
    v_mul_f32 v90, v90, v5
    v_mul_f32 v91, v91, v5
    v_cvt_pk_bf16_f32 v112, v88, v89
    v_cvt_pk_bf16_f32 v113, v90, v91
    ds_write_b64 v134, v[112:113] offset:0
    v_fma_f32 v92, -v6, v104, v92
    v_fma_f32 v93, -v6, v105, v93
    v_fma_f32 v94, -v6, v106, v94
    v_fma_f32 v95, -v6, v107, v95
    v_mul_f32 v92, v92, v5
    v_mul_f32 v93, v93, v5
    v_mul_f32 v94, v94, v5
    v_mul_f32 v95, v95, v5
    v_cvt_pk_bf16_f32 v114, v92, v93
    v_cvt_pk_bf16_f32 v115, v94, v95
    ds_write_b64 v134, v[114:115] offset:512
    v_fma_f32 v96, -v6, v108, v96
    v_fma_f32 v97, -v6, v109, v97
    v_fma_f32 v98, -v6, v110, v98
    v_fma_f32 v99, -v6, v111, v99
    v_mul_f32 v96, v96, v5
    v_mul_f32 v97, v97, v5
    v_mul_f32 v98, v98, v5
    v_mul_f32 v99, v99, v5
    v_cvt_pk_bf16_f32 v116, v96, v97
    v_cvt_pk_bf16_f32 v117, v98, v99
    ds_write_b64 v134, v[116:117] offset:1024
    s_waitcnt vmcnt(9)
    s_waitcnt lgkmcnt(0)
    s_barrier
    ds_read_b128 v[136:139], v135 offset:0
    ds_read_b128 a[96:99], v130 offset:0
    ds_read_b128 v[140:143], v135 offset:1024
    ds_read_b128 a[100:103], v131 offset:0
    ds_read_b128 v[144:147], v135 offset:2048
    ds_read_b128 a[104:107], v130 offset:128
    ds_read_b128 v[148:151], v135 offset:3072
    ds_read_b128 a[108:111], v131 offset:128
    ds_read_b128 v[152:155], v135 offset:4096
    ds_read_b128 a[112:115], v130 offset:256
    ds_read_b128 v[156:159], v135 offset:5120
    ds_read_b128 a[116:119], v131 offset:256
    s_waitcnt lgkmcnt(10)
    v_mfma_f32_16x16x32_bf16 v[88:91], a[96:99], v[136:139], 0
    s_waitcnt lgkmcnt(8)
    v_mfma_f32_16x16x32_bf16 v[92:95], a[100:103], v[140:143], 0
    s_waitcnt lgkmcnt(6)
    v_mfma_f32_16x16x32_bf16 v[88:91], a[104:107], v[144:147], v[88:91]
    s_waitcnt lgkmcnt(4)
    v_mfma_f32_16x16x32_bf16 v[92:95], a[108:111], v[148:151], v[92:95]
    s_waitcnt lgkmcnt(2)
    v_mfma_f32_16x16x32_bf16 v[88:91], a[112:115], v[152:155], v[88:91]
    s_waitcnt lgkmcnt(0)
    v_mfma_f32_16x16x32_bf16 v[92:95], a[116:119], v[156:159], v[92:95]
    s_nop 7
    v_add_f32 v88, v88, v92
    v_add_f32 v89, v89, v93
    v_add_f32 v90, v90, v94
    v_add_f32 v91, v91, v95
    v_mul_f32 v88, 0x419fecaf, v88
    v_mul_f32 v89, 0x419fecaf, v89
    v_mul_f32 v90, 0x419fecaf, v90
    v_mul_f32 v91, 0x419fecaf, v91
    v_cvt_pk_bf16_f32 v120, v88, v89
    v_cvt_pk_bf16_f32 v121, v90, v91
    buffer_store_dwordx4 v[120:123], v65, s[32:35], s61 offen sc1
    buffer_load_dwordx4 v25, s[24:27], s58 offen offset:3072 nt lds
    s_add_u32 m0, s41, 4096
    s_nop 0
    buffer_load_dwordx4 v26, s[24:27], s58 offen offset:0 nt lds
    buffer_load_dwordx4 v27, s[24:27], s58 offen offset:1024 nt lds
    s_barrier
    buffer_load_dwordx4 v28, s[24:27], s58 offen offset:2048 nt lds
    buffer_load_dwordx4 v29, s[24:27], s58 offen offset:3072 nt lds
    s_add_u32 m0, s41, 8192
    s_nop 0
    buffer_load_dwordx4 v30, s[24:27], s58 offen offset:0 nt lds
    buffer_load_dwordx4 v31, s[24:27], s58 offen offset:1024 nt lds
    buffer_load_dwordx4 v32, s[24:27], s58 offen offset:2048 nt lds
    buffer_load_dwordx4 v33, s[24:27], s58 offen offset:3072 nt lds
    v_and_b32 v1, 15, v0
    v_lshrrev_b32 v6, 5, v0
    v_bfe_u32 v3, v0, 4, 1
    v_lshl_or_b32 v3, v3, 1, v6
    v_lshrrev_b32 v4, 2, v0
    v_bfe_u32 v5, v0, 1, 1
    v_lshrrev_b32 v6, 3, v1
    v_and_or_b32 v6, v1, 6, v6
    v_xor_b32 v6, v6, v3
    v_mul_u32_u24 v7, 384, v1
    v_lshl_add_u32 v6, v6, 4, v7
    v_add_u32 v34, s40, v6
    v_xor_b32 v35, 64, v34
    v_lshrrev_b32 v6, 3, v1
    v_and_b32 v7, 7, v1
    v_lshl_or_b32 v6, v7, 1, v6
    v_xor_b32 v6, v6, v3
    v_mul_u32_u24 v7, 768, v1
    v_lshl_add_u32 v6, v6, 4, v7
    v_add_u32 v40, s41, v6
    v_xor_b32 v41, 0x40, v40
    v_xor_b32 v42, 0x80, v40
    v_xor_b32 v43, 0xc0, v40
    v_and_b32 v2, 1, v0
    v_lshlrev_b32 v2, 3, v2
    s_mul_i32 s56, s3, 96
    v_lshrrev_b32 v6, 3, v4
    v_and_or_b32 v6, v4, 6, v6
    v_xor_b32 v6, v6, v5
    v_lshl_add_u32 v6, v6, 4, v2
    v_mul_u32_u24 v7, 384, v4
    s_add_u32 s57, s56, 0
    v_xad_u32 v36, v6, s57, v7
    s_add_u32 s57, s56, 32
    v_xad_u32 v37, v6, s57, v7
    s_add_u32 s57, s56, 64
    v_xad_u32 v38, v6, s57, v7
    v_lshrrev_b32 v6, 3, v4
    v_and_b32 v3, 7, v4
    v_lshl_or_b32 v6, v3, 1, v6
    v_xor_b32 v6, v6, v5
    v_lshl_add_u32 v6, v6, 4, v2
    v_lshlrev_b32 v7, 1, v7
    v_add_u32 v7, 24576, v7
    s_add_u32 s57, s56, 0
    v_xad_u32 v44, v6, s57, v7
    s_add_u32 s57, s56, 384
    v_xad_u32 v45, v6, s57, v7
    s_add_u32 s57, s56, 32
    v_xad_u32 v46, v6, s57, v7
    s_add_u32 s57, s56, 416
    v_xad_u32 v47, v6, s57, v7
    s_add_u32 s57, s56, 64
    v_xad_u32 v48, v6, s57, v7
    s_add_u32 s57, s56, 448
    v_xad_u32 v49, v6, s57, v7
    v_lshrrev_b32 v1, 5, v0
    v_lshlrev_b32 v1, 8, v1
    v_and_b32 v2, 15, v0
    v_lshl_add_u32 v1, v2, 4, v1
    v_bfe_u32 v2, v0, 4, 1
    v_lshl_add_u32 v1, v2, 3, v1
    s_mul_i32 s56, s3, 1536
    s_add_u32 s56, s56, 147456
    v_add_u32 v236, s56, v1
    s_mul_i32 s56, s3, 3072
    s_add_u32 s56, s56, 24576
    v_add_u32 v237, s56, v65
    v_add_u32 v238, s41, v65
    s_lshl_b32 s56, s3, 10
    v_add_u32 v240, 159744, v65
    v_add_u32 v239, s56, v240
    v_add_u32 v241, 147456, v65
    v_bfe_u32 v1, v0, 2, 2
    v_lshrrev_b32 v2, 4, v0
    v_lshl_or_b32 v1, v1, 4, v2
    v_mul_u32_u24 v1, 32768, v1
    v_and_b32 v2, 3, v0
    v_lshl_or_b32 v242, v2, 4, v1
    v_xor_b32 v243, 0x70, v242
    s_mul_i32 s56, s3, 3
    v_min_u32 v1, 2, v0
    v_add_u32 v1, s56, v1
    v_lshlrev_b32 v245, 7, v1
    v_lshlrev_b32 v1, 3, v0
    v_add_u32 v254, 126976, v1
    s_lshl_b32 s56, s3, 9
    v_add_u32 v238, s56, v254
    v_add_u32 v253, 122880, v65
    s_lshl_b32 s56, s3, 10
    v_add_u32 v237, s56, v253
    s_mov_b32 s52, 0x41c00000
    s_add_u32 m0, s42, 0
    s_add_u32 s59, s37, 196608
    buffer_load_dwordx4 v22, s[24:27], s59 offen offset:0 nt lds
    buffer_load_dwordx4 v23, s[24:27], s59 offen offset:1024 nt lds
    buffer_load_dwordx4 v24, s[24:27], s59 offen offset:2048 nt lds
    buffer_load_dwordx4 v25, s[24:27], s59 offen offset:3072 nt lds
    s_add_u32 m0, s42, 4096
    s_nop 0
    buffer_load_dwordx4 v26, s[24:27], s59 offen offset:0 nt lds
    buffer_load_dwordx4 v27, s[24:27], s59 offen offset:1024 nt lds
    buffer_load_dwordx4 v28, s[24:27], s59 offen offset:2048 nt lds
    buffer_load_dwordx4 v29, s[24:27], s59 offen offset:3072 nt lds
    s_add_u32 m0, s42, 8192
    s_nop 0
    buffer_load_dwordx4 v30, s[24:27], s59 offen offset:0 nt lds
    buffer_load_dwordx4 v31, s[24:27], s59 offen offset:1024 nt lds
    buffer_load_dwordx4 v32, s[24:27], s59 offen offset:2048 nt lds
    buffer_load_dwordx4 v33, s[24:27], s59 offen offset:3072 nt lds
    s_mov_b32 s43, -1
    s_branch L_join
L_vprod:
    s_mul_i32 s60, s3, 18432
    s_add_u32 m0, s60, 73728
    s_nop 0
    buffer_load_dwordx4 v16, s[64:67], s60 offen offset:0  lds
    buffer_load_dwordx4 v17, s[64:67], s60 offen offset:1024  lds
    buffer_load_dwordx4 v18, s[64:67], s60 offen offset:2048  lds
    buffer_load_dwordx4 v19, s[64:67], s60 offen offset:3072  lds
    s_add_u32 m0, s60, 77824
    s_nop 0
    buffer_load_dwordx4 v20, s[64:67], s60 offen offset:0  lds
    buffer_load_dwordx4 v21, s[64:67], s60 offen offset:1024  lds
    s_add_u32 s60, s60, 6144
    s_add_u32 m0, s60, 73728
    s_nop 0
    buffer_load_dwordx4 v16, s[64:67], s60 offen offset:0  lds
    buffer_load_dwordx4 v17, s[64:67], s60 offen offset:1024  lds
    buffer_load_dwordx4 v18, s[64:67], s60 offen offset:2048  lds
    buffer_load_dwordx4 v19, s[64:67], s60 offen offset:3072  lds
    s_add_u32 m0, s60, 77824
    s_nop 0
    buffer_load_dwordx4 v20, s[64:67], s60 offen offset:0  lds
    buffer_load_dwordx4 v21, s[64:67], s60 offen offset:1024  lds
    s_add_u32 s60, s60, 6144
    s_add_u32 m0, s60, 73728
    s_nop 0
    buffer_load_dwordx4 v16, s[64:67], s60 offen offset:0  lds
    v_lshrrev_b32 v1, 4, v0
    v_and_b32 v5, 1, v1
    v_bfe_u32 v2, v0, 2, 2
    v_lshl_add_u32 v3, v1, 3, v2
    buffer_load_dwordx4 v17, s[64:67], s60 offen offset:1024  lds
    v_mul_u32_u24 v3, 384, v3
    v_and_b32 v4, 1, v0
    v_lshl_add_u32 v3, v4, 3, v3
    v_add_u32 v3, 73728, v3
    buffer_load_dwordx4 v18, s[64:67], s60 offen offset:2048  lds
    v_and_or_b32 v2, v2, 2, v5
    v_bfe_u32 v4, v0, 1, 1
    v_xor_b32 v2, v2, v4
    s_mul_i32 s56, s3, 6
    buffer_load_dwordx4 v19, s[64:67], s60 offen offset:3072  lds
    s_add_u32 s57, s56, 0
    v_xor_b32 v4, s57, v2
    v_lshl_add_u32 v136, v4, 4, v3
    v_xor_b32 v137, 64, v136
    s_add_u32 m0, s60, 77824
    s_nop 0
    buffer_load_dwordx4 v20, s[64:67], s60 offen offset:0  lds
    s_add_u32 s57, s56, 2
    v_xor_b32 v4, s57, v2
    v_lshl_add_u32 v138, v4, 4, v3
    v_xor_b32 v139, 64, v138
    buffer_load_dwordx4 v21, s[64:67], s60 offen offset:1024  lds
    s_add_u32 s57, s56, 4
    v_xor_b32 v4, s57, v2
    v_lshl_add_u32 v140, v4, 4, v3
    v_xor_b32 v141, 64, v140
    s_lshl_b32 s61, s43, 2
    s_add_u32 s61, s61, s3
    s_mul_i32 s60, s61, 6144
    s_add_u32 m0, s41, 6144
    s_nop 0
    buffer_load_dwordx4 v16, s[68:71], s60 offen offset:0  lds
    v_bfe_u32 v1, v0, 2, 1
    v_and_b32 v2, 3, v0
    v_lshl_or_b32 v2, v1, 3, v2
    v_and_or_b32 v1, v0, 2, v1
    buffer_load_dwordx4 v17, s[68:71], s60 offen offset:1024  lds
    v_lshrrev_b32 v3, 4, v0
    v_xor_b32 v1, v1, v3
    v_mul_u32_u24 v2, 384, v2
    v_lshl_add_u32 v1, v1, 4, v2
    buffer_load_dwordx4 v18, s[68:71], s60 offen offset:2048  lds
    v_bfe_u32 v2, v0, 3, 1
    v_mul_u32_u24 v2, 12288, v2
    s_mov_b32 s56, 30720
    v_add3_u32 v142, s56, v1, v2
    buffer_load_dwordx4 v19, s[68:71], s60 offen offset:3072  lds
    v_xor_b32 v143, 64, v142
    s_add_u32 m0, s41, 10240
    s_nop 0
    buffer_load_dwordx4 v20, s[68:71], s60 offen offset:0  lds
    buffer_load_dwordx4 v21, s[68:71], s60 offen offset:1024  lds
    s_load_dword s38, s[22:23], 0
    s_barrier
    s_add_u32 m0, s40, 0
    s_add_u32 s57, s36, 0
    buffer_load_dwordx4 v16, s[28:31], s57 offen offset:0 nt lds
    buffer_load_dwordx4 v17, s[28:31], s57 offen offset:1024 nt lds
    buffer_load_dwordx4 v18, s[28:31], s57 offen offset:2048 nt lds
    buffer_load_dwordx4 v19, s[28:31], s57 offen offset:3072 nt lds
    s_add_u32 m0, s40, 4096
    s_nop 0
    buffer_load_dwordx4 v20, s[28:31], s57 offen offset:0 nt lds
    buffer_load_dwordx4 v21, s[28:31], s57 offen offset:1024 nt lds
    s_add_u32 m0, s41, 0
    s_add_u32 s58, s37, 0
    buffer_load_dwordx4 v22, s[24:27], s58 offen offset:0 nt lds
    buffer_load_dwordx4 v23, s[24:27], s58 offen offset:1024 nt lds
    buffer_load_dwordx4 v24, s[24:27], s58 offen offset:2048 nt lds
    s_waitcnt vmcnt(9)
    s_barrier
    ds_read_b128 a[96:99], v142 offset:0
    ds_read_b128 a[100:103], v143 offset:0
    ds_read_b128 a[104:107], v142 offset:128
    ds_read_b128 a[108:111], v143 offset:128
    ds_read_b128 a[112:115], v142 offset:256
    ds_read_b128 a[116:119], v143 offset:256
    ds_read_b128 a[120:123], v143 offset:1536
    ds_read_b128 a[124:127], v142 offset:1536
    ds_read_b128 a[128:131], v143 offset:1664
    ds_read_b128 a[132:135], v142 offset:1664
    ds_read_b128 a[136:139], v143 offset:1792
    ds_read_b128 a[140:143], v142 offset:1792
    ds_read_b128 a[144:147], v142 offset:24576
    ds_read_b128 a[148:151], v143 offset:24576
    ds_read_b128 a[152:155], v142 offset:24704
    ds_read_b128 a[156:159], v143 offset:24704
    ds_read_b128 a[160:163], v142 offset:24832
    ds_read_b128 a[164:167], v143 offset:24832
    ds_read_b128 a[168:171], v143 offset:26112
    ds_read_b128 a[172:175], v142 offset:26112
    ds_read_b128 a[176:179], v143 offset:26240
    ds_read_b128 a[180:183], v142 offset:26240
    ds_read_b128 a[184:187], v143 offset:26368
    ds_read_b128 a[188:191], v142 offset:26368
    ds_read_b64_tr_b16 v[160:161], v136 offset:0
    ds_read_b64_tr_b16 v[162:163], v137 offset:1536
    ds_read_b64_tr_b16 v[164:165], v136 offset:12288
    ds_read_b64_tr_b16 v[166:167], v137 offset:13824
    ds_read_b64_tr_b16 v[168:169], v136 offset:24576
    ds_read_b64_tr_b16 v[170:171], v137 offset:26112
    ds_read_b64_tr_b16 v[172:173], v136 offset:36864
    ds_read_b64_tr_b16 v[174:175], v137 offset:38400
    ds_read_b64_tr_b16 v[176:177], v136 offset:49152
    ds_read_b64_tr_b16 v[178:179], v137 offset:50688
    ds_read_b64_tr_b16 v[180:181], v136 offset:61440
    ds_read_b64_tr_b16 v[182:183], v137 offset:62976
    ds_read_b64_tr_b16 v[184:185], v138 offset:0
    ds_read_b64_tr_b16 v[186:187], v139 offset:1536
    ds_read_b64_tr_b16 v[188:189], v138 offset:12288
    ds_read_b64_tr_b16 v[190:191], v139 offset:13824
    ds_read_b64_tr_b16 v[192:193], v138 offset:24576
    ds_read_b64_tr_b16 v[194:195], v139 offset:26112
    ds_read_b64_tr_b16 v[196:197], v138 offset:36864
    ds_read_b64_tr_b16 v[198:199], v139 offset:38400
    ds_read_b64_tr_b16 v[200:201], v138 offset:49152
    ds_read_b64_tr_b16 v[202:203], v139 offset:50688
    ds_read_b64_tr_b16 v[204:205], v138 offset:61440
    ds_read_b64_tr_b16 v[206:207], v139 offset:62976
    ds_read_b64_tr_b16 v[208:209], v140 offset:0
    ds_read_b64_tr_b16 v[210:211], v141 offset:1536
    ds_read_b64_tr_b16 v[212:213], v140 offset:12288
    ds_read_b64_tr_b16 v[214:215], v141 offset:13824
    ds_read_b64_tr_b16 v[216:217], v140 offset:24576
    ds_read_b64_tr_b16 v[218:219], v141 offset:26112
    ds_read_b64_tr_b16 v[220:221], v140 offset:36864
    ds_read_b64_tr_b16 v[222:223], v141 offset:38400
    ds_read_b64_tr_b16 v[224:225], v140 offset:49152
    ds_read_b64_tr_b16 v[226:227], v141 offset:50688
    ds_read_b64_tr_b16 v[228:229], v140 offset:61440
    ds_read_b64_tr_b16 v[230:231], v141 offset:62976
    s_waitcnt lgkmcnt(0)
    s_barrier
    s_mul_i32 s60, s3, 18432
    s_lshl_b32 s61, s43, 11
    s_add_u32 s60, s60, s61
    s_add_u32 s60, s60, 3145728
    v_mfma_f32_16x16x32_bf16 v[88:91], a[96:99], v[160:163], 0
    v_mfma_f32_16x16x32_bf16 v[92:95], a[120:123], v[160:163], 0
    v_mfma_f32_16x16x32_bf16 v[96:99], a[144:147], v[160:163], 0
    v_mfma_f32_16x16x32_bf16 v[100:103], a[168:171], v[160:163], 0
    buffer_load_dwordx4 v25, s[24:27], s58 offen offset:3072 nt lds
    v_mfma_f32_16x16x32_bf16 v[88:91], a[100:103], v[164:167], v[88:91]
    v_mfma_f32_16x16x32_bf16 v[92:95], a[124:127], v[164:167], v[92:95]
    v_mfma_f32_16x16x32_bf16 v[96:99], a[148:151], v[164:167], v[96:99]
    v_mfma_f32_16x16x32_bf16 v[100:103], a[172:175], v[164:167], v[100:103]
    s_add_u32 m0, s41, 4096
    s_nop 0
    buffer_load_dwordx4 v26, s[24:27], s58 offen offset:0 nt lds
    v_mfma_f32_16x16x32_bf16 v[88:91], a[104:107], v[168:171], v[88:91]
    v_mfma_f32_16x16x32_bf16 v[92:95], a[128:131], v[168:171], v[92:95]
    v_mfma_f32_16x16x32_bf16 v[96:99], a[152:155], v[168:171], v[96:99]
    v_mfma_f32_16x16x32_bf16 v[100:103], a[176:179], v[168:171], v[100:103]
    buffer_load_dwordx4 v27, s[24:27], s58 offen offset:1024 nt lds
    v_mfma_f32_16x16x32_bf16 v[88:91], a[108:111], v[172:175], v[88:91]
    v_mfma_f32_16x16x32_bf16 v[92:95], a[132:135], v[172:175], v[92:95]
    v_mfma_f32_16x16x32_bf16 v[96:99], a[156:159], v[172:175], v[96:99]
    v_mfma_f32_16x16x32_bf16 v[100:103], a[180:183], v[172:175], v[100:103]
    buffer_load_dwordx4 v28, s[24:27], s58 offen offset:2048 nt lds
    v_mfma_f32_16x16x32_bf16 v[88:91], a[112:115], v[176:179], v[88:91]
    v_mfma_f32_16x16x32_bf16 v[92:95], a[136:139], v[176:179], v[92:95]
    v_mfma_f32_16x16x32_bf16 v[96:99], a[160:163], v[176:179], v[96:99]
    v_mfma_f32_16x16x32_bf16 v[100:103], a[184:187], v[176:179], v[100:103]
    buffer_load_dwordx4 v29, s[24:27], s58 offen offset:3072 nt lds
    v_mfma_f32_16x16x32_bf16 v[88:91], a[116:119], v[180:183], v[88:91]
    v_mfma_f32_16x16x32_bf16 v[92:95], a[140:143], v[180:183], v[92:95]
    v_mfma_f32_16x16x32_bf16 v[96:99], a[164:167], v[180:183], v[96:99]
    v_mfma_f32_16x16x32_bf16 v[100:103], a[188:191], v[180:183], v[100:103]
    v_mfma_f32_16x16x32_bf16 v[104:107], a[96:99], v[184:187], 0
    v_mfma_f32_16x16x32_bf16 v[108:111], a[120:123], v[184:187], 0
    v_mfma_f32_16x16x32_bf16 v[112:115], a[144:147], v[184:187], 0
    v_mfma_f32_16x16x32_bf16 v[116:119], a[168:171], v[184:187], 0
    s_add_u32 m0, s41, 8192
    s_nop 0
    buffer_load_dwordx4 v30, s[24:27], s58 offen offset:0 nt lds
    v_mfma_f32_16x16x32_bf16 v[104:107], a[100:103], v[188:191], v[104:107]
    v_mfma_f32_16x16x32_bf16 v[108:111], a[124:127], v[188:191], v[108:111]
    v_mfma_f32_16x16x32_bf16 v[112:115], a[148:151], v[188:191], v[112:115]
    v_mfma_f32_16x16x32_bf16 v[116:119], a[172:175], v[188:191], v[116:119]
    buffer_load_dwordx4 v31, s[24:27], s58 offen offset:1024 nt lds
    v_mfma_f32_16x16x32_bf16 v[104:107], a[104:107], v[192:195], v[104:107]
    v_mfma_f32_16x16x32_bf16 v[108:111], a[128:131], v[192:195], v[108:111]
    v_mfma_f32_16x16x32_bf16 v[112:115], a[152:155], v[192:195], v[112:115]
    v_mfma_f32_16x16x32_bf16 v[116:119], a[176:179], v[192:195], v[116:119]
    buffer_load_dwordx4 v32, s[24:27], s58 offen offset:2048 nt lds
    v_cvt_pk_bf16_f32 v144, v88, v89
    v_cvt_pk_bf16_f32 v145, v90, v91
    v_cvt_pk_bf16_f32 v146, v92, v93
    v_cvt_pk_bf16_f32 v147, v94, v95
    buffer_store_dwordx4 v[144:147], v65, s[32:35], s60 offen offset:0 sc1
    v_cvt_pk_bf16_f32 v148, v96, v97
    v_cvt_pk_bf16_f32 v149, v98, v99
    v_cvt_pk_bf16_f32 v150, v100, v101
    v_cvt_pk_bf16_f32 v151, v102, v103
    buffer_store_dwordx4 v[148:151], v65, s[32:35], s60 offen offset:1024 sc1
    s_add_u32 s60, s60, 6144
    v_mfma_f32_16x16x32_bf16 v[104:107], a[108:111], v[196:199], v[104:107]
    v_mfma_f32_16x16x32_bf16 v[108:111], a[132:135], v[196:199], v[108:111]
    v_mfma_f32_16x16x32_bf16 v[112:115], a[156:159], v[196:199], v[112:115]
    v_mfma_f32_16x16x32_bf16 v[116:119], a[180:183], v[196:199], v[116:119]
    buffer_load_dwordx4 v33, s[24:27], s58 offen offset:3072 nt lds
    v_mfma_f32_16x16x32_bf16 v[104:107], a[112:115], v[200:203], v[104:107]
    v_mfma_f32_16x16x32_bf16 v[108:111], a[136:139], v[200:203], v[108:111]
    v_mfma_f32_16x16x32_bf16 v[112:115], a[160:163], v[200:203], v[112:115]
    v_mfma_f32_16x16x32_bf16 v[116:119], a[184:187], v[200:203], v[116:119]
    s_add_u32 m0, s42, 0
    s_add_u32 s59, s37, 196608
    buffer_load_dwordx4 v22, s[24:27], s59 offen offset:0 nt lds
    v_mfma_f32_16x16x32_bf16 v[104:107], a[116:119], v[204:207], v[104:107]
    v_mfma_f32_16x16x32_bf16 v[108:111], a[140:143], v[204:207], v[108:111]
    v_mfma_f32_16x16x32_bf16 v[112:115], a[164:167], v[204:207], v[112:115]
    v_mfma_f32_16x16x32_bf16 v[116:119], a[188:191], v[204:207], v[116:119]
    v_mfma_f32_16x16x32_bf16 v[120:123], a[96:99], v[208:211], 0
    v_mfma_f32_16x16x32_bf16 v[124:127], a[120:123], v[208:211], 0
    v_mfma_f32_16x16x32_bf16 v[128:131], a[144:147], v[208:211], 0
    v_mfma_f32_16x16x32_bf16 v[132:135], a[168:171], v[208:211], 0
    buffer_load_dwordx4 v23, s[24:27], s59 offen offset:1024 nt lds
    v_mfma_f32_16x16x32_bf16 v[120:123], a[100:103], v[212:215], v[120:123]
    v_mfma_f32_16x16x32_bf16 v[124:127], a[124:127], v[212:215], v[124:127]
    v_mfma_f32_16x16x32_bf16 v[128:131], a[148:151], v[212:215], v[128:131]
    v_mfma_f32_16x16x32_bf16 v[132:135], a[172:175], v[212:215], v[132:135]
    buffer_load_dwordx4 v24, s[24:27], s59 offen offset:2048 nt lds
    v_mfma_f32_16x16x32_bf16 v[120:123], a[104:107], v[216:219], v[120:123]
    v_mfma_f32_16x16x32_bf16 v[124:127], a[128:131], v[216:219], v[124:127]
    v_mfma_f32_16x16x32_bf16 v[128:131], a[152:155], v[216:219], v[128:131]
    v_mfma_f32_16x16x32_bf16 v[132:135], a[176:179], v[216:219], v[132:135]
    buffer_load_dwordx4 v25, s[24:27], s59 offen offset:3072 nt lds
    v_cvt_pk_bf16_f32 v152, v104, v105
    v_cvt_pk_bf16_f32 v153, v106, v107
    v_cvt_pk_bf16_f32 v154, v108, v109
    v_cvt_pk_bf16_f32 v155, v110, v111
    buffer_store_dwordx4 v[152:155], v65, s[32:35], s60 offen offset:0 sc1
    v_cvt_pk_bf16_f32 v156, v112, v113
    v_cvt_pk_bf16_f32 v157, v114, v115
    v_cvt_pk_bf16_f32 v158, v116, v117
    v_cvt_pk_bf16_f32 v159, v118, v119
    buffer_store_dwordx4 v[156:159], v65, s[32:35], s60 offen offset:1024 sc1
    s_add_u32 s60, s60, 6144
    v_mfma_f32_16x16x32_bf16 v[120:123], a[108:111], v[220:223], v[120:123]
    v_mfma_f32_16x16x32_bf16 v[124:127], a[132:135], v[220:223], v[124:127]
    v_mfma_f32_16x16x32_bf16 v[128:131], a[156:159], v[220:223], v[128:131]
    v_mfma_f32_16x16x32_bf16 v[132:135], a[180:183], v[220:223], v[132:135]
    s_add_u32 m0, s42, 4096
    s_nop 0
    buffer_load_dwordx4 v26, s[24:27], s59 offen offset:0 nt lds
    v_mfma_f32_16x16x32_bf16 v[120:123], a[112:115], v[224:227], v[120:123]
    v_mfma_f32_16x16x32_bf16 v[124:127], a[136:139], v[224:227], v[124:127]
    v_mfma_f32_16x16x32_bf16 v[128:131], a[160:163], v[224:227], v[128:131]
    v_mfma_f32_16x16x32_bf16 v[132:135], a[184:187], v[224:227], v[132:135]
    buffer_load_dwordx4 v27, s[24:27], s59 offen offset:1024 nt lds
    v_mfma_f32_16x16x32_bf16 v[120:123], a[116:119], v[228:231], v[120:123]
    v_mfma_f32_16x16x32_bf16 v[124:127], a[140:143], v[228:231], v[124:127]
    v_mfma_f32_16x16x32_bf16 v[128:131], a[164:167], v[228:231], v[128:131]
    v_mfma_f32_16x16x32_bf16 v[132:135], a[188:191], v[228:231], v[132:135]
    s_nop 4
    v_cvt_pk_bf16_f32 v144, v120, v121
    v_cvt_pk_bf16_f32 v145, v122, v123
    v_cvt_pk_bf16_f32 v146, v124, v125
    v_cvt_pk_bf16_f32 v147, v126, v127
    buffer_store_dwordx4 v[144:147], v65, s[32:35], s60 offen offset:0 sc1
    v_cvt_pk_bf16_f32 v148, v128, v129
    v_cvt_pk_bf16_f32 v149, v130, v131
    v_cvt_pk_bf16_f32 v150, v132, v133
    v_cvt_pk_bf16_f32 v151, v134, v135
    buffer_store_dwordx4 v[148:151], v65, s[32:35], s60 offen offset:1024 sc1
    v_and_b32 v1, 15, v0
    v_lshrrev_b32 v6, 5, v0
    v_bfe_u32 v3, v0, 4, 1
    v_lshl_or_b32 v3, v3, 1, v6
    v_lshrrev_b32 v4, 2, v0
    v_bfe_u32 v5, v0, 1, 1
    v_lshrrev_b32 v6, 3, v1
    v_and_or_b32 v6, v1, 6, v6
    v_xor_b32 v6, v6, v3
    v_mul_u32_u24 v7, 384, v1
    v_lshl_add_u32 v6, v6, 4, v7
    v_add_u32 v34, s40, v6
    v_xor_b32 v35, 64, v34
    v_lshrrev_b32 v6, 3, v1
    v_and_b32 v7, 7, v1
    v_lshl_or_b32 v6, v7, 1, v6
    v_xor_b32 v6, v6, v3
    v_mul_u32_u24 v7, 768, v1
    v_lshl_add_u32 v6, v6, 4, v7
    v_add_u32 v40, s41, v6
    v_xor_b32 v41, 0x40, v40
    v_xor_b32 v42, 0x80, v40
    v_xor_b32 v43, 0xc0, v40
    v_and_b32 v2, 1, v0
    v_lshlrev_b32 v2, 3, v2
    s_mul_i32 s56, s3, 96
    v_lshrrev_b32 v6, 3, v4
    v_and_or_b32 v6, v4, 6, v6
    v_xor_b32 v6, v6, v5
    v_lshl_add_u32 v6, v6, 4, v2
    v_mul_u32_u24 v7, 384, v4
    s_add_u32 s57, s56, 0
    v_xad_u32 v36, v6, s57, v7
    s_add_u32 s57, s56, 32
    v_xad_u32 v37, v6, s57, v7
    s_add_u32 s57, s56, 64
    v_xad_u32 v38, v6, s57, v7
    v_lshrrev_b32 v6, 3, v4
    v_and_b32 v3, 7, v4
    v_lshl_or_b32 v6, v3, 1, v6
    v_xor_b32 v6, v6, v5
    v_lshl_add_u32 v6, v6, 4, v2
    v_lshlrev_b32 v7, 1, v7
    v_add_u32 v7, 24576, v7
    s_add_u32 s57, s56, 0
    v_xad_u32 v44, v6, s57, v7
    s_add_u32 s57, s56, 384
    v_xad_u32 v45, v6, s57, v7
    s_add_u32 s57, s56, 32
    v_xad_u32 v46, v6, s57, v7
    s_add_u32 s57, s56, 416
    v_xad_u32 v47, v6, s57, v7
    s_add_u32 s57, s56, 64
    v_xad_u32 v48, v6, s57, v7
    s_add_u32 s57, s56, 448
    v_xad_u32 v49, v6, s57, v7
    v_mov_b32 v52, 0x3f803f80
    v_mov_b32 v56, 0x3ebcbe62
    s_mov_b32 s44, 0x100001
    s_mov_b32 s45, 0x10000100
    v_mov_b32 v53, 0x3f803f80
    v_mov_b32 v57, 0x3ebcbe62
    s_mov_b32 s46, 0x200002
    s_mov_b32 s47, 0x20000200
    v_mov_b32 v54, 0x3f803f80
    v_mov_b32 v58, 0x3ebcbe62
    s_mov_b32 s48, 0x400004
    s_mov_b32 s49, 0x40000400
    v_mov_b32 v55, 0x3f803f80
    v_mov_b32 v59, 0x3ebcbe62
    s_mov_b32 s50, 0x800008
    s_mov_b32 s51, 0x80000800
    v_mov_b32 v60, 0x43400000
    v_lshrrev_b32 v1, 5, v0
    v_lshlrev_b32 v1, 8, v1
    v_and_b32 v2, 15, v0
    v_lshl_add_u32 v1, v2, 4, v1
    v_bfe_u32 v2, v0, 4, 1
    v_lshl_add_u32 v1, v2, 3, v1
    s_mul_i32 s56, s3, 1536
    s_add_u32 s56, s56, 147456
    v_add_u32 v236, s56, v1
    s_mul_i32 s56, s3, 3072
    s_add_u32 s56, s56, 24576
    v_add_u32 v237, s56, v65
    v_add_u32 v238, s41, v65
    s_lshl_b32 s56, s3, 10
    v_add_u32 v240, 159744, v65
    v_add_u32 v239, s56, v240
    v_add_u32 v241, 147456, v65
    v_bfe_u32 v1, v0, 2, 2
    v_lshrrev_b32 v2, 4, v0
    v_lshl_or_b32 v1, v1, 4, v2
    v_mul_u32_u24 v1, 32768, v1
    v_and_b32 v2, 3, v0
    v_lshl_or_b32 v242, v2, 4, v1
    v_xor_b32 v243, 0x70, v242
    s_mul_i32 s56, s3, 3
    v_min_u32 v1, 2, v0
    v_add_u32 v1, s56, v1
    v_lshlrev_b32 v245, 7, v1
    v_lshlrev_b32 v1, 3, v0
    v_add_u32 v254, 126976, v1
    s_lshl_b32 s56, s3, 9
    v_add_u32 v238, s56, v254
    v_add_u32 v253, 122880, v65
    s_lshl_b32 s56, s3, 10
    v_add_u32 v237, s56, v253
    s_mov_b32 s52, 0x41c00000
    buffer_load_dwordx4 v28, s[24:27], s59 offen offset:2048 nt lds
    buffer_load_dwordx4 v29, s[24:27], s59 offen offset:3072 nt lds
    s_add_u32 m0, s42, 8192
    s_nop 0
    buffer_load_dwordx4 v30, s[24:27], s59 offen offset:0 nt lds
    buffer_load_dwordx4 v31, s[24:27], s59 offen offset:1024 nt lds
    buffer_load_dwordx4 v32, s[24:27], s59 offen offset:2048 nt lds
    buffer_load_dwordx4 v33, s[24:27], s59 offen offset:3072 nt lds
    s_branch L_join
L_xt3:
    s_call_b64 s[54:55], L_xslow
    s_branch L_post3
L_xt24:
    s_call_b64 s[54:55], L_xslow
    s_branch L_post24
L_xt6:
    s_call_b64 s[54:55], L_xslow
    s_branch L_post6
L_xt27:
    s_call_b64 s[54:55], L_xslow
    s_branch L_post27
L_xt9:
    s_call_b64 s[54:55], L_xslow
    s_branch L_post9
L_xt11:
    s_call_b64 s[54:55], L_xalt
    ds_read_b128 a[192:195], v253 offset:12288
    ds_read_b128 a[196:199], v253 offset:13312
    ds_read_b128 a[200:203], v253 offset:14336
    ds_read_b128 a[204:207], v253 offset:15360
    s_waitcnt lgkmcnt(0)
    s_branch L_post11
L_xslow:
    s_waitcnt lgkmcnt(0)
    ds_write_b32 v239, v62
    s_waitcnt lgkmcnt(0)
    s_barrier
    ds_read_b32 v12, v240 offset:0
    ds_read_b32 v13, v240 offset:1024
    ds_read_b32 v14, v240 offset:2048
    ds_read_b32 v15, v240 offset:3072
    v_mov_b32 v9, 0
    ds_write_b32 v254, v9 offset:4096
    s_waitcnt lgkmcnt(0)
    v_min3_f32 v1, v12, v13, v14
    v_min_f32 v1, v1, v15
    v_sub_f32 v2, v1, v255
    v_sub_f32 v12, v1, v62
    v_exp_f32 v2, v2
    v_exp_f32 v12, v12
    v_mov_b32 v62, v1
    v_mov_b32 v255, v1
    v_mul_f32 v88, v88, v12
    v_mul_f32 v89, v89, v12
    v_mul_f32 v90, v90, v12
    v_mul_f32 v91, v91, v12
    v_mul_f32 v104, v104, v12
    v_mul_f32 v105, v105, v12
    v_mul_f32 v106, v106, v12
    v_mul_f32 v107, v107, v12
    v_mul_f32 v68, v68, v12
    v_mul_f32 v69, v69, v12
    v_mul_f32 v70, v70, v12
    v_mul_f32 v71, v71, v12
    v_mul_f32 v112, v112, v12
    v_mul_f32 v113, v113, v12
    v_mul_f32 v114, v114, v12
    v_mul_f32 v115, v115, v12
    v_mul_f32 v63, v63, v12
    v_mul_f32 v64, v64, v12
    v_accvgpr_read_b32 v1, a0
    v_mul_f32 v1, v1, v2
    v_accvgpr_write_b32 a0, v1
    v_accvgpr_read_b32 v1, a1
    v_mul_f32 v1, v1, v2
    v_accvgpr_write_b32 a1, v1
    v_accvgpr_read_b32 v1, a2
    v_mul_f32 v1, v1, v2
    v_accvgpr_write_b32 a2, v1
    v_accvgpr_read_b32 v1, a3
    v_mul_f32 v1, v1, v2
    v_accvgpr_write_b32 a3, v1
    v_accvgpr_read_b32 v1, a4
    v_mul_f32 v1, v1, v2
    v_accvgpr_write_b32 a4, v1
    v_accvgpr_read_b32 v1, a5
    v_mul_f32 v1, v1, v2
    v_accvgpr_write_b32 a5, v1
    v_accvgpr_read_b32 v1, a6
    v_mul_f32 v1, v1, v2
    v_accvgpr_write_b32 a6, v1
    v_accvgpr_read_b32 v1, a7
    v_mul_f32 v1, v1, v2
    v_accvgpr_write_b32 a7, v1
    v_accvgpr_read_b32 v1, a8
    v_mul_f32 v1, v1, v2
    v_accvgpr_write_b32 a8, v1
    v_accvgpr_read_b32 v1, a9
    v_mul_f32 v1, v1, v2
    v_accvgpr_write_b32 a9, v1
    v_accvgpr_read_b32 v1, a10
    v_mul_f32 v1, v1, v2
    v_accvgpr_write_b32 a10, v1
    v_accvgpr_read_b32 v1, a11
    v_mul_f32 v1, v1, v2
    v_accvgpr_write_b32 a11, v1
    v_cvt_pk_bf16_f32 v72, v88, v89
    v_cvt_pk_bf16_f32 v73, v90, v91
    v_cvt_pk_bf16_f32 v74, v104, v105
    v_cvt_pk_bf16_f32 v75, v106, v107
    ds_write_b128 v237, v[72:75] offset:0
    v_cvt_pk_bf16_f32 v66, v68, v69
    v_cvt_pk_bf16_f32 v67, v70, v71
    ds_write_b64 v238, v[66:67]
    s_waitcnt lgkmcnt(0)
    s_barrier
    s_setpc_b64 s[54:55]
L_xlast:
    s_waitcnt lgkmcnt(0)
    ds_write_b32 v239, v62
    s_waitcnt lgkmcnt(0)
    s_barrier
    ds_read_b32 v12, v240 offset:0
    ds_read_b32 v13, v240 offset:1024
    ds_read_b32 v14, v240 offset:2048
    ds_read_b32 v15, v240 offset:3072
    v_mov_b32 v9, 0
    ds_write_b32 v254, v9 offset:4096
    s_waitcnt lgkmcnt(0)
    v_min3_f32 v1, v12, v13, v14
    v_min_f32 v1, v1, v15
    v_sub_f32 v2, v1, v255
    v_sub_f32 v12, v1, v62
    v_exp_f32 v2, v2
    v_exp_f32 v12, v12
    v_mov_b32 v62, v1
    v_mov_b32 v255, v1
    v_mul_f32 v88, v88, v12
    v_mul_f32 v89, v89, v12
    v_mul_f32 v90, v90, v12
    v_mul_f32 v91, v91, v12
    v_mul_f32 v104, v104, v12
    v_mul_f32 v105, v105, v12
    v_mul_f32 v106, v106, v12
    v_mul_f32 v107, v107, v12
    v_mul_f32 v68, v68, v12
    v_mul_f32 v69, v69, v12
    v_mul_f32 v70, v70, v12
    v_mul_f32 v71, v71, v12
    v_mul_f32 v10, v10, v12
    v_mul_f32 v11, v11, v12
    v_mul_f32 v16, v16, v2
    v_mul_f32 v17, v17, v2
    v_mul_f32 v18, v18, v2
    v_mul_f32 v19, v19, v2
    v_mul_f32 v20, v20, v2
    v_mul_f32 v21, v21, v2
    v_mul_f32 v22, v22, v2
    v_mul_f32 v23, v23, v2
    v_mul_f32 v24, v24, v2
    v_mul_f32 v25, v25, v2
    v_mul_f32 v26, v26, v2
    v_mul_f32 v27, v27, v2
    v_cvt_pk_bf16_f32 v72, v88, v89
    v_cvt_pk_bf16_f32 v73, v90, v91
    v_cvt_pk_bf16_f32 v74, v104, v105
    v_cvt_pk_bf16_f32 v75, v106, v107
    ds_write_b128 v237, v[72:75] offset:0
    v_cvt_pk_bf16_f32 v66, v68, v69
    v_cvt_pk_bf16_f32 v67, v70, v71
    ds_write_b64 v238, v[66:67]
    ds_write_b64 v238, v[10:11] offset:2048
    s_waitcnt lgkmcnt(0)
    s_barrier
    s_branch L_postx
L_xalt:
    s_waitcnt lgkmcnt(0)
    ds_write_b32 v239, v62
    s_waitcnt lgkmcnt(0)
    s_barrier
    ds_read_b32 v12, v240 offset:0
    ds_read_b32 v13, v240 offset:1024
    ds_read_b32 v14, v240 offset:2048
    ds_read_b32 v15, v240 offset:3072
    v_mov_b32 v9, 0
    ds_write_b32 v254, v9 offset:4100
    s_waitcnt lgkmcnt(0)
    v_min3_f32 v1, v12, v13, v14
    v_min_f32 v1, v1, v15
    v_sub_f32 v2, v1, v255
    v_sub_f32 v12, v1, v62
    v_exp_f32 v2, v2
    v_exp_f32 v12, v12
    v_mov_b32 v62, v1
    v_mov_b32 v255, v1
    v_mul_f32 v88, v88, v12
    v_mul_f32 v89, v89, v12
    v_mul_f32 v90, v90, v12
    v_mul_f32 v91, v91, v12
    v_mul_f32 v104, v104, v12
    v_mul_f32 v105, v105, v12
    v_mul_f32 v106, v106, v12
    v_mul_f32 v107, v107, v12
    v_mul_f32 v68, v68, v12
    v_mul_f32 v69, v69, v12
    v_mul_f32 v70, v70, v12
    v_mul_f32 v71, v71, v12
    v_mul_f32 v112, v112, v12
    v_mul_f32 v113, v113, v12
    v_mul_f32 v114, v114, v12
    v_mul_f32 v115, v115, v12
    v_mul_f32 v63, v63, v12
    v_mul_f32 v64, v64, v12
    v_mul_f32 v16, v16, v2
    v_mul_f32 v17, v17, v2
    v_mul_f32 v18, v18, v2
    v_mul_f32 v19, v19, v2
    v_mul_f32 v20, v20, v2
    v_mul_f32 v21, v21, v2
    v_mul_f32 v22, v22, v2
    v_mul_f32 v23, v23, v2
    v_mul_f32 v24, v24, v2
    v_mul_f32 v25, v25, v2
    v_mul_f32 v26, v26, v2
    v_mul_f32 v27, v27, v2
    v_cvt_pk_bf16_f32 v72, v88, v89
    v_cvt_pk_bf16_f32 v73, v90, v91
    v_cvt_pk_bf16_f32 v74, v104, v105
    v_cvt_pk_bf16_f32 v75, v106, v107
    ds_write_b128 v237, v[72:75] offset:12288
    s_waitcnt lgkmcnt(0)
    s_barrier
    s_setpc_b64 s[54:55]
L_c_slow:
    s_cmp_eq_u32 s43, 0
    s_cbranch_scc1 L_c_out
    s_mov_b32 s43, 0
    buffer_load_dwordx4 v[76:79], v65, s[32:35], s30 offen offset:0 sc1
    buffer_load_dwordx4 v[80:83], v65, s[32:35], s30 offen offset:1024 sc1
    buffer_load_dwordx4 v[84:87], v65, s[32:35], s30 offen offset:2048 sc1
    buffer_load_dwordx4 v[108:111], v65, s[32:35], s30 offen offset:3072 sc1
    buffer_load_dwordx4 v[112:115], v65, s[32:35], s31 offen offset:0 sc1
    buffer_load_dwordx4 v[128:131], v65, s[32:35], s31 offen offset:1024 sc1
    buffer_load_dwordx4 v[132:135], v65, s[32:35], s31 offen offset:2048 sc1
    buffer_load_dwordx4 v[52:55], v65, s[32:35], s31 offen offset:3072 sc1
    s_waitcnt vmcnt(0)
    v_sub_u32 v49, v79, v247
    v_max_f32 v42, v42, v49
    v_sub_u32 v49, v83, v247
    v_max_f32 v42, v42, v49
    v_sub_u32 v49, v87, v247
    v_max_f32 v42, v42, v49
    v_sub_u32 v49, v111, v247
    v_max_f32 v42, v42, v49
    v_sub_u32 v49, v115, v247
    v_max_f32 v42, v42, v49
    v_sub_u32 v49, v131, v247
    v_max_f32 v42, v42, v49
    v_sub_u32 v49, v135, v247
    v_max_f32 v42, v42, v49
    v_sub_u32 v49, v55, v247
    v_max_f32 v42, v42, v49
    s_nop 1
    v_max_f32_dpp v42, v42, v42 row_ror:8 row_mask:0xf bank_mask:0xf
    v_mov_b32 v48, v42
    s_nop 1
    v_permlane32_swap_b32 v42, v48
    v_max_f32 v42, v42, v48
    v_mov_b32 v48, v42
    s_nop 1
    v_permlane16_swap_b32 v42, v48
    v_max_f32 v42, v42, v48
    s_lshl_b32 s56, s3, 2
    v_add_u32 v48, s56, v251
    ds_write_b32 v48, v42 offset:1024
    s_waitcnt lgkmcnt(0)
    s_barrier
    ds_read_b128 v[48:51], v251 offset:1024
    v_mov_b32 v16, 0
    v_mov_b32 v17, 0
    v_mov_b32 v18, 0
    v_mov_b32 v19, 0
    v_mov_b32 v20, 0
    v_mov_b32 v21, 0
    v_mov_b32 v22, 0
    s_waitcnt lgkmcnt(0)
    v_max3_f32 v42, v48, v49, v50
    v_max_f32 v42, v42, v51
    v_sub_u32 v49, v79, v247
    v_sub_f32 v49, v49, v42
    v_exp_f32 v49, v49
    s_nop 0
    v_cvt_pk_bf16_f32 v49, v49, 0
    v_lshlrev_b32 v50, 16, v49
    v_dot2_f32_bf16 v16, v76, v49, v16
    v_dot2_f32_bf16 v18, v77, v49, v18
    v_dot2_f32_bf16 v20, v78, v49, v20
    v_add_f32 v22, v22, v50
    v_dot2_f32_bf16 v17, v76, v50, v17
    v_dot2_f32_bf16 v19, v77, v50, v19
    v_dot2_f32_bf16 v21, v78, v50, v21
    v_sub_u32 v49, v83, v247
    v_sub_f32 v49, v49, v42
    v_exp_f32 v49, v49
    s_nop 0
    v_cvt_pk_bf16_f32 v49, v49, 0
    v_lshlrev_b32 v50, 16, v49
    v_dot2_f32_bf16 v16, v80, v49, v16
    v_dot2_f32_bf16 v18, v81, v49, v18
    v_dot2_f32_bf16 v20, v82, v49, v20
    v_add_f32 v22, v22, v50
    v_dot2_f32_bf16 v17, v80, v50, v17
    v_dot2_f32_bf16 v19, v81, v50, v19
    v_dot2_f32_bf16 v21, v82, v50, v21
    v_sub_u32 v49, v87, v247
    v_sub_f32 v49, v49, v42
    v_exp_f32 v49, v49
    s_nop 0
    v_cvt_pk_bf16_f32 v49, v49, 0
    v_lshlrev_b32 v50, 16, v49
    v_dot2_f32_bf16 v16, v84, v49, v16
    v_dot2_f32_bf16 v18, v85, v49, v18
    v_dot2_f32_bf16 v20, v86, v49, v20
    v_add_f32 v22, v22, v50
    v_dot2_f32_bf16 v17, v84, v50, v17
    v_dot2_f32_bf16 v19, v85, v50, v19
    v_dot2_f32_bf16 v21, v86, v50, v21
    v_sub_u32 v49, v111, v247
    v_sub_f32 v49, v49, v42
    v_exp_f32 v49, v49
    s_nop 0
    v_cvt_pk_bf16_f32 v49, v49, 0
    v_lshlrev_b32 v50, 16, v49
    v_dot2_f32_bf16 v16, v108, v49, v16
    v_dot2_f32_bf16 v18, v109, v49, v18
    v_dot2_f32_bf16 v20, v110, v49, v20
    v_add_f32 v22, v22, v50
    v_dot2_f32_bf16 v17, v108, v50, v17
    v_dot2_f32_bf16 v19, v109, v50, v19
    v_dot2_f32_bf16 v21, v110, v50, v21
    v_sub_u32 v49, v115, v247
    v_sub_f32 v49, v49, v42
    v_exp_f32 v49, v49
    s_nop 0
    v_cvt_pk_bf16_f32 v49, v49, 0
    v_lshlrev_b32 v50, 16, v49
    v_dot2_f32_bf16 v16, v112, v49, v16
    v_dot2_f32_bf16 v18, v113, v49, v18
    v_dot2_f32_bf16 v20, v114, v49, v20
    v_add_f32 v22, v22, v50
    v_dot2_f32_bf16 v17, v112, v50, v17
    v_dot2_f32_bf16 v19, v113, v50, v19
    v_dot2_f32_bf16 v21, v114, v50, v21
    v_sub_u32 v49, v131, v247
    v_sub_f32 v49, v49, v42
    v_exp_f32 v49, v49
    s_nop 0
    v_cvt_pk_bf16_f32 v49, v49, 0
    v_lshlrev_b32 v50, 16, v49
    v_dot2_f32_bf16 v16, v128, v49, v16
    v_dot2_f32_bf16 v18, v129, v49, v18
    v_dot2_f32_bf16 v20, v130, v49, v20
    v_add_f32 v22, v22, v50
    v_dot2_f32_bf16 v17, v128, v50, v17
    v_dot2_f32_bf16 v19, v129, v50, v19
    v_dot2_f32_bf16 v21, v130, v50, v21
    v_sub_u32 v49, v135, v247
    v_sub_f32 v49, v49, v42
    v_exp_f32 v49, v49
    s_nop 0
    v_cvt_pk_bf16_f32 v49, v49, 0
    v_lshlrev_b32 v50, 16, v49
    v_dot2_f32_bf16 v16, v132, v49, v16
    v_dot2_f32_bf16 v18, v133, v49, v18
    v_dot2_f32_bf16 v20, v134, v49, v20
    v_add_f32 v22, v22, v50
    v_dot2_f32_bf16 v17, v132, v50, v17
    v_dot2_f32_bf16 v19, v133, v50, v19
    v_dot2_f32_bf16 v21, v134, v50, v21
    v_sub_u32 v49, v55, v247
    v_sub_f32 v49, v49, v42
    v_exp_f32 v49, v49
    s_nop 0
    v_cvt_pk_bf16_f32 v49, v49, 0
    v_lshlrev_b32 v50, 16, v49
    v_dot2_f32_bf16 v16, v52, v49, v16
    v_dot2_f32_bf16 v18, v53, v49, v18
    v_dot2_f32_bf16 v20, v54, v49, v20
    v_add_f32 v22, v22, v50
    v_dot2_f32_bf16 v17, v52, v50, v17
    v_dot2_f32_bf16 v19, v53, v50, v19
    v_dot2_f32_bf16 v21, v54, v50, v21
    s_nop 2
    s_branch L_c_red
L_qk_retry:
    s_mov_b32 s53, 0
L_qk_again:
    s_mul_i32 s56, s3, 3072
    s_add_u32 s56, s56, 16384
    buffer_load_dwordx4 v[136:139], v65, s[32:35], s56 offen offset:0 sc1
    buffer_load_dwordx4 v[140:143], v65, s[32:35], s56 offen offset:1024 sc1
    buffer_load_dwordx4 v[144:147], v65, s[32:35], s56 offen offset:2048 sc1
    s_add_u32 s53, s53, 1
    s_waitcnt vmcnt(0)
    v_xor_b32 v1, s39, v138
    v_xor_b32 v2, s39, v142
    v_xor_b32 v3, s39, v146
    v_or3_b32 v1, v1, v2, v3
    v_cmp_ne_u32 vcc, 0, v1
    s_cbranch_vccz L_qk_ok
    s_cmp_lt_u32 s53, 65536
    s_cbranch_scc1 L_qk_again
    s_branch L_qk_ok
L_fl_retry:
    s_mov_b32 s53, 0
L_fl_again:
    buffer_load_dword v244, v245, s[32:35], 0 offen offset:128 sc1
    s_add_u32 s53, s53, 1
    s_waitcnt vmcnt(0)
    v_cmp_ne_u32 vcc, s39, v244
    s_cbranch_vccz L_fl_ok
    s_cmp_lt_u32 s53, 65536
    s_cbranch_scc1 L_fl_again
    s_branch L_fl_ok
L_site0:
    s_call_b64 s[54:55], L_rare2
    s_branch L_back0
L_site1:
    s_call_b64 s[54:55], L_rare3
    s_branch L_back1
L_site2:
    s_call_b64 s[54:55], L_rare2
    s_branch L_back2
L_site3:
    s_call_b64 s[54:55], L_rare3
    s_branch L_back3
L_site4:
    s_call_b64 s[54:55], L_rare2
    s_branch L_back4
L_site5:
    s_call_b64 s[54:55], L_rare3
    s_branch L_back5
L_site6:
    s_call_b64 s[54:55], L_rare2
    s_branch L_back6
L_site7:
    s_call_b64 s[54:55], L_rare3
    s_branch L_back7
L_site8:
    s_call_b64 s[54:55], L_rare2
    s_branch L_back8
L_site9:
    s_call_b64 s[54:55], L_rare3
    s_branch L_back9
L_site10:
    s_call_b64 s[54:55], L_rare6
    s_branch L_back10
L_site11:
    s_call_b64 s[54:55], L_rare7
    s_branch L_back11
L_site12:
    s_call_b64 s[54:55], L_rare2
    s_branch L_back12
L_site13:
    s_call_b64 s[54:55], L_rare5
    s_branch L_back13
L_rare2:
    s_nop 7
    s_nop 7
    v_mov_b32 v2, v1
    s_nop 1
    v_permlane32_swap_b32 v1, v2
    v_max_f32 v1, v1, v2
    v_mov_b32 v2, v1
    s_nop 1
    v_permlane16_swap_b32 v1, v2
    v_max_f32 v1, v1, v2
    v_max_f32 v1, 0, v1
    v_sub_f32 v62, v62, v1
    v_sub_f32 v88, v88, v1
    v_sub_f32 v89, v89, v1
    v_sub_f32 v90, v90, v1
    v_sub_f32 v91, v91, v1
    v_sub_f32 v1, 0, v1
    v_exp_f32 v1, v1
    s_nop 0
    v_mul_f32 v63, v63, v1
    v_mul_f32 v64, v64, v1
    v_mul_f32 v68, v68, v1
    v_mul_f32 v69, v69, v1
    v_mul_f32 v70, v70, v1
    v_mul_f32 v71, v71, v1
    v_mov_b32 v2, 1
    ds_write_b32 v254, v2 offset:4096
    s_waitcnt lgkmcnt(0)
    s_nop 3
    s_setpc_b64 s[54:55]
L_rare3:
    s_nop 7
    s_nop 7
    v_mov_b32 v2, v1
    s_nop 1
    v_permlane32_swap_b32 v1, v2
    v_max_f32 v1, v1, v2
    v_mov_b32 v2, v1
    s_nop 1
    v_permlane16_swap_b32 v1, v2
    v_max_f32 v1, v1, v2
    v_max_f32 v1, 0, v1
    v_sub_f32 v62, v62, v1
    v_sub_f32 v104, v104, v1
    v_sub_f32 v105, v105, v1
    v_sub_f32 v106, v106, v1
    v_sub_f32 v107, v107, v1
    v_sub_f32 v1, 0, v1
    v_exp_f32 v1, v1
    s_nop 0
    v_mul_f32 v63, v63, v1
    v_mul_f32 v64, v64, v1
    v_mul_f32 v68, v68, v1
    v_mul_f32 v69, v69, v1
    v_mul_f32 v70, v70, v1
    v_mul_f32 v71, v71, v1
    v_mul_f32 v88, v88, v1
    v_mul_f32 v89, v89, v1
    v_mul_f32 v90, v90, v1
    v_mul_f32 v91, v91, v1
    v_mov_b32 v2, 1
    ds_write_b32 v254, v2 offset:4096
    s_waitcnt lgkmcnt(0)
    s_nop 3
    s_setpc_b64 s[54:55]
L_rare5:
    s_nop 7
    s_nop 7
    v_mov_b32 v2, v1
    s_nop 1
    v_permlane32_swap_b32 v1, v2
    v_max_f32 v1, v1, v2
    v_mov_b32 v2, v1
    s_nop 1
    v_permlane16_swap_b32 v1, v2
    v_max_f32 v1, v1, v2
    v_max_f32 v1, 0, v1
    v_sub_f32 v62, v62, v1
    v_sub_f32 v104, v104, v1
    v_sub_f32 v105, v105, v1
    v_sub_f32 v106, v106, v1
    v_sub_f32 v107, v107, v1
    v_sub_f32 v1, 0, v1
    v_exp_f32 v1, v1
    s_nop 0
    v_mul_f32 v63, v63, v1
    v_mul_f32 v64, v64, v1
    v_mul_f32 v68, v68, v1
    v_mul_f32 v69, v69, v1
    v_mul_f32 v70, v70, v1
    v_mul_f32 v71, v71, v1
    v_mul_f32 v88, v88, v1
    v_mul_f32 v89, v89, v1
    v_mul_f32 v90, v90, v1
    v_mul_f32 v91, v91, v1
    v_cvt_pk_bf16_f32 v72, v88, v89
    v_cvt_pk_bf16_f32 v73, v90, v91
    v_mov_b32 v2, 1
    ds_write_b32 v254, v2 offset:4096
    s_waitcnt lgkmcnt(0)
    s_nop 3
    s_setpc_b64 s[54:55]
L_rare6:
    s_nop 7
    s_nop 7
    v_mov_b32 v2, v1
    s_nop 1
    v_permlane32_swap_b32 v1, v2
    v_max_f32 v1, v1, v2
    v_mov_b32 v2, v1
    s_nop 1
    v_permlane16_swap_b32 v1, v2
    v_max_f32 v1, v1, v2
    v_max_f32 v1, 0, v1
    v_sub_f32 v62, v62, v1
    v_sub_f32 v88, v88, v1
    v_sub_f32 v89, v89, v1
    v_sub_f32 v90, v90, v1
    v_sub_f32 v91, v91, v1
    v_sub_f32 v1, 0, v1
    v_exp_f32 v1, v1
    s_nop 0
    v_mul_f32 v63, v63, v1
    v_mul_f32 v64, v64, v1
    v_mul_f32 v68, v68, v1
    v_mul_f32 v69, v69, v1
    v_mul_f32 v70, v70, v1
    v_mul_f32 v71, v71, v1
    v_mov_b32 v2, 1
    ds_write_b32 v254, v2 offset:4100
    s_waitcnt lgkmcnt(0)
    s_nop 3
    s_setpc_b64 s[54:55]
L_rare7:
    s_nop 7
    s_nop 7
    v_mov_b32 v2, v1
    s_nop 1
    v_permlane32_swap_b32 v1, v2
    v_max_f32 v1, v1, v2
    v_mov_b32 v2, v1
    s_nop 1
    v_permlane16_swap_b32 v1, v2
    v_max_f32 v1, v1, v2
    v_max_f32 v1, 0, v1
    v_sub_f32 v62, v62, v1
    v_sub_f32 v104, v104, v1
    v_sub_f32 v105, v105, v1
    v_sub_f32 v106, v106, v1
    v_sub_f32 v107, v107, v1
    v_sub_f32 v1, 0, v1
    v_exp_f32 v1, v1
    s_nop 0
    v_mul_f32 v63, v63, v1
    v_mul_f32 v64, v64, v1
    v_mul_f32 v68, v68, v1
    v_mul_f32 v69, v69, v1
    v_mul_f32 v70, v70, v1
    v_mul_f32 v71, v71, v1
    v_mul_f32 v88, v88, v1
    v_mul_f32 v89, v89, v1
    v_mul_f32 v90, v90, v1
    v_mul_f32 v91, v91, v1
    v_mov_b32 v2, 1
    ds_write_b32 v254, v2 offset:4100
    s_waitcnt lgkmcnt(0)
    s_nop 3
    s_setpc_b64 s[54:55]
L_codeend:
.section .rodata,"a"
.p2align 6
.amdhsa_kernel standalone__detection_seg_dino__vision_kernel
  .amdhsa_next_free_vgpr 464
  .amdhsa_next_free_sgpr 102
  .amdhsa_accum_offset 256
  .amdhsa_group_segment_fixed_size 0
  .amdhsa_kernarg_size 80
  .amdhsa_user_sgpr_count 2
  .amdhsa_user_sgpr_kernarg_segment_ptr 1
  .amdhsa_system_sgpr_workgroup_id_x 1
  .amdhsa_float_denorm_mode_32 3
.end_amdhsa_kernel
```

```asm
; @launch grid=(256,1,1) block=(256,1,1) lds=163840
.amdgcn_target "amdgcn-amd-amdhsa--gfx950"
.text
.globl standalone__detection_seg_dino__vision_kernel
.p2align 8
.type standalone__detection_seg_dino__vision_kernel,@function
standalone__detection_seg_dino__vision_kernel:
    s_cmp_ge_u32 s2, 256
    s_cbranch_scc1 L_end
    s_load_dwordx16 s[4:19], s[0:1], 0
    s_load_dwordx4 s[20:23], s[0:1], 64
    s_getpc_b64 s[54:55]
L_pc_main:
    v_lshlrev_b32 v233, 7, v0
    v_min_u32 v233, L_codeend - L_pc_main - 4, v233
    global_load_dword v232, v233, s[54:55]
    s_mov_b64 s[100:101], s[54:55]
    v_lshrrev_b32 v1, 6, v0
    v_and_b32 v0, 63, v0
    v_readfirstlane_b32 s3, v1
    v_lshlrev_b32 v65, 4, v0
    v_lshrrev_b32 v1, 2, v0
    v_and_b32 v1, 14, v1
    s_mov_b32 s56, 0x5000
    v_bfe_u32 v2, s56, v1, 2
    v_lshlrev_b32 v2, 5, v2
    v_xor_b32 v16, v65, v2
    s_mov_b32 s56, 0xaa55
    v_bfe_u32 v2, s56, v1, 2
    v_lshlrev_b32 v2, 5, v2
    v_xor_b32 v17, v65, v2
    s_mov_b32 s56, 0xfffa
    v_bfe_u32 v2, s56, v1, 2
    v_lshlrev_b32 v2, 5, v2
    v_xor_b32 v18, v65, v2
    v_xor_b32 v19, 16, v16
    v_xor_b32 v20, 0x1010, v17
    v_xor_b32 v21, 0x1010, v18
    v_lshrrev_b32 v1, 3, v0
    v_and_b32 v1, 6, v1
    s_mov_b32 s56, 0x40
    v_bfe_u32 v2, s56, v1, 2
    v_lshlrev_b32 v2, 5, v2
    v_xor_b32 v22, v65, v2
    s_mov_b32 s56, 0xa5
    v_bfe_u32 v2, s56, v1, 2
    v_lshlrev_b32 v2, 5, v2
    v_xor_b32 v23, v65, v2
    s_mov_b32 s56, 0xfe
    v_bfe_u32 v2, s56, v1, 2
    v_lshlrev_b32 v2, 5, v2
    v_xor_b32 v24, v65, v2
    v_xor_b32 v25, 0x80, v22
    v_xor_b32 v26, 0x1080, v23
    v_xor_b32 v27, 0x1080, v24
    v_xor_b32 v28, 0x1010, v22
    v_xor_b32 v29, 0x1010, v23
    v_xor_b32 v30, 0x2010, v24
    v_xor_b32 v31, 0x2090, v22
    v_xor_b32 v32, 0x2090, v23
    v_xor_b32 v33, 0x2090, v24
    v_mov_b32 v248, 0x10000
    s_mul_i32 s36, s3, 6144
    s_mul_i32 s37, s3, 12288
    s_add_u32 s40, s36, 0
    s_add_u32 s41, s37, 24576
    s_add_u32 s42, s37, 73728
    s_mul_i32 s56, s2, 393216
    s_mul_i32 s57, s2, 98304
    s_mov_b64 s[60:61], s[56:57]
    s_mov_b32 s30, 98304
    s_mov_b32 s31, 0x20000
    s_mov_b32 s26, 393216
    s_mov_b32 s27, 0x20000
    s_mov_b32 s34, 8388608
    s_mov_b32 s35, 0x20000
    s_mov_b32 m0, s40
    s_and_b32 s56, s2, 7
    s_cmp_eq_u32 s56, 6
    s_cbranch_scc1 L_spec
    s_and_b32 s56, s2, 7
    s_cbranch_scc1 L_plain
L_spec:
    s_waitcnt lgkmcnt(0)
    s_add_u32 s28, s8, s61
    s_addc_u32 s29, s9, 0
    s_add_u32 s24, s6, s60
    s_addc_u32 s25, s7, 0
    s_mov_b64 s[32:33], s[22:23]
    s_lshr_b32 s43, s2, 3
    s_mul_i32 s57, s43, 2304
    v_min_u32 v1, 17, v0
    v_lshlrev_b32 v1, 7, v1
    s_mov_b32 s66, 73728
    s_mov_b32 s67, 0x20000
    s_mov_b32 s70, 73728
    s_mov_b32 s71, 0x20000
    s_mov_b32 s72, s4
    s_mov_b32 s73, s5
    s_mov_b32 s74, 6144
    s_mov_b32 s75, 0x20000
    s_bitcmp1_b32 s2, 2
    s_cselect_b64 s[64:65], s[16:17], s[10:11]
    s_cselect_b64 s[68:69], s[14:15], s[12:13]
    s_cmp_eq_u32 s3, 0
    s_cbranch_scc1 L_pf0
    s_cmp_eq_u32 s3, 1
    s_cbranch_scc0 L_pfdone
    s_lshl_b32 s58, s43, 8
    buffer_load_dword v234, v1, s[68:71], s57 offen
    v_min_u32 v2, 128, v1
    buffer_load_dword v235, v2, s[72:75], s58 offen
    s_branch L_pfdone
L_pf0:
    buffer_load_dword v234, v1, s[64:67], s57 offen
L_pfdone:
    s_cmp_ge_u32 s43, 3
    s_cbranch_scc1 L_nopf
    s_mov_b32 s0, 1
    s_bitcmp1_b32 s2, 2
    s_cbranch_scc0 L_prod
    s_branch L_vprod
L_plain:
    s_waitcnt lgkmcnt(0)
L_nopf:
    s_add_u32 s28, s8, s61
    s_addc_u32 s29, s9, 0
    buffer_load_dwordx4 v16, s[28:31], s36 offen offset:0 nt lds
    s_add_u32 s24, s6, s60
    s_addc_u32 s25, s7, 0
    s_mov_b64 s[32:33], s[22:23]
    s_mov_b32 s0, 0
    buffer_load_dwordx4 v17, s[28:31], s36 offen offset:1024 nt lds
    buffer_load_dwordx4 v18, s[28:31], s36 offen offset:2048 nt lds
    buffer_load_dwordx4 v19, s[28:31], s36 offen offset:3072 nt lds
    s_add_u32 m0, s40, 4096
    s_load_dword s38, s[22:23], 0
    buffer_load_dwordx4 v20, s[28:31], s36 offen offset:0 nt lds
    buffer_load_dwordx4 v21, s[28:31], s36 offen offset:1024 nt lds
    s_mov_b32 s43, -1
    s_sub_u32 s59, s2, 64
    s_cmp_ge_u32 s59, 64
    s_cbranch_scc1 L_nocs
    s_mov_b32 s64, s4
    s_mov_b32 s65, s5
    s_mov_b32 s66, 6144
    s_mov_b32 s67, 0x20000
    s_mov_b32 s68, s18
    s_mov_b32 s69, s19
    s_mov_b32 s70, 6144
    s_mov_b32 s71, 0x20000
    v_bfe_u32 v1, v0, 2, 1
    v_mul_u32_u24 v2, 7, v1
    v_xor_b32 v2, v0, v2
    v_and_b32 v2, 3, v2
    s_lshr_b32 s56, s59, 4
    s_lshl_b32 s56, s56, 2
    v_add_u32 v2, s56, v2
    v_lshlrev_b32 v252, 2, v2
    v_lshrrev_b32 v3, 4, v0
    v_mad_u32_u24 v3, v1, 3, v3
    v_lshrrev_b32 v4, 1, v3
    v_and_b32 v3, 1, v3
    v_lshlrev_b32 v3, 2, v3
    v_lshl_add_u32 v3, v4, 5, v3
    v_bfe_u32 v4, v0, 3, 1
    v_lshl_add_u32 v3, v4, 1, v3
    v_mul_u32_u24 v2, 384, v2
    s_bfe_u32 s56, s59, 0x20002
    s_mul_i32 s56, s56, 96
    s_and_b32 s57, s59, 3
    s_lshl_b32 s57, s57, 3
    s_add_u32 s56, s56, s57
    v_add3_u32 v248, s56, v2, v3
    v_cmp_gt_u32 vcc, 48, v0
    v_mov_b32 v4, 0x10000
    s_lshl_b32 s56, s3, 2
    v_cndmask_b32 v248, v4, v248, vcc
    buffer_load_ushort v249, v248, s[64:67], 0 offen
    s_or_b32 s57, s59, s3
    s_cselect_b32 s70, 0, 6144
    v_lshlrev_b32 v4, 7, v0
    buffer_load_ushort v246, v4, s[68:71], 0 offen
    v_add_u32 v250, s56, v65
    v_and_b32 v251, 0x70, v65
L_nocs:
    s_add_u32 m0, s41, 0
    s_add_u32 s58, s37, 0
    buffer_load_dwordx4 v22, s[24:27], s58 offen offset:0 nt lds
    buffer_load_dwordx4 v23, s[24:27], s58 offen offset:1024 nt lds
    buffer_load_dwordx4 v24, s[24:27], s58 offen offset:2048 nt lds
    buffer_load_dwordx4 v25, s[24:27], s58 offen offset:3072 nt lds
    s_add_u32 m0, s41, 4096
    s_nop 0
    buffer_load_dwordx4 v26, s[24:27], s58 offen offset:0 nt lds
    buffer_load_dwordx4 v27, s[24:27], s58 offen offset:1024 nt lds
    buffer_load_dwordx4 v28, s[24:27], s58 offen offset:2048 nt lds
    buffer_load_dwordx4 v29, s[24:27], s58 offen offset:3072 nt lds
    s_add_u32 m0, s41, 8192
    s_nop 0
    buffer_load_dwordx4 v30, s[24:27], s58 offen offset:0 nt lds
    buffer_load_dwordx4 v31, s[24:27], s58 offen offset:1024 nt lds
    buffer_load_dwordx4 v32, s[24:27], s58 offen offset:2048 nt lds
    buffer_load_dwordx4 v33, s[24:27], s58 offen offset:3072 nt lds
    s_add_u32 m0, s42, 0
    s_add_u32 s59, s37, 196608
    buffer_load_dwordx4 v22, s[24:27], s59 offen offset:0 nt lds
    buffer_load_dwordx4 v23, s[24:27], s59 offen offset:1024 nt lds
    buffer_load_dwordx4 v24, s[24:27], s59 offen offset:2048 nt lds
    buffer_load_dwordx4 v25, s[24:27], s59 offen offset:3072 nt lds
    s_add_u32 m0, s42, 4096
    s_nop 0
    buffer_load_dwordx4 v26, s[24:27], s59 offen offset:0 nt lds
    buffer_load_dwordx4 v27, s[24:27], s59 offen offset:1024 nt lds
    buffer_load_dwordx4 v28, s[24:27], s59 offen offset:2048 nt lds
    buffer_load_dwordx4 v29, s[24:27], s59 offen offset:3072 nt lds
    s_add_u32 m0, s42, 8192
    s_nop 0
    buffer_load_dwordx4 v30, s[24:27], s59 offen offset:0 nt lds
    buffer_load_dwordx4 v31, s[24:27], s59 offen offset:1024 nt lds
    buffer_load_dwordx4 v32, s[24:27], s59 offen offset:2048 nt lds
    buffer_load_dwordx4 v33, s[24:27], s59 offen offset:3072 nt lds
    v_and_b32 v1, 15, v0
    v_lshrrev_b32 v6, 5, v0
    v_bfe_u32 v3, v0, 4, 1
    v_lshl_or_b32 v3, v3, 1, v6
    v_lshrrev_b32 v4, 2, v0
    v_bfe_u32 v5, v0, 1, 1
    v_lshrrev_b32 v6, 3, v1
    v_and_or_b32 v6, v1, 6, v6
    v_xor_b32 v6, v6, v3
    v_mul_u32_u24 v7, 384, v1
    v_lshl_add_u32 v6, v6, 4, v7
    v_add_u32 v34, s40, v6
    v_xor_b32 v35, 64, v34
    v_lshrrev_b32 v6, 3, v1
    v_and_b32 v7, 7, v1
    v_lshl_or_b32 v6, v7, 1, v6
    v_xor_b32 v6, v6, v3
    v_mul_u32_u24 v7, 768, v1
    v_lshl_add_u32 v6, v6, 4, v7
    v_add_u32 v40, s41, v6
    v_xor_b32 v41, 0x40, v40
    v_xor_b32 v42, 0x80, v40
    v_xor_b32 v43, 0xc0, v40
    v_and_b32 v2, 1, v0
    v_lshlrev_b32 v2, 3, v2
    s_mul_i32 s56, s3, 96
    v_lshrrev_b32 v6, 3, v4
    v_and_or_b32 v6, v4, 6, v6
    v_xor_b32 v6, v6, v5
    v_lshl_add_u32 v6, v6, 4, v2
    v_mul_u32_u24 v7, 384, v4
    s_add_u32 s57, s56, 0
    v_xad_u32 v36, v6, s57, v7
    s_add_u32 s57, s56, 32
    v_xad_u32 v37, v6, s57, v7
    s_add_u32 s57, s56, 64
    v_xad_u32 v38, v6, s57, v7
    v_lshrrev_b32 v6, 3, v4
    v_and_b32 v3, 7, v4
    v_lshl_or_b32 v6, v3, 1, v6
    v_xor_b32 v6, v6, v5
    v_lshl_add_u32 v6, v6, 4, v2
    v_lshlrev_b32 v7, 1, v7
    v_add_u32 v7, 24576, v7
    s_add_u32 s57, s56, 0
    v_xad_u32 v44, v6, s57, v7
    s_add_u32 s57, s56, 384
    v_xad_u32 v45, v6, s57, v7
    s_add_u32 s57, s56, 32
    v_xad_u32 v46, v6, s57, v7
    s_add_u32 s57, s56, 416
    v_xad_u32 v47, v6, s57, v7
    s_add_u32 s57, s56, 64
    v_xad_u32 v48, v6, s57, v7
    s_add_u32 s57, s56, 448
    v_xad_u32 v49, v6, s57, v7
    v_mov_b32 v52, 0x3f803f80
    v_mov_b32 v56, 0x3ebcbe62
    s_mov_b32 s44, 0x100001
    s_mov_b32 s45, 0x10000100
    v_mov_b32 v53, 0x3f803f80
    v_mov_b32 v57, 0x3ebcbe62
    s_mov_b32 s46, 0x200002
    s_mov_b32 s47, 0x20000200
    v_mov_b32 v54, 0x3f803f80
    v_mov_b32 v58, 0x3ebcbe62
    s_mov_b32 s48, 0x400004
    s_mov_b32 s49, 0x40000400
    v_mov_b32 v55, 0x3f803f80
    v_mov_b32 v59, 0x3ebcbe62
    s_mov_b32 s50, 0x800008
    s_mov_b32 s51, 0x80000800
    v_mov_b32 v60, 0x43400000
    v_lshrrev_b32 v1, 5, v0
    v_lshlrev_b32 v1, 8, v1
    v_and_b32 v2, 15, v0
    v_lshl_add_u32 v1, v2, 4, v1
    v_bfe_u32 v2, v0, 4, 1
    v_lshl_add_u32 v1, v2, 3, v1
    s_mul_i32 s56, s3, 1536
    s_add_u32 s56, s56, 147456
    v_add_u32 v236, s56, v1
    s_mul_i32 s56, s3, 3072
    s_add_u32 s56, s56, 24576
    v_add_u32 v237, s56, v65
    v_add_u32 v238, s41, v65
    s_lshl_b32 s56, s3, 10
    v_add_u32 v240, 159744, v65
    v_add_u32 v239, s56, v240
    v_add_u32 v241, 147456, v65
    v_bfe_u32 v1, v0, 2, 2
    v_lshrrev_b32 v2, 4, v0
    v_lshl_or_b32 v1, v1, 4, v2
    v_mul_u32_u24 v1, 32768, v1
    v_and_b32 v2, 3, v0
    v_lshl_or_b32 v242, v2, 4, v1
    v_xor_b32 v243, 0x70, v242
    s_mul_i32 s56, s3, 3
    v_min_u32 v1, 2, v0
    v_add_u32 v1, s56, v1
    v_lshlrev_b32 v245, 7, v1
    v_lshlrev_b32 v1, 3, v0
    v_add_u32 v254, 126976, v1
    s_lshl_b32 s56, s3, 9
    v_add_u32 v238, s56, v254
    v_add_u32 v253, 122880, v65
    s_lshl_b32 s56, s3, 10
    v_add_u32 v237, s56, v253
    s_mov_b32 s52, 0x41c00000
L_join:
    s_mul_i32 s60, s3, 18432
    s_mov_b32 s72, s22
    s_mov_b32 s73, s23
    s_mov_b32 s74, 8388608
    s_mov_b32 s75, 0x20000
    s_cmp_eq_u32 s0, 1
    s_cselect_b32 s74, 0, s74
    s_waitcnt vmcnt(24)
    s_waitcnt lgkmcnt(0)
    s_barrier
    ds_read_b128 a[48:51], v34 offset:0
    ds_read_b128 a[52:55], v35 offset:0
    ds_read_b128 a[56:59], v34 offset:128
    ds_read_b128 a[60:63], v35 offset:128
    ds_read_b128 a[64:67], v34 offset:256
    ds_read_b128 a[68:71], v35 offset:256
    s_waitcnt lgkmcnt(5)
    v_mfma_f32_16x16x32_bf16 v[84:87], a[48:51], a[48:51], 0
    ds_read_b64_tr_b16 a[72:73], v36 offset:0
    ds_read_b64_tr_b16 a[74:75], v36 offset:6144
    v_mfma_f32_16x16x32_bf16 v[80:83], a[48:51], v[52:55], 0
    ds_read_b64_tr_b16 a[76:77], v36 offset:12288
    ds_read_b64_tr_b16 a[78:79], v36 offset:18432
    s_waitcnt lgkmcnt(8)
    v_mfma_f32_16x16x32_bf16 v[84:87], a[52:55], a[52:55], v[84:87]
    ds_read_b64_tr_b16 a[80:81], v37 offset:0
    ds_read_b64_tr_b16 a[82:83], v37 offset:6144
    v_mfma_f32_16x16x32_bf16 v[80:83], a[52:55], v[52:55], v[80:83]
    ds_read_b64_tr_b16 a[84:85], v37 offset:12288
    ds_read_b64_tr_b16 a[86:87], v37 offset:18432
    s_waitcnt lgkmcnt(11)
    v_mfma_f32_16x16x32_bf16 v[84:87], a[56:59], a[56:59], v[84:87]
    ds_read_b64_tr_b16 a[88:89], v38 offset:0
    ds_read_b64_tr_b16 a[90:91], v38 offset:6144
    v_mfma_f32_16x16x32_bf16 v[80:83], a[56:59], v[52:55], v[80:83]
    ds_read_b64_tr_b16 a[92:93], v38 offset:12288
    ds_read_b64_tr_b16 a[94:95], v38 offset:18432
    s_waitcnt lgkmcnt(14)
    v_mfma_f32_16x16x32_bf16 v[84:87], a[60:63], a[60:63], v[84:87]
    v_mfma_f32_16x16x32_bf16 v[80:83], a[60:63], v[52:55], v[80:83]
    s_waitcnt lgkmcnt(13)
    v_mfma_f32_16x16x32_bf16 v[84:87], a[64:67], a[64:67], v[84:87]
    v_mfma_f32_16x16x32_bf16 v[80:83], a[64:67], v[52:55], v[80:83]
    s_waitcnt lgkmcnt(12)
    v_mfma_f32_16x16x32_bf16 v[84:87], a[68:71], a[68:71], v[84:87]
    v_mfma_f32_16x16x32_bf16 v[80:83], a[68:71], v[52:55], v[80:83]
    s_waitcnt lgkmcnt(0)
    s_mul_i32 s39, s38, 0x9e3779b1
    s_add_u32 s39, s39, 0x7f4a7c16
    s_or_b32 s39, s39, 1
    s_mul_i32 s56, s3, 3072
    s_add_u32 s56, s56, 16384
    buffer_load_dwordx4 v[136:139], v65, s[32:35], s56 offen offset:0 sc1
    buffer_load_dwordx4 v[140:143], v65, s[32:35], s56 offen offset:1024 sc1
    buffer_load_dwordx4 v[144:147], v65, s[32:35], s56 offen offset:2048 sc1
    s_waitcnt vmcnt(15)
    s_barrier
    ds_read_b128 a[96:99], v40 offset:0
    ds_read_b128 a[100:103], v41 offset:0
    ds_read_b128 a[104:107], v42 offset:0
    ds_read_b128 a[108:111], v43 offset:0
    ds_read_b128 a[112:115], v40 offset:256
    ds_read_b128 a[116:119], v41 offset:256
    ds_read_b128 a[120:123], v42 offset:256
    ds_read_b128 a[124:127], v43 offset:256
    ds_read_b128 a[128:131], v40 offset:512
    ds_read_b128 a[132:135], v41 offset:512
    ds_read_b128 a[136:139], v42 offset:512
    ds_read_b128 a[140:143], v43 offset:512
    ds_read_b64_tr_b16 a[144:145], v44 offset:0
    ds_read_b64_tr_b16 a[146:147], v45 offset:0
    ds_read_b64_tr_b16 a[148:149], v44 offset:12288
    ds_read_b64_tr_b16 a[150:151], v45 offset:12288
    ds_read_b64_tr_b16 a[152:153], v44 offset:24576
    ds_read_b64_tr_b16 a[154:155], v45 offset:24576
    ds_read_b64_tr_b16 a[156:157], v44 offset:36864
    ds_read_b64_tr_b16 a[158:159], v45 offset:36864
    ds_read_b64_tr_b16 a[160:161], v46 offset:0
    ds_read_b64_tr_b16 a[162:163], v47 offset:0
    ds_read_b64_tr_b16 a[164:165], v46 offset:12288
    ds_read_b64_tr_b16 a[166:167], v47 offset:12288
    ds_read_b64_tr_b16 a[168:169], v46 offset:24576
    ds_read_b64_tr_b16 a[170:171], v47 offset:24576
    ds_read_b64_tr_b16 a[172:173], v46 offset:36864
    ds_read_b64_tr_b16 a[174:175], v47 offset:36864
    ds_read_b64_tr_b16 a[176:177], v48 offset:0
    ds_read_b64_tr_b16 a[178:179], v49 offset:0
    ds_read_b64_tr_b16 a[180:181], v48 offset:12288
    ds_read_b64_tr_b16 a[182:183], v49 offset:12288
    ds_read_b64_tr_b16 a[184:185], v48 offset:24576
    ds_read_b64_tr_b16 a[186:187], v49 offset:24576
    ds_read_b64_tr_b16 a[188:189], v48 offset:36864
    ds_read_b64_tr_b16 a[190:191], v49 offset:36864
    s_waitcnt lgkmcnt(0)
    s_barrier
    s_cmp_ge_u32 s43, 3
    s_cbranch_scc1 L_v_nofl
    s_mul_i32 s56, s3, 3
    s_add_u32 s56, s56, s43
    s_lshl_b32 s56, s56, 7
    v_mov_b32 v1, s39
    v_mov_b32 v2, 0
    s_mov_b64 exec, 1
    s_waitcnt vmcnt(9)
    buffer_store_dword v1, v2, s[32:35], s56 offen offset:128 sc1
    s_mov_b64 exec, -1
L_v_nofl:
    v_mfma_f32_16x16x32_bf16 v[96:99], a[96:99], a[96:99], v[84:87]
    s_add_u32 m0, s40, 0
    s_add_u32 s57, s36, 24576
    buffer_load_dwordx4 v16, s[28:31], s57 offen offset:0 nt lds
    v_add_u32 v44, 49152, v44
    v_add_u32 v45, 49152, v45
    v_mfma_f32_16x16x32_bf16 v[100:103], a[96:99], a[48:51], 0
    buffer_load_dwordx4 v17, s[28:31], s57 offen offset:1024 nt lds
    v_add_u32 v46, 49152, v46
    v_add_u32 v47, 49152, v47
    v_mfma_f32_16x16x32_bf16 v[96:99], a[100:103], a[100:103], v[96:99]
    buffer_load_dwordx4 v18, s[28:31], s57 offen offset:2048 nt lds
    v_add_u32 v48, 49152, v48
    v_add_u32 v49, 49152, v49
    v_mfma_f32_16x16x32_bf16 v[100:103], a[100:103], a[52:55], v[100:103]
    v_mfma_f32_16x16x32_bf16 v[96:99], a[104:107], a[104:107], v[96:99]
    v_mfma_f32_16x16x32_bf16 v[100:103], a[104:107], a[56:59], v[100:103]
    v_mfma_f32_16x16x32_bf16 v[96:99], a[108:111], a[108:111], v[96:99]
    v_mfma_f32_16x16x32_bf16 v[100:103], a[108:111], a[60:63], v[100:103]
    v_mfma_f32_16x16x32_bf16 v[96:99], a[112:115], a[112:115], v[96:99]
    v_mfma_f32_16x16x32_bf16 v[100:103], a[112:115], a[64:67], v[100:103]
    v_mfma_f32_16x16x32_bf16 v[96:99], a[116:119], a[116:119], v[96:99]
    v_mfma_f32_16x16x32_bf16 v[100:103], a[116:119], a[68:71], v[100:103]
    v_mfma_f32_16x16x32_bf16 v[92:95], a[96:99], v[52:55], v[80:83]
    v_mfma_f32_16x16x32_bf16 v[92:95], a[100:103], v[52:55], v[92:95]
    v_mfma_f32_16x16x32_bf16 v[92:95], a[104:107], v[52:55], v[92:95]
    v_mfma_f32_16x16x32_bf16 v[92:95], a[108:111], v[52:55], v[92:95]
    s_nop 3
    v_fma_f32 v96, v100, 2.0, v96
    v_fma_f32 v97, v101, 2.0, v97
    v_mfma_f32_16x16x32_bf16 v[92:95], a[112:115], v[52:55], v[92:95]
    buffer_load_dwordx4 v19, s[28:31], s57 offen offset:3072 nt lds
    v_fma_f32 v98, v102, 2.0, v98
    v_fma_f32 v99, v103, 2.0, v99
    v_mfma_f32_16x16x32_bf16 v[92:95], a[116:119], v[52:55], v[92:95]
    v_cndmask_b32 v3, 0, v96, s[44:45]
    v_cndmask_b32 v3, v3, v97, s[46:47]
    v_mfma_f32_16x16x32_bf16 v[112:115], a[120:123], a[120:123], v[84:87]
    v_cndmask_b32 v3, v3, v98, s[48:49]
    v_cndmask_b32 v3, v3, v99, s[50:51]
    v_mfma_f32_16x16x32_bf16 v[116:119], a[120:123], a[48:51], 0
    s_nop 0
    s_nop 0
    v_mfma_f32_16x16x32_bf16 v[112:115], a[124:127], a[124:127], v[112:115]
    v_mfma_f32_16x16x4_f32 v[120:123], v3, v60, v[56:59]
    v_mfma_f32_16x16x32_bf16 v[116:119], a[124:127], a[52:55], v[116:119]
    v_mfma_f32_16x16x32_bf16 v[112:115], a[128:131], a[128:131], v[112:115]
    v_mfma_f32_16x16x32_bf16 v[116:119], a[128:131], a[56:59], v[116:119]
    v_mfma_f32_16x16x32_bf16 v[112:115], a[132:135], a[132:135], v[112:115]
    s_nop 5
    v_fma_f32 v128, -v92, v92, v120
    v_fma_f32 v129, -v93, v93, v121
    v_mfma_f32_16x16x32_bf16 v[116:119], a[132:135], a[60:63], v[116:119]
    v_fma_f32 v130, -v94, v94, v122
    v_fma_f32 v131, -v95, v95, v123
    v_mfma_f32_16x16x32_bf16 v[112:115], a[136:139], a[136:139], v[112:115]
    v_max_f32 v128, v128, v56
    v_max_f32 v129, v129, v56
    v_mfma_f32_16x16x32_bf16 v[116:119], a[136:139], a[64:67], v[116:119]
    s_add_u32 m0, s40, 4096
    s_nop 0
    buffer_load_dwordx4 v20, s[28:31], s57 offen offset:0 nt lds
    v_max_f32 v130, v130, v56
    v_max_f32 v131, v131, v56
    v_mfma_f32_16x16x32_bf16 v[112:115], a[140:143], a[140:143], v[112:115]
    v_rsq_f32 v128, v128
    v_mfma_f32_16x16x32_bf16 v[116:119], a[140:143], a[68:71], v[116:119]
    v_rsq_f32 v129, v129
    v_mfma_f32_16x16x32_bf16 v[108:111], a[120:123], v[52:55], v[80:83]
    v_rsq_f32 v130, v130
    v_mfma_f32_16x16x32_bf16 v[108:111], a[124:127], v[52:55], v[108:111]
    v_rsq_f32 v131, v131
    v_mfma_f32_16x16x32_bf16 v[108:111], a[128:131], v[52:55], v[108:111]
    v_mfma_f32_16x16x32_bf16 v[108:111], a[132:135], v[52:55], v[108:111]
    v_mfma_f32_16x16x32_bf16 v[108:111], a[136:139], v[52:55], v[108:111]
    v_fma_f32 v112, v116, 2.0, v112
    v_fma_f32 v113, v117, 2.0, v113
    v_mfma_f32_16x16x32_bf16 v[108:111], a[140:143], v[52:55], v[108:111]
    v_fma_f32 v114, v118, 2.0, v114
    v_fma_f32 v115, v119, 2.0, v115
    v_cndmask_b32 v4, 0, v112, s[44:45]
    v_cndmask_b32 v4, v4, v113, s[46:47]
    v_cndmask_b32 v4, v4, v114, s[48:49]
    v_cndmask_b32 v4, v4, v115, s[50:51]
    s_nop 0
    s_nop 0
    v_mfma_f32_16x16x4_f32 v[124:127], v4, v60, v[56:59]
    s_nop 9
    v_fma_f32 v132, -v108, v108, v124
    v_fma_f32 v133, -v109, v109, v125
    v_fma_f32 v134, -v110, v110, v126
    v_fma_f32 v135, -v111, v111, v127
    v_max_f32 v132, v132, v56
    v_max_f32 v133, v133, v56
    v_max_f32 v134, v134, v56
    v_max_f32 v135, v135, v56
    v_rsq_f32 v132, v132
    v_rsq_f32 v133, v133
    v_rsq_f32 v134, v134
    v_rsq_f32 v135, v135
    s_mul_i32 s56, s3, 1536
    v_lshlrev_b32 v5, 3, v0
    v_add_u32 v5, 153600, v5
    v_add_u32 v4, s56, v5
    buffer_load_dwordx4 v21, s[28:31], s57 offen offset:1024 nt lds
    s_add_u32 m0, s41, 0
    s_add_u32 s58, s37, 49152
    buffer_load_dwordx4 v22, s[24:27], s58 offen offset:0 nt lds
    buffer_load_dwordx4 v23, s[24:27], s58 offen offset:1024 nt lds
    buffer_load_dwordx4 v24, s[24:27], s58 offen offset:2048 nt lds
    buffer_load_dwordx4 v25, s[24:27], s58 offen offset:3072 nt lds
    s_add_u32 m0, s41, 4096
    s_nop 0
    buffer_load_dwordx4 v26, s[24:27], s58 offen offset:0 nt lds
    buffer_load_dwordx4 v27, s[24:27], s58 offen offset:1024 nt lds
    s_waitcnt vmcnt(12)
    v_xor_b32 v1, s39, v138
    v_xor_b32 v2, s39, v142
    v_xor_b32 v3, s39, v146
    v_or3_b32 v1, v1, v2, v3
    v_cmp_ne_u32 vcc, 0, v1
    s_cbranch_vccnz L_qk_retry
L_qk_ok:
    ds_write_b64 v4, v[136:137] offset:0
    ds_write_b64 v4, v[140:141] offset:512
    ds_write_b64 v4, v[144:145] offset:1024
    s_waitcnt lgkmcnt(0)
    s_barrier
    ds_read2st64_b64 v[136:139], v5 offset0:0 offset1:1
    ds_read2st64_b64 v[140:143], v5 offset0:2 offset1:3
    ds_read2st64_b64 v[144:147], v5 offset0:4 offset1:5
    ds_read2st64_b64 v[148:151], v5 offset0:6 offset1:7
    ds_read2st64_b64 v[152:155], v5 offset0:8 offset1:9
    ds_read2st64_b64 v[156:159], v5 offset0:10 offset1:11
    s_waitcnt lgkmcnt(5)
    v_mfma_f32_16x16x32_bf16 v[120:123], v[52:55], v[136:139], 0
    buffer_load_dwordx4 v28, s[24:27], s58 offen offset:2048 nt lds
    v_mfma_f32_16x16x32_bf16 v[76:79], a[48:51], v[136:139], 0
    s_waitcnt lgkmcnt(4)
    v_mfma_f32_16x16x32_bf16 v[120:123], v[52:55], v[140:143], v[120:123]
    v_mfma_f32_16x16x32_bf16 v[76:79], a[52:55], v[140:143], v[76:79]
    s_waitcnt lgkmcnt(3)
    v_mfma_f32_16x16x32_bf16 v[120:123], v[52:55], v[144:147], v[120:123]
    v_mfma_f32_16x16x32_bf16 v[76:79], a[56:59], v[144:147], v[76:79]
    s_waitcnt lgkmcnt(2)
    v_mfma_f32_16x16x32_bf16 v[120:123], v[52:55], v[148:151], v[120:123]
    v_mfma_f32_16x16x32_bf16 v[76:79], a[60:63], v[148:151], v[76:79]
    s_waitcnt lgkmcnt(1)
    v_mfma_f32_16x16x32_bf16 v[120:123], v[52:55], v[152:155], v[120:123]
    buffer_load_dwordx4 v29, s[24:27], s58 offen offset:3072 nt lds
    v_mfma_f32_16x16x32_bf16 v[76:79], a[64:67], v[152:155], v[76:79]
    s_waitcnt lgkmcnt(0)
    v_mfma_f32_16x16x32_bf16 v[120:123], v[52:55], v[156:159], v[120:123]
    v_mfma_f32_16x16x32_bf16 v[76:79], a[68:71], v[156:159], v[76:79]
    s_nop 6
    v_mul_f32 v61, 0x3baaaaab, v120
    v_mfma_f32_16x16x32_bf16 v[88:91], a[96:99], v[136:139], v[76:79]
    v_mov_b32 v9, 0
    v_mfma_f32_16x16x32_bf16 v[88:91], a[100:103], v[140:143], v[88:91]
    v_mfma_f32_16x16x32_bf16 v[88:91], a[104:107], v[144:147], v[88:91]
    v_mfma_f32_16x16x32_bf16 v[88:91], a[108:111], v[148:151], v[88:91]
    v_mfma_f32_16x16x32_bf16 v[88:91], a[112:115], v[152:155], v[88:91]
    v_mfma_f32_16x16x32_bf16 v[88:91], a[116:119], v[156:159], v[88:91]
    ds_write_b32 v254, v9 offset:4096
    ds_write_b32 v254, v9 offset:4100
    v_mfma_f32_16x16x32_bf16 v[104:107], a[120:123], v[136:139], v[76:79]
    v_mfma_f32_16x16x32_bf16 v[104:107], a[124:127], v[140:143], v[104:107]
    v_mfma_f32_16x16x32_bf16 v[104:107], a[128:131], v[144:147], v[104:107]
    v_mfma_f32_16x16x32_bf16 v[104:107], a[132:135], v[148:151], v[104:107]
    s_nop 1
    v_fma_f32 v88, -v92, v61, v88
    v_fma_f32 v89, -v93, v61, v89
    v_mfma_f32_16x16x32_bf16 v[104:107], a[136:139], v[152:155], v[104:107]
    s_add_u32 m0, s41, 8192
    s_nop 0
    buffer_load_dwordx4 v30, s[24:27], s58 offen offset:0 nt lds
    v_fma_f32 v90, -v94, v61, v90
    v_fma_f32 v91, -v95, v61, v91
    v_mfma_f32_16x16x32_bf16 v[104:107], a[140:143], v[156:159], v[104:107]
    v_mul_f32 v88, v88, v128
    v_mul_f32 v89, v89, v129
    v_mul_f32 v90, v90, v130
    v_mul_f32 v91, v91, v131
    v_max3_f32 v1, v88, v89, v90
    v_max_f32 v1, v1, v91
    s_nop 1
    v_fma_f32 v104, -v108, v61, v104
    v_fma_f32 v105, -v109, v61, v105
    v_fma_f32 v106, -v110, v61, v106
    v_fma_f32 v107, -v111, v61, v107
    v_mul_f32 v104, v104, v132
    v_mul_f32 v105, v105, v133
    v_mul_f32 v106, v106, v134
    v_mul_f32 v107, v107, v135
    v_max3_f32 v1, v1, v104, v105
    v_max3_f32 v1, v1, v106, v107
    v_mov_b32 v2, v1
    s_nop 1
    v_permlane32_swap_b32 v1, v2
    v_max_f32 v1, v1, v2
    v_mov_b32 v2, v1
    s_nop 1
    v_permlane16_swap_b32 v1, v2
    v_max_f32 v1, v1, v2
    ds_write_b32 v239, v1
    s_waitcnt lgkmcnt(0)
    s_barrier
    ds_read_b32 v12, v240 offset:0
    ds_read_b32 v13, v240 offset:1024
    ds_read_b32 v14, v240 offset:2048
    ds_read_b32 v15, v240 offset:3072
    buffer_load_dwordx4 v31, s[24:27], s58 offen offset:1024 nt lds
    s_waitcnt lgkmcnt(0)
    v_max3_f32 v1, v12, v13, v14
    v_max_f32 v1, v1, v15
    v_sub_f32 v88, v88, v1
    v_sub_f32 v89, v89, v1
    v_sub_f32 v90, v90, v1
    v_sub_f32 v91, v91, v1
    v_sub_f32 v104, v104, v1
    v_sub_f32 v105, v105, v1
    v_sub_f32 v106, v106, v1
    v_sub_f32 v107, v107, v1
    v_sub_f32 v62, 0, v1
    v_sub_f32 v255, 0, v1
    v_exp_f32 v96, v88
    v_exp_f32 v97, v89
    v_exp_f32 v98, v90
    v_exp_f32 v99, v91
    v_mul_f32 v88, v96, v128
    v_mul_f32 v89, v97, v129
    v_mul_f32 v90, v98, v130
    v_mul_f32 v91, v99, v131
    v_exp_f32 v112, v104
    v_exp_f32 v113, v105
    v_exp_f32 v114, v106
    v_exp_f32 v115, v107
    v_cvt_pk_bf16_f32 v72, v88, v89
    v_cvt_pk_bf16_f32 v73, v90, v91
    v_mul_f32 v104, v112, v132
    v_mul_f32 v105, v113, v133
    v_mul_f32 v106, v114, v134
    v_mul_f32 v107, v115, v135
    v_cvt_pk_bf16_f32 v74, v104, v105
    v_cvt_pk_bf16_f32 v75, v106, v107
    ds_write_b128 v237, v[72:75] offset:0
    v_mov_b32 v63, v96
    v_mul_f32 v64, v88, v92
    v_add_f32 v63, v63, v97
    v_fmac_f32 v64, v89, v93
    v_add_f32 v63, v63, v98
    v_fmac_f32 v64, v90, v94
    v_add_f32 v63, v63, v99
    v_fmac_f32 v64, v91, v95
    v_mov_b32 v68, v88
    v_mov_b32 v69, v89
    v_mov_b32 v70, v90
    v_mov_b32 v71, v91
    s_waitcnt lgkmcnt(0)
    s_barrier
    ds_read_b128 v[92:95], v253 offset:0
    ds_read_b128 v[96:99], v253 offset:1024
    ds_read_b128 v[100:103], v253 offset:2048
    ds_read_b128 v[116:119], v253 offset:3072
    s_waitcnt lgkmcnt(3)
    v_mfma_f32_16x16x32_bf16 a[0:3], a[144:147], v[92:95], 0
    buffer_load_dwordx4 v32, s[24:27], s58 offen offset:2048 nt lds
    v_add_f32 v68, v68, v104
    v_add_f32 v69, v69, v105
    v_mfma_f32_16x16x32_bf16 a[4:7], a[160:163], v[92:95], 0
    buffer_load_dwordx4 v33, s[24:27], s58 offen offset:3072 nt lds
    v_add_f32 v70, v70, v106
    v_add_f32 v71, v71, v107
    v_mfma_f32_16x16x32_bf16 a[8:11], a[176:179], v[92:95], 0
    v_add_f32 v63, v63, v112
    v_fma_f32 v64, v104, v108, v64
    s_waitcnt lgkmcnt(2)
    v_mfma_f32_16x16x32_bf16 a[0:3], a[148:151], v[96:99], a[0:3]
    v_add_f32 v63, v63, v113
    v_fma_f32 v64, v105, v109, v64
    v_mfma_f32_16x16x32_bf16 a[4:7], a[164:167], v[96:99], a[4:7]
    v_add_f32 v63, v63, v114
    v_fma_f32 v64, v106, v110, v64
    v_mfma_f32_16x16x32_bf16 a[8:11], a[180:183], v[96:99], a[8:11]
    v_add_f32 v63, v63, v115
    v_fma_f32 v64, v107, v111, v64
    s_waitcnt lgkmcnt(1)
    v_mfma_f32_16x16x32_bf16 a[0:3], a[152:155], v[100:103], a[0:3]
    v_mfma_f32_16x16x32_bf16 a[4:7], a[168:171], v[100:103], a[4:7]
    v_mfma_f32_16x16x32_bf16 a[8:11], a[184:187], v[100:103], a[8:11]
    s_waitcnt lgkmcnt(0)
    v_mfma_f32_16x16x32_bf16 a[0:3], a[156:159], v[116:119], a[0:3]
    v_mfma_f32_16x16x32_bf16 a[4:7], a[172:175], v[116:119], a[4:7]
    v_mfma_f32_16x16x32_bf16 a[8:11], a[188:191], v[116:119], a[8:11]
    s_barrier
    ds_read_b128 a[96:99], v40 offset:49152
    ds_read_b128 a[100:103], v41 offset:49152
    ds_read_b128 a[104:107], v42 offset:49152
    ds_read_b128 a[108:111], v43 offset:49152
    ds_read_b128 a[112:115], v40 offset:49408
    ds_read_b128 a[116:119], v41 offset:49408
    ds_read_b128 a[120:123], v42 offset:49408
    ds_read_b128 a[124:127], v43 offset:49408
    ds_read_b128 a[128:131], v40 offset:49664
    ds_read_b128 a[132:135], v41 offset:49664
    ds_read_b128 a[136:139], v42 offset:49664
    ds_read_b128 a[140:143], v43 offset:49664
    s_waitcnt lgkmcnt(11)
    v_mfma_f32_16x16x32_bf16 v[96:99], a[96:99], a[96:99], v[84:87]
    ds_read_b64_tr_b16 a[144:145], v44 offset:0
    ds_read_b64_tr_b16 a[146:147], v45 offset:0
    v_mfma_f32_16x16x32_bf16 v[100:103], a[96:99], a[48:51], 0
    ds_read_b64_tr_b16 a[148:149], v44 offset:12288
    ds_read_b64_tr_b16 a[150:151], v45 offset:12288
    s_waitcnt lgkmcnt(14)
    v_mfma_f32_16x16x32_bf16 v[96:99], a[100:103], a[100:103], v[96:99]
    ds_read_b64_tr_b16 a[152:153], v44 offset:24576
    ds_read_b64_tr_b16 a[154:155], v45 offset:24576
    v_mfma_f32_16x16x32_bf16 v[100:103], a[100:103], a[52:55], v[100:103]
    ds_read_b64_tr_b16 a[156:157], v44 offset:36864
    ds_read_b64_tr_b16 a[158:159], v45 offset:36864
    s_waitcnt lgkmcnt(15)
    v_mfma_f32_16x16x32_bf16 v[96:99], a[104:107], a[104:107], v[96:99]
    ds_read_b64_tr_b16 a[160:161], v46 offset:0
    ds_read_b64_tr_b16 a[162:163], v47 offset:0
    v_mfma_f32_16x16x32_bf16 v[100:103], a[104:107], a[56:59], v[100:103]
    ds_read_b64_tr_b16 a[164:165], v46 offset:12288
    ds_read_b64_tr_b16 a[166:167], v47 offset:12288
    v_mfma_f32_16x16x32_bf16 v[96:99], a[108:111], a[108:111], v[96:99]
    ds_read_b64_tr_b16 a[168:169], v46 offset:24576
    ds_read_b64_tr_b16 a[170:171], v47 offset:24576
    v_mfma_f32_16x16x32_bf16 v[100:103], a[108:111], a[60:63], v[100:103]
    ds_read_b64_tr_b16 a[172:173], v46 offset:36864
    ds_read_b64_tr_b16 a[174:175], v47 offset:36864
    v_mfma_f32_16x16x32_bf16 v[96:99], a[112:115], a[112:115], v[96:99]
    ds_read_b64_tr_b16 a[176:177], v48 offset:0
    ds_read_b64_tr_b16 a[178:179], v49 offset:0
    v_mfma_f32_16x16x32_bf16 v[100:103], a[112:115], a[64:67], v[100:103]
    ds_read_b64_tr_b16 a[180:181], v48 offset:12288
    ds_read_b64_tr_b16 a[182:183], v49 offset:12288
    s_waitcnt lgkmcnt(15)
    v_mfma_f32_16x16x32_bf16 v[96:99], a[116:119], a[116:119], v[96:99]
    ds_read_b64_tr_b16 a[184:185], v48 offset:24576
    ds_read_b64_tr_b16 a[186:187], v49 offset:24576
    v_mfma_f32_16x16x32_bf16 v[100:103], a[116:119], a[68:71], v[100:103]
    ds_read_b64_tr_b16 a[188:189], v48 offset:36864
    ds_read_b64_tr_b16 a[190:191], v49 offset:36864
    v_mfma_f32_16x16x32_bf16 v[92:95], a[96:99], v[52:55], v[80:83]
    v_mfma_f32_16x16x32_bf16 v[92:95], a[100:103], v[52:55], v[92:95]
    v_mfma_f32_16x16x32_bf16 v[92:95], a[104:107], v[52:55], v[92:95]
    v_mfma_f32_16x16x32_bf16 v[92:95], a[108:111], v[52:55], v[92:95]
    s_nop 1
    v_fma_f32 v96, v100, 2.0, v96
    v_fma_f32 v97, v101, 2.0, v97
    v_mfma_f32_16x16x32_bf16 v[92:95], a[112:115], v[52:55], v[92:95]
    v_fma_f32 v98, v102, 2.0, v98
    v_fma_f32 v99, v103, 2.0, v99
    v_mfma_f32_16x16x32_bf16 v[92:95], a[116:119], v[52:55], v[92:95]
    v_cndmask_b32 v3, 0, v96, s[44:45]
    v_cndmask_b32 v3, v3, v97, s[46:47]
    v_mfma_f32_16x16x32_bf16 v[88:91], a[96:99], v[136:139], v[76:79]
    v_cndmask_b32 v3, v3, v98, s[48:49]
    v_cndmask_b32 v3, v3, v99, s[50:51]
    v_mfma_f32_16x16x32_bf16 v[88:91], a[100:103], v[140:143], v[88:91]
    s_nop 0
    s_nop 0
    v_mfma_f32_16x16x32_bf16 v[88:91], a[104:107], v[144:147], v[88:91]
    v_mfma_f32_16x16x4_f32 v[120:123], v3, v60, v[56:59]
    v_mfma_f32_16x16x32_bf16 v[88:91], a[108:111], v[148:151], v[88:91]
    v_mfma_f32_16x16x32_bf16 v[88:91], a[112:115], v[152:155], v[88:91]
    v_mfma_f32_16x16x32_bf16 v[88:91], a[116:119], v[156:159], v[88:91]
    s_waitcnt lgkmcnt(0)
    s_barrier
    v_mfma_f32_16x16x32_bf16 v[112:115], a[120:123], a[120:123], v[84:87]
    s_add_u32 m0, s42, 0
    s_add_u32 s59, s37, 245760
    buffer_load_dwordx4 v22, s[24:27], s59 offen offset:0 nt lds
    v_mfma_f32_16x16x32_bf16 v[116:119], a[120:123], a[48:51], 0
    buffer_load_dwordx4 v23, s[24:27], s59 offen offset:1024 nt lds
    v_mfma_f32_16x16x32_bf16 v[112:115], a[124:127], a[124:127], v[112:115]
    buffer_load_dwordx4 v24, s[24:27], s59 offen offset:2048 nt lds
    v_mfma_f32_16x16x32_bf16 v[116:119], a[124:127], a[52:55], v[116:119]
    buffer_load_dwordx4 v25, s[24:27], s59 offen offset:3072 nt lds
    v_fma_f32 v128, -v92, v92, v120
    v_fma_f32 v129, -v93, v93, v121
    v_mfma_f32_16x16x32_bf16 v[112:115], a[128:131], a[128:131], v[112:115]
    v_fma_f32 v130, -v94, v94, v122
    v_fma_f32 v131, -v95, v95, v123
    v_mfma_f32_16x16x32_bf16 v[116:119], a[128:131], a[56:59], v[116:119]
    v_max_f32 v128, v128, v56
    v_max_f32 v129, v129, v56
    v_mfma_f32_16x16x32_bf16 v[112:115], a[132:135], a[132:135], v[112:115]
    v_max_f32 v130, v130, v56
    v_max_f32 v131, v131, v56
    v_mfma_f32_16x16x32_bf16 v[116:119], a[132:135], a[60:63], v[116:119]
    s_add_u32 m0, s42, 4096
    s_nop 0
    buffer_load_dwordx4 v26, s[24:27], s59 offen offset:0 nt lds
    v_rsq_f32 v128, v128
    v_mfma_f32_16x16x32_bf16 v[112:115], a[136:139], a[136:139], v[112:115]
    v_rsq_f32 v129, v129
    v_mfma_f32_16x16x32_bf16 v[116:119], a[136:139], a[64:67], v[116:119]
    v_rsq_f32 v130, v130
    v_mfma_f32_16x16x32_bf16 v[112:115], a[140:143], a[140:143], v[112:115]
    v_rsq_f32 v131, v131
    v_mfma_f32_16x16x32_bf16 v[116:119], a[140:143], a[68:71], v[116:119]
    v_fma_f32 v88, -v92, v61, v88
    v_fma_f32 v89, -v93, v61, v89
    v_mfma_f32_16x16x32_bf16 v[108:111], a[120:123], v[52:55], v[80:83]
    v_fma_f32 v90, -v94, v61, v90
    v_fma_f32 v91, -v95, v61, v91
    v_mfma_f32_16x16x32_bf16 v[108:111], a[124:127], v[52:55], v[108:111]
    v_fma_f32 v88, v88, v128, v62
    v_fma_f32 v89, v89, v129, v62
    v_mfma_f32_16x16x32_bf16 v[108:111], a[128:131], v[52:55], v[108:111]
    v_fma_f32 v90, v90, v130, v62
    v_fma_f32 v91, v91, v131, v62
    v_mfma_f32_16x16x32_bf16 v[108:111], a[132:135], v[52:55], v[108:111]
    v_max3_f32 v1, v88, v89, v90
    v_max_f32 v1, v1, v91
    v_mfma_f32_16x16x32_bf16 v[108:111], a[136:139], v[52:55], v[108:111]
    v_cmp_lt_f32 vcc, s52, v1
    s_cbranch_vccnz L_site0
L_back0:
    v_mfma_f32_16x16x32_bf16 v[108:111], a[140:143], v[52:55], v[108:111]
    v_exp_f32 v96, v88
    v_mfma_f32_16x16x32_bf16 v[104:107], a[120:123], v[136:139], v[76:79]
    v_exp_f32 v97, v89
    v_mfma_f32_16x16x32_bf16 v[104:107], a[124:127], v[140:143], v[104:107]
    v_exp_f32 v98, v90
    v_mfma_f32_16x16x32_bf16 v[104:107], a[128:131], v[144:147], v[104:107]
    buffer_load_dwordx4 v27, s[24:27], s59 offen offset:1024 nt lds
    v_exp_f32 v99, v91
    v_mfma_f32_16x16x32_bf16 v[104:107], a[132:135], v[148:151], v[104:107]
    v_mul_f32 v88, v96, v128
    v_mul_f32 v89, v97, v129
    v_mfma_f32_16x16x32_bf16 v[104:107], a[136:139], v[152:155], v[104:107]
    v_mul_f32 v90, v98, v130
    v_mul_f32 v91, v99, v131
    v_mfma_f32_16x16x32_bf16 v[104:107], a[140:143], v[156:159], v[104:107]
    v_fma_f32 v112, v116, 2.0, v112
    v_fma_f32 v113, v117, 2.0, v113
    v_fma_f32 v114, v118, 2.0, v114
    v_fma_f32 v115, v119, 2.0, v115
    v_cndmask_b32 v4, 0, v112, s[44:45]
    v_cndmask_b32 v4, v4, v113, s[46:47]
    v_cndmask_b32 v4, v4, v114, s[48:49]
    v_cndmask_b32 v4, v4, v115, s[50:51]
    v_add_f32 v63, v63, v96
    v_fmac_f32 v64, v88, v92
    v_mfma_f32_16x16x4_f32 v[124:127], v4, v60, v[56:59]
    v_add_f32 v63, v63, v97
    v_fmac_f32 v64, v89, v93
    v_add_f32 v63, v63, v98
    v_fmac_f32 v64, v90, v94
    v_add_f32 v63, v63, v99
    v_fmac_f32 v64, v91, v95
    v_add_f32 v68, v68, v88
    v_add_f32 v69, v69, v89
    v_add_f32 v70, v70, v90
    v_add_f32 v71, v71, v91
    v_add_u32 v44, -49152, v44
    v_add_u32 v45, -49152, v45
    v_add_u32 v46, -49152, v46
    v_add_u32 v47, -49152, v47
    v_add_u32 v48, -49152, v48
    v_add_u32 v49, -49152, v49
    v_fma_f32 v132, -v108, v108, v124
    v_fma_f32 v133, -v109, v109, v125
    v_fma_f32 v134, -v110, v110, v126
    v_fma_f32 v135, -v111, v111, v127
    v_max_f32 v132, v132, v56
    v_max_f32 v133, v133, v56
    v_max_f32 v134, v134, v56
    v_max_f32 v135, v135, v56
    v_rsq_f32 v132, v132
    v_rsq_f32 v133, v133
    v_rsq_f32 v134, v134
    v_rsq_f32 v135, v135
    buffer_load_dwordx4 v28, s[24:27], s59 offen offset:2048 nt lds
    v_fma_f32 v104, -v108, v61, v104
    v_fma_f32 v105, -v109, v61, v105
    v_fma_f32 v106, -v110, v61, v106
    v_fma_f32 v107, -v111, v61, v107
    v_fma_f32 v104, v104, v132, v62
    v_fma_f32 v105, v105, v133, v62
    v_fma_f32 v106, v106, v134, v62
    v_fma_f32 v107, v107, v135, v62
    v_max3_f32 v1, v104, v105, v106
    v_max_f32 v1, v1, v107
    v_cmp_lt_f32 vcc, s52, v1
    s_cbranch_vccnz L_site1
L_back1:
    v_exp_f32 v112, v104
    v_exp_f32 v113, v105
    v_exp_f32 v114, v106
    v_exp_f32 v115, v107
    v_cvt_pk_bf16_f32 v72, v88, v89
    v_cvt_pk_bf16_f32 v73, v90, v91
    v_mul_f32 v104, v112, v132
    v_mul_f32 v105, v113, v133
    v_mul_f32 v106, v114, v134
    v_mul_f32 v107, v115, v135
    v_cvt_pk_bf16_f32 v74, v104, v105
    v_cvt_pk_bf16_f32 v75, v106, v107
    ds_write_b128 v237, v[72:75] offset:0
    v_add_f32 v68, v68, v104
    v_add_f32 v69, v69, v105
    v_add_f32 v70, v70, v106
    v_add_f32 v71, v71, v107
    v_cvt_pk_bf16_f32 v66, v68, v69
    v_cvt_pk_bf16_f32 v67, v70, v71
    ds_write_b64 v238, v[66:67]
    buffer_load_dwordx4 v29, s[24:27], s59 offen offset:3072 nt lds
    s_waitcnt vmcnt(20)
    s_waitcnt lgkmcnt(0)
    s_barrier
L_post3:
    ds_read_b32 v9, v254 offset:4096
    ds_read_b64 v[120:121], v254 offset:0
    ds_read_b64 v[122:123], v254 offset:512
    ds_read_b64 v[124:125], v254 offset:1024
    ds_read_b64 v[126:127], v254 offset:1536
    ds_read_b128 v[92:95], v253 offset:0
    ds_read_b128 v[96:99], v253 offset:1024
    ds_read_b128 v[100:103], v253 offset:2048
    ds_read_b128 v[116:119], v253 offset:3072
    ds_read_b128 a[48:51], v34 offset:0
    ds_read_b128 a[52:55], v35 offset:0
    ds_read_b128 a[56:59], v34 offset:128
    ds_read_b128 a[60:63], v35 offset:128
    ds_read_b128 a[64:67], v34 offset:256
    ds_read_b128 a[68:71], v35 offset:256
    s_waitcnt lgkmcnt(14)
    v_cmp_ne_u32 vcc, 0, v9
    s_cbranch_vccnz L_xt3
    s_waitcnt lgkmcnt(12)
    v_mfma_f32_16x16x32_bf16 a[0:3], a[72:75], v[120:123], a[0:3]
    v_add_f32 v63, v63, v112
    v_fma_f32 v64, v104, v108, v64
    v_mfma_f32_16x16x32_bf16 a[4:7], a[80:83], v[120:123], a[4:7]
    v_add_f32 v63, v63, v113
    v_fma_f32 v64, v105, v109, v64
    v_mfma_f32_16x16x32_bf16 a[8:11], a[88:91], v[120:123], a[8:11]
    s_add_u32 m0, s42, 8192
    s_nop 0
    buffer_load_dwordx4 v30, s[24:27], s59 offen offset:0 nt lds
    v_add_f32 v63, v63, v114
    v_fma_f32 v64, v106, v110, v64
    s_waitcnt lgkmcnt(10)
    v_mfma_f32_16x16x32_bf16 a[0:3], a[76:79], v[124:127], a[0:3]
    v_add_f32 v63, v63, v115
    v_fma_f32 v64, v107, v111, v64
    v_mfma_f32_16x16x32_bf16 a[4:7], a[84:87], v[124:127], a[4:7]
    v_mfma_f32_16x16x32_bf16 a[8:11], a[92:95], v[124:127], a[8:11]
    s_waitcnt lgkmcnt(9)
    v_mfma_f32_16x16x32_bf16 a[0:3], a[144:147], v[92:95], a[0:3]
    ds_read_b64_tr_b16 a[72:73], v36 offset:0
    ds_read_b64_tr_b16 a[74:75], v36 offset:6144
    v_mfma_f32_16x16x32_bf16 a[4:7], a[160:163], v[92:95], a[4:7]
    ds_read_b64_tr_b16 a[76:77], v36 offset:12288
    ds_read_b64_tr_b16 a[78:79], v36 offset:18432
    v_mfma_f32_16x16x32_bf16 a[8:11], a[176:179], v[92:95], a[8:11]
    ds_read_b64_tr_b16 a[80:81], v37 offset:0
    ds_read_b64_tr_b16 a[82:83], v37 offset:6144
    s_waitcnt lgkmcnt(14)
    v_mfma_f32_16x16x32_bf16 a[0:3], a[148:151], v[96:99], a[0:3]
    ds_read_b64_tr_b16 a[84:85], v37 offset:12288
    ds_read_b64_tr_b16 a[86:87], v37 offset:18432
    v_mfma_f32_16x16x32_bf16 a[4:7], a[164:167], v[96:99], a[4:7]
    ds_read_b64_tr_b16 a[88:89], v38 offset:0
    ds_read_b64_tr_b16 a[90:91], v38 offset:6144
    v_mfma_f32_16x16x32_bf16 a[8:11], a[180:183], v[96:99], a[8:11]
    ds_read_b64_tr_b16 a[92:93], v38 offset:12288
    ds_read_b64_tr_b16 a[94:95], v38 offset:18432
    s_waitcnt lgkmcnt(15)
    v_mfma_f32_16x16x32_bf16 a[0:3], a[152:155], v[100:103], a[0:3]
    buffer_load_dwordx4 v31, s[24:27], s59 offen offset:1024 nt lds
    v_mfma_f32_16x16x32_bf16 a[4:7], a[168:171], v[100:103], a[4:7]
    v_mfma_f32_16x16x32_bf16 a[8:11], a[184:187], v[100:103], a[8:11]
    v_mfma_f32_16x16x32_bf16 a[0:3], a[156:159], v[116:119], a[0:3]
    v_mfma_f32_16x16x32_bf16 a[4:7], a[172:175], v[116:119], a[4:7]
    v_mfma_f32_16x16x32_bf16 a[8:11], a[188:191], v[116:119], a[8:11]
    v_mfma_f32_16x16x32_bf16 v[84:87], a[48:51], a[48:51], 0
    v_mfma_f32_16x16x32_bf16 v[80:83], a[48:51], v[52:55], 0
    v_mfma_f32_16x16x32_bf16 v[84:87], a[52:55], a[52:55], v[84:87]
    v_mfma_f32_16x16x32_bf16 v[80:83], a[52:55], v[52:55], v[80:83]
    v_mfma_f32_16x16x32_bf16 v[84:87], a[56:59], a[56:59], v[84:87]
    v_mfma_f32_16x16x32_bf16 v[80:83], a[56:59], v[52:55], v[80:83]
    s_waitcnt lgkmcnt(14)
    v_mfma_f32_16x16x32_bf16 v[84:87], a[60:63], a[60:63], v[84:87]
    v_mfma_f32_16x16x32_bf16 v[80:83], a[60:63], v[52:55], v[80:83]
    s_waitcnt lgkmcnt(13)
    v_mfma_f32_16x16x32_bf16 v[84:87], a[64:67], a[64:67], v[84:87]
    buffer_load_dwordx4 v32, s[24:27], s59 offen offset:2048 nt lds
    v_mfma_f32_16x16x32_bf16 v[80:83], a[64:67], v[52:55], v[80:83]
    s_waitcnt lgkmcnt(12)
    v_mfma_f32_16x16x32_bf16 v[84:87], a[68:71], a[68:71], v[84:87]
    v_mfma_f32_16x16x32_bf16 v[80:83], a[68:71], v[52:55], v[80:83]
    s_waitcnt lgkmcnt(0)
    v_mfma_f32_16x16x32_bf16 v[76:79], a[48:51], v[136:139], 0
    v_mfma_f32_16x16x32_bf16 v[76:79], a[52:55], v[140:143], v[76:79]
    v_mfma_f32_16x16x32_bf16 v[76:79], a[56:59], v[144:147], v[76:79]
    v_mfma_f32_16x16x32_bf16 v[76:79], a[60:63], v[148:151], v[76:79]
    v_mfma_f32_16x16x32_bf16 v[76:79], a[64:67], v[152:155], v[76:79]
    v_mfma_f32_16x16x32_bf16 v[76:79], a[68:71], v[156:159], v[76:79]
    v_lshrrev_b32 v1, 3, v0
    v_and_b32 v2, 6, v1
    v_xor_b32 v2, v0, v2
    v_and_b32 v2, 7, v2
    v_mul_u32_u24 v1, 768, v1
    v_lshl_add_u32 v224, v2, 4, v1
    v_xor_b32 v225, 16, v224
    v_add_u32 v225, 5120, v225
    buffer_load_dwordx4 v33, s[24:27], s59 offen offset:3072 nt lds
    s_waitcnt vmcnt(12)
    s_barrier
    ds_read_b128 a[96:99], v40 offset:0
    ds_read_b128 a[100:103], v41 offset:0
    ds_read_b128 a[104:107], v42 offset:0
    ds_read_b128 a[108:111], v43 offset:0
    ds_read_b128 a[112:115], v40 offset:256
    ds_read_b128 a[116:119], v41 offset:256
    ds_read_b128 a[120:123], v42 offset:256
    ds_read_b128 a[124:127], v43 offset:256
    ds_read_b128 a[128:131], v40 offset:512
    ds_read_b128 a[132:135], v41 offset:512
    ds_read_b128 a[136:139], v42 offset:512
    ds_read_b128 a[140:143], v43 offset:512
    s_waitcnt lgkmcnt(11)
    v_mfma_f32_16x16x32_bf16 v[96:99], a[96:99], a[96:99], v[84:87]
    ds_read_b64_tr_b16 a[144:145], v44 offset:0
    ds_read_b64_tr_b16 a[146:147], v45 offset:0
    v_mfma_f32_16x16x32_bf16 v[100:103], a[96:99], a[48:51], 0
    ds_read_b64_tr_b16 a[148:149], v44 offset:12288
    ds_read_b64_tr_b16 a[150:151], v45 offset:12288
    s_waitcnt lgkmcnt(14)
    v_mfma_f32_16x16x32_bf16 v[96:99], a[100:103], a[100:103], v[96:99]
    ds_read_b64_tr_b16 a[152:153], v44 offset:24576
    ds_read_b64_tr_b16 a[154:155], v45 offset:24576
    v_mfma_f32_16x16x32_bf16 v[100:103], a[100:103], a[52:55], v[100:103]
    ds_read_b64_tr_b16 a[156:157], v44 offset:36864
    ds_read_b64_tr_b16 a[158:159], v45 offset:36864
    s_waitcnt lgkmcnt(15)
    v_mfma_f32_16x16x32_bf16 v[96:99], a[104:107], a[104:107], v[96:99]
    ds_read_b64_tr_b16 a[160:161], v46 offset:0
    ds_read_b64_tr_b16 a[162:163], v47 offset:0
    v_mfma_f32_16x16x32_bf16 v[100:103], a[104:107], a[56:59], v[100:103]
    s_add_u32 m0, s40, 0
    s_add_u32 s57, s36, 49152
    buffer_load_dwordx4 v16, s[28:31], s57 offen offset:0 nt lds
    ds_read_b64_tr_b16 a[164:165], v46 offset:12288
    ds_read_b64_tr_b16 a[166:167], v47 offset:12288
    v_mfma_f32_16x16x32_bf16 v[96:99], a[108:111], a[108:111], v[96:99]
    ds_read_b64_tr_b16 a[168:169], v46 offset:24576
    ds_read_b64_tr_b16 a[170:171], v47 offset:24576
    v_mfma_f32_16x16x32_bf16 v[100:103], a[108:111], a[60:63], v[100:103]
    ds_read_b64_tr_b16 a[172:173], v46 offset:36864
    ds_read_b64_tr_b16 a[174:175], v47 offset:36864
    v_mfma_f32_16x16x32_bf16 v[96:99], a[112:115], a[112:115], v[96:99]
    ds_read_b64_tr_b16 a[176:177], v48 offset:0
    ds_read_b64_tr_b16 a[178:179], v49 offset:0
    v_mfma_f32_16x16x32_bf16 v[100:103], a[112:115], a[64:67], v[100:103]
    ds_read_b64_tr_b16 a[180:181], v48 offset:12288
    ds_read_b64_tr_b16 a[182:183], v49 offset:12288
    s_waitcnt lgkmcnt(15)
    v_mfma_f32_16x16x32_bf16 v[96:99], a[116:119], a[116:119], v[96:99]
    ds_read_b64_tr_b16 a[184:185], v48 offset:24576
    ds_read_b64_tr_b16 a[186:187], v49 offset:24576
    v_mfma_f32_16x16x32_bf16 v[100:103], a[116:119], a[68:71], v[100:103]
    ds_read_b64_tr_b16 a[188:189], v48 offset:36864
    ds_read_b64_tr_b16 a[190:191], v49 offset:36864
    v_mfma_f32_16x16x32_bf16 v[92:95], a[96:99], v[52:55], v[80:83]
    v_mfma_f32_16x16x32_bf16 v[92:95], a[100:103], v[52:55], v[92:95]
    v_mfma_f32_16x16x32_bf16 v[92:95], a[104:107], v[52:55], v[92:95]
    v_mfma_f32_16x16x32_bf16 v[92:95], a[108:111], v[52:55], v[92:95]
    s_nop 1
    v_fma_f32 v96, v100, 2.0, v96
    v_fma_f32 v97, v101, 2.0, v97
    v_mfma_f32_16x16x32_bf16 v[92:95], a[112:115], v[52:55], v[92:95]
    buffer_load_dwordx4 v17, s[28:31], s57 offen offset:1024 nt lds
    v_fma_f32 v98, v102, 2.0, v98
    v_fma_f32 v99, v103, 2.0, v99
    v_mfma_f32_16x16x32_bf16 v[92:95], a[116:119], v[52:55], v[92:95]
    v_cndmask_b32 v3, 0, v96, s[44:45]
    v_cndmask_b32 v3, v3, v97, s[46:47]
    v_mfma_f32_16x16x32_bf16 v[88:91], a[96:99], v[136:139], v[76:79]
    v_cndmask_b32 v3, v3, v98, s[48:49]
    v_cndmask_b32 v3, v3, v99, s[50:51]
    v_mfma_f32_16x16x32_bf16 v[88:91], a[100:103], v[140:143], v[88:91]
    s_nop 0
    s_nop 0
    v_mfma_f32_16x16x32_bf16 v[88:91], a[104:107], v[144:147], v[88:91]
    v_mfma_f32_16x16x4_f32 v[120:123], v3, v60, v[56:59]
    v_mfma_f32_16x16x32_bf16 v[88:91], a[108:111], v[148:151], v[88:91]
    v_mfma_f32_16x16x32_bf16 v[88:91], a[112:115], v[152:155], v[88:91]
    v_mfma_f32_16x16x32_bf16 v[88:91], a[116:119], v[156:159], v[88:91]
    v_mfma_f32_16x16x32_bf16 v[112:115], a[120:123], a[120:123], v[84:87]
    v_mfma_f32_16x16x32_bf16 v[116:119], a[120:123], a[48:51], 0
    v_mfma_f32_16x16x32_bf16 v[112:115], a[124:127], a[124:127], v[112:115]
    v_mfma_f32_16x16x32_bf16 v[116:119], a[124:127], a[52:55], v[116:119]
    buffer_load_dwordx4 v18, s[28:31], s57 offen offset:2048 nt lds
    s_nop 1
    v_fma_f32 v128, -v92, v92, v120
    v_fma_f32 v129, -v93, v93, v121
    v_mfma_f32_16x16x32_bf16 v[112:115], a[128:131], a[128:131], v[112:115]
    v_fma_f32 v130, -v94, v94, v122
    v_fma_f32 v131, -v95, v95, v123
    v_mfma_f32_16x16x32_bf16 v[116:119], a[128:131], a[56:59], v[116:119]
    v_max_f32 v128, v128, v56
    v_max_f32 v129, v129, v56
    v_mfma_f32_16x16x32_bf16 v[112:115], a[132:135], a[132:135], v[112:115]
    v_max_f32 v130, v130, v56
    v_max_f32 v131, v131, v56
    v_mfma_f32_16x16x32_bf16 v[116:119], a[132:135], a[60:63], v[116:119]
    v_rsq_f32 v128, v128
    v_mfma_f32_16x16x32_bf16 v[112:115], a[136:139], a[136:139], v[112:115]
    v_rsq_f32 v129, v129
    v_mfma_f32_16x16x32_bf16 v[116:119], a[136:139], a[64:67], v[116:119]
    v_rsq_f32 v130, v130
    v_mfma_f32_16x16x32_bf16 v[112:115], a[140:143], a[140:143], v[112:115]
    v_rsq_f32 v131, v131
    v_mfma_f32_16x16x32_bf16 v[116:119], a[140:143], a[68:71], v[116:119]
    v_fma_f32 v88, -v92, v61, v88
    v_fma_f32 v89, -v93, v61, v89
    v_mfma_f32_16x16x32_bf16 v[108:111], a[120:123], v[52:55], v[80:83]
    v_fma_f32 v90, -v94, v61, v90
    v_fma_f32 v91, -v95, v61, v91
    v_mfma_f32_16x16x32_bf16 v[108:111], a[124:127], v[52:55], v[108:111]
    v_fma_f32 v88, v88, v128, v62
    v_fma_f32 v89, v89, v129, v62
    v_mfma_f32_16x16x32_bf16 v[108:111], a[128:131], v[52:55], v[108:111]
    v_fma_f32 v90, v90, v130, v62
    v_fma_f32 v91, v91, v131, v62
    v_mfma_f32_16x16x32_bf16 v[108:111], a[132:135], v[52:55], v[108:111]
    v_max3_f32 v1, v88, v89, v90
    v_max_f32 v1, v1, v91
    v_mfma_f32_16x16x32_bf16 v[108:111], a[136:139], v[52:55], v[108:111]
    buffer_load_dwordx4 v19, s[28:31], s57 offen offset:3072 nt lds
    v_cmp_lt_f32 vcc, s52, v1
    s_cbranch_vccnz L_site2
L_back2:
    v_mfma_f32_16x16x32_bf16 v[108:111], a[140:143], v[52:55], v[108:111]
    v_exp_f32 v96, v88
    v_mfma_f32_16x16x32_bf16 v[104:107], a[120:123], v[136:139], v[76:79]
    v_exp_f32 v97, v89
    v_mfma_f32_16x16x32_bf16 v[104:107], a[124:127], v[140:143], v[104:107]
    v_exp_f32 v98, v90
    v_mfma_f32_16x16x32_bf16 v[104:107], a[128:131], v[144:147], v[104:107]
    v_exp_f32 v99, v91
    v_mfma_f32_16x16x32_bf16 v[104:107], a[132:135], v[148:151], v[104:107]
    v_mul_f32 v88, v96, v128
    v_mul_f32 v89, v97, v129
    v_mfma_f32_16x16x32_bf16 v[104:107], a[136:139], v[152:155], v[104:107]
    v_mul_f32 v90, v98, v130
    v_mul_f32 v91, v99, v131
    v_mfma_f32_16x16x32_bf16 v[104:107], a[140:143], v[156:159], v[104:107]
    v_fma_f32 v112, v116, 2.0, v112
    v_fma_f32 v113, v117, 2.0, v113
    v_fma_f32 v114, v118, 2.0, v114
    v_fma_f32 v115, v119, 2.0, v115
    v_cndmask_b32 v4, 0, v112, s[44:45]
    v_cndmask_b32 v4, v4, v113, s[46:47]
    v_cndmask_b32 v4, v4, v114, s[48:49]
    v_cndmask_b32 v4, v4, v115, s[50:51]
    v_add_f32 v63, v63, v96
    v_fmac_f32 v64, v88, v92
    v_mfma_f32_16x16x4_f32 v[124:127], v4, v60, v[56:59]
    v_add_f32 v63, v63, v97
    v_fmac_f32 v64, v89, v93
    v_add_f32 v63, v63, v98
    v_fmac_f32 v64, v90, v94
    v_add_f32 v63, v63, v99
    v_fmac_f32 v64, v91, v95
    v_mov_b32 v68, v88
    v_mov_b32 v69, v89
    v_mov_b32 v70, v90
    v_mov_b32 v71, v91
    v_add_u32 v44, 49152, v44
    v_add_u32 v45, 49152, v45
    v_add_u32 v46, 49152, v46
    v_add_u32 v47, 49152, v47
    v_add_u32 v48, 49152, v48
    v_add_u32 v49, 49152, v49
    v_fma_f32 v132, -v108, v108, v124
    v_fma_f32 v133, -v109, v109, v125
    v_fma_f32 v134, -v110, v110, v126
    v_fma_f32 v135, -v111, v111, v127
    v_max_f32 v132, v132, v56
    v_max_f32 v133, v133, v56
    v_max_f32 v134, v134, v56
    v_max_f32 v135, v135, v56
    v_rsq_f32 v132, v132
    v_rsq_f32 v133, v133
    v_rsq_f32 v134, v134
    v_rsq_f32 v135, v135
    s_add_u32 m0, s40, 4096
    s_nop 0
    buffer_load_dwordx4 v20, s[28:31], s57 offen offset:0 nt lds
    v_fma_f32 v104, -v108, v61, v104
    v_fma_f32 v105, -v109, v61, v105
    v_fma_f32 v106, -v110, v61, v106
    v_fma_f32 v107, -v111, v61, v107
    v_fma_f32 v104, v104, v132, v62
    v_fma_f32 v105, v105, v133, v62
    v_fma_f32 v106, v106, v134, v62
    v_fma_f32 v107, v107, v135, v62
    v_max3_f32 v1, v104, v105, v106
    v_max_f32 v1, v1, v107
    v_cmp_lt_f32 vcc, s52, v1
    s_cbranch_vccnz L_site3
L_back3:
    v_exp_f32 v112, v104
    v_exp_f32 v113, v105
    v_exp_f32 v114, v106
    v_exp_f32 v115, v107
    v_cvt_pk_bf16_f32 v72, v88, v89
    v_cvt_pk_bf16_f32 v73, v90, v91
    v_mul_f32 v104, v112, v132
    v_mul_f32 v105, v113, v133
    v_mul_f32 v106, v114, v134
    v_mul_f32 v107, v115, v135
    v_cvt_pk_bf16_f32 v74, v104, v105
    v_cvt_pk_bf16_f32 v75, v106, v107
    ds_write_b128 v237, v[72:75] offset:0
    s_waitcnt lgkmcnt(0)
    s_barrier
L_post24:
    ds_read_b32 v9, v254 offset:4096
    ds_read_b128 v[92:95], v253 offset:0
    ds_read_b128 v[96:99], v253 offset:1024
    ds_read_b128 v[100:103], v253 offset:2048
    ds_read_b128 v[116:119], v253 offset:3072
    s_waitcnt lgkmcnt(4)
    v_cmp_ne_u32 vcc, 0, v9
    s_cbranch_vccnz L_xt24
    s_waitcnt lgkmcnt(3)
    v_mfma_f32_16x16x32_bf16 a[0:3], a[144:147], v[92:95], a[0:3]
    buffer_load_dwordx4 v21, s[28:31], s57 offen offset:1024 nt lds
    v_add_f32 v68, v68, v104
    v_add_f32 v69, v69, v105
    v_mfma_f32_16x16x32_bf16 a[4:7], a[160:163], v[92:95], a[4:7]
    buffer_load_dword v244, v245, s[32:35], 0 offen offset:128 sc1
    v_add_f32 v70, v70, v106
    v_add_f32 v71, v71, v107
    v_mfma_f32_16x16x32_bf16 a[8:11], a[176:179], v[92:95], a[8:11]
    v_add_f32 v63, v63, v112
    v_fma_f32 v64, v104, v108, v64
    s_waitcnt lgkmcnt(2)
    v_mfma_f32_16x16x32_bf16 a[0:3], a[148:151], v[96:99], a[0:3]
    v_add_f32 v63, v63, v113
    v_fma_f32 v64, v105, v109, v64
    v_mfma_f32_16x16x32_bf16 a[4:7], a[164:167], v[96:99], a[4:7]
    v_add_f32 v63, v63, v114
    v_fma_f32 v64, v106, v110, v64
    v_mfma_f32_16x16x32_bf16 a[8:11], a[180:183], v[96:99], a[8:11]
    v_add_f32 v63, v63, v115
    v_fma_f32 v64, v107, v111, v64
    s_waitcnt lgkmcnt(1)
    v_mfma_f32_16x16x32_bf16 a[0:3], a[152:155], v[100:103], a[0:3]
    v_mfma_f32_16x16x32_bf16 a[4:7], a[168:171], v[100:103], a[4:7]
    s_add_u32 m0, s41, 0
    s_add_u32 s58, s37, 98304
    buffer_load_dwordx4 v22, s[24:27], s58 offen offset:0 nt lds
    v_mfma_f32_16x16x32_bf16 a[8:11], a[184:187], v[100:103], a[8:11]
    s_waitcnt lgkmcnt(0)
    v_mfma_f32_16x16x32_bf16 a[0:3], a[156:159], v[116:119], a[0:3]
    v_mfma_f32_16x16x32_bf16 a[4:7], a[172:175], v[116:119], a[4:7]
    v_mfma_f32_16x16x32_bf16 a[8:11], a[188:191], v[116:119], a[8:11]
    buffer_load_dwordx4 v23, s[24:27], s58 offen offset:1024 nt lds
    buffer_load_dwordx4 v24, s[24:27], s58 offen offset:2048 nt lds
    buffer_load_dwordx4 v25, s[24:27], s58 offen offset:3072 nt lds
    s_add_u32 m0, s41, 4096
    s_nop 0
    buffer_load_dwordx4 v26, s[24:27], s58 offen offset:0 nt lds
    s_waitcnt vmcnt(12)
    s_barrier
    ds_read_b128 a[96:99], v40 offset:49152
    ds_read_b128 a[100:103], v41 offset:49152
    ds_read_b128 a[104:107], v42 offset:49152
    ds_read_b128 a[108:111], v43 offset:49152
    ds_read_b128 a[112:115], v40 offset:49408
    ds_read_b128 a[116:119], v41 offset:49408
    ds_read_b128 a[120:123], v42 offset:49408
    ds_read_b128 a[124:127], v43 offset:49408
    ds_read_b128 a[128:131], v40 offset:49664
    ds_read_b128 a[132:135], v41 offset:49664
    ds_read_b128 a[136:139], v42 offset:49664
    ds_read_b128 a[140:143], v43 offset:49664
    s_waitcnt lgkmcnt(11)
    v_mfma_f32_16x16x32_bf16 v[96:99], a[96:99], a[96:99], v[84:87]
    ds_read_b64_tr_b16 a[144:145], v44 offset:0
    ds_read_b64_tr_b16 a[146:147], v45 offset:0
    v_mfma_f32_16x16x32_bf16 v[100:103], a[96:99], a[48:51], 0
    ds_read_b64_tr_b16 a[148:149], v44 offset:12288
    ds_read_b64_tr_b16 a[150:151], v45 offset:12288
    s_waitcnt lgkmcnt(14)
    v_mfma_f32_16x16x32_bf16 v[96:99], a[100:103], a[100:103], v[96:99]
    ds_read_b64_tr_b16 a[152:153], v44 offset:24576
    ds_read_b64_tr_b16 a[154:155], v45 offset:24576
    v_mfma_f32_16x16x32_bf16 v[100:103], a[100:103], a[52:55], v[100:103]
    ds_read_b64_tr_b16 a[156:157], v44 offset:36864
    ds_read_b64_tr_b16 a[158:159], v45 offset:36864
    s_waitcnt lgkmcnt(15)
    v_mfma_f32_16x16x32_bf16 v[96:99], a[104:107], a[104:107], v[96:99]
    ds_read_b64_tr_b16 a[160:161], v46 offset:0
    ds_read_b64_tr_b16 a[162:163], v47 offset:0
    v_mfma_f32_16x16x32_bf16 v[100:103], a[104:107], a[56:59], v[100:103]
    ds_read_b64_tr_b16 a[164:165], v46 offset:12288
    ds_read_b64_tr_b16 a[166:167], v47 offset:12288
    v_mfma_f32_16x16x32_bf16 v[96:99], a[108:111], a[108:111], v[96:99]
    buffer_load_dwordx4 v27, s[24:27], s58 offen offset:1024 nt lds
    ds_read_b64_tr_b16 a[168:169], v46 offset:24576
    ds_read_b64_tr_b16 a[170:171], v47 offset:24576
    v_mfma_f32_16x16x32_bf16 v[100:103], a[108:111], a[60:63], v[100:103]
    ds_read_b64_tr_b16 a[172:173], v46 offset:36864
    ds_read_b64_tr_b16 a[174:175], v47 offset:36864
    v_mfma_f32_16x16x32_bf16 v[96:99], a[112:115], a[112:115], v[96:99]
    ds_read_b64_tr_b16 a[176:177], v48 offset:0
    ds_read_b64_tr_b16 a[178:179], v49 offset:0
    v_mfma_f32_16x16x32_bf16 v[100:103], a[112:115], a[64:67], v[100:103]
    ds_read_b64_tr_b16 a[180:181], v48 offset:12288
    ds_read_b64_tr_b16 a[182:183], v49 offset:12288
    s_waitcnt lgkmcnt(15)
    v_mfma_f32_16x16x32_bf16 v[96:99], a[116:119], a[116:119], v[96:99]
    ds_read_b64_tr_b16 a[184:185], v48 offset:24576
    ds_read_b64_tr_b16 a[186:187], v49 offset:24576
    v_mfma_f32_16x16x32_bf16 v[100:103], a[116:119], a[68:71], v[100:103]
    ds_read_b64_tr_b16 a[188:189], v48 offset:36864
    ds_read_b64_tr_b16 a[190:191], v49 offset:36864
    v_mfma_f32_16x16x32_bf16 v[92:95], a[96:99], v[52:55], v[80:83]
    v_mfma_f32_16x16x32_bf16 v[92:95], a[100:103], v[52:55], v[92:95]
    v_mfma_f32_16x16x32_bf16 v[92:95], a[104:107], v[52:55], v[92:95]
    v_mfma_f32_16x16x32_bf16 v[92:95], a[108:111], v[52:55], v[92:95]
    s_nop 1
    v_fma_f32 v96, v100, 2.0, v96
    v_fma_f32 v97, v101, 2.0, v97
    v_mfma_f32_16x16x32_bf16 v[92:95], a[112:115], v[52:55], v[92:95]
    v_fma_f32 v98, v102, 2.0, v98
    v_fma_f32 v99, v103, 2.0, v99
    v_mfma_f32_16x16x32_bf16 v[92:95], a[116:119], v[52:55], v[92:95]
    v_cndmask_b32 v3, 0, v96, s[44:45]
    v_cndmask_b32 v3, v3, v97, s[46:47]
    v_mfma_f32_16x16x32_bf16 v[88:91], a[96:99], v[136:139], v[76:79]
    buffer_load_dwordx4 v28, s[24:27], s58 offen offset:2048 nt lds
    v_cndmask_b32 v3, v3, v98, s[48:49]
    v_cndmask_b32 v3, v3, v99, s[50:51]
    v_mfma_f32_16x16x32_bf16 v[88:91], a[100:103], v[140:143], v[88:91]
    s_nop 0
    s_nop 0
    v_mfma_f32_16x16x32_bf16 v[88:91], a[104:107], v[144:147], v[88:91]
    v_mfma_f32_16x16x4_f32 v[120:123], v3, v60, v[56:59]
    v_mfma_f32_16x16x32_bf16 v[88:91], a[108:111], v[148:151], v[88:91]
    v_mfma_f32_16x16x32_bf16 v[88:91], a[112:115], v[152:155], v[88:91]
    v_mfma_f32_16x16x32_bf16 v[88:91], a[116:119], v[156:159], v[88:91]
    v_mfma_f32_16x16x32_bf16 v[112:115], a[120:123], a[120:123], v[84:87]
    v_mfma_f32_16x16x32_bf16 v[116:119], a[120:123], a[48:51], 0
    v_mfma_f32_16x16x32_bf16 v[112:115], a[124:127], a[124:127], v[112:115]
    v_mfma_f32_16x16x32_bf16 v[116:119], a[124:127], a[52:55], v[116:119]
    s_nop 2
    v_fma_f32 v128, -v92, v92, v120
    v_fma_f32 v129, -v93, v93, v121
    v_mfma_f32_16x16x32_bf16 v[112:115], a[128:131], a[128:131], v[112:115]
    v_fma_f32 v130, -v94, v94, v122
    v_fma_f32 v131, -v95, v95, v123
    v_mfma_f32_16x16x32_bf16 v[116:119], a[128:131], a[56:59], v[116:119]
    buffer_load_dwordx4 v29, s[24:27], s58 offen offset:3072 nt lds
    v_max_f32 v128, v128, v56
    v_max_f32 v129, v129, v56
    v_mfma_f32_16x16x32_bf16 v[112:115], a[132:135], a[132:135], v[112:115]
    v_max_f32 v130, v130, v56
    v_max_f32 v131, v131, v56
    v_mfma_f32_16x16x32_bf16 v[116:119], a[132:135], a[60:63], v[116:119]
    v_rsq_f32 v128, v128
    v_mfma_f32_16x16x32_bf16 v[112:115], a[136:139], a[136:139], v[112:115]
    v_rsq_f32 v129, v129
    v_mfma_f32_16x16x32_bf16 v[116:119], a[136:139], a[64:67], v[116:119]
    v_rsq_f32 v130, v130
    v_mfma_f32_16x16x32_bf16 v[112:115], a[140:143], a[140:143], v[112:115]
    v_rsq_f32 v131, v131
    v_mfma_f32_16x16x32_bf16 v[116:119], a[140:143], a[68:71], v[116:119]
    v_fma_f32 v88, -v92, v61, v88
    v_fma_f32 v89, -v93, v61, v89
    v_mfma_f32_16x16x32_bf16 v[108:111], a[120:123], v[52:55], v[80:83]
    v_fma_f32 v90, -v94, v61, v90
    v_fma_f32 v91, -v95, v61, v91
    v_mfma_f32_16x16x32_bf16 v[108:111], a[124:127], v[52:55], v[108:111]
    v_fma_f32 v88, v88, v128, v62
    v_fma_f32 v89, v89, v129, v62
    v_mfma_f32_16x16x32_bf16 v[108:111], a[128:131], v[52:55], v[108:111]
    v_fma_f32 v90, v90, v130, v62
    v_fma_f32 v91, v91, v131, v62
    v_mfma_f32_16x16x32_bf16 v[108:111], a[132:135], v[52:55], v[108:111]
    v_max3_f32 v1, v88, v89, v90
    v_max_f32 v1, v1, v91
    v_mfma_f32_16x16x32_bf16 v[108:111], a[136:139], v[52:55], v[108:111]
    v_cmp_lt_f32 vcc, s52, v1
    s_cbranch_vccnz L_site4
L_back4:
    v_mfma_f32_16x16x32_bf16 v[108:111], a[140:143], v[52:55], v[108:111]
    v_exp_f32 v96, v88
    v_mfma_f32_16x16x32_bf16 v[104:107], a[120:123], v[136:139], v[76:79]
    s_add_u32 m0, s41, 8192
    s_nop 0
    buffer_load_dwordx4 v30, s[24:27], s58 offen offset:0 nt lds
    v_exp_f32 v97, v89
    v_mfma_f32_16x16x32_bf16 v[104:107], a[124:127], v[140:143], v[104:107]
    v_exp_f32 v98, v90
    v_mfma_f32_16x16x32_bf16 v[104:107], a[128:131], v[144:147], v[104:107]
    v_exp_f32 v99, v91
    v_mfma_f32_16x16x32_bf16 v[104:107], a[132:135], v[148:151], v[104:107]
    v_mul_f32 v88, v96, v128
    v_mul_f32 v89, v97, v129
    v_mfma_f32_16x16x32_bf16 v[104:107], a[136:139], v[152:155], v[104:107]
    v_mul_f32 v90, v98, v130
    v_mul_f32 v91, v99, v131
    v_mfma_f32_16x16x32_bf16 v[104:107], a[140:143], v[156:159], v[104:107]
    v_fma_f32 v112, v116, 2.0, v112
    v_fma_f32 v113, v117, 2.0, v113
    v_fma_f32 v114, v118, 2.0, v114
    v_fma_f32 v115, v119, 2.0, v115
    v_cndmask_b32 v4, 0, v112, s[44:45]
    v_cndmask_b32 v4, v4, v113, s[46:47]
    v_cndmask_b32 v4, v4, v114, s[48:49]
    v_cndmask_b32 v4, v4, v115, s[50:51]
    v_add_f32 v63, v63, v96
    v_fmac_f32 v64, v88, v92
    v_mfma_f32_16x16x4_f32 v[124:127], v4, v60, v[56:59]
    v_add_f32 v63, v63, v97
    v_fmac_f32 v64, v89, v93
    v_add_f32 v63, v63, v98
    v_fmac_f32 v64, v90, v94
    v_add_f32 v63, v63, v99
    v_fmac_f32 v64, v91, v95
    v_add_f32 v68, v68, v88
    v_add_f32 v69, v69, v89
    v_add_f32 v70, v70, v90
    v_add_f32 v71, v71, v91
    v_add_u32 v44, -49152, v44
    v_add_u32 v45, -49152, v45
    v_add_u32 v46, -49152, v46
    v_add_u32 v47, -49152, v47
    v_add_u32 v48, -49152, v48
    v_add_u32 v49, -49152, v49
    v_fma_f32 v132, -v108, v108, v124
    v_fma_f32 v133, -v109, v109, v125
    v_fma_f32 v134, -v110, v110, v126
    v_fma_f32 v135, -v111, v111, v127
    v_max_f32 v132, v132, v56
    v_max_f32 v133, v133, v56
    v_max_f32 v134, v134, v56
    v_max_f32 v135, v135, v56
    v_rsq_f32 v132, v132
    v_rsq_f32 v133, v133
    v_rsq_f32 v134, v134
    v_rsq_f32 v135, v135
    buffer_load_dwordx4 v31, s[24:27], s58 offen offset:1024 nt lds
    v_fma_f32 v104, -v108, v61, v104
    v_fma_f32 v105, -v109, v61, v105
    v_fma_f32 v106, -v110, v61, v106
    v_fma_f32 v107, -v111, v61, v107
    v_fma_f32 v104, v104, v132, v62
    v_fma_f32 v105, v105, v133, v62
    v_fma_f32 v106, v106, v134, v62
    v_fma_f32 v107, v107, v135, v62
    v_max3_f32 v1, v104, v105, v106
    v_max_f32 v1, v1, v107
    v_cmp_lt_f32 vcc, s52, v1
    s_cbranch_vccnz L_site5
L_back5:
    v_exp_f32 v112, v104
    v_exp_f32 v113, v105
    v_exp_f32 v114, v106
    v_exp_f32 v115, v107
    v_cvt_pk_bf16_f32 v72, v88, v89
    v_cvt_pk_bf16_f32 v73, v90, v91
    v_mul_f32 v104, v112, v132
    v_mul_f32 v105, v113, v133
    v_mul_f32 v106, v114, v134
    v_mul_f32 v107, v115, v135
    v_cvt_pk_bf16_f32 v74, v104, v105
    v_cvt_pk_bf16_f32 v75, v106, v107
    ds_write_b128 v237, v[72:75] offset:0
    v_add_f32 v68, v68, v104
    v_add_f32 v69, v69, v105
    v_add_f32 v70, v70, v106
    v_add_f32 v71, v71, v107
    v_cvt_pk_bf16_f32 v66, v68, v69
    v_cvt_pk_bf16_f32 v67, v70, v71
    ds_write_b64 v238, v[66:67]
    buffer_load_dwordx4 v32, s[24:27], s58 offen offset:2048 nt lds
    buffer_load_dwordx4 v33, s[24:27], s58 offen offset:3072 nt lds
    s_waitcnt vmcnt(13)
    s_waitcnt vmcnt(12)
    v_cmp_ne_u32 vcc, s39, v244
    s_cbranch_vccnz L_fl_retry
L_fl_ok:
    s_waitcnt lgkmcnt(0)
    s_barrier
L_post6:
    ds_read_b32 v9, v254 offset:4096
    ds_read_b64 v[120:121], v254 offset:0
    ds_read_b64 v[122:123], v254 offset:512
    ds_read_b64 v[124:125], v254 offset:1024
    ds_read_b64 v[126:127], v254 offset:1536
    ds_read_b128 v[92:95], v253 offset:0
    ds_read_b128 v[96:99], v253 offset:1024
    ds_read_b128 v[100:103], v253 offset:2048
    ds_read_b128 v[116:119], v253 offset:3072
    ds_read_b128 a[48:51], v34 offset:0
    ds_read_b128 a[52:55], v35 offset:0
    ds_read_b128 a[56:59], v34 offset:128
    ds_read_b128 a[60:63], v35 offset:128
    ds_read_b128 a[64:67], v34 offset:256
    ds_read_b128 a[68:71], v35 offset:256
    s_waitcnt lgkmcnt(14)
    v_cmp_ne_u32 vcc, 0, v9
    s_cbranch_vccnz L_xt6
    s_waitcnt lgkmcnt(12)
    v_mfma_f32_16x16x32_bf16 a[0:3], a[72:75], v[120:123], a[0:3]
    s_add_u32 m0, s42, 0
    s_add_u32 s59, s37, 294912
    buffer_load_dwordx4 v22, s[24:27], s59 offen offset:0 nt lds
    v_add_f32 v63, v63, v112
    v_fma_f32 v64, v104, v108, v64
    v_mfma_f32_16x16x32_bf16 a[4:7], a[80:83], v[120:123], a[4:7]
    v_add_f32 v63, v63, v113
    v_fma_f32 v64, v105, v109, v64
    v_mfma_f32_16x16x32_bf16 a[8:11], a[88:91], v[120:123], a[8:11]
    v_add_f32 v63, v63, v114
    v_fma_f32 v64, v106, v110, v64
    s_waitcnt lgkmcnt(10)
    v_mfma_f32_16x16x32_bf16 a[0:3], a[76:79], v[124:127], a[0:3]
    v_add_f32 v63, v63, v115
    v_fma_f32 v64, v107, v111, v64
    v_mfma_f32_16x16x32_bf16 a[4:7], a[84:87], v[124:127], a[4:7]
    v_mfma_f32_16x16x32_bf16 a[8:11], a[92:95], v[124:127], a[8:11]
    s_waitcnt lgkmcnt(9)
    v_mfma_f32_16x16x32_bf16 a[0:3], a[144:147], v[92:95], a[0:3]
    ds_read_b64_tr_b16 a[72:73], v36 offset:0
    ds_read_b64_tr_b16 a[74:75], v36 offset:6144
    v_mfma_f32_16x16x32_bf16 a[4:7], a[160:163], v[92:95], a[4:7]
    ds_read_b64_tr_b16 a[76:77], v36 offset:12288
    ds_read_b64_tr_b16 a[78:79], v36 offset:18432
    v_mfma_f32_16x16x32_bf16 a[8:11], a[176:179], v[92:95], a[8:11]
    ds_read_b64_tr_b16 a[80:81], v37 offset:0
    ds_read_b64_tr_b16 a[82:83], v37 offset:6144
    s_waitcnt lgkmcnt(14)
    v_mfma_f32_16x16x32_bf16 a[0:3], a[148:151], v[96:99], a[0:3]
    buffer_load_dwordx4 v23, s[24:27], s59 offen offset:1024 nt lds
    ds_read_b64_tr_b16 a[84:85], v37 offset:12288
    ds_read_b64_tr_b16 a[86:87], v37 offset:18432
    v_mfma_f32_16x16x32_bf16 a[4:7], a[164:167], v[96:99], a[4:7]
    ds_read_b64_tr_b16 a[88:89], v38 offset:0
    ds_read_b64_tr_b16 a[90:91], v38 offset:6144
    v_mfma_f32_16x16x32_bf16 a[8:11], a[180:183], v[96:99], a[8:11]
    ds_read_b64_tr_b16 a[92:93], v38 offset:12288
    ds_read_b64_tr_b16 a[94:95], v38 offset:18432
    s_waitcnt lgkmcnt(15)
    v_mfma_f32_16x16x32_bf16 a[0:3], a[152:155], v[100:103], a[0:3]
    v_mfma_f32_16x16x32_bf16 a[4:7], a[168:171], v[100:103], a[4:7]
    v_mfma_f32_16x16x32_bf16 a[8:11], a[184:187], v[100:103], a[8:11]
    v_mfma_f32_16x16x32_bf16 a[0:3], a[156:159], v[116:119], a[0:3]
    v_mfma_f32_16x16x32_bf16 a[4:7], a[172:175], v[116:119], a[4:7]
    v_mfma_f32_16x16x32_bf16 a[8:11], a[188:191], v[116:119], a[8:11]
    v_mfma_f32_16x16x32_bf16 v[84:87], a[48:51], a[48:51], 0
    v_mfma_f32_16x16x32_bf16 v[80:83], a[48:51], v[52:55], 0
    v_mfma_f32_16x16x32_bf16 v[84:87], a[52:55], a[52:55], v[84:87]
    v_mfma_f32_16x16x32_bf16 v[80:83], a[52:55], v[52:55], v[80:83]
    v_mfma_f32_16x16x32_bf16 v[84:87], a[56:59], a[56:59], v[84:87]
    s_add_u32 s61, s60, 3145728
    buffer_load_dwordx4 v[160:163], v65, s[72:75], s61 offen offset:0 sc1
    v_mfma_f32_16x16x32_bf16 v[80:83], a[56:59], v[52:55], v[80:83]
    s_waitcnt lgkmcnt(14)
    v_mfma_f32_16x16x32_bf16 v[84:87], a[60:63], a[60:63], v[84:87]
    v_mfma_f32_16x16x32_bf16 v[80:83], a[60:63], v[52:55], v[80:83]
    s_waitcnt lgkmcnt(13)
    v_mfma_f32_16x16x32_bf16 v[84:87], a[64:67], a[64:67], v[84:87]
    v_mfma_f32_16x16x32_bf16 v[80:83], a[64:67], v[52:55], v[80:83]
    s_waitcnt lgkmcnt(12)
    v_mfma_f32_16x16x32_bf16 v[84:87], a[68:71], a[68:71], v[84:87]
    v_mfma_f32_16x16x32_bf16 v[80:83], a[68:71], v[52:55], v[80:83]
    s_waitcnt lgkmcnt(0)
    v_mfma_f32_16x16x32_bf16 v[76:79], a[48:51], v[136:139], 0
    v_mfma_f32_16x16x32_bf16 v[76:79], a[52:55], v[140:143], v[76:79]
    v_mfma_f32_16x16x32_bf16 v[76:79], a[56:59], v[144:147], v[76:79]
    v_mfma_f32_16x16x32_bf16 v[76:79], a[60:63], v[148:151], v[76:79]
    v_mfma_f32_16x16x32_bf16 v[76:79], a[64:67], v[152:155], v[76:79]
    v_mfma_f32_16x16x32_bf16 v[76:79], a[68:71], v[156:159], v[76:79]
    buffer_load_dwordx4 v24, s[24:27], s59 offen offset:2048 nt lds
    buffer_load_dwordx4 v25, s[24:27], s59 offen offset:3072 nt lds
    s_add_u32 m0, s42, 4096
    s_nop 0
    buffer_load_dwordx4 v26, s[24:27], s59 offen offset:0 nt lds
    buffer_load_dwordx4 v27, s[24:27], s59 offen offset:1024 nt lds
    buffer_load_dwordx4 v[164:167], v65, s[72:75], s61 offen offset:1024 sc1
    buffer_load_dwordx4 v28, s[24:27], s59 offen offset:2048 nt lds
    buffer_load_dwordx4 v29, s[24:27], s59 offen offset:3072 nt lds
    s_add_u32 m0, s42, 8192
    s_nop 0
    buffer_load_dwordx4 v30, s[24:27], s59 offen offset:0 nt lds
    buffer_load_dwordx4 v31, s[24:27], s59 offen offset:1024 nt lds
    s_waitcnt vmcnt(12)
    s_barrier
    ds_read_b128 a[96:99], v40 offset:0
    ds_read_b128 a[100:103], v41 offset:0
    ds_read_b128 a[104:107], v42 offset:0
    ds_read_b128 a[108:111], v43 offset:0
    ds_read_b128 a[112:115], v40 offset:256
    ds_read_b128 a[116:119], v41 offset:256
    ds_read_b128 a[120:123], v42 offset:256
    ds_read_b128 a[124:127], v43 offset:256
    ds_read_b128 a[128:131], v40 offset:512
    ds_read_b128 a[132:135], v41 offset:512
    ds_read_b128 a[136:139], v42 offset:512
    ds_read_b128 a[140:143], v43 offset:512
    s_waitcnt lgkmcnt(11)
    v_mfma_f32_16x16x32_bf16 v[96:99], a[96:99], a[96:99], v[84:87]
    ds_read_b64_tr_b16 a[144:145], v44 offset:0
    ds_read_b64_tr_b16 a[146:147], v45 offset:0
    v_mfma_f32_16x16x32_bf16 v[100:103], a[96:99], a[48:51], 0
    ds_read_b64_tr_b16 a[148:149], v44 offset:12288
    ds_read_b64_tr_b16 a[150:151], v45 offset:12288
    s_waitcnt lgkmcnt(14)
    v_mfma_f32_16x16x32_bf16 v[96:99], a[100:103], a[100:103], v[96:99]
    ds_read_b64_tr_b16 a[152:153], v44 offset:24576
    ds_read_b64_tr_b16 a[154:155], v45 offset:24576
    v_mfma_f32_16x16x32_bf16 v[100:103], a[100:103], a[52:55], v[100:103]
    ds_read_b64_tr_b16 a[156:157], v44 offset:36864
    ds_read_b64_tr_b16 a[158:159], v45 offset:36864
    s_waitcnt lgkmcnt(15)
    v_mfma_f32_16x16x32_bf16 v[96:99], a[104:107], a[104:107], v[96:99]
    ds_read_b64_tr_b16 a[160:161], v46 offset:0
    ds_read_b64_tr_b16 a[162:163], v47 offset:0
    v_mfma_f32_16x16x32_bf16 v[100:103], a[104:107], a[56:59], v[100:103]
    ds_read_b64_tr_b16 a[164:165], v46 offset:12288
    ds_read_b64_tr_b16 a[166:167], v47 offset:12288
    v_mfma_f32_16x16x32_bf16 v[96:99], a[108:111], a[108:111], v[96:99]
    buffer_load_dwordx4 v[168:171], v65, s[72:75], s61 offen offset:2048 sc1
    ds_read_b64_tr_b16 a[168:169], v46 offset:24576
    ds_read_b64_tr_b16 a[170:171], v47 offset:24576
    v_mfma_f32_16x16x32_bf16 v[100:103], a[108:111], a[60:63], v[100:103]
    ds_read_b64_tr_b16 a[172:173], v46 offset:36864
    ds_read_b64_tr_b16 a[174:175], v47 offset:36864
    v_mfma_f32_16x16x32_bf16 v[96:99], a[112:115], a[112:115], v[96:99]
    ds_read_b64_tr_b16 a[176:177], v48 offset:0
    ds_read_b64_tr_b16 a[178:179], v49 offset:0
    v_mfma_f32_16x16x32_bf16 v[100:103], a[112:115], a[64:67], v[100:103]
    ds_read_b64_tr_b16 a[180:181], v48 offset:12288
    ds_read_b64_tr_b16 a[182:183], v49 offset:12288
    s_waitcnt lgkmcnt(15)
    v_mfma_f32_16x16x32_bf16 v[96:99], a[116:119], a[116:119], v[96:99]
    ds_read_b64_tr_b16 a[184:185], v48 offset:24576
    ds_read_b64_tr_b16 a[186:187], v49 offset:24576
    v_mfma_f32_16x16x32_bf16 v[100:103], a[116:119], a[68:71], v[100:103]
    ds_read_b64_tr_b16 a[188:189], v48 offset:36864
    ds_read_b64_tr_b16 a[190:191], v49 offset:36864
    v_mfma_f32_16x16x32_bf16 v[92:95], a[96:99], v[52:55], v[80:83]
    v_mfma_f32_16x16x32_bf16 v[92:95], a[100:103], v[52:55], v[92:95]
    v_mfma_f32_16x16x32_bf16 v[92:95], a[104:107], v[52:55], v[92:95]
    v_mfma_f32_16x16x32_bf16 v[92:95], a[108:111], v[52:55], v[92:95]
    s_nop 1
    v_fma_f32 v96, v100, 2.0, v96
    v_fma_f32 v97, v101, 2.0, v97
    v_mfma_f32_16x16x32_bf16 v[92:95], a[112:115], v[52:55], v[92:95]
    v_fma_f32 v98, v102, 2.0, v98
    v_fma_f32 v99, v103, 2.0, v99
    v_mfma_f32_16x16x32_bf16 v[92:95], a[116:119], v[52:55], v[92:95]
    v_cndmask_b32 v3, 0, v96, s[44:45]
    v_cndmask_b32 v3, v3, v97, s[46:47]
    v_mfma_f32_16x16x32_bf16 v[88:91], a[96:99], v[136:139], v[76:79]
    buffer_load_dwordx4 v32, s[24:27], s59 offen offset:2048 nt lds
    v_cndmask_b32 v3, v3, v98, s[48:49]
    v_cndmask_b32 v3, v3, v99, s[50:51]
    v_mfma_f32_16x16x32_bf16 v[88:91], a[100:103], v[140:143], v[88:91]
    buffer_load_dwordx4 v33, s[24:27], s59 offen offset:3072 nt lds
    s_nop 0
    s_nop 0
    v_mfma_f32_16x16x32_bf16 v[88:91], a[104:107], v[144:147], v[88:91]
    v_mfma_f32_16x16x4_f32 v[120:123], v3, v60, v[56:59]
    v_mfma_f32_16x16x32_bf16 v[88:91], a[108:111], v[148:151], v[88:91]
    v_mfma_f32_16x16x32_bf16 v[88:91], a[112:115], v[152:155], v[88:91]
    v_mfma_f32_16x16x32_bf16 v[88:91], a[116:119], v[156:159], v[88:91]
    v_mfma_f32_16x16x32_bf16 v[112:115], a[120:123], a[120:123], v[84:87]
    v_mfma_f32_16x16x32_bf16 v[116:119], a[120:123], a[48:51], 0
    v_mfma_f32_16x16x32_bf16 v[112:115], a[124:127], a[124:127], v[112:115]
    v_mfma_f32_16x16x32_bf16 v[116:119], a[124:127], a[52:55], v[116:119]
    s_nop 2
    v_fma_f32 v128, -v92, v92, v120
    v_fma_f32 v129, -v93, v93, v121
    v_mfma_f32_16x16x32_bf16 v[112:115], a[128:131], a[128:131], v[112:115]
    s_add_u32 m0, s40, 0
    s_add_u32 s57, s36, 73728
    buffer_load_dwordx4 v16, s[28:31], s57 offen offset:0 nt lds
    v_fma_f32 v130, -v94, v94, v122
    v_fma_f32 v131, -v95, v95, v123
    v_mfma_f32_16x16x32_bf16 v[116:119], a[128:131], a[56:59], v[116:119]
    v_max_f32 v128, v128, v56
    v_max_f32 v129, v129, v56
    v_mfma_f32_16x16x32_bf16 v[112:115], a[132:135], a[132:135], v[112:115]
    v_max_f32 v130, v130, v56
    v_max_f32 v131, v131, v56
    v_mfma_f32_16x16x32_bf16 v[116:119], a[132:135], a[60:63], v[116:119]
    v_rsq_f32 v128, v128
    v_mfma_f32_16x16x32_bf16 v[112:115], a[136:139], a[136:139], v[112:115]
    v_rsq_f32 v129, v129
    v_mfma_f32_16x16x32_bf16 v[116:119], a[136:139], a[64:67], v[116:119]
    v_rsq_f32 v130, v130
    v_mfma_f32_16x16x32_bf16 v[112:115], a[140:143], a[140:143], v[112:115]
    v_rsq_f32 v131, v131
    v_mfma_f32_16x16x32_bf16 v[116:119], a[140:143], a[68:71], v[116:119]
    v_fma_f32 v88, -v92, v61, v88
    v_fma_f32 v89, -v93, v61, v89
    v_mfma_f32_16x16x32_bf16 v[108:111], a[120:123], v[52:55], v[80:83]
    v_fma_f32 v90, -v94, v61, v90
    v_fma_f32 v91, -v95, v61, v91
    v_mfma_f32_16x16x32_bf16 v[108:111], a[124:127], v[52:55], v[108:111]
    v_fma_f32 v88, v88, v128, v62
    v_fma_f32 v89, v89, v129, v62
    v_mfma_f32_16x16x32_bf16 v[108:111], a[128:131], v[52:55], v[108:111]
    v_fma_f32 v90, v90, v130, v62
    v_fma_f32 v91, v91, v131, v62
    v_mfma_f32_16x16x32_bf16 v[108:111], a[132:135], v[52:55], v[108:111]
    v_max3_f32 v1, v88, v89, v90
    v_max_f32 v1, v1, v91
    v_mfma_f32_16x16x32_bf16 v[108:111], a[136:139], v[52:55], v[108:111]
    buffer_load_dwordx4 v17, s[28:31], s57 offen offset:1024 nt lds
    v_cmp_lt_f32 vcc, s52, v1
    s_cbranch_vccnz L_site6
L_back6:
    v_mfma_f32_16x16x32_bf16 v[108:111], a[140:143], v[52:55], v[108:111]
    v_exp_f32 v96, v88
    v_mfma_f32_16x16x32_bf16 v[104:107], a[120:123], v[136:139], v[76:79]
    v_exp_f32 v97, v89
    v_mfma_f32_16x16x32_bf16 v[104:107], a[124:127], v[140:143], v[104:107]
    v_exp_f32 v98, v90
    v_mfma_f32_16x16x32_bf16 v[104:107], a[128:131], v[144:147], v[104:107]
    v_exp_f32 v99, v91
    v_mfma_f32_16x16x32_bf16 v[104:107], a[132:135], v[148:151], v[104:107]
    v_mul_f32 v88, v96, v128
    v_mul_f32 v89, v97, v129
    v_mfma_f32_16x16x32_bf16 v[104:107], a[136:139], v[152:155], v[104:107]
    v_mul_f32 v90, v98, v130
    v_mul_f32 v91, v99, v131
    v_mfma_f32_16x16x32_bf16 v[104:107], a[140:143], v[156:159], v[104:107]
    v_fma_f32 v112, v116, 2.0, v112
    v_fma_f32 v113, v117, 2.0, v113
    v_fma_f32 v114, v118, 2.0, v114
    v_fma_f32 v115, v119, 2.0, v115
    v_cndmask_b32 v4, 0, v112, s[44:45]
    v_cndmask_b32 v4, v4, v113, s[46:47]
    v_cndmask_b32 v4, v4, v114, s[48:49]
    v_cndmask_b32 v4, v4, v115, s[50:51]
    v_add_f32 v63, v63, v96
    v_fmac_f32 v64, v88, v92
    v_mfma_f32_16x16x4_f32 v[124:127], v4, v60, v[56:59]
    v_add_f32 v63, v63, v97
    v_fmac_f32 v64, v89, v93
    v_add_f32 v63, v63, v98
    v_fmac_f32 v64, v90, v94
    v_add_f32 v63, v63, v99
    v_fmac_f32 v64, v91, v95
    v_mov_b32 v68, v88
    v_mov_b32 v69, v89
    v_mov_b32 v70, v90
    v_mov_b32 v71, v91
    v_add_u32 v44, 49152, v44
    v_add_u32 v45, 49152, v45
    v_add_u32 v46, 49152, v46
    v_add_u32 v47, 49152, v47
    v_add_u32 v48, 49152, v48
    v_add_u32 v49, 49152, v49
    v_fma_f32 v132, -v108, v108, v124
    v_fma_f32 v133, -v109, v109, v125
    v_fma_f32 v134, -v110, v110, v126
    v_fma_f32 v135, -v111, v111, v127
    v_max_f32 v132, v132, v56
    v_max_f32 v133, v133, v56
    v_max_f32 v134, v134, v56
    v_max_f32 v135, v135, v56
    v_rsq_f32 v132, v132
    v_rsq_f32 v133, v133
    v_rsq_f32 v134, v134
    v_rsq_f32 v135, v135
    buffer_load_dwordx4 v[172:175], v65, s[72:75], s61 offen offset:3072 sc1
    v_fma_f32 v104, -v108, v61, v104
    v_fma_f32 v105, -v109, v61, v105
    v_fma_f32 v106, -v110, v61, v106
    v_fma_f32 v107, -v111, v61, v107
    v_fma_f32 v104, v104, v132, v62
    v_fma_f32 v105, v105, v133, v62
    v_fma_f32 v106, v106, v134, v62
    v_fma_f32 v107, v107, v135, v62
    v_max3_f32 v1, v104, v105, v106
    v_max_f32 v1, v1, v107
    v_cmp_lt_f32 vcc, s52, v1
    s_cbranch_vccnz L_site7
L_back7:
    v_exp_f32 v112, v104
    v_exp_f32 v113, v105
    v_exp_f32 v114, v106
    v_exp_f32 v115, v107
    v_cvt_pk_bf16_f32 v72, v88, v89
    v_cvt_pk_bf16_f32 v73, v90, v91
    v_mul_f32 v104, v112, v132
    v_mul_f32 v105, v113, v133
    v_mul_f32 v106, v114, v134
    v_mul_f32 v107, v115, v135
    v_cvt_pk_bf16_f32 v74, v104, v105
    v_cvt_pk_bf16_f32 v75, v106, v107
    ds_write_b128 v237, v[72:75] offset:0
    s_waitcnt lgkmcnt(0)
    s_barrier
L_post27:
    ds_read_b32 v9, v254 offset:4096
    ds_read_b128 v[92:95], v253 offset:0
    ds_read_b128 v[96:99], v253 offset:1024
    ds_read_b128 v[100:103], v253 offset:2048
    ds_read_b128 v[116:119], v253 offset:3072
    s_waitcnt lgkmcnt(4)
    v_cmp_ne_u32 vcc, 0, v9
    s_cbranch_vccnz L_xt27
    s_waitcnt lgkmcnt(3)
    v_mfma_f32_16x16x32_bf16 a[0:3], a[144:147], v[92:95], a[0:3]
    buffer_load_dwordx4 v18, s[28:31], s57 offen offset:2048 nt lds
    v_add_f32 v68, v68, v104
    v_add_f32 v69, v69, v105
    v_mfma_f32_16x16x32_bf16 a[4:7], a[160:163], v[92:95], a[4:7]
    buffer_load_dwordx4 v19, s[28:31], s57 offen offset:3072 nt lds
    v_add_f32 v70, v70, v106
    v_add_f32 v71, v71, v107
    v_mfma_f32_16x16x32_bf16 a[8:11], a[176:179], v[92:95], a[8:11]
    s_add_u32 m0, s40, 4096
    s_nop 0
    buffer_load_dwordx4 v20, s[28:31], s57 offen offset:0 nt lds
    v_add_f32 v63, v63, v112
    v_fma_f32 v64, v104, v108, v64
    s_waitcnt lgkmcnt(2)
    v_mfma_f32_16x16x32_bf16 a[0:3], a[148:151], v[96:99], a[0:3]
    v_add_f32 v63, v63, v113
    v_fma_f32 v64, v105, v109, v64
    v_mfma_f32_16x16x32_bf16 a[4:7], a[164:167], v[96:99], a[4:7]
    v_add_f32 v63, v63, v114
    v_fma_f32 v64, v106, v110, v64
    v_mfma_f32_16x16x32_bf16 a[8:11], a[180:183], v[96:99], a[8:11]
    v_add_f32 v63, v63, v115
    v_fma_f32 v64, v107, v111, v64
    s_waitcnt lgkmcnt(1)
    v_mfma_f32_16x16x32_bf16 a[0:3], a[152:155], v[100:103], a[0:3]
    s_add_u32 s61, s60, 3149824
    buffer_load_dwordx4 v[176:179], v65, s[72:75], s61 offen offset:0 sc1
    v_mfma_f32_16x16x32_bf16 a[4:7], a[168:171], v[100:103], a[4:7]
    v_mfma_f32_16x16x32_bf16 a[8:11], a[184:187], v[100:103], a[8:11]
    s_waitcnt lgkmcnt(0)
    v_mfma_f32_16x16x32_bf16 a[0:3], a[156:159], v[116:119], a[0:3]
    v_mfma_f32_16x16x32_bf16 a[4:7], a[172:175], v[116:119], a[4:7]
    v_mfma_f32_16x16x32_bf16 a[8:11], a[188:191], v[116:119], a[8:11]
    buffer_load_dwordx4 v21, s[28:31], s57 offen offset:1024 nt lds
    s_add_u32 m0, s41, 0
    s_add_u32 s58, s37, 147456
    buffer_load_dwordx4 v224, s[24:27], s58 offen offset:0 nt lds
    buffer_load_dwordx4 v225, s[24:27], s58 offen offset:1024 nt lds
    s_add_u32 m0, s41, 2048
    s_add_u32 s58, s37, 147584
    buffer_load_dwordx4 v224, s[24:27], s58 offen offset:0 nt lds
    buffer_load_dwordx4 v[180:183], v65, s[72:75], s61 offen offset:1024 sc1
    s_waitcnt vmcnt(12)
    s_barrier
    ds_read_b128 a[96:99], v40 offset:49152
    ds_read_b128 a[100:103], v41 offset:49152
    ds_read_b128 a[104:107], v42 offset:49152
    ds_read_b128 a[108:111], v43 offset:49152
    ds_read_b128 a[112:115], v40 offset:49408
    ds_read_b128 a[116:119], v41 offset:49408
    ds_read_b128 a[120:123], v42 offset:49408
    ds_read_b128 a[124:127], v43 offset:49408
    ds_read_b128 a[128:131], v40 offset:49664
    ds_read_b128 a[132:135], v41 offset:49664
    ds_read_b128 a[136:139], v42 offset:49664
    ds_read_b128 a[140:143], v43 offset:49664
    s_waitcnt lgkmcnt(11)
    v_mfma_f32_16x16x32_bf16 v[96:99], a[96:99], a[96:99], v[84:87]
    ds_read_b64_tr_b16 a[144:145], v44 offset:0
    ds_read_b64_tr_b16 a[146:147], v45 offset:0
    v_mfma_f32_16x16x32_bf16 v[100:103], a[96:99], a[48:51], 0
    ds_read_b64_tr_b16 a[148:149], v44 offset:12288
    ds_read_b64_tr_b16 a[150:151], v45 offset:12288
    s_waitcnt lgkmcnt(14)
    v_mfma_f32_16x16x32_bf16 v[96:99], a[100:103], a[100:103], v[96:99]
    ds_read_b64_tr_b16 a[152:153], v44 offset:24576
    ds_read_b64_tr_b16 a[154:155], v45 offset:24576
    v_mfma_f32_16x16x32_bf16 v[100:103], a[100:103], a[52:55], v[100:103]
    ds_read_b64_tr_b16 a[156:157], v44 offset:36864
    ds_read_b64_tr_b16 a[158:159], v45 offset:36864
    s_waitcnt lgkmcnt(15)
    v_mfma_f32_16x16x32_bf16 v[96:99], a[104:107], a[104:107], v[96:99]
    ds_read_b64_tr_b16 a[160:161], v46 offset:0
    ds_read_b64_tr_b16 a[162:163], v47 offset:0
    v_mfma_f32_16x16x32_bf16 v[100:103], a[104:107], a[56:59], v[100:103]
    ds_read_b64_tr_b16 a[164:165], v46 offset:12288
    ds_read_b64_tr_b16 a[166:167], v47 offset:12288
    v_mfma_f32_16x16x32_bf16 v[96:99], a[108:111], a[108:111], v[96:99]
    buffer_load_dwordx4 v225, s[24:27], s58 offen offset:1024 nt lds
    ds_read_b64_tr_b16 a[168:169], v46 offset:24576
    ds_read_b64_tr_b16 a[170:171], v47 offset:24576
    v_mfma_f32_16x16x32_bf16 v[100:103], a[108:111], a[60:63], v[100:103]
    ds_read_b64_tr_b16 a[172:173], v46 offset:36864
    ds_read_b64_tr_b16 a[174:175], v47 offset:36864
    v_mfma_f32_16x16x32_bf16 v[96:99], a[112:115], a[112:115], v[96:99]
    ds_read_b64_tr_b16 a[176:177], v48 offset:0
    ds_read_b64_tr_b16 a[178:179], v49 offset:0
    v_mfma_f32_16x16x32_bf16 v[100:103], a[112:115], a[64:67], v[100:103]
    ds_read_b64_tr_b16 a[180:181], v48 offset:12288
    ds_read_b64_tr_b16 a[182:183], v49 offset:12288
    s_waitcnt lgkmcnt(15)
    v_mfma_f32_16x16x32_bf16 v[96:99], a[116:119], a[116:119], v[96:99]
    ds_read_b64_tr_b16 a[184:185], v48 offset:24576
    ds_read_b64_tr_b16 a[186:187], v49 offset:24576
    v_mfma_f32_16x16x32_bf16 v[100:103], a[116:119], a[68:71], v[100:103]
    ds_read_b64_tr_b16 a[188:189], v48 offset:36864
    ds_read_b64_tr_b16 a[190:191], v49 offset:36864
    v_mfma_f32_16x16x32_bf16 v[92:95], a[96:99], v[52:55], v[80:83]
    v_mfma_f32_16x16x32_bf16 v[92:95], a[100:103], v[52:55], v[92:95]
    v_mfma_f32_16x16x32_bf16 v[92:95], a[104:107], v[52:55], v[92:95]
    v_mfma_f32_16x16x32_bf16 v[92:95], a[108:111], v[52:55], v[92:95]
    s_nop 1
    v_fma_f32 v96, v100, 2.0, v96
    v_fma_f32 v97, v101, 2.0, v97
    v_mfma_f32_16x16x32_bf16 v[92:95], a[112:115], v[52:55], v[92:95]
    v_fma_f32 v98, v102, 2.0, v98
    v_fma_f32 v99, v103, 2.0, v99
    v_mfma_f32_16x16x32_bf16 v[92:95], a[116:119], v[52:55], v[92:95]
    v_cndmask_b32 v3, 0, v96, s[44:45]
    v_cndmask_b32 v3, v3, v97, s[46:47]
    v_mfma_f32_16x16x32_bf16 v[88:91], a[96:99], v[136:139], v[76:79]
    s_add_u32 m0, s41, 4096
    s_add_u32 s58, s37, 147712
    buffer_load_dwordx4 v224, s[24:27], s58 offen offset:0 nt lds
    v_cndmask_b32 v3, v3, v98, s[48:49]
    v_cndmask_b32 v3, v3, v99, s[50:51]
    v_mfma_f32_16x16x32_bf16 v[88:91], a[100:103], v[140:143], v[88:91]
    buffer_load_dwordx4 v225, s[24:27], s58 offen offset:1024 nt lds
    s_nop 0
    s_nop 0
    v_mfma_f32_16x16x32_bf16 v[88:91], a[104:107], v[144:147], v[88:91]
    v_mfma_f32_16x16x4_f32 v[120:123], v3, v60, v[56:59]
    v_mfma_f32_16x16x32_bf16 v[88:91], a[108:111], v[148:151], v[88:91]
    v_mfma_f32_16x16x32_bf16 v[88:91], a[112:115], v[152:155], v[88:91]
    v_mfma_f32_16x16x32_bf16 v[88:91], a[116:119], v[156:159], v[88:91]
    v_mfma_f32_16x16x32_bf16 v[112:115], a[120:123], a[120:123], v[84:87]
    v_mfma_f32_16x16x32_bf16 v[116:119], a[120:123], a[48:51], 0
    v_mfma_f32_16x16x32_bf16 v[112:115], a[124:127], a[124:127], v[112:115]
    v_mfma_f32_16x16x32_bf16 v[116:119], a[124:127], a[52:55], v[116:119]
    s_add_u32 m0, s41, 6144
    s_add_u32 s58, s37, 147840
    buffer_load_dwordx4 v224, s[24:27], s58 offen offset:0 nt lds
    v_fma_f32 v128, -v92, v92, v120
    v_fma_f32 v129, -v93, v93, v121
    v_mfma_f32_16x16x32_bf16 v[112:115], a[128:131], a[128:131], v[112:115]
    v_fma_f32 v130, -v94, v94, v122
    v_fma_f32 v131, -v95, v95, v123
    v_mfma_f32_16x16x32_bf16 v[116:119], a[128:131], a[56:59], v[116:119]
    v_max_f32 v128, v128, v56
    v_max_f32 v129, v129, v56
    v_mfma_f32_16x16x32_bf16 v[112:115], a[132:135], a[132:135], v[112:115]
    v_max_f32 v130, v130, v56
    v_max_f32 v131, v131, v56
    v_mfma_f32_16x16x32_bf16 v[116:119], a[132:135], a[60:63], v[116:119]
    v_rsq_f32 v128, v128
    v_mfma_f32_16x16x32_bf16 v[112:115], a[136:139], a[136:139], v[112:115]
    v_rsq_f32 v129, v129
    v_mfma_f32_16x16x32_bf16 v[116:119], a[136:139], a[64:67], v[116:119]
    v_rsq_f32 v130, v130
    v_mfma_f32_16x16x32_bf16 v[112:115], a[140:143], a[140:143], v[112:115]
    v_rsq_f32 v131, v131
    v_mfma_f32_16x16x32_bf16 v[116:119], a[140:143], a[68:71], v[116:119]
    v_fma_f32 v88, -v92, v61, v88
    v_fma_f32 v89, -v93, v61, v89
    v_mfma_f32_16x16x32_bf16 v[108:111], a[120:123], v[52:55], v[80:83]
    v_fma_f32 v90, -v94, v61, v90
    v_fma_f32 v91, -v95, v61, v91
    v_mfma_f32_16x16x32_bf16 v[108:111], a[124:127], v[52:55], v[108:111]
    v_fma_f32 v88, v88, v128, v62
    v_fma_f32 v89, v89, v129, v62
    v_mfma_f32_16x16x32_bf16 v[108:111], a[128:131], v[52:55], v[108:111]
    v_fma_f32 v90, v90, v130, v62
    v_fma_f32 v91, v91, v131, v62
    v_mfma_f32_16x16x32_bf16 v[108:111], a[132:135], v[52:55], v[108:111]
    v_max3_f32 v1, v88, v89, v90
    v_max_f32 v1, v1, v91
    v_mfma_f32_16x16x32_bf16 v[108:111], a[136:139], v[52:55], v[108:111]
    buffer_load_dwordx4 v[184:187], v65, s[72:75], s61 offen offset:2048 sc1
    v_cmp_lt_f32 vcc, s52, v1
    s_cbranch_vccnz L_site8
L_back8:
    v_mfma_f32_16x16x32_bf16 v[108:111], a[140:143], v[52:55], v[108:111]
    v_exp_f32 v96, v88
    v_mfma_f32_16x16x32_bf16 v[104:107], a[120:123], v[136:139], v[76:79]
    v_exp_f32 v97, v89
    v_mfma_f32_16x16x32_bf16 v[104:107], a[124:127], v[140:143], v[104:107]
    v_exp_f32 v98, v90
    v_mfma_f32_16x16x32_bf16 v[104:107], a[128:131], v[144:147], v[104:107]
    v_exp_f32 v99, v91
    v_mfma_f32_16x16x32_bf16 v[104:107], a[132:135], v[148:151], v[104:107]
    v_mul_f32 v88, v96, v128
    v_mul_f32 v89, v97, v129
    v_mfma_f32_16x16x32_bf16 v[104:107], a[136:139], v[152:155], v[104:107]
    v_mul_f32 v90, v98, v130
    v_mul_f32 v91, v99, v131
    v_mfma_f32_16x16x32_bf16 v[104:107], a[140:143], v[156:159], v[104:107]
    v_fma_f32 v112, v116, 2.0, v112
    v_fma_f32 v113, v117, 2.0, v113
    v_fma_f32 v114, v118, 2.0, v114
    v_fma_f32 v115, v119, 2.0, v115
    v_cndmask_b32 v4, 0, v112, s[44:45]
    v_cndmask_b32 v4, v4, v113, s[46:47]
    v_cndmask_b32 v4, v4, v114, s[48:49]
    v_cndmask_b32 v4, v4, v115, s[50:51]
    v_add_f32 v63, v63, v96
    v_fmac_f32 v64, v88, v92
    v_mfma_f32_16x16x4_f32 v[124:127], v4, v60, v[56:59]
    v_add_f32 v63, v63, v97
    v_fmac_f32 v64, v89, v93
    v_add_f32 v63, v63, v98
    v_fmac_f32 v64, v90, v94
    v_add_f32 v63, v63, v99
    v_fmac_f32 v64, v91, v95
    v_add_f32 v68, v68, v88
    v_add_f32 v69, v69, v89
    v_add_f32 v70, v70, v90
    v_add_f32 v71, v71, v91
    v_add_u32 v44, -49152, v44
    v_add_u32 v45, -49152, v45
    v_add_u32 v46, -49152, v46
    v_add_u32 v47, -49152, v47
    v_add_u32 v48, -49152, v48
    v_add_u32 v49, -49152, v49
    v_fma_f32 v132, -v108, v108, v124
    v_fma_f32 v133, -v109, v109, v125
    v_fma_f32 v134, -v110, v110, v126
    v_fma_f32 v135, -v111, v111, v127
    v_max_f32 v132, v132, v56
    v_max_f32 v133, v133, v56
    v_max_f32 v134, v134, v56
    v_max_f32 v135, v135, v56
    v_rsq_f32 v132, v132
    v_rsq_f32 v133, v133
    v_rsq_f32 v134, v134
    v_rsq_f32 v135, v135
    buffer_load_dwordx4 v225, s[24:27], s58 offen offset:1024 nt lds
    v_fma_f32 v104, -v108, v61, v104
    v_fma_f32 v105, -v109, v61, v105
    v_fma_f32 v106, -v110, v61, v106
    v_fma_f32 v107, -v111, v61, v107
    v_fma_f32 v104, v104, v132, v62
    v_fma_f32 v105, v105, v133, v62
    v_fma_f32 v106, v106, v134, v62
    v_fma_f32 v107, v107, v135, v62
    v_max3_f32 v1, v104, v105, v106
    v_max_f32 v1, v1, v107
    v_cmp_lt_f32 vcc, s52, v1
    s_cbranch_vccnz L_site9
L_back9:
    s_add_u32 m0, s41, 8192
    s_add_u32 s58, s37, 147968
    buffer_load_dwordx4 v224, s[24:27], s58 offen offset:0 nt lds
    v_exp_f32 v112, v104
    v_exp_f32 v113, v105
    v_exp_f32 v114, v106
    v_exp_f32 v115, v107
    v_cvt_pk_bf16_f32 v72, v88, v89
    v_cvt_pk_bf16_f32 v73, v90, v91
    v_mul_f32 v104, v112, v132
    v_mul_f32 v105, v113, v133
    v_mul_f32 v106, v114, v134
    v_mul_f32 v107, v115, v135
    v_cvt_pk_bf16_f32 v74, v104, v105
    v_cvt_pk_bf16_f32 v75, v106, v107
    ds_write_b128 v237, v[72:75] offset:0
    v_add_f32 v68, v68, v104
    v_add_f32 v69, v69, v105
    v_add_f32 v70, v70, v106
    v_add_f32 v71, v71, v107
    v_cvt_pk_bf16_f32 v66, v68, v69
    v_cvt_pk_bf16_f32 v67, v70, v71
    ds_write_b64 v238, v[66:67]
    s_lshl_b32 s56, s3, 13
    v_lshl_add_u32 v233, v0, 7, s56
    v_min_u32 v233, L_hot - L_tail, v233
    v_add_u32 v233, L_tail - L_pc_main, v233
    global_load_dword v234, v233, s[100:101]
    s_waitcnt vmcnt(12)
    s_waitcnt lgkmcnt(0)
    s_barrier
L_post9:
    ds_read_b32 v9, v254 offset:4096
    ds_read_b64 v[120:121], v254 offset:0
    ds_read_b64 v[122:123], v254 offset:512
    ds_read_b64 v[124:125], v254 offset:1024
    ds_read_b64 v[126:127], v254 offset:1536
    ds_read_b128 v[92:95], v253 offset:0
    ds_read_b128 v[96:99], v253 offset:1024
    ds_read_b128 v[100:103], v253 offset:2048
    ds_read_b128 v[116:119], v253 offset:3072
    ds_read_b128 a[48:51], v34 offset:0
    ds_read_b128 a[52:55], v35 offset:0
    ds_read_b128 a[56:59], v34 offset:128
    ds_read_b128 a[60:63], v35 offset:128
    ds_read_b128 a[64:67], v34 offset:256
    ds_read_b128 a[68:71], v35 offset:256
    s_waitcnt lgkmcnt(14)
    v_cmp_ne_u32 vcc, 0, v9
    s_cbranch_vccnz L_xt9
    s_waitcnt lgkmcnt(12)
    v_mfma_f32_16x16x32_bf16 a[0:3], a[72:75], v[120:123], a[0:3]
    buffer_load_dwordx4 v225, s[24:27], s58 offen offset:1024 nt lds
    v_add_f32 v63, v63, v112
    v_fma_f32 v64, v104, v108, v64
    v_mfma_f32_16x16x32_bf16 a[4:7], a[80:83], v[120:123], a[4:7]
    v_add_f32 v63, v63, v113
    v_fma_f32 v64, v105, v109, v64
    v_mfma_f32_16x16x32_bf16 a[8:11], a[88:91], v[120:123], a[8:11]
    v_add_f32 v63, v63, v114
    v_fma_f32 v64, v106, v110, v64
    s_waitcnt lgkmcnt(10)
    v_mfma_f32_16x16x32_bf16 a[0:3], a[76:79], v[124:127], a[0:3]
    v_add_f32 v63, v63, v115
    v_fma_f32 v64, v107, v111, v64
    v_mfma_f32_16x16x32_bf16 a[4:7], a[84:87], v[124:127], a[4:7]
    v_mfma_f32_16x16x32_bf16 a[8:11], a[92:95], v[124:127], a[8:11]
    s_waitcnt lgkmcnt(9)
    v_mfma_f32_16x16x32_bf16 a[0:3], a[144:147], v[92:95], a[0:3]
    ds_read_b64_tr_b16 a[72:73], v36 offset:0
    ds_read_b64_tr_b16 a[74:75], v36 offset:6144
    v_mfma_f32_16x16x32_bf16 a[4:7], a[160:163], v[92:95], a[4:7]
    ds_read_b64_tr_b16 a[76:77], v36 offset:12288
    ds_read_b64_tr_b16 a[78:79], v36 offset:18432
    v_mfma_f32_16x16x32_bf16 a[8:11], a[176:179], v[92:95], a[8:11]
    s_add_u32 m0, s41, 10240
    s_add_u32 s58, s37, 148096
    buffer_load_dwordx4 v224, s[24:27], s58 offen offset:0 nt lds
    ds_read_b64_tr_b16 a[80:81], v37 offset:0
    ds_read_b64_tr_b16 a[82:83], v37 offset:6144
    s_waitcnt lgkmcnt(14)
    v_mfma_f32_16x16x32_bf16 a[0:3], a[148:151], v[96:99], a[0:3]
    ds_read_b64_tr_b16 a[84:85], v37 offset:12288
    ds_read_b64_tr_b16 a[86:87], v37 offset:18432
    v_mfma_f32_16x16x32_bf16 a[4:7], a[164:167], v[96:99], a[4:7]
    ds_read_b64_tr_b16 a[88:89], v38 offset:0
    ds_read_b64_tr_b16 a[90:91], v38 offset:6144
    v_mfma_f32_16x16x32_bf16 a[8:11], a[180:183], v[96:99], a[8:11]
    ds_read_b64_tr_b16 a[92:93], v38 offset:12288
    ds_read_b64_tr_b16 a[94:95], v38 offset:18432
    s_waitcnt lgkmcnt(15)
    v_mfma_f32_16x16x32_bf16 a[0:3], a[152:155], v[100:103], a[0:3]
    v_mfma_f32_16x16x32_bf16 a[4:7], a[168:171], v[100:103], a[4:7]
    v_mfma_f32_16x16x32_bf16 a[8:11], a[184:187], v[100:103], a[8:11]
    v_mfma_f32_16x16x32_bf16 a[0:3], a[156:159], v[116:119], a[0:3]
    v_mfma_f32_16x16x32_bf16 a[4:7], a[172:175], v[116:119], a[4:7]
    v_mfma_f32_16x16x32_bf16 a[8:11], a[188:191], v[116:119], a[8:11]
    v_mfma_f32_16x16x32_bf16 v[84:87], a[48:51], a[48:51], 0
    v_mfma_f32_16x16x32_bf16 v[80:83], a[48:51], v[52:55], 0
    buffer_load_dwordx4 v[188:191], v65, s[72:75], s61 offen offset:3072 sc1
    v_mfma_f32_16x16x32_bf16 v[84:87], a[52:55], a[52:55], v[84:87]
    buffer_load_dwordx4 v225, s[24:27], s58 offen offset:1024 nt lds
    v_mfma_f32_16x16x32_bf16 v[80:83], a[52:55], v[52:55], v[80:83]
    v_mfma_f32_16x16x32_bf16 v[84:87], a[56:59], a[56:59], v[84:87]
    v_mfma_f32_16x16x32_bf16 v[80:83], a[56:59], v[52:55], v[80:83]
    s_waitcnt lgkmcnt(14)
    v_mfma_f32_16x16x32_bf16 v[84:87], a[60:63], a[60:63], v[84:87]
    v_mfma_f32_16x16x32_bf16 v[80:83], a[60:63], v[52:55], v[80:83]
    s_waitcnt lgkmcnt(13)
    v_mfma_f32_16x16x32_bf16 v[84:87], a[64:67], a[64:67], v[84:87]
    v_mfma_f32_16x16x32_bf16 v[80:83], a[64:67], v[52:55], v[80:83]
    s_waitcnt lgkmcnt(12)
    v_mfma_f32_16x16x32_bf16 v[84:87], a[68:71], a[68:71], v[84:87]
    v_mfma_f32_16x16x32_bf16 v[80:83], a[68:71], v[52:55], v[80:83]
    s_waitcnt lgkmcnt(0)
    v_mfma_f32_16x16x32_bf16 v[76:79], a[48:51], v[136:139], 0
    v_mfma_f32_16x16x32_bf16 v[76:79], a[52:55], v[140:143], v[76:79]
    v_mfma_f32_16x16x32_bf16 v[76:79], a[56:59], v[144:147], v[76:79]
    s_add_u32 m0, s42, 0
    s_add_u32 s59, s37, 344064
    buffer_load_dwordx4 v224, s[24:27], s59 offen offset:0 nt lds
    v_mfma_f32_16x16x32_bf16 v[76:79], a[60:63], v[148:151], v[76:79]
    v_mfma_f32_16x16x32_bf16 v[76:79], a[64:67], v[152:155], v[76:79]
    v_mfma_f32_16x16x32_bf16 v[76:79], a[68:71], v[156:159], v[76:79]
    s_mul_i32 s28, s3, 131072
    s_and_b32 s56, s2, 7
    s_lshl_b32 s56, s56, 10
    s_add_u32 s28, s28, s56
    s_bfe_u32 s56, s2, 0x30003
    s_lshl_b32 s56, s56, 7
    s_add_u32 s28, s28, s56
    s_lshr_b32 s56, s2, 6
    s_lshl_b32 s56, s56, 13
    s_add_u32 s28, s28, s56
    s_add_u32 s28, s28, 65536
    s_sub_u32 s29, s2, 64
    s_mul_i32 s30, s29, 32768
    s_lshl_b32 s56, s3, 13
    s_add_u32 s30, s30, s56
    s_add_u32 s30, s30, 65536
    s_add_u32 s31, s30, 4096
    v_mov_b32 v28, v242
    v_bfe_u32 v1, v0, 4, 1
    v_mul_u32_u24 v2, 32768, v1
    v_mul_u32_u24 v1, 0x70, v1
    v_xor_b32 v242, v242, v1
    v_sub_u32 v242, v242, v2
    v_add_u32 v243, 32768, v242
    v_mov_b32 v232, 0x53800000
    s_mov_b32 s43, 1
    s_mov_b32 s68, s18
    s_mov_b32 s69, s19
    s_mov_b32 s70, 6144
    s_mov_b32 s71, 0x20000
L_tail:
    v_and_b32 v1, 15, v0
    v_lshlrev_b32 v1, 8, v1
    v_sub_u32 v1, v34, v1
    v_lshrrev_b32 v2, 2, v0
    v_lshlrev_b32 v2, 8, v2
    s_sub_u32 s56, s41, s40
    v_add_u32 v40, s56, v1
    v_xor_b32 v41, 64, v40
    s_sub_u32 s56, s42, s40
    v_add_u32 v42, s56, v1
    v_xor_b32 v43, 64, v42
    s_mul_i32 s56, s3, 3
    s_add_u32 s57, s56, 0
    s_lshr_b32 s57, s57, 2
    s_mul_i32 s57, s57, 1920
    s_add_u32 s57, s57, 24576
    v_sub_u32 v44, v36, v2
    v_add_u32 v44, s57, v44
    v_add_u32 v47, 49152, v44
    s_add_u32 s57, s56, 1
    s_lshr_b32 s57, s57, 2
    s_mul_i32 s57, s57, 1920
    s_add_u32 s57, s57, 24576
    v_sub_u32 v45, v37, v2
    v_add_u32 v45, s57, v45
    v_add_u32 v48, 49152, v45
    s_add_u32 s57, s56, 2
    s_lshr_b32 s57, s57, 2
    s_mul_i32 s57, s57, 1920
    s_add_u32 s57, s57, 24576
    v_sub_u32 v46, v38, v2
    v_add_u32 v46, s57, v46
    v_add_u32 v49, 49152, v46
    v_accvgpr_read_b32 v16, a0
    v_accvgpr_read_b32 v17, a1
    v_accvgpr_read_b32 v18, a2
    v_accvgpr_read_b32 v19, a3
    v_accvgpr_read_b32 v20, a4
    v_accvgpr_read_b32 v21, a5
    v_accvgpr_read_b32 v22, a6
    v_accvgpr_read_b32 v23, a7
    v_accvgpr_read_b32 v24, a8
    v_accvgpr_read_b32 v25, a9
    v_accvgpr_read_b32 v26, a10
    v_accvgpr_read_b32 v27, a11
    buffer_load_dwordx4 v225, s[24:27], s59 offen offset:1024 nt lds
    s_add_u32 m0, s42, 2048
    s_add_u32 s59, s37, 344192
    buffer_load_dwordx4 v224, s[24:27], s59 offen offset:0 nt lds
    s_waitcnt vmcnt(12)
    s_barrier
    ds_read_b128 a[96:99], v40 offset:0
    ds_read_b128 a[100:103], v41 offset:0
    ds_read_b128 a[104:107], v40 offset:2048
    ds_read_b128 a[108:111], v41 offset:2048
    ds_read_b128 a[112:115], v40 offset:4096
    ds_read_b128 a[116:119], v41 offset:4096
    s_waitcnt lgkmcnt(5)
    v_mfma_f32_16x16x32_bf16 v[96:99], a[96:99], a[96:99], v[84:87]
    ds_read_b64_tr_b16 a[144:145], v44 offset:0
    ds_read_b64_tr_b16 a[148:149], v44 offset:12288
    v_mfma_f32_16x16x32_bf16 v[100:103], a[96:99], a[48:51], 0
    ds_read_b64_tr_b16 a[152:153], v44 offset:24576
    ds_read_b64_tr_b16 a[156:157], v44 offset:36864
    s_waitcnt lgkmcnt(8)
    v_mfma_f32_16x16x32_bf16 v[96:99], a[100:103], a[100:103], v[96:99]
    ds_read_b64_tr_b16 a[160:161], v45 offset:0
    ds_read_b64_tr_b16 a[164:165], v45 offset:12288
    v_mfma_f32_16x16x32_bf16 v[100:103], a[100:103], a[52:55], v[100:103]
    ds_read_b64_tr_b16 a[168:169], v45 offset:24576
    ds_read_b64_tr_b16 a[172:173], v45 offset:36864
    s_waitcnt lgkmcnt(11)
    v_mfma_f32_16x16x32_bf16 v[96:99], a[104:107], a[104:107], v[96:99]
    buffer_load_dwordx4 v225, s[24:27], s59 offen offset:1024 nt lds
    ds_read_b64_tr_b16 a[176:177], v46 offset:0
    ds_read_b64_tr_b16 a[180:181], v46 offset:12288
    v_mfma_f32_16x16x32_bf16 v[100:103], a[104:107], a[56:59], v[100:103]
    s_add_u32 m0, s42, 4096
    s_add_u32 s59, s37, 344320
    buffer_load_dwordx4 v224, s[24:27], s59 offen offset:0 nt lds
    ds_read_b64_tr_b16 a[184:185], v46 offset:24576
    ds_read_b64_tr_b16 a[188:189], v46 offset:36864
    s_waitcnt lgkmcnt(14)
    v_mfma_f32_16x16x32_bf16 v[96:99], a[108:111], a[108:111], v[96:99]
    v_mfma_f32_16x16x32_bf16 v[100:103], a[108:111], a[60:63], v[100:103]
    s_waitcnt lgkmcnt(13)
    v_mfma_f32_16x16x32_bf16 v[96:99], a[112:115], a[112:115], v[96:99]
    v_mfma_f32_16x16x32_bf16 v[100:103], a[112:115], a[64:67], v[100:103]
    s_waitcnt lgkmcnt(12)
    v_mfma_f32_16x16x32_bf16 v[96:99], a[116:119], a[116:119], v[96:99]
    v_mfma_f32_16x16x32_bf16 v[100:103], a[116:119], a[68:71], v[100:103]
    v_mfma_f32_16x16x32_bf16 v[92:95], a[96:99], v[52:55], v[80:83]
    v_mfma_f32_16x16x32_bf16 v[92:95], a[100:103], v[52:55], v[92:95]
    v_mfma_f32_16x16x32_bf16 v[92:95], a[104:107], v[52:55], v[92:95]
    v_mfma_f32_16x16x32_bf16 v[92:95], a[108:111], v[52:55], v[92:95]
    buffer_load_dwordx4 v225, s[24:27], s59 offen offset:1024 nt lds
    s_nop 2
    v_fma_f32 v96, v100, 2.0, v96
    v_fma_f32 v97, v101, 2.0, v97
    v_mfma_f32_16x16x32_bf16 v[92:95], a[112:115], v[52:55], v[92:95]
    v_fma_f32 v98, v102, 2.0, v98
    v_fma_f32 v99, v103, 2.0, v99
    v_mfma_f32_16x16x32_bf16 v[92:95], a[116:119], v[52:55], v[92:95]
    v_cndmask_b32 v3, 0, v96, s[44:45]
    v_cndmask_b32 v3, v3, v97, s[46:47]
    v_mfma_f32_16x16x32_bf16 v[88:91], a[96:99], v[136:139], v[76:79]
    v_cndmask_b32 v3, v3, v98, s[48:49]
    v_cndmask_b32 v3, v3, v99, s[50:51]
    v_mfma_f32_16x16x32_bf16 v[88:91], a[100:103], v[140:143], v[88:91]
    s_nop 0
    s_nop 0
    v_mfma_f32_16x16x32_bf16 v[88:91], a[104:107], v[144:147], v[88:91]
    v_mfma_f32_16x16x4_f32 v[120:123], v3, v60, v[56:59]
    v_mfma_f32_16x16x32_bf16 v[88:91], a[108:111], v[148:151], v[88:91]
    v_mfma_f32_16x16x32_bf16 v[88:91], a[112:115], v[152:155], v[88:91]
    v_mfma_f32_16x16x32_bf16 v[88:91], a[116:119], v[156:159], v[88:91]
    s_nop 6
    v_fma_f32 v128, -v92, v92, v120
    v_fma_f32 v129, -v93, v93, v121
    v_fma_f32 v130, -v94, v94, v122
    v_fma_f32 v131, -v95, v95, v123
    v_max_f32 v128, v128, v56
    v_max_f32 v129, v129, v56
    v_max_f32 v130, v130, v56
    v_max_f32 v131, v131, v56
    v_rsq_f32 v128, v128
    v_rsq_f32 v129, v129
    v_rsq_f32 v130, v130
    v_rsq_f32 v131, v131
    s_add_u32 m0, s42, 6144
    s_add_u32 s59, s37, 344448
    buffer_load_dwordx4 v224, s[24:27], s59 offen offset:0 nt lds
    v_fma_f32 v88, -v92, v61, v88
    v_fma_f32 v89, -v93, v61, v89
    v_fma_f32 v90, -v94, v61, v90
    v_fma_f32 v91, -v95, v61, v91
    v_fma_f32 v88, v88, v128, v62
    v_fma_f32 v89, v89, v129, v62
    buffer_load_dwordx4 v225, s[24:27], s59 offen offset:1024 nt lds
    v_fma_f32 v90, v90, v130, v62
    v_fma_f32 v91, v91, v131, v62
    v_max3_f32 v1, v88, v89, v90
    v_max_f32 v1, v1, v91
    v_cmp_lt_f32 vcc, s52, v1
    s_cbranch_vccnz L_site10
L_back10:
    v_exp_f32 v96, v88
    v_exp_f32 v97, v89
    v_exp_f32 v98, v90
    v_exp_f32 v99, v91
    v_mul_f32 v88, v96, v128
    v_mul_f32 v89, v97, v129
    v_mul_f32 v90, v98, v130
    v_mul_f32 v91, v99, v131
    v_add_f32 v63, v63, v96
    v_fmac_f32 v64, v88, v92
    v_add_f32 v63, v63, v97
    v_fmac_f32 v64, v89, v93
    v_add_f32 v63, v63, v98
    v_fmac_f32 v64, v90, v94
    v_add_f32 v63, v63, v99
    v_fmac_f32 v64, v91, v95
    v_mov_b32 v68, v88
    v_mov_b32 v69, v89
    v_mov_b32 v70, v90
    v_mov_b32 v71, v91
    s_waitcnt vmcnt(14)
    ds_read_b128 a[120:123], v40 offset:6144
    ds_read_b128 a[124:127], v41 offset:6144
    s_waitcnt lgkmcnt(1)
    v_mfma_f32_16x16x32_bf16 v[112:115], a[120:123], a[120:123], v[84:87]
    s_add_u32 m0, s42, 8192
    s_add_u32 s59, s37, 344576
    buffer_load_dwordx4 v224, s[24:27], s59 offen offset:0 nt lds
    v_mfma_f32_16x16x32_bf16 v[116:119], a[120:123], a[48:51], 0
    s_waitcnt lgkmcnt(0)
    v_mfma_f32_16x16x32_bf16 v[112:115], a[124:127], a[124:127], v[112:115]
    v_mfma_f32_16x16x32_bf16 v[116:119], a[124:127], a[52:55], v[116:119]
    v_mfma_f32_16x16x32_bf16 v[108:111], a[120:123], v[52:55], v[80:83]
    v_mfma_f32_16x16x32_bf16 v[104:107], a[120:123], v[136:139], v[76:79]
    s_waitcnt vmcnt(12)
    ds_read_b128 a[128:131], v40 offset:8192
    ds_read_b128 a[132:135], v41 offset:8192
    v_mfma_f32_16x16x32_bf16 v[108:111], a[124:127], v[52:55], v[108:111]
    buffer_load_dwordx4 v225, s[24:27], s59 offen offset:1024 nt lds
    v_mfma_f32_16x16x32_bf16 v[104:107], a[124:127], v[140:143], v[104:107]
    s_add_u32 m0, s42, 10240
    s_add_u32 s59, s37, 344704
    buffer_load_dwordx4 v224, s[24:27], s59 offen offset:0 nt lds
    s_waitcnt lgkmcnt(1)
    v_mfma_f32_16x16x32_bf16 v[112:115], a[128:131], a[128:131], v[112:115]
    v_mfma_f32_16x16x32_bf16 v[116:119], a[128:131], a[56:59], v[116:119]
    s_waitcnt lgkmcnt(0)
    v_mfma_f32_16x16x32_bf16 v[112:115], a[132:135], a[132:135], v[112:115]
    v_mfma_f32_16x16x32_bf16 v[116:119], a[132:135], a[60:63], v[116:119]
    v_mfma_f32_16x16x32_bf16 v[108:111], a[128:131], v[52:55], v[108:111]
    v_mfma_f32_16x16x32_bf16 v[104:107], a[128:131], v[144:147], v[104:107]
    buffer_load_dwordx4 v225, s[24:27], s59 offen offset:1024 nt lds
    s_waitcnt vmcnt(12)
    ds_read_b128 a[136:139], v40 offset:10240
    ds_read_b128 a[140:143], v41 offset:10240
    s_barrier
    s_add_u32 s61, s60, 3153920
    buffer_load_dwordx4 v[192:195], v65, s[32:35], s61 offen offset:0 sc1
    v_mfma_f32_16x16x32_bf16 v[108:111], a[132:135], v[52:55], v[108:111]
    ds_read_b64_tr_b16 a[146:147], v44 offset:6144
    v_mfma_f32_16x16x32_bf16 v[104:107], a[132:135], v[148:151], v[104:107]
    ds_read_b64_tr_b16 a[150:151], v44 offset:18432
    s_waitcnt lgkmcnt(3)
    v_mfma_f32_16x16x32_bf16 v[112:115], a[136:139], a[136:139], v[112:115]
    ds_read_b64_tr_b16 a[154:155], v44 offset:30720
    v_mfma_f32_16x16x32_bf16 v[116:119], a[136:139], a[64:67], v[116:119]
    ds_read_b64_tr_b16 a[158:159], v44 offset:43008
    s_waitcnt lgkmcnt(4)
    v_mfma_f32_16x16x32_bf16 v[112:115], a[140:143], a[140:143], v[112:115]
    ds_read_b64_tr_b16 a[162:163], v45 offset:6144
    v_mfma_f32_16x16x32_bf16 v[116:119], a[140:143], a[68:71], v[116:119]
    ds_read_b64_tr_b16 a[166:167], v45 offset:18432
    v_mfma_f32_16x16x32_bf16 v[108:111], a[136:139], v[52:55], v[108:111]
    ds_read_b64_tr_b16 a[170:171], v45 offset:30720
    v_mfma_f32_16x16x32_bf16 v[108:111], a[140:143], v[52:55], v[108:111]
    ds_read_b64_tr_b16 a[174:175], v45 offset:43008
    s_nop 2
    v_fma_f32 v112, v116, 2.0, v112
    v_fma_f32 v113, v117, 2.0, v113
    v_fma_f32 v114, v118, 2.0, v114
    v_fma_f32 v115, v119, 2.0, v115
    v_cndmask_b32 v4, 0, v112, s[44:45]
    v_cndmask_b32 v4, v4, v113, s[46:47]
    v_cndmask_b32 v4, v4, v114, s[48:49]
    v_cndmask_b32 v4, v4, v115, s[50:51]
    ds_read_b64_tr_b16 a[178:179], v46 offset:6144
    ds_read_b64_tr_b16 a[182:183], v46 offset:18432
    v_mfma_f32_16x16x4_f32 v[124:127], v4, v60, v[56:59]
    ds_read_b64_tr_b16 a[186:187], v46 offset:30720
    ds_read_b64_tr_b16 a[190:191], v46 offset:43008
    buffer_load_dwordx4 v[196:199], v65, s[32:35], s61 offen offset:1024 sc1
    s_nop 5
    v_mfma_f32_16x16x32_bf16 v[104:107], a[136:139], v[152:155], v[104:107]
    v_fma_f32 v132, -v108, v108, v124
    v_fma_f32 v133, -v109, v109, v125
    v_mfma_f32_16x16x32_bf16 v[104:107], a[140:143], v[156:159], v[104:107]
    v_fma_f32 v134, -v110, v110, v126
    v_fma_f32 v135, -v111, v111, v127
    v_max_f32 v132, v132, v56
    v_max_f32 v133, v133, v56
    v_max_f32 v134, v134, v56
    v_max_f32 v135, v135, v56
    v_rsq_f32 v132, v132
    v_rsq_f32 v133, v133
    v_rsq_f32 v134, v134
    v_rsq_f32 v135, v135
    v_pk_fma_f32 v[104:105], v[108:109], v[60:61], v[104:105] op_sel:[0,1,0] neg_lo:[1,0,0] neg_hi:[1,0,0]
    v_pk_fma_f32 v[106:107], v[110:111], v[60:61], v[106:107] op_sel:[0,1,0] neg_lo:[1,0,0] neg_hi:[1,0,0]
    v_pk_fma_f32 v[104:105], v[104:105], v[132:133], v[62:63] op_sel_hi:[1,1,0]
    v_pk_fma_f32 v[106:107], v[106:107], v[134:135], v[62:63] op_sel_hi:[1,1,0]
L_back11:
    v_max3_f32 v1, v104, v105, v106
    v_max_f32 v1, v1, v107
    v_cmp_lt_f32 vcc, s52, v1
    v_exp_f32 v112, v104
    v_exp_f32 v113, v105
    v_exp_f32 v114, v106
    v_exp_f32 v115, v107
    s_cbranch_vccnz L_site11
    v_cvt_pk_bf16_f32 v72, v88, v89
    v_cvt_pk_bf16_f32 v73, v90, v91
    v_pk_mul_f32 v[104:105], v[112:113], v[132:133]
    v_pk_mul_f32 v[106:107], v[114:115], v[134:135]
    v_cvt_pk_bf16_f32 v74, v104, v105
    v_cvt_pk_bf16_f32 v75, v106, v107
    ds_write_b128 v237, v[72:75] offset:12288
    s_waitcnt lgkmcnt(0)
    s_barrier
    ds_read_b32 v9, v254 offset:4100
    ds_read_b128 a[192:195], v253 offset:12288
    ds_read_b128 a[196:199], v253 offset:13312
    ds_read_b128 a[200:203], v253 offset:14336
    ds_read_b128 a[204:207], v253 offset:15360
    buffer_load_dwordx4 v[200:203], v65, s[32:35], s61 offen offset:2048 sc1
    buffer_load_dwordx4 v[204:207], v65, s[32:35], s61 offen offset:3072 sc1
    s_waitcnt lgkmcnt(4)
    v_cmp_ne_u32 vcc, 0, v9
    s_cbranch_vccnz L_xt11
L_post11:
    s_waitcnt lgkmcnt(3)
    v_mfma_f32_16x16x32_bf16 v[16:19], a[144:147], a[192:195], v[16:19]
    v_add_f32 v68, v68, v104
    v_add_f32 v69, v69, v105
    v_mfma_f32_16x16x32_bf16 v[20:23], a[160:163], a[192:195], v[20:23]
    v_add_f32 v70, v70, v106
    v_add_f32 v71, v71, v107
    v_mfma_f32_16x16x32_bf16 v[24:27], a[176:179], a[192:195], v[24:27]
    v_add_f32 v63, v63, v112
    v_fma_f32 v64, v104, v108, v64
    s_waitcnt lgkmcnt(2)
    v_mfma_f32_16x16x32_bf16 v[16:19], a[148:151], a[196:199], v[16:19]
    s_waitcnt vmcnt(14)
    ds_read_b128 a[96:99], v42 offset:0
    ds_read_b128 a[100:103], v43 offset:0
    v_mfma_f32_16x16x32_bf16 v[20:23], a[164:167], a[196:199], v[20:23]
    v_add_f32 v63, v63, v113
    v_fma_f32 v64, v105, v109, v64
    v_mfma_f32_16x16x32_bf16 v[24:27], a[180:183], a[196:199], v[24:27]
    v_add_f32 v63, v63, v114
    v_fma_f32 v64, v106, v110, v64
    s_waitcnt lgkmcnt(3)
    v_mfma_f32_16x16x32_bf16 v[16:19], a[152:155], a[200:203], v[16:19]
    v_add_f32 v63, v63, v115
    v_fma_f32 v64, v107, v111, v64
    v_mfma_f32_16x16x32_bf16 v[20:23], a[168:171], a[200:203], v[20:23]
    s_waitcnt vmcnt(12)
    ds_read_b128 a[104:107], v42 offset:2048
    ds_read_b128 a[108:111], v43 offset:2048
    v_mfma_f32_16x16x32_bf16 v[24:27], a[184:187], a[200:203], v[24:27]
    s_waitcnt lgkmcnt(4)
    v_mfma_f32_16x16x32_bf16 v[16:19], a[156:159], a[204:207], v[16:19]
    v_mfma_f32_16x16x32_bf16 v[20:23], a[172:175], a[204:207], v[20:23]
    v_mfma_f32_16x16x32_bf16 v[24:27], a[188:191], a[204:207], v[24:27]
    s_waitcnt lgkmcnt(3)
    v_mfma_f32_16x16x32_bf16 v[96:99], a[96:99], a[96:99], v[84:87]
    v_mfma_f32_16x16x32_bf16 v[100:103], a[96:99], a[48:51], 0
    s_waitcnt lgkmcnt(2)
    v_mfma_f32_16x16x32_bf16 v[96:99], a[100:103], a[100:103], v[96:99]
    v_mfma_f32_16x16x32_bf16 v[100:103], a[100:103], a[52:55], v[100:103]
    s_waitcnt vmcnt(10)
    ds_read_b128 a[112:115], v42 offset:4096
    ds_read_b128 a[116:119], v43 offset:4096
    s_barrier
    v_mfma_f32_16x16x32_bf16 v[92:95], a[96:99], v[52:55], v[80:83]
    s_add_u32 s61, s60, 3158016
    buffer_load_dwordx4 v[208:211], v65, s[32:35], s61 offen offset:0 sc1
    ds_read_b64_tr_b16 a[0:1], v47 offset:0
    v_mfma_f32_16x16x32_bf16 v[88:91], a[96:99], v[136:139], v[76:79]
    ds_read_b64_tr_b16 a[4:5], v47 offset:12288
    v_mfma_f32_16x16x32_bf16 v[92:95], a[100:103], v[52:55], v[92:95]
    ds_read_b64_tr_b16 a[8:9], v47 offset:24576
    v_mfma_f32_16x16x32_bf16 v[88:91], a[100:103], v[140:143], v[88:91]
    ds_read_b64_tr_b16 a[12:13], v47 offset:36864
    s_waitcnt lgkmcnt(7)
    v_mfma_f32_16x16x32_bf16 v[96:99], a[104:107], a[104:107], v[96:99]
    buffer_load_dwordx4 v[212:215], v65, s[32:35], s61 offen offset:1024 sc1
    ds_read_b64_tr_b16 a[16:17], v48 offset:0
    v_mfma_f32_16x16x32_bf16 v[100:103], a[104:107], a[56:59], v[100:103]
    ds_read_b64_tr_b16 a[20:21], v48 offset:12288
    s_waitcnt lgkmcnt(8)
    v_mfma_f32_16x16x32_bf16 v[96:99], a[108:111], a[108:111], v[96:99]
    ds_read_b64_tr_b16 a[24:25], v48 offset:24576
    v_mfma_f32_16x16x32_bf16 v[100:103], a[108:111], a[60:63], v[100:103]
    ds_read_b64_tr_b16 a[28:29], v48 offset:36864
    v_mfma_f32_16x16x32_bf16 v[92:95], a[104:107], v[52:55], v[92:95]
    buffer_load_dwordx4 v[216:219], v65, s[32:35], s61 offen offset:2048 sc1
    ds_read_b64_tr_b16 a[32:33], v49 offset:0
    v_mfma_f32_16x16x32_bf16 v[88:91], a[104:107], v[144:147], v[88:91]
    ds_read_b64_tr_b16 a[36:37], v49 offset:12288
    v_mfma_f32_16x16x32_bf16 v[92:95], a[108:111], v[52:55], v[92:95]
    ds_read_b64_tr_b16 a[40:41], v49 offset:24576
    v_mfma_f32_16x16x32_bf16 v[88:91], a[108:111], v[148:151], v[88:91]
    ds_read_b64_tr_b16 a[44:45], v49 offset:36864
    s_waitcnt lgkmcnt(13)
    v_mfma_f32_16x16x32_bf16 v[96:99], a[112:115], a[112:115], v[96:99]
    v_mfma_f32_16x16x32_bf16 v[100:103], a[112:115], a[64:67], v[100:103]
    s_waitcnt lgkmcnt(12)
    v_mfma_f32_16x16x32_bf16 v[96:99], a[116:119], a[116:119], v[96:99]
    v_mfma_f32_16x16x32_bf16 v[100:103], a[116:119], a[68:71], v[100:103]
    s_waitcnt vmcnt(11)
    ds_read_b128 a[120:123], v42 offset:6144
    ds_read_b128 a[124:127], v43 offset:6144
    buffer_load_dwordx4 v[220:223], v65, s[32:35], s61 offen offset:3072 sc1
    v_mfma_f32_16x16x32_bf16 v[92:95], a[112:115], v[52:55], v[92:95]
    v_mfma_f32_16x16x32_bf16 v[92:95], a[116:119], v[52:55], v[92:95]
    s_nop 1
    v_fma_f32 v96, v100, 2.0, v96
    v_fma_f32 v97, v101, 2.0, v97
    v_mfma_f32_16x16x32_bf16 v[88:91], a[112:115], v[152:155], v[88:91]
    v_fma_f32 v98, v102, 2.0, v98
    v_fma_f32 v99, v103, 2.0, v99
    v_mfma_f32_16x16x32_bf16 v[88:91], a[116:119], v[156:159], v[88:91]
    v_cndmask_b32 v3, 0, v96, s[44:45]
    v_cndmask_b32 v3, v3, v97, s[46:47]
    v_cndmask_b32 v3, v3, v98, s[48:49]
    v_cndmask_b32 v3, v3, v99, s[50:51]
    s_nop 0
    s_nop 0
    v_mfma_f32_16x16x4_f32 v[120:123], v3, v60, v[56:59]
    s_waitcnt lgkmcnt(1)
    v_mfma_f32_16x16x32_bf16 v[112:115], a[120:123], a[120:123], v[84:87]
    v_mfma_f32_16x16x32_bf16 v[116:119], a[120:123], a[48:51], 0
    s_waitcnt vmcnt(10)
    ds_read_b128 a[128:131], v42 offset:8192
    ds_read_b128 a[132:135], v43 offset:8192
    s_add_u32 s61, s60, 3162112
    buffer_load_dwordx4 v[224:227], v65, s[32:35], s61 offen offset:0 sc1
    s_waitcnt lgkmcnt(2)
    v_mfma_f32_16x16x32_bf16 v[112:115], a[124:127], a[124:127], v[112:115]
    v_fma_f32 v128, -v92, v92, v120
    v_fma_f32 v129, -v93, v93, v121
    v_fma_f32 v130, -v94, v94, v122
    v_mfma_f32_16x16x32_bf16 v[116:119], a[124:127], a[52:55], v[116:119]
    v_fma_f32 v131, -v95, v95, v123
    v_max_f32 v128, v128, v56
    v_max_f32 v129, v129, v56
    v_mfma_f32_16x16x32_bf16 v[108:111], a[120:123], v[52:55], v[80:83]
    v_max_f32 v130, v130, v56
    v_max_f32 v131, v131, v56
    v_mfma_f32_16x16x32_bf16 v[104:107], a[120:123], v[136:139], v[76:79]
    v_rsq_f32 v128, v128
    v_mfma_f32_16x16x32_bf16 v[108:111], a[124:127], v[52:55], v[108:111]
    v_rsq_f32 v129, v129
    v_mfma_f32_16x16x32_bf16 v[104:107], a[124:127], v[140:143], v[104:107]
    v_rsq_f32 v130, v130
    s_waitcnt lgkmcnt(1)
    v_mfma_f32_16x16x32_bf16 v[112:115], a[128:131], a[128:131], v[112:115]
    v_rsq_f32 v131, v131
    v_fma_f32 v88, -v92, v61, v88
    v_mfma_f32_16x16x32_bf16 v[116:119], a[128:131], a[56:59], v[116:119]
    v_fma_f32 v89, -v93, v61, v89
    v_fma_f32 v90, -v94, v61, v90
    v_fma_f32 v91, -v95, v61, v91
    s_waitcnt lgkmcnt(0)
    v_mfma_f32_16x16x32_bf16 v[112:115], a[132:135], a[132:135], v[112:115]
    v_fma_f32 v88, v88, v128, v62
    v_fma_f32 v89, v89, v129, v62
    v_fma_f32 v90, v90, v130, v62
    v_mfma_f32_16x16x32_bf16 v[116:119], a[132:135], a[60:63], v[116:119]
    v_fma_f32 v91, v91, v131, v62
    v_max3_f32 v1, v88, v89, v90
    v_max_f32 v1, v1, v91
    v_mfma_f32_16x16x32_bf16 v[108:111], a[128:131], v[52:55], v[108:111]
    v_cmp_lt_f32 vcc, s52, v1
    s_cbranch_vccnz L_site12
L_back12:
    v_mfma_f32_16x16x32_bf16 v[104:107], a[128:131], v[144:147], v[104:107]
    s_waitcnt vmcnt(9)
    ds_read_b128 a[136:139], v42 offset:10240
    ds_read_b128 a[140:143], v43 offset:10240
    s_barrier
    buffer_load_dwordx4 v[228:231], v65, s[32:35], s61 offen offset:1024 sc1
    s_cmp_eq_u32 s0, 1
    s_cbranch_scc0 L_nolate
    s_add_u32 s56, s60, 3145728
    buffer_load_dwordx4 v[160:163], v65, s[32:35], s56 offen offset:0 sc1
    buffer_load_dwordx4 v[164:167], v65, s[32:35], s56 offen offset:1024 sc1
    buffer_load_dwordx4 v[168:171], v65, s[32:35], s56 offen offset:2048 sc1
    buffer_load_dwordx4 v[172:175], v65, s[32:35], s56 offen offset:3072 sc1
    s_add_u32 s56, s60, 3149824
    buffer_load_dwordx4 v[176:179], v65, s[32:35], s56 offen offset:0 sc1
    buffer_load_dwordx4 v[180:183], v65, s[32:35], s56 offen offset:1024 sc1
    buffer_load_dwordx4 v[184:187], v65, s[32:35], s56 offen offset:2048 sc1
    buffer_load_dwordx4 v[188:191], v65, s[32:35], s56 offen offset:3072 sc1
L_nolate:
    buffer_load_dword v244, v28, s[32:35], s28 offen
    v_mfma_f32_16x16x32_bf16 v[108:111], a[132:135], v[52:55], v[108:111]
    ds_read_b64_tr_b16 a[2:3], v47 offset:6144
    v_exp_f32 v96, v88
    v_mfma_f32_16x16x32_bf16 v[104:107], a[132:135], v[148:151], v[104:107]
    ds_read_b64_tr_b16 a[6:7], v47 offset:18432
    v_exp_f32 v97, v89
    s_waitcnt lgkmcnt(3)
    v_mfma_f32_16x16x32_bf16 v[112:115], a[136:139], a[136:139], v[112:115]
    ds_read_b64_tr_b16 a[10:11], v47 offset:30720
    v_exp_f32 v98, v90
    v_mfma_f32_16x16x32_bf16 v[116:119], a[136:139], a[64:67], v[116:119]
    ds_read_b64_tr_b16 a[14:15], v47 offset:43008
    v_exp_f32 v99, v91
    s_waitcnt lgkmcnt(4)
    v_mfma_f32_16x16x32_bf16 v[112:115], a[140:143], a[140:143], v[112:115]
    ds_read_b64_tr_b16 a[18:19], v48 offset:6144
    v_mul_f32 v88, v96, v128
    v_mul_f32 v89, v97, v129
    v_mfma_f32_16x16x32_bf16 v[116:119], a[140:143], a[68:71], v[116:119]
    ds_read_b64_tr_b16 a[22:23], v48 offset:18432
    v_mul_f32 v90, v98, v130
    v_mul_f32 v91, v99, v131
    v_mfma_f32_16x16x32_bf16 v[108:111], a[136:139], v[52:55], v[108:111]
    ds_read_b64_tr_b16 a[26:27], v48 offset:30720
    v_add_f32 v63, v63, v96
    v_fmac_f32 v64, v88, v92
    v_mfma_f32_16x16x32_bf16 v[108:111], a[140:143], v[52:55], v[108:111]
    ds_read_b64_tr_b16 a[30:31], v48 offset:43008
    v_add_f32 v63, v63, v97
    v_fmac_f32 v64, v89, v93
    v_add_f32 v63, v63, v98
    v_fma_f32 v112, v116, 2.0, v112
    v_fma_f32 v113, v117, 2.0, v113
    v_fma_f32 v114, v118, 2.0, v114
    v_fma_f32 v115, v119, 2.0, v115
    v_cndmask_b32 v4, 0, v112, s[44:45]
    v_cndmask_b32 v4, v4, v113, s[46:47]
    v_cndmask_b32 v4, v4, v114, s[48:49]
    v_cndmask_b32 v4, v4, v115, s[50:51]
    ds_read_b64_tr_b16 a[34:35], v49 offset:6144
    ds_read_b64_tr_b16 a[38:39], v49 offset:18432
    v_mfma_f32_16x16x4_f32 v[124:127], v4, v60, v[56:59]
    ds_read_b64_tr_b16 a[42:43], v49 offset:30720
    ds_read_b64_tr_b16 a[46:47], v49 offset:43008
    v_fmac_f32 v64, v90, v94
    v_add_f32 v63, v63, v99
    v_fmac_f32 v64, v91, v95
    v_add_f32 v68, v68, v88
    v_add_f32 v69, v69, v89
    v_add_f32 v70, v70, v90
    v_add_f32 v71, v71, v91
    v_mfma_f32_16x16x32_bf16 v[104:107], a[136:139], v[152:155], v[104:107]
    v_cvt_pk_bf16_f32 v72, v88, v89
    v_cvt_pk_bf16_f32 v73, v90, v91
    v_mfma_f32_16x16x32_bf16 v[104:107], a[140:143], v[156:159], v[104:107]
    v_fma_f32 v132, -v108, v108, v124
    v_fma_f32 v133, -v109, v109, v125
    v_fma_f32 v134, -v110, v110, v126
    v_fma_f32 v135, -v111, v111, v127
    v_max_f32 v132, v132, v56
    v_max_f32 v133, v133, v56
    v_max_f32 v134, v134, v56
    v_max_f32 v135, v135, v56
    v_rsq_f32 v132, v132
    v_rsq_f32 v133, v133
    v_rsq_f32 v134, v134
    v_rsq_f32 v135, v135
    v_pk_fma_f32 v[104:105], v[108:109], v[60:61], v[104:105] op_sel:[0,1,0] neg_lo:[1,0,0] neg_hi:[1,0,0]
    v_pk_fma_f32 v[106:107], v[110:111], v[60:61], v[106:107] op_sel:[0,1,0] neg_lo:[1,0,0] neg_hi:[1,0,0]
    v_pk_fma_f32 v[104:105], v[104:105], v[132:133], v[62:63] op_sel_hi:[1,1,0]
    v_pk_fma_f32 v[106:107], v[106:107], v[134:135], v[62:63] op_sel_hi:[1,1,0]
L_back13:
    v_max3_f32 v1, v104, v105, v106
    v_max_f32 v1, v1, v107
    v_cmp_lt_f32 vcc, s52, v1
    v_exp_f32 v112, v104
    v_exp_f32 v113, v105
    v_exp_f32 v114, v106
    v_exp_f32 v115, v107
    s_cbranch_vccnz L_site13
    v_pk_mul_f32 v[104:105], v[112:113], v[132:133]
    v_pk_mul_f32 v[106:107], v[114:115], v[134:135]
    v_cvt_pk_bf16_f32 v74, v104, v105
    v_cvt_pk_bf16_f32 v75, v106, v107
    ds_write_b128 v237, v[72:75] offset:0
    v_pk_add_f32 v[68:69], v[68:69], v[104:105]
    v_pk_add_f32 v[70:71], v[70:71], v[106:107]
    v_pk_add_f32 v[112:113], v[112:113], v[114:115]
    v_cvt_pk_bf16_f32 v66, v68, v69
    v_cvt_pk_bf16_f32 v67, v70, v71
    ds_write_b64 v238, v[66:67]
    v_pk_mul_f32 v[114:115], v[104:105], v[108:109]
    v_add_f32 v63, v63, v112
    v_pk_fma_f32 v[114:115], v[106:107], v[110:111], v[114:115]
    v_add_f32 v10, v63, v113
    v_add_f32 v64, v64, v114
    v_add_f32 v11, v64, v115
    ds_write_b64 v238, v[10:11] offset:2048
L_merge:
    s_waitcnt lgkmcnt(0)
    s_barrier
L_postx:
    ds_read_b32 v9, v254 offset:4096
    ds_read_b128 v[92:95], v253 offset:0
    ds_read_b128 v[96:99], v253 offset:1024
    ds_read_b128 v[100:103], v253 offset:2048
    ds_read_b64 v[136:137], v254 offset:2048
    ds_read_b64 v[138:139], v254 offset:2560
    ds_read_b64 v[140:141], v254 offset:3072
    ds_read_b64 v[142:143], v254 offset:3584
    ds_read_b128 v[116:119], v253 offset:3072
    ds_read_b64 v[120:121], v254 offset:0
    ds_read_b64 v[122:123], v254 offset:512
    s_waitcnt lgkmcnt(10)
    v_cmp_ne_u32 vcc, 0, v9
    s_cbranch_vccnz L_xlast
    s_waitcnt lgkmcnt(9)
    v_mfma_f32_16x16x32_bf16 v[16:19], a[0:3], v[92:95], v[16:19]
    ds_read_b64 v[124:125], v254 offset:1024
    v_mfma_f32_16x16x32_bf16 v[20:23], a[16:19], v[92:95], v[20:23]
    ds_read_b64 v[126:127], v254 offset:1536
    v_mfma_f32_16x16x32_bf16 v[24:27], a[32:35], v[92:95], v[24:27]
    s_waitcnt lgkmcnt(10)
    v_mfma_f32_16x16x32_bf16 v[16:19], a[4:7], v[96:99], v[16:19]
    v_mfma_f32_16x16x32_bf16 v[20:23], a[20:23], v[96:99], v[20:23]
    v_mfma_f32_16x16x32_bf16 v[24:27], a[36:39], v[96:99], v[24:27]
    s_waitcnt lgkmcnt(9)
    v_mfma_f32_16x16x32_bf16 v[16:19], a[8:11], v[100:103], v[16:19]
    s_waitcnt lgkmcnt(5)
    v_add_f32 v1, v136, v138
    v_add_f32 v2, v137, v139
    v_add_f32 v140, v140, v142
    v_mfma_f32_16x16x32_bf16 v[20:23], a[24:27], v[100:103], v[20:23]
    v_add_f32 v141, v141, v143
    v_add_f32 v1, v1, v140
    v_add_f32 v2, v2, v141
    v_mfma_f32_16x16x32_bf16 v[24:27], a[40:43], v[100:103], v[24:27]
    s_nop 0
    v_permlane32_swap_b32 v1, v2
    v_add_f32 v1, v1, v2
    v_mov_b32 v2, v1
    s_waitcnt lgkmcnt(4)
    v_mfma_f32_16x16x32_bf16 v[16:19], a[12:15], v[116:119], v[16:19]
    v_permlane16_swap_b32 v1, v2
    v_add_f32 v1, v1, v2
    v_mov_b32 v2, v1
    s_waitcnt lgkmcnt(2)
    v_mfma_f32_16x16x32_bf16 v[16:19], a[72:75], v[120:123], v[16:19]
    v_permlane32_swap_b32 v1, v2
    v_rcp_f32 v3, v1
    s_waitcnt lgkmcnt(0)
    v_mfma_f32_16x16x32_bf16 v[16:19], a[76:79], v[124:127], v[16:19]
    v_log_f32 v4, v1
    v_mul_f32 v5, v60, v3
    v_mfma_f32_16x16x32_bf16 v[20:23], a[28:31], v[116:119], v[20:23]
    v_mul_f32 v6, v2, v3
    v_sub_f32 v4, v4, v255
    v_mfma_f32_16x16x32_bf16 v[20:23], a[80:83], v[120:123], v[20:23]
    v_mfma_f32_16x16x32_bf16 v[20:23], a[84:87], v[124:127], v[20:23]
    v_mfma_f32_16x16x32_bf16 v[24:27], a[44:47], v[116:119], v[24:27]
    v_fma_f32 v16, v16, v5, -v6
    v_fma_f32 v17, v17, v5, -v6
    v_mfma_f32_16x16x32_bf16 v[24:27], a[88:91], v[120:123], v[24:27]
    v_fma_f32 v18, v18, v5, -v6
    v_fma_f32 v19, v19, v5, -v6
    v_mfma_f32_16x16x32_bf16 v[24:27], a[92:95], v[124:127], v[24:27]
    v_cvt_pk_bf16_f32 v66, v16, v17
    v_cvt_pk_bf16_f32 v67, v18, v19
    ds_write_b64 v236, v[66:67] offset:0
    v_pk_fma_f32 v[20:21], v[20:21], v[4:5], v[6:7] op_sel:[0,1,0] op_sel_hi:[1,1,0] neg_lo:[0,0,1] neg_hi:[0,0,1]
    v_pk_fma_f32 v[22:23], v[22:23], v[4:5], v[6:7] op_sel:[0,1,0] op_sel_hi:[1,1,0] neg_lo:[0,0,1] neg_hi:[0,0,1]
    v_cvt_pk_bf16_f32 v68, v20, v21
    v_cvt_pk_bf16_f32 v69, v22, v23
    ds_write_b64 v236, v[68:69] offset:512
    v_pk_fma_f32 v[24:25], v[24:25], v[4:5], v[6:7] op_sel:[0,1,0] op_sel_hi:[1,1,0] neg_lo:[0,0,1] neg_hi:[0,0,1]
    v_pk_fma_f32 v[26:27], v[26:27], v[4:5], v[6:7] op_sel:[0,1,0] op_sel_hi:[1,1,0] neg_lo:[0,0,1] neg_hi:[0,0,1]
    v_cvt_pk_bf16_f32 v70, v24, v25
    v_cvt_pk_bf16_f32 v71, v26, v27
    ds_write_b64 v236, v[70:71] offset:1024
    s_waitcnt lgkmcnt(0)
    s_barrier
    ds_read_b128 v[136:139], v241 offset:0
    ds_read_b128 v[140:143], v241 offset:1024
    ds_read_b128 v[144:147], v241 offset:2048
    ds_read_b128 v[148:151], v241 offset:3072
    ds_read_b128 v[152:155], v241 offset:4096
    ds_read_b128 v[156:159], v241 offset:5120
    s_waitcnt vmcnt(1)
    v_mov_b32 v35, v4
    v_add_u32 v39, s39, v4
    s_waitcnt lgkmcnt(5)
    v_mfma_f32_16x16x32_bf16 v[16:19], v[160:163], v[136:139], 0
    v_mfma_f32_16x16x32_bf16 v[20:23], v[184:187], v[136:139], 0
    v_mfma_f32_16x16x32_bf16 v[24:27], v[208:211], v[136:139], 0
    s_waitcnt lgkmcnt(4)
    v_mfma_f32_16x16x32_bf16 v[16:19], v[164:167], v[140:143], v[16:19]
    v_mfma_f32_16x16x32_bf16 v[20:23], v[188:191], v[140:143], v[20:23]
    v_mfma_f32_16x16x32_bf16 v[24:27], v[212:215], v[140:143], v[24:27]
    s_waitcnt lgkmcnt(3)
    v_mfma_f32_16x16x32_bf16 v[16:19], v[168:171], v[144:147], v[16:19]
    v_mfma_f32_16x16x32_bf16 v[20:23], v[192:195], v[144:147], v[20:23]
    v_mfma_f32_16x16x32_bf16 v[24:27], v[216:219], v[144:147], v[24:27]
    s_waitcnt lgkmcnt(2)
    v_mfma_f32_16x16x32_bf16 v[16:19], v[172:175], v[148:151], v[16:19]
    s_waitcnt lgkmcnt(1)
    v_mfma_f32_16x16x32_bf16 v[16:19], v[176:179], v[152:155], v[16:19]
    s_waitcnt lgkmcnt(0)
    v_mfma_f32_16x16x32_bf16 v[16:19], v[180:183], v[156:159], v[16:19]
    v_mfma_f32_16x16x32_bf16 v[20:23], v[196:199], v[148:151], v[20:23]
    v_mfma_f32_16x16x32_bf16 v[20:23], v[200:203], v[152:155], v[20:23]
    v_mfma_f32_16x16x32_bf16 v[20:23], v[204:207], v[156:159], v[20:23]
    v_mfma_f32_16x16x32_bf16 v[24:27], v[220:223], v[148:151], v[24:27]
    v_mfma_f32_16x16x32_bf16 v[24:27], v[224:227], v[152:155], v[24:27]
    s_nop 2
    v_cvt_pk_bf16_f32 v32, v16, v17
    v_mfma_f32_16x16x32_bf16 v[24:27], v[228:231], v[156:159], v[24:27]
    v_cvt_pk_bf16_f32 v33, v18, v19
    v_cvt_pk_bf16_f32 v34, v20, v21
    v_cvt_pk_bf16_f32 v36, v22, v23
    v_permlane16_swap_b32 v35, v39
    s_nop 0
    v_permlane16_swap_b32 v32, v36
    s_nop 1
    v_cvt_pk_bf16_f32 v37, v24, v25
    v_cvt_pk_bf16_f32 v38, v26, v27
    s_nop 0
    v_permlane16_swap_b32 v33, v37
    v_permlane16_swap_b32 v34, v38
    buffer_store_dwordx4 v[32:35], v242, s[32:35], s28 offen sc1
    buffer_store_dwordx4 v[36:39], v243, s[32:35], s28 offen sc1
    s_cmp_lt_u32 s29, 64
    s_cbranch_scc0 L_fin
    buffer_load_dwordx4 v[76:79], v65, s[32:35], s30 offen offset:0 sc1
    buffer_load_dwordx4 v[80:83], v65, s[32:35], s30 offen offset:1024 sc1
    buffer_load_dwordx4 v[84:87], v65, s[32:35], s30 offen offset:2048 sc1
    buffer_load_dwordx4 v[108:111], v65, s[32:35], s30 offen offset:3072 sc1
    buffer_load_dwordx4 v[112:115], v65, s[32:35], s31 offen offset:0 sc1
    buffer_load_dwordx4 v[128:131], v65, s[32:35], s31 offen offset:1024 sc1
    buffer_load_dwordx4 v[132:135], v65, s[32:35], s31 offen offset:2048 sc1
    buffer_load_dwordx4 v[52:55], v65, s[32:35], s31 offen offset:3072 sc1
    ds_bpermute_b32 v42, v252, v4
    v_bfe_u32 v48, v0, 2, 1
    v_cmp_eq_u32 vcc, 1, v48
    v_mov_b32 v246, s39
    s_movk_i32 s26, 0x101
    v_cndmask_b32 v247, 0, v246, vcc
    v_sub_u32 v246, v246, v247
    v_sub_u32 v246, v246, v247
    v_mov_b32 v16, 0
    v_mov_b32 v17, 0
    v_mov_b32 v18, 0
    v_mov_b32 v19, 0
    v_mov_b32 v20, 0
    v_mov_b32 v21, 0
    v_mov_b32 v22, 0
    v_mov_b32 v97, 0
    s_mov_b32 s53, 0
    v_mov_b32 v160, 0x101
    v_mov_b32 v161, 0x202
    v_mov_b32 v162, 0x404
    v_mov_b32 v163, 0x808
    v_mov_b32 v164, 0x1010
    v_mov_b32 v165, 0x2020
    v_mov_b32 v166, 0x4040
    v_mov_b32 v167, 0x8080
    s_waitcnt vmcnt(0)
    v_sub_u32_dpp v136, v79, v79 row_half_mirror row_mask:0xf bank_mask:0xf
    v_sub_u32_dpp v137, v83, v83 row_half_mirror row_mask:0xf bank_mask:0xf
    v_sub_u32_dpp v138, v87, v87 row_half_mirror row_mask:0xf bank_mask:0xf
    v_sub_u32_dpp v139, v111, v111 row_half_mirror row_mask:0xf bank_mask:0xf
    v_sub_u32_dpp v140, v115, v115 row_half_mirror row_mask:0xf bank_mask:0xf
    v_sub_u32_dpp v141, v131, v131 row_half_mirror row_mask:0xf bank_mask:0xf
    v_sub_u32_dpp v142, v135, v135 row_half_mirror row_mask:0xf bank_mask:0xf
    v_sub_u32_dpp v143, v55, v55 row_half_mirror row_mask:0xf bank_mask:0xf
    v_cmp_eq_u32 s[6:7], v136, v246
    v_cmp_eq_u32 s[8:9], v137, v246
    v_cmp_eq_u32 s[10:11], v138, v246
    v_cmp_eq_u32 s[12:13], v139, v246
    v_cmp_eq_u32 s[14:15], v140, v246
    v_cmp_eq_u32 s[16:17], v141, v246
    v_cmp_eq_u32 s[36:37], v142, v246
    v_cmp_eq_u32 s[40:41], v143, v246
    v_cndmask_b32 v136, v160, 0, s[6:7]
    v_cndmask_b32 v137, v161, 0, s[8:9]
    v_cndmask_b32 v138, v162, 0, s[10:11]
    v_cndmask_b32 v139, v163, 0, s[12:13]
    v_cndmask_b32 v140, v164, 0, s[14:15]
    v_cndmask_b32 v141, v165, 0, s[16:17]
    v_cndmask_b32 v142, v166, 0, s[36:37]
    v_cndmask_b32 v143, v167, 0, s[40:41]
    v_or3_b32 v96, v136, v137, v138
    v_or3_b32 v139, v139, v140, v141
    v_or3_b32 v96, v96, v142, v143
    v_or_b32 v96, v96, v139
    v_cmp_ne_u32 vcc, 0, v96
    v_sub_u32 v168, v79, v247
    v_sub_u32 v169, v83, v247
    v_sub_u32 v170, v87, v247
    v_sub_u32 v171, v111, v247
    s_cbranch_vccz L_c_all
    v_lshrrev_b32 v48, v97, v96
    v_ffbl_b32 v48, v48
    v_add_u32 v48, v48, v97
    v_and_b32 v48, 7, v48
    v_lshl_add_u32 v51, v48, 10, v65
    v_lshlrev_b32 v88, v48, s26
    v_add_u32 v97, 1, v48
    s_mov_b64 exec, vcc
    buffer_load_dwordx4 v[136:139], v51, s[32:35], s30 offen sc1
    s_mov_b64 exec, -1
    v_lshrrev_b32 v48, v97, v96
    v_ffbl_b32 v48, v48
    v_add_u32 v48, v48, v97
    v_and_b32 v48, 7, v48
    v_lshl_add_u32 v51, v48, 10, v65
    v_lshlrev_b32 v89, v48, s26
    v_add_u32 v97, 1, v48
    s_mov_b64 exec, vcc
    buffer_load_dwordx4 v[140:143], v51, s[32:35], s30 offen sc1
    s_mov_b64 exec, -1
    v_lshrrev_b32 v48, v97, v96
    v_ffbl_b32 v48, v48
    v_add_u32 v48, v48, v97
    v_and_b32 v48, 7, v48
    v_lshl_add_u32 v51, v48, 10, v65
    v_lshlrev_b32 v90, v48, s26
    v_add_u32 v97, 1, v48
    s_mov_b64 exec, vcc
    buffer_load_dwordx4 v[144:147], v51, s[32:35], s30 offen sc1
    s_mov_b64 exec, -1
    v_lshrrev_b32 v48, v97, v96
    v_ffbl_b32 v48, v48
    v_add_u32 v48, v48, v97
    v_and_b32 v48, 7, v48
    v_lshl_add_u32 v51, v48, 10, v65
    v_lshlrev_b32 v91, v48, s26
    v_add_u32 v97, 1, v48
    s_mov_b64 exec, vcc
    buffer_load_dwordx4 v[148:151], v51, s[32:35], s30 offen sc1
    s_mov_b64 exec, -1
L_c_all:
    v_sub_u32 v172, v115, v247
    v_sub_u32 v173, v131, v247
    v_sub_u32 v174, v135, v247
    v_sub_u32 v175, v55, v247
    s_waitcnt lgkmcnt(0)
    v_sub_f32 v168, v168, v42
    v_sub_f32 v169, v169, v42
    v_sub_f32 v170, v170, v42
    v_sub_f32 v171, v171, v42
    v_sub_f32 v172, v172, v42
    v_sub_f32 v173, v173, v42
    v_sub_f32 v174, v174, v42
    v_sub_f32 v175, v175, v42
    v_exp_f32 v168, v168
    v_exp_f32 v169, v169
    v_exp_f32 v170, v170
    v_exp_f32 v171, v171
    v_exp_f32 v172, v172
    v_exp_f32 v173, v173
    v_exp_f32 v174, v174
    v_exp_f32 v175, v175
    v_cvt_pk_bf16_f32 v168, v168, 0
    v_cvt_pk_bf16_f32 v169, v169, 0
    v_cvt_pk_bf16_f32 v170, v170, 0
    v_cvt_pk_bf16_f32 v171, v171, 0
    v_cvt_pk_bf16_f32 v172, v172, 0
    v_cvt_pk_bf16_f32 v173, v173, 0
    v_cvt_pk_bf16_f32 v174, v174, 0
    v_cvt_pk_bf16_f32 v175, v175, 0
    v_lshlrev_b32 v176, 16, v168
    v_lshlrev_b32 v177, 16, v169
    v_lshlrev_b32 v178, 16, v170
    v_lshlrev_b32 v179, 16, v171
    v_lshlrev_b32 v180, 16, v172
    v_lshlrev_b32 v181, 16, v173
    v_lshlrev_b32 v182, 16, v174
    v_lshlrev_b32 v183, 16, v175
    s_mov_b64 exec, s[6:7]
    v_dot2c_f32_bf16 v16, v76, v168
    v_dot2c_f32_bf16 v18, v77, v168
    v_dot2c_f32_bf16 v20, v78, v168
    v_add_f32 v22, v22, v176
    v_dot2c_f32_bf16 v17, v76, v176
    v_dot2c_f32_bf16 v19, v77, v176
    v_dot2c_f32_bf16 v21, v78, v176
    s_mov_b64 exec, s[8:9]
    v_dot2c_f32_bf16 v16, v80, v169
    v_dot2c_f32_bf16 v18, v81, v169
    v_dot2c_f32_bf16 v20, v82, v169
    v_add_f32 v22, v22, v177
    v_dot2c_f32_bf16 v17, v80, v177
    v_dot2c_f32_bf16 v19, v81, v177
    v_dot2c_f32_bf16 v21, v82, v177
    s_mov_b64 exec, s[10:11]
    v_dot2c_f32_bf16 v16, v84, v170
    v_dot2c_f32_bf16 v18, v85, v170
    v_dot2c_f32_bf16 v20, v86, v170
    v_add_f32 v22, v22, v178
    v_dot2c_f32_bf16 v17, v84, v178
    v_dot2c_f32_bf16 v19, v85, v178
    v_dot2c_f32_bf16 v21, v86, v178
    s_mov_b64 exec, s[12:13]
    v_dot2c_f32_bf16 v16, v108, v171
    v_dot2c_f32_bf16 v18, v109, v171
    v_dot2c_f32_bf16 v20, v110, v171
    v_add_f32 v22, v22, v179
    v_dot2c_f32_bf16 v17, v108, v179
    v_dot2c_f32_bf16 v19, v109, v179
    v_dot2c_f32_bf16 v21, v110, v179
    s_mov_b64 exec, s[14:15]
    v_dot2c_f32_bf16 v16, v112, v172
    v_dot2c_f32_bf16 v18, v113, v172
    v_dot2c_f32_bf16 v20, v114, v172
    v_add_f32 v22, v22, v180
    v_dot2c_f32_bf16 v17, v112, v180
    v_dot2c_f32_bf16 v19, v113, v180
    v_dot2c_f32_bf16 v21, v114, v180
    s_mov_b64 exec, s[16:17]
    v_dot2c_f32_bf16 v16, v128, v173
    v_dot2c_f32_bf16 v18, v129, v173
    v_dot2c_f32_bf16 v20, v130, v173
    v_add_f32 v22, v22, v181
    v_dot2c_f32_bf16 v17, v128, v181
    v_dot2c_f32_bf16 v19, v129, v181
    v_dot2c_f32_bf16 v21, v130, v181
    s_mov_b64 exec, s[36:37]
    v_dot2c_f32_bf16 v16, v132, v174
    v_dot2c_f32_bf16 v18, v133, v174
    v_dot2c_f32_bf16 v20, v134, v174
    v_add_f32 v22, v22, v182
    v_dot2c_f32_bf16 v17, v132, v182
    v_dot2c_f32_bf16 v19, v133, v182
    v_dot2c_f32_bf16 v21, v134, v182
    s_mov_b64 exec, s[40:41]
    v_dot2c_f32_bf16 v16, v52, v175
    v_dot2c_f32_bf16 v18, v53, v175
    v_dot2c_f32_bf16 v20, v54, v175
    v_add_f32 v22, v22, v183
    v_dot2c_f32_bf16 v17, v52, v183
    v_dot2c_f32_bf16 v19, v53, v183
    v_dot2c_f32_bf16 v21, v54, v183
    s_mov_b64 exec, -1
    s_cbranch_vccz L_c_red
L_c_loop:
    s_waitcnt vmcnt(3)
    v_sub_u32_dpp v48, v139, v139 row_half_mirror row_mask:0xf bank_mask:0xf
    v_and_b32 v49, v88, v96
    v_cmpx_eq_u32 vcc, v48, v246
    v_cmpx_ne_u32 vcc, 0, v49
    v_xor_b32 v96, v96, v88
    v_sub_u32 v49, v139, v247
    v_sub_f32 v49, v49, v42
    v_exp_f32 v49, v49
    s_cbranch_execz L_c_s0
    v_cvt_pk_bf16_f32 v49, v49, 0
    v_lshlrev_b32 v50, 16, v49
    v_dot2c_f32_bf16 v16, v136, v49
    v_dot2c_f32_bf16 v18, v137, v49
    v_dot2c_f32_bf16 v20, v138, v49
    v_add_f32 v22, v22, v50
    v_dot2c_f32_bf16 v17, v136, v50
    v_dot2c_f32_bf16 v19, v137, v50
    v_dot2c_f32_bf16 v21, v138, v50
L_c_s0:
    s_mov_b64 exec, -1
    v_cmp_ne_u32 vcc, 0, v96
    v_lshrrev_b32 v48, v97, v96
    v_ffbl_b32 v48, v48
    s_cbranch_vccz L_c_red
    v_add_u32 v48, v48, v97
    v_and_b32 v48, 7, v48
    v_lshl_add_u32 v51, v48, 10, v65
    v_lshlrev_b32 v88, v48, s26
    v_add_u32 v97, 1, v48
    s_mov_b64 exec, vcc
    buffer_load_dwordx4 v[136:139], v51, s[32:35], s30 offen sc1
    s_mov_b64 exec, -1
    s_waitcnt vmcnt(3)
    v_sub_u32_dpp v48, v143, v143 row_half_mirror row_mask:0xf bank_mask:0xf
    v_and_b32 v49, v89, v96
    v_cmpx_eq_u32 vcc, v48, v246
    v_cmpx_ne_u32 vcc, 0, v49
    v_xor_b32 v96, v96, v89
    v_sub_u32 v49, v143, v247
    v_sub_f32 v49, v49, v42
    v_exp_f32 v49, v49
    s_cbranch_execz L_c_s1
    v_cvt_pk_bf16_f32 v49, v49, 0
    v_lshlrev_b32 v50, 16, v49
    v_dot2c_f32_bf16 v16, v140, v49
    v_dot2c_f32_bf16 v18, v141, v49
    v_dot2c_f32_bf16 v20, v142, v49
    v_add_f32 v22, v22, v50
    v_dot2c_f32_bf16 v17, v140, v50
    v_dot2c_f32_bf16 v19, v141, v50
    v_dot2c_f32_bf16 v21, v142, v50
L_c_s1:
    s_mov_b64 exec, -1
    v_cmp_ne_u32 vcc, 0, v96
    v_lshrrev_b32 v48, v97, v96
    v_ffbl_b32 v48, v48
    s_cbranch_vccz L_c_red
    v_add_u32 v48, v48, v97
    v_and_b32 v48, 7, v48
    v_lshl_add_u32 v51, v48, 10, v65
    v_lshlrev_b32 v89, v48, s26
    v_add_u32 v97, 1, v48
    s_mov_b64 exec, vcc
    buffer_load_dwordx4 v[140:143], v51, s[32:35], s30 offen sc1
    s_mov_b64 exec, -1
    s_waitcnt vmcnt(3)
    v_sub_u32_dpp v48, v147, v147 row_half_mirror row_mask:0xf bank_mask:0xf
    v_and_b32 v49, v90, v96
    v_cmpx_eq_u32 vcc, v48, v246
    v_cmpx_ne_u32 vcc, 0, v49
    v_xor_b32 v96, v96, v90
    v_sub_u32 v49, v147, v247
    v_sub_f32 v49, v49, v42
    v_exp_f32 v49, v49
    s_cbranch_execz L_c_s2
    v_cvt_pk_bf16_f32 v49, v49, 0
    v_lshlrev_b32 v50, 16, v49
    v_dot2c_f32_bf16 v16, v144, v49
    v_dot2c_f32_bf16 v18, v145, v49
    v_dot2c_f32_bf16 v20, v146, v49
    v_add_f32 v22, v22, v50
    v_dot2c_f32_bf16 v17, v144, v50
    v_dot2c_f32_bf16 v19, v145, v50
    v_dot2c_f32_bf16 v21, v146, v50
L_c_s2:
    s_mov_b64 exec, -1
    v_cmp_ne_u32 vcc, 0, v96
    v_lshrrev_b32 v48, v97, v96
    v_ffbl_b32 v48, v48
    s_cbranch_vccz L_c_red
    v_add_u32 v48, v48, v97
    v_and_b32 v48, 7, v48
    v_lshl_add_u32 v51, v48, 10, v65
    v_lshlrev_b32 v90, v48, s26
    v_add_u32 v97, 1, v48
    s_mov_b64 exec, vcc
    buffer_load_dwordx4 v[144:147], v51, s[32:35], s30 offen sc1
    s_mov_b64 exec, -1
    s_waitcnt vmcnt(3)
    v_sub_u32_dpp v48, v151, v151 row_half_mirror row_mask:0xf bank_mask:0xf
    v_and_b32 v49, v91, v96
    v_cmpx_eq_u32 vcc, v48, v246
    v_cmpx_ne_u32 vcc, 0, v49
    v_xor_b32 v96, v96, v91
    v_sub_u32 v49, v151, v247
    v_sub_f32 v49, v49, v42
    v_exp_f32 v49, v49
    s_cbranch_execz L_c_s3
    v_cvt_pk_bf16_f32 v49, v49, 0
    v_lshlrev_b32 v50, 16, v49
    v_dot2c_f32_bf16 v16, v148, v49
    v_dot2c_f32_bf16 v18, v149, v49
    v_dot2c_f32_bf16 v20, v150, v49
    v_add_f32 v22, v22, v50
    v_dot2c_f32_bf16 v17, v148, v50
    v_dot2c_f32_bf16 v19, v149, v50
    v_dot2c_f32_bf16 v21, v150, v50
L_c_s3:
    s_mov_b64 exec, -1
    v_cmp_ne_u32 vcc, 0, v96
    v_lshrrev_b32 v48, v97, v96
    v_ffbl_b32 v48, v48
    s_cbranch_vccz L_c_red
    v_add_u32 v48, v48, v97
    v_and_b32 v48, 7, v48
    v_lshl_add_u32 v51, v48, 10, v65
    v_lshlrev_b32 v91, v48, s26
    v_add_u32 v97, 1, v48
    s_mov_b64 exec, vcc
    buffer_load_dwordx4 v[148:151], v51, s[32:35], s30 offen sc1
    s_mov_b64 exec, -1
    s_add_u32 s53, s53, 1
    s_cmp_lt_u32 s53, 65536
    s_cbranch_scc1 L_c_loop
L_c_red:
    v_mov_b32 v23, v22
    v_permlane32_swap_b32 v16, v20
    v_permlane32_swap_b32 v17, v21
    v_permlane32_swap_b32 v18, v22
    v_permlane32_swap_b32 v19, v23
    v_add_f32 v16, v16, v20
    v_add_f32 v17, v17, v21
    v_add_f32 v18, v18, v22
    v_add_f32 v19, v19, v23
    s_nop 0
    v_permlane16_swap_b32 v16, v18
    v_permlane16_swap_b32 v17, v19
    v_add_f32 v16, v16, v18
    v_add_f32 v17, v17, v19
    s_nop 0
    v_add_f32_dpp v48, v16, v16 row_ror:8 row_mask:0xf bank_mask:0x3
    s_nop 1
    v_add_f32_dpp v48, v17, v17 row_ror:8 row_mask:0xf bank_mask:0xc
    ds_write_b32 v250, v48
    s_waitcnt lgkmcnt(0)
    s_barrier
    ds_read_b128 v[48:51], v251 offset:768
    ds_read_b128 v[52:55], v65
    v_lshlrev_b32 v18, 16, v249
    s_waitcnt lgkmcnt(1)
    v_add_f32 v48, v48, v49
    v_add_f32 v50, v50, v51
    v_add_f32 v48, v48, v50
    v_cmp_nlt_f32 vcc, v48, v232
    v_rcp_f32 v48, v48
    s_waitcnt lgkmcnt(0)
    s_cbranch_vccnz L_c_slow
L_c_out:
    s_cmp_lg_u32 s3, 0
    s_cbranch_scc1 L_fin
    v_add_f32 v52, v52, v53
    v_add_f32 v54, v54, v55
    v_add_f32 v52, v52, v54
    v_fmac_f32 v18, v52, v48
    v_cvt_pk_bf16_f32 v18, v18, v18
    buffer_store_short v18, v248, s[68:71], 0 offen sc1
    s_cmp_lg_u32 s29, 0
    s_cbranch_scc1 L_fin
    v_mov_b32 v48, s39
    v_mov_b32 v49, 0
    s_mov_b64 exec, 1
    buffer_store_dword v48, v49, s[32:35], 0 offen offset:0 sc1
    s_mov_b64 exec, -1
L_fin:
L_end:
    s_endpgm
L_hot:
L_prod:
    s_cmp_lg_u32 s3, 0
    s_cbranch_scc1 L_p_noq
    s_mov_b32 m0, 147456
    s_nop 0
    buffer_load_dwordx4 v16, s[72:75], 0 offen offset:0  lds
    buffer_load_dwordx4 v17, s[72:75], 0 offen offset:1024  lds
    buffer_load_dwordx4 v18, s[72:75], 0 offen offset:2048  lds
    buffer_load_dwordx4 v19, s[72:75], 0 offen offset:3072  lds
    s_mov_b32 m0, 151552
    s_nop 0
    buffer_load_dwordx4 v20, s[72:75], 0 offen offset:0  lds
    buffer_load_dwordx4 v21, s[72:75], 0 offen offset:1024  lds
L_p_noq:
    s_mul_i32 s60, s3, 18432
    s_add_u32 m0, s60, 73728
    s_nop 0
    buffer_load_dwordx4 v16, s[64:67], s60 offen offset:0  lds
    buffer_load_dwordx4 v17, s[64:67], s60 offen offset:1024  lds
    buffer_load_dwordx4 v18, s[64:67], s60 offen offset:2048  lds
    buffer_load_dwordx4 v19, s[64:67], s60 offen offset:3072  lds
    s_add_u32 m0, s60, 77824
    s_nop 0
    buffer_load_dwordx4 v20, s[64:67], s60 offen offset:0  lds
    buffer_load_dwordx4 v21, s[64:67], s60 offen offset:1024  lds
    s_add_u32 s60, s60, 6144
    s_add_u32 m0, s60, 73728
    s_nop 0
    buffer_load_dwordx4 v16, s[64:67], s60 offen offset:0  lds
    buffer_load_dwordx4 v17, s[64:67], s60 offen offset:1024  lds
    buffer_load_dwordx4 v18, s[64:67], s60 offen offset:2048  lds
    buffer_load_dwordx4 v19, s[64:67], s60 offen offset:3072  lds
    s_add_u32 m0, s60, 77824
    s_nop 0
    buffer_load_dwordx4 v20, s[64:67], s60 offen offset:0  lds
    buffer_load_dwordx4 v21, s[64:67], s60 offen offset:1024  lds
    s_add_u32 s60, s60, 6144
    s_add_u32 m0, s60, 73728
    s_nop 0
    buffer_load_dwordx4 v16, s[64:67], s60 offen offset:0  lds
    v_mov_b32 v52, 0x3f803f80
    v_mov_b32 v56, 0x3ebcbe62
    s_mov_b32 s44, 0x100001
    s_mov_b32 s45, 0x10000100
    v_mov_b32 v53, 0x3f803f80
    v_mov_b32 v57, 0x3ebcbe62
    s_mov_b32 s46, 0x200002
    buffer_load_dwordx4 v17, s[64:67], s60 offen offset:1024  lds
    s_mov_b32 s47, 0x20000200
    v_mov_b32 v54, 0x3f803f80
    v_mov_b32 v58, 0x3ebcbe62
    s_mov_b32 s48, 0x400004
    s_mov_b32 s49, 0x40000400
    v_mov_b32 v55, 0x3f803f80
    v_mov_b32 v59, 0x3ebcbe62
    buffer_load_dwordx4 v18, s[64:67], s60 offen offset:2048  lds
    s_mov_b32 s50, 0x800008
    s_mov_b32 s51, 0x80000800
    v_mov_b32 v60, 0x43400000
    v_lshrrev_b32 v1, 5, v0
    v_lshlrev_b32 v1, 8, v1
    v_and_b32 v2, 15, v0
    v_lshl_add_u32 v1, v2, 4, v1
    buffer_load_dwordx4 v19, s[64:67], s60 offen offset:3072  lds
    v_bfe_u32 v2, v0, 4, 1
    v_lshl_add_u32 v1, v2, 3, v1
    s_mul_i32 s56, s3, 1536
    s_add_u32 s56, s56, 153600
    v_add_u32 v134, s56, v1
    v_bfe_u32 v1, v0, 4, 1
    v_lshrrev_b32 v5, 5, v0
    s_add_u32 m0, s60, 77824
    s_nop 0
    buffer_load_dwordx4 v20, s[64:67], s60 offen offset:0  lds
    v_lshl_or_b32 v1, v1, 1, v5
    v_bfe_u32 v2, v0, 2, 2
    v_lshl_add_u32 v3, v1, 3, v2
    v_mul_u32_u24 v3, 384, v3
    v_and_b32 v4, 1, v0
    v_lshl_add_u32 v3, v4, 3, v3
    v_add_u32 v3, 73728, v3
    buffer_load_dwordx4 v21, s[64:67], s60 offen offset:1024  lds
    v_and_or_b32 v2, v2, 2, v5
    v_bfe_u32 v4, v0, 1, 1
    v_xor_b32 v2, v2, v4
    s_mul_i32 s56, s3, 6
    s_add_u32 s57, s56, 0
    v_xor_b32 v4, s57, v2
    v_lshl_add_u32 v124, v4, 4, v3
    s_lshl_b32 s61, s43, 2
    s_add_u32 s61, s61, s3
    s_mul_i32 s60, s61, 6144
    s_add_u32 m0, s41, 6144
    s_nop 0
    buffer_load_dwordx4 v16, s[68:71], s60 offen offset:0  lds
    v_xor_b32 v125, 64, v124
    s_add_u32 s57, s56, 2
    v_xor_b32 v4, s57, v2
    v_lshl_add_u32 v126, v4, 4, v3
    v_xor_b32 v127, 64, v126
    s_add_u32 s57, s56, 4
    v_xor_b32 v4, s57, v2
    buffer_load_dwordx4 v17, s[68:71], s60 offen offset:1024  lds
    v_lshl_add_u32 v128, v4, 4, v3
    v_xor_b32 v129, 64, v128
    v_and_b32 v2, 15, v0
    v_bfe_u32 v3, v0, 3, 1
    v_and_or_b32 v4, v0, 6, v3
    v_xor_b32 v4, v4, v1
    v_mul_u32_u24 v2, 384, v2
    buffer_load_dwordx4 v18, s[68:71], s60 offen offset:2048  lds
    v_lshl_add_u32 v2, v4, 4, v2
    v_add_u32 v132, 147456, v2
    v_xor_b32 v133, 64, v132
    s_and_b32 s56, s3, 1
    s_lshl_b32 s56, s56, 2
    s_lshr_b32 s57, s3, 1
    s_mul_i32 s57, s57, 24576
    buffer_load_dwordx4 v19, s[68:71], s60 offen offset:3072  lds
    s_add_u32 s57, s57, 30720
    v_and_b32 v1, 11, v0
    v_or_b32 v1, s56, v1
    v_and_or_b32 v2, v1, 6, v3
    v_lshrrev_b32 v3, 4, v0
    v_xor_b32 v2, v2, v3
    v_mul_u32_u24 v1, 384, v1
    s_add_u32 m0, s41, 10240
    s_nop 0
    buffer_load_dwordx4 v20, s[68:71], s60 offen offset:0  lds
    v_lshl_add_u32 v1, v2, 4, v1
    v_bfe_u32 v2, v0, 2, 1
    v_mul_u32_u24 v2, 12288, v2
    v_add3_u32 v130, s57, v1, v2
    v_xor_b32 v131, 64, v130
    v_add_u32 v135, 153600, v65
    buffer_load_dwordx4 v21, s[68:71], s60 offen offset:1024  lds
    s_waitcnt vmcnt(24)
    s_barrier
    s_load_dword s38, s[22:23], 0
    ds_read_b128 v[136:139], v132 offset:0
    ds_read_b128 v[140:143], v133 offset:0
    ds_read_b128 v[144:147], v132 offset:128
    ds_read_b128 v[148:151], v133 offset:128
    ds_read_b128 v[152:155], v132 offset:256
    ds_read_b128 v[156:159], v133 offset:256
    s_add_u32 m0, s40, 0
    s_add_u32 s57, s36, 0
    buffer_load_dwordx4 v16, s[28:31], s57 offen offset:0 nt lds
    buffer_load_dwordx4 v17, s[28:31], s57 offen offset:1024 nt lds
    buffer_load_dwordx4 v18, s[28:31], s57 offen offset:2048 nt lds
    buffer_load_dwordx4 v19, s[28:31], s57 offen offset:3072 nt lds
    s_add_u32 m0, s40, 4096
    s_nop 0
    buffer_load_dwordx4 v20, s[28:31], s57 offen offset:0 nt lds
    buffer_load_dwordx4 v21, s[28:31], s57 offen offset:1024 nt lds
    s_waitcnt lgkmcnt(0)
    v_mfma_f32_16x16x32_bf16 v[112:115], v[136:139], v[136:139], 0
    v_mfma_f32_16x16x32_bf16 v[116:119], v[52:55], v[136:139], 0
    s_add_u32 m0, s41, 0
    s_add_u32 s58, s37, 0
    buffer_load_dwordx4 v22, s[24:27], s58 offen offset:0 nt lds
    v_mfma_f32_16x16x32_bf16 v[112:115], v[140:143], v[140:143], v[112:115]
    v_mfma_f32_16x16x32_bf16 v[116:119], v[52:55], v[140:143], v[116:119]
    buffer_load_dwordx4 v23, s[24:27], s58 offen offset:1024 nt lds
    v_mfma_f32_16x16x32_bf16 v[112:115], v[144:147], v[144:147], v[112:115]
    v_mfma_f32_16x16x32_bf16 v[116:119], v[52:55], v[144:147], v[116:119]
    buffer_load_dwordx4 v24, s[24:27], s58 offen offset:2048 nt lds
    v_mfma_f32_16x16x32_bf16 v[112:115], v[148:151], v[148:151], v[112:115]
    v_mfma_f32_16x16x32_bf16 v[116:119], v[52:55], v[148:151], v[116:119]
    v_mfma_f32_16x16x32_bf16 v[112:115], v[152:155], v[152:155], v[112:115]
    v_mfma_f32_16x16x32_bf16 v[116:119], v[52:55], v[152:155], v[116:119]
    v_mfma_f32_16x16x32_bf16 v[112:115], v[156:159], v[156:159], v[112:115]
    v_mfma_f32_16x16x32_bf16 v[116:119], v[52:55], v[156:159], v[116:119]
    s_mul_i32 s39, s38, 0x9e3779b1
    s_add_u32 s39, s39, 0x7f4a7c16
    s_or_b32 s39, s39, 1
    s_lshl_b32 s61, s61, 10
    s_add_u32 s61, s61, 16384
    s_waitcnt vmcnt(15)
    s_barrier
    ds_read_b64_tr_b16 v[160:161], v124 offset:0
    ds_read_b64_tr_b16 v[162:163], v125 offset:1536
    ds_read_b64_tr_b16 v[184:185], v126 offset:0
    ds_read_b64_tr_b16 v[186:187], v127 offset:1536
    ds_read_b64_tr_b16 v[208:209], v128 offset:0
    ds_read_b64_tr_b16 v[210:211], v129 offset:1536
    ds_read_b64_tr_b16 v[164:165], v124 offset:12288
    ds_read_b64_tr_b16 v[166:167], v125 offset:13824
    ds_read_b64_tr_b16 v[188:189], v126 offset:12288
    ds_read_b64_tr_b16 v[190:191], v127 offset:13824
    ds_read_b64_tr_b16 v[212:213], v128 offset:12288
    ds_read_b64_tr_b16 v[214:215], v129 offset:13824
    v_cndmask_b32 v3, 0, v112, s[44:45]
    v_cndmask_b32 v3, v3, v113, s[46:47]
    v_cndmask_b32 v3, v3, v114, s[48:49]
    v_cndmask_b32 v3, v3, v115, s[50:51]
    v_mul_f32 v6, 0x3baaaaab, v116
    ds_read_b64_tr_b16 v[168:169], v124 offset:24576
    ds_read_b64_tr_b16 v[170:171], v125 offset:26112
    v_mfma_f32_16x16x4_f32 v[120:123], v60, v3, v[56:59]
    s_waitcnt lgkmcnt(12)
    v_mfma_f32_16x16x32_bf16 v[88:91], v[160:163], v[136:139], 0
    ds_read_b64_tr_b16 v[192:193], v126 offset:24576
    v_mfma_f32_16x16x32_bf16 v[100:103], v[160:163], v[52:55], 0
    ds_read_b64_tr_b16 v[194:195], v127 offset:26112
    s_waitcnt lgkmcnt(12)
    v_mfma_f32_16x16x32_bf16 v[92:95], v[184:187], v[136:139], 0
    ds_read_b64_tr_b16 v[216:217], v128 offset:24576
    v_mfma_f32_16x16x32_bf16 v[104:107], v[184:187], v[52:55], 0
    ds_read_b64_tr_b16 v[218:219], v129 offset:26112
    s_waitcnt lgkmcnt(12)
    v_mfma_f32_16x16x32_bf16 v[96:99], v[208:211], v[136:139], 0
    ds_read_b64_tr_b16 v[172:173], v124 offset:36864
    v_mfma_f32_16x16x32_bf16 v[108:111], v[208:211], v[52:55], 0
    ds_read_b64_tr_b16 v[174:175], v125 offset:38400
    s_waitcnt lgkmcnt(12)
    v_mfma_f32_16x16x32_bf16 v[88:91], v[164:167], v[140:143], v[88:91]
    ds_read_b64_tr_b16 v[196:197], v126 offset:36864
    v_mfma_f32_16x16x32_bf16 v[100:103], v[164:167], v[52:55], v[100:103]
    ds_read_b64_tr_b16 v[198:199], v127 offset:38400
    s_waitcnt lgkmcnt(12)
    v_mfma_f32_16x16x32_bf16 v[92:95], v[188:191], v[140:143], v[92:95]
    ds_read_b64_tr_b16 v[220:221], v128 offset:36864
    v_mfma_f32_16x16x32_bf16 v[104:107], v[188:191], v[52:55], v[104:107]
    ds_read_b64_tr_b16 v[222:223], v129 offset:38400
    s_waitcnt lgkmcnt(12)
    v_mfma_f32_16x16x32_bf16 v[96:99], v[212:215], v[140:143], v[96:99]
    ds_read_b64_tr_b16 v[176:177], v124 offset:49152
    v_mfma_f32_16x16x32_bf16 v[108:111], v[212:215], v[52:55], v[108:111]
    ds_read_b64_tr_b16 v[178:179], v125 offset:50688
    s_waitcnt lgkmcnt(12)
    v_mfma_f32_16x16x32_bf16 v[88:91], v[168:171], v[144:147], v[88:91]
    ds_read_b64_tr_b16 v[200:201], v126 offset:49152
    v_mfma_f32_16x16x32_bf16 v[100:103], v[168:171], v[52:55], v[100:103]
    ds_read_b64_tr_b16 v[202:203], v127 offset:50688
    s_waitcnt lgkmcnt(12)
    v_mfma_f32_16x16x32_bf16 v[92:95], v[192:195], v[144:147], v[92:95]
    ds_read_b64_tr_b16 v[224:225], v128 offset:49152
    v_mfma_f32_16x16x32_bf16 v[104:107], v[192:195], v[52:55], v[104:107]
    ds_read_b64_tr_b16 v[226:227], v129 offset:50688
    s_waitcnt lgkmcnt(12)
    v_mfma_f32_16x16x32_bf16 v[96:99], v[216:219], v[144:147], v[96:99]
    ds_read_b64_tr_b16 v[180:181], v124 offset:61440
    v_mfma_f32_16x16x32_bf16 v[108:111], v[216:219], v[52:55], v[108:111]
    ds_read_b64_tr_b16 v[182:183], v125 offset:62976
    s_waitcnt lgkmcnt(12)
    v_mfma_f32_16x16x32_bf16 v[88:91], v[172:175], v[148:151], v[88:91]
    ds_read_b64_tr_b16 v[204:205], v126 offset:61440
    v_mfma_f32_16x16x32_bf16 v[100:103], v[172:175], v[52:55], v[100:103]
    ds_read_b64_tr_b16 v[206:207], v127 offset:62976
    s_waitcnt lgkmcnt(12)
    v_mfma_f32_16x16x32_bf16 v[92:95], v[196:199], v[148:151], v[92:95]
    ds_read_b64_tr_b16 v[228:229], v128 offset:61440
    v_mfma_f32_16x16x32_bf16 v[104:107], v[196:199], v[52:55], v[104:107]
    ds_read_b64_tr_b16 v[230:231], v129 offset:62976
    s_waitcnt lgkmcnt(12)
    v_mfma_f32_16x16x32_bf16 v[96:99], v[220:223], v[148:151], v[96:99]
    v_fma_f32 v5, -v116, v116, v120
    v_mfma_f32_16x16x32_bf16 v[108:111], v[220:223], v[52:55], v[108:111]
    v_max_f32 v5, v5, v56
    s_waitcnt lgkmcnt(10)
    v_mfma_f32_16x16x32_bf16 v[88:91], v[176:179], v[152:155], v[88:91]
    v_rsq_f32 v5, v5
    v_mfma_f32_16x16x32_bf16 v[100:103], v[176:179], v[52:55], v[100:103]
    v_mov_b32 v122, s39
    s_waitcnt lgkmcnt(8)
    v_mfma_f32_16x16x32_bf16 v[92:95], v[200:203], v[152:155], v[92:95]
    v_mul_f32 v5, v60, v5
    v_mfma_f32_16x16x32_bf16 v[104:107], v[200:203], v[52:55], v[104:107]
    v_mov_b32 v123, s39
    s_waitcnt lgkmcnt(6)
    v_mfma_f32_16x16x32_bf16 v[96:99], v[224:227], v[152:155], v[96:99]
    v_mfma_f32_16x16x32_bf16 v[108:111], v[224:227], v[52:55], v[108:111]
    s_waitcnt lgkmcnt(4)
    v_mfma_f32_16x16x32_bf16 v[88:91], v[180:183], v[156:159], v[88:91]
    v_mfma_f32_16x16x32_bf16 v[100:103], v[180:183], v[52:55], v[100:103]
    s_waitcnt lgkmcnt(2)
    v_mfma_f32_16x16x32_bf16 v[92:95], v[204:207], v[156:159], v[92:95]
    v_mfma_f32_16x16x32_bf16 v[104:107], v[204:207], v[52:55], v[104:107]
    s_waitcnt lgkmcnt(0)
    v_mfma_f32_16x16x32_bf16 v[96:99], v[228:231], v[156:159], v[96:99]
    v_mfma_f32_16x16x32_bf16 v[108:111], v[228:231], v[52:55], v[108:111]
    s_nop 1
    v_fma_f32 v88, -v6, v100, v88
    v_fma_f32 v89, -v6, v101, v89
    v_fma_f32 v90, -v6, v102, v90
    v_fma_f32 v91, -v6, v103, v91
    v_mul_f32 v88, v88, v5
    v_mul_f32 v89, v89, v5
    v_mul_f32 v90, v90, v5
    v_mul_f32 v91, v91, v5
    v_cvt_pk_bf16_f32 v112, v88, v89
    v_cvt_pk_bf16_f32 v113, v90, v91
    ds_write_b64 v134, v[112:113] offset:0
    v_fma_f32 v92, -v6, v104, v92
    v_fma_f32 v93, -v6, v105, v93
    v_fma_f32 v94, -v6, v106, v94
    v_fma_f32 v95, -v6, v107, v95
    v_mul_f32 v92, v92, v5
    v_mul_f32 v93, v93, v5
    v_mul_f32 v94, v94, v5
    v_mul_f32 v95, v95, v5
    v_cvt_pk_bf16_f32 v114, v92, v93
    v_cvt_pk_bf16_f32 v115, v94, v95
    ds_write_b64 v134, v[114:115] offset:512
    v_fma_f32 v96, -v6, v108, v96
    v_fma_f32 v97, -v6, v109, v97
    v_fma_f32 v98, -v6, v110, v98
    v_fma_f32 v99, -v6, v111, v99
    v_mul_f32 v96, v96, v5
    v_mul_f32 v97, v97, v5
    v_mul_f32 v98, v98, v5
    v_mul_f32 v99, v99, v5
    v_cvt_pk_bf16_f32 v116, v96, v97
    v_cvt_pk_bf16_f32 v117, v98, v99
    ds_write_b64 v134, v[116:117] offset:1024
    s_waitcnt vmcnt(9)
    s_waitcnt lgkmcnt(0)
    s_barrier
    ds_read_b128 v[136:139], v135 offset:0
    ds_read_b128 a[96:99], v130 offset:0
    ds_read_b128 v[140:143], v135 offset:1024
    ds_read_b128 a[100:103], v131 offset:0
    ds_read_b128 v[144:147], v135 offset:2048
    ds_read_b128 a[104:107], v130 offset:128
    ds_read_b128 v[148:151], v135 offset:3072
    ds_read_b128 a[108:111], v131 offset:128
    ds_read_b128 v[152:155], v135 offset:4096
    ds_read_b128 a[112:115], v130 offset:256
    ds_read_b128 v[156:159], v135 offset:5120
    ds_read_b128 a[116:119], v131 offset:256
    s_waitcnt lgkmcnt(10)
    v_mfma_f32_16x16x32_bf16 v[88:91], a[96:99], v[136:139], 0
    s_waitcnt lgkmcnt(8)
    v_mfma_f32_16x16x32_bf16 v[92:95], a[100:103], v[140:143], 0
    s_waitcnt lgkmcnt(6)
    v_mfma_f32_16x16x32_bf16 v[88:91], a[104:107], v[144:147], v[88:91]
    s_waitcnt lgkmcnt(4)
    v_mfma_f32_16x16x32_bf16 v[92:95], a[108:111], v[148:151], v[92:95]
    s_waitcnt lgkmcnt(2)
    v_mfma_f32_16x16x32_bf16 v[88:91], a[112:115], v[152:155], v[88:91]
    s_waitcnt lgkmcnt(0)
    v_mfma_f32_16x16x32_bf16 v[92:95], a[116:119], v[156:159], v[92:95]
    s_nop 7
    v_add_f32 v88, v88, v92
    v_add_f32 v89, v89, v93
    v_add_f32 v90, v90, v94
    v_add_f32 v91, v91, v95
    v_mul_f32 v88, 0x419fecaf, v88
    v_mul_f32 v89, 0x419fecaf, v89
    v_mul_f32 v90, 0x419fecaf, v90
    v_mul_f32 v91, 0x419fecaf, v91
    v_cvt_pk_bf16_f32 v120, v88, v89
    v_cvt_pk_bf16_f32 v121, v90, v91
    buffer_store_dwordx4 v[120:123], v65, s[32:35], s61 offen sc1
    buffer_load_dwordx4 v25, s[24:27], s58 offen offset:3072 nt lds
    s_add_u32 m0, s41, 4096
    s_nop 0
    buffer_load_dwordx4 v26, s[24:27], s58 offen offset:0 nt lds
    buffer_load_dwordx4 v27, s[24:27], s58 offen offset:1024 nt lds
    s_barrier
    buffer_load_dwordx4 v28, s[24:27], s58 offen offset:2048 nt lds
    buffer_load_dwordx4 v29, s[24:27], s58 offen offset:3072 nt lds
    s_add_u32 m0, s41, 8192
    s_nop 0
    buffer_load_dwordx4 v30, s[24:27], s58 offen offset:0 nt lds
    buffer_load_dwordx4 v31, s[24:27], s58 offen offset:1024 nt lds
    buffer_load_dwordx4 v32, s[24:27], s58 offen offset:2048 nt lds
    buffer_load_dwordx4 v33, s[24:27], s58 offen offset:3072 nt lds
    v_and_b32 v1, 15, v0
    v_lshrrev_b32 v6, 5, v0
    v_bfe_u32 v3, v0, 4, 1
    v_lshl_or_b32 v3, v3, 1, v6
    v_lshrrev_b32 v4, 2, v0
    v_bfe_u32 v5, v0, 1, 1
    v_lshrrev_b32 v6, 3, v1
    v_and_or_b32 v6, v1, 6, v6
    v_xor_b32 v6, v6, v3
    v_mul_u32_u24 v7, 384, v1
    v_lshl_add_u32 v6, v6, 4, v7
    v_add_u32 v34, s40, v6
    v_xor_b32 v35, 64, v34
    v_lshrrev_b32 v6, 3, v1
    v_and_b32 v7, 7, v1
    v_lshl_or_b32 v6, v7, 1, v6
    v_xor_b32 v6, v6, v3
    v_mul_u32_u24 v7, 768, v1
    v_lshl_add_u32 v6, v6, 4, v7
    v_add_u32 v40, s41, v6
    v_xor_b32 v41, 0x40, v40
    v_xor_b32 v42, 0x80, v40
    v_xor_b32 v43, 0xc0, v40
    v_and_b32 v2, 1, v0
    v_lshlrev_b32 v2, 3, v2
    s_mul_i32 s56, s3, 96
    v_lshrrev_b32 v6, 3, v4
    v_and_or_b32 v6, v4, 6, v6
    v_xor_b32 v6, v6, v5
    v_lshl_add_u32 v6, v6, 4, v2
    v_mul_u32_u24 v7, 384, v4
    s_add_u32 s57, s56, 0
    v_xad_u32 v36, v6, s57, v7
    s_add_u32 s57, s56, 32
    v_xad_u32 v37, v6, s57, v7
    s_add_u32 s57, s56, 64
    v_xad_u32 v38, v6, s57, v7
    v_lshrrev_b32 v6, 3, v4
    v_and_b32 v3, 7, v4
    v_lshl_or_b32 v6, v3, 1, v6
    v_xor_b32 v6, v6, v5
    v_lshl_add_u32 v6, v6, 4, v2
    v_lshlrev_b32 v7, 1, v7
    v_add_u32 v7, 24576, v7
    s_add_u32 s57, s56, 0
    v_xad_u32 v44, v6, s57, v7
    s_add_u32 s57, s56, 384
    v_xad_u32 v45, v6, s57, v7
    s_add_u32 s57, s56, 32
    v_xad_u32 v46, v6, s57, v7
    s_add_u32 s57, s56, 416
    v_xad_u32 v47, v6, s57, v7
    s_add_u32 s57, s56, 64
    v_xad_u32 v48, v6, s57, v7
    s_add_u32 s57, s56, 448
    v_xad_u32 v49, v6, s57, v7
    v_lshrrev_b32 v1, 5, v0
    v_lshlrev_b32 v1, 8, v1
    v_and_b32 v2, 15, v0
    v_lshl_add_u32 v1, v2, 4, v1
    v_bfe_u32 v2, v0, 4, 1
    v_lshl_add_u32 v1, v2, 3, v1
    s_mul_i32 s56, s3, 1536
    s_add_u32 s56, s56, 147456
    v_add_u32 v236, s56, v1
    s_mul_i32 s56, s3, 3072
    s_add_u32 s56, s56, 24576
    v_add_u32 v237, s56, v65
    v_add_u32 v238, s41, v65
    s_lshl_b32 s56, s3, 10
    v_add_u32 v240, 159744, v65
    v_add_u32 v239, s56, v240
    v_add_u32 v241, 147456, v65
    v_bfe_u32 v1, v0, 2, 2
    v_lshrrev_b32 v2, 4, v0
    v_lshl_or_b32 v1, v1, 4, v2
    v_mul_u32_u24 v1, 32768, v1
    v_and_b32 v2, 3, v0
    v_lshl_or_b32 v242, v2, 4, v1
    v_xor_b32 v243, 0x70, v242
    s_mul_i32 s56, s3, 3
    v_min_u32 v1, 2, v0
    v_add_u32 v1, s56, v1
    v_lshlrev_b32 v245, 7, v1
    v_lshlrev_b32 v1, 3, v0
    v_add_u32 v254, 126976, v1
    s_lshl_b32 s56, s3, 9
    v_add_u32 v238, s56, v254
    v_add_u32 v253, 122880, v65
    s_lshl_b32 s56, s3, 10
    v_add_u32 v237, s56, v253
    s_mov_b32 s52, 0x41c00000
    s_add_u32 m0, s42, 0
    s_add_u32 s59, s37, 196608
    buffer_load_dwordx4 v22, s[24:27], s59 offen offset:0 nt lds
    buffer_load_dwordx4 v23, s[24:27], s59 offen offset:1024 nt lds
    buffer_load_dwordx4 v24, s[24:27], s59 offen offset:2048 nt lds
    buffer_load_dwordx4 v25, s[24:27], s59 offen offset:3072 nt lds
    s_add_u32 m0, s42, 4096
    s_nop 0
    buffer_load_dwordx4 v26, s[24:27], s59 offen offset:0 nt lds
    buffer_load_dwordx4 v27, s[24:27], s59 offen offset:1024 nt lds
    buffer_load_dwordx4 v28, s[24:27], s59 offen offset:2048 nt lds
    buffer_load_dwordx4 v29, s[24:27], s59 offen offset:3072 nt lds
    s_add_u32 m0, s42, 8192
    s_nop 0
    buffer_load_dwordx4 v30, s[24:27], s59 offen offset:0 nt lds
    buffer_load_dwordx4 v31, s[24:27], s59 offen offset:1024 nt lds
    buffer_load_dwordx4 v32, s[24:27], s59 offen offset:2048 nt lds
    buffer_load_dwordx4 v33, s[24:27], s59 offen offset:3072 nt lds
    s_mov_b32 s43, -1
    s_branch L_join
L_vprod:
    s_mul_i32 s60, s3, 18432
    s_add_u32 m0, s60, 73728
    s_nop 0
    buffer_load_dwordx4 v16, s[64:67], s60 offen offset:0  lds
    buffer_load_dwordx4 v17, s[64:67], s60 offen offset:1024  lds
    buffer_load_dwordx4 v18, s[64:67], s60 offen offset:2048  lds
    buffer_load_dwordx4 v19, s[64:67], s60 offen offset:3072  lds
    s_add_u32 m0, s60, 77824
    s_nop 0
    buffer_load_dwordx4 v20, s[64:67], s60 offen offset:0  lds
    buffer_load_dwordx4 v21, s[64:67], s60 offen offset:1024  lds
    s_add_u32 s60, s60, 6144
    s_add_u32 m0, s60, 73728
    s_nop 0
    buffer_load_dwordx4 v16, s[64:67], s60 offen offset:0  lds
    buffer_load_dwordx4 v17, s[64:67], s60 offen offset:1024  lds
    buffer_load_dwordx4 v18, s[64:67], s60 offen offset:2048  lds
    buffer_load_dwordx4 v19, s[64:67], s60 offen offset:3072  lds
    s_add_u32 m0, s60, 77824
    s_nop 0
    buffer_load_dwordx4 v20, s[64:67], s60 offen offset:0  lds
    buffer_load_dwordx4 v21, s[64:67], s60 offen offset:1024  lds
    s_add_u32 s60, s60, 6144
    s_add_u32 m0, s60, 73728
    s_nop 0
    buffer_load_dwordx4 v16, s[64:67], s60 offen offset:0  lds
    v_lshrrev_b32 v1, 4, v0
    v_and_b32 v5, 1, v1
    v_bfe_u32 v2, v0, 2, 2
    v_lshl_add_u32 v3, v1, 3, v2
    buffer_load_dwordx4 v17, s[64:67], s60 offen offset:1024  lds
    v_mul_u32_u24 v3, 384, v3
    v_and_b32 v4, 1, v0
    v_lshl_add_u32 v3, v4, 3, v3
    v_add_u32 v3, 73728, v3
    buffer_load_dwordx4 v18, s[64:67], s60 offen offset:2048  lds
    v_and_or_b32 v2, v2, 2, v5
    v_bfe_u32 v4, v0, 1, 1
    v_xor_b32 v2, v2, v4
    s_mul_i32 s56, s3, 6
    buffer_load_dwordx4 v19, s[64:67], s60 offen offset:3072  lds
    s_add_u32 s57, s56, 0
    v_xor_b32 v4, s57, v2
    v_lshl_add_u32 v136, v4, 4, v3
    v_xor_b32 v137, 64, v136
    s_add_u32 m0, s60, 77824
    s_nop 0
    buffer_load_dwordx4 v20, s[64:67], s60 offen offset:0  lds
    s_add_u32 s57, s56, 2
    v_xor_b32 v4, s57, v2
    v_lshl_add_u32 v138, v4, 4, v3
    v_xor_b32 v139, 64, v138
    buffer_load_dwordx4 v21, s[64:67], s60 offen offset:1024  lds
    s_add_u32 s57, s56, 4
    v_xor_b32 v4, s57, v2
    v_lshl_add_u32 v140, v4, 4, v3
    v_xor_b32 v141, 64, v140
    s_lshl_b32 s61, s43, 2
    s_add_u32 s61, s61, s3
    s_mul_i32 s60, s61, 6144
    s_add_u32 m0, s41, 6144
    s_nop 0
    buffer_load_dwordx4 v16, s[68:71], s60 offen offset:0  lds
    v_bfe_u32 v1, v0, 2, 1
    v_and_b32 v2, 3, v0
    v_lshl_or_b32 v2, v1, 3, v2
    v_and_or_b32 v1, v0, 2, v1
    buffer_load_dwordx4 v17, s[68:71], s60 offen offset:1024  lds
    v_lshrrev_b32 v3, 4, v0
    v_xor_b32 v1, v1, v3
    v_mul_u32_u24 v2, 384, v2
    v_lshl_add_u32 v1, v1, 4, v2
    buffer_load_dwordx4 v18, s[68:71], s60 offen offset:2048  lds
    v_bfe_u32 v2, v0, 3, 1
    v_mul_u32_u24 v2, 12288, v2
    s_mov_b32 s56, 30720
    v_add3_u32 v142, s56, v1, v2
    buffer_load_dwordx4 v19, s[68:71], s60 offen offset:3072  lds
    v_xor_b32 v143, 64, v142
    s_add_u32 m0, s41, 10240
    s_nop 0
    buffer_load_dwordx4 v20, s[68:71], s60 offen offset:0  lds
    buffer_load_dwordx4 v21, s[68:71], s60 offen offset:1024  lds
    s_load_dword s38, s[22:23], 0
    s_barrier
    s_add_u32 m0, s40, 0
    s_add_u32 s57, s36, 0
    buffer_load_dwordx4 v16, s[28:31], s57 offen offset:0 nt lds
    buffer_load_dwordx4 v17, s[28:31], s57 offen offset:1024 nt lds
    buffer_load_dwordx4 v18, s[28:31], s57 offen offset:2048 nt lds
    buffer_load_dwordx4 v19, s[28:31], s57 offen offset:3072 nt lds
    s_add_u32 m0, s40, 4096
    s_nop 0
    buffer_load_dwordx4 v20, s[28:31], s57 offen offset:0 nt lds
    buffer_load_dwordx4 v21, s[28:31], s57 offen offset:1024 nt lds
    s_add_u32 m0, s41, 0
    s_add_u32 s58, s37, 0
    buffer_load_dwordx4 v22, s[24:27], s58 offen offset:0 nt lds
    buffer_load_dwordx4 v23, s[24:27], s58 offen offset:1024 nt lds
    buffer_load_dwordx4 v24, s[24:27], s58 offen offset:2048 nt lds
    s_waitcnt vmcnt(9)
    s_barrier
    ds_read_b128 a[96:99], v142 offset:0
    ds_read_b128 a[100:103], v143 offset:0
    ds_read_b128 a[104:107], v142 offset:128
    ds_read_b128 a[108:111], v143 offset:128
    ds_read_b128 a[112:115], v142 offset:256
    ds_read_b128 a[116:119], v143 offset:256
    ds_read_b128 a[120:123], v143 offset:1536
    ds_read_b128 a[124:127], v142 offset:1536
    ds_read_b128 a[128:131], v143 offset:1664
    ds_read_b128 a[132:135], v142 offset:1664
    ds_read_b128 a[136:139], v143 offset:1792
    ds_read_b128 a[140:143], v142 offset:1792
    ds_read_b128 a[144:147], v142 offset:24576
    ds_read_b128 a[148:151], v143 offset:24576
    ds_read_b128 a[152:155], v142 offset:24704
    ds_read_b128 a[156:159], v143 offset:24704
    ds_read_b128 a[160:163], v142 offset:24832
    ds_read_b128 a[164:167], v143 offset:24832
    ds_read_b128 a[168:171], v143 offset:26112
    ds_read_b128 a[172:175], v142 offset:26112
    ds_read_b128 a[176:179], v143 offset:26240
    ds_read_b128 a[180:183], v142 offset:26240
    ds_read_b128 a[184:187], v143 offset:26368
    ds_read_b128 a[188:191], v142 offset:26368
    ds_read_b64_tr_b16 v[160:161], v136 offset:0
    ds_read_b64_tr_b16 v[162:163], v137 offset:1536
    ds_read_b64_tr_b16 v[164:165], v136 offset:12288
    ds_read_b64_tr_b16 v[166:167], v137 offset:13824
    ds_read_b64_tr_b16 v[168:169], v136 offset:24576
    ds_read_b64_tr_b16 v[170:171], v137 offset:26112
    ds_read_b64_tr_b16 v[172:173], v136 offset:36864
    ds_read_b64_tr_b16 v[174:175], v137 offset:38400
    ds_read_b64_tr_b16 v[176:177], v136 offset:49152
    ds_read_b64_tr_b16 v[178:179], v137 offset:50688
    ds_read_b64_tr_b16 v[180:181], v136 offset:61440
    ds_read_b64_tr_b16 v[182:183], v137 offset:62976
    ds_read_b64_tr_b16 v[184:185], v138 offset:0
    ds_read_b64_tr_b16 v[186:187], v139 offset:1536
    ds_read_b64_tr_b16 v[188:189], v138 offset:12288
    ds_read_b64_tr_b16 v[190:191], v139 offset:13824
    ds_read_b64_tr_b16 v[192:193], v138 offset:24576
    ds_read_b64_tr_b16 v[194:195], v139 offset:26112
    ds_read_b64_tr_b16 v[196:197], v138 offset:36864
    ds_read_b64_tr_b16 v[198:199], v139 offset:38400
    ds_read_b64_tr_b16 v[200:201], v138 offset:49152
    ds_read_b64_tr_b16 v[202:203], v139 offset:50688
    ds_read_b64_tr_b16 v[204:205], v138 offset:61440
    ds_read_b64_tr_b16 v[206:207], v139 offset:62976
    ds_read_b64_tr_b16 v[208:209], v140 offset:0
    ds_read_b64_tr_b16 v[210:211], v141 offset:1536
    ds_read_b64_tr_b16 v[212:213], v140 offset:12288
    ds_read_b64_tr_b16 v[214:215], v141 offset:13824
    ds_read_b64_tr_b16 v[216:217], v140 offset:24576
    ds_read_b64_tr_b16 v[218:219], v141 offset:26112
    ds_read_b64_tr_b16 v[220:221], v140 offset:36864
    ds_read_b64_tr_b16 v[222:223], v141 offset:38400
    ds_read_b64_tr_b16 v[224:225], v140 offset:49152
    ds_read_b64_tr_b16 v[226:227], v141 offset:50688
    ds_read_b64_tr_b16 v[228:229], v140 offset:61440
    ds_read_b64_tr_b16 v[230:231], v141 offset:62976
    s_waitcnt lgkmcnt(0)
    s_barrier
    s_mul_i32 s60, s3, 18432
    s_lshl_b32 s61, s43, 11
    s_add_u32 s60, s60, s61
    s_add_u32 s60, s60, 3145728
    v_mfma_f32_16x16x32_bf16 v[88:91], a[96:99], v[160:163], 0
    v_mfma_f32_16x16x32_bf16 v[92:95], a[120:123], v[160:163], 0
    v_mfma_f32_16x16x32_bf16 v[96:99], a[144:147], v[160:163], 0
    v_mfma_f32_16x16x32_bf16 v[100:103], a[168:171], v[160:163], 0
    buffer_load_dwordx4 v25, s[24:27], s58 offen offset:3072 nt lds
    v_mfma_f32_16x16x32_bf16 v[88:91], a[100:103], v[164:167], v[88:91]
    v_mfma_f32_16x16x32_bf16 v[92:95], a[124:127], v[164:167], v[92:95]
    v_mfma_f32_16x16x32_bf16 v[96:99], a[148:151], v[164:167], v[96:99]
    v_mfma_f32_16x16x32_bf16 v[100:103], a[172:175], v[164:167], v[100:103]
    s_add_u32 m0, s41, 4096
    s_nop 0
    buffer_load_dwordx4 v26, s[24:27], s58 offen offset:0 nt lds
    v_mfma_f32_16x16x32_bf16 v[88:91], a[104:107], v[168:171], v[88:91]
    v_mfma_f32_16x16x32_bf16 v[92:95], a[128:131], v[168:171], v[92:95]
    v_mfma_f32_16x16x32_bf16 v[96:99], a[152:155], v[168:171], v[96:99]
    v_mfma_f32_16x16x32_bf16 v[100:103], a[176:179], v[168:171], v[100:103]
    buffer_load_dwordx4 v27, s[24:27], s58 offen offset:1024 nt lds
    v_mfma_f32_16x16x32_bf16 v[88:91], a[108:111], v[172:175], v[88:91]
    v_mfma_f32_16x16x32_bf16 v[92:95], a[132:135], v[172:175], v[92:95]
    v_mfma_f32_16x16x32_bf16 v[96:99], a[156:159], v[172:175], v[96:99]
    v_mfma_f32_16x16x32_bf16 v[100:103], a[180:183], v[172:175], v[100:103]
    buffer_load_dwordx4 v28, s[24:27], s58 offen offset:2048 nt lds
    v_mfma_f32_16x16x32_bf16 v[88:91], a[112:115], v[176:179], v[88:91]
    v_mfma_f32_16x16x32_bf16 v[92:95], a[136:139], v[176:179], v[92:95]
    v_mfma_f32_16x16x32_bf16 v[96:99], a[160:163], v[176:179], v[96:99]
    v_mfma_f32_16x16x32_bf16 v[100:103], a[184:187], v[176:179], v[100:103]
    buffer_load_dwordx4 v29, s[24:27], s58 offen offset:3072 nt lds
    v_mfma_f32_16x16x32_bf16 v[88:91], a[116:119], v[180:183], v[88:91]
    v_mfma_f32_16x16x32_bf16 v[92:95], a[140:143], v[180:183], v[92:95]
    v_mfma_f32_16x16x32_bf16 v[96:99], a[164:167], v[180:183], v[96:99]
    v_mfma_f32_16x16x32_bf16 v[100:103], a[188:191], v[180:183], v[100:103]
    v_mfma_f32_16x16x32_bf16 v[104:107], a[96:99], v[184:187], 0
    v_mfma_f32_16x16x32_bf16 v[108:111], a[120:123], v[184:187], 0
    v_mfma_f32_16x16x32_bf16 v[112:115], a[144:147], v[184:187], 0
    v_mfma_f32_16x16x32_bf16 v[116:119], a[168:171], v[184:187], 0
    s_add_u32 m0, s41, 8192
    s_nop 0
    buffer_load_dwordx4 v30, s[24:27], s58 offen offset:0 nt lds
    v_mfma_f32_16x16x32_bf16 v[104:107], a[100:103], v[188:191], v[104:107]
    v_mfma_f32_16x16x32_bf16 v[108:111], a[124:127], v[188:191], v[108:111]
    v_mfma_f32_16x16x32_bf16 v[112:115], a[148:151], v[188:191], v[112:115]
    v_mfma_f32_16x16x32_bf16 v[116:119], a[172:175], v[188:191], v[116:119]
    buffer_load_dwordx4 v31, s[24:27], s58 offen offset:1024 nt lds
    v_mfma_f32_16x16x32_bf16 v[104:107], a[104:107], v[192:195], v[104:107]
    v_mfma_f32_16x16x32_bf16 v[108:111], a[128:131], v[192:195], v[108:111]
    v_mfma_f32_16x16x32_bf16 v[112:115], a[152:155], v[192:195], v[112:115]
    v_mfma_f32_16x16x32_bf16 v[116:119], a[176:179], v[192:195], v[116:119]
    buffer_load_dwordx4 v32, s[24:27], s58 offen offset:2048 nt lds
    v_cvt_pk_bf16_f32 v144, v88, v89
    v_cvt_pk_bf16_f32 v145, v90, v91
    v_cvt_pk_bf16_f32 v146, v92, v93
    v_cvt_pk_bf16_f32 v147, v94, v95
    buffer_store_dwordx4 v[144:147], v65, s[32:35], s60 offen offset:0 sc1
    v_cvt_pk_bf16_f32 v148, v96, v97
    v_cvt_pk_bf16_f32 v149, v98, v99
    v_cvt_pk_bf16_f32 v150, v100, v101
    v_cvt_pk_bf16_f32 v151, v102, v103
    buffer_store_dwordx4 v[148:151], v65, s[32:35], s60 offen offset:1024 sc1
    s_add_u32 s60, s60, 6144
    v_mfma_f32_16x16x32_bf16 v[104:107], a[108:111], v[196:199], v[104:107]
    v_mfma_f32_16x16x32_bf16 v[108:111], a[132:135], v[196:199], v[108:111]
    v_mfma_f32_16x16x32_bf16 v[112:115], a[156:159], v[196:199], v[112:115]
    v_mfma_f32_16x16x32_bf16 v[116:119], a[180:183], v[196:199], v[116:119]
    buffer_load_dwordx4 v33, s[24:27], s58 offen offset:3072 nt lds
    v_mfma_f32_16x16x32_bf16 v[104:107], a[112:115], v[200:203], v[104:107]
    v_mfma_f32_16x16x32_bf16 v[108:111], a[136:139], v[200:203], v[108:111]
    v_mfma_f32_16x16x32_bf16 v[112:115], a[160:163], v[200:203], v[112:115]
    v_mfma_f32_16x16x32_bf16 v[116:119], a[184:187], v[200:203], v[116:119]
    s_add_u32 m0, s42, 0
    s_add_u32 s59, s37, 196608
    buffer_load_dwordx4 v22, s[24:27], s59 offen offset:0 nt lds
    v_mfma_f32_16x16x32_bf16 v[104:107], a[116:119], v[204:207], v[104:107]
    v_mfma_f32_16x16x32_bf16 v[108:111], a[140:143], v[204:207], v[108:111]
    v_mfma_f32_16x16x32_bf16 v[112:115], a[164:167], v[204:207], v[112:115]
    v_mfma_f32_16x16x32_bf16 v[116:119], a[188:191], v[204:207], v[116:119]
    v_mfma_f32_16x16x32_bf16 v[120:123], a[96:99], v[208:211], 0
    v_mfma_f32_16x16x32_bf16 v[124:127], a[120:123], v[208:211], 0
    v_mfma_f32_16x16x32_bf16 v[128:131], a[144:147], v[208:211], 0
    v_mfma_f32_16x16x32_bf16 v[132:135], a[168:171], v[208:211], 0
    buffer_load_dwordx4 v23, s[24:27], s59 offen offset:1024 nt lds
    v_mfma_f32_16x16x32_bf16 v[120:123], a[100:103], v[212:215], v[120:123]
    v_mfma_f32_16x16x32_bf16 v[124:127], a[124:127], v[212:215], v[124:127]
    v_mfma_f32_16x16x32_bf16 v[128:131], a[148:151], v[212:215], v[128:131]
    v_mfma_f32_16x16x32_bf16 v[132:135], a[172:175], v[212:215], v[132:135]
    buffer_load_dwordx4 v24, s[24:27], s59 offen offset:2048 nt lds
    v_mfma_f32_16x16x32_bf16 v[120:123], a[104:107], v[216:219], v[120:123]
    v_mfma_f32_16x16x32_bf16 v[124:127], a[128:131], v[216:219], v[124:127]
    v_mfma_f32_16x16x32_bf16 v[128:131], a[152:155], v[216:219], v[128:131]
    v_mfma_f32_16x16x32_bf16 v[132:135], a[176:179], v[216:219], v[132:135]
    buffer_load_dwordx4 v25, s[24:27], s59 offen offset:3072 nt lds
    v_cvt_pk_bf16_f32 v152, v104, v105
    v_cvt_pk_bf16_f32 v153, v106, v107
    v_cvt_pk_bf16_f32 v154, v108, v109
    v_cvt_pk_bf16_f32 v155, v110, v111
    buffer_store_dwordx4 v[152:155], v65, s[32:35], s60 offen offset:0 sc1
    v_cvt_pk_bf16_f32 v156, v112, v113
    v_cvt_pk_bf16_f32 v157, v114, v115
    v_cvt_pk_bf16_f32 v158, v116, v117
    v_cvt_pk_bf16_f32 v159, v118, v119
    buffer_store_dwordx4 v[156:159], v65, s[32:35], s60 offen offset:1024 sc1
    s_add_u32 s60, s60, 6144
    v_mfma_f32_16x16x32_bf16 v[120:123], a[108:111], v[220:223], v[120:123]
    v_mfma_f32_16x16x32_bf16 v[124:127], a[132:135], v[220:223], v[124:127]
    v_mfma_f32_16x16x32_bf16 v[128:131], a[156:159], v[220:223], v[128:131]
    v_mfma_f32_16x16x32_bf16 v[132:135], a[180:183], v[220:223], v[132:135]
    s_add_u32 m0, s42, 4096
    s_nop 0
    buffer_load_dwordx4 v26, s[24:27], s59 offen offset:0 nt lds
    v_mfma_f32_16x16x32_bf16 v[120:123], a[112:115], v[224:227], v[120:123]
    v_mfma_f32_16x16x32_bf16 v[124:127], a[136:139], v[224:227], v[124:127]
    v_mfma_f32_16x16x32_bf16 v[128:131], a[160:163], v[224:227], v[128:131]
    v_mfma_f32_16x16x32_bf16 v[132:135], a[184:187], v[224:227], v[132:135]
    buffer_load_dwordx4 v27, s[24:27], s59 offen offset:1024 nt lds
    v_mfma_f32_16x16x32_bf16 v[120:123], a[116:119], v[228:231], v[120:123]
    v_mfma_f32_16x16x32_bf16 v[124:127], a[140:143], v[228:231], v[124:127]
    v_mfma_f32_16x16x32_bf16 v[128:131], a[164:167], v[228:231], v[128:131]
    v_mfma_f32_16x16x32_bf16 v[132:135], a[188:191], v[228:231], v[132:135]
    s_nop 4
    v_cvt_pk_bf16_f32 v144, v120, v121
    v_cvt_pk_bf16_f32 v145, v122, v123
    v_cvt_pk_bf16_f32 v146, v124, v125
    v_cvt_pk_bf16_f32 v147, v126, v127
    buffer_store_dwordx4 v[144:147], v65, s[32:35], s60 offen offset:0 sc1
    v_cvt_pk_bf16_f32 v148, v128, v129
    v_cvt_pk_bf16_f32 v149, v130, v131
    v_cvt_pk_bf16_f32 v150, v132, v133
    v_cvt_pk_bf16_f32 v151, v134, v135
    buffer_store_dwordx4 v[148:151], v65, s[32:35], s60 offen offset:1024 sc1
    v_and_b32 v1, 15, v0
    v_lshrrev_b32 v6, 5, v0
    v_bfe_u32 v3, v0, 4, 1
    v_lshl_or_b32 v3, v3, 1, v6
    v_lshrrev_b32 v4, 2, v0
    v_bfe_u32 v5, v0, 1, 1
    v_lshrrev_b32 v6, 3, v1
    v_and_or_b32 v6, v1, 6, v6
    v_xor_b32 v6, v6, v3
    v_mul_u32_u24 v7, 384, v1
    v_lshl_add_u32 v6, v6, 4, v7
    v_add_u32 v34, s40, v6
    v_xor_b32 v35, 64, v34
    v_lshrrev_b32 v6, 3, v1
    v_and_b32 v7, 7, v1
    v_lshl_or_b32 v6, v7, 1, v6
    v_xor_b32 v6, v6, v3
    v_mul_u32_u24 v7, 768, v1
    v_lshl_add_u32 v6, v6, 4, v7
    v_add_u32 v40, s41, v6
    v_xor_b32 v41, 0x40, v40
    v_xor_b32 v42, 0x80, v40
    v_xor_b32 v43, 0xc0, v40
    v_and_b32 v2, 1, v0
    v_lshlrev_b32 v2, 3, v2
    s_mul_i32 s56, s3, 96
    v_lshrrev_b32 v6, 3, v4
    v_and_or_b32 v6, v4, 6, v6
    v_xor_b32 v6, v6, v5
    v_lshl_add_u32 v6, v6, 4, v2
    v_mul_u32_u24 v7, 384, v4
    s_add_u32 s57, s56, 0
    v_xad_u32 v36, v6, s57, v7
    s_add_u32 s57, s56, 32
    v_xad_u32 v37, v6, s57, v7
    s_add_u32 s57, s56, 64
    v_xad_u32 v38, v6, s57, v7
    v_lshrrev_b32 v6, 3, v4
    v_and_b32 v3, 7, v4
    v_lshl_or_b32 v6, v3, 1, v6
    v_xor_b32 v6, v6, v5
    v_lshl_add_u32 v6, v6, 4, v2
    v_lshlrev_b32 v7, 1, v7
    v_add_u32 v7, 24576, v7
    s_add_u32 s57, s56, 0
    v_xad_u32 v44, v6, s57, v7
    s_add_u32 s57, s56, 384
    v_xad_u32 v45, v6, s57, v7
    s_add_u32 s57, s56, 32
    v_xad_u32 v46, v6, s57, v7
    s_add_u32 s57, s56, 416
    v_xad_u32 v47, v6, s57, v7
    s_add_u32 s57, s56, 64
    v_xad_u32 v48, v6, s57, v7
    s_add_u32 s57, s56, 448
    v_xad_u32 v49, v6, s57, v7
    v_mov_b32 v52, 0x3f803f80
    v_mov_b32 v56, 0x3ebcbe62
    s_mov_b32 s44, 0x100001
    s_mov_b32 s45, 0x10000100
    v_mov_b32 v53, 0x3f803f80
    v_mov_b32 v57, 0x3ebcbe62
    s_mov_b32 s46, 0x200002
    s_mov_b32 s47, 0x20000200
    v_mov_b32 v54, 0x3f803f80
    v_mov_b32 v58, 0x3ebcbe62
    s_mov_b32 s48, 0x400004
    s_mov_b32 s49, 0x40000400
    v_mov_b32 v55, 0x3f803f80
    v_mov_b32 v59, 0x3ebcbe62
    s_mov_b32 s50, 0x800008
    s_mov_b32 s51, 0x80000800
    v_mov_b32 v60, 0x43400000
    v_lshrrev_b32 v1, 5, v0
    v_lshlrev_b32 v1, 8, v1
    v_and_b32 v2, 15, v0
    v_lshl_add_u32 v1, v2, 4, v1
    v_bfe_u32 v2, v0, 4, 1
    v_lshl_add_u32 v1, v2, 3, v1
    s_mul_i32 s56, s3, 1536
    s_add_u32 s56, s56, 147456
    v_add_u32 v236, s56, v1
    s_mul_i32 s56, s3, 3072
    s_add_u32 s56, s56, 24576
    v_add_u32 v237, s56, v65
    v_add_u32 v238, s41, v65
    s_lshl_b32 s56, s3, 10
    v_add_u32 v240, 159744, v65
    v_add_u32 v239, s56, v240
    v_add_u32 v241, 147456, v65
    v_bfe_u32 v1, v0, 2, 2
    v_lshrrev_b32 v2, 4, v0
    v_lshl_or_b32 v1, v1, 4, v2
    v_mul_u32_u24 v1, 32768, v1
    v_and_b32 v2, 3, v0
    v_lshl_or_b32 v242, v2, 4, v1
    v_xor_b32 v243, 0x70, v242
    s_mul_i32 s56, s3, 3
    v_min_u32 v1, 2, v0
    v_add_u32 v1, s56, v1
    v_lshlrev_b32 v245, 7, v1
    v_lshlrev_b32 v1, 3, v0
    v_add_u32 v254, 126976, v1
    s_lshl_b32 s56, s3, 9
    v_add_u32 v238, s56, v254
    v_add_u32 v253, 122880, v65
    s_lshl_b32 s56, s3, 10
    v_add_u32 v237, s56, v253
    s_mov_b32 s52, 0x41c00000
    buffer_load_dwordx4 v28, s[24:27], s59 offen offset:2048 nt lds
    buffer_load_dwordx4 v29, s[24:27], s59 offen offset:3072 nt lds
    s_add_u32 m0, s42, 8192
    s_nop 0
    buffer_load_dwordx4 v30, s[24:27], s59 offen offset:0 nt lds
    buffer_load_dwordx4 v31, s[24:27], s59 offen offset:1024 nt lds
    buffer_load_dwordx4 v32, s[24:27], s59 offen offset:2048 nt lds
    buffer_load_dwordx4 v33, s[24:27], s59 offen offset:3072 nt lds
    s_branch L_join
L_xt3:
    s_call_b64 s[54:55], L_xslow
    s_branch L_post3
L_xt24:
    s_call_b64 s[54:55], L_xslow
    s_branch L_post24
L_xt6:
    s_call_b64 s[54:55], L_xslow
    s_branch L_post6
L_xt27:
    s_call_b64 s[54:55], L_xslow
    s_branch L_post27
L_xt9:
    s_call_b64 s[54:55], L_xslow
    s_branch L_post9
L_xt11:
    s_call_b64 s[54:55], L_xalt
    ds_read_b128 a[192:195], v253 offset:12288
    ds_read_b128 a[196:199], v253 offset:13312
    ds_read_b128 a[200:203], v253 offset:14336
    ds_read_b128 a[204:207], v253 offset:15360
    s_waitcnt lgkmcnt(0)
    s_branch L_post11
L_xslow:
    s_waitcnt lgkmcnt(0)
    ds_write_b32 v239, v62
    s_waitcnt lgkmcnt(0)
    s_barrier
    ds_read_b32 v12, v240 offset:0
    ds_read_b32 v13, v240 offset:1024
    ds_read_b32 v14, v240 offset:2048
    ds_read_b32 v15, v240 offset:3072
    v_mov_b32 v9, 0
    ds_write_b32 v254, v9 offset:4096
    s_waitcnt lgkmcnt(0)
    v_min3_f32 v1, v12, v13, v14
    v_min_f32 v1, v1, v15
    v_sub_f32 v2, v1, v255
    v_sub_f32 v12, v1, v62
    v_exp_f32 v2, v2
    v_exp_f32 v12, v12
    v_mov_b32 v62, v1
    v_mov_b32 v255, v1
    v_mul_f32 v88, v88, v12
    v_mul_f32 v89, v89, v12
    v_mul_f32 v90, v90, v12
    v_mul_f32 v91, v91, v12
    v_mul_f32 v104, v104, v12
    v_mul_f32 v105, v105, v12
    v_mul_f32 v106, v106, v12
    v_mul_f32 v107, v107, v12
    v_mul_f32 v68, v68, v12
    v_mul_f32 v69, v69, v12
    v_mul_f32 v70, v70, v12
    v_mul_f32 v71, v71, v12
    v_mul_f32 v112, v112, v12
    v_mul_f32 v113, v113, v12
    v_mul_f32 v114, v114, v12
    v_mul_f32 v115, v115, v12
    v_mul_f32 v63, v63, v12
    v_mul_f32 v64, v64, v12
    v_accvgpr_read_b32 v1, a0
    v_mul_f32 v1, v1, v2
    v_accvgpr_write_b32 a0, v1
    v_accvgpr_read_b32 v1, a1
    v_mul_f32 v1, v1, v2
    v_accvgpr_write_b32 a1, v1
    v_accvgpr_read_b32 v1, a2
    v_mul_f32 v1, v1, v2
    v_accvgpr_write_b32 a2, v1
    v_accvgpr_read_b32 v1, a3
    v_mul_f32 v1, v1, v2
    v_accvgpr_write_b32 a3, v1
    v_accvgpr_read_b32 v1, a4
    v_mul_f32 v1, v1, v2
    v_accvgpr_write_b32 a4, v1
    v_accvgpr_read_b32 v1, a5
    v_mul_f32 v1, v1, v2
    v_accvgpr_write_b32 a5, v1
    v_accvgpr_read_b32 v1, a6
    v_mul_f32 v1, v1, v2
    v_accvgpr_write_b32 a6, v1
    v_accvgpr_read_b32 v1, a7
    v_mul_f32 v1, v1, v2
    v_accvgpr_write_b32 a7, v1
    v_accvgpr_read_b32 v1, a8
    v_mul_f32 v1, v1, v2
    v_accvgpr_write_b32 a8, v1
    v_accvgpr_read_b32 v1, a9
    v_mul_f32 v1, v1, v2
    v_accvgpr_write_b32 a9, v1
    v_accvgpr_read_b32 v1, a10
    v_mul_f32 v1, v1, v2
    v_accvgpr_write_b32 a10, v1
    v_accvgpr_read_b32 v1, a11
    v_mul_f32 v1, v1, v2
    v_accvgpr_write_b32 a11, v1
    v_cvt_pk_bf16_f32 v72, v88, v89
    v_cvt_pk_bf16_f32 v73, v90, v91
    v_cvt_pk_bf16_f32 v74, v104, v105
    v_cvt_pk_bf16_f32 v75, v106, v107
    ds_write_b128 v237, v[72:75] offset:0
    v_cvt_pk_bf16_f32 v66, v68, v69
    v_cvt_pk_bf16_f32 v67, v70, v71
    ds_write_b64 v238, v[66:67]
    s_waitcnt lgkmcnt(0)
    s_barrier
    s_setpc_b64 s[54:55]
L_xlast:
    s_waitcnt lgkmcnt(0)
    ds_write_b32 v239, v62
    s_waitcnt lgkmcnt(0)
    s_barrier
    ds_read_b32 v12, v240 offset:0
    ds_read_b32 v13, v240 offset:1024
    ds_read_b32 v14, v240 offset:2048
    ds_read_b32 v15, v240 offset:3072
    v_mov_b32 v9, 0
    ds_write_b32 v254, v9 offset:4096
    s_waitcnt lgkmcnt(0)
    v_min3_f32 v1, v12, v13, v14
    v_min_f32 v1, v1, v15
    v_sub_f32 v2, v1, v255
    v_sub_f32 v12, v1, v62
    v_exp_f32 v2, v2
    v_exp_f32 v12, v12
    v_mov_b32 v62, v1
    v_mov_b32 v255, v1
    v_mul_f32 v88, v88, v12
    v_mul_f32 v89, v89, v12
    v_mul_f32 v90, v90, v12
    v_mul_f32 v91, v91, v12
    v_mul_f32 v104, v104, v12
    v_mul_f32 v105, v105, v12
    v_mul_f32 v106, v106, v12
    v_mul_f32 v107, v107, v12
    v_mul_f32 v68, v68, v12
    v_mul_f32 v69, v69, v12
    v_mul_f32 v70, v70, v12
    v_mul_f32 v71, v71, v12
    v_mul_f32 v10, v10, v12
    v_mul_f32 v11, v11, v12
    v_mul_f32 v16, v16, v2
    v_mul_f32 v17, v17, v2
    v_mul_f32 v18, v18, v2
    v_mul_f32 v19, v19, v2
    v_mul_f32 v20, v20, v2
    v_mul_f32 v21, v21, v2
    v_mul_f32 v22, v22, v2
    v_mul_f32 v23, v23, v2
    v_mul_f32 v24, v24, v2
    v_mul_f32 v25, v25, v2
    v_mul_f32 v26, v26, v2
    v_mul_f32 v27, v27, v2
    v_cvt_pk_bf16_f32 v72, v88, v89
    v_cvt_pk_bf16_f32 v73, v90, v91
    v_cvt_pk_bf16_f32 v74, v104, v105
    v_cvt_pk_bf16_f32 v75, v106, v107
    ds_write_b128 v237, v[72:75] offset:0
    v_cvt_pk_bf16_f32 v66, v68, v69
    v_cvt_pk_bf16_f32 v67, v70, v71
    ds_write_b64 v238, v[66:67]
    ds_write_b64 v238, v[10:11] offset:2048
    s_waitcnt lgkmcnt(0)
    s_barrier
    s_branch L_postx
L_xalt:
    s_waitcnt lgkmcnt(0)
    ds_write_b32 v239, v62
    s_waitcnt lgkmcnt(0)
    s_barrier
    ds_read_b32 v12, v240 offset:0
    ds_read_b32 v13, v240 offset:1024
    ds_read_b32 v14, v240 offset:2048
    ds_read_b32 v15, v240 offset:3072
    v_mov_b32 v9, 0
    ds_write_b32 v254, v9 offset:4100
    s_waitcnt lgkmcnt(0)
    v_min3_f32 v1, v12, v13, v14
    v_min_f32 v1, v1, v15
    v_sub_f32 v2, v1, v255
    v_sub_f32 v12, v1, v62
    v_exp_f32 v2, v2
    v_exp_f32 v12, v12
    v_mov_b32 v62, v1
    v_mov_b32 v255, v1
    v_mul_f32 v88, v88, v12
    v_mul_f32 v89, v89, v12
    v_mul_f32 v90, v90, v12
    v_mul_f32 v91, v91, v12
    v_mul_f32 v104, v104, v12
    v_mul_f32 v105, v105, v12
    v_mul_f32 v106, v106, v12
    v_mul_f32 v107, v107, v12
    v_mul_f32 v68, v68, v12
    v_mul_f32 v69, v69, v12
    v_mul_f32 v70, v70, v12
    v_mul_f32 v71, v71, v12
    v_mul_f32 v112, v112, v12
    v_mul_f32 v113, v113, v12
    v_mul_f32 v114, v114, v12
    v_mul_f32 v115, v115, v12
    v_mul_f32 v63, v63, v12
    v_mul_f32 v64, v64, v12
    v_mul_f32 v16, v16, v2
    v_mul_f32 v17, v17, v2
    v_mul_f32 v18, v18, v2
    v_mul_f32 v19, v19, v2
    v_mul_f32 v20, v20, v2
    v_mul_f32 v21, v21, v2
    v_mul_f32 v22, v22, v2
    v_mul_f32 v23, v23, v2
    v_mul_f32 v24, v24, v2
    v_mul_f32 v25, v25, v2
    v_mul_f32 v26, v26, v2
    v_mul_f32 v27, v27, v2
    v_cvt_pk_bf16_f32 v72, v88, v89
    v_cvt_pk_bf16_f32 v73, v90, v91
    v_cvt_pk_bf16_f32 v74, v104, v105
    v_cvt_pk_bf16_f32 v75, v106, v107
    ds_write_b128 v237, v[72:75] offset:12288
    s_waitcnt lgkmcnt(0)
    s_barrier
    s_setpc_b64 s[54:55]
L_c_slow:
    s_cmp_eq_u32 s43, 0
    s_cbranch_scc1 L_c_out
    s_mov_b32 s43, 0
    buffer_load_dwordx4 v[76:79], v65, s[32:35], s30 offen offset:0 sc1
    buffer_load_dwordx4 v[80:83], v65, s[32:35], s30 offen offset:1024 sc1
    buffer_load_dwordx4 v[84:87], v65, s[32:35], s30 offen offset:2048 sc1
    buffer_load_dwordx4 v[108:111], v65, s[32:35], s30 offen offset:3072 sc1
    buffer_load_dwordx4 v[112:115], v65, s[32:35], s31 offen offset:0 sc1
    buffer_load_dwordx4 v[128:131], v65, s[32:35], s31 offen offset:1024 sc1
    buffer_load_dwordx4 v[132:135], v65, s[32:35], s31 offen offset:2048 sc1
    buffer_load_dwordx4 v[52:55], v65, s[32:35], s31 offen offset:3072 sc1
    s_waitcnt vmcnt(0)
    v_sub_u32 v49, v79, v247
    v_max_f32 v42, v42, v49
    v_sub_u32 v49, v83, v247
    v_max_f32 v42, v42, v49
    v_sub_u32 v49, v87, v247
    v_max_f32 v42, v42, v49
    v_sub_u32 v49, v111, v247
    v_max_f32 v42, v42, v49
    v_sub_u32 v49, v115, v247
    v_max_f32 v42, v42, v49
    v_sub_u32 v49, v131, v247
    v_max_f32 v42, v42, v49
    v_sub_u32 v49, v135, v247
    v_max_f32 v42, v42, v49
    v_sub_u32 v49, v55, v247
    v_max_f32 v42, v42, v49
    s_nop 1
    v_max_f32_dpp v42, v42, v42 row_ror:8 row_mask:0xf bank_mask:0xf
    v_mov_b32 v48, v42
    s_nop 1
    v_permlane32_swap_b32 v42, v48
    v_max_f32 v42, v42, v48
    v_mov_b32 v48, v42
    s_nop 1
    v_permlane16_swap_b32 v42, v48
    v_max_f32 v42, v42, v48
    s_lshl_b32 s56, s3, 2
    v_add_u32 v48, s56, v251
    ds_write_b32 v48, v42 offset:1024
    s_waitcnt lgkmcnt(0)
    s_barrier
    ds_read_b128 v[48:51], v251 offset:1024
    v_mov_b32 v16, 0
    v_mov_b32 v17, 0
    v_mov_b32 v18, 0
    v_mov_b32 v19, 0
    v_mov_b32 v20, 0
    v_mov_b32 v21, 0
    v_mov_b32 v22, 0
    s_waitcnt lgkmcnt(0)
    v_max3_f32 v42, v48, v49, v50
    v_max_f32 v42, v42, v51
    v_sub_u32 v49, v79, v247
    v_sub_f32 v49, v49, v42
    v_exp_f32 v49, v49
    s_nop 0
    v_cvt_pk_bf16_f32 v49, v49, 0
    v_lshlrev_b32 v50, 16, v49
    v_dot2_f32_bf16 v16, v76, v49, v16
    v_dot2_f32_bf16 v18, v77, v49, v18
    v_dot2_f32_bf16 v20, v78, v49, v20
    v_add_f32 v22, v22, v50
    v_dot2_f32_bf16 v17, v76, v50, v17
    v_dot2_f32_bf16 v19, v77, v50, v19
    v_dot2_f32_bf16 v21, v78, v50, v21
    v_sub_u32 v49, v83, v247
    v_sub_f32 v49, v49, v42
    v_exp_f32 v49, v49
    s_nop 0
    v_cvt_pk_bf16_f32 v49, v49, 0
    v_lshlrev_b32 v50, 16, v49
    v_dot2_f32_bf16 v16, v80, v49, v16
    v_dot2_f32_bf16 v18, v81, v49, v18
    v_dot2_f32_bf16 v20, v82, v49, v20
    v_add_f32 v22, v22, v50
    v_dot2_f32_bf16 v17, v80, v50, v17
    v_dot2_f32_bf16 v19, v81, v50, v19
    v_dot2_f32_bf16 v21, v82, v50, v21
    v_sub_u32 v49, v87, v247
    v_sub_f32 v49, v49, v42
    v_exp_f32 v49, v49
    s_nop 0
    v_cvt_pk_bf16_f32 v49, v49, 0
    v_lshlrev_b32 v50, 16, v49
    v_dot2_f32_bf16 v16, v84, v49, v16
    v_dot2_f32_bf16 v18, v85, v49, v18
    v_dot2_f32_bf16 v20, v86, v49, v20
    v_add_f32 v22, v22, v50
    v_dot2_f32_bf16 v17, v84, v50, v17
    v_dot2_f32_bf16 v19, v85, v50, v19
    v_dot2_f32_bf16 v21, v86, v50, v21
    v_sub_u32 v49, v111, v247
    v_sub_f32 v49, v49, v42
    v_exp_f32 v49, v49
    s_nop 0
    v_cvt_pk_bf16_f32 v49, v49, 0
    v_lshlrev_b32 v50, 16, v49
    v_dot2_f32_bf16 v16, v108, v49, v16
    v_dot2_f32_bf16 v18, v109, v49, v18
    v_dot2_f32_bf16 v20, v110, v49, v20
    v_add_f32 v22, v22, v50
    v_dot2_f32_bf16 v17, v108, v50, v17
    v_dot2_f32_bf16 v19, v109, v50, v19
    v_dot2_f32_bf16 v21, v110, v50, v21
    v_sub_u32 v49, v115, v247
    v_sub_f32 v49, v49, v42
    v_exp_f32 v49, v49
    s_nop 0
    v_cvt_pk_bf16_f32 v49, v49, 0
    v_lshlrev_b32 v50, 16, v49
    v_dot2_f32_bf16 v16, v112, v49, v16
    v_dot2_f32_bf16 v18, v113, v49, v18
    v_dot2_f32_bf16 v20, v114, v49, v20
    v_add_f32 v22, v22, v50
    v_dot2_f32_bf16 v17, v112, v50, v17
    v_dot2_f32_bf16 v19, v113, v50, v19
    v_dot2_f32_bf16 v21, v114, v50, v21
    v_sub_u32 v49, v131, v247
    v_sub_f32 v49, v49, v42
    v_exp_f32 v49, v49
    s_nop 0
    v_cvt_pk_bf16_f32 v49, v49, 0
    v_lshlrev_b32 v50, 16, v49
    v_dot2_f32_bf16 v16, v128, v49, v16
    v_dot2_f32_bf16 v18, v129, v49, v18
    v_dot2_f32_bf16 v20, v130, v49, v20
    v_add_f32 v22, v22, v50
    v_dot2_f32_bf16 v17, v128, v50, v17
    v_dot2_f32_bf16 v19, v129, v50, v19
    v_dot2_f32_bf16 v21, v130, v50, v21
    v_sub_u32 v49, v135, v247
    v_sub_f32 v49, v49, v42
    v_exp_f32 v49, v49
    s_nop 0
    v_cvt_pk_bf16_f32 v49, v49, 0
    v_lshlrev_b32 v50, 16, v49
    v_dot2_f32_bf16 v16, v132, v49, v16
    v_dot2_f32_bf16 v18, v133, v49, v18
    v_dot2_f32_bf16 v20, v134, v49, v20
    v_add_f32 v22, v22, v50
    v_dot2_f32_bf16 v17, v132, v50, v17
    v_dot2_f32_bf16 v19, v133, v50, v19
    v_dot2_f32_bf16 v21, v134, v50, v21
    v_sub_u32 v49, v55, v247
    v_sub_f32 v49, v49, v42
    v_exp_f32 v49, v49
    s_nop 0
    v_cvt_pk_bf16_f32 v49, v49, 0
    v_lshlrev_b32 v50, 16, v49
    v_dot2_f32_bf16 v16, v52, v49, v16
    v_dot2_f32_bf16 v18, v53, v49, v18
    v_dot2_f32_bf16 v20, v54, v49, v20
    v_add_f32 v22, v22, v50
    v_dot2_f32_bf16 v17, v52, v50, v17
    v_dot2_f32_bf16 v19, v53, v50, v19
    v_dot2_f32_bf16 v21, v54, v50, v21
    s_nop 2
    s_branch L_c_red
L_qk_retry:
    s_mov_b32 s53, 0
L_qk_again:
    s_mul_i32 s56, s3, 3072
    s_add_u32 s56, s56, 16384
    buffer_load_dwordx4 v[136:139], v65, s[32:35], s56 offen offset:0 sc1
    buffer_load_dwordx4 v[140:143], v65, s[32:35], s56 offen offset:1024 sc1
    buffer_load_dwordx4 v[144:147], v65, s[32:35], s56 offen offset:2048 sc1
    s_add_u32 s53, s53, 1
    s_waitcnt vmcnt(0)
    v_xor_b32 v1, s39, v138
    v_xor_b32 v2, s39, v142
    v_xor_b32 v3, s39, v146
    v_or3_b32 v1, v1, v2, v3
    v_cmp_ne_u32 vcc, 0, v1
    s_cbranch_vccz L_qk_ok
    s_cmp_lt_u32 s53, 65536
    s_cbranch_scc1 L_qk_again
    s_branch L_qk_ok
L_fl_retry:
    s_mov_b32 s53, 0
L_fl_again:
    buffer_load_dword v244, v245, s[32:35], 0 offen offset:128 sc1
    s_add_u32 s53, s53, 1
    s_waitcnt vmcnt(0)
    v_cmp_ne_u32 vcc, s39, v244
    s_cbranch_vccz L_fl_ok
    s_cmp_lt_u32 s53, 65536
    s_cbranch_scc1 L_fl_again
    s_branch L_fl_ok
L_site0:
    s_call_b64 s[54:55], L_rare2
    s_branch L_back0
L_site1:
    s_call_b64 s[54:55], L_rare3
    s_branch L_back1
L_site2:
    s_call_b64 s[54:55], L_rare2
    s_branch L_back2
L_site3:
    s_call_b64 s[54:55], L_rare3
    s_branch L_back3
L_site4:
    s_call_b64 s[54:55], L_rare2
    s_branch L_back4
L_site5:
    s_call_b64 s[54:55], L_rare3
    s_branch L_back5
L_site6:
    s_call_b64 s[54:55], L_rare2
    s_branch L_back6
L_site7:
    s_call_b64 s[54:55], L_rare3
    s_branch L_back7
L_site8:
    s_call_b64 s[54:55], L_rare2
    s_branch L_back8
L_site9:
    s_call_b64 s[54:55], L_rare3
    s_branch L_back9
L_site10:
    s_call_b64 s[54:55], L_rare6
    s_branch L_back10
L_site11:
    s_call_b64 s[54:55], L_rare7
    s_branch L_back11
L_site12:
    s_call_b64 s[54:55], L_rare2
    s_branch L_back12
L_site13:
    s_call_b64 s[54:55], L_rare5
    s_branch L_back13
L_rare2:
    s_nop 7
    s_nop 7
    v_mov_b32 v2, v1
    s_nop 1
    v_permlane32_swap_b32 v1, v2
    v_max_f32 v1, v1, v2
    v_mov_b32 v2, v1
    s_nop 1
    v_permlane16_swap_b32 v1, v2
    v_max_f32 v1, v1, v2
    v_max_f32 v1, 0, v1
    v_sub_f32 v62, v62, v1
    v_sub_f32 v88, v88, v1
    v_sub_f32 v89, v89, v1
    v_sub_f32 v90, v90, v1
    v_sub_f32 v91, v91, v1
    v_sub_f32 v1, 0, v1
    v_exp_f32 v1, v1
    s_nop 0
    v_mul_f32 v63, v63, v1
    v_mul_f32 v64, v64, v1
    v_mul_f32 v68, v68, v1
    v_mul_f32 v69, v69, v1
    v_mul_f32 v70, v70, v1
    v_mul_f32 v71, v71, v1
    v_mov_b32 v2, 1
    ds_write_b32 v254, v2 offset:4096
    s_waitcnt lgkmcnt(0)
    s_nop 3
    s_setpc_b64 s[54:55]
L_rare3:
    s_nop 7
    s_nop 7
    v_mov_b32 v2, v1
    s_nop 1
    v_permlane32_swap_b32 v1, v2
    v_max_f32 v1, v1, v2
    v_mov_b32 v2, v1
    s_nop 1
    v_permlane16_swap_b32 v1, v2
    v_max_f32 v1, v1, v2
    v_max_f32 v1, 0, v1
    v_sub_f32 v62, v62, v1
    v_sub_f32 v104, v104, v1
    v_sub_f32 v105, v105, v1
    v_sub_f32 v106, v106, v1
    v_sub_f32 v107, v107, v1
    v_sub_f32 v1, 0, v1
    v_exp_f32 v1, v1
    s_nop 0
    v_mul_f32 v63, v63, v1
    v_mul_f32 v64, v64, v1
    v_mul_f32 v68, v68, v1
    v_mul_f32 v69, v69, v1
    v_mul_f32 v70, v70, v1
    v_mul_f32 v71, v71, v1
    v_mul_f32 v88, v88, v1
    v_mul_f32 v89, v89, v1
    v_mul_f32 v90, v90, v1
    v_mul_f32 v91, v91, v1
    v_mov_b32 v2, 1
    ds_write_b32 v254, v2 offset:4096
    s_waitcnt lgkmcnt(0)
    s_nop 3
    s_setpc_b64 s[54:55]
L_rare5:
    s_nop 7
    s_nop 7
    v_mov_b32 v2, v1
    s_nop 1
    v_permlane32_swap_b32 v1, v2
    v_max_f32 v1, v1, v2
    v_mov_b32 v2, v1
    s_nop 1
    v_permlane16_swap_b32 v1, v2
    v_max_f32 v1, v1, v2
    v_max_f32 v1, 0, v1
    v_sub_f32 v62, v62, v1
    v_sub_f32 v104, v104, v1
    v_sub_f32 v105, v105, v1
    v_sub_f32 v106, v106, v1
    v_sub_f32 v107, v107, v1
    v_sub_f32 v1, 0, v1
    v_exp_f32 v1, v1
    s_nop 0
    v_mul_f32 v63, v63, v1
    v_mul_f32 v64, v64, v1
    v_mul_f32 v68, v68, v1
    v_mul_f32 v69, v69, v1
    v_mul_f32 v70, v70, v1
    v_mul_f32 v71, v71, v1
    v_mul_f32 v88, v88, v1
    v_mul_f32 v89, v89, v1
    v_mul_f32 v90, v90, v1
    v_mul_f32 v91, v91, v1
    v_cvt_pk_bf16_f32 v72, v88, v89
    v_cvt_pk_bf16_f32 v73, v90, v91
    v_mov_b32 v2, 1
    ds_write_b32 v254, v2 offset:4096
    s_waitcnt lgkmcnt(0)
    s_nop 3
    s_setpc_b64 s[54:55]
L_rare6:
    s_nop 7
    s_nop 7
    v_mov_b32 v2, v1
    s_nop 1
    v_permlane32_swap_b32 v1, v2
    v_max_f32 v1, v1, v2
    v_mov_b32 v2, v1
    s_nop 1
    v_permlane16_swap_b32 v1, v2
    v_max_f32 v1, v1, v2
    v_max_f32 v1, 0, v1
    v_sub_f32 v62, v62, v1
    v_sub_f32 v88, v88, v1
    v_sub_f32 v89, v89, v1
    v_sub_f32 v90, v90, v1
    v_sub_f32 v91, v91, v1
    v_sub_f32 v1, 0, v1
    v_exp_f32 v1, v1
    s_nop 0
    v_mul_f32 v63, v63, v1
    v_mul_f32 v64, v64, v1
    v_mul_f32 v68, v68, v1
    v_mul_f32 v69, v69, v1
    v_mul_f32 v70, v70, v1
    v_mul_f32 v71, v71, v1
    v_mov_b32 v2, 1
    ds_write_b32 v254, v2 offset:4100
    s_waitcnt lgkmcnt(0)
    s_nop 3
    s_setpc_b64 s[54:55]
L_rare7:
    s_nop 7
    s_nop 7
    v_mov_b32 v2, v1
    s_nop 1
    v_permlane32_swap_b32 v1, v2
    v_max_f32 v1, v1, v2
    v_mov_b32 v2, v1
    s_nop 1
    v_permlane16_swap_b32 v1, v2
    v_max_f32 v1, v1, v2
    v_max_f32 v1, 0, v1
    v_sub_f32 v62, v62, v1
    v_sub_f32 v104, v104, v1
    v_sub_f32 v105, v105, v1
    v_sub_f32 v106, v106, v1
    v_sub_f32 v107, v107, v1
    v_sub_f32 v1, 0, v1
    v_exp_f32 v1, v1
    s_nop 0
    v_mul_f32 v63, v63, v1
    v_mul_f32 v64, v64, v1
    v_mul_f32 v68, v68, v1
    v_mul_f32 v69, v69, v1
    v_mul_f32 v70, v70, v1
    v_mul_f32 v71, v71, v1
    v_mul_f32 v88, v88, v1
    v_mul_f32 v89, v89, v1
    v_mul_f32 v90, v90, v1
    v_mul_f32 v91, v91, v1
    v_mov_b32 v2, 1
    ds_write_b32 v254, v2 offset:4100
    s_waitcnt lgkmcnt(0)
    s_nop 3
    s_setpc_b64 s[54:55]
L_codeend:
.section .rodata,"a"
.p2align 6
.amdhsa_kernel standalone__detection_seg_dino__vision_kernel
  .amdhsa_next_free_vgpr 464
  .amdhsa_next_free_sgpr 102
  .amdhsa_accum_offset 256
  .amdhsa_group_segment_fixed_size 0
  .amdhsa_kernarg_size 80
  .amdhsa_user_sgpr_count 2
  .amdhsa_user_sgpr_kernarg_segment_ptr 1
  .amdhsa_system_sgpr_workgroup_id_x 1
  .amdhsa_float_denorm_mode_32 3
.end_amdhsa_kernel
```

```asm
; @launch grid=(256,1,1) block=(256,1,1) lds=163840
.amdgcn_target "amdgcn-amd-amdhsa--gfx950"
.text
.globl standalone__detection_seg_dino__vision_kernel
.p2align 8
.type standalone__detection_seg_dino__vision_kernel,@function
standalone__detection_seg_dino__vision_kernel:
    s_cmp_ge_u32 s2, 256
    s_cbranch_scc1 L_end
    s_load_dwordx16 s[4:19], s[0:1], 0
    s_load_dwordx4 s[20:23], s[0:1], 64
    s_getpc_b64 s[54:55]
L_pc_main:
    v_lshlrev_b32 v233, 7, v0
    v_min_u32 v233, L_codeend - L_pc_main - 4, v233
    global_load_dword v232, v233, s[54:55]
    s_mov_b64 s[100:101], s[54:55]
    v_lshrrev_b32 v1, 6, v0
    v_and_b32 v0, 63, v0
    v_readfirstlane_b32 s3, v1
    v_lshlrev_b32 v65, 4, v0
    v_lshrrev_b32 v1, 2, v0
    v_and_b32 v1, 14, v1
    s_mov_b32 s56, 0x5000
    v_bfe_u32 v2, s56, v1, 2
    v_lshlrev_b32 v2, 5, v2
    v_xor_b32 v16, v65, v2
    s_mov_b32 s56, 0xaa55
    v_bfe_u32 v2, s56, v1, 2
    v_lshlrev_b32 v2, 5, v2
    v_xor_b32 v17, v65, v2
    s_mov_b32 s56, 0xfffa
    v_bfe_u32 v2, s56, v1, 2
    v_lshlrev_b32 v2, 5, v2
    v_xor_b32 v18, v65, v2
    v_xor_b32 v19, 16, v16
    v_xor_b32 v20, 0x1010, v17
    v_xor_b32 v21, 0x1010, v18
    v_lshrrev_b32 v1, 3, v0
    v_and_b32 v1, 6, v1
    s_mov_b32 s56, 0x40
    v_bfe_u32 v2, s56, v1, 2
    v_lshlrev_b32 v2, 5, v2
    v_xor_b32 v22, v65, v2
    s_mov_b32 s56, 0xa5
    v_bfe_u32 v2, s56, v1, 2
    v_lshlrev_b32 v2, 5, v2
    v_xor_b32 v23, v65, v2
    s_mov_b32 s56, 0xfe
    v_bfe_u32 v2, s56, v1, 2
    v_lshlrev_b32 v2, 5, v2
    v_xor_b32 v24, v65, v2
    v_xor_b32 v25, 0x80, v22
    v_xor_b32 v26, 0x1080, v23
    v_xor_b32 v27, 0x1080, v24
    v_xor_b32 v28, 0x1010, v22
    v_xor_b32 v29, 0x1010, v23
    v_xor_b32 v30, 0x2010, v24
    v_xor_b32 v31, 0x2090, v22
    v_xor_b32 v32, 0x2090, v23
    v_xor_b32 v33, 0x2090, v24
    v_mov_b32 v248, 0x10000
    s_mul_i32 s36, s3, 6144
    s_mul_i32 s37, s3, 12288
    s_add_u32 s40, s36, 0
    s_add_u32 s41, s37, 24576
    s_add_u32 s42, s37, 73728
    s_and_b32 s58, s2, 7
    s_lshr_b32 s57, s2, 3
    s_lshl_b32 s58, s58, 5
    s_add_u32 s58, s58, s57
    s_lshr_b32 s57, s58, 7
    s_mul_i32 s57, s57, 384
    s_add_u32 s58, s57, s58
    s_lshr_b32 s56, s58, 2
    s_mul_i32 s56, s56, 196608
    s_mul_i32 s57, s58, 24576
    s_lshl1_add_u32 s56, s57, s56
    s_mov_b64 s[60:61], s[56:57]
    s_mov_b32 s30, 9461760
    s_mov_b32 s31, 0x20000
    s_mov_b32 s26, 37994496
    s_mov_b32 s27, 0x20000
    s_mov_b32 s34, 8388608
    s_mov_b32 s35, 0x20000
    s_mov_b32 m0, s40
    s_and_b32 s56, s2, 7
    s_cmp_eq_u32 s56, 2
    s_cbranch_scc1 L_spec
    s_and_b32 s56, s2, 7
    s_cbranch_scc1 L_plain
L_spec:
    s_waitcnt lgkmcnt(0)
    s_add_u32 s28, s8, s61
    s_addc_u32 s29, s9, 0
    s_add_u32 s24, s6, s60
    s_addc_u32 s25, s7, 0
    s_mov_b64 s[32:33], s[22:23]
    s_lshr_b32 s43, s2, 3
    s_mul_i32 s57, s43, 2304
    v_min_u32 v1, 17, v0
    v_lshlrev_b32 v1, 7, v1
    s_mov_b32 s66, 73728
    s_mov_b32 s67, 0x20000
    s_mov_b32 s70, 73728
    s_mov_b32 s71, 0x20000
    s_mov_b32 s72, s4
    s_mov_b32 s73, s5
    s_mov_b32 s74, 6144
    s_mov_b32 s75, 0x20000
    s_bitcmp1_b32 s2, 1
    s_cselect_b64 s[64:65], s[16:17], s[10:11]
    s_cselect_b64 s[68:69], s[14:15], s[12:13]
    s_cmp_eq_u32 s3, 0
    s_cbranch_scc1 L_pf0
    s_cmp_eq_u32 s3, 1
    s_cbranch_scc0 L_pfdone
    s_lshl_b32 s58, s43, 8
    buffer_load_dword v234, v1, s[68:71], s57 offen
    v_min_u32 v2, 128, v1
    buffer_load_dword v235, v2, s[72:75], s58 offen
    s_branch L_pfdone
L_pf0:
    buffer_load_dword v234, v1, s[64:67], s57 offen
L_pfdone:
    s_cmp_ge_u32 s43, 3
    s_cbranch_scc1 L_nopf
    s_mov_b32 s0, 1
    s_bitcmp1_b32 s2, 1
    s_cbranch_scc0 L_prod
    s_branch L_vprod
L_plain:
    s_waitcnt lgkmcnt(0)
L_nopf:
    s_add_u32 s28, s8, s61
    s_addc_u32 s29, s9, 0
    buffer_load_dwordx4 v16, s[28:31], s36 offen offset:0 nt lds
    s_add_u32 s24, s6, s60
    s_addc_u32 s25, s7, 0
    s_mov_b64 s[32:33], s[22:23]
    s_mov_b32 s0, 0
    buffer_load_dwordx4 v17, s[28:31], s36 offen offset:1024 nt lds
    buffer_load_dwordx4 v18, s[28:31], s36 offen offset:2048 nt lds
    buffer_load_dwordx4 v19, s[28:31], s36 offen offset:3072 nt lds
    s_add_u32 m0, s40, 4096
    s_load_dword s38, s[22:23], 0
    buffer_load_dwordx4 v20, s[28:31], s36 offen offset:0 nt lds
    buffer_load_dwordx4 v21, s[28:31], s36 offen offset:1024 nt lds
    s_mov_b32 s43, -1
    s_sub_u32 s59, s2, 64
    s_cmp_ge_u32 s59, 64
    s_cbranch_scc1 L_nocs
    s_mov_b32 s64, s4
    s_mov_b32 s65, s5
    s_mov_b32 s66, 6144
    s_mov_b32 s67, 0x20000
    s_mov_b32 s68, s18
    s_mov_b32 s69, s19
    s_mov_b32 s70, 6144
    s_mov_b32 s71, 0x20000
    v_bfe_u32 v1, v0, 2, 1
    v_mul_u32_u24 v2, 7, v1
    v_xor_b32 v2, v0, v2
    v_and_b32 v2, 3, v2
    s_lshr_b32 s56, s59, 4
    s_lshl_b32 s56, s56, 2
    v_add_u32 v2, s56, v2
    v_lshlrev_b32 v252, 2, v2
    v_lshrrev_b32 v3, 4, v0
    v_mad_u32_u24 v3, v1, 3, v3
    v_lshrrev_b32 v4, 1, v3
    v_and_b32 v3, 1, v3
    v_lshlrev_b32 v3, 2, v3
    v_lshl_add_u32 v3, v4, 5, v3
    v_bfe_u32 v4, v0, 3, 1
    v_lshl_add_u32 v3, v4, 1, v3
    v_mul_u32_u24 v2, 384, v2
    s_bfe_u32 s56, s59, 0x20002
    s_mul_i32 s56, s56, 96
    s_and_b32 s57, s59, 3
    s_lshl_b32 s57, s57, 3
    s_add_u32 s56, s56, s57
    v_add3_u32 v248, s56, v2, v3
    v_cmp_gt_u32 vcc, 48, v0
    v_mov_b32 v4, 0x10000
    s_lshl_b32 s56, s3, 2
    v_cndmask_b32 v248, v4, v248, vcc
    buffer_load_ushort v249, v248, s[64:67], 0 offen
    s_or_b32 s57, s59, s3
    s_cselect_b32 s70, 0, 6144
    v_lshlrev_b32 v4, 7, v0
    buffer_load_ushort v246, v4, s[68:71], 0 offen
    v_add_u32 v250, s56, v65
    v_and_b32 v251, 0x70, v65
L_nocs:
    s_add_u32 m0, s41, 0
    s_add_u32 s58, s37, 0
    buffer_load_dwordx4 v22, s[24:27], s58 offen offset:0 nt lds
    buffer_load_dwordx4 v23, s[24:27], s58 offen offset:1024 nt lds
    buffer_load_dwordx4 v24, s[24:27], s58 offen offset:2048 nt lds
    buffer_load_dwordx4 v25, s[24:27], s58 offen offset:3072 nt lds
    s_add_u32 m0, s41, 4096
    s_nop 0
    buffer_load_dwordx4 v26, s[24:27], s58 offen offset:0 nt lds
    buffer_load_dwordx4 v27, s[24:27], s58 offen offset:1024 nt lds
    buffer_load_dwordx4 v28, s[24:27], s58 offen offset:2048 nt lds
    buffer_load_dwordx4 v29, s[24:27], s58 offen offset:3072 nt lds
    s_add_u32 m0, s41, 8192
    s_nop 0
    buffer_load_dwordx4 v30, s[24:27], s58 offen offset:0 nt lds
    buffer_load_dwordx4 v31, s[24:27], s58 offen offset:1024 nt lds
    buffer_load_dwordx4 v32, s[24:27], s58 offen offset:2048 nt lds
    buffer_load_dwordx4 v33, s[24:27], s58 offen offset:3072 nt lds
    s_add_u32 m0, s42, 0
    s_add_u32 s59, s37, 196608
    buffer_load_dwordx4 v22, s[24:27], s59 offen offset:0 nt lds
    buffer_load_dwordx4 v23, s[24:27], s59 offen offset:1024 nt lds
    buffer_load_dwordx4 v24, s[24:27], s59 offen offset:2048 nt lds
    buffer_load_dwordx4 v25, s[24:27], s59 offen offset:3072 nt lds
    s_add_u32 m0, s42, 4096
    s_nop 0
    buffer_load_dwordx4 v26, s[24:27], s59 offen offset:0 nt lds
    buffer_load_dwordx4 v27, s[24:27], s59 offen offset:1024 nt lds
    buffer_load_dwordx4 v28, s[24:27], s59 offen offset:2048 nt lds
    buffer_load_dwordx4 v29, s[24:27], s59 offen offset:3072 nt lds
    s_add_u32 m0, s42, 8192
    s_nop 0
    buffer_load_dwordx4 v30, s[24:27], s59 offen offset:0 nt lds
    buffer_load_dwordx4 v31, s[24:27], s59 offen offset:1024 nt lds
    buffer_load_dwordx4 v32, s[24:27], s59 offen offset:2048 nt lds
    buffer_load_dwordx4 v33, s[24:27], s59 offen offset:3072 nt lds
    v_and_b32 v1, 15, v0
    v_lshrrev_b32 v6, 5, v0
    v_bfe_u32 v3, v0, 4, 1
    v_lshl_or_b32 v3, v3, 1, v6
    v_lshrrev_b32 v4, 2, v0
    v_bfe_u32 v5, v0, 1, 1
    v_lshrrev_b32 v6, 3, v1
    v_and_or_b32 v6, v1, 6, v6
    v_xor_b32 v6, v6, v3
    v_mul_u32_u24 v7, 384, v1
    v_lshl_add_u32 v6, v6, 4, v7
    v_add_u32 v34, s40, v6
    v_xor_b32 v35, 64, v34
    v_lshrrev_b32 v6, 3, v1
    v_and_b32 v7, 7, v1
    v_lshl_or_b32 v6, v7, 1, v6
    v_xor_b32 v6, v6, v3
    v_mul_u32_u24 v7, 768, v1
    v_lshl_add_u32 v6, v6, 4, v7
    v_add_u32 v40, s41, v6
    v_xor_b32 v41, 0x40, v40
    v_xor_b32 v42, 0x80, v40
    v_xor_b32 v43, 0xc0, v40
    v_and_b32 v2, 1, v0
    v_lshlrev_b32 v2, 3, v2
    s_mul_i32 s56, s3, 96
    v_lshrrev_b32 v6, 3, v4
    v_and_or_b32 v6, v4, 6, v6
    v_xor_b32 v6, v6, v5
    v_lshl_add_u32 v6, v6, 4, v2
    v_mul_u32_u24 v7, 384, v4
    s_add_u32 s57, s56, 0
    v_xad_u32 v36, v6, s57, v7
    s_add_u32 s57, s56, 32
    v_xad_u32 v37, v6, s57, v7
    s_add_u32 s57, s56, 64
    v_xad_u32 v38, v6, s57, v7
    v_lshrrev_b32 v6, 3, v4
    v_and_b32 v3, 7, v4
    v_lshl_or_b32 v6, v3, 1, v6
    v_xor_b32 v6, v6, v5
    v_lshl_add_u32 v6, v6, 4, v2
    v_lshlrev_b32 v7, 1, v7
    v_add_u32 v7, 24576, v7
    s_add_u32 s57, s56, 0
    v_xad_u32 v44, v6, s57, v7
    s_add_u32 s57, s56, 384
    v_xad_u32 v45, v6, s57, v7
    s_add_u32 s57, s56, 32
    v_xad_u32 v46, v6, s57, v7
    s_add_u32 s57, s56, 416
    v_xad_u32 v47, v6, s57, v7
    s_add_u32 s57, s56, 64
    v_xad_u32 v48, v6, s57, v7
    s_add_u32 s57, s56, 448
    v_xad_u32 v49, v6, s57, v7
    v_mov_b32 v52, 0x3f803f80
    v_mov_b32 v56, 0x3ebcbe62
    s_mov_b32 s44, 0x100001
    s_mov_b32 s45, 0x10000100
    v_mov_b32 v53, 0x3f803f80
    v_mov_b32 v57, 0x3ebcbe62
    s_mov_b32 s46, 0x200002
    s_mov_b32 s47, 0x20000200
    v_mov_b32 v54, 0x3f803f80
    v_mov_b32 v58, 0x3ebcbe62
    s_mov_b32 s48, 0x400004
    s_mov_b32 s49, 0x40000400
    v_mov_b32 v55, 0x3f803f80
    v_mov_b32 v59, 0x3ebcbe62
    s_mov_b32 s50, 0x800008
    s_mov_b32 s51, 0x80000800
    v_mov_b32 v60, 0x43400000
    v_lshrrev_b32 v1, 5, v0
    v_lshlrev_b32 v1, 8, v1
    v_and_b32 v2, 15, v0
    v_lshl_add_u32 v1, v2, 4, v1
    v_bfe_u32 v2, v0, 4, 1
    v_lshl_add_u32 v1, v2, 3, v1
    s_mul_i32 s56, s3, 1536
    s_add_u32 s56, s56, 147456
    v_add_u32 v236, s56, v1
    s_mul_i32 s56, s3, 3072
    s_add_u32 s56, s56, 24576
    v_add_u32 v237, s56, v65
    v_add_u32 v238, s41, v65
    s_lshl_b32 s56, s3, 10
    v_add_u32 v240, 159744, v65
    v_add_u32 v239, s56, v240
    v_add_u32 v241, 147456, v65
    v_bfe_u32 v1, v0, 2, 2
    v_lshrrev_b32 v2, 4, v0
    v_lshl_or_b32 v1, v1, 4, v2
    v_mul_u32_u24 v1, 32768, v1
    v_and_b32 v2, 3, v0
    v_lshl_or_b32 v242, v2, 4, v1
    v_xor_b32 v243, 0x70, v242
    s_mul_i32 s56, s3, 3
    v_min_u32 v1, 2, v0
    v_add_u32 v1, s56, v1
    v_lshlrev_b32 v245, 7, v1
    v_lshlrev_b32 v1, 3, v0
    v_add_u32 v254, 126976, v1
    s_lshl_b32 s56, s3, 9
    v_add_u32 v238, s56, v254
    v_add_u32 v253, 122880, v65
    s_lshl_b32 s56, s3, 10
    v_add_u32 v237, s56, v253
    s_mov_b32 s52, 0x41c00000
L_join:
    s_mul_i32 s60, s3, 18432
    s_mov_b32 s72, s22
    s_mov_b32 s73, s23
    s_mov_b32 s74, 8388608
    s_mov_b32 s75, 0x20000
    s_cmp_eq_u32 s0, 1
    s_cselect_b32 s74, 0, s74
    s_waitcnt vmcnt(24)
    s_waitcnt lgkmcnt(0)
    s_barrier
    ds_read_b128 a[48:51], v34 offset:0
    ds_read_b128 a[52:55], v35 offset:0
    ds_read_b128 a[56:59], v34 offset:128
    ds_read_b128 a[60:63], v35 offset:128
    ds_read_b128 a[64:67], v34 offset:256
    ds_read_b128 a[68:71], v35 offset:256
    s_waitcnt lgkmcnt(5)
    v_mfma_f32_16x16x32_bf16 v[84:87], a[48:51], a[48:51], 0
    ds_read_b64_tr_b16 a[72:73], v36 offset:0
    ds_read_b64_tr_b16 a[74:75], v36 offset:6144
    v_mfma_f32_16x16x32_bf16 v[80:83], a[48:51], v[52:55], 0
    ds_read_b64_tr_b16 a[76:77], v36 offset:12288
    ds_read_b64_tr_b16 a[78:79], v36 offset:18432
    s_waitcnt lgkmcnt(8)
    v_mfma_f32_16x16x32_bf16 v[84:87], a[52:55], a[52:55], v[84:87]
    ds_read_b64_tr_b16 a[80:81], v37 offset:0
    ds_read_b64_tr_b16 a[82:83], v37 offset:6144
    v_mfma_f32_16x16x32_bf16 v[80:83], a[52:55], v[52:55], v[80:83]
    ds_read_b64_tr_b16 a[84:85], v37 offset:12288
    ds_read_b64_tr_b16 a[86:87], v37 offset:18432
    s_waitcnt lgkmcnt(11)
    v_mfma_f32_16x16x32_bf16 v[84:87], a[56:59], a[56:59], v[84:87]
    ds_read_b64_tr_b16 a[88:89], v38 offset:0
    ds_read_b64_tr_b16 a[90:91], v38 offset:6144
    v_mfma_f32_16x16x32_bf16 v[80:83], a[56:59], v[52:55], v[80:83]
    ds_read_b64_tr_b16 a[92:93], v38 offset:12288
    ds_read_b64_tr_b16 a[94:95], v38 offset:18432
    s_waitcnt lgkmcnt(14)
    v_mfma_f32_16x16x32_bf16 v[84:87], a[60:63], a[60:63], v[84:87]
    v_mfma_f32_16x16x32_bf16 v[80:83], a[60:63], v[52:55], v[80:83]
    s_waitcnt lgkmcnt(13)
    v_mfma_f32_16x16x32_bf16 v[84:87], a[64:67], a[64:67], v[84:87]
    v_mfma_f32_16x16x32_bf16 v[80:83], a[64:67], v[52:55], v[80:83]
    s_waitcnt lgkmcnt(12)
    v_mfma_f32_16x16x32_bf16 v[84:87], a[68:71], a[68:71], v[84:87]
    v_mfma_f32_16x16x32_bf16 v[80:83], a[68:71], v[52:55], v[80:83]
    s_waitcnt lgkmcnt(0)
    s_mul_i32 s39, s38, 0x9e3779b1
    s_add_u32 s39, s39, 0x7f4a7c16
    s_or_b32 s39, s39, 1
    s_mul_i32 s56, s3, 3072
    s_add_u32 s56, s56, 16384
    buffer_load_dwordx4 v[136:139], v65, s[32:35], s56 offen offset:0 sc1
    buffer_load_dwordx4 v[140:143], v65, s[32:35], s56 offen offset:1024 sc1
    buffer_load_dwordx4 v[144:147], v65, s[32:35], s56 offen offset:2048 sc1
    s_waitcnt vmcnt(15)
    s_barrier
    ds_read_b128 a[96:99], v40 offset:0
    ds_read_b128 a[100:103], v41 offset:0
    ds_read_b128 a[104:107], v42 offset:0
    ds_read_b128 a[108:111], v43 offset:0
    ds_read_b128 a[112:115], v40 offset:256
    ds_read_b128 a[116:119], v41 offset:256
    ds_read_b128 a[120:123], v42 offset:256
    ds_read_b128 a[124:127], v43 offset:256
    ds_read_b128 a[128:131], v40 offset:512
    ds_read_b128 a[132:135], v41 offset:512
    ds_read_b128 a[136:139], v42 offset:512
    ds_read_b128 a[140:143], v43 offset:512
    ds_read_b64_tr_b16 a[144:145], v44 offset:0
    ds_read_b64_tr_b16 a[146:147], v45 offset:0
    ds_read_b64_tr_b16 a[148:149], v44 offset:12288
    ds_read_b64_tr_b16 a[150:151], v45 offset:12288
    ds_read_b64_tr_b16 a[152:153], v44 offset:24576
    ds_read_b64_tr_b16 a[154:155], v45 offset:24576
    ds_read_b64_tr_b16 a[156:157], v44 offset:36864
    ds_read_b64_tr_b16 a[158:159], v45 offset:36864
    ds_read_b64_tr_b16 a[160:161], v46 offset:0
    ds_read_b64_tr_b16 a[162:163], v47 offset:0
    ds_read_b64_tr_b16 a[164:165], v46 offset:12288
    ds_read_b64_tr_b16 a[166:167], v47 offset:12288
    ds_read_b64_tr_b16 a[168:169], v46 offset:24576
    ds_read_b64_tr_b16 a[170:171], v47 offset:24576
    ds_read_b64_tr_b16 a[172:173], v46 offset:36864
    ds_read_b64_tr_b16 a[174:175], v47 offset:36864
    ds_read_b64_tr_b16 a[176:177], v48 offset:0
    ds_read_b64_tr_b16 a[178:179], v49 offset:0
    ds_read_b64_tr_b16 a[180:181], v48 offset:12288
    ds_read_b64_tr_b16 a[182:183], v49 offset:12288
    ds_read_b64_tr_b16 a[184:185], v48 offset:24576
    ds_read_b64_tr_b16 a[186:187], v49 offset:24576
    ds_read_b64_tr_b16 a[188:189], v48 offset:36864
    ds_read_b64_tr_b16 a[190:191], v49 offset:36864
    s_waitcnt lgkmcnt(0)
    s_barrier
    s_cmp_ge_u32 s43, 3
    s_cbranch_scc1 L_v_nofl
    s_mul_i32 s56, s3, 3
    s_add_u32 s56, s56, s43
    s_lshl_b32 s56, s56, 7
    v_mov_b32 v1, s39
    v_mov_b32 v2, 0
    s_mov_b64 exec, 1
    s_waitcnt vmcnt(9)
    buffer_store_dword v1, v2, s[32:35], s56 offen offset:128 sc1
    s_mov_b64 exec, -1
L_v_nofl:
    v_mfma_f32_16x16x32_bf16 v[96:99], a[96:99], a[96:99], v[84:87]
    s_cmp_eq_u32 s0, 0
    s_cbranch_scc0 L_g1
    s_waitcnt vmcnt(8)
L_g1:
    s_add_u32 m0, s40, 0
    s_add_u32 s57, s36, 3145728
    buffer_load_dwordx4 v16, s[28:31], s57 offen offset:0 nt lds
    v_add_u32 v44, 49152, v44
    v_add_u32 v45, 49152, v45
    v_mfma_f32_16x16x32_bf16 v[100:103], a[96:99], a[48:51], 0
    s_cmp_eq_u32 s0, 0
    s_cbranch_scc0 L_g2
    s_waitcnt vmcnt(8)
L_g2:
    buffer_load_dwordx4 v17, s[28:31], s57 offen offset:1024 nt lds
    v_add_u32 v46, 49152, v46
    v_add_u32 v47, 49152, v47
    v_mfma_f32_16x16x32_bf16 v[96:99], a[100:103], a[100:103], v[96:99]
    s_cmp_eq_u32 s0, 0
    s_cbranch_scc0 L_g3
    s_waitcnt vmcnt(8)
L_g3:
    buffer_load_dwordx4 v18, s[28:31], s57 offen offset:2048 nt lds
    v_add_u32 v48, 49152, v48
    v_add_u32 v49, 49152, v49
    v_mfma_f32_16x16x32_bf16 v[100:103], a[100:103], a[52:55], v[100:103]
    v_mfma_f32_16x16x32_bf16 v[96:99], a[104:107], a[104:107], v[96:99]
    v_mfma_f32_16x16x32_bf16 v[100:103], a[104:107], a[56:59], v[100:103]
    v_mfma_f32_16x16x32_bf16 v[96:99], a[108:111], a[108:111], v[96:99]
    v_mfma_f32_16x16x32_bf16 v[100:103], a[108:111], a[60:63], v[100:103]
    v_mfma_f32_16x16x32_bf16 v[96:99], a[112:115], a[112:115], v[96:99]
    v_mfma_f32_16x16x32_bf16 v[100:103], a[112:115], a[64:67], v[100:103]
    v_mfma_f32_16x16x32_bf16 v[96:99], a[116:119], a[116:119], v[96:99]
    v_mfma_f32_16x16x32_bf16 v[100:103], a[116:119], a[68:71], v[100:103]
    v_mfma_f32_16x16x32_bf16 v[92:95], a[96:99], v[52:55], v[80:83]
    v_mfma_f32_16x16x32_bf16 v[92:95], a[100:103], v[52:55], v[92:95]
    v_mfma_f32_16x16x32_bf16 v[92:95], a[104:107], v[52:55], v[92:95]
    v_mfma_f32_16x16x32_bf16 v[92:95], a[108:111], v[52:55], v[92:95]
    s_nop 3
    v_fma_f32 v96, v100, 2.0, v96
    v_fma_f32 v97, v101, 2.0, v97
    v_mfma_f32_16x16x32_bf16 v[92:95], a[112:115], v[52:55], v[92:95]
    s_cmp_eq_u32 s0, 0
    s_cbranch_scc0 L_g4
    s_waitcnt vmcnt(8)
L_g4:
    buffer_load_dwordx4 v19, s[28:31], s57 offen offset:3072 nt lds
    v_fma_f32 v98, v102, 2.0, v98
    v_fma_f32 v99, v103, 2.0, v99
    v_mfma_f32_16x16x32_bf16 v[92:95], a[116:119], v[52:55], v[92:95]
    v_cndmask_b32 v3, 0, v96, s[44:45]
    v_cndmask_b32 v3, v3, v97, s[46:47]
    v_mfma_f32_16x16x32_bf16 v[112:115], a[120:123], a[120:123], v[84:87]
    v_cndmask_b32 v3, v3, v98, s[48:49]
    v_cndmask_b32 v3, v3, v99, s[50:51]
    v_mfma_f32_16x16x32_bf16 v[116:119], a[120:123], a[48:51], 0
    s_nop 0
    s_nop 0
    v_mfma_f32_16x16x32_bf16 v[112:115], a[124:127], a[124:127], v[112:115]
    v_mfma_f32_16x16x4_f32 v[120:123], v3, v60, v[56:59]
    v_mfma_f32_16x16x32_bf16 v[116:119], a[124:127], a[52:55], v[116:119]
    v_mfma_f32_16x16x32_bf16 v[112:115], a[128:131], a[128:131], v[112:115]
    v_mfma_f32_16x16x32_bf16 v[116:119], a[128:131], a[56:59], v[116:119]
    v_mfma_f32_16x16x32_bf16 v[112:115], a[132:135], a[132:135], v[112:115]
    s_nop 5
    v_fma_f32 v128, -v92, v92, v120
    v_fma_f32 v129, -v93, v93, v121
    v_mfma_f32_16x16x32_bf16 v[116:119], a[132:135], a[60:63], v[116:119]
    v_fma_f32 v130, -v94, v94, v122
    v_fma_f32 v131, -v95, v95, v123
    v_mfma_f32_16x16x32_bf16 v[112:115], a[136:139], a[136:139], v[112:115]
    v_max_f32 v128, v128, v56
    v_max_f32 v129, v129, v56
    v_mfma_f32_16x16x32_bf16 v[116:119], a[136:139], a[64:67], v[116:119]
    s_cmp_eq_u32 s0, 0
    s_cbranch_scc0 L_g5
    s_waitcnt vmcnt(8)
L_g5:
    s_add_u32 m0, s40, 4096
    s_nop 0
    buffer_load_dwordx4 v20, s[28:31], s57 offen offset:0 nt lds
    v_max_f32 v130, v130, v56
    v_max_f32 v131, v131, v56
    v_mfma_f32_16x16x32_bf16 v[112:115], a[140:143], a[140:143], v[112:115]
    v_rsq_f32 v128, v128
    v_mfma_f32_16x16x32_bf16 v[116:119], a[140:143], a[68:71], v[116:119]
    v_rsq_f32 v129, v129
    v_mfma_f32_16x16x32_bf16 v[108:111], a[120:123], v[52:55], v[80:83]
    v_rsq_f32 v130, v130
    v_mfma_f32_16x16x32_bf16 v[108:111], a[124:127], v[52:55], v[108:111]
    v_rsq_f32 v131, v131
    v_mfma_f32_16x16x32_bf16 v[108:111], a[128:131], v[52:55], v[108:111]
    v_mfma_f32_16x16x32_bf16 v[108:111], a[132:135], v[52:55], v[108:111]
    v_mfma_f32_16x16x32_bf16 v[108:111], a[136:139], v[52:55], v[108:111]
    v_fma_f32 v112, v116, 2.0, v112
    v_fma_f32 v113, v117, 2.0, v113
    v_mfma_f32_16x16x32_bf16 v[108:111], a[140:143], v[52:55], v[108:111]
    v_fma_f32 v114, v118, 2.0, v114
    v_fma_f32 v115, v119, 2.0, v115
    v_cndmask_b32 v4, 0, v112, s[44:45]
    v_cndmask_b32 v4, v4, v113, s[46:47]
    v_cndmask_b32 v4, v4, v114, s[48:49]
    v_cndmask_b32 v4, v4, v115, s[50:51]
    s_nop 0
    s_nop 0
    v_mfma_f32_16x16x4_f32 v[124:127], v4, v60, v[56:59]
    s_nop 9
    v_fma_f32 v132, -v108, v108, v124
    v_fma_f32 v133, -v109, v109, v125
    v_fma_f32 v134, -v110, v110, v126
    v_fma_f32 v135, -v111, v111, v127
    v_max_f32 v132, v132, v56
    v_max_f32 v133, v133, v56
    v_max_f32 v134, v134, v56
    v_max_f32 v135, v135, v56
    v_rsq_f32 v132, v132
    v_rsq_f32 v133, v133
    v_rsq_f32 v134, v134
    v_rsq_f32 v135, v135
    s_mul_i32 s56, s3, 1536
    v_lshlrev_b32 v5, 3, v0
    v_add_u32 v5, 153600, v5
    v_add_u32 v4, s56, v5
    s_cmp_eq_u32 s0, 0
    s_cbranch_scc0 L_g6
    s_waitcnt vmcnt(8)
L_g6:
    buffer_load_dwordx4 v21, s[28:31], s57 offen offset:1024 nt lds
    s_cmp_eq_u32 s0, 0
    s_cbranch_scc0 L_g7
    s_waitcnt vmcnt(8)
L_g7:
    s_add_u32 m0, s41, 0
    s_add_u32 s58, s37, 12582912
    buffer_load_dwordx4 v22, s[24:27], s58 offen offset:0 nt lds
    s_cmp_eq_u32 s0, 0
    s_cbranch_scc0 L_g8
    s_waitcnt vmcnt(8)
L_g8:
    buffer_load_dwordx4 v23, s[24:27], s58 offen offset:1024 nt lds
    s_cmp_eq_u32 s0, 0
    s_cbranch_scc0 L_g9
    s_waitcnt vmcnt(8)
L_g9:
    buffer_load_dwordx4 v24, s[24:27], s58 offen offset:2048 nt lds
    s_cmp_eq_u32 s0, 0
    s_cbranch_scc0 L_g10
    s_waitcnt vmcnt(8)
L_g10:
    buffer_load_dwordx4 v25, s[24:27], s58 offen offset:3072 nt lds
    s_cmp_eq_u32 s0, 0
    s_cbranch_scc0 L_g11
    s_waitcnt vmcnt(8)
L_g11:
    s_add_u32 m0, s41, 4096
    s_nop 0
    buffer_load_dwordx4 v26, s[24:27], s58 offen offset:0 nt lds
    s_cmp_eq_u32 s0, 0
    s_cbranch_scc0 L_g12
    s_waitcnt vmcnt(8)
L_g12:
    buffer_load_dwordx4 v27, s[24:27], s58 offen offset:1024 nt lds
    s_waitcnt vmcnt(12)
    v_xor_b32 v1, s39, v138
    v_xor_b32 v2, s39, v142
    v_xor_b32 v3, s39, v146
    v_or3_b32 v1, v1, v2, v3
    v_cmp_ne_u32 vcc, 0, v1
    s_cbranch_vccnz L_qk_retry
L_qk_ok:
    ds_write_b64 v4, v[136:137] offset:0
    ds_write_b64 v4, v[140:141] offset:512
    ds_write_b64 v4, v[144:145] offset:1024
    s_waitcnt lgkmcnt(0)
    s_barrier
    ds_read2st64_b64 v[136:139], v5 offset0:0 offset1:1
    ds_read2st64_b64 v[140:143], v5 offset0:2 offset1:3
    ds_read2st64_b64 v[144:147], v5 offset0:4 offset1:5
    ds_read2st64_b64 v[148:151], v5 offset0:6 offset1:7
    ds_read2st64_b64 v[152:155], v5 offset0:8 offset1:9
    ds_read2st64_b64 v[156:159], v5 offset0:10 offset1:11
    s_waitcnt lgkmcnt(5)
    v_mfma_f32_16x16x32_bf16 v[120:123], v[52:55], v[136:139], 0
    s_cmp_eq_u32 s0, 0
    s_cbranch_scc0 L_g13
    s_waitcnt vmcnt(8)
L_g13:
    buffer_load_dwordx4 v28, s[24:27], s58 offen offset:2048 nt lds
    v_mfma_f32_16x16x32_bf16 v[76:79], a[48:51], v[136:139], 0
    s_waitcnt lgkmcnt(4)
    v_mfma_f32_16x16x32_bf16 v[120:123], v[52:55], v[140:143], v[120:123]
    v_mfma_f32_16x16x32_bf16 v[76:79], a[52:55], v[140:143], v[76:79]
    s_waitcnt lgkmcnt(3)
    v_mfma_f32_16x16x32_bf16 v[120:123], v[52:55], v[144:147], v[120:123]
    v_mfma_f32_16x16x32_bf16 v[76:79], a[56:59], v[144:147], v[76:79]
    s_waitcnt lgkmcnt(2)
    v_mfma_f32_16x16x32_bf16 v[120:123], v[52:55], v[148:151], v[120:123]
    v_mfma_f32_16x16x32_bf16 v[76:79], a[60:63], v[148:151], v[76:79]
    s_waitcnt lgkmcnt(1)
    v_mfma_f32_16x16x32_bf16 v[120:123], v[52:55], v[152:155], v[120:123]
    s_cmp_eq_u32 s0, 0
    s_cbranch_scc0 L_g14
    s_waitcnt vmcnt(8)
L_g14:
    buffer_load_dwordx4 v29, s[24:27], s58 offen offset:3072 nt lds
    v_mfma_f32_16x16x32_bf16 v[76:79], a[64:67], v[152:155], v[76:79]
    s_waitcnt lgkmcnt(0)
    v_mfma_f32_16x16x32_bf16 v[120:123], v[52:55], v[156:159], v[120:123]
    v_mfma_f32_16x16x32_bf16 v[76:79], a[68:71], v[156:159], v[76:79]
    s_nop 6
    v_mul_f32 v61, 0x3baaaaab, v120
    v_mfma_f32_16x16x32_bf16 v[88:91], a[96:99], v[136:139], v[76:79]
    v_mov_b32 v9, 0
    v_mfma_f32_16x16x32_bf16 v[88:91], a[100:103], v[140:143], v[88:91]
    v_mfma_f32_16x16x32_bf16 v[88:91], a[104:107], v[144:147], v[88:91]
    v_mfma_f32_16x16x32_bf16 v[88:91], a[108:111], v[148:151], v[88:91]
    v_mfma_f32_16x16x32_bf16 v[88:91], a[112:115], v[152:155], v[88:91]
    v_mfma_f32_16x16x32_bf16 v[88:91], a[116:119], v[156:159], v[88:91]
    ds_write_b32 v254, v9 offset:4096
    ds_write_b32 v254, v9 offset:4100
    v_mfma_f32_16x16x32_bf16 v[104:107], a[120:123], v[136:139], v[76:79]
    v_mfma_f32_16x16x32_bf16 v[104:107], a[124:127], v[140:143], v[104:107]
    v_mfma_f32_16x16x32_bf16 v[104:107], a[128:131], v[144:147], v[104:107]
    v_mfma_f32_16x16x32_bf16 v[104:107], a[132:135], v[148:151], v[104:107]
    s_nop 1
    v_fma_f32 v88, -v92, v61, v88
    v_fma_f32 v89, -v93, v61, v89
    v_mfma_f32_16x16x32_bf16 v[104:107], a[136:139], v[152:155], v[104:107]
    s_cmp_eq_u32 s0, 0
    s_cbranch_scc0 L_g15
    s_waitcnt vmcnt(8)
L_g15:
    s_add_u32 m0, s41, 8192
    s_nop 0
    buffer_load_dwordx4 v30, s[24:27], s58 offen offset:0 nt lds
    v_fma_f32 v90, -v94, v61, v90
    v_fma_f32 v91, -v95, v61, v91
    v_mfma_f32_16x16x32_bf16 v[104:107], a[140:143], v[156:159], v[104:107]
    v_mul_f32 v88, v88, v128
    v_mul_f32 v89, v89, v129
    v_mul_f32 v90, v90, v130
    v_mul_f32 v91, v91, v131
    v_max3_f32 v1, v88, v89, v90
    v_max_f32 v1, v1, v91
    s_nop 1
    v_fma_f32 v104, -v108, v61, v104
    v_fma_f32 v105, -v109, v61, v105
    v_fma_f32 v106, -v110, v61, v106
    v_fma_f32 v107, -v111, v61, v107
    v_mul_f32 v104, v104, v132
    v_mul_f32 v105, v105, v133
    v_mul_f32 v106, v106, v134
    v_mul_f32 v107, v107, v135
    v_max3_f32 v1, v1, v104, v105
    v_max3_f32 v1, v1, v106, v107
    v_mov_b32 v2, v1
    s_nop 1
    v_permlane32_swap_b32 v1, v2
    v_max_f32 v1, v1, v2
    v_mov_b32 v2, v1
    s_nop 1
    v_permlane16_swap_b32 v1, v2
    v_max_f32 v1, v1, v2
    ds_write_b32 v239, v1
    s_waitcnt lgkmcnt(0)
    s_barrier
    ds_read_b32 v12, v240 offset:0
    ds_read_b32 v13, v240 offset:1024
    ds_read_b32 v14, v240 offset:2048
    ds_read_b32 v15, v240 offset:3072
    s_cmp_eq_u32 s0, 0
    s_cbranch_scc0 L_g16
    s_waitcnt vmcnt(8)
L_g16:
    buffer_load_dwordx4 v31, s[24:27], s58 offen offset:1024 nt lds
    s_waitcnt lgkmcnt(0)
    v_max3_f32 v1, v12, v13, v14
    v_max_f32 v1, v1, v15
    v_sub_f32 v88, v88, v1
    v_sub_f32 v89, v89, v1
    v_sub_f32 v90, v90, v1
    v_sub_f32 v91, v91, v1
    v_sub_f32 v104, v104, v1
    v_sub_f32 v105, v105, v1
    v_sub_f32 v106, v106, v1
    v_sub_f32 v107, v107, v1
    v_sub_f32 v62, 0, v1
    v_sub_f32 v255, 0, v1
    v_exp_f32 v96, v88
    v_exp_f32 v97, v89
    v_exp_f32 v98, v90
    v_exp_f32 v99, v91
    v_mul_f32 v88, v96, v128
    v_mul_f32 v89, v97, v129
    v_mul_f32 v90, v98, v130
    v_mul_f32 v91, v99, v131
    v_exp_f32 v112, v104
    v_exp_f32 v113, v105
    v_exp_f32 v114, v106
    v_exp_f32 v115, v107
    v_cvt_pk_bf16_f32 v72, v88, v89
    v_cvt_pk_bf16_f32 v73, v90, v91
    v_mul_f32 v104, v112, v132
    v_mul_f32 v105, v113, v133
    v_mul_f32 v106, v114, v134
    v_mul_f32 v107, v115, v135
    v_cvt_pk_bf16_f32 v74, v104, v105
    v_cvt_pk_bf16_f32 v75, v106, v107
    ds_write_b128 v237, v[72:75] offset:0
    v_mov_b32 v63, v96
    v_mul_f32 v64, v88, v92
    v_add_f32 v63, v63, v97
    v_fmac_f32 v64, v89, v93
    v_add_f32 v63, v63, v98
    v_fmac_f32 v64, v90, v94
    v_add_f32 v63, v63, v99
    v_fmac_f32 v64, v91, v95
    v_mov_b32 v68, v88
    v_mov_b32 v69, v89
    v_mov_b32 v70, v90
    v_mov_b32 v71, v91
    s_waitcnt lgkmcnt(0)
    s_barrier
    ds_read_b128 v[92:95], v253 offset:0
    ds_read_b128 v[96:99], v253 offset:1024
    ds_read_b128 v[100:103], v253 offset:2048
    ds_read_b128 v[116:119], v253 offset:3072
    s_waitcnt lgkmcnt(3)
    v_mfma_f32_16x16x32_bf16 a[0:3], a[144:147], v[92:95], 0
    s_cmp_eq_u32 s0, 0
    s_cbranch_scc0 L_g17
    s_waitcnt vmcnt(8)
L_g17:
    buffer_load_dwordx4 v32, s[24:27], s58 offen offset:2048 nt lds
    v_add_f32 v68, v68, v104
    v_add_f32 v69, v69, v105
    v_mfma_f32_16x16x32_bf16 a[4:7], a[160:163], v[92:95], 0
    s_cmp_eq_u32 s0, 0
    s_cbranch_scc0 L_g18
    s_waitcnt vmcnt(8)
L_g18:
    buffer_load_dwordx4 v33, s[24:27], s58 offen offset:3072 nt lds
    v_add_f32 v70, v70, v106
    v_add_f32 v71, v71, v107
    v_mfma_f32_16x16x32_bf16 a[8:11], a[176:179], v[92:95], 0
    v_add_f32 v63, v63, v112
    v_fma_f32 v64, v104, v108, v64
    s_waitcnt lgkmcnt(2)
    v_mfma_f32_16x16x32_bf16 a[0:3], a[148:151], v[96:99], a[0:3]
    v_add_f32 v63, v63, v113
    v_fma_f32 v64, v105, v109, v64
    v_mfma_f32_16x16x32_bf16 a[4:7], a[164:167], v[96:99], a[4:7]
    v_add_f32 v63, v63, v114
    v_fma_f32 v64, v106, v110, v64
    v_mfma_f32_16x16x32_bf16 a[8:11], a[180:183], v[96:99], a[8:11]
    v_add_f32 v63, v63, v115
    v_fma_f32 v64, v107, v111, v64
    s_waitcnt lgkmcnt(1)
    v_mfma_f32_16x16x32_bf16 a[0:3], a[152:155], v[100:103], a[0:3]
    v_mfma_f32_16x16x32_bf16 a[4:7], a[168:171], v[100:103], a[4:7]
    v_mfma_f32_16x16x32_bf16 a[8:11], a[184:187], v[100:103], a[8:11]
    s_waitcnt lgkmcnt(0)
    v_mfma_f32_16x16x32_bf16 a[0:3], a[156:159], v[116:119], a[0:3]
    v_mfma_f32_16x16x32_bf16 a[4:7], a[172:175], v[116:119], a[4:7]
    v_mfma_f32_16x16x32_bf16 a[8:11], a[188:191], v[116:119], a[8:11]
    s_barrier
    ds_read_b128 a[96:99], v40 offset:49152
    ds_read_b128 a[100:103], v41 offset:49152
    ds_read_b128 a[104:107], v42 offset:49152
    ds_read_b128 a[108:111], v43 offset:49152
    ds_read_b128 a[112:115], v40 offset:49408
    ds_read_b128 a[116:119], v41 offset:49408
    ds_read_b128 a[120:123], v42 offset:49408
    ds_read_b128 a[124:127], v43 offset:49408
    ds_read_b128 a[128:131], v40 offset:49664
    ds_read_b128 a[132:135], v41 offset:49664
    ds_read_b128 a[136:139], v42 offset:49664
    ds_read_b128 a[140:143], v43 offset:49664
    s_waitcnt lgkmcnt(11)
    v_mfma_f32_16x16x32_bf16 v[96:99], a[96:99], a[96:99], v[84:87]
    ds_read_b64_tr_b16 a[144:145], v44 offset:0
    ds_read_b64_tr_b16 a[146:147], v45 offset:0
    v_mfma_f32_16x16x32_bf16 v[100:103], a[96:99], a[48:51], 0
    ds_read_b64_tr_b16 a[148:149], v44 offset:12288
    ds_read_b64_tr_b16 a[150:151], v45 offset:12288
    s_waitcnt lgkmcnt(14)
    v_mfma_f32_16x16x32_bf16 v[96:99], a[100:103], a[100:103], v[96:99]
    ds_read_b64_tr_b16 a[152:153], v44 offset:24576
    ds_read_b64_tr_b16 a[154:155], v45 offset:24576
    v_mfma_f32_16x16x32_bf16 v[100:103], a[100:103], a[52:55], v[100:103]
    ds_read_b64_tr_b16 a[156:157], v44 offset:36864
    ds_read_b64_tr_b16 a[158:159], v45 offset:36864
    s_waitcnt lgkmcnt(15)
    v_mfma_f32_16x16x32_bf16 v[96:99], a[104:107], a[104:107], v[96:99]
    ds_read_b64_tr_b16 a[160:161], v46 offset:0
    ds_read_b64_tr_b16 a[162:163], v47 offset:0
    v_mfma_f32_16x16x32_bf16 v[100:103], a[104:107], a[56:59], v[100:103]
    ds_read_b64_tr_b16 a[164:165], v46 offset:12288
    ds_read_b64_tr_b16 a[166:167], v47 offset:12288
    v_mfma_f32_16x16x32_bf16 v[96:99], a[108:111], a[108:111], v[96:99]
    ds_read_b64_tr_b16 a[168:169], v46 offset:24576
    ds_read_b64_tr_b16 a[170:171], v47 offset:24576
    v_mfma_f32_16x16x32_bf16 v[100:103], a[108:111], a[60:63], v[100:103]
    ds_read_b64_tr_b16 a[172:173], v46 offset:36864
    ds_read_b64_tr_b16 a[174:175], v47 offset:36864
    v_mfma_f32_16x16x32_bf16 v[96:99], a[112:115], a[112:115], v[96:99]
    ds_read_b64_tr_b16 a[176:177], v48 offset:0
    ds_read_b64_tr_b16 a[178:179], v49 offset:0
    v_mfma_f32_16x16x32_bf16 v[100:103], a[112:115], a[64:67], v[100:103]
    ds_read_b64_tr_b16 a[180:181], v48 offset:12288
    ds_read_b64_tr_b16 a[182:183], v49 offset:12288
    s_waitcnt lgkmcnt(15)
    v_mfma_f32_16x16x32_bf16 v[96:99], a[116:119], a[116:119], v[96:99]
    ds_read_b64_tr_b16 a[184:185], v48 offset:24576
    ds_read_b64_tr_b16 a[186:187], v49 offset:24576
    v_mfma_f32_16x16x32_bf16 v[100:103], a[116:119], a[68:71], v[100:103]
    ds_read_b64_tr_b16 a[188:189], v48 offset:36864
    ds_read_b64_tr_b16 a[190:191], v49 offset:36864
    v_mfma_f32_16x16x32_bf16 v[92:95], a[96:99], v[52:55], v[80:83]
    v_mfma_f32_16x16x32_bf16 v[92:95], a[100:103], v[52:55], v[92:95]
    v_mfma_f32_16x16x32_bf16 v[92:95], a[104:107], v[52:55], v[92:95]
    v_mfma_f32_16x16x32_bf16 v[92:95], a[108:111], v[52:55], v[92:95]
    s_nop 1
    v_fma_f32 v96, v100, 2.0, v96
    v_fma_f32 v97, v101, 2.0, v97
    v_mfma_f32_16x16x32_bf16 v[92:95], a[112:115], v[52:55], v[92:95]
    v_fma_f32 v98, v102, 2.0, v98
    v_fma_f32 v99, v103, 2.0, v99
    v_mfma_f32_16x16x32_bf16 v[92:95], a[116:119], v[52:55], v[92:95]
    v_cndmask_b32 v3, 0, v96, s[44:45]
    v_cndmask_b32 v3, v3, v97, s[46:47]
    v_mfma_f32_16x16x32_bf16 v[88:91], a[96:99], v[136:139], v[76:79]
    v_cndmask_b32 v3, v3, v98, s[48:49]
    v_cndmask_b32 v3, v3, v99, s[50:51]
    v_mfma_f32_16x16x32_bf16 v[88:91], a[100:103], v[140:143], v[88:91]
    s_nop 0
    s_nop 0
    v_mfma_f32_16x16x32_bf16 v[88:91], a[104:107], v[144:147], v[88:91]
    v_mfma_f32_16x16x4_f32 v[120:123], v3, v60, v[56:59]
    v_mfma_f32_16x16x32_bf16 v[88:91], a[108:111], v[148:151], v[88:91]
    v_mfma_f32_16x16x32_bf16 v[88:91], a[112:115], v[152:155], v[88:91]
    v_mfma_f32_16x16x32_bf16 v[88:91], a[116:119], v[156:159], v[88:91]
    s_waitcnt lgkmcnt(0)
    s_barrier
    v_mfma_f32_16x16x32_bf16 v[112:115], a[120:123], a[120:123], v[84:87]
    s_cmp_eq_u32 s0, 0
    s_cbranch_scc0 L_g19
    s_waitcnt vmcnt(8)
L_g19:
    s_add_u32 m0, s42, 0
    s_add_u32 s59, s37, 12779520
    buffer_load_dwordx4 v22, s[24:27], s59 offen offset:0 nt lds
    v_mfma_f32_16x16x32_bf16 v[116:119], a[120:123], a[48:51], 0
    s_cmp_eq_u32 s0, 0
    s_cbranch_scc0 L_g20
    s_waitcnt vmcnt(8)
L_g20:
    buffer_load_dwordx4 v23, s[24:27], s59 offen offset:1024 nt lds
    v_mfma_f32_16x16x32_bf16 v[112:115], a[124:127], a[124:127], v[112:115]
    s_cmp_eq_u32 s0, 0
    s_cbranch_scc0 L_g21
    s_waitcnt vmcnt(8)
L_g21:
    buffer_load_dwordx4 v24, s[24:27], s59 offen offset:2048 nt lds
    v_mfma_f32_16x16x32_bf16 v[116:119], a[124:127], a[52:55], v[116:119]
    s_cmp_eq_u32 s0, 0
    s_cbranch_scc0 L_g22
    s_waitcnt vmcnt(8)
L_g22:
    buffer_load_dwordx4 v25, s[24:27], s59 offen offset:3072 nt lds
    v_fma_f32 v128, -v92, v92, v120
    v_fma_f32 v129, -v93, v93, v121
    v_mfma_f32_16x16x32_bf16 v[112:115], a[128:131], a[128:131], v[112:115]
    v_fma_f32 v130, -v94, v94, v122
    v_fma_f32 v131, -v95, v95, v123
    v_mfma_f32_16x16x32_bf16 v[116:119], a[128:131], a[56:59], v[116:119]
    v_max_f32 v128, v128, v56
    v_max_f32 v129, v129, v56
    v_mfma_f32_16x16x32_bf16 v[112:115], a[132:135], a[132:135], v[112:115]
    v_max_f32 v130, v130, v56
    v_max_f32 v131, v131, v56
    v_mfma_f32_16x16x32_bf16 v[116:119], a[132:135], a[60:63], v[116:119]
    s_cmp_eq_u32 s0, 0
    s_cbranch_scc0 L_g23
    s_waitcnt vmcnt(8)
L_g23:
    s_add_u32 m0, s42, 4096
    s_nop 0
    buffer_load_dwordx4 v26, s[24:27], s59 offen offset:0 nt lds
    v_rsq_f32 v128, v128
    v_mfma_f32_16x16x32_bf16 v[112:115], a[136:139], a[136:139], v[112:115]
    v_rsq_f32 v129, v129
    v_mfma_f32_16x16x32_bf16 v[116:119], a[136:139], a[64:67], v[116:119]
    v_rsq_f32 v130, v130
    v_mfma_f32_16x16x32_bf16 v[112:115], a[140:143], a[140:143], v[112:115]
    v_rsq_f32 v131, v131
    v_mfma_f32_16x16x32_bf16 v[116:119], a[140:143], a[68:71], v[116:119]
    v_fma_f32 v88, -v92, v61, v88
    v_fma_f32 v89, -v93, v61, v89
    v_mfma_f32_16x16x32_bf16 v[108:111], a[120:123], v[52:55], v[80:83]
    v_fma_f32 v90, -v94, v61, v90
    v_fma_f32 v91, -v95, v61, v91
    v_mfma_f32_16x16x32_bf16 v[108:111], a[124:127], v[52:55], v[108:111]
    v_fma_f32 v88, v88, v128, v62
    v_fma_f32 v89, v89, v129, v62
    v_mfma_f32_16x16x32_bf16 v[108:111], a[128:131], v[52:55], v[108:111]
    v_fma_f32 v90, v90, v130, v62
    v_fma_f32 v91, v91, v131, v62
    v_mfma_f32_16x16x32_bf16 v[108:111], a[132:135], v[52:55], v[108:111]
    v_max3_f32 v1, v88, v89, v90
    v_max_f32 v1, v1, v91
    v_mfma_f32_16x16x32_bf16 v[108:111], a[136:139], v[52:55], v[108:111]
    v_cmp_lt_f32 vcc, s52, v1
    s_cbranch_vccnz L_site0
L_back0:
    v_mfma_f32_16x16x32_bf16 v[108:111], a[140:143], v[52:55], v[108:111]
    v_exp_f32 v96, v88
    v_mfma_f32_16x16x32_bf16 v[104:107], a[120:123], v[136:139], v[76:79]
    v_exp_f32 v97, v89
    v_mfma_f32_16x16x32_bf16 v[104:107], a[124:127], v[140:143], v[104:107]
    v_exp_f32 v98, v90
    v_mfma_f32_16x16x32_bf16 v[104:107], a[128:131], v[144:147], v[104:107]
    s_cmp_eq_u32 s0, 0
    s_cbranch_scc0 L_g24
    s_waitcnt vmcnt(8)
L_g24:
    buffer_load_dwordx4 v27, s[24:27], s59 offen offset:1024 nt lds
    v_exp_f32 v99, v91
    v_mfma_f32_16x16x32_bf16 v[104:107], a[132:135], v[148:151], v[104:107]
    v_mul_f32 v88, v96, v128
    v_mul_f32 v89, v97, v129
    v_mfma_f32_16x16x32_bf16 v[104:107], a[136:139], v[152:155], v[104:107]
    v_mul_f32 v90, v98, v130
    v_mul_f32 v91, v99, v131
    v_mfma_f32_16x16x32_bf16 v[104:107], a[140:143], v[156:159], v[104:107]
    v_fma_f32 v112, v116, 2.0, v112
    v_fma_f32 v113, v117, 2.0, v113
    v_fma_f32 v114, v118, 2.0, v114
    v_fma_f32 v115, v119, 2.0, v115
    v_cndmask_b32 v4, 0, v112, s[44:45]
    v_cndmask_b32 v4, v4, v113, s[46:47]
    v_cndmask_b32 v4, v4, v114, s[48:49]
    v_cndmask_b32 v4, v4, v115, s[50:51]
    v_add_f32 v63, v63, v96
    v_fmac_f32 v64, v88, v92
    v_mfma_f32_16x16x4_f32 v[124:127], v4, v60, v[56:59]
    v_add_f32 v63, v63, v97
    v_fmac_f32 v64, v89, v93
    v_add_f32 v63, v63, v98
    v_fmac_f32 v64, v90, v94
    v_add_f32 v63, v63, v99
    v_fmac_f32 v64, v91, v95
    v_add_f32 v68, v68, v88
    v_add_f32 v69, v69, v89
    v_add_f32 v70, v70, v90
    v_add_f32 v71, v71, v91
    v_add_u32 v44, -49152, v44
    v_add_u32 v45, -49152, v45
    v_add_u32 v46, -49152, v46
    v_add_u32 v47, -49152, v47
    v_add_u32 v48, -49152, v48
    v_add_u32 v49, -49152, v49
    v_fma_f32 v132, -v108, v108, v124
    v_fma_f32 v133, -v109, v109, v125
    v_fma_f32 v134, -v110, v110, v126
    v_fma_f32 v135, -v111, v111, v127
    v_max_f32 v132, v132, v56
    v_max_f32 v133, v133, v56
    v_max_f32 v134, v134, v56
    v_max_f32 v135, v135, v56
    v_rsq_f32 v132, v132
    v_rsq_f32 v133, v133
    v_rsq_f32 v134, v134
    v_rsq_f32 v135, v135
    s_cmp_eq_u32 s0, 0
    s_cbranch_scc0 L_g25
    s_waitcnt vmcnt(8)
L_g25:
    buffer_load_dwordx4 v28, s[24:27], s59 offen offset:2048 nt lds
    v_fma_f32 v104, -v108, v61, v104
    v_fma_f32 v105, -v109, v61, v105
    v_fma_f32 v106, -v110, v61, v106
    v_fma_f32 v107, -v111, v61, v107
    v_fma_f32 v104, v104, v132, v62
    v_fma_f32 v105, v105, v133, v62
    v_fma_f32 v106, v106, v134, v62
    v_fma_f32 v107, v107, v135, v62
    v_max3_f32 v1, v104, v105, v106
    v_max_f32 v1, v1, v107
    v_cmp_lt_f32 vcc, s52, v1
    s_cbranch_vccnz L_site1
L_back1:
    v_exp_f32 v112, v104
    v_exp_f32 v113, v105
    v_exp_f32 v114, v106
    v_exp_f32 v115, v107
    v_cvt_pk_bf16_f32 v72, v88, v89
    v_cvt_pk_bf16_f32 v73, v90, v91
    v_mul_f32 v104, v112, v132
    v_mul_f32 v105, v113, v133
    v_mul_f32 v106, v114, v134
    v_mul_f32 v107, v115, v135
    v_cvt_pk_bf16_f32 v74, v104, v105
    v_cvt_pk_bf16_f32 v75, v106, v107
    ds_write_b128 v237, v[72:75] offset:0
    v_add_f32 v68, v68, v104
    v_add_f32 v69, v69, v105
    v_add_f32 v70, v70, v106
    v_add_f32 v71, v71, v107
    v_cvt_pk_bf16_f32 v66, v68, v69
    v_cvt_pk_bf16_f32 v67, v70, v71
    ds_write_b64 v238, v[66:67]
    s_cmp_eq_u32 s0, 0
    s_cbranch_scc0 L_g26
    s_waitcnt vmcnt(8)
L_g26:
    buffer_load_dwordx4 v29, s[24:27], s59 offen offset:3072 nt lds
    s_waitcnt vmcnt(20)
    s_waitcnt lgkmcnt(0)
    s_barrier
L_post3:
    ds_read_b32 v9, v254 offset:4096
    ds_read_b64 v[120:121], v254 offset:0
    ds_read_b64 v[122:123], v254 offset:512
    ds_read_b64 v[124:125], v254 offset:1024
    ds_read_b64 v[126:127], v254 offset:1536
    ds_read_b128 v[92:95], v253 offset:0
    ds_read_b128 v[96:99], v253 offset:1024
    ds_read_b128 v[100:103], v253 offset:2048
    ds_read_b128 v[116:119], v253 offset:3072
    ds_read_b128 a[48:51], v34 offset:0
    ds_read_b128 a[52:55], v35 offset:0
    ds_read_b128 a[56:59], v34 offset:128
    ds_read_b128 a[60:63], v35 offset:128
    ds_read_b128 a[64:67], v34 offset:256
    ds_read_b128 a[68:71], v35 offset:256
    s_waitcnt lgkmcnt(14)
    v_cmp_ne_u32 vcc, 0, v9
    s_cbranch_vccnz L_xt3
    s_waitcnt lgkmcnt(12)
    v_mfma_f32_16x16x32_bf16 a[0:3], a[72:75], v[120:123], a[0:3]
    v_add_f32 v63, v63, v112
    v_fma_f32 v64, v104, v108, v64
    v_mfma_f32_16x16x32_bf16 a[4:7], a[80:83], v[120:123], a[4:7]
    v_add_f32 v63, v63, v113
    v_fma_f32 v64, v105, v109, v64
    v_mfma_f32_16x16x32_bf16 a[8:11], a[88:91], v[120:123], a[8:11]
    s_cmp_eq_u32 s0, 0
    s_cbranch_scc0 L_g27
    s_waitcnt vmcnt(8)
L_g27:
    s_add_u32 m0, s42, 8192
    s_nop 0
    buffer_load_dwordx4 v30, s[24:27], s59 offen offset:0 nt lds
    v_add_f32 v63, v63, v114
    v_fma_f32 v64, v106, v110, v64
    s_waitcnt lgkmcnt(10)
    v_mfma_f32_16x16x32_bf16 a[0:3], a[76:79], v[124:127], a[0:3]
    v_add_f32 v63, v63, v115
    v_fma_f32 v64, v107, v111, v64
    v_mfma_f32_16x16x32_bf16 a[4:7], a[84:87], v[124:127], a[4:7]
    v_mfma_f32_16x16x32_bf16 a[8:11], a[92:95], v[124:127], a[8:11]
    s_waitcnt lgkmcnt(9)
    v_mfma_f32_16x16x32_bf16 a[0:3], a[144:147], v[92:95], a[0:3]
    ds_read_b64_tr_b16 a[72:73], v36 offset:0
    ds_read_b64_tr_b16 a[74:75], v36 offset:6144
    v_mfma_f32_16x16x32_bf16 a[4:7], a[160:163], v[92:95], a[4:7]
    ds_read_b64_tr_b16 a[76:77], v36 offset:12288
    ds_read_b64_tr_b16 a[78:79], v36 offset:18432
    v_mfma_f32_16x16x32_bf16 a[8:11], a[176:179], v[92:95], a[8:11]
    ds_read_b64_tr_b16 a[80:81], v37 offset:0
    ds_read_b64_tr_b16 a[82:83], v37 offset:6144
    s_waitcnt lgkmcnt(14)
    v_mfma_f32_16x16x32_bf16 a[0:3], a[148:151], v[96:99], a[0:3]
    ds_read_b64_tr_b16 a[84:85], v37 offset:12288
    ds_read_b64_tr_b16 a[86:87], v37 offset:18432
    v_mfma_f32_16x16x32_bf16 a[4:7], a[164:167], v[96:99], a[4:7]
    ds_read_b64_tr_b16 a[88:89], v38 offset:0
    ds_read_b64_tr_b16 a[90:91], v38 offset:6144
    v_mfma_f32_16x16x32_bf16 a[8:11], a[180:183], v[96:99], a[8:11]
    ds_read_b64_tr_b16 a[92:93], v38 offset:12288
    ds_read_b64_tr_b16 a[94:95], v38 offset:18432
    s_waitcnt lgkmcnt(15)
    v_mfma_f32_16x16x32_bf16 a[0:3], a[152:155], v[100:103], a[0:3]
    s_cmp_eq_u32 s0, 0
    s_cbranch_scc0 L_g28
    s_waitcnt vmcnt(8)
L_g28:
    buffer_load_dwordx4 v31, s[24:27], s59 offen offset:1024 nt lds
    v_mfma_f32_16x16x32_bf16 a[4:7], a[168:171], v[100:103], a[4:7]
    v_mfma_f32_16x16x32_bf16 a[8:11], a[184:187], v[100:103], a[8:11]
    v_mfma_f32_16x16x32_bf16 a[0:3], a[156:159], v[116:119], a[0:3]
    v_mfma_f32_16x16x32_bf16 a[4:7], a[172:175], v[116:119], a[4:7]
    v_mfma_f32_16x16x32_bf16 a[8:11], a[188:191], v[116:119], a[8:11]
    v_mfma_f32_16x16x32_bf16 v[84:87], a[48:51], a[48:51], 0
    v_mfma_f32_16x16x32_bf16 v[80:83], a[48:51], v[52:55], 0
    v_mfma_f32_16x16x32_bf16 v[84:87], a[52:55], a[52:55], v[84:87]
    v_mfma_f32_16x16x32_bf16 v[80:83], a[52:55], v[52:55], v[80:83]
    v_mfma_f32_16x16x32_bf16 v[84:87], a[56:59], a[56:59], v[84:87]
    v_mfma_f32_16x16x32_bf16 v[80:83], a[56:59], v[52:55], v[80:83]
    s_waitcnt lgkmcnt(14)
    v_mfma_f32_16x16x32_bf16 v[84:87], a[60:63], a[60:63], v[84:87]
    v_mfma_f32_16x16x32_bf16 v[80:83], a[60:63], v[52:55], v[80:83]
    s_waitcnt lgkmcnt(13)
    v_mfma_f32_16x16x32_bf16 v[84:87], a[64:67], a[64:67], v[84:87]
    s_cmp_eq_u32 s0, 0
    s_cbranch_scc0 L_g29
    s_waitcnt vmcnt(8)
L_g29:
    buffer_load_dwordx4 v32, s[24:27], s59 offen offset:2048 nt lds
    v_mfma_f32_16x16x32_bf16 v[80:83], a[64:67], v[52:55], v[80:83]
    s_waitcnt lgkmcnt(12)
    v_mfma_f32_16x16x32_bf16 v[84:87], a[68:71], a[68:71], v[84:87]
    v_mfma_f32_16x16x32_bf16 v[80:83], a[68:71], v[52:55], v[80:83]
    s_waitcnt lgkmcnt(0)
    v_mfma_f32_16x16x32_bf16 v[76:79], a[48:51], v[136:139], 0
    v_mfma_f32_16x16x32_bf16 v[76:79], a[52:55], v[140:143], v[76:79]
    v_mfma_f32_16x16x32_bf16 v[76:79], a[56:59], v[144:147], v[76:79]
    v_mfma_f32_16x16x32_bf16 v[76:79], a[60:63], v[148:151], v[76:79]
    v_mfma_f32_16x16x32_bf16 v[76:79], a[64:67], v[152:155], v[76:79]
    v_mfma_f32_16x16x32_bf16 v[76:79], a[68:71], v[156:159], v[76:79]
    v_lshrrev_b32 v1, 3, v0
    v_and_b32 v2, 6, v1
    v_xor_b32 v2, v0, v2
    v_and_b32 v2, 7, v2
    v_mul_u32_u24 v1, 768, v1
    v_lshl_add_u32 v224, v2, 4, v1
    v_xor_b32 v225, 16, v224
    v_add_u32 v225, 5120, v225
    s_cmp_eq_u32 s0, 0
    s_cbranch_scc0 L_g30
    s_waitcnt vmcnt(8)
L_g30:
    buffer_load_dwordx4 v33, s[24:27], s59 offen offset:3072 nt lds
    s_waitcnt vmcnt(12)
    s_barrier
    ds_read_b128 a[96:99], v40 offset:0
    ds_read_b128 a[100:103], v41 offset:0
    ds_read_b128 a[104:107], v42 offset:0
    ds_read_b128 a[108:111], v43 offset:0
    ds_read_b128 a[112:115], v40 offset:256
    ds_read_b128 a[116:119], v41 offset:256
    ds_read_b128 a[120:123], v42 offset:256
    ds_read_b128 a[124:127], v43 offset:256
    ds_read_b128 a[128:131], v40 offset:512
    ds_read_b128 a[132:135], v41 offset:512
    ds_read_b128 a[136:139], v42 offset:512
    ds_read_b128 a[140:143], v43 offset:512
    s_waitcnt lgkmcnt(11)
    v_mfma_f32_16x16x32_bf16 v[96:99], a[96:99], a[96:99], v[84:87]
    ds_read_b64_tr_b16 a[144:145], v44 offset:0
    ds_read_b64_tr_b16 a[146:147], v45 offset:0
    v_mfma_f32_16x16x32_bf16 v[100:103], a[96:99], a[48:51], 0
    ds_read_b64_tr_b16 a[148:149], v44 offset:12288
    ds_read_b64_tr_b16 a[150:151], v45 offset:12288
    s_waitcnt lgkmcnt(14)
    v_mfma_f32_16x16x32_bf16 v[96:99], a[100:103], a[100:103], v[96:99]
    ds_read_b64_tr_b16 a[152:153], v44 offset:24576
    ds_read_b64_tr_b16 a[154:155], v45 offset:24576
    v_mfma_f32_16x16x32_bf16 v[100:103], a[100:103], a[52:55], v[100:103]
    ds_read_b64_tr_b16 a[156:157], v44 offset:36864
    ds_read_b64_tr_b16 a[158:159], v45 offset:36864
    s_waitcnt lgkmcnt(15)
    v_mfma_f32_16x16x32_bf16 v[96:99], a[104:107], a[104:107], v[96:99]
    ds_read_b64_tr_b16 a[160:161], v46 offset:0
    ds_read_b64_tr_b16 a[162:163], v47 offset:0
    v_mfma_f32_16x16x32_bf16 v[100:103], a[104:107], a[56:59], v[100:103]
    s_cmp_eq_u32 s0, 0
    s_cbranch_scc0 L_g31
    s_waitcnt vmcnt(8)
L_g31:
    s_add_u32 m0, s40, 0
    s_add_u32 s57, s36, 6291456
    buffer_load_dwordx4 v16, s[28:31], s57 offen offset:0 nt lds
    ds_read_b64_tr_b16 a[164:165], v46 offset:12288
    ds_read_b64_tr_b16 a[166:167], v47 offset:12288
    v_mfma_f32_16x16x32_bf16 v[96:99], a[108:111], a[108:111], v[96:99]
    ds_read_b64_tr_b16 a[168:169], v46 offset:24576
    ds_read_b64_tr_b16 a[170:171], v47 offset:24576
    v_mfma_f32_16x16x32_bf16 v[100:103], a[108:111], a[60:63], v[100:103]
    ds_read_b64_tr_b16 a[172:173], v46 offset:36864
    ds_read_b64_tr_b16 a[174:175], v47 offset:36864
    v_mfma_f32_16x16x32_bf16 v[96:99], a[112:115], a[112:115], v[96:99]
    ds_read_b64_tr_b16 a[176:177], v48 offset:0
    ds_read_b64_tr_b16 a[178:179], v49 offset:0
    v_mfma_f32_16x16x32_bf16 v[100:103], a[112:115], a[64:67], v[100:103]
    ds_read_b64_tr_b16 a[180:181], v48 offset:12288
    ds_read_b64_tr_b16 a[182:183], v49 offset:12288
    s_waitcnt lgkmcnt(15)
    v_mfma_f32_16x16x32_bf16 v[96:99], a[116:119], a[116:119], v[96:99]
    ds_read_b64_tr_b16 a[184:185], v48 offset:24576
    ds_read_b64_tr_b16 a[186:187], v49 offset:24576
    v_mfma_f32_16x16x32_bf16 v[100:103], a[116:119], a[68:71], v[100:103]
    ds_read_b64_tr_b16 a[188:189], v48 offset:36864
    ds_read_b64_tr_b16 a[190:191], v49 offset:36864
    v_mfma_f32_16x16x32_bf16 v[92:95], a[96:99], v[52:55], v[80:83]
    v_mfma_f32_16x16x32_bf16 v[92:95], a[100:103], v[52:55], v[92:95]
    v_mfma_f32_16x16x32_bf16 v[92:95], a[104:107], v[52:55], v[92:95]
    v_mfma_f32_16x16x32_bf16 v[92:95], a[108:111], v[52:55], v[92:95]
    s_nop 1
    v_fma_f32 v96, v100, 2.0, v96
    v_fma_f32 v97, v101, 2.0, v97
    v_mfma_f32_16x16x32_bf16 v[92:95], a[112:115], v[52:55], v[92:95]
    s_cmp_eq_u32 s0, 0
    s_cbranch_scc0 L_g32
    s_waitcnt vmcnt(8)
L_g32:
    buffer_load_dwordx4 v17, s[28:31], s57 offen offset:1024 nt lds
    v_fma_f32 v98, v102, 2.0, v98
    v_fma_f32 v99, v103, 2.0, v99
    v_mfma_f32_16x16x32_bf16 v[92:95], a[116:119], v[52:55], v[92:95]
    v_cndmask_b32 v3, 0, v96, s[44:45]
    v_cndmask_b32 v3, v3, v97, s[46:47]
    v_mfma_f32_16x16x32_bf16 v[88:91], a[96:99], v[136:139], v[76:79]
    v_cndmask_b32 v3, v3, v98, s[48:49]
    v_cndmask_b32 v3, v3, v99, s[50:51]
    v_mfma_f32_16x16x32_bf16 v[88:91], a[100:103], v[140:143], v[88:91]
    s_nop 0
    s_nop 0
    v_mfma_f32_16x16x32_bf16 v[88:91], a[104:107], v[144:147], v[88:91]
    v_mfma_f32_16x16x4_f32 v[120:123], v3, v60, v[56:59]
    v_mfma_f32_16x16x32_bf16 v[88:91], a[108:111], v[148:151], v[88:91]
    v_mfma_f32_16x16x32_bf16 v[88:91], a[112:115], v[152:155], v[88:91]
    v_mfma_f32_16x16x32_bf16 v[88:91], a[116:119], v[156:159], v[88:91]
    v_mfma_f32_16x16x32_bf16 v[112:115], a[120:123], a[120:123], v[84:87]
    v_mfma_f32_16x16x32_bf16 v[116:119], a[120:123], a[48:51], 0
    v_mfma_f32_16x16x32_bf16 v[112:115], a[124:127], a[124:127], v[112:115]
    v_mfma_f32_16x16x32_bf16 v[116:119], a[124:127], a[52:55], v[116:119]
    s_cmp_eq_u32 s0, 0
    s_cbranch_scc0 L_g33
    s_waitcnt vmcnt(8)
L_g33:
    buffer_load_dwordx4 v18, s[28:31], s57 offen offset:2048 nt lds
    v_fma_f32 v128, -v92, v92, v120
    v_fma_f32 v129, -v93, v93, v121
    v_mfma_f32_16x16x32_bf16 v[112:115], a[128:131], a[128:131], v[112:115]
    v_fma_f32 v130, -v94, v94, v122
    v_fma_f32 v131, -v95, v95, v123
    v_mfma_f32_16x16x32_bf16 v[116:119], a[128:131], a[56:59], v[116:119]
    v_max_f32 v128, v128, v56
    v_max_f32 v129, v129, v56
    v_mfma_f32_16x16x32_bf16 v[112:115], a[132:135], a[132:135], v[112:115]
    v_max_f32 v130, v130, v56
    v_max_f32 v131, v131, v56
    v_mfma_f32_16x16x32_bf16 v[116:119], a[132:135], a[60:63], v[116:119]
    v_rsq_f32 v128, v128
    v_mfma_f32_16x16x32_bf16 v[112:115], a[136:139], a[136:139], v[112:115]
    v_rsq_f32 v129, v129
    v_mfma_f32_16x16x32_bf16 v[116:119], a[136:139], a[64:67], v[116:119]
    v_rsq_f32 v130, v130
    v_mfma_f32_16x16x32_bf16 v[112:115], a[140:143], a[140:143], v[112:115]
    v_rsq_f32 v131, v131
    v_mfma_f32_16x16x32_bf16 v[116:119], a[140:143], a[68:71], v[116:119]
    v_fma_f32 v88, -v92, v61, v88
    v_fma_f32 v89, -v93, v61, v89
    v_mfma_f32_16x16x32_bf16 v[108:111], a[120:123], v[52:55], v[80:83]
    v_fma_f32 v90, -v94, v61, v90
    v_fma_f32 v91, -v95, v61, v91
    v_mfma_f32_16x16x32_bf16 v[108:111], a[124:127], v[52:55], v[108:111]
    v_fma_f32 v88, v88, v128, v62
    v_fma_f32 v89, v89, v129, v62
    v_mfma_f32_16x16x32_bf16 v[108:111], a[128:131], v[52:55], v[108:111]
    v_fma_f32 v90, v90, v130, v62
    v_fma_f32 v91, v91, v131, v62
    v_mfma_f32_16x16x32_bf16 v[108:111], a[132:135], v[52:55], v[108:111]
    v_max3_f32 v1, v88, v89, v90
    v_max_f32 v1, v1, v91
    v_mfma_f32_16x16x32_bf16 v[108:111], a[136:139], v[52:55], v[108:111]
    s_cmp_eq_u32 s0, 0
    s_cbranch_scc0 L_g34
    s_waitcnt vmcnt(8)
L_g34:
    buffer_load_dwordx4 v19, s[28:31], s57 offen offset:3072 nt lds
    v_cmp_lt_f32 vcc, s52, v1
    s_cbranch_vccnz L_site2
L_back2:
    v_mfma_f32_16x16x32_bf16 v[108:111], a[140:143], v[52:55], v[108:111]
    v_exp_f32 v96, v88
    v_mfma_f32_16x16x32_bf16 v[104:107], a[120:123], v[136:139], v[76:79]
    v_exp_f32 v97, v89
    v_mfma_f32_16x16x32_bf16 v[104:107], a[124:127], v[140:143], v[104:107]
    v_exp_f32 v98, v90
    v_mfma_f32_16x16x32_bf16 v[104:107], a[128:131], v[144:147], v[104:107]
    v_exp_f32 v99, v91
    v_mfma_f32_16x16x32_bf16 v[104:107], a[132:135], v[148:151], v[104:107]
    v_mul_f32 v88, v96, v128
    v_mul_f32 v89, v97, v129
    v_mfma_f32_16x16x32_bf16 v[104:107], a[136:139], v[152:155], v[104:107]
    v_mul_f32 v90, v98, v130
    v_mul_f32 v91, v99, v131
    v_mfma_f32_16x16x32_bf16 v[104:107], a[140:143], v[156:159], v[104:107]
    v_fma_f32 v112, v116, 2.0, v112
    v_fma_f32 v113, v117, 2.0, v113
    v_fma_f32 v114, v118, 2.0, v114
    v_fma_f32 v115, v119, 2.0, v115
    v_cndmask_b32 v4, 0, v112, s[44:45]
    v_cndmask_b32 v4, v4, v113, s[46:47]
    v_cndmask_b32 v4, v4, v114, s[48:49]
    v_cndmask_b32 v4, v4, v115, s[50:51]
    v_add_f32 v63, v63, v96
    v_fmac_f32 v64, v88, v92
    v_mfma_f32_16x16x4_f32 v[124:127], v4, v60, v[56:59]
    v_add_f32 v63, v63, v97
    v_fmac_f32 v64, v89, v93
    v_add_f32 v63, v63, v98
    v_fmac_f32 v64, v90, v94
    v_add_f32 v63, v63, v99
    v_fmac_f32 v64, v91, v95
    v_mov_b32 v68, v88
    v_mov_b32 v69, v89
    v_mov_b32 v70, v90
    v_mov_b32 v71, v91
    v_add_u32 v44, 49152, v44
    v_add_u32 v45, 49152, v45
    v_add_u32 v46, 49152, v46
    v_add_u32 v47, 49152, v47
    v_add_u32 v48, 49152, v48
    v_add_u32 v49, 49152, v49
    v_fma_f32 v132, -v108, v108, v124
    v_fma_f32 v133, -v109, v109, v125
    v_fma_f32 v134, -v110, v110, v126
    v_fma_f32 v135, -v111, v111, v127
    v_max_f32 v132, v132, v56
    v_max_f32 v133, v133, v56
    v_max_f32 v134, v134, v56
    v_max_f32 v135, v135, v56
    v_rsq_f32 v132, v132
    v_rsq_f32 v133, v133
    v_rsq_f32 v134, v134
    v_rsq_f32 v135, v135
    s_cmp_eq_u32 s0, 0
    s_cbranch_scc0 L_g35
    s_waitcnt vmcnt(8)
L_g35:
    s_add_u32 m0, s40, 4096
    s_nop 0
    buffer_load_dwordx4 v20, s[28:31], s57 offen offset:0 nt lds
    v_fma_f32 v104, -v108, v61, v104
    v_fma_f32 v105, -v109, v61, v105
    v_fma_f32 v106, -v110, v61, v106
    v_fma_f32 v107, -v111, v61, v107
    v_fma_f32 v104, v104, v132, v62
    v_fma_f32 v105, v105, v133, v62
    v_fma_f32 v106, v106, v134, v62
    v_fma_f32 v107, v107, v135, v62
    v_max3_f32 v1, v104, v105, v106
    v_max_f32 v1, v1, v107
    v_cmp_lt_f32 vcc, s52, v1
    s_cbranch_vccnz L_site3
L_back3:
    v_exp_f32 v112, v104
    v_exp_f32 v113, v105
    v_exp_f32 v114, v106
    v_exp_f32 v115, v107
    v_cvt_pk_bf16_f32 v72, v88, v89
    v_cvt_pk_bf16_f32 v73, v90, v91
    v_mul_f32 v104, v112, v132
    v_mul_f32 v105, v113, v133
    v_mul_f32 v106, v114, v134
    v_mul_f32 v107, v115, v135
    v_cvt_pk_bf16_f32 v74, v104, v105
    v_cvt_pk_bf16_f32 v75, v106, v107
    ds_write_b128 v237, v[72:75] offset:0
    s_waitcnt lgkmcnt(0)
    s_barrier
L_post24:
    ds_read_b32 v9, v254 offset:4096
    ds_read_b128 v[92:95], v253 offset:0
    ds_read_b128 v[96:99], v253 offset:1024
    ds_read_b128 v[100:103], v253 offset:2048
    ds_read_b128 v[116:119], v253 offset:3072
    s_waitcnt lgkmcnt(4)
    v_cmp_ne_u32 vcc, 0, v9
    s_cbranch_vccnz L_xt24
    s_waitcnt lgkmcnt(3)
    v_mfma_f32_16x16x32_bf16 a[0:3], a[144:147], v[92:95], a[0:3]
    s_cmp_eq_u32 s0, 0
    s_cbranch_scc0 L_g36
    s_waitcnt vmcnt(8)
L_g36:
    buffer_load_dwordx4 v21, s[28:31], s57 offen offset:1024 nt lds
    v_add_f32 v68, v68, v104
    v_add_f32 v69, v69, v105
    v_mfma_f32_16x16x32_bf16 a[4:7], a[160:163], v[92:95], a[4:7]
    buffer_load_dword v244, v245, s[32:35], 0 offen offset:128 sc1
    v_add_f32 v70, v70, v106
    v_add_f32 v71, v71, v107
    v_mfma_f32_16x16x32_bf16 a[8:11], a[176:179], v[92:95], a[8:11]
    v_add_f32 v63, v63, v112
    v_fma_f32 v64, v104, v108, v64
    s_waitcnt lgkmcnt(2)
    v_mfma_f32_16x16x32_bf16 a[0:3], a[148:151], v[96:99], a[0:3]
    v_add_f32 v63, v63, v113
    v_fma_f32 v64, v105, v109, v64
    v_mfma_f32_16x16x32_bf16 a[4:7], a[164:167], v[96:99], a[4:7]
    v_add_f32 v63, v63, v114
    v_fma_f32 v64, v106, v110, v64
    v_mfma_f32_16x16x32_bf16 a[8:11], a[180:183], v[96:99], a[8:11]
    v_add_f32 v63, v63, v115
    v_fma_f32 v64, v107, v111, v64
    s_waitcnt lgkmcnt(1)
    v_mfma_f32_16x16x32_bf16 a[0:3], a[152:155], v[100:103], a[0:3]
    v_mfma_f32_16x16x32_bf16 a[4:7], a[168:171], v[100:103], a[4:7]
    s_cmp_eq_u32 s0, 0
    s_cbranch_scc0 L_g37
    s_waitcnt vmcnt(8)
L_g37:
    s_add_u32 m0, s41, 0
    s_add_u32 s58, s37, 25165824
    buffer_load_dwordx4 v22, s[24:27], s58 offen offset:0 nt lds
    v_mfma_f32_16x16x32_bf16 a[8:11], a[184:187], v[100:103], a[8:11]
    s_waitcnt lgkmcnt(0)
    v_mfma_f32_16x16x32_bf16 a[0:3], a[156:159], v[116:119], a[0:3]
    v_mfma_f32_16x16x32_bf16 a[4:7], a[172:175], v[116:119], a[4:7]
    v_mfma_f32_16x16x32_bf16 a[8:11], a[188:191], v[116:119], a[8:11]
    s_cmp_eq_u32 s0, 0
    s_cbranch_scc0 L_g38
    s_waitcnt vmcnt(8)
L_g38:
    buffer_load_dwordx4 v23, s[24:27], s58 offen offset:1024 nt lds
    s_cmp_eq_u32 s0, 0
    s_cbranch_scc0 L_g39
    s_waitcnt vmcnt(8)
L_g39:
    buffer_load_dwordx4 v24, s[24:27], s58 offen offset:2048 nt lds
    s_cmp_eq_u32 s0, 0
    s_cbranch_scc0 L_g40
    s_waitcnt vmcnt(8)
L_g40:
    buffer_load_dwordx4 v25, s[24:27], s58 offen offset:3072 nt lds
    s_cmp_eq_u32 s0, 0
    s_cbranch_scc0 L_g41
    s_waitcnt vmcnt(8)
L_g41:
    s_add_u32 m0, s41, 4096
    s_nop 0
    buffer_load_dwordx4 v26, s[24:27], s58 offen offset:0 nt lds
    s_waitcnt vmcnt(12)
    s_barrier
    ds_read_b128 a[96:99], v40 offset:49152
    ds_read_b128 a[100:103], v41 offset:49152
    ds_read_b128 a[104:107], v42 offset:49152
    ds_read_b128 a[108:111], v43 offset:49152
    ds_read_b128 a[112:115], v40 offset:49408
    ds_read_b128 a[116:119], v41 offset:49408
    ds_read_b128 a[120:123], v42 offset:49408
    ds_read_b128 a[124:127], v43 offset:49408
    ds_read_b128 a[128:131], v40 offset:49664
    ds_read_b128 a[132:135], v41 offset:49664
    ds_read_b128 a[136:139], v42 offset:49664
    ds_read_b128 a[140:143], v43 offset:49664
    s_waitcnt lgkmcnt(11)
    v_mfma_f32_16x16x32_bf16 v[96:99], a[96:99], a[96:99], v[84:87]
    ds_read_b64_tr_b16 a[144:145], v44 offset:0
    ds_read_b64_tr_b16 a[146:147], v45 offset:0
    v_mfma_f32_16x16x32_bf16 v[100:103], a[96:99], a[48:51], 0
    ds_read_b64_tr_b16 a[148:149], v44 offset:12288
    ds_read_b64_tr_b16 a[150:151], v45 offset:12288
    s_waitcnt lgkmcnt(14)
    v_mfma_f32_16x16x32_bf16 v[96:99], a[100:103], a[100:103], v[96:99]
    ds_read_b64_tr_b16 a[152:153], v44 offset:24576
    ds_read_b64_tr_b16 a[154:155], v45 offset:24576
    v_mfma_f32_16x16x32_bf16 v[100:103], a[100:103], a[52:55], v[100:103]
    ds_read_b64_tr_b16 a[156:157], v44 offset:36864
    ds_read_b64_tr_b16 a[158:159], v45 offset:36864
    s_waitcnt lgkmcnt(15)
    v_mfma_f32_16x16x32_bf16 v[96:99], a[104:107], a[104:107], v[96:99]
    ds_read_b64_tr_b16 a[160:161], v46 offset:0
    ds_read_b64_tr_b16 a[162:163], v47 offset:0
    v_mfma_f32_16x16x32_bf16 v[100:103], a[104:107], a[56:59], v[100:103]
    ds_read_b64_tr_b16 a[164:165], v46 offset:12288
    ds_read_b64_tr_b16 a[166:167], v47 offset:12288
    v_mfma_f32_16x16x32_bf16 v[96:99], a[108:111], a[108:111], v[96:99]
    s_cmp_eq_u32 s0, 0
    s_cbranch_scc0 L_g42
    s_waitcnt vmcnt(8)
L_g42:
    buffer_load_dwordx4 v27, s[24:27], s58 offen offset:1024 nt lds
    ds_read_b64_tr_b16 a[168:169], v46 offset:24576
    ds_read_b64_tr_b16 a[170:171], v47 offset:24576
    v_mfma_f32_16x16x32_bf16 v[100:103], a[108:111], a[60:63], v[100:103]
    ds_read_b64_tr_b16 a[172:173], v46 offset:36864
    ds_read_b64_tr_b16 a[174:175], v47 offset:36864
    v_mfma_f32_16x16x32_bf16 v[96:99], a[112:115], a[112:115], v[96:99]
    ds_read_b64_tr_b16 a[176:177], v48 offset:0
    ds_read_b64_tr_b16 a[178:179], v49 offset:0
    v_mfma_f32_16x16x32_bf16 v[100:103], a[112:115], a[64:67], v[100:103]
    ds_read_b64_tr_b16 a[180:181], v48 offset:12288
    ds_read_b64_tr_b16 a[182:183], v49 offset:12288
    s_waitcnt lgkmcnt(15)
    v_mfma_f32_16x16x32_bf16 v[96:99], a[116:119], a[116:119], v[96:99]
    ds_read_b64_tr_b16 a[184:185], v48 offset:24576
    ds_read_b64_tr_b16 a[186:187], v49 offset:24576
    v_mfma_f32_16x16x32_bf16 v[100:103], a[116:119], a[68:71], v[100:103]
    ds_read_b64_tr_b16 a[188:189], v48 offset:36864
    ds_read_b64_tr_b16 a[190:191], v49 offset:36864
    v_mfma_f32_16x16x32_bf16 v[92:95], a[96:99], v[52:55], v[80:83]
    v_mfma_f32_16x16x32_bf16 v[92:95], a[100:103], v[52:55], v[92:95]
    v_mfma_f32_16x16x32_bf16 v[92:95], a[104:107], v[52:55], v[92:95]
    v_mfma_f32_16x16x32_bf16 v[92:95], a[108:111], v[52:55], v[92:95]
    s_nop 1
    v_fma_f32 v96, v100, 2.0, v96
    v_fma_f32 v97, v101, 2.0, v97
    v_mfma_f32_16x16x32_bf16 v[92:95], a[112:115], v[52:55], v[92:95]
    v_fma_f32 v98, v102, 2.0, v98
    v_fma_f32 v99, v103, 2.0, v99
    v_mfma_f32_16x16x32_bf16 v[92:95], a[116:119], v[52:55], v[92:95]
    v_cndmask_b32 v3, 0, v96, s[44:45]
    v_cndmask_b32 v3, v3, v97, s[46:47]
    v_mfma_f32_16x16x32_bf16 v[88:91], a[96:99], v[136:139], v[76:79]
    s_cmp_eq_u32 s0, 0
    s_cbranch_scc0 L_g43
    s_waitcnt vmcnt(8)
L_g43:
    buffer_load_dwordx4 v28, s[24:27], s58 offen offset:2048 nt lds
    v_cndmask_b32 v3, v3, v98, s[48:49]
    v_cndmask_b32 v3, v3, v99, s[50:51]
    v_mfma_f32_16x16x32_bf16 v[88:91], a[100:103], v[140:143], v[88:91]
    s_nop 0
    s_nop 0
    v_mfma_f32_16x16x32_bf16 v[88:91], a[104:107], v[144:147], v[88:91]
    v_mfma_f32_16x16x4_f32 v[120:123], v3, v60, v[56:59]
    v_mfma_f32_16x16x32_bf16 v[88:91], a[108:111], v[148:151], v[88:91]
    v_mfma_f32_16x16x32_bf16 v[88:91], a[112:115], v[152:155], v[88:91]
    v_mfma_f32_16x16x32_bf16 v[88:91], a[116:119], v[156:159], v[88:91]
    v_mfma_f32_16x16x32_bf16 v[112:115], a[120:123], a[120:123], v[84:87]
    v_mfma_f32_16x16x32_bf16 v[116:119], a[120:123], a[48:51], 0
    v_mfma_f32_16x16x32_bf16 v[112:115], a[124:127], a[124:127], v[112:115]
    v_mfma_f32_16x16x32_bf16 v[116:119], a[124:127], a[52:55], v[116:119]
    s_nop 2
    v_fma_f32 v128, -v92, v92, v120
    v_fma_f32 v129, -v93, v93, v121
    v_mfma_f32_16x16x32_bf16 v[112:115], a[128:131], a[128:131], v[112:115]
    v_fma_f32 v130, -v94, v94, v122
    v_fma_f32 v131, -v95, v95, v123
    v_mfma_f32_16x16x32_bf16 v[116:119], a[128:131], a[56:59], v[116:119]
    s_cmp_eq_u32 s0, 0
    s_cbranch_scc0 L_g44
    s_waitcnt vmcnt(8)
L_g44:
    buffer_load_dwordx4 v29, s[24:27], s58 offen offset:3072 nt lds
    v_max_f32 v128, v128, v56
    v_max_f32 v129, v129, v56
    v_mfma_f32_16x16x32_bf16 v[112:115], a[132:135], a[132:135], v[112:115]
    v_max_f32 v130, v130, v56
    v_max_f32 v131, v131, v56
    v_mfma_f32_16x16x32_bf16 v[116:119], a[132:135], a[60:63], v[116:119]
    v_rsq_f32 v128, v128
    v_mfma_f32_16x16x32_bf16 v[112:115], a[136:139], a[136:139], v[112:115]
    v_rsq_f32 v129, v129
    v_mfma_f32_16x16x32_bf16 v[116:119], a[136:139], a[64:67], v[116:119]
    v_rsq_f32 v130, v130
    v_mfma_f32_16x16x32_bf16 v[112:115], a[140:143], a[140:143], v[112:115]
    v_rsq_f32 v131, v131
    v_mfma_f32_16x16x32_bf16 v[116:119], a[140:143], a[68:71], v[116:119]
    v_fma_f32 v88, -v92, v61, v88
    v_fma_f32 v89, -v93, v61, v89
    v_mfma_f32_16x16x32_bf16 v[108:111], a[120:123], v[52:55], v[80:83]
    v_fma_f32 v90, -v94, v61, v90
    v_fma_f32 v91, -v95, v61, v91
    v_mfma_f32_16x16x32_bf16 v[108:111], a[124:127], v[52:55], v[108:111]
    v_fma_f32 v88, v88, v128, v62
    v_fma_f32 v89, v89, v129, v62
    v_mfma_f32_16x16x32_bf16 v[108:111], a[128:131], v[52:55], v[108:111]
    v_fma_f32 v90, v90, v130, v62
    v_fma_f32 v91, v91, v131, v62
    v_mfma_f32_16x16x32_bf16 v[108:111], a[132:135], v[52:55], v[108:111]
    v_max3_f32 v1, v88, v89, v90
    v_max_f32 v1, v1, v91
    v_mfma_f32_16x16x32_bf16 v[108:111], a[136:139], v[52:55], v[108:111]
    v_cmp_lt_f32 vcc, s52, v1
    s_cbranch_vccnz L_site4
L_back4:
    v_mfma_f32_16x16x32_bf16 v[108:111], a[140:143], v[52:55], v[108:111]
    v_exp_f32 v96, v88
    v_mfma_f32_16x16x32_bf16 v[104:107], a[120:123], v[136:139], v[76:79]
    s_cmp_eq_u32 s0, 0
    s_cbranch_scc0 L_g45
    s_waitcnt vmcnt(8)
L_g45:
    s_add_u32 m0, s41, 8192
    s_nop 0
    buffer_load_dwordx4 v30, s[24:27], s58 offen offset:0 nt lds
    v_exp_f32 v97, v89
    v_mfma_f32_16x16x32_bf16 v[104:107], a[124:127], v[140:143], v[104:107]
    v_exp_f32 v98, v90
    v_mfma_f32_16x16x32_bf16 v[104:107], a[128:131], v[144:147], v[104:107]
    v_exp_f32 v99, v91
    v_mfma_f32_16x16x32_bf16 v[104:107], a[132:135], v[148:151], v[104:107]
    v_mul_f32 v88, v96, v128
    v_mul_f32 v89, v97, v129
    v_mfma_f32_16x16x32_bf16 v[104:107], a[136:139], v[152:155], v[104:107]
    v_mul_f32 v90, v98, v130
    v_mul_f32 v91, v99, v131
    v_mfma_f32_16x16x32_bf16 v[104:107], a[140:143], v[156:159], v[104:107]
    v_fma_f32 v112, v116, 2.0, v112
    v_fma_f32 v113, v117, 2.0, v113
    v_fma_f32 v114, v118, 2.0, v114
    v_fma_f32 v115, v119, 2.0, v115
    v_cndmask_b32 v4, 0, v112, s[44:45]
    v_cndmask_b32 v4, v4, v113, s[46:47]
    v_cndmask_b32 v4, v4, v114, s[48:49]
    v_cndmask_b32 v4, v4, v115, s[50:51]
    v_add_f32 v63, v63, v96
    v_fmac_f32 v64, v88, v92
    v_mfma_f32_16x16x4_f32 v[124:127], v4, v60, v[56:59]
    v_add_f32 v63, v63, v97
    v_fmac_f32 v64, v89, v93
    v_add_f32 v63, v63, v98
    v_fmac_f32 v64, v90, v94
    v_add_f32 v63, v63, v99
    v_fmac_f32 v64, v91, v95
    v_add_f32 v68, v68, v88
    v_add_f32 v69, v69, v89
    v_add_f32 v70, v70, v90
    v_add_f32 v71, v71, v91
    v_add_u32 v44, -49152, v44
    v_add_u32 v45, -49152, v45
    v_add_u32 v46, -49152, v46
    v_add_u32 v47, -49152, v47
    v_add_u32 v48, -49152, v48
    v_add_u32 v49, -49152, v49
    v_fma_f32 v132, -v108, v108, v124
    v_fma_f32 v133, -v109, v109, v125
    v_fma_f32 v134, -v110, v110, v126
    v_fma_f32 v135, -v111, v111, v127
    v_max_f32 v132, v132, v56
    v_max_f32 v133, v133, v56
    v_max_f32 v134, v134, v56
    v_max_f32 v135, v135, v56
    v_rsq_f32 v132, v132
    v_rsq_f32 v133, v133
    v_rsq_f32 v134, v134
    v_rsq_f32 v135, v135
    s_cmp_eq_u32 s0, 0
    s_cbranch_scc0 L_g46
    s_waitcnt vmcnt(8)
L_g46:
    buffer_load_dwordx4 v31, s[24:27], s58 offen offset:1024 nt lds
    v_fma_f32 v104, -v108, v61, v104
    v_fma_f32 v105, -v109, v61, v105
    v_fma_f32 v106, -v110, v61, v106
    v_fma_f32 v107, -v111, v61, v107
    v_fma_f32 v104, v104, v132, v62
    v_fma_f32 v105, v105, v133, v62
    v_fma_f32 v106, v106, v134, v62
    v_fma_f32 v107, v107, v135, v62
    v_max3_f32 v1, v104, v105, v106
    v_max_f32 v1, v1, v107
    v_cmp_lt_f32 vcc, s52, v1
    s_cbranch_vccnz L_site5
L_back5:
    v_exp_f32 v112, v104
    v_exp_f32 v113, v105
    v_exp_f32 v114, v106
    v_exp_f32 v115, v107
    v_cvt_pk_bf16_f32 v72, v88, v89
    v_cvt_pk_bf16_f32 v73, v90, v91
    v_mul_f32 v104, v112, v132
    v_mul_f32 v105, v113, v133
    v_mul_f32 v106, v114, v134
    v_mul_f32 v107, v115, v135
    v_cvt_pk_bf16_f32 v74, v104, v105
    v_cvt_pk_bf16_f32 v75, v106, v107
    ds_write_b128 v237, v[72:75] offset:0
    v_add_f32 v68, v68, v104
    v_add_f32 v69, v69, v105
    v_add_f32 v70, v70, v106
    v_add_f32 v71, v71, v107
    v_cvt_pk_bf16_f32 v66, v68, v69
    v_cvt_pk_bf16_f32 v67, v70, v71
    ds_write_b64 v238, v[66:67]
    s_cmp_eq_u32 s0, 0
    s_cbranch_scc0 L_g47
    s_waitcnt vmcnt(8)
L_g47:
    buffer_load_dwordx4 v32, s[24:27], s58 offen offset:2048 nt lds
    s_cmp_eq_u32 s0, 0
    s_cbranch_scc0 L_g48
    s_waitcnt vmcnt(8)
L_g48:
    buffer_load_dwordx4 v33, s[24:27], s58 offen offset:3072 nt lds
    s_waitcnt vmcnt(13)
    s_waitcnt vmcnt(12)
    v_cmp_ne_u32 vcc, s39, v244
    s_cbranch_vccnz L_fl_retry
L_fl_ok:
    s_waitcnt lgkmcnt(0)
    s_barrier
L_post6:
    ds_read_b32 v9, v254 offset:4096
    ds_read_b64 v[120:121], v254 offset:0
    ds_read_b64 v[122:123], v254 offset:512
    ds_read_b64 v[124:125], v254 offset:1024
    ds_read_b64 v[126:127], v254 offset:1536
    ds_read_b128 v[92:95], v253 offset:0
    ds_read_b128 v[96:99], v253 offset:1024
    ds_read_b128 v[100:103], v253 offset:2048
    ds_read_b128 v[116:119], v253 offset:3072
    ds_read_b128 a[48:51], v34 offset:0
    ds_read_b128 a[52:55], v35 offset:0
    ds_read_b128 a[56:59], v34 offset:128
    ds_read_b128 a[60:63], v35 offset:128
    ds_read_b128 a[64:67], v34 offset:256
    ds_read_b128 a[68:71], v35 offset:256
    s_waitcnt lgkmcnt(14)
    v_cmp_ne_u32 vcc, 0, v9
    s_cbranch_vccnz L_xt6
    s_waitcnt lgkmcnt(12)
    v_mfma_f32_16x16x32_bf16 a[0:3], a[72:75], v[120:123], a[0:3]
    s_cmp_eq_u32 s0, 0
    s_cbranch_scc0 L_g49
    s_waitcnt vmcnt(8)
L_g49:
    s_add_u32 m0, s42, 0
    s_add_u32 s59, s37, 25362432
    buffer_load_dwordx4 v22, s[24:27], s59 offen offset:0 nt lds
    v_add_f32 v63, v63, v112
    v_fma_f32 v64, v104, v108, v64
    v_mfma_f32_16x16x32_bf16 a[4:7], a[80:83], v[120:123], a[4:7]
    v_add_f32 v63, v63, v113
    v_fma_f32 v64, v105, v109, v64
    v_mfma_f32_16x16x32_bf16 a[8:11], a[88:91], v[120:123], a[8:11]
    v_add_f32 v63, v63, v114
    v_fma_f32 v64, v106, v110, v64
    s_waitcnt lgkmcnt(10)
    v_mfma_f32_16x16x32_bf16 a[0:3], a[76:79], v[124:127], a[0:3]
    v_add_f32 v63, v63, v115
    v_fma_f32 v64, v107, v111, v64
    v_mfma_f32_16x16x32_bf16 a[4:7], a[84:87], v[124:127], a[4:7]
    v_mfma_f32_16x16x32_bf16 a[8:11], a[92:95], v[124:127], a[8:11]
    s_waitcnt lgkmcnt(9)
    v_mfma_f32_16x16x32_bf16 a[0:3], a[144:147], v[92:95], a[0:3]
    ds_read_b64_tr_b16 a[72:73], v36 offset:0
    ds_read_b64_tr_b16 a[74:75], v36 offset:6144
    v_mfma_f32_16x16x32_bf16 a[4:7], a[160:163], v[92:95], a[4:7]
    ds_read_b64_tr_b16 a[76:77], v36 offset:12288
    ds_read_b64_tr_b16 a[78:79], v36 offset:18432
    v_mfma_f32_16x16x32_bf16 a[8:11], a[176:179], v[92:95], a[8:11]
    ds_read_b64_tr_b16 a[80:81], v37 offset:0
    ds_read_b64_tr_b16 a[82:83], v37 offset:6144
    s_waitcnt lgkmcnt(14)
    v_mfma_f32_16x16x32_bf16 a[0:3], a[148:151], v[96:99], a[0:3]
    s_cmp_eq_u32 s0, 0
    s_cbranch_scc0 L_g50
    s_waitcnt vmcnt(8)
L_g50:
    buffer_load_dwordx4 v23, s[24:27], s59 offen offset:1024 nt lds
    ds_read_b64_tr_b16 a[84:85], v37 offset:12288
    ds_read_b64_tr_b16 a[86:87], v37 offset:18432
    v_mfma_f32_16x16x32_bf16 a[4:7], a[164:167], v[96:99], a[4:7]
    ds_read_b64_tr_b16 a[88:89], v38 offset:0
    ds_read_b64_tr_b16 a[90:91], v38 offset:6144
    v_mfma_f32_16x16x32_bf16 a[8:11], a[180:183], v[96:99], a[8:11]
    ds_read_b64_tr_b16 a[92:93], v38 offset:12288
    ds_read_b64_tr_b16 a[94:95], v38 offset:18432
    s_waitcnt lgkmcnt(15)
    v_mfma_f32_16x16x32_bf16 a[0:3], a[152:155], v[100:103], a[0:3]
    v_mfma_f32_16x16x32_bf16 a[4:7], a[168:171], v[100:103], a[4:7]
    v_mfma_f32_16x16x32_bf16 a[8:11], a[184:187], v[100:103], a[8:11]
    v_mfma_f32_16x16x32_bf16 a[0:3], a[156:159], v[116:119], a[0:3]
    v_mfma_f32_16x16x32_bf16 a[4:7], a[172:175], v[116:119], a[4:7]
    v_mfma_f32_16x16x32_bf16 a[8:11], a[188:191], v[116:119], a[8:11]
    v_mfma_f32_16x16x32_bf16 v[84:87], a[48:51], a[48:51], 0
    v_mfma_f32_16x16x32_bf16 v[80:83], a[48:51], v[52:55], 0
    v_mfma_f32_16x16x32_bf16 v[84:87], a[52:55], a[52:55], v[84:87]
    v_mfma_f32_16x16x32_bf16 v[80:83], a[52:55], v[52:55], v[80:83]
    v_mfma_f32_16x16x32_bf16 v[84:87], a[56:59], a[56:59], v[84:87]
    s_add_u32 s61, s60, 3145728
    buffer_load_dwordx4 v[160:163], v65, s[72:75], s61 offen offset:0 sc1
    v_mfma_f32_16x16x32_bf16 v[80:83], a[56:59], v[52:55], v[80:83]
    s_waitcnt lgkmcnt(14)
    v_mfma_f32_16x16x32_bf16 v[84:87], a[60:63], a[60:63], v[84:87]
    v_mfma_f32_16x16x32_bf16 v[80:83], a[60:63], v[52:55], v[80:83]
    s_waitcnt lgkmcnt(13)
    v_mfma_f32_16x16x32_bf16 v[84:87], a[64:67], a[64:67], v[84:87]
    v_mfma_f32_16x16x32_bf16 v[80:83], a[64:67], v[52:55], v[80:83]
    s_waitcnt lgkmcnt(12)
    v_mfma_f32_16x16x32_bf16 v[84:87], a[68:71], a[68:71], v[84:87]
    v_mfma_f32_16x16x32_bf16 v[80:83], a[68:71], v[52:55], v[80:83]
    s_waitcnt lgkmcnt(0)
    v_mfma_f32_16x16x32_bf16 v[76:79], a[48:51], v[136:139], 0
    v_mfma_f32_16x16x32_bf16 v[76:79], a[52:55], v[140:143], v[76:79]
    v_mfma_f32_16x16x32_bf16 v[76:79], a[56:59], v[144:147], v[76:79]
    v_mfma_f32_16x16x32_bf16 v[76:79], a[60:63], v[148:151], v[76:79]
    v_mfma_f32_16x16x32_bf16 v[76:79], a[64:67], v[152:155], v[76:79]
    v_mfma_f32_16x16x32_bf16 v[76:79], a[68:71], v[156:159], v[76:79]
    s_cmp_eq_u32 s0, 0
    s_cbranch_scc0 L_g51
    s_waitcnt vmcnt(8)
L_g51:
    buffer_load_dwordx4 v24, s[24:27], s59 offen offset:2048 nt lds
    s_cmp_eq_u32 s0, 0
    s_cbranch_scc0 L_g52
    s_waitcnt vmcnt(8)
L_g52:
    buffer_load_dwordx4 v25, s[24:27], s59 offen offset:3072 nt lds
    s_cmp_eq_u32 s0, 0
    s_cbranch_scc0 L_g53
    s_waitcnt vmcnt(8)
L_g53:
    s_add_u32 m0, s42, 4096
    s_nop 0
    buffer_load_dwordx4 v26, s[24:27], s59 offen offset:0 nt lds
    s_cmp_eq_u32 s0, 0
    s_cbranch_scc0 L_g54
    s_waitcnt vmcnt(8)
L_g54:
    buffer_load_dwordx4 v27, s[24:27], s59 offen offset:1024 nt lds
    buffer_load_dwordx4 v[164:167], v65, s[72:75], s61 offen offset:1024 sc1
    s_cmp_eq_u32 s0, 0
    s_cbranch_scc0 L_g55
    s_waitcnt vmcnt(8)
L_g55:
    buffer_load_dwordx4 v28, s[24:27], s59 offen offset:2048 nt lds
    s_cmp_eq_u32 s0, 0
    s_cbranch_scc0 L_g56
    s_waitcnt vmcnt(8)
L_g56:
    buffer_load_dwordx4 v29, s[24:27], s59 offen offset:3072 nt lds
    s_cmp_eq_u32 s0, 0
    s_cbranch_scc0 L_g57
    s_waitcnt vmcnt(8)
L_g57:
    s_add_u32 m0, s42, 8192
    s_nop 0
    buffer_load_dwordx4 v30, s[24:27], s59 offen offset:0 nt lds
    s_cmp_eq_u32 s0, 0
    s_cbranch_scc0 L_g58
    s_waitcnt vmcnt(8)
L_g58:
    buffer_load_dwordx4 v31, s[24:27], s59 offen offset:1024 nt lds
    s_waitcnt vmcnt(12)
    s_barrier
    ds_read_b128 a[96:99], v40 offset:0
    ds_read_b128 a[100:103], v41 offset:0
    ds_read_b128 a[104:107], v42 offset:0
    ds_read_b128 a[108:111], v43 offset:0
    ds_read_b128 a[112:115], v40 offset:256
    ds_read_b128 a[116:119], v41 offset:256
    ds_read_b128 a[120:123], v42 offset:256
    ds_read_b128 a[124:127], v43 offset:256
    ds_read_b128 a[128:131], v40 offset:512
    ds_read_b128 a[132:135], v41 offset:512
    ds_read_b128 a[136:139], v42 offset:512
    ds_read_b128 a[140:143], v43 offset:512
    s_waitcnt lgkmcnt(11)
    v_mfma_f32_16x16x32_bf16 v[96:99], a[96:99], a[96:99], v[84:87]
    ds_read_b64_tr_b16 a[144:145], v44 offset:0
    ds_read_b64_tr_b16 a[146:147], v45 offset:0
    v_mfma_f32_16x16x32_bf16 v[100:103], a[96:99], a[48:51], 0
    ds_read_b64_tr_b16 a[148:149], v44 offset:12288
    ds_read_b64_tr_b16 a[150:151], v45 offset:12288
    s_waitcnt lgkmcnt(14)
    v_mfma_f32_16x16x32_bf16 v[96:99], a[100:103], a[100:103], v[96:99]
    ds_read_b64_tr_b16 a[152:153], v44 offset:24576
    ds_read_b64_tr_b16 a[154:155], v45 offset:24576
    v_mfma_f32_16x16x32_bf16 v[100:103], a[100:103], a[52:55], v[100:103]
    ds_read_b64_tr_b16 a[156:157], v44 offset:36864
    ds_read_b64_tr_b16 a[158:159], v45 offset:36864
    s_waitcnt lgkmcnt(15)
    v_mfma_f32_16x16x32_bf16 v[96:99], a[104:107], a[104:107], v[96:99]
    ds_read_b64_tr_b16 a[160:161], v46 offset:0
    ds_read_b64_tr_b16 a[162:163], v47 offset:0
    v_mfma_f32_16x16x32_bf16 v[100:103], a[104:107], a[56:59], v[100:103]
    ds_read_b64_tr_b16 a[164:165], v46 offset:12288
    ds_read_b64_tr_b16 a[166:167], v47 offset:12288
    v_mfma_f32_16x16x32_bf16 v[96:99], a[108:111], a[108:111], v[96:99]
    buffer_load_dwordx4 v[168:171], v65, s[72:75], s61 offen offset:2048 sc1
    ds_read_b64_tr_b16 a[168:169], v46 offset:24576
    ds_read_b64_tr_b16 a[170:171], v47 offset:24576
    v_mfma_f32_16x16x32_bf16 v[100:103], a[108:111], a[60:63], v[100:103]
    ds_read_b64_tr_b16 a[172:173], v46 offset:36864
    ds_read_b64_tr_b16 a[174:175], v47 offset:36864
    v_mfma_f32_16x16x32_bf16 v[96:99], a[112:115], a[112:115], v[96:99]
    ds_read_b64_tr_b16 a[176:177], v48 offset:0
    ds_read_b64_tr_b16 a[178:179], v49 offset:0
    v_mfma_f32_16x16x32_bf16 v[100:103], a[112:115], a[64:67], v[100:103]
    ds_read_b64_tr_b16 a[180:181], v48 offset:12288
    ds_read_b64_tr_b16 a[182:183], v49 offset:12288
    s_waitcnt lgkmcnt(15)
    v_mfma_f32_16x16x32_bf16 v[96:99], a[116:119], a[116:119], v[96:99]
    ds_read_b64_tr_b16 a[184:185], v48 offset:24576
    ds_read_b64_tr_b16 a[186:187], v49 offset:24576
    v_mfma_f32_16x16x32_bf16 v[100:103], a[116:119], a[68:71], v[100:103]
    ds_read_b64_tr_b16 a[188:189], v48 offset:36864
    ds_read_b64_tr_b16 a[190:191], v49 offset:36864
    v_mfma_f32_16x16x32_bf16 v[92:95], a[96:99], v[52:55], v[80:83]
    v_mfma_f32_16x16x32_bf16 v[92:95], a[100:103], v[52:55], v[92:95]
    v_mfma_f32_16x16x32_bf16 v[92:95], a[104:107], v[52:55], v[92:95]
    v_mfma_f32_16x16x32_bf16 v[92:95], a[108:111], v[52:55], v[92:95]
    s_nop 1
    v_fma_f32 v96, v100, 2.0, v96
    v_fma_f32 v97, v101, 2.0, v97
    v_mfma_f32_16x16x32_bf16 v[92:95], a[112:115], v[52:55], v[92:95]
    v_fma_f32 v98, v102, 2.0, v98
    v_fma_f32 v99, v103, 2.0, v99
    v_mfma_f32_16x16x32_bf16 v[92:95], a[116:119], v[52:55], v[92:95]
    v_cndmask_b32 v3, 0, v96, s[44:45]
    v_cndmask_b32 v3, v3, v97, s[46:47]
    v_mfma_f32_16x16x32_bf16 v[88:91], a[96:99], v[136:139], v[76:79]
    s_cmp_eq_u32 s0, 0
    s_cbranch_scc0 L_g59
    s_waitcnt vmcnt(8)
L_g59:
    buffer_load_dwordx4 v32, s[24:27], s59 offen offset:2048 nt lds
    v_cndmask_b32 v3, v3, v98, s[48:49]
    v_cndmask_b32 v3, v3, v99, s[50:51]
    v_mfma_f32_16x16x32_bf16 v[88:91], a[100:103], v[140:143], v[88:91]
    buffer_load_dwordx4 v33, s[24:27], s59 offen offset:3072 nt lds
    s_nop 0
    s_nop 0
    v_mfma_f32_16x16x32_bf16 v[88:91], a[104:107], v[144:147], v[88:91]
    v_mfma_f32_16x16x4_f32 v[120:123], v3, v60, v[56:59]
    v_mfma_f32_16x16x32_bf16 v[88:91], a[108:111], v[148:151], v[88:91]
    v_mfma_f32_16x16x32_bf16 v[88:91], a[112:115], v[152:155], v[88:91]
    v_mfma_f32_16x16x32_bf16 v[88:91], a[116:119], v[156:159], v[88:91]
    v_mfma_f32_16x16x32_bf16 v[112:115], a[120:123], a[120:123], v[84:87]
    v_mfma_f32_16x16x32_bf16 v[116:119], a[120:123], a[48:51], 0
    v_mfma_f32_16x16x32_bf16 v[112:115], a[124:127], a[124:127], v[112:115]
    v_mfma_f32_16x16x32_bf16 v[116:119], a[124:127], a[52:55], v[116:119]
    s_nop 2
    v_fma_f32 v128, -v92, v92, v120
    v_fma_f32 v129, -v93, v93, v121
    v_mfma_f32_16x16x32_bf16 v[112:115], a[128:131], a[128:131], v[112:115]
    s_add_u32 m0, s40, 0
    s_add_u32 s57, s36, 9437184
    buffer_load_dwordx4 v16, s[28:31], s57 offen offset:0 nt lds
    v_fma_f32 v130, -v94, v94, v122
    v_fma_f32 v131, -v95, v95, v123
    v_mfma_f32_16x16x32_bf16 v[116:119], a[128:131], a[56:59], v[116:119]
    v_max_f32 v128, v128, v56
    v_max_f32 v129, v129, v56
    v_mfma_f32_16x16x32_bf16 v[112:115], a[132:135], a[132:135], v[112:115]
    v_max_f32 v130, v130, v56
    v_max_f32 v131, v131, v56
    v_mfma_f32_16x16x32_bf16 v[116:119], a[132:135], a[60:63], v[116:119]
    v_rsq_f32 v128, v128
    v_mfma_f32_16x16x32_bf16 v[112:115], a[136:139], a[136:139], v[112:115]
    v_rsq_f32 v129, v129
    v_mfma_f32_16x16x32_bf16 v[116:119], a[136:139], a[64:67], v[116:119]
    v_rsq_f32 v130, v130
    v_mfma_f32_16x16x32_bf16 v[112:115], a[140:143], a[140:143], v[112:115]
    v_rsq_f32 v131, v131
    v_mfma_f32_16x16x32_bf16 v[116:119], a[140:143], a[68:71], v[116:119]
    v_fma_f32 v88, -v92, v61, v88
    v_fma_f32 v89, -v93, v61, v89
    v_mfma_f32_16x16x32_bf16 v[108:111], a[120:123], v[52:55], v[80:83]
    v_fma_f32 v90, -v94, v61, v90
    v_fma_f32 v91, -v95, v61, v91
    v_mfma_f32_16x16x32_bf16 v[108:111], a[124:127], v[52:55], v[108:111]
    v_fma_f32 v88, v88, v128, v62
    v_fma_f32 v89, v89, v129, v62
    v_mfma_f32_16x16x32_bf16 v[108:111], a[128:131], v[52:55], v[108:111]
    v_fma_f32 v90, v90, v130, v62
    v_fma_f32 v91, v91, v131, v62
    v_mfma_f32_16x16x32_bf16 v[108:111], a[132:135], v[52:55], v[108:111]
    v_max3_f32 v1, v88, v89, v90
    v_max_f32 v1, v1, v91
    v_mfma_f32_16x16x32_bf16 v[108:111], a[136:139], v[52:55], v[108:111]
    buffer_load_dwordx4 v17, s[28:31], s57 offen offset:1024 nt lds
    v_cmp_lt_f32 vcc, s52, v1
    s_cbranch_vccnz L_site6
L_back6:
    v_mfma_f32_16x16x32_bf16 v[108:111], a[140:143], v[52:55], v[108:111]
    v_exp_f32 v96, v88
    v_mfma_f32_16x16x32_bf16 v[104:107], a[120:123], v[136:139], v[76:79]
    v_exp_f32 v97, v89
    v_mfma_f32_16x16x32_bf16 v[104:107], a[124:127], v[140:143], v[104:107]
    v_exp_f32 v98, v90
    v_mfma_f32_16x16x32_bf16 v[104:107], a[128:131], v[144:147], v[104:107]
    v_exp_f32 v99, v91
    v_mfma_f32_16x16x32_bf16 v[104:107], a[132:135], v[148:151], v[104:107]
    v_mul_f32 v88, v96, v128
    v_mul_f32 v89, v97, v129
    v_mfma_f32_16x16x32_bf16 v[104:107], a[136:139], v[152:155], v[104:107]
    v_mul_f32 v90, v98, v130
    v_mul_f32 v91, v99, v131
    v_mfma_f32_16x16x32_bf16 v[104:107], a[140:143], v[156:159], v[104:107]
    v_fma_f32 v112, v116, 2.0, v112
    v_fma_f32 v113, v117, 2.0, v113
    v_fma_f32 v114, v118, 2.0, v114
    v_fma_f32 v115, v119, 2.0, v115
    v_cndmask_b32 v4, 0, v112, s[44:45]
    v_cndmask_b32 v4, v4, v113, s[46:47]
    v_cndmask_b32 v4, v4, v114, s[48:49]
    v_cndmask_b32 v4, v4, v115, s[50:51]
    v_add_f32 v63, v63, v96
    v_fmac_f32 v64, v88, v92
    v_mfma_f32_16x16x4_f32 v[124:127], v4, v60, v[56:59]
    v_add_f32 v63, v63, v97
    v_fmac_f32 v64, v89, v93
    v_add_f32 v63, v63, v98
    v_fmac_f32 v64, v90, v94
    v_add_f32 v63, v63, v99
    v_fmac_f32 v64, v91, v95
    v_mov_b32 v68, v88
    v_mov_b32 v69, v89
    v_mov_b32 v70, v90
    v_mov_b32 v71, v91
    v_add_u32 v44, 49152, v44
    v_add_u32 v45, 49152, v45
    v_add_u32 v46, 49152, v46
    v_add_u32 v47, 49152, v47
    v_add_u32 v48, 49152, v48
    v_add_u32 v49, 49152, v49
    v_fma_f32 v132, -v108, v108, v124
    v_fma_f32 v133, -v109, v109, v125
    v_fma_f32 v134, -v110, v110, v126
    v_fma_f32 v135, -v111, v111, v127
    v_max_f32 v132, v132, v56
    v_max_f32 v133, v133, v56
    v_max_f32 v134, v134, v56
    v_max_f32 v135, v135, v56
    v_rsq_f32 v132, v132
    v_rsq_f32 v133, v133
    v_rsq_f32 v134, v134
    v_rsq_f32 v135, v135
    buffer_load_dwordx4 v[172:175], v65, s[72:75], s61 offen offset:3072 sc1
    v_fma_f32 v104, -v108, v61, v104
    v_fma_f32 v105, -v109, v61, v105
    v_fma_f32 v106, -v110, v61, v106
    v_fma_f32 v107, -v111, v61, v107
    v_fma_f32 v104, v104, v132, v62
    v_fma_f32 v105, v105, v133, v62
    v_fma_f32 v106, v106, v134, v62
    v_fma_f32 v107, v107, v135, v62
    v_max3_f32 v1, v104, v105, v106
    v_max_f32 v1, v1, v107
    v_cmp_lt_f32 vcc, s52, v1
    s_cbranch_vccnz L_site7
L_back7:
    v_exp_f32 v112, v104
    v_exp_f32 v113, v105
    v_exp_f32 v114, v106
    v_exp_f32 v115, v107
    v_cvt_pk_bf16_f32 v72, v88, v89
    v_cvt_pk_bf16_f32 v73, v90, v91
    v_mul_f32 v104, v112, v132
    v_mul_f32 v105, v113, v133
    v_mul_f32 v106, v114, v134
    v_mul_f32 v107, v115, v135
    v_cvt_pk_bf16_f32 v74, v104, v105
    v_cvt_pk_bf16_f32 v75, v106, v107
    ds_write_b128 v237, v[72:75] offset:0
    s_waitcnt lgkmcnt(0)
    s_barrier
L_post27:
    ds_read_b32 v9, v254 offset:4096
    ds_read_b128 v[92:95], v253 offset:0
    ds_read_b128 v[96:99], v253 offset:1024
    ds_read_b128 v[100:103], v253 offset:2048
    ds_read_b128 v[116:119], v253 offset:3072
    s_waitcnt lgkmcnt(4)
    v_cmp_ne_u32 vcc, 0, v9
    s_cbranch_vccnz L_xt27
    s_waitcnt lgkmcnt(3)
    v_mfma_f32_16x16x32_bf16 a[0:3], a[144:147], v[92:95], a[0:3]
    buffer_load_dwordx4 v18, s[28:31], s57 offen offset:2048 nt lds
    v_add_f32 v68, v68, v104
    v_add_f32 v69, v69, v105
    v_mfma_f32_16x16x32_bf16 a[4:7], a[160:163], v[92:95], a[4:7]
    buffer_load_dwordx4 v19, s[28:31], s57 offen offset:3072 nt lds
    v_add_f32 v70, v70, v106
    v_add_f32 v71, v71, v107
    v_mfma_f32_16x16x32_bf16 a[8:11], a[176:179], v[92:95], a[8:11]
    s_add_u32 m0, s40, 4096
    s_nop 0
    buffer_load_dwordx4 v20, s[28:31], s57 offen offset:0 nt lds
    v_add_f32 v63, v63, v112
    v_fma_f32 v64, v104, v108, v64
    s_waitcnt lgkmcnt(2)
    v_mfma_f32_16x16x32_bf16 a[0:3], a[148:151], v[96:99], a[0:3]
    v_add_f32 v63, v63, v113
    v_fma_f32 v64, v105, v109, v64
    v_mfma_f32_16x16x32_bf16 a[4:7], a[164:167], v[96:99], a[4:7]
    v_add_f32 v63, v63, v114
    v_fma_f32 v64, v106, v110, v64
    v_mfma_f32_16x16x32_bf16 a[8:11], a[180:183], v[96:99], a[8:11]
    v_add_f32 v63, v63, v115
    v_fma_f32 v64, v107, v111, v64
    s_waitcnt lgkmcnt(1)
    v_mfma_f32_16x16x32_bf16 a[0:3], a[152:155], v[100:103], a[0:3]
    s_add_u32 s61, s60, 3149824
    buffer_load_dwordx4 v[176:179], v65, s[72:75], s61 offen offset:0 sc1
    v_mfma_f32_16x16x32_bf16 a[4:7], a[168:171], v[100:103], a[4:7]
    v_mfma_f32_16x16x32_bf16 a[8:11], a[184:187], v[100:103], a[8:11]
    s_waitcnt lgkmcnt(0)
    v_mfma_f32_16x16x32_bf16 a[0:3], a[156:159], v[116:119], a[0:3]
    v_mfma_f32_16x16x32_bf16 a[4:7], a[172:175], v[116:119], a[4:7]
    v_mfma_f32_16x16x32_bf16 a[8:11], a[188:191], v[116:119], a[8:11]
    buffer_load_dwordx4 v21, s[28:31], s57 offen offset:1024 nt lds
    s_add_u32 m0, s41, 0
    s_add_u32 s58, s37, 37748736
    buffer_load_dwordx4 v224, s[24:27], s58 offen offset:0 nt lds
    buffer_load_dwordx4 v225, s[24:27], s58 offen offset:1024 nt lds
    s_add_u32 m0, s41, 2048
    s_add_u32 s58, s37, 37748864
    buffer_load_dwordx4 v224, s[24:27], s58 offen offset:0 nt lds
    buffer_load_dwordx4 v[180:183], v65, s[72:75], s61 offen offset:1024 sc1
    s_waitcnt vmcnt(12)
    s_barrier
    ds_read_b128 a[96:99], v40 offset:49152
    ds_read_b128 a[100:103], v41 offset:49152
    ds_read_b128 a[104:107], v42 offset:49152
    ds_read_b128 a[108:111], v43 offset:49152
    ds_read_b128 a[112:115], v40 offset:49408
    ds_read_b128 a[116:119], v41 offset:49408
    ds_read_b128 a[120:123], v42 offset:49408
    ds_read_b128 a[124:127], v43 offset:49408
    ds_read_b128 a[128:131], v40 offset:49664
    ds_read_b128 a[132:135], v41 offset:49664
    ds_read_b128 a[136:139], v42 offset:49664
    ds_read_b128 a[140:143], v43 offset:49664
    s_waitcnt lgkmcnt(11)
    v_mfma_f32_16x16x32_bf16 v[96:99], a[96:99], a[96:99], v[84:87]
    ds_read_b64_tr_b16 a[144:145], v44 offset:0
    ds_read_b64_tr_b16 a[146:147], v45 offset:0
    v_mfma_f32_16x16x32_bf16 v[100:103], a[96:99], a[48:51], 0
    ds_read_b64_tr_b16 a[148:149], v44 offset:12288
    ds_read_b64_tr_b16 a[150:151], v45 offset:12288
    s_waitcnt lgkmcnt(14)
    v_mfma_f32_16x16x32_bf16 v[96:99], a[100:103], a[100:103], v[96:99]
    ds_read_b64_tr_b16 a[152:153], v44 offset:24576
    ds_read_b64_tr_b16 a[154:155], v45 offset:24576
    v_mfma_f32_16x16x32_bf16 v[100:103], a[100:103], a[52:55], v[100:103]
    ds_read_b64_tr_b16 a[156:157], v44 offset:36864
    ds_read_b64_tr_b16 a[158:159], v45 offset:36864
    s_waitcnt lgkmcnt(15)
    v_mfma_f32_16x16x32_bf16 v[96:99], a[104:107], a[104:107], v[96:99]
    ds_read_b64_tr_b16 a[160:161], v46 offset:0
    ds_read_b64_tr_b16 a[162:163], v47 offset:0
    v_mfma_f32_16x16x32_bf16 v[100:103], a[104:107], a[56:59], v[100:103]
    ds_read_b64_tr_b16 a[164:165], v46 offset:12288
    ds_read_b64_tr_b16 a[166:167], v47 offset:12288
    v_mfma_f32_16x16x32_bf16 v[96:99], a[108:111], a[108:111], v[96:99]
    buffer_load_dwordx4 v225, s[24:27], s58 offen offset:1024 nt lds
    ds_read_b64_tr_b16 a[168:169], v46 offset:24576
    ds_read_b64_tr_b16 a[170:171], v47 offset:24576
    v_mfma_f32_16x16x32_bf16 v[100:103], a[108:111], a[60:63], v[100:103]
    ds_read_b64_tr_b16 a[172:173], v46 offset:36864
    ds_read_b64_tr_b16 a[174:175], v47 offset:36864
    v_mfma_f32_16x16x32_bf16 v[96:99], a[112:115], a[112:115], v[96:99]
    ds_read_b64_tr_b16 a[176:177], v48 offset:0
    ds_read_b64_tr_b16 a[178:179], v49 offset:0
    v_mfma_f32_16x16x32_bf16 v[100:103], a[112:115], a[64:67], v[100:103]
    ds_read_b64_tr_b16 a[180:181], v48 offset:12288
    ds_read_b64_tr_b16 a[182:183], v49 offset:12288
    s_waitcnt lgkmcnt(15)
    v_mfma_f32_16x16x32_bf16 v[96:99], a[116:119], a[116:119], v[96:99]
    ds_read_b64_tr_b16 a[184:185], v48 offset:24576
    ds_read_b64_tr_b16 a[186:187], v49 offset:24576
    v_mfma_f32_16x16x32_bf16 v[100:103], a[116:119], a[68:71], v[100:103]
    ds_read_b64_tr_b16 a[188:189], v48 offset:36864
    ds_read_b64_tr_b16 a[190:191], v49 offset:36864
    v_mfma_f32_16x16x32_bf16 v[92:95], a[96:99], v[52:55], v[80:83]
    v_mfma_f32_16x16x32_bf16 v[92:95], a[100:103], v[52:55], v[92:95]
    v_mfma_f32_16x16x32_bf16 v[92:95], a[104:107], v[52:55], v[92:95]
    v_mfma_f32_16x16x32_bf16 v[92:95], a[108:111], v[52:55], v[92:95]
    s_nop 1
    v_fma_f32 v96, v100, 2.0, v96
    v_fma_f32 v97, v101, 2.0, v97
    v_mfma_f32_16x16x32_bf16 v[92:95], a[112:115], v[52:55], v[92:95]
    v_fma_f32 v98, v102, 2.0, v98
    v_fma_f32 v99, v103, 2.0, v99
    v_mfma_f32_16x16x32_bf16 v[92:95], a[116:119], v[52:55], v[92:95]
    v_cndmask_b32 v3, 0, v96, s[44:45]
    v_cndmask_b32 v3, v3, v97, s[46:47]
    v_mfma_f32_16x16x32_bf16 v[88:91], a[96:99], v[136:139], v[76:79]
    s_add_u32 m0, s41, 4096
    s_add_u32 s58, s37, 37748992
    buffer_load_dwordx4 v224, s[24:27], s58 offen offset:0 nt lds
    v_cndmask_b32 v3, v3, v98, s[48:49]
    v_cndmask_b32 v3, v3, v99, s[50:51]
    v_mfma_f32_16x16x32_bf16 v[88:91], a[100:103], v[140:143], v[88:91]
    buffer_load_dwordx4 v225, s[24:27], s58 offen offset:1024 nt lds
    s_nop 0
    s_nop 0
    v_mfma_f32_16x16x32_bf16 v[88:91], a[104:107], v[144:147], v[88:91]
    v_mfma_f32_16x16x4_f32 v[120:123], v3, v60, v[56:59]
    v_mfma_f32_16x16x32_bf16 v[88:91], a[108:111], v[148:151], v[88:91]
    v_mfma_f32_16x16x32_bf16 v[88:91], a[112:115], v[152:155], v[88:91]
    v_mfma_f32_16x16x32_bf16 v[88:91], a[116:119], v[156:159], v[88:91]
    v_mfma_f32_16x16x32_bf16 v[112:115], a[120:123], a[120:123], v[84:87]
    v_mfma_f32_16x16x32_bf16 v[116:119], a[120:123], a[48:51], 0
    v_mfma_f32_16x16x32_bf16 v[112:115], a[124:127], a[124:127], v[112:115]
    v_mfma_f32_16x16x32_bf16 v[116:119], a[124:127], a[52:55], v[116:119]
    s_add_u32 m0, s41, 6144
    s_add_u32 s58, s37, 37749120
    buffer_load_dwordx4 v224, s[24:27], s58 offen offset:0 nt lds
    v_fma_f32 v128, -v92, v92, v120
    v_fma_f32 v129, -v93, v93, v121
    v_mfma_f32_16x16x32_bf16 v[112:115], a[128:131], a[128:131], v[112:115]
    v_fma_f32 v130, -v94, v94, v122
    v_fma_f32 v131, -v95, v95, v123
    v_mfma_f32_16x16x32_bf16 v[116:119], a[128:131], a[56:59], v[116:119]
    v_max_f32 v128, v128, v56
    v_max_f32 v129, v129, v56
    v_mfma_f32_16x16x32_bf16 v[112:115], a[132:135], a[132:135], v[112:115]
    v_max_f32 v130, v130, v56
    v_max_f32 v131, v131, v56
    v_mfma_f32_16x16x32_bf16 v[116:119], a[132:135], a[60:63], v[116:119]
    v_rsq_f32 v128, v128
    v_mfma_f32_16x16x32_bf16 v[112:115], a[136:139], a[136:139], v[112:115]
    v_rsq_f32 v129, v129
    v_mfma_f32_16x16x32_bf16 v[116:119], a[136:139], a[64:67], v[116:119]
    v_rsq_f32 v130, v130
    v_mfma_f32_16x16x32_bf16 v[112:115], a[140:143], a[140:143], v[112:115]
    v_rsq_f32 v131, v131
    v_mfma_f32_16x16x32_bf16 v[116:119], a[140:143], a[68:71], v[116:119]
    v_fma_f32 v88, -v92, v61, v88
    v_fma_f32 v89, -v93, v61, v89
    v_mfma_f32_16x16x32_bf16 v[108:111], a[120:123], v[52:55], v[80:83]
    v_fma_f32 v90, -v94, v61, v90
    v_fma_f32 v91, -v95, v61, v91
    v_mfma_f32_16x16x32_bf16 v[108:111], a[124:127], v[52:55], v[108:111]
    v_fma_f32 v88, v88, v128, v62
    v_fma_f32 v89, v89, v129, v62
    v_mfma_f32_16x16x32_bf16 v[108:111], a[128:131], v[52:55], v[108:111]
    v_fma_f32 v90, v90, v130, v62
    v_fma_f32 v91, v91, v131, v62
    v_mfma_f32_16x16x32_bf16 v[108:111], a[132:135], v[52:55], v[108:111]
    v_max3_f32 v1, v88, v89, v90
    v_max_f32 v1, v1, v91
    v_mfma_f32_16x16x32_bf16 v[108:111], a[136:139], v[52:55], v[108:111]
    buffer_load_dwordx4 v[184:187], v65, s[72:75], s61 offen offset:2048 sc1
    v_cmp_lt_f32 vcc, s52, v1
    s_cbranch_vccnz L_site8
L_back8:
    v_mfma_f32_16x16x32_bf16 v[108:111], a[140:143], v[52:55], v[108:111]
    v_exp_f32 v96, v88
    v_mfma_f32_16x16x32_bf16 v[104:107], a[120:123], v[136:139], v[76:79]
    v_exp_f32 v97, v89
    v_mfma_f32_16x16x32_bf16 v[104:107], a[124:127], v[140:143], v[104:107]
    v_exp_f32 v98, v90
    v_mfma_f32_16x16x32_bf16 v[104:107], a[128:131], v[144:147], v[104:107]
    v_exp_f32 v99, v91
    v_mfma_f32_16x16x32_bf16 v[104:107], a[132:135], v[148:151], v[104:107]
    v_mul_f32 v88, v96, v128
    v_mul_f32 v89, v97, v129
    v_mfma_f32_16x16x32_bf16 v[104:107], a[136:139], v[152:155], v[104:107]
    v_mul_f32 v90, v98, v130
    v_mul_f32 v91, v99, v131
    v_mfma_f32_16x16x32_bf16 v[104:107], a[140:143], v[156:159], v[104:107]
    v_fma_f32 v112, v116, 2.0, v112
    v_fma_f32 v113, v117, 2.0, v113
    v_fma_f32 v114, v118, 2.0, v114
    v_fma_f32 v115, v119, 2.0, v115
    v_cndmask_b32 v4, 0, v112, s[44:45]
    v_cndmask_b32 v4, v4, v113, s[46:47]
    v_cndmask_b32 v4, v4, v114, s[48:49]
    v_cndmask_b32 v4, v4, v115, s[50:51]
    v_add_f32 v63, v63, v96
    v_fmac_f32 v64, v88, v92
    v_mfma_f32_16x16x4_f32 v[124:127], v4, v60, v[56:59]
    v_add_f32 v63, v63, v97
    v_fmac_f32 v64, v89, v93
    v_add_f32 v63, v63, v98
    v_fmac_f32 v64, v90, v94
    v_add_f32 v63, v63, v99
    v_fmac_f32 v64, v91, v95
    v_add_f32 v68, v68, v88
    v_add_f32 v69, v69, v89
    v_add_f32 v70, v70, v90
    v_add_f32 v71, v71, v91
    v_add_u32 v44, -49152, v44
    v_add_u32 v45, -49152, v45
    v_add_u32 v46, -49152, v46
    v_add_u32 v47, -49152, v47
    v_add_u32 v48, -49152, v48
    v_add_u32 v49, -49152, v49
    v_fma_f32 v132, -v108, v108, v124
    v_fma_f32 v133, -v109, v109, v125
    v_fma_f32 v134, -v110, v110, v126
    v_fma_f32 v135, -v111, v111, v127
    v_max_f32 v132, v132, v56
    v_max_f32 v133, v133, v56
    v_max_f32 v134, v134, v56
    v_max_f32 v135, v135, v56
    v_rsq_f32 v132, v132
    v_rsq_f32 v133, v133
    v_rsq_f32 v134, v134
    v_rsq_f32 v135, v135
    buffer_load_dwordx4 v225, s[24:27], s58 offen offset:1024 nt lds
    v_fma_f32 v104, -v108, v61, v104
    v_fma_f32 v105, -v109, v61, v105
    v_fma_f32 v106, -v110, v61, v106
    v_fma_f32 v107, -v111, v61, v107
    v_fma_f32 v104, v104, v132, v62
    v_fma_f32 v105, v105, v133, v62
    v_fma_f32 v106, v106, v134, v62
    v_fma_f32 v107, v107, v135, v62
    v_max3_f32 v1, v104, v105, v106
    v_max_f32 v1, v1, v107
    v_cmp_lt_f32 vcc, s52, v1
    s_cbranch_vccnz L_site9
L_back9:
    s_add_u32 m0, s41, 8192
    s_add_u32 s58, s37, 37749248
    buffer_load_dwordx4 v224, s[24:27], s58 offen offset:0 nt lds
    v_exp_f32 v112, v104
    v_exp_f32 v113, v105
    v_exp_f32 v114, v106
    v_exp_f32 v115, v107
    v_cvt_pk_bf16_f32 v72, v88, v89
    v_cvt_pk_bf16_f32 v73, v90, v91
    v_mul_f32 v104, v112, v132
    v_mul_f32 v105, v113, v133
    v_mul_f32 v106, v114, v134
    v_mul_f32 v107, v115, v135
    v_cvt_pk_bf16_f32 v74, v104, v105
    v_cvt_pk_bf16_f32 v75, v106, v107
    ds_write_b128 v237, v[72:75] offset:0
    v_add_f32 v68, v68, v104
    v_add_f32 v69, v69, v105
    v_add_f32 v70, v70, v106
    v_add_f32 v71, v71, v107
    v_cvt_pk_bf16_f32 v66, v68, v69
    v_cvt_pk_bf16_f32 v67, v70, v71
    ds_write_b64 v238, v[66:67]
    s_lshl_b32 s56, s3, 13
    v_lshl_add_u32 v233, v0, 7, s56
    v_min_u32 v233, L_hot - L_tail, v233
    v_add_u32 v233, L_tail - L_pc_main, v233
    global_load_dword v234, v233, s[100:101]
    s_waitcnt vmcnt(12)
    s_waitcnt lgkmcnt(0)
    s_barrier
L_post9:
    ds_read_b32 v9, v254 offset:4096
    ds_read_b64 v[120:121], v254 offset:0
    ds_read_b64 v[122:123], v254 offset:512
    ds_read_b64 v[124:125], v254 offset:1024
    ds_read_b64 v[126:127], v254 offset:1536
    ds_read_b128 v[92:95], v253 offset:0
    ds_read_b128 v[96:99], v253 offset:1024
    ds_read_b128 v[100:103], v253 offset:2048
    ds_read_b128 v[116:119], v253 offset:3072
    ds_read_b128 a[48:51], v34 offset:0
    ds_read_b128 a[52:55], v35 offset:0
    ds_read_b128 a[56:59], v34 offset:128
    ds_read_b128 a[60:63], v35 offset:128
    ds_read_b128 a[64:67], v34 offset:256
    ds_read_b128 a[68:71], v35 offset:256
    s_waitcnt lgkmcnt(14)
    v_cmp_ne_u32 vcc, 0, v9
    s_cbranch_vccnz L_xt9
    s_waitcnt lgkmcnt(12)
    v_mfma_f32_16x16x32_bf16 a[0:3], a[72:75], v[120:123], a[0:3]
    buffer_load_dwordx4 v225, s[24:27], s58 offen offset:1024 nt lds
    v_add_f32 v63, v63, v112
    v_fma_f32 v64, v104, v108, v64
    v_mfma_f32_16x16x32_bf16 a[4:7], a[80:83], v[120:123], a[4:7]
    v_add_f32 v63, v63, v113
    v_fma_f32 v64, v105, v109, v64
    v_mfma_f32_16x16x32_bf16 a[8:11], a[88:91], v[120:123], a[8:11]
    v_add_f32 v63, v63, v114
    v_fma_f32 v64, v106, v110, v64
    s_waitcnt lgkmcnt(10)
    v_mfma_f32_16x16x32_bf16 a[0:3], a[76:79], v[124:127], a[0:3]
    v_add_f32 v63, v63, v115
    v_fma_f32 v64, v107, v111, v64
    v_mfma_f32_16x16x32_bf16 a[4:7], a[84:87], v[124:127], a[4:7]
    v_mfma_f32_16x16x32_bf16 a[8:11], a[92:95], v[124:127], a[8:11]
    s_waitcnt lgkmcnt(9)
    v_mfma_f32_16x16x32_bf16 a[0:3], a[144:147], v[92:95], a[0:3]
    ds_read_b64_tr_b16 a[72:73], v36 offset:0
    ds_read_b64_tr_b16 a[74:75], v36 offset:6144
    v_mfma_f32_16x16x32_bf16 a[4:7], a[160:163], v[92:95], a[4:7]
    ds_read_b64_tr_b16 a[76:77], v36 offset:12288
    ds_read_b64_tr_b16 a[78:79], v36 offset:18432
    v_mfma_f32_16x16x32_bf16 a[8:11], a[176:179], v[92:95], a[8:11]
    s_add_u32 m0, s41, 10240
    s_add_u32 s58, s37, 37749376
    buffer_load_dwordx4 v224, s[24:27], s58 offen offset:0 nt lds
    ds_read_b64_tr_b16 a[80:81], v37 offset:0
    ds_read_b64_tr_b16 a[82:83], v37 offset:6144
    s_waitcnt lgkmcnt(14)
    v_mfma_f32_16x16x32_bf16 a[0:3], a[148:151], v[96:99], a[0:3]
    ds_read_b64_tr_b16 a[84:85], v37 offset:12288
    ds_read_b64_tr_b16 a[86:87], v37 offset:18432
    v_mfma_f32_16x16x32_bf16 a[4:7], a[164:167], v[96:99], a[4:7]
    ds_read_b64_tr_b16 a[88:89], v38 offset:0
    ds_read_b64_tr_b16 a[90:91], v38 offset:6144
    v_mfma_f32_16x16x32_bf16 a[8:11], a[180:183], v[96:99], a[8:11]
    ds_read_b64_tr_b16 a[92:93], v38 offset:12288
    ds_read_b64_tr_b16 a[94:95], v38 offset:18432
    s_waitcnt lgkmcnt(15)
    v_mfma_f32_16x16x32_bf16 a[0:3], a[152:155], v[100:103], a[0:3]
    v_mfma_f32_16x16x32_bf16 a[4:7], a[168:171], v[100:103], a[4:7]
    v_mfma_f32_16x16x32_bf16 a[8:11], a[184:187], v[100:103], a[8:11]
    v_mfma_f32_16x16x32_bf16 a[0:3], a[156:159], v[116:119], a[0:3]
    v_mfma_f32_16x16x32_bf16 a[4:7], a[172:175], v[116:119], a[4:7]
    v_mfma_f32_16x16x32_bf16 a[8:11], a[188:191], v[116:119], a[8:11]
    v_mfma_f32_16x16x32_bf16 v[84:87], a[48:51], a[48:51], 0
    v_mfma_f32_16x16x32_bf16 v[80:83], a[48:51], v[52:55], 0
    buffer_load_dwordx4 v[188:191], v65, s[72:75], s61 offen offset:3072 sc1
    v_mfma_f32_16x16x32_bf16 v[84:87], a[52:55], a[52:55], v[84:87]
    buffer_load_dwordx4 v225, s[24:27], s58 offen offset:1024 nt lds
    v_mfma_f32_16x16x32_bf16 v[80:83], a[52:55], v[52:55], v[80:83]
    v_mfma_f32_16x16x32_bf16 v[84:87], a[56:59], a[56:59], v[84:87]
    v_mfma_f32_16x16x32_bf16 v[80:83], a[56:59], v[52:55], v[80:83]
    s_waitcnt lgkmcnt(14)
    v_mfma_f32_16x16x32_bf16 v[84:87], a[60:63], a[60:63], v[84:87]
    v_mfma_f32_16x16x32_bf16 v[80:83], a[60:63], v[52:55], v[80:83]
    s_waitcnt lgkmcnt(13)
    v_mfma_f32_16x16x32_bf16 v[84:87], a[64:67], a[64:67], v[84:87]
    v_mfma_f32_16x16x32_bf16 v[80:83], a[64:67], v[52:55], v[80:83]
    s_waitcnt lgkmcnt(12)
    v_mfma_f32_16x16x32_bf16 v[84:87], a[68:71], a[68:71], v[84:87]
    v_mfma_f32_16x16x32_bf16 v[80:83], a[68:71], v[52:55], v[80:83]
    s_waitcnt lgkmcnt(0)
    v_mfma_f32_16x16x32_bf16 v[76:79], a[48:51], v[136:139], 0
    v_mfma_f32_16x16x32_bf16 v[76:79], a[52:55], v[140:143], v[76:79]
    v_mfma_f32_16x16x32_bf16 v[76:79], a[56:59], v[144:147], v[76:79]
    s_add_u32 m0, s42, 0
    s_add_u32 s59, s37, 37945344
    buffer_load_dwordx4 v224, s[24:27], s59 offen offset:0 nt lds
    v_mfma_f32_16x16x32_bf16 v[76:79], a[60:63], v[148:151], v[76:79]
    v_mfma_f32_16x16x32_bf16 v[76:79], a[64:67], v[152:155], v[76:79]
    v_mfma_f32_16x16x32_bf16 v[76:79], a[68:71], v[156:159], v[76:79]
    s_mul_i32 s28, s3, 131072
    s_and_b32 s56, s2, 7
    s_lshl_b32 s56, s56, 10
    s_add_u32 s28, s28, s56
    s_bfe_u32 s56, s2, 0x30003
    s_lshl_b32 s56, s56, 7
    s_add_u32 s28, s28, s56
    s_lshr_b32 s56, s2, 6
    s_lshl_b32 s56, s56, 13
    s_add_u32 s28, s28, s56
    s_add_u32 s28, s28, 65536
    s_sub_u32 s29, s2, 64
    s_mul_i32 s30, s29, 32768
    s_lshl_b32 s56, s3, 13
    s_add_u32 s30, s30, s56
    s_add_u32 s30, s30, 65536
    s_add_u32 s31, s30, 4096
    v_mov_b32 v28, v242
    v_bfe_u32 v1, v0, 4, 1
    v_mul_u32_u24 v2, 32768, v1
    v_mul_u32_u24 v1, 0x70, v1
    v_xor_b32 v242, v242, v1
    v_sub_u32 v242, v242, v2
    v_add_u32 v243, 32768, v242
    v_mov_b32 v232, 0x53800000
    s_mov_b32 s43, 1
    s_mov_b32 s68, s18
    s_mov_b32 s69, s19
    s_mov_b32 s70, 6144
    s_mov_b32 s71, 0x20000
L_tail:
    v_and_b32 v1, 15, v0
    v_lshlrev_b32 v1, 8, v1
    v_sub_u32 v1, v34, v1
    v_lshrrev_b32 v2, 2, v0
    v_lshlrev_b32 v2, 8, v2
    s_sub_u32 s56, s41, s40
    v_add_u32 v40, s56, v1
    v_xor_b32 v41, 64, v40
    s_sub_u32 s56, s42, s40
    v_add_u32 v42, s56, v1
    v_xor_b32 v43, 64, v42
    s_mul_i32 s56, s3, 3
    s_add_u32 s57, s56, 0
    s_lshr_b32 s57, s57, 2
    s_mul_i32 s57, s57, 1920
    s_add_u32 s57, s57, 24576
    v_sub_u32 v44, v36, v2
    v_add_u32 v44, s57, v44
    v_add_u32 v47, 49152, v44
    s_add_u32 s57, s56, 1
    s_lshr_b32 s57, s57, 2
    s_mul_i32 s57, s57, 1920
    s_add_u32 s57, s57, 24576
    v_sub_u32 v45, v37, v2
    v_add_u32 v45, s57, v45
    v_add_u32 v48, 49152, v45
    s_add_u32 s57, s56, 2
    s_lshr_b32 s57, s57, 2
    s_mul_i32 s57, s57, 1920
    s_add_u32 s57, s57, 24576
    v_sub_u32 v46, v38, v2
    v_add_u32 v46, s57, v46
    v_add_u32 v49, 49152, v46
    v_accvgpr_read_b32 v16, a0
    v_accvgpr_read_b32 v17, a1
    v_accvgpr_read_b32 v18, a2
    v_accvgpr_read_b32 v19, a3
    v_accvgpr_read_b32 v20, a4
    v_accvgpr_read_b32 v21, a5
    v_accvgpr_read_b32 v22, a6
    v_accvgpr_read_b32 v23, a7
    v_accvgpr_read_b32 v24, a8
    v_accvgpr_read_b32 v25, a9
    v_accvgpr_read_b32 v26, a10
    v_accvgpr_read_b32 v27, a11
    buffer_load_dwordx4 v225, s[24:27], s59 offen offset:1024 nt lds
    s_add_u32 m0, s42, 2048
    s_add_u32 s59, s37, 37945472
    buffer_load_dwordx4 v224, s[24:27], s59 offen offset:0 nt lds
    s_waitcnt vmcnt(12)
    s_barrier
    ds_read_b128 a[96:99], v40 offset:0
    ds_read_b128 a[100:103], v41 offset:0
    ds_read_b128 a[104:107], v40 offset:2048
    ds_read_b128 a[108:111], v41 offset:2048
    ds_read_b128 a[112:115], v40 offset:4096
    ds_read_b128 a[116:119], v41 offset:4096
    s_waitcnt lgkmcnt(5)
    v_mfma_f32_16x16x32_bf16 v[96:99], a[96:99], a[96:99], v[84:87]
    ds_read_b64_tr_b16 a[144:145], v44 offset:0
    ds_read_b64_tr_b16 a[148:149], v44 offset:12288
    v_mfma_f32_16x16x32_bf16 v[100:103], a[96:99], a[48:51], 0
    ds_read_b64_tr_b16 a[152:153], v44 offset:24576
    ds_read_b64_tr_b16 a[156:157], v44 offset:36864
    s_waitcnt lgkmcnt(8)
    v_mfma_f32_16x16x32_bf16 v[96:99], a[100:103], a[100:103], v[96:99]
    ds_read_b64_tr_b16 a[160:161], v45 offset:0
    ds_read_b64_tr_b16 a[164:165], v45 offset:12288
    v_mfma_f32_16x16x32_bf16 v[100:103], a[100:103], a[52:55], v[100:103]
    ds_read_b64_tr_b16 a[168:169], v45 offset:24576
    ds_read_b64_tr_b16 a[172:173], v45 offset:36864
    s_waitcnt lgkmcnt(11)
    v_mfma_f32_16x16x32_bf16 v[96:99], a[104:107], a[104:107], v[96:99]
    buffer_load_dwordx4 v225, s[24:27], s59 offen offset:1024 nt lds
    ds_read_b64_tr_b16 a[176:177], v46 offset:0
    ds_read_b64_tr_b16 a[180:181], v46 offset:12288
    v_mfma_f32_16x16x32_bf16 v[100:103], a[104:107], a[56:59], v[100:103]
    s_add_u32 m0, s42, 4096
    s_add_u32 s59, s37, 37945600
    buffer_load_dwordx4 v224, s[24:27], s59 offen offset:0 nt lds
    ds_read_b64_tr_b16 a[184:185], v46 offset:24576
    ds_read_b64_tr_b16 a[188:189], v46 offset:36864
    s_waitcnt lgkmcnt(14)
    v_mfma_f32_16x16x32_bf16 v[96:99], a[108:111], a[108:111], v[96:99]
    v_mfma_f32_16x16x32_bf16 v[100:103], a[108:111], a[60:63], v[100:103]
    s_waitcnt lgkmcnt(13)
    v_mfma_f32_16x16x32_bf16 v[96:99], a[112:115], a[112:115], v[96:99]
    v_mfma_f32_16x16x32_bf16 v[100:103], a[112:115], a[64:67], v[100:103]
    s_waitcnt lgkmcnt(12)
    v_mfma_f32_16x16x32_bf16 v[96:99], a[116:119], a[116:119], v[96:99]
    v_mfma_f32_16x16x32_bf16 v[100:103], a[116:119], a[68:71], v[100:103]
    v_mfma_f32_16x16x32_bf16 v[92:95], a[96:99], v[52:55], v[80:83]
    v_mfma_f32_16x16x32_bf16 v[92:95], a[100:103], v[52:55], v[92:95]
    v_mfma_f32_16x16x32_bf16 v[92:95], a[104:107], v[52:55], v[92:95]
    v_mfma_f32_16x16x32_bf16 v[92:95], a[108:111], v[52:55], v[92:95]
    buffer_load_dwordx4 v225, s[24:27], s59 offen offset:1024 nt lds
    s_nop 2
    v_fma_f32 v96, v100, 2.0, v96
    v_fma_f32 v97, v101, 2.0, v97
    v_mfma_f32_16x16x32_bf16 v[92:95], a[112:115], v[52:55], v[92:95]
    v_fma_f32 v98, v102, 2.0, v98
    v_fma_f32 v99, v103, 2.0, v99
    v_mfma_f32_16x16x32_bf16 v[92:95], a[116:119], v[52:55], v[92:95]
    v_cndmask_b32 v3, 0, v96, s[44:45]
    v_cndmask_b32 v3, v3, v97, s[46:47]
    v_mfma_f32_16x16x32_bf16 v[88:91], a[96:99], v[136:139], v[76:79]
    v_cndmask_b32 v3, v3, v98, s[48:49]
    v_cndmask_b32 v3, v3, v99, s[50:51]
    v_mfma_f32_16x16x32_bf16 v[88:91], a[100:103], v[140:143], v[88:91]
    s_nop 0
    s_nop 0
    v_mfma_f32_16x16x32_bf16 v[88:91], a[104:107], v[144:147], v[88:91]
    v_mfma_f32_16x16x4_f32 v[120:123], v3, v60, v[56:59]
    v_mfma_f32_16x16x32_bf16 v[88:91], a[108:111], v[148:151], v[88:91]
    v_mfma_f32_16x16x32_bf16 v[88:91], a[112:115], v[152:155], v[88:91]
    v_mfma_f32_16x16x32_bf16 v[88:91], a[116:119], v[156:159], v[88:91]
    s_nop 6
    v_fma_f32 v128, -v92, v92, v120
    v_fma_f32 v129, -v93, v93, v121
    v_fma_f32 v130, -v94, v94, v122
    v_fma_f32 v131, -v95, v95, v123
    v_max_f32 v128, v128, v56
    v_max_f32 v129, v129, v56
    v_max_f32 v130, v130, v56
    v_max_f32 v131, v131, v56
    v_rsq_f32 v128, v128
    v_rsq_f32 v129, v129
    v_rsq_f32 v130, v130
    v_rsq_f32 v131, v131
    s_add_u32 m0, s42, 6144
    s_add_u32 s59, s37, 37945728
    buffer_load_dwordx4 v224, s[24:27], s59 offen offset:0 nt lds
    v_fma_f32 v88, -v92, v61, v88
    v_fma_f32 v89, -v93, v61, v89
    v_fma_f32 v90, -v94, v61, v90
    v_fma_f32 v91, -v95, v61, v91
    v_fma_f32 v88, v88, v128, v62
    v_fma_f32 v89, v89, v129, v62
    buffer_load_dwordx4 v225, s[24:27], s59 offen offset:1024 nt lds
    v_fma_f32 v90, v90, v130, v62
    v_fma_f32 v91, v91, v131, v62
    v_max3_f32 v1, v88, v89, v90
    v_max_f32 v1, v1, v91
    v_cmp_lt_f32 vcc, s52, v1
    s_cbranch_vccnz L_site10
L_back10:
    v_exp_f32 v96, v88
    v_exp_f32 v97, v89
    v_exp_f32 v98, v90
    v_exp_f32 v99, v91
    v_mul_f32 v88, v96, v128
    v_mul_f32 v89, v97, v129
    v_mul_f32 v90, v98, v130
    v_mul_f32 v91, v99, v131
    v_add_f32 v63, v63, v96
    v_fmac_f32 v64, v88, v92
    v_add_f32 v63, v63, v97
    v_fmac_f32 v64, v89, v93
    v_add_f32 v63, v63, v98
    v_fmac_f32 v64, v90, v94
    v_add_f32 v63, v63, v99
    v_fmac_f32 v64, v91, v95
    v_mov_b32 v68, v88
    v_mov_b32 v69, v89
    v_mov_b32 v70, v90
    v_mov_b32 v71, v91
    s_waitcnt vmcnt(14)
    ds_read_b128 a[120:123], v40 offset:6144
    ds_read_b128 a[124:127], v41 offset:6144
    s_waitcnt lgkmcnt(1)
    v_mfma_f32_16x16x32_bf16 v[112:115], a[120:123], a[120:123], v[84:87]
    s_add_u32 m0, s42, 8192
    s_add_u32 s59, s37, 37945856
    buffer_load_dwordx4 v224, s[24:27], s59 offen offset:0 nt lds
    v_mfma_f32_16x16x32_bf16 v[116:119], a[120:123], a[48:51], 0
    s_waitcnt lgkmcnt(0)
    v_mfma_f32_16x16x32_bf16 v[112:115], a[124:127], a[124:127], v[112:115]
    v_mfma_f32_16x16x32_bf16 v[116:119], a[124:127], a[52:55], v[116:119]
    v_mfma_f32_16x16x32_bf16 v[108:111], a[120:123], v[52:55], v[80:83]
    v_mfma_f32_16x16x32_bf16 v[104:107], a[120:123], v[136:139], v[76:79]
    s_waitcnt vmcnt(12)
    ds_read_b128 a[128:131], v40 offset:8192
    ds_read_b128 a[132:135], v41 offset:8192
    v_mfma_f32_16x16x32_bf16 v[108:111], a[124:127], v[52:55], v[108:111]
    buffer_load_dwordx4 v225, s[24:27], s59 offen offset:1024 nt lds
    v_mfma_f32_16x16x32_bf16 v[104:107], a[124:127], v[140:143], v[104:107]
    s_add_u32 m0, s42, 10240
    s_add_u32 s59, s37, 37945984
    buffer_load_dwordx4 v224, s[24:27], s59 offen offset:0 nt lds
    s_waitcnt lgkmcnt(1)
    v_mfma_f32_16x16x32_bf16 v[112:115], a[128:131], a[128:131], v[112:115]
    v_mfma_f32_16x16x32_bf16 v[116:119], a[128:131], a[56:59], v[116:119]
    s_waitcnt lgkmcnt(0)
    v_mfma_f32_16x16x32_bf16 v[112:115], a[132:135], a[132:135], v[112:115]
    v_mfma_f32_16x16x32_bf16 v[116:119], a[132:135], a[60:63], v[116:119]
    v_mfma_f32_16x16x32_bf16 v[108:111], a[128:131], v[52:55], v[108:111]
    v_mfma_f32_16x16x32_bf16 v[104:107], a[128:131], v[144:147], v[104:107]
    buffer_load_dwordx4 v225, s[24:27], s59 offen offset:1024 nt lds
    s_waitcnt vmcnt(12)
    ds_read_b128 a[136:139], v40 offset:10240
    ds_read_b128 a[140:143], v41 offset:10240
    s_barrier
    s_add_u32 s61, s60, 3153920
    buffer_load_dwordx4 v[192:195], v65, s[32:35], s61 offen offset:0 sc1
    v_mfma_f32_16x16x32_bf16 v[108:111], a[132:135], v[52:55], v[108:111]
    ds_read_b64_tr_b16 a[146:147], v44 offset:6144
    v_mfma_f32_16x16x32_bf16 v[104:107], a[132:135], v[148:151], v[104:107]
    ds_read_b64_tr_b16 a[150:151], v44 offset:18432
    s_waitcnt lgkmcnt(3)
    v_mfma_f32_16x16x32_bf16 v[112:115], a[136:139], a[136:139], v[112:115]
    ds_read_b64_tr_b16 a[154:155], v44 offset:30720
    v_mfma_f32_16x16x32_bf16 v[116:119], a[136:139], a[64:67], v[116:119]
    ds_read_b64_tr_b16 a[158:159], v44 offset:43008
    s_waitcnt lgkmcnt(4)
    v_mfma_f32_16x16x32_bf16 v[112:115], a[140:143], a[140:143], v[112:115]
    ds_read_b64_tr_b16 a[162:163], v45 offset:6144
    v_mfma_f32_16x16x32_bf16 v[116:119], a[140:143], a[68:71], v[116:119]
    ds_read_b64_tr_b16 a[166:167], v45 offset:18432
    v_mfma_f32_16x16x32_bf16 v[108:111], a[136:139], v[52:55], v[108:111]
    ds_read_b64_tr_b16 a[170:171], v45 offset:30720
    v_mfma_f32_16x16x32_bf16 v[108:111], a[140:143], v[52:55], v[108:111]
    ds_read_b64_tr_b16 a[174:175], v45 offset:43008
    s_nop 2
    v_fma_f32 v112, v116, 2.0, v112
    v_fma_f32 v113, v117, 2.0, v113
    v_fma_f32 v114, v118, 2.0, v114
    v_fma_f32 v115, v119, 2.0, v115
    v_cndmask_b32 v4, 0, v112, s[44:45]
    v_cndmask_b32 v4, v4, v113, s[46:47]
    v_cndmask_b32 v4, v4, v114, s[48:49]
    v_cndmask_b32 v4, v4, v115, s[50:51]
    ds_read_b64_tr_b16 a[178:179], v46 offset:6144
    ds_read_b64_tr_b16 a[182:183], v46 offset:18432
    v_mfma_f32_16x16x4_f32 v[124:127], v4, v60, v[56:59]
    ds_read_b64_tr_b16 a[186:187], v46 offset:30720
    ds_read_b64_tr_b16 a[190:191], v46 offset:43008
    buffer_load_dwordx4 v[196:199], v65, s[32:35], s61 offen offset:1024 sc1
    s_nop 5
    v_mfma_f32_16x16x32_bf16 v[104:107], a[136:139], v[152:155], v[104:107]
    v_fma_f32 v132, -v108, v108, v124
    v_fma_f32 v133, -v109, v109, v125
    v_mfma_f32_16x16x32_bf16 v[104:107], a[140:143], v[156:159], v[104:107]
    v_fma_f32 v134, -v110, v110, v126
    v_fma_f32 v135, -v111, v111, v127
    v_max_f32 v132, v132, v56
    v_max_f32 v133, v133, v56
    v_max_f32 v134, v134, v56
    v_max_f32 v135, v135, v56
    v_rsq_f32 v132, v132
    v_rsq_f32 v133, v133
    v_rsq_f32 v134, v134
    v_rsq_f32 v135, v135
    v_pk_fma_f32 v[104:105], v[108:109], v[60:61], v[104:105] op_sel:[0,1,0] neg_lo:[1,0,0] neg_hi:[1,0,0]
    v_pk_fma_f32 v[106:107], v[110:111], v[60:61], v[106:107] op_sel:[0,1,0] neg_lo:[1,0,0] neg_hi:[1,0,0]
    v_pk_fma_f32 v[104:105], v[104:105], v[132:133], v[62:63] op_sel_hi:[1,1,0]
    v_pk_fma_f32 v[106:107], v[106:107], v[134:135], v[62:63] op_sel_hi:[1,1,0]
L_back11:
    v_max3_f32 v1, v104, v105, v106
    v_max_f32 v1, v1, v107
    v_cmp_lt_f32 vcc, s52, v1
    v_exp_f32 v112, v104
    v_exp_f32 v113, v105
    v_exp_f32 v114, v106
    v_exp_f32 v115, v107
    s_cbranch_vccnz L_site11
    v_cvt_pk_bf16_f32 v72, v88, v89
    v_cvt_pk_bf16_f32 v73, v90, v91
    v_pk_mul_f32 v[104:105], v[112:113], v[132:133]
    v_pk_mul_f32 v[106:107], v[114:115], v[134:135]
    v_cvt_pk_bf16_f32 v74, v104, v105
    v_cvt_pk_bf16_f32 v75, v106, v107
    ds_write_b128 v237, v[72:75] offset:12288
    s_waitcnt lgkmcnt(0)
    s_barrier
    ds_read_b32 v9, v254 offset:4100
    ds_read_b128 a[192:195], v253 offset:12288
    ds_read_b128 a[196:199], v253 offset:13312
    ds_read_b128 a[200:203], v253 offset:14336
    ds_read_b128 a[204:207], v253 offset:15360
    buffer_load_dwordx4 v[200:203], v65, s[32:35], s61 offen offset:2048 sc1
    buffer_load_dwordx4 v[204:207], v65, s[32:35], s61 offen offset:3072 sc1
    s_waitcnt lgkmcnt(4)
    v_cmp_ne_u32 vcc, 0, v9
    s_cbranch_vccnz L_xt11
L_post11:
    s_waitcnt lgkmcnt(3)
    v_mfma_f32_16x16x32_bf16 v[16:19], a[144:147], a[192:195], v[16:19]
    v_add_f32 v68, v68, v104
    v_add_f32 v69, v69, v105
    v_mfma_f32_16x16x32_bf16 v[20:23], a[160:163], a[192:195], v[20:23]
    v_add_f32 v70, v70, v106
    v_add_f32 v71, v71, v107
    v_mfma_f32_16x16x32_bf16 v[24:27], a[176:179], a[192:195], v[24:27]
    v_add_f32 v63, v63, v112
    v_fma_f32 v64, v104, v108, v64
    s_waitcnt lgkmcnt(2)
    v_mfma_f32_16x16x32_bf16 v[16:19], a[148:151], a[196:199], v[16:19]
    s_waitcnt vmcnt(14)
    ds_read_b128 a[96:99], v42 offset:0
    ds_read_b128 a[100:103], v43 offset:0
    v_mfma_f32_16x16x32_bf16 v[20:23], a[164:167], a[196:199], v[20:23]
    v_add_f32 v63, v63, v113
    v_fma_f32 v64, v105, v109, v64
    v_mfma_f32_16x16x32_bf16 v[24:27], a[180:183], a[196:199], v[24:27]
    v_add_f32 v63, v63, v114
    v_fma_f32 v64, v106, v110, v64
    s_waitcnt lgkmcnt(3)
    v_mfma_f32_16x16x32_bf16 v[16:19], a[152:155], a[200:203], v[16:19]
    v_add_f32 v63, v63, v115
    v_fma_f32 v64, v107, v111, v64
    v_mfma_f32_16x16x32_bf16 v[20:23], a[168:171], a[200:203], v[20:23]
    s_waitcnt vmcnt(12)
    ds_read_b128 a[104:107], v42 offset:2048
    ds_read_b128 a[108:111], v43 offset:2048
    v_mfma_f32_16x16x32_bf16 v[24:27], a[184:187], a[200:203], v[24:27]
    s_waitcnt lgkmcnt(4)
    v_mfma_f32_16x16x32_bf16 v[16:19], a[156:159], a[204:207], v[16:19]
    v_mfma_f32_16x16x32_bf16 v[20:23], a[172:175], a[204:207], v[20:23]
    v_mfma_f32_16x16x32_bf16 v[24:27], a[188:191], a[204:207], v[24:27]
    s_waitcnt lgkmcnt(3)
    v_mfma_f32_16x16x32_bf16 v[96:99], a[96:99], a[96:99], v[84:87]
    v_mfma_f32_16x16x32_bf16 v[100:103], a[96:99], a[48:51], 0
    s_waitcnt lgkmcnt(2)
    v_mfma_f32_16x16x32_bf16 v[96:99], a[100:103], a[100:103], v[96:99]
    v_mfma_f32_16x16x32_bf16 v[100:103], a[100:103], a[52:55], v[100:103]
    s_waitcnt vmcnt(10)
    ds_read_b128 a[112:115], v42 offset:4096
    ds_read_b128 a[116:119], v43 offset:4096
    s_barrier
    v_mfma_f32_16x16x32_bf16 v[92:95], a[96:99], v[52:55], v[80:83]
    s_add_u32 s61, s60, 3158016
    buffer_load_dwordx4 v[208:211], v65, s[32:35], s61 offen offset:0 sc1
    ds_read_b64_tr_b16 a[0:1], v47 offset:0
    v_mfma_f32_16x16x32_bf16 v[88:91], a[96:99], v[136:139], v[76:79]
    ds_read_b64_tr_b16 a[4:5], v47 offset:12288
    v_mfma_f32_16x16x32_bf16 v[92:95], a[100:103], v[52:55], v[92:95]
    ds_read_b64_tr_b16 a[8:9], v47 offset:24576
    v_mfma_f32_16x16x32_bf16 v[88:91], a[100:103], v[140:143], v[88:91]
    ds_read_b64_tr_b16 a[12:13], v47 offset:36864
    s_waitcnt lgkmcnt(7)
    v_mfma_f32_16x16x32_bf16 v[96:99], a[104:107], a[104:107], v[96:99]
    buffer_load_dwordx4 v[212:215], v65, s[32:35], s61 offen offset:1024 sc1
    ds_read_b64_tr_b16 a[16:17], v48 offset:0
    v_mfma_f32_16x16x32_bf16 v[100:103], a[104:107], a[56:59], v[100:103]
    ds_read_b64_tr_b16 a[20:21], v48 offset:12288
    s_waitcnt lgkmcnt(8)
    v_mfma_f32_16x16x32_bf16 v[96:99], a[108:111], a[108:111], v[96:99]
    ds_read_b64_tr_b16 a[24:25], v48 offset:24576
    v_mfma_f32_16x16x32_bf16 v[100:103], a[108:111], a[60:63], v[100:103]
    ds_read_b64_tr_b16 a[28:29], v48 offset:36864
    v_mfma_f32_16x16x32_bf16 v[92:95], a[104:107], v[52:55], v[92:95]
    buffer_load_dwordx4 v[216:219], v65, s[32:35], s61 offen offset:2048 sc1
    ds_read_b64_tr_b16 a[32:33], v49 offset:0
    v_mfma_f32_16x16x32_bf16 v[88:91], a[104:107], v[144:147], v[88:91]
    ds_read_b64_tr_b16 a[36:37], v49 offset:12288
    v_mfma_f32_16x16x32_bf16 v[92:95], a[108:111], v[52:55], v[92:95]
    ds_read_b64_tr_b16 a[40:41], v49 offset:24576
    v_mfma_f32_16x16x32_bf16 v[88:91], a[108:111], v[148:151], v[88:91]
    ds_read_b64_tr_b16 a[44:45], v49 offset:36864
    s_waitcnt lgkmcnt(13)
    v_mfma_f32_16x16x32_bf16 v[96:99], a[112:115], a[112:115], v[96:99]
    v_mfma_f32_16x16x32_bf16 v[100:103], a[112:115], a[64:67], v[100:103]
    s_waitcnt lgkmcnt(12)
    v_mfma_f32_16x16x32_bf16 v[96:99], a[116:119], a[116:119], v[96:99]
    v_mfma_f32_16x16x32_bf16 v[100:103], a[116:119], a[68:71], v[100:103]
    s_waitcnt vmcnt(11)
    ds_read_b128 a[120:123], v42 offset:6144
    ds_read_b128 a[124:127], v43 offset:6144
    buffer_load_dwordx4 v[220:223], v65, s[32:35], s61 offen offset:3072 sc1
    v_mfma_f32_16x16x32_bf16 v[92:95], a[112:115], v[52:55], v[92:95]
    v_mfma_f32_16x16x32_bf16 v[92:95], a[116:119], v[52:55], v[92:95]
    s_nop 1
    v_fma_f32 v96, v100, 2.0, v96
    v_fma_f32 v97, v101, 2.0, v97
    v_mfma_f32_16x16x32_bf16 v[88:91], a[112:115], v[152:155], v[88:91]
    v_fma_f32 v98, v102, 2.0, v98
    v_fma_f32 v99, v103, 2.0, v99
    v_mfma_f32_16x16x32_bf16 v[88:91], a[116:119], v[156:159], v[88:91]
    v_cndmask_b32 v3, 0, v96, s[44:45]
    v_cndmask_b32 v3, v3, v97, s[46:47]
    v_cndmask_b32 v3, v3, v98, s[48:49]
    v_cndmask_b32 v3, v3, v99, s[50:51]
    s_nop 0
    s_nop 0
    v_mfma_f32_16x16x4_f32 v[120:123], v3, v60, v[56:59]
    s_waitcnt lgkmcnt(1)
    v_mfma_f32_16x16x32_bf16 v[112:115], a[120:123], a[120:123], v[84:87]
    v_mfma_f32_16x16x32_bf16 v[116:119], a[120:123], a[48:51], 0
    s_waitcnt vmcnt(10)
    ds_read_b128 a[128:131], v42 offset:8192
    ds_read_b128 a[132:135], v43 offset:8192
    s_add_u32 s61, s60, 3162112
    buffer_load_dwordx4 v[224:227], v65, s[32:35], s61 offen offset:0 sc1
    s_waitcnt lgkmcnt(2)
    v_mfma_f32_16x16x32_bf16 v[112:115], a[124:127], a[124:127], v[112:115]
    v_fma_f32 v128, -v92, v92, v120
    v_fma_f32 v129, -v93, v93, v121
    v_fma_f32 v130, -v94, v94, v122
    v_mfma_f32_16x16x32_bf16 v[116:119], a[124:127], a[52:55], v[116:119]
    v_fma_f32 v131, -v95, v95, v123
    v_max_f32 v128, v128, v56
    v_max_f32 v129, v129, v56
    v_mfma_f32_16x16x32_bf16 v[108:111], a[120:123], v[52:55], v[80:83]
    v_max_f32 v130, v130, v56
    v_max_f32 v131, v131, v56
    v_mfma_f32_16x16x32_bf16 v[104:107], a[120:123], v[136:139], v[76:79]
    v_rsq_f32 v128, v128
    v_mfma_f32_16x16x32_bf16 v[108:111], a[124:127], v[52:55], v[108:111]
    v_rsq_f32 v129, v129
    v_mfma_f32_16x16x32_bf16 v[104:107], a[124:127], v[140:143], v[104:107]
    v_rsq_f32 v130, v130
    s_waitcnt lgkmcnt(1)
    v_mfma_f32_16x16x32_bf16 v[112:115], a[128:131], a[128:131], v[112:115]
    v_rsq_f32 v131, v131
    v_fma_f32 v88, -v92, v61, v88
    v_mfma_f32_16x16x32_bf16 v[116:119], a[128:131], a[56:59], v[116:119]
    v_fma_f32 v89, -v93, v61, v89
    v_fma_f32 v90, -v94, v61, v90
    v_fma_f32 v91, -v95, v61, v91
    s_waitcnt lgkmcnt(0)
    v_mfma_f32_16x16x32_bf16 v[112:115], a[132:135], a[132:135], v[112:115]
    v_fma_f32 v88, v88, v128, v62
    v_fma_f32 v89, v89, v129, v62
    v_fma_f32 v90, v90, v130, v62
    v_mfma_f32_16x16x32_bf16 v[116:119], a[132:135], a[60:63], v[116:119]
    v_fma_f32 v91, v91, v131, v62
    v_max3_f32 v1, v88, v89, v90
    v_max_f32 v1, v1, v91
    v_mfma_f32_16x16x32_bf16 v[108:111], a[128:131], v[52:55], v[108:111]
    v_cmp_lt_f32 vcc, s52, v1
    s_cbranch_vccnz L_site12
L_back12:
    v_mfma_f32_16x16x32_bf16 v[104:107], a[128:131], v[144:147], v[104:107]
    s_waitcnt vmcnt(9)
    ds_read_b128 a[136:139], v42 offset:10240
    ds_read_b128 a[140:143], v43 offset:10240
    s_barrier
    buffer_load_dwordx4 v[228:231], v65, s[32:35], s61 offen offset:1024 sc1
    s_cmp_eq_u32 s0, 1
    s_cbranch_scc0 L_nolate
    s_add_u32 s56, s60, 3145728
    buffer_load_dwordx4 v[160:163], v65, s[32:35], s56 offen offset:0 sc1
    buffer_load_dwordx4 v[164:167], v65, s[32:35], s56 offen offset:1024 sc1
    buffer_load_dwordx4 v[168:171], v65, s[32:35], s56 offen offset:2048 sc1
    buffer_load_dwordx4 v[172:175], v65, s[32:35], s56 offen offset:3072 sc1
    s_add_u32 s56, s60, 3149824
    buffer_load_dwordx4 v[176:179], v65, s[32:35], s56 offen offset:0 sc1
    buffer_load_dwordx4 v[180:183], v65, s[32:35], s56 offen offset:1024 sc1
    buffer_load_dwordx4 v[184:187], v65, s[32:35], s56 offen offset:2048 sc1
    buffer_load_dwordx4 v[188:191], v65, s[32:35], s56 offen offset:3072 sc1
L_nolate:
    buffer_load_dword v244, v28, s[32:35], s28 offen
    v_mfma_f32_16x16x32_bf16 v[108:111], a[132:135], v[52:55], v[108:111]
    ds_read_b64_tr_b16 a[2:3], v47 offset:6144
    v_exp_f32 v96, v88
    v_mfma_f32_16x16x32_bf16 v[104:107], a[132:135], v[148:151], v[104:107]
    ds_read_b64_tr_b16 a[6:7], v47 offset:18432
    v_exp_f32 v97, v89
    s_waitcnt lgkmcnt(3)
    v_mfma_f32_16x16x32_bf16 v[112:115], a[136:139], a[136:139], v[112:115]
    ds_read_b64_tr_b16 a[10:11], v47 offset:30720
    v_exp_f32 v98, v90
    v_mfma_f32_16x16x32_bf16 v[116:119], a[136:139], a[64:67], v[116:119]
    ds_read_b64_tr_b16 a[14:15], v47 offset:43008
    v_exp_f32 v99, v91
    s_waitcnt lgkmcnt(4)
    v_mfma_f32_16x16x32_bf16 v[112:115], a[140:143], a[140:143], v[112:115]
    ds_read_b64_tr_b16 a[18:19], v48 offset:6144
    v_mul_f32 v88, v96, v128
    v_mul_f32 v89, v97, v129
    v_mfma_f32_16x16x32_bf16 v[116:119], a[140:143], a[68:71], v[116:119]
    ds_read_b64_tr_b16 a[22:23], v48 offset:18432
    v_mul_f32 v90, v98, v130
    v_mul_f32 v91, v99, v131
    v_mfma_f32_16x16x32_bf16 v[108:111], a[136:139], v[52:55], v[108:111]
    ds_read_b64_tr_b16 a[26:27], v48 offset:30720
    v_add_f32 v63, v63, v96
    v_fmac_f32 v64, v88, v92
    v_mfma_f32_16x16x32_bf16 v[108:111], a[140:143], v[52:55], v[108:111]
    ds_read_b64_tr_b16 a[30:31], v48 offset:43008
    v_add_f32 v63, v63, v97
    v_fmac_f32 v64, v89, v93
    v_add_f32 v63, v63, v98
    v_fma_f32 v112, v116, 2.0, v112
    v_fma_f32 v113, v117, 2.0, v113
    v_fma_f32 v114, v118, 2.0, v114
    v_fma_f32 v115, v119, 2.0, v115
    v_cndmask_b32 v4, 0, v112, s[44:45]
    v_cndmask_b32 v4, v4, v113, s[46:47]
    v_cndmask_b32 v4, v4, v114, s[48:49]
    v_cndmask_b32 v4, v4, v115, s[50:51]
    ds_read_b64_tr_b16 a[34:35], v49 offset:6144
    ds_read_b64_tr_b16 a[38:39], v49 offset:18432
    v_mfma_f32_16x16x4_f32 v[124:127], v4, v60, v[56:59]
    ds_read_b64_tr_b16 a[42:43], v49 offset:30720
    ds_read_b64_tr_b16 a[46:47], v49 offset:43008
    v_fmac_f32 v64, v90, v94
    v_add_f32 v63, v63, v99
    v_fmac_f32 v64, v91, v95
    v_add_f32 v68, v68, v88
    v_add_f32 v69, v69, v89
    v_add_f32 v70, v70, v90
    v_add_f32 v71, v71, v91
    v_mfma_f32_16x16x32_bf16 v[104:107], a[136:139], v[152:155], v[104:107]
    v_cvt_pk_bf16_f32 v72, v88, v89
    v_cvt_pk_bf16_f32 v73, v90, v91
    v_mfma_f32_16x16x32_bf16 v[104:107], a[140:143], v[156:159], v[104:107]
    v_fma_f32 v132, -v108, v108, v124
    v_fma_f32 v133, -v109, v109, v125
    v_fma_f32 v134, -v110, v110, v126
    v_fma_f32 v135, -v111, v111, v127
    v_max_f32 v132, v132, v56
    v_max_f32 v133, v133, v56
    v_max_f32 v134, v134, v56
    v_max_f32 v135, v135, v56
    v_rsq_f32 v132, v132
    v_rsq_f32 v133, v133
    v_rsq_f32 v134, v134
    v_rsq_f32 v135, v135
    v_pk_fma_f32 v[104:105], v[108:109], v[60:61], v[104:105] op_sel:[0,1,0] neg_lo:[1,0,0] neg_hi:[1,0,0]
    v_pk_fma_f32 v[106:107], v[110:111], v[60:61], v[106:107] op_sel:[0,1,0] neg_lo:[1,0,0] neg_hi:[1,0,0]
    v_pk_fma_f32 v[104:105], v[104:105], v[132:133], v[62:63] op_sel_hi:[1,1,0]
    v_pk_fma_f32 v[106:107], v[106:107], v[134:135], v[62:63] op_sel_hi:[1,1,0]
L_back13:
    v_max3_f32 v1, v104, v105, v106
    v_max_f32 v1, v1, v107
    v_cmp_lt_f32 vcc, s52, v1
    v_exp_f32 v112, v104
    v_exp_f32 v113, v105
    v_exp_f32 v114, v106
    v_exp_f32 v115, v107
    s_cbranch_vccnz L_site13
    v_pk_mul_f32 v[104:105], v[112:113], v[132:133]
    v_pk_mul_f32 v[106:107], v[114:115], v[134:135]
    v_cvt_pk_bf16_f32 v74, v104, v105
    v_cvt_pk_bf16_f32 v75, v106, v107
    ds_write_b128 v237, v[72:75] offset:0
    v_pk_add_f32 v[68:69], v[68:69], v[104:105]
    v_pk_add_f32 v[70:71], v[70:71], v[106:107]
    v_pk_add_f32 v[112:113], v[112:113], v[114:115]
    v_cvt_pk_bf16_f32 v66, v68, v69
    v_cvt_pk_bf16_f32 v67, v70, v71
    ds_write_b64 v238, v[66:67]
    v_pk_mul_f32 v[114:115], v[104:105], v[108:109]
    v_add_f32 v63, v63, v112
    v_pk_fma_f32 v[114:115], v[106:107], v[110:111], v[114:115]
    v_add_f32 v10, v63, v113
    v_add_f32 v64, v64, v114
    v_add_f32 v11, v64, v115
    ds_write_b64 v238, v[10:11] offset:2048
L_merge:
    s_waitcnt lgkmcnt(0)
    s_barrier
L_postx:
    ds_read_b32 v9, v254 offset:4096
    ds_read_b128 v[92:95], v253 offset:0
    ds_read_b128 v[96:99], v253 offset:1024
    ds_read_b128 v[100:103], v253 offset:2048
    ds_read_b64 v[136:137], v254 offset:2048
    ds_read_b64 v[138:139], v254 offset:2560
    ds_read_b64 v[140:141], v254 offset:3072
    ds_read_b64 v[142:143], v254 offset:3584
    ds_read_b128 v[116:119], v253 offset:3072
    ds_read_b64 v[120:121], v254 offset:0
    ds_read_b64 v[122:123], v254 offset:512
    s_waitcnt lgkmcnt(10)
    v_cmp_ne_u32 vcc, 0, v9
    s_cbranch_vccnz L_xlast
    s_waitcnt lgkmcnt(9)
    v_mfma_f32_16x16x32_bf16 v[16:19], a[0:3], v[92:95], v[16:19]
    ds_read_b64 v[124:125], v254 offset:1024
    v_mfma_f32_16x16x32_bf16 v[20:23], a[16:19], v[92:95], v[20:23]
    ds_read_b64 v[126:127], v254 offset:1536
    v_mfma_f32_16x16x32_bf16 v[24:27], a[32:35], v[92:95], v[24:27]
    s_waitcnt lgkmcnt(10)
    v_mfma_f32_16x16x32_bf16 v[16:19], a[4:7], v[96:99], v[16:19]
    v_mfma_f32_16x16x32_bf16 v[20:23], a[20:23], v[96:99], v[20:23]
    v_mfma_f32_16x16x32_bf16 v[24:27], a[36:39], v[96:99], v[24:27]
    s_waitcnt lgkmcnt(9)
    v_mfma_f32_16x16x32_bf16 v[16:19], a[8:11], v[100:103], v[16:19]
    s_waitcnt lgkmcnt(5)
    v_add_f32 v1, v136, v138
    v_add_f32 v2, v137, v139
    v_add_f32 v140, v140, v142
    v_mfma_f32_16x16x32_bf16 v[20:23], a[24:27], v[100:103], v[20:23]
    v_add_f32 v141, v141, v143
    v_add_f32 v1, v1, v140
    v_add_f32 v2, v2, v141
    v_mfma_f32_16x16x32_bf16 v[24:27], a[40:43], v[100:103], v[24:27]
    s_nop 0
    v_permlane32_swap_b32 v1, v2
    v_add_f32 v1, v1, v2
    v_mov_b32 v2, v1
    s_waitcnt lgkmcnt(4)
    v_mfma_f32_16x16x32_bf16 v[16:19], a[12:15], v[116:119], v[16:19]
    v_permlane16_swap_b32 v1, v2
    v_add_f32 v1, v1, v2
    v_mov_b32 v2, v1
    s_waitcnt lgkmcnt(2)
    v_mfma_f32_16x16x32_bf16 v[16:19], a[72:75], v[120:123], v[16:19]
    v_permlane32_swap_b32 v1, v2
    v_rcp_f32 v3, v1
    s_waitcnt lgkmcnt(0)
    v_mfma_f32_16x16x32_bf16 v[16:19], a[76:79], v[124:127], v[16:19]
    v_log_f32 v4, v1
    v_mul_f32 v5, v60, v3
    v_mfma_f32_16x16x32_bf16 v[20:23], a[28:31], v[116:119], v[20:23]
    v_mul_f32 v6, v2, v3
    v_sub_f32 v4, v4, v255
    v_mfma_f32_16x16x32_bf16 v[20:23], a[80:83], v[120:123], v[20:23]
    v_mfma_f32_16x16x32_bf16 v[20:23], a[84:87], v[124:127], v[20:23]
    v_mfma_f32_16x16x32_bf16 v[24:27], a[44:47], v[116:119], v[24:27]
    v_fma_f32 v16, v16, v5, -v6
    v_fma_f32 v17, v17, v5, -v6
    v_mfma_f32_16x16x32_bf16 v[24:27], a[88:91], v[120:123], v[24:27]
    v_fma_f32 v18, v18, v5, -v6
    v_fma_f32 v19, v19, v5, -v6
    v_mfma_f32_16x16x32_bf16 v[24:27], a[92:95], v[124:127], v[24:27]
    v_cvt_pk_bf16_f32 v66, v16, v17
    v_cvt_pk_bf16_f32 v67, v18, v19
    ds_write_b64 v236, v[66:67] offset:0
    v_pk_fma_f32 v[20:21], v[20:21], v[4:5], v[6:7] op_sel:[0,1,0] op_sel_hi:[1,1,0] neg_lo:[0,0,1] neg_hi:[0,0,1]
    v_pk_fma_f32 v[22:23], v[22:23], v[4:5], v[6:7] op_sel:[0,1,0] op_sel_hi:[1,1,0] neg_lo:[0,0,1] neg_hi:[0,0,1]
    v_cvt_pk_bf16_f32 v68, v20, v21
    v_cvt_pk_bf16_f32 v69, v22, v23
    ds_write_b64 v236, v[68:69] offset:512
    v_pk_fma_f32 v[24:25], v[24:25], v[4:5], v[6:7] op_sel:[0,1,0] op_sel_hi:[1,1,0] neg_lo:[0,0,1] neg_hi:[0,0,1]
    v_pk_fma_f32 v[26:27], v[26:27], v[4:5], v[6:7] op_sel:[0,1,0] op_sel_hi:[1,1,0] neg_lo:[0,0,1] neg_hi:[0,0,1]
    v_cvt_pk_bf16_f32 v70, v24, v25
    v_cvt_pk_bf16_f32 v71, v26, v27
    ds_write_b64 v236, v[70:71] offset:1024
    s_waitcnt lgkmcnt(0)
    s_barrier
    ds_read_b128 v[136:139], v241 offset:0
    ds_read_b128 v[140:143], v241 offset:1024
    ds_read_b128 v[144:147], v241 offset:2048
    ds_read_b128 v[148:151], v241 offset:3072
    ds_read_b128 v[152:155], v241 offset:4096
    ds_read_b128 v[156:159], v241 offset:5120
    s_waitcnt vmcnt(1)
    v_subrev_u32 v35, s39, v4
    v_add_u32 v39, s39, v4
    s_waitcnt lgkmcnt(5)
    v_mfma_f32_16x16x32_bf16 v[16:19], v[160:163], v[136:139], 0
    v_mfma_f32_16x16x32_bf16 v[20:23], v[184:187], v[136:139], 0
    v_mfma_f32_16x16x32_bf16 v[24:27], v[208:211], v[136:139], 0
    s_waitcnt lgkmcnt(4)
    v_mfma_f32_16x16x32_bf16 v[16:19], v[164:167], v[140:143], v[16:19]
    v_mfma_f32_16x16x32_bf16 v[20:23], v[188:191], v[140:143], v[20:23]
    v_mfma_f32_16x16x32_bf16 v[24:27], v[212:215], v[140:143], v[24:27]
    s_waitcnt lgkmcnt(3)
    v_mfma_f32_16x16x32_bf16 v[16:19], v[168:171], v[144:147], v[16:19]
    v_mfma_f32_16x16x32_bf16 v[20:23], v[192:195], v[144:147], v[20:23]
    v_mfma_f32_16x16x32_bf16 v[24:27], v[216:219], v[144:147], v[24:27]
    s_waitcnt lgkmcnt(2)
    v_mfma_f32_16x16x32_bf16 v[16:19], v[172:175], v[148:151], v[16:19]
    s_waitcnt lgkmcnt(1)
    v_mfma_f32_16x16x32_bf16 v[16:19], v[176:179], v[152:155], v[16:19]
    s_waitcnt lgkmcnt(0)
    v_mfma_f32_16x16x32_bf16 v[16:19], v[180:183], v[156:159], v[16:19]
    v_mfma_f32_16x16x32_bf16 v[20:23], v[196:199], v[148:151], v[20:23]
    v_mfma_f32_16x16x32_bf16 v[20:23], v[200:203], v[152:155], v[20:23]
    v_mfma_f32_16x16x32_bf16 v[20:23], v[204:207], v[156:159], v[20:23]
    v_mfma_f32_16x16x32_bf16 v[24:27], v[220:223], v[148:151], v[24:27]
    v_mfma_f32_16x16x32_bf16 v[24:27], v[224:227], v[152:155], v[24:27]
    s_nop 2
    v_cvt_pk_bf16_f32 v32, v16, v17
    v_mfma_f32_16x16x32_bf16 v[24:27], v[228:231], v[156:159], v[24:27]
    v_cvt_pk_bf16_f32 v33, v18, v19
    v_cvt_pk_bf16_f32 v34, v20, v21
    v_cvt_pk_bf16_f32 v36, v22, v23
    v_permlane16_swap_b32 v35, v39
    s_nop 0
    v_permlane16_swap_b32 v32, v36
    s_nop 1
    v_cvt_pk_bf16_f32 v37, v24, v25
    v_cvt_pk_bf16_f32 v38, v26, v27
    s_nop 0
    v_permlane16_swap_b32 v33, v37
    v_permlane16_swap_b32 v34, v38
    buffer_store_dwordx4 v[32:35], v242, s[32:35], s28 offen sc1
    buffer_store_dwordx4 v[36:39], v243, s[32:35], s28 offen sc1
    s_cmp_lt_u32 s29, 64
    s_cbranch_scc0 L_fin
    buffer_load_dwordx4 v[76:79], v65, s[32:35], s30 offen offset:0 sc1
    buffer_load_dwordx4 v[80:83], v65, s[32:35], s30 offen offset:1024 sc1
    buffer_load_dwordx4 v[84:87], v65, s[32:35], s30 offen offset:2048 sc1
    buffer_load_dwordx4 v[108:111], v65, s[32:35], s30 offen offset:3072 sc1
    buffer_load_dwordx4 v[112:115], v65, s[32:35], s31 offen offset:0 sc1
    buffer_load_dwordx4 v[128:131], v65, s[32:35], s31 offen offset:1024 sc1
    buffer_load_dwordx4 v[132:135], v65, s[32:35], s31 offen offset:2048 sc1
    buffer_load_dwordx4 v[52:55], v65, s[32:35], s31 offen offset:3072 sc1
    ds_bpermute_b32 v42, v252, v4
    v_bfe_u32 v48, v0, 2, 1
    v_cmp_eq_u32 vcc, 1, v48
    v_mov_b32 v246, s39
    s_movk_i32 s26, 0x101
    v_sub_u32 v247, 0, v246
    v_cndmask_b32 v247, v247, v246, vcc
    v_mul_lo_u32 v246, v247, -2
    v_mov_b32 v16, 0
    v_mov_b32 v17, 0
    v_mov_b32 v18, 0
    v_mov_b32 v19, 0
    v_mov_b32 v20, 0
    v_mov_b32 v21, 0
    v_mov_b32 v22, 0
    v_mov_b32 v97, 0
    s_mov_b32 s53, 0
    v_mov_b32 v160, 0x101
    v_mov_b32 v161, 0x202
    v_mov_b32 v162, 0x404
    v_mov_b32 v163, 0x808
    v_mov_b32 v164, 0x1010
    v_mov_b32 v165, 0x2020
    v_mov_b32 v166, 0x4040
    v_mov_b32 v167, 0x8080
    s_waitcnt vmcnt(0)
    v_sub_u32_dpp v136, v79, v79 row_half_mirror row_mask:0xf bank_mask:0xf
    v_sub_u32_dpp v137, v83, v83 row_half_mirror row_mask:0xf bank_mask:0xf
    v_sub_u32_dpp v138, v87, v87 row_half_mirror row_mask:0xf bank_mask:0xf
    v_sub_u32_dpp v139, v111, v111 row_half_mirror row_mask:0xf bank_mask:0xf
    v_sub_u32_dpp v140, v115, v115 row_half_mirror row_mask:0xf bank_mask:0xf
    v_sub_u32_dpp v141, v131, v131 row_half_mirror row_mask:0xf bank_mask:0xf
    v_sub_u32_dpp v142, v135, v135 row_half_mirror row_mask:0xf bank_mask:0xf
    v_sub_u32_dpp v143, v55, v55 row_half_mirror row_mask:0xf bank_mask:0xf
    v_cmp_eq_u32 s[6:7], v136, v246
    v_cmp_eq_u32 s[8:9], v137, v246
    v_cmp_eq_u32 s[10:11], v138, v246
    v_cmp_eq_u32 s[12:13], v139, v246
    v_cmp_eq_u32 s[14:15], v140, v246
    v_cmp_eq_u32 s[16:17], v141, v246
    v_cmp_eq_u32 s[36:37], v142, v246
    v_cmp_eq_u32 s[40:41], v143, v246
    v_cndmask_b32 v136, v160, 0, s[6:7]
    v_cndmask_b32 v137, v161, 0, s[8:9]
    v_cndmask_b32 v138, v162, 0, s[10:11]
    v_cndmask_b32 v139, v163, 0, s[12:13]
    v_cndmask_b32 v140, v164, 0, s[14:15]
    v_cndmask_b32 v141, v165, 0, s[16:17]
    v_cndmask_b32 v142, v166, 0, s[36:37]
    v_cndmask_b32 v143, v167, 0, s[40:41]
    v_or3_b32 v96, v136, v137, v138
    v_or3_b32 v139, v139, v140, v141
    v_or3_b32 v96, v96, v142, v143
    v_or_b32 v96, v96, v139
    v_cmp_ne_u32 vcc, 0, v96
    v_sub_u32 v168, v79, v247
    v_sub_u32 v169, v83, v247
    v_sub_u32 v170, v87, v247
    v_sub_u32 v171, v111, v247
    s_cbranch_vccz L_c_all
    v_lshrrev_b32 v48, v97, v96
    v_ffbl_b32 v48, v48
    v_add_u32 v48, v48, v97
    v_and_b32 v48, 7, v48
    v_lshl_add_u32 v51, v48, 10, v65
    v_lshlrev_b32 v88, v48, s26
    v_add_u32 v97, 1, v48
    s_mov_b64 exec, vcc
    buffer_load_dwordx4 v[136:139], v51, s[32:35], s30 offen sc1
    s_mov_b64 exec, -1
    v_lshrrev_b32 v48, v97, v96
    v_ffbl_b32 v48, v48
    v_add_u32 v48, v48, v97
    v_and_b32 v48, 7, v48
    v_lshl_add_u32 v51, v48, 10, v65
    v_lshlrev_b32 v89, v48, s26
    v_add_u32 v97, 1, v48
    s_mov_b64 exec, vcc
    buffer_load_dwordx4 v[140:143], v51, s[32:35], s30 offen sc1
    s_mov_b64 exec, -1
    v_lshrrev_b32 v48, v97, v96
    v_ffbl_b32 v48, v48
    v_add_u32 v48, v48, v97
    v_and_b32 v48, 7, v48
    v_lshl_add_u32 v51, v48, 10, v65
    v_lshlrev_b32 v90, v48, s26
    v_add_u32 v97, 1, v48
    s_mov_b64 exec, vcc
    buffer_load_dwordx4 v[144:147], v51, s[32:35], s30 offen sc1
    s_mov_b64 exec, -1
    v_lshrrev_b32 v48, v97, v96
    v_ffbl_b32 v48, v48
    v_add_u32 v48, v48, v97
    v_and_b32 v48, 7, v48
    v_lshl_add_u32 v51, v48, 10, v65
    v_lshlrev_b32 v91, v48, s26
    v_add_u32 v97, 1, v48
    s_mov_b64 exec, vcc
    buffer_load_dwordx4 v[148:151], v51, s[32:35], s30 offen sc1
    s_mov_b64 exec, -1
L_c_all:
    v_sub_u32 v172, v115, v247
    v_sub_u32 v173, v131, v247
    v_sub_u32 v174, v135, v247
    v_sub_u32 v175, v55, v247
    s_waitcnt lgkmcnt(0)
    v_sub_f32 v168, v168, v42
    v_sub_f32 v169, v169, v42
    v_sub_f32 v170, v170, v42
    v_sub_f32 v171, v171, v42
    v_sub_f32 v172, v172, v42
    v_sub_f32 v173, v173, v42
    v_sub_f32 v174, v174, v42
    v_sub_f32 v175, v175, v42
    v_exp_f32 v168, v168
    v_exp_f32 v169, v169
    v_exp_f32 v170, v170
    v_exp_f32 v171, v171
    v_exp_f32 v172, v172
    v_exp_f32 v173, v173
    v_exp_f32 v174, v174
    v_exp_f32 v175, v175
    v_cvt_pk_bf16_f32 v168, v168, 0
    v_cvt_pk_bf16_f32 v169, v169, 0
    v_cvt_pk_bf16_f32 v170, v170, 0
    v_cvt_pk_bf16_f32 v171, v171, 0
    v_cvt_pk_bf16_f32 v172, v172, 0
    v_cvt_pk_bf16_f32 v173, v173, 0
    v_cvt_pk_bf16_f32 v174, v174, 0
    v_cvt_pk_bf16_f32 v175, v175, 0
    v_lshlrev_b32 v176, 16, v168
    v_lshlrev_b32 v177, 16, v169
    v_lshlrev_b32 v178, 16, v170
    v_lshlrev_b32 v179, 16, v171
    v_lshlrev_b32 v180, 16, v172
    v_lshlrev_b32 v181, 16, v173
    v_lshlrev_b32 v182, 16, v174
    v_lshlrev_b32 v183, 16, v175
    s_mov_b64 exec, s[6:7]
    v_dot2c_f32_bf16 v16, v76, v168
    v_dot2c_f32_bf16 v18, v77, v168
    v_dot2c_f32_bf16 v20, v78, v168
    v_add_f32 v22, v22, v176
    v_dot2c_f32_bf16 v17, v76, v176
    v_dot2c_f32_bf16 v19, v77, v176
    v_dot2c_f32_bf16 v21, v78, v176
    s_mov_b64 exec, s[8:9]
    v_dot2c_f32_bf16 v16, v80, v169
    v_dot2c_f32_bf16 v18, v81, v169
    v_dot2c_f32_bf16 v20, v82, v169
    v_add_f32 v22, v22, v177
    v_dot2c_f32_bf16 v17, v80, v177
    v_dot2c_f32_bf16 v19, v81, v177
    v_dot2c_f32_bf16 v21, v82, v177
    s_mov_b64 exec, s[10:11]
    v_dot2c_f32_bf16 v16, v84, v170
    v_dot2c_f32_bf16 v18, v85, v170
    v_dot2c_f32_bf16 v20, v86, v170
    v_add_f32 v22, v22, v178
    v_dot2c_f32_bf16 v17, v84, v178
    v_dot2c_f32_bf16 v19, v85, v178
    v_dot2c_f32_bf16 v21, v86, v178
    s_mov_b64 exec, s[12:13]
    v_dot2c_f32_bf16 v16, v108, v171
    v_dot2c_f32_bf16 v18, v109, v171
    v_dot2c_f32_bf16 v20, v110, v171
    v_add_f32 v22, v22, v179
    v_dot2c_f32_bf16 v17, v108, v179
    v_dot2c_f32_bf16 v19, v109, v179
    v_dot2c_f32_bf16 v21, v110, v179
    s_mov_b64 exec, s[14:15]
    v_dot2c_f32_bf16 v16, v112, v172
    v_dot2c_f32_bf16 v18, v113, v172
    v_dot2c_f32_bf16 v20, v114, v172
    v_add_f32 v22, v22, v180
    v_dot2c_f32_bf16 v17, v112, v180
    v_dot2c_f32_bf16 v19, v113, v180
    v_dot2c_f32_bf16 v21, v114, v180
    s_mov_b64 exec, s[16:17]
    v_dot2c_f32_bf16 v16, v128, v173
    v_dot2c_f32_bf16 v18, v129, v173
    v_dot2c_f32_bf16 v20, v130, v173
    v_add_f32 v22, v22, v181
    v_dot2c_f32_bf16 v17, v128, v181
    v_dot2c_f32_bf16 v19, v129, v181
    v_dot2c_f32_bf16 v21, v130, v181
    s_mov_b64 exec, s[36:37]
    v_dot2c_f32_bf16 v16, v132, v174
    v_dot2c_f32_bf16 v18, v133, v174
    v_dot2c_f32_bf16 v20, v134, v174
    v_add_f32 v22, v22, v182
    v_dot2c_f32_bf16 v17, v132, v182
    v_dot2c_f32_bf16 v19, v133, v182
    v_dot2c_f32_bf16 v21, v134, v182
    s_mov_b64 exec, s[40:41]
    v_dot2c_f32_bf16 v16, v52, v175
    v_dot2c_f32_bf16 v18, v53, v175
    v_dot2c_f32_bf16 v20, v54, v175
    v_add_f32 v22, v22, v183
    v_dot2c_f32_bf16 v17, v52, v183
    v_dot2c_f32_bf16 v19, v53, v183
    v_dot2c_f32_bf16 v21, v54, v183
    s_mov_b64 exec, -1
    s_cbranch_vccz L_c_red
L_c_loop:
    s_waitcnt vmcnt(3)
    v_sub_u32_dpp v48, v139, v139 row_half_mirror row_mask:0xf bank_mask:0xf
    v_and_b32 v49, v88, v96
    v_cmpx_eq_u32 vcc, v48, v246
    v_cmpx_ne_u32 vcc, 0, v49
    v_xor_b32 v96, v96, v88
    v_sub_u32 v49, v139, v247
    v_sub_f32 v49, v49, v42
    v_exp_f32 v49, v49
    s_cbranch_execz L_c_s0
    v_cvt_pk_bf16_f32 v49, v49, 0
    v_lshlrev_b32 v50, 16, v49
    v_dot2c_f32_bf16 v16, v136, v49
    v_dot2c_f32_bf16 v18, v137, v49
    v_dot2c_f32_bf16 v20, v138, v49
    v_add_f32 v22, v22, v50
    v_dot2c_f32_bf16 v17, v136, v50
    v_dot2c_f32_bf16 v19, v137, v50
    v_dot2c_f32_bf16 v21, v138, v50
L_c_s0:
    s_mov_b64 exec, -1
    v_cmp_ne_u32 vcc, 0, v96
    v_lshrrev_b32 v48, v97, v96
    v_ffbl_b32 v48, v48
    s_cbranch_vccz L_c_red
    v_add_u32 v48, v48, v97
    v_and_b32 v48, 7, v48
    v_lshl_add_u32 v51, v48, 10, v65
    v_lshlrev_b32 v88, v48, s26
    v_add_u32 v97, 1, v48
    s_mov_b64 exec, vcc
    buffer_load_dwordx4 v[136:139], v51, s[32:35], s30 offen sc1
    s_mov_b64 exec, -1
    s_waitcnt vmcnt(3)
    v_sub_u32_dpp v48, v143, v143 row_half_mirror row_mask:0xf bank_mask:0xf
    v_and_b32 v49, v89, v96
    v_cmpx_eq_u32 vcc, v48, v246
    v_cmpx_ne_u32 vcc, 0, v49
    v_xor_b32 v96, v96, v89
    v_sub_u32 v49, v143, v247
    v_sub_f32 v49, v49, v42
    v_exp_f32 v49, v49
    s_cbranch_execz L_c_s1
    v_cvt_pk_bf16_f32 v49, v49, 0
    v_lshlrev_b32 v50, 16, v49
    v_dot2c_f32_bf16 v16, v140, v49
    v_dot2c_f32_bf16 v18, v141, v49
    v_dot2c_f32_bf16 v20, v142, v49
    v_add_f32 v22, v22, v50
    v_dot2c_f32_bf16 v17, v140, v50
    v_dot2c_f32_bf16 v19, v141, v50
    v_dot2c_f32_bf16 v21, v142, v50
L_c_s1:
    s_mov_b64 exec, -1
    v_cmp_ne_u32 vcc, 0, v96
    v_lshrrev_b32 v48, v97, v96
    v_ffbl_b32 v48, v48
    s_cbranch_vccz L_c_red
    v_add_u32 v48, v48, v97
    v_and_b32 v48, 7, v48
    v_lshl_add_u32 v51, v48, 10, v65
    v_lshlrev_b32 v89, v48, s26
    v_add_u32 v97, 1, v48
    s_mov_b64 exec, vcc
    buffer_load_dwordx4 v[140:143], v51, s[32:35], s30 offen sc1
    s_mov_b64 exec, -1
    s_waitcnt vmcnt(3)
    v_sub_u32_dpp v48, v147, v147 row_half_mirror row_mask:0xf bank_mask:0xf
    v_and_b32 v49, v90, v96
    v_cmpx_eq_u32 vcc, v48, v246
    v_cmpx_ne_u32 vcc, 0, v49
    v_xor_b32 v96, v96, v90
    v_sub_u32 v49, v147, v247
    v_sub_f32 v49, v49, v42
    v_exp_f32 v49, v49
    s_cbranch_execz L_c_s2
    v_cvt_pk_bf16_f32 v49, v49, 0
    v_lshlrev_b32 v50, 16, v49
    v_dot2c_f32_bf16 v16, v144, v49
    v_dot2c_f32_bf16 v18, v145, v49
    v_dot2c_f32_bf16 v20, v146, v49
    v_add_f32 v22, v22, v50
    v_dot2c_f32_bf16 v17, v144, v50
    v_dot2c_f32_bf16 v19, v145, v50
    v_dot2c_f32_bf16 v21, v146, v50
L_c_s2:
    s_mov_b64 exec, -1
    v_cmp_ne_u32 vcc, 0, v96
    v_lshrrev_b32 v48, v97, v96
    v_ffbl_b32 v48, v48
    s_cbranch_vccz L_c_red
    v_add_u32 v48, v48, v97
    v_and_b32 v48, 7, v48
    v_lshl_add_u32 v51, v48, 10, v65
    v_lshlrev_b32 v90, v48, s26
    v_add_u32 v97, 1, v48
    s_mov_b64 exec, vcc
    buffer_load_dwordx4 v[144:147], v51, s[32:35], s30 offen sc1
    s_mov_b64 exec, -1
    s_waitcnt vmcnt(3)
    v_sub_u32_dpp v48, v151, v151 row_half_mirror row_mask:0xf bank_mask:0xf
    v_and_b32 v49, v91, v96
    v_cmpx_eq_u32 vcc, v48, v246
    v_cmpx_ne_u32 vcc, 0, v49
    v_xor_b32 v96, v96, v91
    v_sub_u32 v49, v151, v247
    v_sub_f32 v49, v49, v42
    v_exp_f32 v49, v49
    s_cbranch_execz L_c_s3
    v_cvt_pk_bf16_f32 v49, v49, 0
    v_lshlrev_b32 v50, 16, v49
    v_dot2c_f32_bf16 v16, v148, v49
    v_dot2c_f32_bf16 v18, v149, v49
    v_dot2c_f32_bf16 v20, v150, v49
    v_add_f32 v22, v22, v50
    v_dot2c_f32_bf16 v17, v148, v50
    v_dot2c_f32_bf16 v19, v149, v50
    v_dot2c_f32_bf16 v21, v150, v50
L_c_s3:
    s_mov_b64 exec, -1
    v_cmp_ne_u32 vcc, 0, v96
    v_lshrrev_b32 v48, v97, v96
    v_ffbl_b32 v48, v48
    s_cbranch_vccz L_c_red
    v_add_u32 v48, v48, v97
    v_and_b32 v48, 7, v48
    v_lshl_add_u32 v51, v48, 10, v65
    v_lshlrev_b32 v91, v48, s26
    v_add_u32 v97, 1, v48
    s_mov_b64 exec, vcc
    buffer_load_dwordx4 v[148:151], v51, s[32:35], s30 offen sc1
    s_mov_b64 exec, -1
    s_add_u32 s53, s53, 1
    s_cmp_lt_u32 s53, 65536
    s_cbranch_scc1 L_c_loop
L_c_red:
    v_mov_b32 v23, v22
    v_permlane32_swap_b32 v16, v20
    v_permlane32_swap_b32 v17, v21
    v_permlane32_swap_b32 v18, v22
    v_permlane32_swap_b32 v19, v23
    v_add_f32 v16, v16, v20
    v_add_f32 v17, v17, v21
    v_add_f32 v18, v18, v22
    v_add_f32 v19, v19, v23
    s_nop 0
    v_permlane16_swap_b32 v16, v18
    v_permlane16_swap_b32 v17, v19
    v_add_f32 v16, v16, v18
    v_add_f32 v17, v17, v19
    s_nop 0
    v_add_f32_dpp v48, v16, v16 row_ror:8 row_mask:0xf bank_mask:0x3
    s_nop 1
    v_add_f32_dpp v48, v17, v17 row_ror:8 row_mask:0xf bank_mask:0xc
    ds_write_b32 v250, v48
    s_waitcnt lgkmcnt(0)
    s_barrier
    ds_read_b128 v[48:51], v251 offset:768
    ds_read_b128 v[52:55], v65
    v_lshlrev_b32 v18, 16, v249
    s_waitcnt lgkmcnt(1)
    v_add_f32 v48, v48, v49
    v_add_f32 v50, v50, v51
    v_add_f32 v48, v48, v50
    v_cmp_nlt_f32 vcc, v48, v232
    v_rcp_f32 v48, v48
    s_waitcnt lgkmcnt(0)
    s_cbranch_vccnz L_c_slow
L_c_out:
    s_cmp_lg_u32 s3, 0
    s_cbranch_scc1 L_fin
    v_add_f32 v52, v52, v53
    v_add_f32 v54, v54, v55
    v_add_f32 v52, v52, v54
    v_fmac_f32 v18, v52, v48
    v_cvt_pk_bf16_f32 v18, v18, v18
    buffer_store_short v18, v248, s[68:71], 0 offen sc1
    s_cmp_lg_u32 s29, 0
    s_cbranch_scc1 L_fin
    v_mov_b32 v48, s39
    v_mov_b32 v49, 0
    s_mov_b64 exec, 1
    buffer_store_dword v48, v49, s[32:35], 0 offen offset:0 sc1
    s_mov_b64 exec, -1
L_fin:
L_end:
    s_endpgm
L_hot:
L_prod:
    s_cmp_lg_u32 s3, 0
    s_cbranch_scc1 L_p_noq
    s_mov_b32 m0, 147456
    s_nop 0
    buffer_load_dwordx4 v16, s[72:75], 0 offen offset:0  lds
    buffer_load_dwordx4 v17, s[72:75], 0 offen offset:1024  lds
    buffer_load_dwordx4 v18, s[72:75], 0 offen offset:2048  lds
    buffer_load_dwordx4 v19, s[72:75], 0 offen offset:3072  lds
    s_mov_b32 m0, 151552
    s_nop 0
    buffer_load_dwordx4 v20, s[72:75], 0 offen offset:0  lds
    buffer_load_dwordx4 v21, s[72:75], 0 offen offset:1024  lds
L_p_noq:
    s_mul_i32 s60, s3, 18432
    s_add_u32 m0, s60, 73728
    s_nop 0
    buffer_load_dwordx4 v16, s[64:67], s60 offen offset:0  lds
    buffer_load_dwordx4 v17, s[64:67], s60 offen offset:1024  lds
    buffer_load_dwordx4 v18, s[64:67], s60 offen offset:2048  lds
    buffer_load_dwordx4 v19, s[64:67], s60 offen offset:3072  lds
    s_add_u32 m0, s60, 77824
    s_nop 0
    buffer_load_dwordx4 v20, s[64:67], s60 offen offset:0  lds
    buffer_load_dwordx4 v21, s[64:67], s60 offen offset:1024  lds
    s_add_u32 s60, s60, 6144
    s_add_u32 m0, s60, 73728
    s_nop 0
    buffer_load_dwordx4 v16, s[64:67], s60 offen offset:0  lds
    buffer_load_dwordx4 v17, s[64:67], s60 offen offset:1024  lds
    buffer_load_dwordx4 v18, s[64:67], s60 offen offset:2048  lds
    buffer_load_dwordx4 v19, s[64:67], s60 offen offset:3072  lds
    s_add_u32 m0, s60, 77824
    s_nop 0
    buffer_load_dwordx4 v20, s[64:67], s60 offen offset:0  lds
    buffer_load_dwordx4 v21, s[64:67], s60 offen offset:1024  lds
    s_add_u32 s60, s60, 6144
    s_add_u32 m0, s60, 73728
    s_nop 0
    buffer_load_dwordx4 v16, s[64:67], s60 offen offset:0  lds
    v_mov_b32 v52, 0x3f803f80
    v_mov_b32 v56, 0x3ebcbe62
    s_mov_b32 s44, 0x100001
    s_mov_b32 s45, 0x10000100
    v_mov_b32 v53, 0x3f803f80
    v_mov_b32 v57, 0x3ebcbe62
    s_mov_b32 s46, 0x200002
    buffer_load_dwordx4 v17, s[64:67], s60 offen offset:1024  lds
    s_mov_b32 s47, 0x20000200
    v_mov_b32 v54, 0x3f803f80
    v_mov_b32 v58, 0x3ebcbe62
    s_mov_b32 s48, 0x400004
    s_mov_b32 s49, 0x40000400
    v_mov_b32 v55, 0x3f803f80
    v_mov_b32 v59, 0x3ebcbe62
    buffer_load_dwordx4 v18, s[64:67], s60 offen offset:2048  lds
    s_mov_b32 s50, 0x800008
    s_mov_b32 s51, 0x80000800
    v_mov_b32 v60, 0x43400000
    v_lshrrev_b32 v1, 5, v0
    v_lshlrev_b32 v1, 8, v1
    v_and_b32 v2, 15, v0
    v_lshl_add_u32 v1, v2, 4, v1
    buffer_load_dwordx4 v19, s[64:67], s60 offen offset:3072  lds
    v_bfe_u32 v2, v0, 4, 1
    v_lshl_add_u32 v1, v2, 3, v1
    s_mul_i32 s56, s3, 1536
    s_add_u32 s56, s56, 153600
    v_add_u32 v134, s56, v1
    v_bfe_u32 v1, v0, 4, 1
    v_lshrrev_b32 v5, 5, v0
    s_add_u32 m0, s60, 77824
    s_nop 0
    buffer_load_dwordx4 v20, s[64:67], s60 offen offset:0  lds
    v_lshl_or_b32 v1, v1, 1, v5
    v_bfe_u32 v2, v0, 2, 2
    v_lshl_add_u32 v3, v1, 3, v2
    v_mul_u32_u24 v3, 384, v3
    v_and_b32 v4, 1, v0
    v_lshl_add_u32 v3, v4, 3, v3
    v_add_u32 v3, 73728, v3
    buffer_load_dwordx4 v21, s[64:67], s60 offen offset:1024  lds
    v_and_or_b32 v2, v2, 2, v5
    v_bfe_u32 v4, v0, 1, 1
    v_xor_b32 v2, v2, v4
    s_mul_i32 s56, s3, 6
    s_add_u32 s57, s56, 0
    v_xor_b32 v4, s57, v2
    v_lshl_add_u32 v124, v4, 4, v3
    s_lshl_b32 s61, s43, 2
    s_add_u32 s61, s61, s3
    s_mul_i32 s60, s61, 6144
    s_add_u32 m0, s41, 6144
    s_nop 0
    buffer_load_dwordx4 v16, s[68:71], s60 offen offset:0  lds
    v_xor_b32 v125, 64, v124
    s_add_u32 s57, s56, 2
    v_xor_b32 v4, s57, v2
    v_lshl_add_u32 v126, v4, 4, v3
    v_xor_b32 v127, 64, v126
    s_add_u32 s57, s56, 4
    v_xor_b32 v4, s57, v2
    buffer_load_dwordx4 v17, s[68:71], s60 offen offset:1024  lds
    v_lshl_add_u32 v128, v4, 4, v3
    v_xor_b32 v129, 64, v128
    v_and_b32 v2, 15, v0
    v_bfe_u32 v3, v0, 3, 1
    v_and_or_b32 v4, v0, 6, v3
    v_xor_b32 v4, v4, v1
    v_mul_u32_u24 v2, 384, v2
    buffer_load_dwordx4 v18, s[68:71], s60 offen offset:2048  lds
    v_lshl_add_u32 v2, v4, 4, v2
    v_add_u32 v132, 147456, v2
    v_xor_b32 v133, 64, v132
    s_and_b32 s56, s3, 1
    s_lshl_b32 s56, s56, 2
    s_lshr_b32 s57, s3, 1
    s_mul_i32 s57, s57, 24576
    buffer_load_dwordx4 v19, s[68:71], s60 offen offset:3072  lds
    s_add_u32 s57, s57, 30720
    v_and_b32 v1, 11, v0
    v_or_b32 v1, s56, v1
    v_and_or_b32 v2, v1, 6, v3
    v_lshrrev_b32 v3, 4, v0
    v_xor_b32 v2, v2, v3
    v_mul_u32_u24 v1, 384, v1
    s_add_u32 m0, s41, 10240
    s_nop 0
    buffer_load_dwordx4 v20, s[68:71], s60 offen offset:0  lds
    v_lshl_add_u32 v1, v2, 4, v1
    v_bfe_u32 v2, v0, 2, 1
    v_mul_u32_u24 v2, 12288, v2
    v_add3_u32 v130, s57, v1, v2
    v_xor_b32 v131, 64, v130
    v_add_u32 v135, 153600, v65
    buffer_load_dwordx4 v21, s[68:71], s60 offen offset:1024  lds
    s_waitcnt vmcnt(24)
    s_barrier
    s_load_dword s38, s[22:23], 0
    ds_read_b128 v[136:139], v132 offset:0
    ds_read_b128 v[140:143], v133 offset:0
    ds_read_b128 v[144:147], v132 offset:128
    ds_read_b128 v[148:151], v133 offset:128
    ds_read_b128 v[152:155], v132 offset:256
    ds_read_b128 v[156:159], v133 offset:256
    s_add_u32 m0, s40, 0
    s_add_u32 s57, s36, 0
    buffer_load_dwordx4 v16, s[28:31], s57 offen offset:0 nt lds
    buffer_load_dwordx4 v17, s[28:31], s57 offen offset:1024 nt lds
    buffer_load_dwordx4 v18, s[28:31], s57 offen offset:2048 nt lds
    buffer_load_dwordx4 v19, s[28:31], s57 offen offset:3072 nt lds
    s_add_u32 m0, s40, 4096
    s_nop 0
    buffer_load_dwordx4 v20, s[28:31], s57 offen offset:0 nt lds
    buffer_load_dwordx4 v21, s[28:31], s57 offen offset:1024 nt lds
    s_waitcnt lgkmcnt(0)
    v_mfma_f32_16x16x32_bf16 v[112:115], v[136:139], v[136:139], 0
    v_mfma_f32_16x16x32_bf16 v[116:119], v[52:55], v[136:139], 0
    s_add_u32 m0, s41, 0
    s_add_u32 s58, s37, 0
    buffer_load_dwordx4 v22, s[24:27], s58 offen offset:0 nt lds
    v_mfma_f32_16x16x32_bf16 v[112:115], v[140:143], v[140:143], v[112:115]
    v_mfma_f32_16x16x32_bf16 v[116:119], v[52:55], v[140:143], v[116:119]
    buffer_load_dwordx4 v23, s[24:27], s58 offen offset:1024 nt lds
    v_mfma_f32_16x16x32_bf16 v[112:115], v[144:147], v[144:147], v[112:115]
    v_mfma_f32_16x16x32_bf16 v[116:119], v[52:55], v[144:147], v[116:119]
    buffer_load_dwordx4 v24, s[24:27], s58 offen offset:2048 nt lds
    v_mfma_f32_16x16x32_bf16 v[112:115], v[148:151], v[148:151], v[112:115]
    v_mfma_f32_16x16x32_bf16 v[116:119], v[52:55], v[148:151], v[116:119]
    v_mfma_f32_16x16x32_bf16 v[112:115], v[152:155], v[152:155], v[112:115]
    v_mfma_f32_16x16x32_bf16 v[116:119], v[52:55], v[152:155], v[116:119]
    v_mfma_f32_16x16x32_bf16 v[112:115], v[156:159], v[156:159], v[112:115]
    v_mfma_f32_16x16x32_bf16 v[116:119], v[52:55], v[156:159], v[116:119]
    s_mul_i32 s39, s38, 0x9e3779b1
    s_add_u32 s39, s39, 0x7f4a7c16
    s_or_b32 s39, s39, 1
    s_lshl_b32 s61, s61, 10
    s_add_u32 s61, s61, 16384
    s_waitcnt vmcnt(15)
    s_barrier
    ds_read_b64_tr_b16 v[160:161], v124 offset:0
    ds_read_b64_tr_b16 v[162:163], v125 offset:1536
    ds_read_b64_tr_b16 v[184:185], v126 offset:0
    ds_read_b64_tr_b16 v[186:187], v127 offset:1536
    ds_read_b64_tr_b16 v[208:209], v128 offset:0
    ds_read_b64_tr_b16 v[210:211], v129 offset:1536
    ds_read_b64_tr_b16 v[164:165], v124 offset:12288
    ds_read_b64_tr_b16 v[166:167], v125 offset:13824
    ds_read_b64_tr_b16 v[188:189], v126 offset:12288
    ds_read_b64_tr_b16 v[190:191], v127 offset:13824
    ds_read_b64_tr_b16 v[212:213], v128 offset:12288
    ds_read_b64_tr_b16 v[214:215], v129 offset:13824
    v_cndmask_b32 v3, 0, v112, s[44:45]
    v_cndmask_b32 v3, v3, v113, s[46:47]
    v_cndmask_b32 v3, v3, v114, s[48:49]
    v_cndmask_b32 v3, v3, v115, s[50:51]
    v_mul_f32 v6, 0x3baaaaab, v116
    ds_read_b64_tr_b16 v[168:169], v124 offset:24576
    ds_read_b64_tr_b16 v[170:171], v125 offset:26112
    v_mfma_f32_16x16x4_f32 v[120:123], v60, v3, v[56:59]
    s_waitcnt lgkmcnt(12)
    v_mfma_f32_16x16x32_bf16 v[88:91], v[160:163], v[136:139], 0
    ds_read_b64_tr_b16 v[192:193], v126 offset:24576
    v_mfma_f32_16x16x32_bf16 v[100:103], v[160:163], v[52:55], 0
    ds_read_b64_tr_b16 v[194:195], v127 offset:26112
    s_waitcnt lgkmcnt(12)
    v_mfma_f32_16x16x32_bf16 v[92:95], v[184:187], v[136:139], 0
    ds_read_b64_tr_b16 v[216:217], v128 offset:24576
    v_mfma_f32_16x16x32_bf16 v[104:107], v[184:187], v[52:55], 0
    ds_read_b64_tr_b16 v[218:219], v129 offset:26112
    s_waitcnt lgkmcnt(12)
    v_mfma_f32_16x16x32_bf16 v[96:99], v[208:211], v[136:139], 0
    ds_read_b64_tr_b16 v[172:173], v124 offset:36864
    v_mfma_f32_16x16x32_bf16 v[108:111], v[208:211], v[52:55], 0
    ds_read_b64_tr_b16 v[174:175], v125 offset:38400
    s_waitcnt lgkmcnt(12)
    v_mfma_f32_16x16x32_bf16 v[88:91], v[164:167], v[140:143], v[88:91]
    ds_read_b64_tr_b16 v[196:197], v126 offset:36864
    v_mfma_f32_16x16x32_bf16 v[100:103], v[164:167], v[52:55], v[100:103]
    ds_read_b64_tr_b16 v[198:199], v127 offset:38400
    s_waitcnt lgkmcnt(12)
    v_mfma_f32_16x16x32_bf16 v[92:95], v[188:191], v[140:143], v[92:95]
    ds_read_b64_tr_b16 v[220:221], v128 offset:36864
    v_mfma_f32_16x16x32_bf16 v[104:107], v[188:191], v[52:55], v[104:107]
    ds_read_b64_tr_b16 v[222:223], v129 offset:38400
    s_waitcnt lgkmcnt(12)
    v_mfma_f32_16x16x32_bf16 v[96:99], v[212:215], v[140:143], v[96:99]
    ds_read_b64_tr_b16 v[176:177], v124 offset:49152
    v_mfma_f32_16x16x32_bf16 v[108:111], v[212:215], v[52:55], v[108:111]
    ds_read_b64_tr_b16 v[178:179], v125 offset:50688
    s_waitcnt lgkmcnt(12)
    v_mfma_f32_16x16x32_bf16 v[88:91], v[168:171], v[144:147], v[88:91]
    ds_read_b64_tr_b16 v[200:201], v126 offset:49152
    v_mfma_f32_16x16x32_bf16 v[100:103], v[168:171], v[52:55], v[100:103]
    ds_read_b64_tr_b16 v[202:203], v127 offset:50688
    s_waitcnt lgkmcnt(12)
    v_mfma_f32_16x16x32_bf16 v[92:95], v[192:195], v[144:147], v[92:95]
    ds_read_b64_tr_b16 v[224:225], v128 offset:49152
    v_mfma_f32_16x16x32_bf16 v[104:107], v[192:195], v[52:55], v[104:107]
    ds_read_b64_tr_b16 v[226:227], v129 offset:50688
    s_waitcnt lgkmcnt(12)
    v_mfma_f32_16x16x32_bf16 v[96:99], v[216:219], v[144:147], v[96:99]
    ds_read_b64_tr_b16 v[180:181], v124 offset:61440
    v_mfma_f32_16x16x32_bf16 v[108:111], v[216:219], v[52:55], v[108:111]
    ds_read_b64_tr_b16 v[182:183], v125 offset:62976
    s_waitcnt lgkmcnt(12)
    v_mfma_f32_16x16x32_bf16 v[88:91], v[172:175], v[148:151], v[88:91]
    ds_read_b64_tr_b16 v[204:205], v126 offset:61440
    v_mfma_f32_16x16x32_bf16 v[100:103], v[172:175], v[52:55], v[100:103]
    ds_read_b64_tr_b16 v[206:207], v127 offset:62976
    s_waitcnt lgkmcnt(12)
    v_mfma_f32_16x16x32_bf16 v[92:95], v[196:199], v[148:151], v[92:95]
    ds_read_b64_tr_b16 v[228:229], v128 offset:61440
    v_mfma_f32_16x16x32_bf16 v[104:107], v[196:199], v[52:55], v[104:107]
    ds_read_b64_tr_b16 v[230:231], v129 offset:62976
    s_waitcnt lgkmcnt(12)
    v_mfma_f32_16x16x32_bf16 v[96:99], v[220:223], v[148:151], v[96:99]
    v_fma_f32 v5, -v116, v116, v120
    v_mfma_f32_16x16x32_bf16 v[108:111], v[220:223], v[52:55], v[108:111]
    v_max_f32 v5, v5, v56
    s_waitcnt lgkmcnt(10)
    v_mfma_f32_16x16x32_bf16 v[88:91], v[176:179], v[152:155], v[88:91]
    v_rsq_f32 v5, v5
    v_mfma_f32_16x16x32_bf16 v[100:103], v[176:179], v[52:55], v[100:103]
    v_mov_b32 v122, s39
    s_waitcnt lgkmcnt(8)
    v_mfma_f32_16x16x32_bf16 v[92:95], v[200:203], v[152:155], v[92:95]
    v_mul_f32 v5, v60, v5
    v_mfma_f32_16x16x32_bf16 v[104:107], v[200:203], v[52:55], v[104:107]
    v_mov_b32 v123, s39
    s_waitcnt lgkmcnt(6)
    v_mfma_f32_16x16x32_bf16 v[96:99], v[224:227], v[152:155], v[96:99]
    v_mfma_f32_16x16x32_bf16 v[108:111], v[224:227], v[52:55], v[108:111]
    s_waitcnt lgkmcnt(4)
    v_mfma_f32_16x16x32_bf16 v[88:91], v[180:183], v[156:159], v[88:91]
    v_mfma_f32_16x16x32_bf16 v[100:103], v[180:183], v[52:55], v[100:103]
    s_waitcnt lgkmcnt(2)
    v_mfma_f32_16x16x32_bf16 v[92:95], v[204:207], v[156:159], v[92:95]
    v_mfma_f32_16x16x32_bf16 v[104:107], v[204:207], v[52:55], v[104:107]
    s_waitcnt lgkmcnt(0)
    v_mfma_f32_16x16x32_bf16 v[96:99], v[228:231], v[156:159], v[96:99]
    v_mfma_f32_16x16x32_bf16 v[108:111], v[228:231], v[52:55], v[108:111]
    s_nop 1
    v_fma_f32 v88, -v6, v100, v88
    v_fma_f32 v89, -v6, v101, v89
    v_fma_f32 v90, -v6, v102, v90
    v_fma_f32 v91, -v6, v103, v91
    v_mul_f32 v88, v88, v5
    v_mul_f32 v89, v89, v5
    v_mul_f32 v90, v90, v5
    v_mul_f32 v91, v91, v5
    v_cvt_pk_bf16_f32 v112, v88, v89
    v_cvt_pk_bf16_f32 v113, v90, v91
    ds_write_b64 v134, v[112:113] offset:0
    v_fma_f32 v92, -v6, v104, v92
    v_fma_f32 v93, -v6, v105, v93
    v_fma_f32 v94, -v6, v106, v94
    v_fma_f32 v95, -v6, v107, v95
    v_mul_f32 v92, v92, v5
    v_mul_f32 v93, v93, v5
    v_mul_f32 v94, v94, v5
    v_mul_f32 v95, v95, v5
    v_cvt_pk_bf16_f32 v114, v92, v93
    v_cvt_pk_bf16_f32 v115, v94, v95
    ds_write_b64 v134, v[114:115] offset:512
    v_fma_f32 v96, -v6, v108, v96
    v_fma_f32 v97, -v6, v109, v97
    v_fma_f32 v98, -v6, v110, v98
    v_fma_f32 v99, -v6, v111, v99
    v_mul_f32 v96, v96, v5
    v_mul_f32 v97, v97, v5
    v_mul_f32 v98, v98, v5
    v_mul_f32 v99, v99, v5
    v_cvt_pk_bf16_f32 v116, v96, v97
    v_cvt_pk_bf16_f32 v117, v98, v99
    ds_write_b64 v134, v[116:117] offset:1024
    s_waitcnt vmcnt(9)
    s_waitcnt lgkmcnt(0)
    s_barrier
    ds_read_b128 v[136:139], v135 offset:0
    ds_read_b128 a[96:99], v130 offset:0
    ds_read_b128 v[140:143], v135 offset:1024
    ds_read_b128 a[100:103], v131 offset:0
    ds_read_b128 v[144:147], v135 offset:2048
    ds_read_b128 a[104:107], v130 offset:128
    ds_read_b128 v[148:151], v135 offset:3072
    ds_read_b128 a[108:111], v131 offset:128
    ds_read_b128 v[152:155], v135 offset:4096
    ds_read_b128 a[112:115], v130 offset:256
    ds_read_b128 v[156:159], v135 offset:5120
    ds_read_b128 a[116:119], v131 offset:256
    s_waitcnt lgkmcnt(10)
    v_mfma_f32_16x16x32_bf16 v[88:91], a[96:99], v[136:139], 0
    s_waitcnt lgkmcnt(8)
    v_mfma_f32_16x16x32_bf16 v[92:95], a[100:103], v[140:143], 0
    s_waitcnt lgkmcnt(6)
    v_mfma_f32_16x16x32_bf16 v[88:91], a[104:107], v[144:147], v[88:91]
    s_waitcnt lgkmcnt(4)
    v_mfma_f32_16x16x32_bf16 v[92:95], a[108:111], v[148:151], v[92:95]
    s_waitcnt lgkmcnt(2)
    v_mfma_f32_16x16x32_bf16 v[88:91], a[112:115], v[152:155], v[88:91]
    s_waitcnt lgkmcnt(0)
    v_mfma_f32_16x16x32_bf16 v[92:95], a[116:119], v[156:159], v[92:95]
    s_nop 7
    v_add_f32 v88, v88, v92
    v_add_f32 v89, v89, v93
    v_add_f32 v90, v90, v94
    v_add_f32 v91, v91, v95
    v_mul_f32 v88, 0x419fecaf, v88
    v_mul_f32 v89, 0x419fecaf, v89
    v_mul_f32 v90, 0x419fecaf, v90
    v_mul_f32 v91, 0x419fecaf, v91
    v_cvt_pk_bf16_f32 v120, v88, v89
    v_cvt_pk_bf16_f32 v121, v90, v91
    buffer_store_dwordx4 v[120:123], v65, s[32:35], s61 offen sc1
    buffer_load_dwordx4 v25, s[24:27], s58 offen offset:3072 nt lds
    s_add_u32 m0, s41, 4096
    s_nop 0
    buffer_load_dwordx4 v26, s[24:27], s58 offen offset:0 nt lds
    buffer_load_dwordx4 v27, s[24:27], s58 offen offset:1024 nt lds
    s_barrier
    buffer_load_dwordx4 v28, s[24:27], s58 offen offset:2048 nt lds
    buffer_load_dwordx4 v29, s[24:27], s58 offen offset:3072 nt lds
    s_add_u32 m0, s41, 8192
    s_nop 0
    buffer_load_dwordx4 v30, s[24:27], s58 offen offset:0 nt lds
    buffer_load_dwordx4 v31, s[24:27], s58 offen offset:1024 nt lds
    buffer_load_dwordx4 v32, s[24:27], s58 offen offset:2048 nt lds
    buffer_load_dwordx4 v33, s[24:27], s58 offen offset:3072 nt lds
    v_and_b32 v1, 15, v0
    v_lshrrev_b32 v6, 5, v0
    v_bfe_u32 v3, v0, 4, 1
    v_lshl_or_b32 v3, v3, 1, v6
    v_lshrrev_b32 v4, 2, v0
    v_bfe_u32 v5, v0, 1, 1
    v_lshrrev_b32 v6, 3, v1
    v_and_or_b32 v6, v1, 6, v6
    v_xor_b32 v6, v6, v3
    v_mul_u32_u24 v7, 384, v1
    v_lshl_add_u32 v6, v6, 4, v7
    v_add_u32 v34, s40, v6
    v_xor_b32 v35, 64, v34
    v_lshrrev_b32 v6, 3, v1
    v_and_b32 v7, 7, v1
    v_lshl_or_b32 v6, v7, 1, v6
    v_xor_b32 v6, v6, v3
    v_mul_u32_u24 v7, 768, v1
    v_lshl_add_u32 v6, v6, 4, v7
    v_add_u32 v40, s41, v6
    v_xor_b32 v41, 0x40, v40
    v_xor_b32 v42, 0x80, v40
    v_xor_b32 v43, 0xc0, v40
    v_and_b32 v2, 1, v0
    v_lshlrev_b32 v2, 3, v2
    s_mul_i32 s56, s3, 96
    v_lshrrev_b32 v6, 3, v4
    v_and_or_b32 v6, v4, 6, v6
    v_xor_b32 v6, v6, v5
    v_lshl_add_u32 v6, v6, 4, v2
    v_mul_u32_u24 v7, 384, v4
    s_add_u32 s57, s56, 0
    v_xad_u32 v36, v6, s57, v7
    s_add_u32 s57, s56, 32
    v_xad_u32 v37, v6, s57, v7
    s_add_u32 s57, s56, 64
    v_xad_u32 v38, v6, s57, v7
    v_lshrrev_b32 v6, 3, v4
    v_and_b32 v3, 7, v4
    v_lshl_or_b32 v6, v3, 1, v6
    v_xor_b32 v6, v6, v5
    v_lshl_add_u32 v6, v6, 4, v2
    v_lshlrev_b32 v7, 1, v7
    v_add_u32 v7, 24576, v7
    s_add_u32 s57, s56, 0
    v_xad_u32 v44, v6, s57, v7
    s_add_u32 s57, s56, 384
    v_xad_u32 v45, v6, s57, v7
    s_add_u32 s57, s56, 32
    v_xad_u32 v46, v6, s57, v7
    s_add_u32 s57, s56, 416
    v_xad_u32 v47, v6, s57, v7
    s_add_u32 s57, s56, 64
    v_xad_u32 v48, v6, s57, v7
    s_add_u32 s57, s56, 448
    v_xad_u32 v49, v6, s57, v7
    v_lshrrev_b32 v1, 5, v0
    v_lshlrev_b32 v1, 8, v1
    v_and_b32 v2, 15, v0
    v_lshl_add_u32 v1, v2, 4, v1
    v_bfe_u32 v2, v0, 4, 1
    v_lshl_add_u32 v1, v2, 3, v1
    s_mul_i32 s56, s3, 1536
    s_add_u32 s56, s56, 147456
    v_add_u32 v236, s56, v1
    s_mul_i32 s56, s3, 3072
    s_add_u32 s56, s56, 24576
    v_add_u32 v237, s56, v65
    v_add_u32 v238, s41, v65
    s_lshl_b32 s56, s3, 10
    v_add_u32 v240, 159744, v65
    v_add_u32 v239, s56, v240
    v_add_u32 v241, 147456, v65
    v_bfe_u32 v1, v0, 2, 2
    v_lshrrev_b32 v2, 4, v0
    v_lshl_or_b32 v1, v1, 4, v2
    v_mul_u32_u24 v1, 32768, v1
    v_and_b32 v2, 3, v0
    v_lshl_or_b32 v242, v2, 4, v1
    v_xor_b32 v243, 0x70, v242
    s_mul_i32 s56, s3, 3
    v_min_u32 v1, 2, v0
    v_add_u32 v1, s56, v1
    v_lshlrev_b32 v245, 7, v1
    v_lshlrev_b32 v1, 3, v0
    v_add_u32 v254, 126976, v1
    s_lshl_b32 s56, s3, 9
    v_add_u32 v238, s56, v254
    v_add_u32 v253, 122880, v65
    s_lshl_b32 s56, s3, 10
    v_add_u32 v237, s56, v253
    s_mov_b32 s52, 0x41c00000
    s_add_u32 m0, s42, 0
    s_add_u32 s59, s37, 196608
    buffer_load_dwordx4 v22, s[24:27], s59 offen offset:0 nt lds
    buffer_load_dwordx4 v23, s[24:27], s59 offen offset:1024 nt lds
    buffer_load_dwordx4 v24, s[24:27], s59 offen offset:2048 nt lds
    buffer_load_dwordx4 v25, s[24:27], s59 offen offset:3072 nt lds
    s_add_u32 m0, s42, 4096
    s_nop 0
    buffer_load_dwordx4 v26, s[24:27], s59 offen offset:0 nt lds
    buffer_load_dwordx4 v27, s[24:27], s59 offen offset:1024 nt lds
    buffer_load_dwordx4 v28, s[24:27], s59 offen offset:2048 nt lds
    buffer_load_dwordx4 v29, s[24:27], s59 offen offset:3072 nt lds
    s_add_u32 m0, s42, 8192
    s_nop 0
    buffer_load_dwordx4 v30, s[24:27], s59 offen offset:0 nt lds
    buffer_load_dwordx4 v31, s[24:27], s59 offen offset:1024 nt lds
    buffer_load_dwordx4 v32, s[24:27], s59 offen offset:2048 nt lds
    buffer_load_dwordx4 v33, s[24:27], s59 offen offset:3072 nt lds
    s_mov_b32 s43, -1
    s_branch L_join
L_vprod:
    s_mul_i32 s60, s3, 18432
    s_add_u32 m0, s60, 73728
    s_nop 0
    buffer_load_dwordx4 v16, s[64:67], s60 offen offset:0  lds
    buffer_load_dwordx4 v17, s[64:67], s60 offen offset:1024  lds
    buffer_load_dwordx4 v18, s[64:67], s60 offen offset:2048  lds
    buffer_load_dwordx4 v19, s[64:67], s60 offen offset:3072  lds
    s_add_u32 m0, s60, 77824
    s_nop 0
    buffer_load_dwordx4 v20, s[64:67], s60 offen offset:0  lds
    buffer_load_dwordx4 v21, s[64:67], s60 offen offset:1024  lds
    s_add_u32 s60, s60, 6144
    s_add_u32 m0, s60, 73728
    s_nop 0
    buffer_load_dwordx4 v16, s[64:67], s60 offen offset:0  lds
    buffer_load_dwordx4 v17, s[64:67], s60 offen offset:1024  lds
    buffer_load_dwordx4 v18, s[64:67], s60 offen offset:2048  lds
    buffer_load_dwordx4 v19, s[64:67], s60 offen offset:3072  lds
    s_add_u32 m0, s60, 77824
    s_nop 0
    buffer_load_dwordx4 v20, s[64:67], s60 offen offset:0  lds
    buffer_load_dwordx4 v21, s[64:67], s60 offen offset:1024  lds
    s_add_u32 s60, s60, 6144
    s_add_u32 m0, s60, 73728
    s_nop 0
    buffer_load_dwordx4 v16, s[64:67], s60 offen offset:0  lds
    v_lshrrev_b32 v1, 4, v0
    v_and_b32 v5, 1, v1
    v_bfe_u32 v2, v0, 2, 2
    v_lshl_add_u32 v3, v1, 3, v2
    buffer_load_dwordx4 v17, s[64:67], s60 offen offset:1024  lds
    v_mul_u32_u24 v3, 384, v3
    v_and_b32 v4, 1, v0
    v_lshl_add_u32 v3, v4, 3, v3
    v_add_u32 v3, 73728, v3
    buffer_load_dwordx4 v18, s[64:67], s60 offen offset:2048  lds
    v_and_or_b32 v2, v2, 2, v5
    v_bfe_u32 v4, v0, 1, 1
    v_xor_b32 v2, v2, v4
    s_mul_i32 s56, s3, 6
    buffer_load_dwordx4 v19, s[64:67], s60 offen offset:3072  lds
    s_add_u32 s57, s56, 0
    v_xor_b32 v4, s57, v2
    v_lshl_add_u32 v136, v4, 4, v3
    v_xor_b32 v137, 64, v136
    s_add_u32 m0, s60, 77824
    s_nop 0
    buffer_load_dwordx4 v20, s[64:67], s60 offen offset:0  lds
    s_add_u32 s57, s56, 2
    v_xor_b32 v4, s57, v2
    v_lshl_add_u32 v138, v4, 4, v3
    v_xor_b32 v139, 64, v138
    buffer_load_dwordx4 v21, s[64:67], s60 offen offset:1024  lds
    s_add_u32 s57, s56, 4
    v_xor_b32 v4, s57, v2
    v_lshl_add_u32 v140, v4, 4, v3
    v_xor_b32 v141, 64, v140
    s_lshl_b32 s61, s43, 2
    s_add_u32 s61, s61, s3
    s_mul_i32 s60, s61, 6144
    s_add_u32 m0, s41, 6144
    s_nop 0
    buffer_load_dwordx4 v16, s[68:71], s60 offen offset:0  lds
    v_bfe_u32 v1, v0, 2, 1
    v_and_b32 v2, 3, v0
    v_lshl_or_b32 v2, v1, 3, v2
    v_and_or_b32 v1, v0, 2, v1
    buffer_load_dwordx4 v17, s[68:71], s60 offen offset:1024  lds
    v_lshrrev_b32 v3, 4, v0
    v_xor_b32 v1, v1, v3
    v_mul_u32_u24 v2, 384, v2
    v_lshl_add_u32 v1, v1, 4, v2
    buffer_load_dwordx4 v18, s[68:71], s60 offen offset:2048  lds
    v_bfe_u32 v2, v0, 3, 1
    v_mul_u32_u24 v2, 12288, v2
    s_mov_b32 s56, 30720
    v_add3_u32 v142, s56, v1, v2
    buffer_load_dwordx4 v19, s[68:71], s60 offen offset:3072  lds
    v_xor_b32 v143, 64, v142
    s_add_u32 m0, s41, 10240
    s_nop 0
    buffer_load_dwordx4 v20, s[68:71], s60 offen offset:0  lds
    buffer_load_dwordx4 v21, s[68:71], s60 offen offset:1024  lds
    s_load_dword s38, s[22:23], 0
    s_barrier
    s_add_u32 m0, s40, 0
    s_add_u32 s57, s36, 0
    buffer_load_dwordx4 v16, s[28:31], s57 offen offset:0 nt lds
    buffer_load_dwordx4 v17, s[28:31], s57 offen offset:1024 nt lds
    buffer_load_dwordx4 v18, s[28:31], s57 offen offset:2048 nt lds
    buffer_load_dwordx4 v19, s[28:31], s57 offen offset:3072 nt lds
    s_add_u32 m0, s40, 4096
    s_nop 0
    buffer_load_dwordx4 v20, s[28:31], s57 offen offset:0 nt lds
    buffer_load_dwordx4 v21, s[28:31], s57 offen offset:1024 nt lds
    s_add_u32 m0, s41, 0
    s_add_u32 s58, s37, 0
    buffer_load_dwordx4 v22, s[24:27], s58 offen offset:0 nt lds
    buffer_load_dwordx4 v23, s[24:27], s58 offen offset:1024 nt lds
    buffer_load_dwordx4 v24, s[24:27], s58 offen offset:2048 nt lds
    s_waitcnt vmcnt(9)
    s_barrier
    ds_read_b128 a[96:99], v142 offset:0
    ds_read_b128 a[100:103], v143 offset:0
    ds_read_b128 a[104:107], v142 offset:128
    ds_read_b128 a[108:111], v143 offset:128
    ds_read_b128 a[112:115], v142 offset:256
    ds_read_b128 a[116:119], v143 offset:256
    ds_read_b128 a[120:123], v143 offset:1536
    ds_read_b128 a[124:127], v142 offset:1536
    ds_read_b128 a[128:131], v143 offset:1664
    ds_read_b128 a[132:135], v142 offset:1664
    ds_read_b128 a[136:139], v143 offset:1792
    ds_read_b128 a[140:143], v142 offset:1792
    ds_read_b128 a[144:147], v142 offset:24576
    ds_read_b128 a[148:151], v143 offset:24576
    ds_read_b128 a[152:155], v142 offset:24704
    ds_read_b128 a[156:159], v143 offset:24704
    ds_read_b128 a[160:163], v142 offset:24832
    ds_read_b128 a[164:167], v143 offset:24832
    ds_read_b128 a[168:171], v143 offset:26112
    ds_read_b128 a[172:175], v142 offset:26112
    ds_read_b128 a[176:179], v143 offset:26240
    ds_read_b128 a[180:183], v142 offset:26240
    ds_read_b128 a[184:187], v143 offset:26368
    ds_read_b128 a[188:191], v142 offset:26368
    ds_read_b64_tr_b16 v[160:161], v136 offset:0
    ds_read_b64_tr_b16 v[162:163], v137 offset:1536
    ds_read_b64_tr_b16 v[164:165], v136 offset:12288
    ds_read_b64_tr_b16 v[166:167], v137 offset:13824
    ds_read_b64_tr_b16 v[168:169], v136 offset:24576
    ds_read_b64_tr_b16 v[170:171], v137 offset:26112
    ds_read_b64_tr_b16 v[172:173], v136 offset:36864
    ds_read_b64_tr_b16 v[174:175], v137 offset:38400
    ds_read_b64_tr_b16 v[176:177], v136 offset:49152
    ds_read_b64_tr_b16 v[178:179], v137 offset:50688
    ds_read_b64_tr_b16 v[180:181], v136 offset:61440
    ds_read_b64_tr_b16 v[182:183], v137 offset:62976
    ds_read_b64_tr_b16 v[184:185], v138 offset:0
    ds_read_b64_tr_b16 v[186:187], v139 offset:1536
    ds_read_b64_tr_b16 v[188:189], v138 offset:12288
    ds_read_b64_tr_b16 v[190:191], v139 offset:13824
    ds_read_b64_tr_b16 v[192:193], v138 offset:24576
    ds_read_b64_tr_b16 v[194:195], v139 offset:26112
    ds_read_b64_tr_b16 v[196:197], v138 offset:36864
    ds_read_b64_tr_b16 v[198:199], v139 offset:38400
    ds_read_b64_tr_b16 v[200:201], v138 offset:49152
    ds_read_b64_tr_b16 v[202:203], v139 offset:50688
    ds_read_b64_tr_b16 v[204:205], v138 offset:61440
    ds_read_b64_tr_b16 v[206:207], v139 offset:62976
    ds_read_b64_tr_b16 v[208:209], v140 offset:0
    ds_read_b64_tr_b16 v[210:211], v141 offset:1536
    ds_read_b64_tr_b16 v[212:213], v140 offset:12288
    ds_read_b64_tr_b16 v[214:215], v141 offset:13824
    ds_read_b64_tr_b16 v[216:217], v140 offset:24576
    ds_read_b64_tr_b16 v[218:219], v141 offset:26112
    ds_read_b64_tr_b16 v[220:221], v140 offset:36864
    ds_read_b64_tr_b16 v[222:223], v141 offset:38400
    ds_read_b64_tr_b16 v[224:225], v140 offset:49152
    ds_read_b64_tr_b16 v[226:227], v141 offset:50688
    ds_read_b64_tr_b16 v[228:229], v140 offset:61440
    ds_read_b64_tr_b16 v[230:231], v141 offset:62976
    s_waitcnt lgkmcnt(0)
    s_barrier
    s_mul_i32 s60, s3, 18432
    s_lshl_b32 s61, s43, 11
    s_add_u32 s60, s60, s61
    s_add_u32 s60, s60, 3145728
    v_mfma_f32_16x16x32_bf16 v[88:91], a[96:99], v[160:163], 0
    v_mfma_f32_16x16x32_bf16 v[92:95], a[120:123], v[160:163], 0
    v_mfma_f32_16x16x32_bf16 v[96:99], a[144:147], v[160:163], 0
    v_mfma_f32_16x16x32_bf16 v[100:103], a[168:171], v[160:163], 0
    buffer_load_dwordx4 v25, s[24:27], s58 offen offset:3072 nt lds
    v_mfma_f32_16x16x32_bf16 v[88:91], a[100:103], v[164:167], v[88:91]
    v_mfma_f32_16x16x32_bf16 v[92:95], a[124:127], v[164:167], v[92:95]
    v_mfma_f32_16x16x32_bf16 v[96:99], a[148:151], v[164:167], v[96:99]
    v_mfma_f32_16x16x32_bf16 v[100:103], a[172:175], v[164:167], v[100:103]
    s_add_u32 m0, s41, 4096
    s_nop 0
    buffer_load_dwordx4 v26, s[24:27], s58 offen offset:0 nt lds
    v_mfma_f32_16x16x32_bf16 v[88:91], a[104:107], v[168:171], v[88:91]
    v_mfma_f32_16x16x32_bf16 v[92:95], a[128:131], v[168:171], v[92:95]
    v_mfma_f32_16x16x32_bf16 v[96:99], a[152:155], v[168:171], v[96:99]
    v_mfma_f32_16x16x32_bf16 v[100:103], a[176:179], v[168:171], v[100:103]
    buffer_load_dwordx4 v27, s[24:27], s58 offen offset:1024 nt lds
    v_mfma_f32_16x16x32_bf16 v[88:91], a[108:111], v[172:175], v[88:91]
    v_mfma_f32_16x16x32_bf16 v[92:95], a[132:135], v[172:175], v[92:95]
    v_mfma_f32_16x16x32_bf16 v[96:99], a[156:159], v[172:175], v[96:99]
    v_mfma_f32_16x16x32_bf16 v[100:103], a[180:183], v[172:175], v[100:103]
    buffer_load_dwordx4 v28, s[24:27], s58 offen offset:2048 nt lds
    v_mfma_f32_16x16x32_bf16 v[88:91], a[112:115], v[176:179], v[88:91]
    v_mfma_f32_16x16x32_bf16 v[92:95], a[136:139], v[176:179], v[92:95]
    v_mfma_f32_16x16x32_bf16 v[96:99], a[160:163], v[176:179], v[96:99]
    v_mfma_f32_16x16x32_bf16 v[100:103], a[184:187], v[176:179], v[100:103]
    buffer_load_dwordx4 v29, s[24:27], s58 offen offset:3072 nt lds
    v_mfma_f32_16x16x32_bf16 v[88:91], a[116:119], v[180:183], v[88:91]
    v_mfma_f32_16x16x32_bf16 v[92:95], a[140:143], v[180:183], v[92:95]
    v_mfma_f32_16x16x32_bf16 v[96:99], a[164:167], v[180:183], v[96:99]
    v_mfma_f32_16x16x32_bf16 v[100:103], a[188:191], v[180:183], v[100:103]
    v_mfma_f32_16x16x32_bf16 v[104:107], a[96:99], v[184:187], 0
    v_mfma_f32_16x16x32_bf16 v[108:111], a[120:123], v[184:187], 0
    v_mfma_f32_16x16x32_bf16 v[112:115], a[144:147], v[184:187], 0
    v_mfma_f32_16x16x32_bf16 v[116:119], a[168:171], v[184:187], 0
    s_add_u32 m0, s41, 8192
    s_nop 0
    buffer_load_dwordx4 v30, s[24:27], s58 offen offset:0 nt lds
    v_mfma_f32_16x16x32_bf16 v[104:107], a[100:103], v[188:191], v[104:107]
    v_mfma_f32_16x16x32_bf16 v[108:111], a[124:127], v[188:191], v[108:111]
    v_mfma_f32_16x16x32_bf16 v[112:115], a[148:151], v[188:191], v[112:115]
    v_mfma_f32_16x16x32_bf16 v[116:119], a[172:175], v[188:191], v[116:119]
    buffer_load_dwordx4 v31, s[24:27], s58 offen offset:1024 nt lds
    v_mfma_f32_16x16x32_bf16 v[104:107], a[104:107], v[192:195], v[104:107]
    v_mfma_f32_16x16x32_bf16 v[108:111], a[128:131], v[192:195], v[108:111]
    v_mfma_f32_16x16x32_bf16 v[112:115], a[152:155], v[192:195], v[112:115]
    v_mfma_f32_16x16x32_bf16 v[116:119], a[176:179], v[192:195], v[116:119]
    buffer_load_dwordx4 v32, s[24:27], s58 offen offset:2048 nt lds
    v_cvt_pk_bf16_f32 v144, v88, v89
    v_cvt_pk_bf16_f32 v145, v90, v91
    v_cvt_pk_bf16_f32 v146, v92, v93
    v_cvt_pk_bf16_f32 v147, v94, v95
    buffer_store_dwordx4 v[144:147], v65, s[32:35], s60 offen offset:0 sc1
    v_cvt_pk_bf16_f32 v148, v96, v97
    v_cvt_pk_bf16_f32 v149, v98, v99
    v_cvt_pk_bf16_f32 v150, v100, v101
    v_cvt_pk_bf16_f32 v151, v102, v103
    buffer_store_dwordx4 v[148:151], v65, s[32:35], s60 offen offset:1024 sc1
    s_add_u32 s60, s60, 6144
    v_mfma_f32_16x16x32_bf16 v[104:107], a[108:111], v[196:199], v[104:107]
    v_mfma_f32_16x16x32_bf16 v[108:111], a[132:135], v[196:199], v[108:111]
    v_mfma_f32_16x16x32_bf16 v[112:115], a[156:159], v[196:199], v[112:115]
    v_mfma_f32_16x16x32_bf16 v[116:119], a[180:183], v[196:199], v[116:119]
    buffer_load_dwordx4 v33, s[24:27], s58 offen offset:3072 nt lds
    v_mfma_f32_16x16x32_bf16 v[104:107], a[112:115], v[200:203], v[104:107]
    v_mfma_f32_16x16x32_bf16 v[108:111], a[136:139], v[200:203], v[108:111]
    v_mfma_f32_16x16x32_bf16 v[112:115], a[160:163], v[200:203], v[112:115]
    v_mfma_f32_16x16x32_bf16 v[116:119], a[184:187], v[200:203], v[116:119]
    s_add_u32 m0, s42, 0
    s_add_u32 s59, s37, 196608
    buffer_load_dwordx4 v22, s[24:27], s59 offen offset:0 nt lds
    v_mfma_f32_16x16x32_bf16 v[104:107], a[116:119], v[204:207], v[104:107]
    v_mfma_f32_16x16x32_bf16 v[108:111], a[140:143], v[204:207], v[108:111]
    v_mfma_f32_16x16x32_bf16 v[112:115], a[164:167], v[204:207], v[112:115]
    v_mfma_f32_16x16x32_bf16 v[116:119], a[188:191], v[204:207], v[116:119]
    v_mfma_f32_16x16x32_bf16 v[120:123], a[96:99], v[208:211], 0
    v_mfma_f32_16x16x32_bf16 v[124:127], a[120:123], v[208:211], 0
    v_mfma_f32_16x16x32_bf16 v[128:131], a[144:147], v[208:211], 0
    v_mfma_f32_16x16x32_bf16 v[132:135], a[168:171], v[208:211], 0
    buffer_load_dwordx4 v23, s[24:27], s59 offen offset:1024 nt lds
    v_mfma_f32_16x16x32_bf16 v[120:123], a[100:103], v[212:215], v[120:123]
    v_mfma_f32_16x16x32_bf16 v[124:127], a[124:127], v[212:215], v[124:127]
    v_mfma_f32_16x16x32_bf16 v[128:131], a[148:151], v[212:215], v[128:131]
    v_mfma_f32_16x16x32_bf16 v[132:135], a[172:175], v[212:215], v[132:135]
    buffer_load_dwordx4 v24, s[24:27], s59 offen offset:2048 nt lds
    v_mfma_f32_16x16x32_bf16 v[120:123], a[104:107], v[216:219], v[120:123]
    v_mfma_f32_16x16x32_bf16 v[124:127], a[128:131], v[216:219], v[124:127]
    v_mfma_f32_16x16x32_bf16 v[128:131], a[152:155], v[216:219], v[128:131]
    v_mfma_f32_16x16x32_bf16 v[132:135], a[176:179], v[216:219], v[132:135]
    buffer_load_dwordx4 v25, s[24:27], s59 offen offset:3072 nt lds
    v_cvt_pk_bf16_f32 v152, v104, v105
    v_cvt_pk_bf16_f32 v153, v106, v107
    v_cvt_pk_bf16_f32 v154, v108, v109
    v_cvt_pk_bf16_f32 v155, v110, v111
    buffer_store_dwordx4 v[152:155], v65, s[32:35], s60 offen offset:0 sc1
    v_cvt_pk_bf16_f32 v156, v112, v113
    v_cvt_pk_bf16_f32 v157, v114, v115
    v_cvt_pk_bf16_f32 v158, v116, v117
    v_cvt_pk_bf16_f32 v159, v118, v119
    buffer_store_dwordx4 v[156:159], v65, s[32:35], s60 offen offset:1024 sc1
    s_add_u32 s60, s60, 6144
    v_mfma_f32_16x16x32_bf16 v[120:123], a[108:111], v[220:223], v[120:123]
    v_mfma_f32_16x16x32_bf16 v[124:127], a[132:135], v[220:223], v[124:127]
    v_mfma_f32_16x16x32_bf16 v[128:131], a[156:159], v[220:223], v[128:131]
    v_mfma_f32_16x16x32_bf16 v[132:135], a[180:183], v[220:223], v[132:135]
    s_add_u32 m0, s42, 4096
    s_nop 0
    buffer_load_dwordx4 v26, s[24:27], s59 offen offset:0 nt lds
    v_mfma_f32_16x16x32_bf16 v[120:123], a[112:115], v[224:227], v[120:123]
    v_mfma_f32_16x16x32_bf16 v[124:127], a[136:139], v[224:227], v[124:127]
    v_mfma_f32_16x16x32_bf16 v[128:131], a[160:163], v[224:227], v[128:131]
    v_mfma_f32_16x16x32_bf16 v[132:135], a[184:187], v[224:227], v[132:135]
    buffer_load_dwordx4 v27, s[24:27], s59 offen offset:1024 nt lds
    v_mfma_f32_16x16x32_bf16 v[120:123], a[116:119], v[228:231], v[120:123]
    v_mfma_f32_16x16x32_bf16 v[124:127], a[140:143], v[228:231], v[124:127]
    v_mfma_f32_16x16x32_bf16 v[128:131], a[164:167], v[228:231], v[128:131]
    v_mfma_f32_16x16x32_bf16 v[132:135], a[188:191], v[228:231], v[132:135]
    s_nop 4
    v_cvt_pk_bf16_f32 v144, v120, v121
    v_cvt_pk_bf16_f32 v145, v122, v123
    v_cvt_pk_bf16_f32 v146, v124, v125
    v_cvt_pk_bf16_f32 v147, v126, v127
    buffer_store_dwordx4 v[144:147], v65, s[32:35], s60 offen offset:0 sc1
    v_cvt_pk_bf16_f32 v148, v128, v129
    v_cvt_pk_bf16_f32 v149, v130, v131
    v_cvt_pk_bf16_f32 v150, v132, v133
    v_cvt_pk_bf16_f32 v151, v134, v135
    buffer_store_dwordx4 v[148:151], v65, s[32:35], s60 offen offset:1024 sc1
    v_and_b32 v1, 15, v0
    v_lshrrev_b32 v6, 5, v0
    v_bfe_u32 v3, v0, 4, 1
    v_lshl_or_b32 v3, v3, 1, v6
    v_lshrrev_b32 v4, 2, v0
    v_bfe_u32 v5, v0, 1, 1
    v_lshrrev_b32 v6, 3, v1
    v_and_or_b32 v6, v1, 6, v6
    v_xor_b32 v6, v6, v3
    v_mul_u32_u24 v7, 384, v1
    v_lshl_add_u32 v6, v6, 4, v7
    v_add_u32 v34, s40, v6
    v_xor_b32 v35, 64, v34
    v_lshrrev_b32 v6, 3, v1
    v_and_b32 v7, 7, v1
    v_lshl_or_b32 v6, v7, 1, v6
    v_xor_b32 v6, v6, v3
    v_mul_u32_u24 v7, 768, v1
    v_lshl_add_u32 v6, v6, 4, v7
    v_add_u32 v40, s41, v6
    v_xor_b32 v41, 0x40, v40
    v_xor_b32 v42, 0x80, v40
    v_xor_b32 v43, 0xc0, v40
    v_and_b32 v2, 1, v0
    v_lshlrev_b32 v2, 3, v2
    s_mul_i32 s56, s3, 96
    v_lshrrev_b32 v6, 3, v4
    v_and_or_b32 v6, v4, 6, v6
    v_xor_b32 v6, v6, v5
    v_lshl_add_u32 v6, v6, 4, v2
    v_mul_u32_u24 v7, 384, v4
    s_add_u32 s57, s56, 0
    v_xad_u32 v36, v6, s57, v7
    s_add_u32 s57, s56, 32
    v_xad_u32 v37, v6, s57, v7
    s_add_u32 s57, s56, 64
    v_xad_u32 v38, v6, s57, v7
    v_lshrrev_b32 v6, 3, v4
    v_and_b32 v3, 7, v4
    v_lshl_or_b32 v6, v3, 1, v6
    v_xor_b32 v6, v6, v5
    v_lshl_add_u32 v6, v6, 4, v2
    v_lshlrev_b32 v7, 1, v7
    v_add_u32 v7, 24576, v7
    s_add_u32 s57, s56, 0
    v_xad_u32 v44, v6, s57, v7
    s_add_u32 s57, s56, 384
    v_xad_u32 v45, v6, s57, v7
    s_add_u32 s57, s56, 32
    v_xad_u32 v46, v6, s57, v7
    s_add_u32 s57, s56, 416
    v_xad_u32 v47, v6, s57, v7
    s_add_u32 s57, s56, 64
    v_xad_u32 v48, v6, s57, v7
    s_add_u32 s57, s56, 448
    v_xad_u32 v49, v6, s57, v7
    v_mov_b32 v52, 0x3f803f80
    v_mov_b32 v56, 0x3ebcbe62
    s_mov_b32 s44, 0x100001
    s_mov_b32 s45, 0x10000100
    v_mov_b32 v53, 0x3f803f80
    v_mov_b32 v57, 0x3ebcbe62
    s_mov_b32 s46, 0x200002
    s_mov_b32 s47, 0x20000200
    v_mov_b32 v54, 0x3f803f80
    v_mov_b32 v58, 0x3ebcbe62
    s_mov_b32 s48, 0x400004
    s_mov_b32 s49, 0x40000400
    v_mov_b32 v55, 0x3f803f80
    v_mov_b32 v59, 0x3ebcbe62
    s_mov_b32 s50, 0x800008
    s_mov_b32 s51, 0x80000800
    v_mov_b32 v60, 0x43400000
    v_lshrrev_b32 v1, 5, v0
    v_lshlrev_b32 v1, 8, v1
    v_and_b32 v2, 15, v0
    v_lshl_add_u32 v1, v2, 4, v1
    v_bfe_u32 v2, v0, 4, 1
    v_lshl_add_u32 v1, v2, 3, v1
    s_mul_i32 s56, s3, 1536
    s_add_u32 s56, s56, 147456
    v_add_u32 v236, s56, v1
    s_mul_i32 s56, s3, 3072
    s_add_u32 s56, s56, 24576
    v_add_u32 v237, s56, v65
    v_add_u32 v238, s41, v65
    s_lshl_b32 s56, s3, 10
    v_add_u32 v240, 159744, v65
    v_add_u32 v239, s56, v240
    v_add_u32 v241, 147456, v65
    v_bfe_u32 v1, v0, 2, 2
    v_lshrrev_b32 v2, 4, v0
    v_lshl_or_b32 v1, v1, 4, v2
    v_mul_u32_u24 v1, 32768, v1
    v_and_b32 v2, 3, v0
    v_lshl_or_b32 v242, v2, 4, v1
    v_xor_b32 v243, 0x70, v242
    s_mul_i32 s56, s3, 3
    v_min_u32 v1, 2, v0
    v_add_u32 v1, s56, v1
    v_lshlrev_b32 v245, 7, v1
    v_lshlrev_b32 v1, 3, v0
    v_add_u32 v254, 126976, v1
    s_lshl_b32 s56, s3, 9
    v_add_u32 v238, s56, v254
    v_add_u32 v253, 122880, v65
    s_lshl_b32 s56, s3, 10
    v_add_u32 v237, s56, v253
    s_mov_b32 s52, 0x41c00000
    buffer_load_dwordx4 v28, s[24:27], s59 offen offset:2048 nt lds
    buffer_load_dwordx4 v29, s[24:27], s59 offen offset:3072 nt lds
    s_add_u32 m0, s42, 8192
    s_nop 0
    buffer_load_dwordx4 v30, s[24:27], s59 offen offset:0 nt lds
    buffer_load_dwordx4 v31, s[24:27], s59 offen offset:1024 nt lds
    buffer_load_dwordx4 v32, s[24:27], s59 offen offset:2048 nt lds
    buffer_load_dwordx4 v33, s[24:27], s59 offen offset:3072 nt lds
    s_branch L_join
L_xt3:
    s_call_b64 s[54:55], L_xslow
    s_branch L_post3
L_xt24:
    s_call_b64 s[54:55], L_xslow
    s_branch L_post24
L_xt6:
    s_call_b64 s[54:55], L_xslow
    s_branch L_post6
L_xt27:
    s_call_b64 s[54:55], L_xslow
    s_branch L_post27
L_xt9:
    s_call_b64 s[54:55], L_xslow
    s_branch L_post9
L_xt11:
    s_call_b64 s[54:55], L_xalt
    ds_read_b128 a[192:195], v253 offset:12288
    ds_read_b128 a[196:199], v253 offset:13312
    ds_read_b128 a[200:203], v253 offset:14336
    ds_read_b128 a[204:207], v253 offset:15360
    s_waitcnt lgkmcnt(0)
    s_branch L_post11
L_xslow:
    s_waitcnt lgkmcnt(0)
    ds_write_b32 v239, v62
    s_waitcnt lgkmcnt(0)
    s_barrier
    ds_read_b32 v12, v240 offset:0
    ds_read_b32 v13, v240 offset:1024
    ds_read_b32 v14, v240 offset:2048
    ds_read_b32 v15, v240 offset:3072
    v_mov_b32 v9, 0
    ds_write_b32 v254, v9 offset:4096
    s_waitcnt lgkmcnt(0)
    v_min3_f32 v1, v12, v13, v14
    v_min_f32 v1, v1, v15
    v_sub_f32 v2, v1, v255
    v_sub_f32 v12, v1, v62
    v_exp_f32 v2, v2
    v_exp_f32 v12, v12
    v_mov_b32 v62, v1
    v_mov_b32 v255, v1
    v_mul_f32 v88, v88, v12
    v_mul_f32 v89, v89, v12
    v_mul_f32 v90, v90, v12
    v_mul_f32 v91, v91, v12
    v_mul_f32 v104, v104, v12
    v_mul_f32 v105, v105, v12
    v_mul_f32 v106, v106, v12
    v_mul_f32 v107, v107, v12
    v_mul_f32 v68, v68, v12
    v_mul_f32 v69, v69, v12
    v_mul_f32 v70, v70, v12
    v_mul_f32 v71, v71, v12
    v_mul_f32 v112, v112, v12
    v_mul_f32 v113, v113, v12
    v_mul_f32 v114, v114, v12
    v_mul_f32 v115, v115, v12
    v_mul_f32 v63, v63, v12
    v_mul_f32 v64, v64, v12
    v_accvgpr_read_b32 v1, a0
    v_mul_f32 v1, v1, v2
    v_accvgpr_write_b32 a0, v1
    v_accvgpr_read_b32 v1, a1
    v_mul_f32 v1, v1, v2
    v_accvgpr_write_b32 a1, v1
    v_accvgpr_read_b32 v1, a2
    v_mul_f32 v1, v1, v2
    v_accvgpr_write_b32 a2, v1
    v_accvgpr_read_b32 v1, a3
    v_mul_f32 v1, v1, v2
    v_accvgpr_write_b32 a3, v1
    v_accvgpr_read_b32 v1, a4
    v_mul_f32 v1, v1, v2
    v_accvgpr_write_b32 a4, v1
    v_accvgpr_read_b32 v1, a5
    v_mul_f32 v1, v1, v2
    v_accvgpr_write_b32 a5, v1
    v_accvgpr_read_b32 v1, a6
    v_mul_f32 v1, v1, v2
    v_accvgpr_write_b32 a6, v1
    v_accvgpr_read_b32 v1, a7
    v_mul_f32 v1, v1, v2
    v_accvgpr_write_b32 a7, v1
    v_accvgpr_read_b32 v1, a8
    v_mul_f32 v1, v1, v2
    v_accvgpr_write_b32 a8, v1
    v_accvgpr_read_b32 v1, a9
    v_mul_f32 v1, v1, v2
    v_accvgpr_write_b32 a9, v1
    v_accvgpr_read_b32 v1, a10
    v_mul_f32 v1, v1, v2
    v_accvgpr_write_b32 a10, v1
    v_accvgpr_read_b32 v1, a11
    v_mul_f32 v1, v1, v2
    v_accvgpr_write_b32 a11, v1
    v_cvt_pk_bf16_f32 v72, v88, v89
    v_cvt_pk_bf16_f32 v73, v90, v91
    v_cvt_pk_bf16_f32 v74, v104, v105
    v_cvt_pk_bf16_f32 v75, v106, v107
    ds_write_b128 v237, v[72:75] offset:0
    v_cvt_pk_bf16_f32 v66, v68, v69
    v_cvt_pk_bf16_f32 v67, v70, v71
    ds_write_b64 v238, v[66:67]
    s_waitcnt lgkmcnt(0)
    s_barrier
    s_setpc_b64 s[54:55]
L_xlast:
    s_waitcnt lgkmcnt(0)
    ds_write_b32 v239, v62
    s_waitcnt lgkmcnt(0)
    s_barrier
    ds_read_b32 v12, v240 offset:0
    ds_read_b32 v13, v240 offset:1024
    ds_read_b32 v14, v240 offset:2048
    ds_read_b32 v15, v240 offset:3072
    v_mov_b32 v9, 0
    ds_write_b32 v254, v9 offset:4096
    s_waitcnt lgkmcnt(0)
    v_min3_f32 v1, v12, v13, v14
    v_min_f32 v1, v1, v15
    v_sub_f32 v2, v1, v255
    v_sub_f32 v12, v1, v62
    v_exp_f32 v2, v2
    v_exp_f32 v12, v12
    v_mov_b32 v62, v1
    v_mov_b32 v255, v1
    v_mul_f32 v88, v88, v12
    v_mul_f32 v89, v89, v12
    v_mul_f32 v90, v90, v12
    v_mul_f32 v91, v91, v12
    v_mul_f32 v104, v104, v12
    v_mul_f32 v105, v105, v12
    v_mul_f32 v106, v106, v12
    v_mul_f32 v107, v107, v12
    v_mul_f32 v68, v68, v12
    v_mul_f32 v69, v69, v12
    v_mul_f32 v70, v70, v12
    v_mul_f32 v71, v71, v12
    v_mul_f32 v10, v10, v12
    v_mul_f32 v11, v11, v12
    v_mul_f32 v16, v16, v2
    v_mul_f32 v17, v17, v2
    v_mul_f32 v18, v18, v2
    v_mul_f32 v19, v19, v2
    v_mul_f32 v20, v20, v2
    v_mul_f32 v21, v21, v2
    v_mul_f32 v22, v22, v2
    v_mul_f32 v23, v23, v2
    v_mul_f32 v24, v24, v2
    v_mul_f32 v25, v25, v2
    v_mul_f32 v26, v26, v2
    v_mul_f32 v27, v27, v2
    v_cvt_pk_bf16_f32 v72, v88, v89
    v_cvt_pk_bf16_f32 v73, v90, v91
    v_cvt_pk_bf16_f32 v74, v104, v105
    v_cvt_pk_bf16_f32 v75, v106, v107
    ds_write_b128 v237, v[72:75] offset:0
    v_cvt_pk_bf16_f32 v66, v68, v69
    v_cvt_pk_bf16_f32 v67, v70, v71
    ds_write_b64 v238, v[66:67]
    ds_write_b64 v238, v[10:11] offset:2048
    s_waitcnt lgkmcnt(0)
    s_barrier
    s_branch L_postx
L_xalt:
    s_waitcnt lgkmcnt(0)
    ds_write_b32 v239, v62
    s_waitcnt lgkmcnt(0)
    s_barrier
    ds_read_b32 v12, v240 offset:0
    ds_read_b32 v13, v240 offset:1024
    ds_read_b32 v14, v240 offset:2048
    ds_read_b32 v15, v240 offset:3072
    v_mov_b32 v9, 0
    ds_write_b32 v254, v9 offset:4100
    s_waitcnt lgkmcnt(0)
    v_min3_f32 v1, v12, v13, v14
    v_min_f32 v1, v1, v15
    v_sub_f32 v2, v1, v255
    v_sub_f32 v12, v1, v62
    v_exp_f32 v2, v2
    v_exp_f32 v12, v12
    v_mov_b32 v62, v1
    v_mov_b32 v255, v1
    v_mul_f32 v88, v88, v12
    v_mul_f32 v89, v89, v12
    v_mul_f32 v90, v90, v12
    v_mul_f32 v91, v91, v12
    v_mul_f32 v104, v104, v12
    v_mul_f32 v105, v105, v12
    v_mul_f32 v106, v106, v12
    v_mul_f32 v107, v107, v12
    v_mul_f32 v68, v68, v12
    v_mul_f32 v69, v69, v12
    v_mul_f32 v70, v70, v12
    v_mul_f32 v71, v71, v12
    v_mul_f32 v112, v112, v12
    v_mul_f32 v113, v113, v12
    v_mul_f32 v114, v114, v12
    v_mul_f32 v115, v115, v12
    v_mul_f32 v63, v63, v12
    v_mul_f32 v64, v64, v12
    v_mul_f32 v16, v16, v2
    v_mul_f32 v17, v17, v2
    v_mul_f32 v18, v18, v2
    v_mul_f32 v19, v19, v2
    v_mul_f32 v20, v20, v2
    v_mul_f32 v21, v21, v2
    v_mul_f32 v22, v22, v2
    v_mul_f32 v23, v23, v2
    v_mul_f32 v24, v24, v2
    v_mul_f32 v25, v25, v2
    v_mul_f32 v26, v26, v2
    v_mul_f32 v27, v27, v2
    v_cvt_pk_bf16_f32 v72, v88, v89
    v_cvt_pk_bf16_f32 v73, v90, v91
    v_cvt_pk_bf16_f32 v74, v104, v105
    v_cvt_pk_bf16_f32 v75, v106, v107
    ds_write_b128 v237, v[72:75] offset:12288
    s_waitcnt lgkmcnt(0)
    s_barrier
    s_setpc_b64 s[54:55]
L_c_slow:
    s_cmp_eq_u32 s43, 0
    s_cbranch_scc1 L_c_out
    s_mov_b32 s43, 0
    buffer_load_dwordx4 v[76:79], v65, s[32:35], s30 offen offset:0 sc1
    buffer_load_dwordx4 v[80:83], v65, s[32:35], s30 offen offset:1024 sc1
    buffer_load_dwordx4 v[84:87], v65, s[32:35], s30 offen offset:2048 sc1
    buffer_load_dwordx4 v[108:111], v65, s[32:35], s30 offen offset:3072 sc1
    buffer_load_dwordx4 v[112:115], v65, s[32:35], s31 offen offset:0 sc1
    buffer_load_dwordx4 v[128:131], v65, s[32:35], s31 offen offset:1024 sc1
    buffer_load_dwordx4 v[132:135], v65, s[32:35], s31 offen offset:2048 sc1
    buffer_load_dwordx4 v[52:55], v65, s[32:35], s31 offen offset:3072 sc1
    s_waitcnt vmcnt(0)
    v_sub_u32 v49, v79, v247
    v_max_f32 v42, v42, v49
    v_sub_u32 v49, v83, v247
    v_max_f32 v42, v42, v49
    v_sub_u32 v49, v87, v247
    v_max_f32 v42, v42, v49
    v_sub_u32 v49, v111, v247
    v_max_f32 v42, v42, v49
    v_sub_u32 v49, v115, v247
    v_max_f32 v42, v42, v49
    v_sub_u32 v49, v131, v247
    v_max_f32 v42, v42, v49
    v_sub_u32 v49, v135, v247
    v_max_f32 v42, v42, v49
    v_sub_u32 v49, v55, v247
    v_max_f32 v42, v42, v49
    s_nop 1
    v_max_f32_dpp v42, v42, v42 row_ror:8 row_mask:0xf bank_mask:0xf
    v_mov_b32 v48, v42
    s_nop 1
    v_permlane32_swap_b32 v42, v48
    v_max_f32 v42, v42, v48
    v_mov_b32 v48, v42
    s_nop 1
    v_permlane16_swap_b32 v42, v48
    v_max_f32 v42, v42, v48
    s_lshl_b32 s56, s3, 2
    v_add_u32 v48, s56, v251
    ds_write_b32 v48, v42 offset:1024
    s_waitcnt lgkmcnt(0)
    s_barrier
    ds_read_b128 v[48:51], v251 offset:1024
    v_mov_b32 v16, 0
    v_mov_b32 v17, 0
    v_mov_b32 v18, 0
    v_mov_b32 v19, 0
    v_mov_b32 v20, 0
    v_mov_b32 v21, 0
    v_mov_b32 v22, 0
    s_waitcnt lgkmcnt(0)
    v_max3_f32 v42, v48, v49, v50
    v_max_f32 v42, v42, v51
    v_sub_u32 v49, v79, v247
    v_sub_f32 v49, v49, v42
    v_exp_f32 v49, v49
    s_nop 0
    v_cvt_pk_bf16_f32 v49, v49, 0
    v_lshlrev_b32 v50, 16, v49
    v_dot2_f32_bf16 v16, v76, v49, v16
    v_dot2_f32_bf16 v18, v77, v49, v18
    v_dot2_f32_bf16 v20, v78, v49, v20
    v_add_f32 v22, v22, v50
    v_dot2_f32_bf16 v17, v76, v50, v17
    v_dot2_f32_bf16 v19, v77, v50, v19
    v_dot2_f32_bf16 v21, v78, v50, v21
    v_sub_u32 v49, v83, v247
    v_sub_f32 v49, v49, v42
    v_exp_f32 v49, v49
    s_nop 0
    v_cvt_pk_bf16_f32 v49, v49, 0
    v_lshlrev_b32 v50, 16, v49
    v_dot2_f32_bf16 v16, v80, v49, v16
    v_dot2_f32_bf16 v18, v81, v49, v18
    v_dot2_f32_bf16 v20, v82, v49, v20
    v_add_f32 v22, v22, v50
    v_dot2_f32_bf16 v17, v80, v50, v17
    v_dot2_f32_bf16 v19, v81, v50, v19
    v_dot2_f32_bf16 v21, v82, v50, v21
    v_sub_u32 v49, v87, v247
    v_sub_f32 v49, v49, v42
    v_exp_f32 v49, v49
    s_nop 0
    v_cvt_pk_bf16_f32 v49, v49, 0
    v_lshlrev_b32 v50, 16, v49
    v_dot2_f32_bf16 v16, v84, v49, v16
    v_dot2_f32_bf16 v18, v85, v49, v18
    v_dot2_f32_bf16 v20, v86, v49, v20
    v_add_f32 v22, v22, v50
    v_dot2_f32_bf16 v17, v84, v50, v17
    v_dot2_f32_bf16 v19, v85, v50, v19
    v_dot2_f32_bf16 v21, v86, v50, v21
    v_sub_u32 v49, v111, v247
    v_sub_f32 v49, v49, v42
    v_exp_f32 v49, v49
    s_nop 0
    v_cvt_pk_bf16_f32 v49, v49, 0
    v_lshlrev_b32 v50, 16, v49
    v_dot2_f32_bf16 v16, v108, v49, v16
    v_dot2_f32_bf16 v18, v109, v49, v18
    v_dot2_f32_bf16 v20, v110, v49, v20
    v_add_f32 v22, v22, v50
    v_dot2_f32_bf16 v17, v108, v50, v17
    v_dot2_f32_bf16 v19, v109, v50, v19
    v_dot2_f32_bf16 v21, v110, v50, v21
    v_sub_u32 v49, v115, v247
    v_sub_f32 v49, v49, v42
    v_exp_f32 v49, v49
    s_nop 0
    v_cvt_pk_bf16_f32 v49, v49, 0
    v_lshlrev_b32 v50, 16, v49
    v_dot2_f32_bf16 v16, v112, v49, v16
    v_dot2_f32_bf16 v18, v113, v49, v18
    v_dot2_f32_bf16 v20, v114, v49, v20
    v_add_f32 v22, v22, v50
    v_dot2_f32_bf16 v17, v112, v50, v17
    v_dot2_f32_bf16 v19, v113, v50, v19
    v_dot2_f32_bf16 v21, v114, v50, v21
    v_sub_u32 v49, v131, v247
    v_sub_f32 v49, v49, v42
    v_exp_f32 v49, v49
    s_nop 0
    v_cvt_pk_bf16_f32 v49, v49, 0
    v_lshlrev_b32 v50, 16, v49
    v_dot2_f32_bf16 v16, v128, v49, v16
    v_dot2_f32_bf16 v18, v129, v49, v18
    v_dot2_f32_bf16 v20, v130, v49, v20
    v_add_f32 v22, v22, v50
    v_dot2_f32_bf16 v17, v128, v50, v17
    v_dot2_f32_bf16 v19, v129, v50, v19
    v_dot2_f32_bf16 v21, v130, v50, v21
    v_sub_u32 v49, v135, v247
    v_sub_f32 v49, v49, v42
    v_exp_f32 v49, v49
    s_nop 0
    v_cvt_pk_bf16_f32 v49, v49, 0
    v_lshlrev_b32 v50, 16, v49
    v_dot2_f32_bf16 v16, v132, v49, v16
    v_dot2_f32_bf16 v18, v133, v49, v18
    v_dot2_f32_bf16 v20, v134, v49, v20
    v_add_f32 v22, v22, v50
    v_dot2_f32_bf16 v17, v132, v50, v17
    v_dot2_f32_bf16 v19, v133, v50, v19
    v_dot2_f32_bf16 v21, v134, v50, v21
    v_sub_u32 v49, v55, v247
    v_sub_f32 v49, v49, v42
    v_exp_f32 v49, v49
    s_nop 0
    v_cvt_pk_bf16_f32 v49, v49, 0
    v_lshlrev_b32 v50, 16, v49
    v_dot2_f32_bf16 v16, v52, v49, v16
    v_dot2_f32_bf16 v18, v53, v49, v18
    v_dot2_f32_bf16 v20, v54, v49, v20
    v_add_f32 v22, v22, v50
    v_dot2_f32_bf16 v17, v52, v50, v17
    v_dot2_f32_bf16 v19, v53, v50, v19
    v_dot2_f32_bf16 v21, v54, v50, v21
    s_nop 2
    s_branch L_c_red
L_qk_retry:
    s_mov_b32 s53, 0
L_qk_again:
    s_mul_i32 s56, s3, 3072
    s_add_u32 s56, s56, 16384
    buffer_load_dwordx4 v[136:139], v65, s[32:35], s56 offen offset:0 sc1
    buffer_load_dwordx4 v[140:143], v65, s[32:35], s56 offen offset:1024 sc1
    buffer_load_dwordx4 v[144:147], v65, s[32:35], s56 offen offset:2048 sc1
    s_add_u32 s53, s53, 1
    s_waitcnt vmcnt(0)
    v_xor_b32 v1, s39, v138
    v_xor_b32 v2, s39, v142
    v_xor_b32 v3, s39, v146
    v_or3_b32 v1, v1, v2, v3
    v_cmp_ne_u32 vcc, 0, v1
    s_cbranch_vccz L_qk_ok
    s_cmp_lt_u32 s53, 65536
    s_cbranch_scc1 L_qk_again
    s_branch L_qk_ok
L_fl_retry:
    s_mov_b32 s53, 0
L_fl_again:
    buffer_load_dword v244, v245, s[32:35], 0 offen offset:128 sc1
    s_add_u32 s53, s53, 1
    s_waitcnt vmcnt(0)
    v_cmp_ne_u32 vcc, s39, v244
    s_cbranch_vccz L_fl_ok
    s_cmp_lt_u32 s53, 65536
    s_cbranch_scc1 L_fl_again
    s_branch L_fl_ok
L_site0:
    s_call_b64 s[54:55], L_rare2
    s_branch L_back0
L_site1:
    s_call_b64 s[54:55], L_rare3
    s_branch L_back1
L_site2:
    s_call_b64 s[54:55], L_rare2
    s_branch L_back2
L_site3:
    s_call_b64 s[54:55], L_rare3
    s_branch L_back3
L_site4:
    s_call_b64 s[54:55], L_rare2
    s_branch L_back4
L_site5:
    s_call_b64 s[54:55], L_rare3
    s_branch L_back5
L_site6:
    s_call_b64 s[54:55], L_rare2
    s_branch L_back6
L_site7:
    s_call_b64 s[54:55], L_rare3
    s_branch L_back7
L_site8:
    s_call_b64 s[54:55], L_rare2
    s_branch L_back8
L_site9:
    s_call_b64 s[54:55], L_rare3
    s_branch L_back9
L_site10:
    s_call_b64 s[54:55], L_rare6
    s_branch L_back10
L_site11:
    s_call_b64 s[54:55], L_rare7
    s_branch L_back11
L_site12:
    s_call_b64 s[54:55], L_rare2
    s_branch L_back12
L_site13:
    s_call_b64 s[54:55], L_rare5
    s_branch L_back13
L_rare2:
    s_nop 7
    s_nop 7
    v_mov_b32 v2, v1
    s_nop 1
    v_permlane32_swap_b32 v1, v2
    v_max_f32 v1, v1, v2
    v_mov_b32 v2, v1
    s_nop 1
    v_permlane16_swap_b32 v1, v2
    v_max_f32 v1, v1, v2
    v_max_f32 v1, 0, v1
    v_sub_f32 v62, v62, v1
    v_sub_f32 v88, v88, v1
    v_sub_f32 v89, v89, v1
    v_sub_f32 v90, v90, v1
    v_sub_f32 v91, v91, v1
    v_sub_f32 v1, 0, v1
    v_exp_f32 v1, v1
    s_nop 0
    v_mul_f32 v63, v63, v1
    v_mul_f32 v64, v64, v1
    v_mul_f32 v68, v68, v1
    v_mul_f32 v69, v69, v1
    v_mul_f32 v70, v70, v1
    v_mul_f32 v71, v71, v1
    v_mov_b32 v2, 1
    ds_write_b32 v254, v2 offset:4096
    s_waitcnt lgkmcnt(0)
    s_nop 3
    s_setpc_b64 s[54:55]
L_rare3:
    s_nop 7
    s_nop 7
    v_mov_b32 v2, v1
    s_nop 1
    v_permlane32_swap_b32 v1, v2
    v_max_f32 v1, v1, v2
    v_mov_b32 v2, v1
    s_nop 1
    v_permlane16_swap_b32 v1, v2
    v_max_f32 v1, v1, v2
    v_max_f32 v1, 0, v1
    v_sub_f32 v62, v62, v1
    v_sub_f32 v104, v104, v1
    v_sub_f32 v105, v105, v1
    v_sub_f32 v106, v106, v1
    v_sub_f32 v107, v107, v1
    v_sub_f32 v1, 0, v1
    v_exp_f32 v1, v1
    s_nop 0
    v_mul_f32 v63, v63, v1
    v_mul_f32 v64, v64, v1
    v_mul_f32 v68, v68, v1
    v_mul_f32 v69, v69, v1
    v_mul_f32 v70, v70, v1
    v_mul_f32 v71, v71, v1
    v_mul_f32 v88, v88, v1
    v_mul_f32 v89, v89, v1
    v_mul_f32 v90, v90, v1
    v_mul_f32 v91, v91, v1
    v_mov_b32 v2, 1
    ds_write_b32 v254, v2 offset:4096
    s_waitcnt lgkmcnt(0)
    s_nop 3
    s_setpc_b64 s[54:55]
L_rare5:
    s_nop 7
    s_nop 7
    v_mov_b32 v2, v1
    s_nop 1
    v_permlane32_swap_b32 v1, v2
    v_max_f32 v1, v1, v2
    v_mov_b32 v2, v1
    s_nop 1
    v_permlane16_swap_b32 v1, v2
    v_max_f32 v1, v1, v2
    v_max_f32 v1, 0, v1
    v_sub_f32 v62, v62, v1
    v_sub_f32 v104, v104, v1
    v_sub_f32 v105, v105, v1
    v_sub_f32 v106, v106, v1
    v_sub_f32 v107, v107, v1
    v_sub_f32 v1, 0, v1
    v_exp_f32 v1, v1
    s_nop 0
    v_mul_f32 v63, v63, v1
    v_mul_f32 v64, v64, v1
    v_mul_f32 v68, v68, v1
    v_mul_f32 v69, v69, v1
    v_mul_f32 v70, v70, v1
    v_mul_f32 v71, v71, v1
    v_mul_f32 v88, v88, v1
    v_mul_f32 v89, v89, v1
    v_mul_f32 v90, v90, v1
    v_mul_f32 v91, v91, v1
    v_cvt_pk_bf16_f32 v72, v88, v89
    v_cvt_pk_bf16_f32 v73, v90, v91
    v_mov_b32 v2, 1
    ds_write_b32 v254, v2 offset:4096
    s_waitcnt lgkmcnt(0)
    s_nop 3
    s_setpc_b64 s[54:55]
L_rare6:
    s_nop 7
    s_nop 7
    v_mov_b32 v2, v1
    s_nop 1
    v_permlane32_swap_b32 v1, v2
    v_max_f32 v1, v1, v2
    v_mov_b32 v2, v1
    s_nop 1
    v_permlane16_swap_b32 v1, v2
    v_max_f32 v1, v1, v2
    v_max_f32 v1, 0, v1
    v_sub_f32 v62, v62, v1
    v_sub_f32 v88, v88, v1
    v_sub_f32 v89, v89, v1
    v_sub_f32 v90, v90, v1
    v_sub_f32 v91, v91, v1
    v_sub_f32 v1, 0, v1
    v_exp_f32 v1, v1
    s_nop 0
    v_mul_f32 v63, v63, v1
    v_mul_f32 v64, v64, v1
    v_mul_f32 v68, v68, v1
    v_mul_f32 v69, v69, v1
    v_mul_f32 v70, v70, v1
    v_mul_f32 v71, v71, v1
    v_mov_b32 v2, 1
    ds_write_b32 v254, v2 offset:4100
    s_waitcnt lgkmcnt(0)
    s_nop 3
    s_setpc_b64 s[54:55]
L_rare7:
    s_nop 7
    s_nop 7
    v_mov_b32 v2, v1
    s_nop 1
    v_permlane32_swap_b32 v1, v2
    v_max_f32 v1, v1, v2
    v_mov_b32 v2, v1
    s_nop 1
    v_permlane16_swap_b32 v1, v2
    v_max_f32 v1, v1, v2
    v_max_f32 v1, 0, v1
    v_sub_f32 v62, v62, v1
    v_sub_f32 v104, v104, v1
    v_sub_f32 v105, v105, v1
    v_sub_f32 v106, v106, v1
    v_sub_f32 v107, v107, v1
    v_sub_f32 v1, 0, v1
    v_exp_f32 v1, v1
    s_nop 0
    v_mul_f32 v63, v63, v1
    v_mul_f32 v64, v64, v1
    v_mul_f32 v68, v68, v1
    v_mul_f32 v69, v69, v1
    v_mul_f32 v70, v70, v1
    v_mul_f32 v71, v71, v1
    v_mul_f32 v88, v88, v1
    v_mul_f32 v89, v89, v1
    v_mul_f32 v90, v90, v1
    v_mul_f32 v91, v91, v1
    v_mov_b32 v2, 1
    ds_write_b32 v254, v2 offset:4100
    s_waitcnt lgkmcnt(0)
    s_nop 3
    s_setpc_b64 s[54:55]
L_codeend:
.section .rodata,"a"
.p2align 6
.amdhsa_kernel standalone__detection_seg_dino__vision_kernel
  .amdhsa_next_free_vgpr 464
  .amdhsa_next_free_sgpr 102
  .amdhsa_accum_offset 256
  .amdhsa_group_segment_fixed_size 0
  .amdhsa_kernarg_size 80
  .amdhsa_user_sgpr_count 2
  .amdhsa_user_sgpr_kernarg_segment_ptr 1
  .amdhsa_system_sgpr_workgroup_id_x 1
  .amdhsa_float_denorm_mode_32 3
.end_amdhsa_kernel
```

```asm
; @launch grid=(256,1,1) block=(256,1,1) lds=163840
.amdgcn_target "amdgcn-amd-amdhsa--gfx950"
.text
.globl standalone__detection_seg_dino__vision_kernel
.p2align 8
.type standalone__detection_seg_dino__vision_kernel,@function
standalone__detection_seg_dino__vision_kernel:
    s_cmp_ge_u32 s2, 256
    s_cbranch_scc1 L_end
    s_load_dwordx16 s[4:19], s[0:1], 0
    s_load_dwordx4 s[20:23], s[0:1], 64
    s_getpc_b64 s[54:55]
L_pc_main:
    v_lshlrev_b32 v233, 7, v0
    v_min_u32 v233, L_codeend - L_pc_main - 4, v233
    global_load_dword v232, v233, s[54:55]
    s_mov_b64 s[100:101], s[54:55]
    v_lshrrev_b32 v1, 6, v0
    v_and_b32 v0, 63, v0
    v_readfirstlane_b32 s3, v1
    v_lshlrev_b32 v65, 4, v0
    v_lshrrev_b32 v1, 2, v0
    v_and_b32 v1, 14, v1
    s_mov_b32 s56, 0x5000
    v_bfe_u32 v2, s56, v1, 2
    v_lshlrev_b32 v2, 5, v2
    v_xor_b32 v16, v65, v2
    s_mov_b32 s56, 0xaa55
    v_bfe_u32 v2, s56, v1, 2
    v_lshlrev_b32 v2, 5, v2
    v_xor_b32 v17, v65, v2
    s_mov_b32 s56, 0xfffa
    v_bfe_u32 v2, s56, v1, 2
    v_lshlrev_b32 v2, 5, v2
    v_xor_b32 v18, v65, v2
    v_xor_b32 v19, 16, v16
    v_xor_b32 v20, 0x1010, v17
    v_xor_b32 v21, 0x1010, v18
    v_lshrrev_b32 v1, 3, v0
    v_and_b32 v1, 6, v1
    s_mov_b32 s56, 0x40
    v_bfe_u32 v2, s56, v1, 2
    v_lshlrev_b32 v2, 5, v2
    v_xor_b32 v22, v65, v2
    s_mov_b32 s56, 0xa5
    v_bfe_u32 v2, s56, v1, 2
    v_lshlrev_b32 v2, 5, v2
    v_xor_b32 v23, v65, v2
    s_mov_b32 s56, 0xfe
    v_bfe_u32 v2, s56, v1, 2
    v_lshlrev_b32 v2, 5, v2
    v_xor_b32 v24, v65, v2
    v_xor_b32 v25, 0x80, v22
    v_xor_b32 v26, 0x1080, v23
    v_xor_b32 v27, 0x1080, v24
    v_xor_b32 v28, 0x1010, v22
    v_xor_b32 v29, 0x1010, v23
    v_xor_b32 v30, 0x2010, v24
    v_xor_b32 v31, 0x2090, v22
    v_xor_b32 v32, 0x2090, v23
    v_xor_b32 v33, 0x2090, v24
    v_mov_b32 v248, 0x10000
    s_mul_i32 s36, s3, 6144
    s_mul_i32 s37, s3, 12288
    s_add_u32 s40, s36, 0
    s_add_u32 s41, s37, 24576
    s_add_u32 s42, s37, 73728
    s_and_b32 s58, s2, 7
    s_lshr_b32 s57, s2, 3
    s_lshl_b32 s58, s58, 5
    s_add_u32 s58, s58, s57
    s_lshr_b32 s56, s58, 2
    s_mul_i32 s56, s56, 196608
    s_mul_i32 s57, s58, 24576
    s_lshl1_add_u32 s56, s57, s56
    s_mov_b64 s[60:61], s[56:57]
    s_mov_b32 s30, 18898944
    s_mov_b32 s31, 0x20000
    s_mov_b32 s26, 75743232
    s_mov_b32 s27, 0x20000
    s_mov_b32 s34, 8388608
    s_mov_b32 s35, 0x20000
    s_mov_b32 m0, s40
    s_and_b32 s56, s2, 7
    s_cmp_eq_u32 s56, 2
    s_cbranch_scc1 L_spec
    s_and_b32 s56, s2, 7
    s_cbranch_scc1 L_plain
L_spec:
    s_waitcnt lgkmcnt(0)
    s_add_u32 s28, s8, s61
    s_addc_u32 s29, s9, 0
    s_add_u32 s24, s6, s60
    s_addc_u32 s25, s7, 0
    s_mov_b64 s[32:33], s[22:23]
    s_lshr_b32 s43, s2, 3
    s_mul_i32 s57, s43, 2304
    v_min_u32 v1, 17, v0
    v_lshlrev_b32 v1, 7, v1
    s_mov_b32 s66, 73728
    s_mov_b32 s67, 0x20000
    s_mov_b32 s70, 73728
    s_mov_b32 s71, 0x20000
    s_mov_b32 s72, s4
    s_mov_b32 s73, s5
    s_mov_b32 s74, 6144
    s_mov_b32 s75, 0x20000
    s_bitcmp1_b32 s2, 1
    s_cselect_b64 s[64:65], s[16:17], s[10:11]
    s_cselect_b64 s[68:69], s[14:15], s[12:13]
    s_cmp_eq_u32 s3, 0
    s_cbranch_scc1 L_pf0
    s_cmp_eq_u32 s3, 1
    s_cbranch_scc0 L_pfdone
    s_lshl_b32 s58, s43, 8
    buffer_load_dword v234, v1, s[68:71], s57 offen
    v_min_u32 v2, 128, v1
    buffer_load_dword v235, v2, s[72:75], s58 offen
    s_branch L_pfdone
L_pf0:
    buffer_load_dword v234, v1, s[64:67], s57 offen
L_pfdone:
    s_cmp_ge_u32 s43, 3
    s_cbranch_scc1 L_nopf
    s_mov_b32 s0, 1
    s_bitcmp1_b32 s2, 1
    s_cbranch_scc0 L_prod
    s_branch L_vprod
L_plain:
    s_waitcnt lgkmcnt(0)
L_nopf:
    s_add_u32 s28, s8, s61
    s_addc_u32 s29, s9, 0
    buffer_load_dwordx4 v16, s[28:31], s36 offen offset:0 nt lds
    s_add_u32 s24, s6, s60
    s_addc_u32 s25, s7, 0
    s_mov_b64 s[32:33], s[22:23]
    s_mov_b32 s0, 0
    buffer_load_dwordx4 v17, s[28:31], s36 offen offset:1024 nt lds
    buffer_load_dwordx4 v18, s[28:31], s36 offen offset:2048 nt lds
    buffer_load_dwordx4 v19, s[28:31], s36 offen offset:3072 nt lds
    s_add_u32 m0, s40, 4096
    s_load_dword s38, s[22:23], 0
    buffer_load_dwordx4 v20, s[28:31], s36 offen offset:0 nt lds
    buffer_load_dwordx4 v21, s[28:31], s36 offen offset:1024 nt lds
    s_mov_b32 s43, -1
    s_sub_u32 s59, s2, 64
    s_cmp_ge_u32 s59, 64
    s_cbranch_scc1 L_nocs
    s_mov_b32 s64, s4
    s_mov_b32 s65, s5
    s_mov_b32 s66, 6144
    s_mov_b32 s67, 0x20000
    s_mov_b32 s68, s18
    s_mov_b32 s69, s19
    s_mov_b32 s70, 6144
    s_mov_b32 s71, 0x20000
    v_bfe_u32 v1, v0, 2, 1
    v_mul_u32_u24 v2, 7, v1
    v_xor_b32 v2, v0, v2
    v_and_b32 v2, 3, v2
    s_lshr_b32 s56, s59, 4
    s_lshl_b32 s56, s56, 2
    v_add_u32 v2, s56, v2
    v_lshlrev_b32 v252, 2, v2
    v_lshrrev_b32 v3, 4, v0
    v_mad_u32_u24 v3, v1, 3, v3
    v_lshrrev_b32 v4, 1, v3
    v_and_b32 v3, 1, v3
    v_lshlrev_b32 v3, 2, v3
    v_lshl_add_u32 v3, v4, 5, v3
    v_bfe_u32 v4, v0, 3, 1
    v_lshl_add_u32 v3, v4, 1, v3
    v_mul_u32_u24 v2, 384, v2
    s_bfe_u32 s56, s59, 0x20002
    s_mul_i32 s56, s56, 96
    s_and_b32 s57, s59, 3
    s_lshl_b32 s57, s57, 3
    s_add_u32 s56, s56, s57
    v_add3_u32 v248, s56, v2, v3
    v_cmp_gt_u32 vcc, 48, v0
    v_mov_b32 v4, 0x10000
    s_lshl_b32 s56, s3, 2
    v_cndmask_b32 v248, v4, v248, vcc
    buffer_load_ushort v249, v248, s[64:67], 0 offen
    s_or_b32 s57, s59, s3
    s_cselect_b32 s70, 0, 6144
    v_lshlrev_b32 v4, 7, v0
    buffer_load_ushort v246, v4, s[68:71], 0 offen
    v_add_u32 v250, s56, v65
    v_and_b32 v251, 0x70, v65
L_nocs:
    s_add_u32 m0, s41, 0
    s_add_u32 s58, s37, 0
    buffer_load_dwordx4 v22, s[24:27], s58 offen offset:0 nt lds
    buffer_load_dwordx4 v23, s[24:27], s58 offen offset:1024 nt lds
    buffer_load_dwordx4 v24, s[24:27], s58 offen offset:2048 nt lds
    buffer_load_dwordx4 v25, s[24:27], s58 offen offset:3072 nt lds
    s_add_u32 m0, s41, 4096
    s_nop 0
    buffer_load_dwordx4 v26, s[24:27], s58 offen offset:0 nt lds
    buffer_load_dwordx4 v27, s[24:27], s58 offen offset:1024 nt lds
    buffer_load_dwordx4 v28, s[24:27], s58 offen offset:2048 nt lds
    buffer_load_dwordx4 v29, s[24:27], s58 offen offset:3072 nt lds
    s_add_u32 m0, s41, 8192
    s_nop 0
    buffer_load_dwordx4 v30, s[24:27], s58 offen offset:0 nt lds
    buffer_load_dwordx4 v31, s[24:27], s58 offen offset:1024 nt lds
    buffer_load_dwordx4 v32, s[24:27], s58 offen offset:2048 nt lds
    buffer_load_dwordx4 v33, s[24:27], s58 offen offset:3072 nt lds
    s_add_u32 m0, s42, 0
    s_add_u32 s59, s37, 196608
    buffer_load_dwordx4 v22, s[24:27], s59 offen offset:0 nt lds
    buffer_load_dwordx4 v23, s[24:27], s59 offen offset:1024 nt lds
    buffer_load_dwordx4 v24, s[24:27], s59 offen offset:2048 nt lds
    buffer_load_dwordx4 v25, s[24:27], s59 offen offset:3072 nt lds
    s_add_u32 m0, s42, 4096
    s_nop 0
    buffer_load_dwordx4 v26, s[24:27], s59 offen offset:0 nt lds
    buffer_load_dwordx4 v27, s[24:27], s59 offen offset:1024 nt lds
    buffer_load_dwordx4 v28, s[24:27], s59 offen offset:2048 nt lds
    buffer_load_dwordx4 v29, s[24:27], s59 offen offset:3072 nt lds
    s_add_u32 m0, s42, 8192
    s_nop 0
    buffer_load_dwordx4 v30, s[24:27], s59 offen offset:0 nt lds
    buffer_load_dwordx4 v31, s[24:27], s59 offen offset:1024 nt lds
    buffer_load_dwordx4 v32, s[24:27], s59 offen offset:2048 nt lds
    buffer_load_dwordx4 v33, s[24:27], s59 offen offset:3072 nt lds
    v_and_b32 v1, 15, v0
    v_lshrrev_b32 v6, 5, v0
    v_bfe_u32 v3, v0, 4, 1
    v_lshl_or_b32 v3, v3, 1, v6
    v_lshrrev_b32 v4, 2, v0
    v_bfe_u32 v5, v0, 1, 1
    v_lshrrev_b32 v6, 3, v1
    v_and_or_b32 v6, v1, 6, v6
    v_xor_b32 v6, v6, v3
    v_mul_u32_u24 v7, 384, v1
    v_lshl_add_u32 v6, v6, 4, v7
    v_add_u32 v34, s40, v6
    v_xor_b32 v35, 64, v34
    v_lshrrev_b32 v6, 3, v1
    v_and_b32 v7, 7, v1
    v_lshl_or_b32 v6, v7, 1, v6
    v_xor_b32 v6, v6, v3
    v_mul_u32_u24 v7, 768, v1
    v_lshl_add_u32 v6, v6, 4, v7
    v_add_u32 v40, s41, v6
    v_xor_b32 v41, 0x40, v40
    v_xor_b32 v42, 0x80, v40
    v_xor_b32 v43, 0xc0, v40
    v_and_b32 v2, 1, v0
    v_lshlrev_b32 v2, 3, v2
    s_mul_i32 s56, s3, 96
    v_lshrrev_b32 v6, 3, v4
    v_and_or_b32 v6, v4, 6, v6
    v_xor_b32 v6, v6, v5
    v_lshl_add_u32 v6, v6, 4, v2
    v_mul_u32_u24 v7, 384, v4
    s_add_u32 s57, s56, 0
    v_xad_u32 v36, v6, s57, v7
    s_add_u32 s57, s56, 32
    v_xad_u32 v37, v6, s57, v7
    s_add_u32 s57, s56, 64
    v_xad_u32 v38, v6, s57, v7
    v_lshrrev_b32 v6, 3, v4
    v_and_b32 v3, 7, v4
    v_lshl_or_b32 v6, v3, 1, v6
    v_xor_b32 v6, v6, v5
    v_lshl_add_u32 v6, v6, 4, v2
    v_lshlrev_b32 v7, 1, v7
    v_add_u32 v7, 24576, v7
    s_add_u32 s57, s56, 0
    v_xad_u32 v44, v6, s57, v7
    s_add_u32 s57, s56, 384
    v_xad_u32 v45, v6, s57, v7
    s_add_u32 s57, s56, 32
    v_xad_u32 v46, v6, s57, v7
    s_add_u32 s57, s56, 416
    v_xad_u32 v47, v6, s57, v7
    s_add_u32 s57, s56, 64
    v_xad_u32 v48, v6, s57, v7
    s_add_u32 s57, s56, 448
    v_xad_u32 v49, v6, s57, v7
    v_mov_b32 v52, 0x3f803f80
    v_mov_b32 v56, 0x3ebcbe62
    s_mov_b32 s44, 0x100001
    s_mov_b32 s45, 0x10000100
    v_mov_b32 v53, 0x3f803f80
    v_mov_b32 v57, 0x3ebcbe62
    s_mov_b32 s46, 0x200002
    s_mov_b32 s47, 0x20000200
    v_mov_b32 v54, 0x3f803f80
    v_mov_b32 v58, 0x3ebcbe62
    s_mov_b32 s48, 0x400004
    s_mov_b32 s49, 0x40000400
    v_mov_b32 v55, 0x3f803f80
    v_mov_b32 v59, 0x3ebcbe62
    s_mov_b32 s50, 0x800008
    s_mov_b32 s51, 0x80000800
    v_mov_b32 v60, 0x43400000
    v_lshrrev_b32 v1, 5, v0
    v_lshlrev_b32 v1, 8, v1
    v_and_b32 v2, 15, v0
    v_lshl_add_u32 v1, v2, 4, v1
    v_bfe_u32 v2, v0, 4, 1
    v_lshl_add_u32 v1, v2, 3, v1
    s_mul_i32 s56, s3, 1536
    s_add_u32 s56, s56, 147456
    v_add_u32 v236, s56, v1
    s_mul_i32 s56, s3, 3072
    s_add_u32 s56, s56, 24576
    v_add_u32 v237, s56, v65
    v_add_u32 v238, s41, v65
    s_lshl_b32 s56, s3, 10
    v_add_u32 v240, 159744, v65
    v_add_u32 v239, s56, v240
    v_add_u32 v241, 147456, v65
    v_bfe_u32 v1, v0, 2, 2
    v_lshrrev_b32 v2, 4, v0
    v_lshl_or_b32 v1, v1, 4, v2
    v_mul_u32_u24 v1, 32768, v1
    v_and_b32 v2, 3, v0
    v_lshl_or_b32 v242, v2, 4, v1
    v_xor_b32 v243, 0x70, v242
    s_mul_i32 s56, s3, 3
    v_min_u32 v1, 2, v0
    v_add_u32 v1, s56, v1
    v_lshlrev_b32 v245, 7, v1
    v_lshlrev_b32 v1, 3, v0
    v_add_u32 v254, 126976, v1
    s_lshl_b32 s56, s3, 9
    v_add_u32 v238, s56, v254
    v_add_u32 v253, 122880, v65
    s_lshl_b32 s56, s3, 10
    v_add_u32 v237, s56, v253
    s_mov_b32 s52, 0x41c00000
L_join:
    s_mul_i32 s60, s3, 18432
    s_mov_b32 s72, s22
    s_mov_b32 s73, s23
    s_mov_b32 s74, 8388608
    s_mov_b32 s75, 0x20000
    s_cmp_eq_u32 s0, 1
    s_cselect_b32 s74, 0, s74
    s_waitcnt vmcnt(24)
    s_waitcnt lgkmcnt(0)
    s_barrier
    ds_read_b128 a[48:51], v34 offset:0
    ds_read_b128 a[52:55], v35 offset:0
    ds_read_b128 a[56:59], v34 offset:128
    ds_read_b128 a[60:63], v35 offset:128
    ds_read_b128 a[64:67], v34 offset:256
    ds_read_b128 a[68:71], v35 offset:256
    s_waitcnt lgkmcnt(5)
    v_mfma_f32_16x16x32_bf16 v[84:87], a[48:51], a[48:51], 0
    ds_read_b64_tr_b16 a[72:73], v36 offset:0
    ds_read_b64_tr_b16 a[74:75], v36 offset:6144
    v_mfma_f32_16x16x32_bf16 v[80:83], a[48:51], v[52:55], 0
    ds_read_b64_tr_b16 a[76:77], v36 offset:12288
    ds_read_b64_tr_b16 a[78:79], v36 offset:18432
    s_waitcnt lgkmcnt(8)
    v_mfma_f32_16x16x32_bf16 v[84:87], a[52:55], a[52:55], v[84:87]
    ds_read_b64_tr_b16 a[80:81], v37 offset:0
    ds_read_b64_tr_b16 a[82:83], v37 offset:6144
    v_mfma_f32_16x16x32_bf16 v[80:83], a[52:55], v[52:55], v[80:83]
    ds_read_b64_tr_b16 a[84:85], v37 offset:12288
    ds_read_b64_tr_b16 a[86:87], v37 offset:18432
    s_waitcnt lgkmcnt(11)
    v_mfma_f32_16x16x32_bf16 v[84:87], a[56:59], a[56:59], v[84:87]
    ds_read_b64_tr_b16 a[88:89], v38 offset:0
    ds_read_b64_tr_b16 a[90:91], v38 offset:6144
    v_mfma_f32_16x16x32_bf16 v[80:83], a[56:59], v[52:55], v[80:83]
    ds_read_b64_tr_b16 a[92:93], v38 offset:12288
    ds_read_b64_tr_b16 a[94:95], v38 offset:18432
    s_waitcnt lgkmcnt(14)
    v_mfma_f32_16x16x32_bf16 v[84:87], a[60:63], a[60:63], v[84:87]
    v_mfma_f32_16x16x32_bf16 v[80:83], a[60:63], v[52:55], v[80:83]
    s_waitcnt lgkmcnt(13)
    v_mfma_f32_16x16x32_bf16 v[84:87], a[64:67], a[64:67], v[84:87]
    v_mfma_f32_16x16x32_bf16 v[80:83], a[64:67], v[52:55], v[80:83]
    s_waitcnt lgkmcnt(12)
    v_mfma_f32_16x16x32_bf16 v[84:87], a[68:71], a[68:71], v[84:87]
    v_mfma_f32_16x16x32_bf16 v[80:83], a[68:71], v[52:55], v[80:83]
    s_waitcnt lgkmcnt(0)
    s_mul_i32 s39, s38, 0x9e3779b1
    s_add_u32 s39, s39, 0x7f4a7c16
    s_or_b32 s39, s39, 1
    s_mul_i32 s56, s3, 3072
    s_add_u32 s56, s56, 16384
    buffer_load_dwordx4 v[136:139], v65, s[32:35], s56 offen offset:0 sc1
    buffer_load_dwordx4 v[140:143], v65, s[32:35], s56 offen offset:1024 sc1
    buffer_load_dwordx4 v[144:147], v65, s[32:35], s56 offen offset:2048 sc1
    s_waitcnt vmcnt(15)
    s_barrier
    ds_read_b128 a[96:99], v40 offset:0
    ds_read_b128 a[100:103], v41 offset:0
    ds_read_b128 a[104:107], v42 offset:0
    ds_read_b128 a[108:111], v43 offset:0
    ds_read_b128 a[112:115], v40 offset:256
    ds_read_b128 a[116:119], v41 offset:256
    ds_read_b128 a[120:123], v42 offset:256
    ds_read_b128 a[124:127], v43 offset:256
    ds_read_b128 a[128:131], v40 offset:512
    ds_read_b128 a[132:135], v41 offset:512
    ds_read_b128 a[136:139], v42 offset:512
    ds_read_b128 a[140:143], v43 offset:512
    ds_read_b64_tr_b16 a[144:145], v44 offset:0
    ds_read_b64_tr_b16 a[146:147], v45 offset:0
    ds_read_b64_tr_b16 a[148:149], v44 offset:12288
    ds_read_b64_tr_b16 a[150:151], v45 offset:12288
    ds_read_b64_tr_b16 a[152:153], v44 offset:24576
    ds_read_b64_tr_b16 a[154:155], v45 offset:24576
    ds_read_b64_tr_b16 a[156:157], v44 offset:36864
    ds_read_b64_tr_b16 a[158:159], v45 offset:36864
    ds_read_b64_tr_b16 a[160:161], v46 offset:0
    ds_read_b64_tr_b16 a[162:163], v47 offset:0
    ds_read_b64_tr_b16 a[164:165], v46 offset:12288
    ds_read_b64_tr_b16 a[166:167], v47 offset:12288
    ds_read_b64_tr_b16 a[168:169], v46 offset:24576
    ds_read_b64_tr_b16 a[170:171], v47 offset:24576
    ds_read_b64_tr_b16 a[172:173], v46 offset:36864
    ds_read_b64_tr_b16 a[174:175], v47 offset:36864
    ds_read_b64_tr_b16 a[176:177], v48 offset:0
    ds_read_b64_tr_b16 a[178:179], v49 offset:0
    ds_read_b64_tr_b16 a[180:181], v48 offset:12288
    ds_read_b64_tr_b16 a[182:183], v49 offset:12288
    ds_read_b64_tr_b16 a[184:185], v48 offset:24576
    ds_read_b64_tr_b16 a[186:187], v49 offset:24576
    ds_read_b64_tr_b16 a[188:189], v48 offset:36864
    ds_read_b64_tr_b16 a[190:191], v49 offset:36864
    s_waitcnt lgkmcnt(0)
    s_barrier
    s_cmp_ge_u32 s43, 3
    s_cbranch_scc1 L_v_nofl
    s_mul_i32 s56, s3, 3
    s_add_u32 s56, s56, s43
    s_lshl_b32 s56, s56, 7
    v_mov_b32 v1, s39
    v_mov_b32 v2, 0
    s_mov_b64 exec, 1
    s_waitcnt vmcnt(9)
    buffer_store_dword v1, v2, s[32:35], s56 offen offset:128 sc1
    s_mov_b64 exec, -1
L_v_nofl:
    v_mfma_f32_16x16x32_bf16 v[96:99], a[96:99], a[96:99], v[84:87]
    s_cmp_eq_u32 s0, 0
    s_cbranch_scc0 L_g1
    s_waitcnt vmcnt(10)
L_g1:
    s_add_u32 m0, s40, 0
    s_add_u32 s57, s36, 6291456
    buffer_load_dwordx4 v16, s[28:31], s57 offen offset:0 nt lds
    v_add_u32 v44, 49152, v44
    v_add_u32 v45, 49152, v45
    v_mfma_f32_16x16x32_bf16 v[100:103], a[96:99], a[48:51], 0
    s_cmp_eq_u32 s0, 0
    s_cbranch_scc0 L_g2
    s_waitcnt vmcnt(10)
L_g2:
    buffer_load_dwordx4 v17, s[28:31], s57 offen offset:1024 nt lds
    v_add_u32 v46, 49152, v46
    v_add_u32 v47, 49152, v47
    v_mfma_f32_16x16x32_bf16 v[96:99], a[100:103], a[100:103], v[96:99]
    v_add_u32 v48, 49152, v48
    v_add_u32 v49, 49152, v49
    v_mfma_f32_16x16x32_bf16 v[100:103], a[100:103], a[52:55], v[100:103]
    s_cmp_eq_u32 s0, 0
    s_cbranch_scc0 L_g3
    s_waitcnt vmcnt(10)
L_g3:
    buffer_load_dwordx4 v18, s[28:31], s57 offen offset:2048 nt lds
    v_mfma_f32_16x16x32_bf16 v[96:99], a[104:107], a[104:107], v[96:99]
    v_mfma_f32_16x16x32_bf16 v[100:103], a[104:107], a[56:59], v[100:103]
    v_mfma_f32_16x16x32_bf16 v[96:99], a[108:111], a[108:111], v[96:99]
    v_mfma_f32_16x16x32_bf16 v[100:103], a[108:111], a[60:63], v[100:103]
    v_mfma_f32_16x16x32_bf16 v[96:99], a[112:115], a[112:115], v[96:99]
    v_mfma_f32_16x16x32_bf16 v[100:103], a[112:115], a[64:67], v[100:103]
    v_mfma_f32_16x16x32_bf16 v[96:99], a[116:119], a[116:119], v[96:99]
    v_mfma_f32_16x16x32_bf16 v[100:103], a[116:119], a[68:71], v[100:103]
    v_mfma_f32_16x16x32_bf16 v[92:95], a[96:99], v[52:55], v[80:83]
    v_mfma_f32_16x16x32_bf16 v[92:95], a[100:103], v[52:55], v[92:95]
    v_mfma_f32_16x16x32_bf16 v[92:95], a[104:107], v[52:55], v[92:95]
    v_mfma_f32_16x16x32_bf16 v[92:95], a[108:111], v[52:55], v[92:95]
    s_nop 3
    v_fma_f32 v96, v100, 2.0, v96
    v_fma_f32 v97, v101, 2.0, v97
    v_mfma_f32_16x16x32_bf16 v[92:95], a[112:115], v[52:55], v[92:95]
    v_fma_f32 v98, v102, 2.0, v98
    v_fma_f32 v99, v103, 2.0, v99
    v_mfma_f32_16x16x32_bf16 v[92:95], a[116:119], v[52:55], v[92:95]
    s_cmp_eq_u32 s0, 0
    s_cbranch_scc0 L_g4
    s_waitcnt vmcnt(10)
L_g4:
    buffer_load_dwordx4 v19, s[28:31], s57 offen offset:3072 nt lds
    v_cndmask_b32 v3, 0, v96, s[44:45]
    v_cndmask_b32 v3, v3, v97, s[46:47]
    v_mfma_f32_16x16x32_bf16 v[112:115], a[120:123], a[120:123], v[84:87]
    v_cndmask_b32 v3, v3, v98, s[48:49]
    v_cndmask_b32 v3, v3, v99, s[50:51]
    v_mfma_f32_16x16x32_bf16 v[116:119], a[120:123], a[48:51], 0
    s_nop 0
    s_nop 0
    v_mfma_f32_16x16x32_bf16 v[112:115], a[124:127], a[124:127], v[112:115]
    v_mfma_f32_16x16x4_f32 v[120:123], v3, v60, v[56:59]
    v_mfma_f32_16x16x32_bf16 v[116:119], a[124:127], a[52:55], v[116:119]
    v_mfma_f32_16x16x32_bf16 v[112:115], a[128:131], a[128:131], v[112:115]
    v_mfma_f32_16x16x32_bf16 v[116:119], a[128:131], a[56:59], v[116:119]
    v_mfma_f32_16x16x32_bf16 v[112:115], a[132:135], a[132:135], v[112:115]
    s_nop 5
    v_fma_f32 v128, -v92, v92, v120
    v_fma_f32 v129, -v93, v93, v121
    v_mfma_f32_16x16x32_bf16 v[116:119], a[132:135], a[60:63], v[116:119]
    v_fma_f32 v130, -v94, v94, v122
    v_fma_f32 v131, -v95, v95, v123
    v_mfma_f32_16x16x32_bf16 v[112:115], a[136:139], a[136:139], v[112:115]
    v_max_f32 v128, v128, v56
    v_max_f32 v129, v129, v56
    v_mfma_f32_16x16x32_bf16 v[116:119], a[136:139], a[64:67], v[116:119]
    v_max_f32 v130, v130, v56
    v_max_f32 v131, v131, v56
    v_mfma_f32_16x16x32_bf16 v[112:115], a[140:143], a[140:143], v[112:115]
    s_cmp_eq_u32 s0, 0
    s_cbranch_scc0 L_g5
    s_waitcnt vmcnt(10)
L_g5:
    s_add_u32 m0, s40, 4096
    s_nop 0
    buffer_load_dwordx4 v20, s[28:31], s57 offen offset:0 nt lds
    v_rsq_f32 v128, v128
    v_mfma_f32_16x16x32_bf16 v[116:119], a[140:143], a[68:71], v[116:119]
    v_rsq_f32 v129, v129
    v_mfma_f32_16x16x32_bf16 v[108:111], a[120:123], v[52:55], v[80:83]
    v_rsq_f32 v130, v130
    v_mfma_f32_16x16x32_bf16 v[108:111], a[124:127], v[52:55], v[108:111]
    v_rsq_f32 v131, v131
    v_mfma_f32_16x16x32_bf16 v[108:111], a[128:131], v[52:55], v[108:111]
    v_mfma_f32_16x16x32_bf16 v[108:111], a[132:135], v[52:55], v[108:111]
    v_mfma_f32_16x16x32_bf16 v[108:111], a[136:139], v[52:55], v[108:111]
    v_fma_f32 v112, v116, 2.0, v112
    v_fma_f32 v113, v117, 2.0, v113
    v_mfma_f32_16x16x32_bf16 v[108:111], a[140:143], v[52:55], v[108:111]
    v_fma_f32 v114, v118, 2.0, v114
    v_fma_f32 v115, v119, 2.0, v115
    v_cndmask_b32 v4, 0, v112, s[44:45]
    v_cndmask_b32 v4, v4, v113, s[46:47]
    v_cndmask_b32 v4, v4, v114, s[48:49]
    v_cndmask_b32 v4, v4, v115, s[50:51]
    s_nop 0
    s_nop 0
    v_mfma_f32_16x16x4_f32 v[124:127], v4, v60, v[56:59]
    s_nop 9
    v_fma_f32 v132, -v108, v108, v124
    v_fma_f32 v133, -v109, v109, v125
    v_fma_f32 v134, -v110, v110, v126
    v_fma_f32 v135, -v111, v111, v127
    v_max_f32 v132, v132, v56
    v_max_f32 v133, v133, v56
    v_max_f32 v134, v134, v56
    v_max_f32 v135, v135, v56
    v_rsq_f32 v132, v132
    v_rsq_f32 v133, v133
    v_rsq_f32 v134, v134
    v_rsq_f32 v135, v135
    s_mul_i32 s56, s3, 1536
    v_lshlrev_b32 v5, 3, v0
    v_add_u32 v5, 153600, v5
    v_add_u32 v4, s56, v5
    s_cmp_eq_u32 s0, 0
    s_cbranch_scc0 L_g6
    s_waitcnt vmcnt(10)
L_g6:
    buffer_load_dwordx4 v21, s[28:31], s57 offen offset:1024 nt lds
    s_cmp_eq_u32 s0, 0
    s_cbranch_scc0 L_g7
    s_waitcnt vmcnt(10)
L_g7:
    s_add_u32 m0, s41, 0
    s_add_u32 s58, s37, 25165824
    buffer_load_dwordx4 v22, s[24:27], s58 offen offset:0 nt lds
    s_cmp_eq_u32 s0, 0
    s_cbranch_scc0 L_g8
    s_waitcnt vmcnt(6)
L_g8:
    buffer_load_dwordx4 v23, s[24:27], s58 offen offset:1024 nt lds
    s_cmp_eq_u32 s0, 0
    s_cbranch_scc0 L_g9
    s_waitcnt vmcnt(6)
L_g9:
    buffer_load_dwordx4 v24, s[24:27], s58 offen offset:2048 nt lds
    s_cmp_eq_u32 s0, 0
    s_cbranch_scc0 L_g10
    s_waitcnt vmcnt(6)
L_g10:
    buffer_load_dwordx4 v25, s[24:27], s58 offen offset:3072 nt lds
    s_cmp_eq_u32 s0, 0
    s_cbranch_scc0 L_g11
    s_waitcnt vmcnt(6)
L_g11:
    s_add_u32 m0, s41, 4096
    s_nop 0
    buffer_load_dwordx4 v26, s[24:27], s58 offen offset:0 nt lds
    s_waitcnt vmcnt(11)
    v_xor_b32 v1, s39, v138
    v_xor_b32 v2, s39, v142
    v_xor_b32 v3, s39, v146
    v_or3_b32 v1, v1, v2, v3
    v_cmp_ne_u32 vcc, 0, v1
    s_cbranch_vccnz L_qk_retry
L_qk_ok:
    ds_write_b64 v4, v[136:137] offset:0
    ds_write_b64 v4, v[140:141] offset:512
    ds_write_b64 v4, v[144:145] offset:1024
    s_waitcnt lgkmcnt(0)
    s_barrier
    ds_read2st64_b64 v[136:139], v5 offset0:0 offset1:1
    ds_read2st64_b64 v[140:143], v5 offset0:2 offset1:3
    ds_read2st64_b64 v[144:147], v5 offset0:4 offset1:5
    ds_read2st64_b64 v[148:151], v5 offset0:6 offset1:7
    ds_read2st64_b64 v[152:155], v5 offset0:8 offset1:9
    ds_read2st64_b64 v[156:159], v5 offset0:10 offset1:11
    s_waitcnt lgkmcnt(5)
    v_mfma_f32_16x16x32_bf16 v[120:123], v[52:55], v[136:139], 0
    v_mfma_f32_16x16x32_bf16 v[76:79], a[48:51], v[136:139], 0
    s_waitcnt lgkmcnt(4)
    v_mfma_f32_16x16x32_bf16 v[120:123], v[52:55], v[140:143], v[120:123]
    v_mfma_f32_16x16x32_bf16 v[76:79], a[52:55], v[140:143], v[76:79]
    s_waitcnt lgkmcnt(3)
    v_mfma_f32_16x16x32_bf16 v[120:123], v[52:55], v[144:147], v[120:123]
    v_mfma_f32_16x16x32_bf16 v[76:79], a[56:59], v[144:147], v[76:79]
    s_cmp_eq_u32 s0, 0
    s_cbranch_scc0 L_g12
    s_waitcnt vmcnt(6)
L_g12:
    buffer_load_dwordx4 v27, s[24:27], s58 offen offset:1024 nt lds
    s_waitcnt lgkmcnt(2)
    v_mfma_f32_16x16x32_bf16 v[120:123], v[52:55], v[148:151], v[120:123]
    v_mfma_f32_16x16x32_bf16 v[76:79], a[60:63], v[148:151], v[76:79]
    s_waitcnt lgkmcnt(1)
    v_mfma_f32_16x16x32_bf16 v[120:123], v[52:55], v[152:155], v[120:123]
    v_mfma_f32_16x16x32_bf16 v[76:79], a[64:67], v[152:155], v[76:79]
    s_waitcnt lgkmcnt(0)
    v_mfma_f32_16x16x32_bf16 v[120:123], v[52:55], v[156:159], v[120:123]
    v_mfma_f32_16x16x32_bf16 v[76:79], a[68:71], v[156:159], v[76:79]
    s_nop 6
    v_mul_f32 v61, 0x3baaaaab, v120
    v_mfma_f32_16x16x32_bf16 v[88:91], a[96:99], v[136:139], v[76:79]
    v_mov_b32 v9, 0
    v_mfma_f32_16x16x32_bf16 v[88:91], a[100:103], v[140:143], v[88:91]
    v_mfma_f32_16x16x32_bf16 v[88:91], a[104:107], v[144:147], v[88:91]
    v_mfma_f32_16x16x32_bf16 v[88:91], a[108:111], v[148:151], v[88:91]
    v_mfma_f32_16x16x32_bf16 v[88:91], a[112:115], v[152:155], v[88:91]
    v_mfma_f32_16x16x32_bf16 v[88:91], a[116:119], v[156:159], v[88:91]
    ds_write_b32 v254, v9 offset:4096
    ds_write_b32 v254, v9 offset:4100
    v_mfma_f32_16x16x32_bf16 v[104:107], a[120:123], v[136:139], v[76:79]
    s_cmp_eq_u32 s0, 0
    s_cbranch_scc0 L_g13
    s_waitcnt vmcnt(6)
L_g13:
    buffer_load_dwordx4 v28, s[24:27], s58 offen offset:2048 nt lds
    v_mfma_f32_16x16x32_bf16 v[104:107], a[124:127], v[140:143], v[104:107]
    v_mfma_f32_16x16x32_bf16 v[104:107], a[128:131], v[144:147], v[104:107]
    v_mfma_f32_16x16x32_bf16 v[104:107], a[132:135], v[148:151], v[104:107]
    v_fma_f32 v88, -v92, v61, v88
    v_fma_f32 v89, -v93, v61, v89
    v_mfma_f32_16x16x32_bf16 v[104:107], a[136:139], v[152:155], v[104:107]
    v_fma_f32 v90, -v94, v61, v90
    v_fma_f32 v91, -v95, v61, v91
    v_mfma_f32_16x16x32_bf16 v[104:107], a[140:143], v[156:159], v[104:107]
    v_mul_f32 v88, v88, v128
    v_mul_f32 v89, v89, v129
    v_mul_f32 v90, v90, v130
    v_mul_f32 v91, v91, v131
    v_max3_f32 v1, v88, v89, v90
    v_max_f32 v1, v1, v91
    s_nop 1
    v_fma_f32 v104, -v108, v61, v104
    v_fma_f32 v105, -v109, v61, v105
    v_fma_f32 v106, -v110, v61, v106
    v_fma_f32 v107, -v111, v61, v107
    v_mul_f32 v104, v104, v132
    v_mul_f32 v105, v105, v133
    v_mul_f32 v106, v106, v134
    v_mul_f32 v107, v107, v135
    v_max3_f32 v1, v1, v104, v105
    v_max3_f32 v1, v1, v106, v107
    v_mov_b32 v2, v1
    s_nop 1
    v_permlane32_swap_b32 v1, v2
    v_max_f32 v1, v1, v2
    v_mov_b32 v2, v1
    s_nop 1
    v_permlane16_swap_b32 v1, v2
    v_max_f32 v1, v1, v2
    ds_write_b32 v239, v1
    s_waitcnt lgkmcnt(0)
    s_barrier
    ds_read_b32 v12, v240 offset:0
    ds_read_b32 v13, v240 offset:1024
    ds_read_b32 v14, v240 offset:2048
    ds_read_b32 v15, v240 offset:3072
    s_cmp_eq_u32 s0, 0
    s_cbranch_scc0 L_g14
    s_waitcnt vmcnt(6)
L_g14:
    buffer_load_dwordx4 v29, s[24:27], s58 offen offset:3072 nt lds
    s_waitcnt lgkmcnt(0)
    v_max3_f32 v1, v12, v13, v14
    v_max_f32 v1, v1, v15
    v_sub_f32 v88, v88, v1
    v_sub_f32 v89, v89, v1
    v_sub_f32 v90, v90, v1
    v_sub_f32 v91, v91, v1
    v_sub_f32 v104, v104, v1
    v_sub_f32 v105, v105, v1
    v_sub_f32 v106, v106, v1
    v_sub_f32 v107, v107, v1
    v_sub_f32 v62, 0, v1
    v_sub_f32 v255, 0, v1
    v_exp_f32 v96, v88
    v_exp_f32 v97, v89
    v_exp_f32 v98, v90
    v_exp_f32 v99, v91
    v_mul_f32 v88, v96, v128
    v_mul_f32 v89, v97, v129
    v_mul_f32 v90, v98, v130
    v_mul_f32 v91, v99, v131
    s_cmp_eq_u32 s0, 0
    s_cbranch_scc0 L_g15
    s_waitcnt vmcnt(6)
L_g15:
    s_add_u32 m0, s41, 8192
    s_nop 0
    buffer_load_dwordx4 v30, s[24:27], s58 offen offset:0 nt lds
    v_exp_f32 v112, v104
    v_exp_f32 v113, v105
    v_exp_f32 v114, v106
    v_exp_f32 v115, v107
    v_cvt_pk_bf16_f32 v72, v88, v89
    v_cvt_pk_bf16_f32 v73, v90, v91
    v_mul_f32 v104, v112, v132
    v_mul_f32 v105, v113, v133
    v_mul_f32 v106, v114, v134
    v_mul_f32 v107, v115, v135
    v_cvt_pk_bf16_f32 v74, v104, v105
    v_cvt_pk_bf16_f32 v75, v106, v107
    ds_write_b128 v237, v[72:75] offset:0
    v_mov_b32 v63, v96
    v_mul_f32 v64, v88, v92
    v_add_f32 v63, v63, v97
    v_fmac_f32 v64, v89, v93
    v_add_f32 v63, v63, v98
    v_fmac_f32 v64, v90, v94
    v_add_f32 v63, v63, v99
    v_fmac_f32 v64, v91, v95
    v_mov_b32 v68, v88
    v_mov_b32 v69, v89
    v_mov_b32 v70, v90
    v_mov_b32 v71, v91
    s_waitcnt lgkmcnt(0)
    s_barrier
    ds_read_b128 v[92:95], v253 offset:0
    ds_read_b128 v[96:99], v253 offset:1024
    ds_read_b128 v[100:103], v253 offset:2048
    ds_read_b128 v[116:119], v253 offset:3072
    s_waitcnt lgkmcnt(3)
    v_mfma_f32_16x16x32_bf16 a[0:3], a[144:147], v[92:95], 0
    s_cmp_eq_u32 s0, 0
    s_cbranch_scc0 L_g16
    s_waitcnt vmcnt(6)
L_g16:
    buffer_load_dwordx4 v31, s[24:27], s58 offen offset:1024 nt lds
    v_add_f32 v68, v68, v104
    v_add_f32 v69, v69, v105
    v_mfma_f32_16x16x32_bf16 a[4:7], a[160:163], v[92:95], 0
    v_add_f32 v70, v70, v106
    v_add_f32 v71, v71, v107
    v_mfma_f32_16x16x32_bf16 a[8:11], a[176:179], v[92:95], 0
    v_add_f32 v63, v63, v112
    v_fma_f32 v64, v104, v108, v64
    s_waitcnt lgkmcnt(2)
    v_mfma_f32_16x16x32_bf16 a[0:3], a[148:151], v[96:99], a[0:3]
    s_cmp_eq_u32 s0, 0
    s_cbranch_scc0 L_g17
    s_waitcnt vmcnt(6)
L_g17:
    buffer_load_dwordx4 v32, s[24:27], s58 offen offset:2048 nt lds
    v_add_f32 v63, v63, v113
    v_fma_f32 v64, v105, v109, v64
    v_mfma_f32_16x16x32_bf16 a[4:7], a[164:167], v[96:99], a[4:7]
    v_add_f32 v63, v63, v114
    v_fma_f32 v64, v106, v110, v64
    v_mfma_f32_16x16x32_bf16 a[8:11], a[180:183], v[96:99], a[8:11]
    v_add_f32 v63, v63, v115
    v_fma_f32 v64, v107, v111, v64
    s_waitcnt lgkmcnt(1)
    v_mfma_f32_16x16x32_bf16 a[0:3], a[152:155], v[100:103], a[0:3]
    v_mfma_f32_16x16x32_bf16 a[4:7], a[168:171], v[100:103], a[4:7]
    v_mfma_f32_16x16x32_bf16 a[8:11], a[184:187], v[100:103], a[8:11]
    s_waitcnt lgkmcnt(0)
    v_mfma_f32_16x16x32_bf16 a[0:3], a[156:159], v[116:119], a[0:3]
    v_mfma_f32_16x16x32_bf16 a[4:7], a[172:175], v[116:119], a[4:7]
    v_mfma_f32_16x16x32_bf16 a[8:11], a[188:191], v[116:119], a[8:11]
    s_barrier
    ds_read_b128 a[96:99], v40 offset:49152
    ds_read_b128 a[100:103], v41 offset:49152
    ds_read_b128 a[104:107], v42 offset:49152
    ds_read_b128 a[108:111], v43 offset:49152
    ds_read_b128 a[112:115], v40 offset:49408
    ds_read_b128 a[116:119], v41 offset:49408
    ds_read_b128 a[120:123], v42 offset:49408
    ds_read_b128 a[124:127], v43 offset:49408
    ds_read_b128 a[128:131], v40 offset:49664
    ds_read_b128 a[132:135], v41 offset:49664
    ds_read_b128 a[136:139], v42 offset:49664
    ds_read_b128 a[140:143], v43 offset:49664
    s_waitcnt lgkmcnt(11)
    v_mfma_f32_16x16x32_bf16 v[96:99], a[96:99], a[96:99], v[84:87]
    s_cmp_eq_u32 s0, 0
    s_cbranch_scc0 L_g18
    s_waitcnt vmcnt(6)
L_g18:
    buffer_load_dwordx4 v33, s[24:27], s58 offen offset:3072 nt lds
    ds_read_b64_tr_b16 a[144:145], v44 offset:0
    ds_read_b64_tr_b16 a[146:147], v45 offset:0
    v_mfma_f32_16x16x32_bf16 v[100:103], a[96:99], a[48:51], 0
    ds_read_b64_tr_b16 a[148:149], v44 offset:12288
    ds_read_b64_tr_b16 a[150:151], v45 offset:12288
    s_waitcnt lgkmcnt(14)
    v_mfma_f32_16x16x32_bf16 v[96:99], a[100:103], a[100:103], v[96:99]
    ds_read_b64_tr_b16 a[152:153], v44 offset:24576
    ds_read_b64_tr_b16 a[154:155], v45 offset:24576
    v_mfma_f32_16x16x32_bf16 v[100:103], a[100:103], a[52:55], v[100:103]
    ds_read_b64_tr_b16 a[156:157], v44 offset:36864
    ds_read_b64_tr_b16 a[158:159], v45 offset:36864
    s_waitcnt lgkmcnt(15)
    v_mfma_f32_16x16x32_bf16 v[96:99], a[104:107], a[104:107], v[96:99]
    ds_read_b64_tr_b16 a[160:161], v46 offset:0
    ds_read_b64_tr_b16 a[162:163], v47 offset:0
    v_mfma_f32_16x16x32_bf16 v[100:103], a[104:107], a[56:59], v[100:103]
    ds_read_b64_tr_b16 a[164:165], v46 offset:12288
    ds_read_b64_tr_b16 a[166:167], v47 offset:12288
    v_mfma_f32_16x16x32_bf16 v[96:99], a[108:111], a[108:111], v[96:99]
    ds_read_b64_tr_b16 a[168:169], v46 offset:24576
    ds_read_b64_tr_b16 a[170:171], v47 offset:24576
    v_mfma_f32_16x16x32_bf16 v[100:103], a[108:111], a[60:63], v[100:103]
    ds_read_b64_tr_b16 a[172:173], v46 offset:36864
    ds_read_b64_tr_b16 a[174:175], v47 offset:36864
    v_mfma_f32_16x16x32_bf16 v[96:99], a[112:115], a[112:115], v[96:99]
    ds_read_b64_tr_b16 a[176:177], v48 offset:0
    ds_read_b64_tr_b16 a[178:179], v49 offset:0
    v_mfma_f32_16x16x32_bf16 v[100:103], a[112:115], a[64:67], v[100:103]
    ds_read_b64_tr_b16 a[180:181], v48 offset:12288
    ds_read_b64_tr_b16 a[182:183], v49 offset:12288
    s_waitcnt lgkmcnt(15)
    v_mfma_f32_16x16x32_bf16 v[96:99], a[116:119], a[116:119], v[96:99]
    ds_read_b64_tr_b16 a[184:185], v48 offset:24576
    ds_read_b64_tr_b16 a[186:187], v49 offset:24576
    v_mfma_f32_16x16x32_bf16 v[100:103], a[116:119], a[68:71], v[100:103]
    ds_read_b64_tr_b16 a[188:189], v48 offset:36864
    ds_read_b64_tr_b16 a[190:191], v49 offset:36864
    v_mfma_f32_16x16x32_bf16 v[92:95], a[96:99], v[52:55], v[80:83]
    v_mfma_f32_16x16x32_bf16 v[92:95], a[100:103], v[52:55], v[92:95]
    v_mfma_f32_16x16x32_bf16 v[92:95], a[104:107], v[52:55], v[92:95]
    v_mfma_f32_16x16x32_bf16 v[92:95], a[108:111], v[52:55], v[92:95]
    s_nop 1
    v_fma_f32 v96, v100, 2.0, v96
    v_fma_f32 v97, v101, 2.0, v97
    v_mfma_f32_16x16x32_bf16 v[92:95], a[112:115], v[52:55], v[92:95]
    v_fma_f32 v98, v102, 2.0, v98
    v_fma_f32 v99, v103, 2.0, v99
    v_mfma_f32_16x16x32_bf16 v[92:95], a[116:119], v[52:55], v[92:95]
    v_cndmask_b32 v3, 0, v96, s[44:45]
    v_cndmask_b32 v3, v3, v97, s[46:47]
    v_mfma_f32_16x16x32_bf16 v[88:91], a[96:99], v[136:139], v[76:79]
    v_cndmask_b32 v3, v3, v98, s[48:49]
    v_cndmask_b32 v3, v3, v99, s[50:51]
    v_mfma_f32_16x16x32_bf16 v[88:91], a[100:103], v[140:143], v[88:91]
    s_nop 0
    s_nop 0
    v_mfma_f32_16x16x32_bf16 v[88:91], a[104:107], v[144:147], v[88:91]
    v_mfma_f32_16x16x4_f32 v[120:123], v3, v60, v[56:59]
    v_mfma_f32_16x16x32_bf16 v[88:91], a[108:111], v[148:151], v[88:91]
    v_mfma_f32_16x16x32_bf16 v[88:91], a[112:115], v[152:155], v[88:91]
    v_mfma_f32_16x16x32_bf16 v[88:91], a[116:119], v[156:159], v[88:91]
    s_waitcnt lgkmcnt(0)
    s_barrier
    v_mfma_f32_16x16x32_bf16 v[112:115], a[120:123], a[120:123], v[84:87]
    s_cmp_eq_u32 s0, 0
    s_cbranch_scc0 L_g19
    s_waitcnt vmcnt(6)
L_g19:
    s_add_u32 m0, s42, 0
    s_add_u32 s59, s37, 25362432
    buffer_load_dwordx4 v22, s[24:27], s59 offen offset:0 nt lds
    v_mfma_f32_16x16x32_bf16 v[116:119], a[120:123], a[48:51], 0
    s_cmp_eq_u32 s0, 0
    s_cbranch_scc0 L_g20
    s_waitcnt vmcnt(6)
L_g20:
    buffer_load_dwordx4 v23, s[24:27], s59 offen offset:1024 nt lds
    v_mfma_f32_16x16x32_bf16 v[112:115], a[124:127], a[124:127], v[112:115]
    v_mfma_f32_16x16x32_bf16 v[116:119], a[124:127], a[52:55], v[116:119]
    v_fma_f32 v128, -v92, v92, v120
    v_fma_f32 v129, -v93, v93, v121
    v_mfma_f32_16x16x32_bf16 v[112:115], a[128:131], a[128:131], v[112:115]
    s_cmp_eq_u32 s0, 0
    s_cbranch_scc0 L_g21
    s_waitcnt vmcnt(6)
L_g21:
    buffer_load_dwordx4 v24, s[24:27], s59 offen offset:2048 nt lds
    v_fma_f32 v130, -v94, v94, v122
    v_fma_f32 v131, -v95, v95, v123
    v_mfma_f32_16x16x32_bf16 v[116:119], a[128:131], a[56:59], v[116:119]
    v_max_f32 v128, v128, v56
    v_max_f32 v129, v129, v56
    v_mfma_f32_16x16x32_bf16 v[112:115], a[132:135], a[132:135], v[112:115]
    v_max_f32 v130, v130, v56
    v_max_f32 v131, v131, v56
    v_mfma_f32_16x16x32_bf16 v[116:119], a[132:135], a[60:63], v[116:119]
    v_rsq_f32 v128, v128
    v_mfma_f32_16x16x32_bf16 v[112:115], a[136:139], a[136:139], v[112:115]
    v_rsq_f32 v129, v129
    v_mfma_f32_16x16x32_bf16 v[116:119], a[136:139], a[64:67], v[116:119]
    v_rsq_f32 v130, v130
    v_mfma_f32_16x16x32_bf16 v[112:115], a[140:143], a[140:143], v[112:115]
    v_rsq_f32 v131, v131
    v_mfma_f32_16x16x32_bf16 v[116:119], a[140:143], a[68:71], v[116:119]
    v_fma_f32 v88, -v92, v61, v88
    v_fma_f32 v89, -v93, v61, v89
    v_mfma_f32_16x16x32_bf16 v[108:111], a[120:123], v[52:55], v[80:83]
    v_fma_f32 v90, -v94, v61, v90
    v_fma_f32 v91, -v95, v61, v91
    v_mfma_f32_16x16x32_bf16 v[108:111], a[124:127], v[52:55], v[108:111]
    v_fma_f32 v88, v88, v128, v62
    v_fma_f32 v89, v89, v129, v62
    v_mfma_f32_16x16x32_bf16 v[108:111], a[128:131], v[52:55], v[108:111]
    v_fma_f32 v90, v90, v130, v62
    v_fma_f32 v91, v91, v131, v62
    v_mfma_f32_16x16x32_bf16 v[108:111], a[132:135], v[52:55], v[108:111]
    v_max3_f32 v1, v88, v89, v90
    v_max_f32 v1, v1, v91
    v_mfma_f32_16x16x32_bf16 v[108:111], a[136:139], v[52:55], v[108:111]
    v_cmp_lt_f32 vcc, s52, v1
    s_cbranch_vccnz L_site0
L_back0:
    v_mfma_f32_16x16x32_bf16 v[108:111], a[140:143], v[52:55], v[108:111]
    s_cmp_eq_u32 s0, 0
    s_cbranch_scc0 L_g22
    s_waitcnt vmcnt(6)
L_g22:
    buffer_load_dwordx4 v25, s[24:27], s59 offen offset:3072 nt lds
    v_exp_f32 v96, v88
    v_mfma_f32_16x16x32_bf16 v[104:107], a[120:123], v[136:139], v[76:79]
    v_exp_f32 v97, v89
    v_mfma_f32_16x16x32_bf16 v[104:107], a[124:127], v[140:143], v[104:107]
    v_exp_f32 v98, v90
    v_mfma_f32_16x16x32_bf16 v[104:107], a[128:131], v[144:147], v[104:107]
    v_exp_f32 v99, v91
    v_mfma_f32_16x16x32_bf16 v[104:107], a[132:135], v[148:151], v[104:107]
    v_mul_f32 v88, v96, v128
    v_mul_f32 v89, v97, v129
    v_mfma_f32_16x16x32_bf16 v[104:107], a[136:139], v[152:155], v[104:107]
    v_mul_f32 v90, v98, v130
    v_mul_f32 v91, v99, v131
    v_mfma_f32_16x16x32_bf16 v[104:107], a[140:143], v[156:159], v[104:107]
    v_fma_f32 v112, v116, 2.0, v112
    v_fma_f32 v113, v117, 2.0, v113
    v_fma_f32 v114, v118, 2.0, v114
    v_fma_f32 v115, v119, 2.0, v115
    v_cndmask_b32 v4, 0, v112, s[44:45]
    v_cndmask_b32 v4, v4, v113, s[46:47]
    v_cndmask_b32 v4, v4, v114, s[48:49]
    v_cndmask_b32 v4, v4, v115, s[50:51]
    v_add_f32 v63, v63, v96
    v_fmac_f32 v64, v88, v92
    v_mfma_f32_16x16x4_f32 v[124:127], v4, v60, v[56:59]
    v_add_f32 v63, v63, v97
    v_fmac_f32 v64, v89, v93
    v_add_f32 v63, v63, v98
    v_fmac_f32 v64, v90, v94
    v_add_f32 v63, v63, v99
    v_fmac_f32 v64, v91, v95
    v_add_f32 v68, v68, v88
    v_add_f32 v69, v69, v89
    v_add_f32 v70, v70, v90
    v_add_f32 v71, v71, v91
    v_add_u32 v44, -49152, v44
    v_add_u32 v45, -49152, v45
    v_add_u32 v46, -49152, v46
    v_add_u32 v47, -49152, v47
    v_add_u32 v48, -49152, v48
    v_add_u32 v49, -49152, v49
    v_fma_f32 v132, -v108, v108, v124
    v_fma_f32 v133, -v109, v109, v125
    v_fma_f32 v134, -v110, v110, v126
    v_fma_f32 v135, -v111, v111, v127
    v_max_f32 v132, v132, v56
    v_max_f32 v133, v133, v56
    v_max_f32 v134, v134, v56
    v_max_f32 v135, v135, v56
    v_rsq_f32 v132, v132
    v_rsq_f32 v133, v133
    v_rsq_f32 v134, v134
    v_rsq_f32 v135, v135
    s_cmp_eq_u32 s0, 0
    s_cbranch_scc0 L_g23
    s_waitcnt vmcnt(6)
L_g23:
    s_add_u32 m0, s42, 4096
    s_nop 0
    buffer_load_dwordx4 v26, s[24:27], s59 offen offset:0 nt lds
    v_fma_f32 v104, -v108, v61, v104
    v_fma_f32 v105, -v109, v61, v105
    v_fma_f32 v106, -v110, v61, v106
    v_fma_f32 v107, -v111, v61, v107
    v_fma_f32 v104, v104, v132, v62
    v_fma_f32 v105, v105, v133, v62
    v_fma_f32 v106, v106, v134, v62
    v_fma_f32 v107, v107, v135, v62
    v_max3_f32 v1, v104, v105, v106
    v_max_f32 v1, v1, v107
    v_cmp_lt_f32 vcc, s52, v1
    s_cbranch_vccnz L_site1
L_back1:
    v_exp_f32 v112, v104
    v_exp_f32 v113, v105
    v_exp_f32 v114, v106
    v_exp_f32 v115, v107
    v_cvt_pk_bf16_f32 v72, v88, v89
    v_cvt_pk_bf16_f32 v73, v90, v91
    v_mul_f32 v104, v112, v132
    v_mul_f32 v105, v113, v133
    v_mul_f32 v106, v114, v134
    v_mul_f32 v107, v115, v135
    v_cvt_pk_bf16_f32 v74, v104, v105
    v_cvt_pk_bf16_f32 v75, v106, v107
    ds_write_b128 v237, v[72:75] offset:0
    v_add_f32 v68, v68, v104
    v_add_f32 v69, v69, v105
    v_add_f32 v70, v70, v106
    v_add_f32 v71, v71, v107
    v_cvt_pk_bf16_f32 v66, v68, v69
    v_cvt_pk_bf16_f32 v67, v70, v71
    ds_write_b64 v238, v[66:67]
    s_cmp_eq_u32 s0, 0
    s_cbranch_scc0 L_g24
    s_waitcnt vmcnt(6)
L_g24:
    buffer_load_dwordx4 v27, s[24:27], s59 offen offset:1024 nt lds
    s_waitcnt vmcnt(18)
    s_waitcnt lgkmcnt(0)
    s_barrier
L_post3:
    ds_read_b32 v9, v254 offset:4096
    ds_read_b64 v[120:121], v254 offset:0
    ds_read_b64 v[122:123], v254 offset:512
    ds_read_b64 v[124:125], v254 offset:1024
    ds_read_b64 v[126:127], v254 offset:1536
    ds_read_b128 v[92:95], v253 offset:0
    ds_read_b128 v[96:99], v253 offset:1024
    ds_read_b128 v[100:103], v253 offset:2048
    ds_read_b128 v[116:119], v253 offset:3072
    ds_read_b128 a[48:51], v34 offset:0
    ds_read_b128 a[52:55], v35 offset:0
    ds_read_b128 a[56:59], v34 offset:128
    ds_read_b128 a[60:63], v35 offset:128
    ds_read_b128 a[64:67], v34 offset:256
    ds_read_b128 a[68:71], v35 offset:256
    s_waitcnt lgkmcnt(14)
    v_cmp_ne_u32 vcc, 0, v9
    s_cbranch_vccnz L_xt3
    s_waitcnt lgkmcnt(12)
    v_mfma_f32_16x16x32_bf16 a[0:3], a[72:75], v[120:123], a[0:3]
    s_cmp_eq_u32 s0, 0
    s_cbranch_scc0 L_g25
    s_waitcnt vmcnt(6)
L_g25:
    buffer_load_dwordx4 v28, s[24:27], s59 offen offset:2048 nt lds
    v_add_f32 v63, v63, v112
    v_fma_f32 v64, v104, v108, v64
    v_mfma_f32_16x16x32_bf16 a[4:7], a[80:83], v[120:123], a[4:7]
    v_add_f32 v63, v63, v113
    v_fma_f32 v64, v105, v109, v64
    v_mfma_f32_16x16x32_bf16 a[8:11], a[88:91], v[120:123], a[8:11]
    v_add_f32 v63, v63, v114
    v_fma_f32 v64, v106, v110, v64
    s_waitcnt lgkmcnt(10)
    v_mfma_f32_16x16x32_bf16 a[0:3], a[76:79], v[124:127], a[0:3]
    v_add_f32 v63, v63, v115
    v_fma_f32 v64, v107, v111, v64
    v_mfma_f32_16x16x32_bf16 a[4:7], a[84:87], v[124:127], a[4:7]
    v_mfma_f32_16x16x32_bf16 a[8:11], a[92:95], v[124:127], a[8:11]
    s_waitcnt lgkmcnt(9)
    v_mfma_f32_16x16x32_bf16 a[0:3], a[144:147], v[92:95], a[0:3]
    ds_read_b64_tr_b16 a[72:73], v36 offset:0
    ds_read_b64_tr_b16 a[74:75], v36 offset:6144
    v_mfma_f32_16x16x32_bf16 a[4:7], a[160:163], v[92:95], a[4:7]
    ds_read_b64_tr_b16 a[76:77], v36 offset:12288
    ds_read_b64_tr_b16 a[78:79], v36 offset:18432
    v_mfma_f32_16x16x32_bf16 a[8:11], a[176:179], v[92:95], a[8:11]
    ds_read_b64_tr_b16 a[80:81], v37 offset:0
    ds_read_b64_tr_b16 a[82:83], v37 offset:6144
    s_waitcnt lgkmcnt(14)
    v_mfma_f32_16x16x32_bf16 a[0:3], a[148:151], v[96:99], a[0:3]
    ds_read_b64_tr_b16 a[84:85], v37 offset:12288
    ds_read_b64_tr_b16 a[86:87], v37 offset:18432
    v_mfma_f32_16x16x32_bf16 a[4:7], a[164:167], v[96:99], a[4:7]
    s_cmp_eq_u32 s0, 0
    s_cbranch_scc0 L_g26
    s_waitcnt vmcnt(6)
L_g26:
    buffer_load_dwordx4 v29, s[24:27], s59 offen offset:3072 nt lds
    ds_read_b64_tr_b16 a[88:89], v38 offset:0
    ds_read_b64_tr_b16 a[90:91], v38 offset:6144
    v_mfma_f32_16x16x32_bf16 a[8:11], a[180:183], v[96:99], a[8:11]
    ds_read_b64_tr_b16 a[92:93], v38 offset:12288
    ds_read_b64_tr_b16 a[94:95], v38 offset:18432
    s_waitcnt lgkmcnt(15)
    v_mfma_f32_16x16x32_bf16 a[0:3], a[152:155], v[100:103], a[0:3]
    v_mfma_f32_16x16x32_bf16 a[4:7], a[168:171], v[100:103], a[4:7]
    v_mfma_f32_16x16x32_bf16 a[8:11], a[184:187], v[100:103], a[8:11]
    v_mfma_f32_16x16x32_bf16 a[0:3], a[156:159], v[116:119], a[0:3]
    v_mfma_f32_16x16x32_bf16 a[4:7], a[172:175], v[116:119], a[4:7]
    v_mfma_f32_16x16x32_bf16 a[8:11], a[188:191], v[116:119], a[8:11]
    v_mfma_f32_16x16x32_bf16 v[84:87], a[48:51], a[48:51], 0
    v_mfma_f32_16x16x32_bf16 v[80:83], a[48:51], v[52:55], 0
    v_mfma_f32_16x16x32_bf16 v[84:87], a[52:55], a[52:55], v[84:87]
    v_mfma_f32_16x16x32_bf16 v[80:83], a[52:55], v[52:55], v[80:83]
    v_mfma_f32_16x16x32_bf16 v[84:87], a[56:59], a[56:59], v[84:87]
    v_mfma_f32_16x16x32_bf16 v[80:83], a[56:59], v[52:55], v[80:83]
    s_cmp_eq_u32 s0, 0
    s_cbranch_scc0 L_g27
    s_waitcnt vmcnt(6)
L_g27:
    s_add_u32 m0, s42, 8192
    s_nop 0
    buffer_load_dwordx4 v30, s[24:27], s59 offen offset:0 nt lds
    s_waitcnt lgkmcnt(14)
    v_mfma_f32_16x16x32_bf16 v[84:87], a[60:63], a[60:63], v[84:87]
    v_mfma_f32_16x16x32_bf16 v[80:83], a[60:63], v[52:55], v[80:83]
    s_waitcnt lgkmcnt(13)
    v_mfma_f32_16x16x32_bf16 v[84:87], a[64:67], a[64:67], v[84:87]
    v_mfma_f32_16x16x32_bf16 v[80:83], a[64:67], v[52:55], v[80:83]
    s_waitcnt lgkmcnt(12)
    v_mfma_f32_16x16x32_bf16 v[84:87], a[68:71], a[68:71], v[84:87]
    v_mfma_f32_16x16x32_bf16 v[80:83], a[68:71], v[52:55], v[80:83]
    s_waitcnt lgkmcnt(0)
    v_mfma_f32_16x16x32_bf16 v[76:79], a[48:51], v[136:139], 0
    v_mfma_f32_16x16x32_bf16 v[76:79], a[52:55], v[140:143], v[76:79]
    v_mfma_f32_16x16x32_bf16 v[76:79], a[56:59], v[144:147], v[76:79]
    v_mfma_f32_16x16x32_bf16 v[76:79], a[60:63], v[148:151], v[76:79]
    v_mfma_f32_16x16x32_bf16 v[76:79], a[64:67], v[152:155], v[76:79]
    v_mfma_f32_16x16x32_bf16 v[76:79], a[68:71], v[156:159], v[76:79]
    v_lshrrev_b32 v1, 3, v0
    v_and_b32 v2, 6, v1
    v_xor_b32 v2, v0, v2
    v_and_b32 v2, 7, v2
    v_mul_u32_u24 v1, 768, v1
    v_lshl_add_u32 v224, v2, 4, v1
    v_xor_b32 v225, 16, v224
    v_add_u32 v225, 5120, v225
    s_cmp_eq_u32 s0, 0
    s_cbranch_scc0 L_g28
    s_waitcnt vmcnt(6)
L_g28:
    buffer_load_dwordx4 v31, s[24:27], s59 offen offset:1024 nt lds
    s_cmp_eq_u32 s0, 0
    s_cbranch_scc0 L_g29
    s_waitcnt vmcnt(6)
L_g29:
    buffer_load_dwordx4 v32, s[24:27], s59 offen offset:2048 nt lds
    s_waitcnt vmcnt(11)
    s_barrier
    ds_read_b128 a[96:99], v40 offset:0
    ds_read_b128 a[100:103], v41 offset:0
    ds_read_b128 a[104:107], v42 offset:0
    ds_read_b128 a[108:111], v43 offset:0
    ds_read_b128 a[112:115], v40 offset:256
    ds_read_b128 a[116:119], v41 offset:256
    ds_read_b128 a[120:123], v42 offset:256
    ds_read_b128 a[124:127], v43 offset:256
    ds_read_b128 a[128:131], v40 offset:512
    ds_read_b128 a[132:135], v41 offset:512
    ds_read_b128 a[136:139], v42 offset:512
    ds_read_b128 a[140:143], v43 offset:512
    s_waitcnt lgkmcnt(11)
    v_mfma_f32_16x16x32_bf16 v[96:99], a[96:99], a[96:99], v[84:87]
    ds_read_b64_tr_b16 a[144:145], v44 offset:0
    ds_read_b64_tr_b16 a[146:147], v45 offset:0
    v_mfma_f32_16x16x32_bf16 v[100:103], a[96:99], a[48:51], 0
    ds_read_b64_tr_b16 a[148:149], v44 offset:12288
    ds_read_b64_tr_b16 a[150:151], v45 offset:12288
    s_waitcnt lgkmcnt(14)
    v_mfma_f32_16x16x32_bf16 v[96:99], a[100:103], a[100:103], v[96:99]
    ds_read_b64_tr_b16 a[152:153], v44 offset:24576
    ds_read_b64_tr_b16 a[154:155], v45 offset:24576
    v_mfma_f32_16x16x32_bf16 v[100:103], a[100:103], a[52:55], v[100:103]
    ds_read_b64_tr_b16 a[156:157], v44 offset:36864
    ds_read_b64_tr_b16 a[158:159], v45 offset:36864
    s_waitcnt lgkmcnt(15)
    v_mfma_f32_16x16x32_bf16 v[96:99], a[104:107], a[104:107], v[96:99]
    ds_read_b64_tr_b16 a[160:161], v46 offset:0
    ds_read_b64_tr_b16 a[162:163], v47 offset:0
    v_mfma_f32_16x16x32_bf16 v[100:103], a[104:107], a[56:59], v[100:103]
    ds_read_b64_tr_b16 a[164:165], v46 offset:12288
    ds_read_b64_tr_b16 a[166:167], v47 offset:12288
    v_mfma_f32_16x16x32_bf16 v[96:99], a[108:111], a[108:111], v[96:99]
    s_cmp_eq_u32 s0, 0
    s_cbranch_scc0 L_g30
    s_waitcnt vmcnt(6)
L_g30:
    buffer_load_dwordx4 v33, s[24:27], s59 offen offset:3072 nt lds
    ds_read_b64_tr_b16 a[168:169], v46 offset:24576
    ds_read_b64_tr_b16 a[170:171], v47 offset:24576
    v_mfma_f32_16x16x32_bf16 v[100:103], a[108:111], a[60:63], v[100:103]
    ds_read_b64_tr_b16 a[172:173], v46 offset:36864
    ds_read_b64_tr_b16 a[174:175], v47 offset:36864
    v_mfma_f32_16x16x32_bf16 v[96:99], a[112:115], a[112:115], v[96:99]
    ds_read_b64_tr_b16 a[176:177], v48 offset:0
    ds_read_b64_tr_b16 a[178:179], v49 offset:0
    v_mfma_f32_16x16x32_bf16 v[100:103], a[112:115], a[64:67], v[100:103]
    ds_read_b64_tr_b16 a[180:181], v48 offset:12288
    ds_read_b64_tr_b16 a[182:183], v49 offset:12288
    s_waitcnt lgkmcnt(15)
    v_mfma_f32_16x16x32_bf16 v[96:99], a[116:119], a[116:119], v[96:99]
    ds_read_b64_tr_b16 a[184:185], v48 offset:24576
    ds_read_b64_tr_b16 a[186:187], v49 offset:24576
    v_mfma_f32_16x16x32_bf16 v[100:103], a[116:119], a[68:71], v[100:103]
    ds_read_b64_tr_b16 a[188:189], v48 offset:36864
    ds_read_b64_tr_b16 a[190:191], v49 offset:36864
    v_mfma_f32_16x16x32_bf16 v[92:95], a[96:99], v[52:55], v[80:83]
    v_mfma_f32_16x16x32_bf16 v[92:95], a[100:103], v[52:55], v[92:95]
    v_mfma_f32_16x16x32_bf16 v[92:95], a[104:107], v[52:55], v[92:95]
    v_mfma_f32_16x16x32_bf16 v[92:95], a[108:111], v[52:55], v[92:95]
    s_nop 1
    v_fma_f32 v96, v100, 2.0, v96
    v_fma_f32 v97, v101, 2.0, v97
    v_mfma_f32_16x16x32_bf16 v[92:95], a[112:115], v[52:55], v[92:95]
    v_fma_f32 v98, v102, 2.0, v98
    v_fma_f32 v99, v103, 2.0, v99
    v_mfma_f32_16x16x32_bf16 v[92:95], a[116:119], v[52:55], v[92:95]
    v_cndmask_b32 v3, 0, v96, s[44:45]
    v_cndmask_b32 v3, v3, v97, s[46:47]
    v_mfma_f32_16x16x32_bf16 v[88:91], a[96:99], v[136:139], v[76:79]
    s_cmp_eq_u32 s0, 0
    s_cbranch_scc0 L_g31
    s_waitcnt vmcnt(6)
L_g31:
    s_add_u32 m0, s40, 0
    s_add_u32 s57, s36, 12582912
    buffer_load_dwordx4 v16, s[28:31], s57 offen offset:0 nt lds
    v_cndmask_b32 v3, v3, v98, s[48:49]
    v_cndmask_b32 v3, v3, v99, s[50:51]
    v_mfma_f32_16x16x32_bf16 v[88:91], a[100:103], v[140:143], v[88:91]
    s_nop 0
    s_nop 0
    v_mfma_f32_16x16x32_bf16 v[88:91], a[104:107], v[144:147], v[88:91]
    v_mfma_f32_16x16x4_f32 v[120:123], v3, v60, v[56:59]
    v_mfma_f32_16x16x32_bf16 v[88:91], a[108:111], v[148:151], v[88:91]
    v_mfma_f32_16x16x32_bf16 v[88:91], a[112:115], v[152:155], v[88:91]
    v_mfma_f32_16x16x32_bf16 v[88:91], a[116:119], v[156:159], v[88:91]
    v_mfma_f32_16x16x32_bf16 v[112:115], a[120:123], a[120:123], v[84:87]
    v_mfma_f32_16x16x32_bf16 v[116:119], a[120:123], a[48:51], 0
    v_mfma_f32_16x16x32_bf16 v[112:115], a[124:127], a[124:127], v[112:115]
    v_mfma_f32_16x16x32_bf16 v[116:119], a[124:127], a[52:55], v[116:119]
    s_nop 2
    v_fma_f32 v128, -v92, v92, v120
    v_fma_f32 v129, -v93, v93, v121
    v_mfma_f32_16x16x32_bf16 v[112:115], a[128:131], a[128:131], v[112:115]
    v_fma_f32 v130, -v94, v94, v122
    v_fma_f32 v131, -v95, v95, v123
    v_mfma_f32_16x16x32_bf16 v[116:119], a[128:131], a[56:59], v[116:119]
    s_cmp_eq_u32 s0, 0
    s_cbranch_scc0 L_g32
    s_waitcnt vmcnt(6)
L_g32:
    buffer_load_dwordx4 v17, s[28:31], s57 offen offset:1024 nt lds
    v_max_f32 v128, v128, v56
    v_max_f32 v129, v129, v56
    v_mfma_f32_16x16x32_bf16 v[112:115], a[132:135], a[132:135], v[112:115]
    v_max_f32 v130, v130, v56
    v_max_f32 v131, v131, v56
    v_mfma_f32_16x16x32_bf16 v[116:119], a[132:135], a[60:63], v[116:119]
    v_rsq_f32 v128, v128
    v_mfma_f32_16x16x32_bf16 v[112:115], a[136:139], a[136:139], v[112:115]
    v_rsq_f32 v129, v129
    v_mfma_f32_16x16x32_bf16 v[116:119], a[136:139], a[64:67], v[116:119]
    v_rsq_f32 v130, v130
    v_mfma_f32_16x16x32_bf16 v[112:115], a[140:143], a[140:143], v[112:115]
    v_rsq_f32 v131, v131
    v_mfma_f32_16x16x32_bf16 v[116:119], a[140:143], a[68:71], v[116:119]
    v_fma_f32 v88, -v92, v61, v88
    v_fma_f32 v89, -v93, v61, v89
    v_mfma_f32_16x16x32_bf16 v[108:111], a[120:123], v[52:55], v[80:83]
    v_fma_f32 v90, -v94, v61, v90
    v_fma_f32 v91, -v95, v61, v91
    v_mfma_f32_16x16x32_bf16 v[108:111], a[124:127], v[52:55], v[108:111]
    v_fma_f32 v88, v88, v128, v62
    v_fma_f32 v89, v89, v129, v62
    v_mfma_f32_16x16x32_bf16 v[108:111], a[128:131], v[52:55], v[108:111]
    v_fma_f32 v90, v90, v130, v62
    v_fma_f32 v91, v91, v131, v62
    v_mfma_f32_16x16x32_bf16 v[108:111], a[132:135], v[52:55], v[108:111]
    v_max3_f32 v1, v88, v89, v90
    v_max_f32 v1, v1, v91
    v_mfma_f32_16x16x32_bf16 v[108:111], a[136:139], v[52:55], v[108:111]
    v_cmp_lt_f32 vcc, s52, v1
    s_cbranch_vccnz L_site2
L_back2:
    v_mfma_f32_16x16x32_bf16 v[108:111], a[140:143], v[52:55], v[108:111]
    s_cmp_eq_u32 s0, 0
    s_cbranch_scc0 L_g33
    s_waitcnt vmcnt(6)
L_g33:
    buffer_load_dwordx4 v18, s[28:31], s57 offen offset:2048 nt lds
    v_exp_f32 v96, v88
    v_mfma_f32_16x16x32_bf16 v[104:107], a[120:123], v[136:139], v[76:79]
    v_exp_f32 v97, v89
    v_mfma_f32_16x16x32_bf16 v[104:107], a[124:127], v[140:143], v[104:107]
    v_exp_f32 v98, v90
    v_mfma_f32_16x16x32_bf16 v[104:107], a[128:131], v[144:147], v[104:107]
    v_exp_f32 v99, v91
    v_mfma_f32_16x16x32_bf16 v[104:107], a[132:135], v[148:151], v[104:107]
    v_mul_f32 v88, v96, v128
    v_mul_f32 v89, v97, v129
    v_mfma_f32_16x16x32_bf16 v[104:107], a[136:139], v[152:155], v[104:107]
    v_mul_f32 v90, v98, v130
    v_mul_f32 v91, v99, v131
    v_mfma_f32_16x16x32_bf16 v[104:107], a[140:143], v[156:159], v[104:107]
    v_fma_f32 v112, v116, 2.0, v112
    v_fma_f32 v113, v117, 2.0, v113
    v_fma_f32 v114, v118, 2.0, v114
    v_fma_f32 v115, v119, 2.0, v115
    v_cndmask_b32 v4, 0, v112, s[44:45]
    v_cndmask_b32 v4, v4, v113, s[46:47]
    v_cndmask_b32 v4, v4, v114, s[48:49]
    v_cndmask_b32 v4, v4, v115, s[50:51]
    v_add_f32 v63, v63, v96
    v_fmac_f32 v64, v88, v92
    v_mfma_f32_16x16x4_f32 v[124:127], v4, v60, v[56:59]
    v_add_f32 v63, v63, v97
    v_fmac_f32 v64, v89, v93
    v_add_f32 v63, v63, v98
    v_fmac_f32 v64, v90, v94
    v_add_f32 v63, v63, v99
    v_fmac_f32 v64, v91, v95
    v_mov_b32 v68, v88
    v_mov_b32 v69, v89
    v_mov_b32 v70, v90
    v_mov_b32 v71, v91
    v_add_u32 v44, 49152, v44
    v_add_u32 v45, 49152, v45
    v_add_u32 v46, 49152, v46
    v_add_u32 v47, 49152, v47
    v_add_u32 v48, 49152, v48
    v_add_u32 v49, 49152, v49
    v_fma_f32 v132, -v108, v108, v124
    v_fma_f32 v133, -v109, v109, v125
    v_fma_f32 v134, -v110, v110, v126
    v_fma_f32 v135, -v111, v111, v127
    v_max_f32 v132, v132, v56
    v_max_f32 v133, v133, v56
    v_max_f32 v134, v134, v56
    v_max_f32 v135, v135, v56
    v_rsq_f32 v132, v132
    v_rsq_f32 v133, v133
    v_rsq_f32 v134, v134
    v_rsq_f32 v135, v135
    s_cmp_eq_u32 s0, 0
    s_cbranch_scc0 L_g34
    s_waitcnt vmcnt(6)
L_g34:
    buffer_load_dwordx4 v19, s[28:31], s57 offen offset:3072 nt lds
    v_fma_f32 v104, -v108, v61, v104
    v_fma_f32 v105, -v109, v61, v105
    v_fma_f32 v106, -v110, v61, v106
    v_fma_f32 v107, -v111, v61, v107
    v_fma_f32 v104, v104, v132, v62
    v_fma_f32 v105, v105, v133, v62
    v_fma_f32 v106, v106, v134, v62
    v_fma_f32 v107, v107, v135, v62
    v_max3_f32 v1, v104, v105, v106
    v_max_f32 v1, v1, v107
    v_cmp_lt_f32 vcc, s52, v1
    s_cbranch_vccnz L_site3
L_back3:
    v_exp_f32 v112, v104
    v_exp_f32 v113, v105
    v_exp_f32 v114, v106
    v_exp_f32 v115, v107
    v_cvt_pk_bf16_f32 v72, v88, v89
    v_cvt_pk_bf16_f32 v73, v90, v91
    v_mul_f32 v104, v112, v132
    v_mul_f32 v105, v113, v133
    v_mul_f32 v106, v114, v134
    v_mul_f32 v107, v115, v135
    v_cvt_pk_bf16_f32 v74, v104, v105
    v_cvt_pk_bf16_f32 v75, v106, v107
    ds_write_b128 v237, v[72:75] offset:0
    s_waitcnt lgkmcnt(0)
    s_barrier
L_post24:
    ds_read_b32 v9, v254 offset:4096
    ds_read_b128 v[92:95], v253 offset:0
    ds_read_b128 v[96:99], v253 offset:1024
    ds_read_b128 v[100:103], v253 offset:2048
    ds_read_b128 v[116:119], v253 offset:3072
    s_waitcnt lgkmcnt(4)
    v_cmp_ne_u32 vcc, 0, v9
    s_cbranch_vccnz L_xt24
    s_waitcnt lgkmcnt(3)
    v_mfma_f32_16x16x32_bf16 a[0:3], a[144:147], v[92:95], a[0:3]
    s_cmp_eq_u32 s0, 0
    s_cbranch_scc0 L_g35
    s_waitcnt vmcnt(6)
L_g35:
    s_add_u32 m0, s40, 4096
    s_nop 0
    buffer_load_dwordx4 v20, s[28:31], s57 offen offset:0 nt lds
    v_add_f32 v68, v68, v104
    v_add_f32 v69, v69, v105
    v_mfma_f32_16x16x32_bf16 a[4:7], a[160:163], v[92:95], a[4:7]
    s_cmp_eq_u32 s0, 0
    s_cbranch_scc0 L_g36
    s_waitcnt vmcnt(6)
L_g36:
    buffer_load_dwordx4 v21, s[28:31], s57 offen offset:1024 nt lds
    v_add_f32 v70, v70, v106
    v_add_f32 v71, v71, v107
    v_mfma_f32_16x16x32_bf16 a[8:11], a[176:179], v[92:95], a[8:11]
    v_add_f32 v63, v63, v112
    v_fma_f32 v64, v104, v108, v64
    s_waitcnt lgkmcnt(2)
    v_mfma_f32_16x16x32_bf16 a[0:3], a[148:151], v[96:99], a[0:3]
    v_add_f32 v63, v63, v113
    v_fma_f32 v64, v105, v109, v64
    v_mfma_f32_16x16x32_bf16 a[4:7], a[164:167], v[96:99], a[4:7]
    v_add_f32 v63, v63, v114
    v_fma_f32 v64, v106, v110, v64
    v_mfma_f32_16x16x32_bf16 a[8:11], a[180:183], v[96:99], a[8:11]
    v_add_f32 v63, v63, v115
    v_fma_f32 v64, v107, v111, v64
    s_waitcnt lgkmcnt(1)
    v_mfma_f32_16x16x32_bf16 a[0:3], a[152:155], v[100:103], a[0:3]
    v_mfma_f32_16x16x32_bf16 a[4:7], a[168:171], v[100:103], a[4:7]
    v_mfma_f32_16x16x32_bf16 a[8:11], a[184:187], v[100:103], a[8:11]
    s_waitcnt lgkmcnt(0)
    v_mfma_f32_16x16x32_bf16 a[0:3], a[156:159], v[116:119], a[0:3]
    buffer_load_dword v244, v245, s[32:35], 0 offen offset:128 sc1
    v_mfma_f32_16x16x32_bf16 a[4:7], a[172:175], v[116:119], a[4:7]
    v_mfma_f32_16x16x32_bf16 a[8:11], a[188:191], v[116:119], a[8:11]
    s_cmp_eq_u32 s0, 0
    s_cbranch_scc0 L_g37
    s_waitcnt vmcnt(7)
L_g37:
    s_add_u32 m0, s41, 0
    s_add_u32 s58, s37, 50331648
    buffer_load_dwordx4 v22, s[24:27], s58 offen offset:0 nt lds
    s_cmp_eq_u32 s0, 0
    s_cbranch_scc0 L_g38
    s_waitcnt vmcnt(7)
L_g38:
    buffer_load_dwordx4 v23, s[24:27], s58 offen offset:1024 nt lds
    s_cmp_eq_u32 s0, 0
    s_cbranch_scc0 L_g39
    s_waitcnt vmcnt(7)
L_g39:
    buffer_load_dwordx4 v24, s[24:27], s58 offen offset:2048 nt lds
    s_cmp_eq_u32 s0, 0
    s_cbranch_scc0 L_g40
    s_waitcnt vmcnt(7)
L_g40:
    buffer_load_dwordx4 v25, s[24:27], s58 offen offset:3072 nt lds
    s_waitcnt vmcnt(11)
    s_barrier
    ds_read_b128 a[96:99], v40 offset:49152
    ds_read_b128 a[100:103], v41 offset:49152
    ds_read_b128 a[104:107], v42 offset:49152
    ds_read_b128 a[108:111], v43 offset:49152
    ds_read_b128 a[112:115], v40 offset:49408
    ds_read_b128 a[116:119], v41 offset:49408
    ds_read_b128 a[120:123], v42 offset:49408
    ds_read_b128 a[124:127], v43 offset:49408
    ds_read_b128 a[128:131], v40 offset:49664
    ds_read_b128 a[132:135], v41 offset:49664
    ds_read_b128 a[136:139], v42 offset:49664
    ds_read_b128 a[140:143], v43 offset:49664
    s_waitcnt lgkmcnt(11)
    v_mfma_f32_16x16x32_bf16 v[96:99], a[96:99], a[96:99], v[84:87]
    ds_read_b64_tr_b16 a[144:145], v44 offset:0
    ds_read_b64_tr_b16 a[146:147], v45 offset:0
    v_mfma_f32_16x16x32_bf16 v[100:103], a[96:99], a[48:51], 0
    ds_read_b64_tr_b16 a[148:149], v44 offset:12288
    ds_read_b64_tr_b16 a[150:151], v45 offset:12288
    s_waitcnt lgkmcnt(14)
    v_mfma_f32_16x16x32_bf16 v[96:99], a[100:103], a[100:103], v[96:99]
    ds_read_b64_tr_b16 a[152:153], v44 offset:24576
    ds_read_b64_tr_b16 a[154:155], v45 offset:24576
    v_mfma_f32_16x16x32_bf16 v[100:103], a[100:103], a[52:55], v[100:103]
    ds_read_b64_tr_b16 a[156:157], v44 offset:36864
    ds_read_b64_tr_b16 a[158:159], v45 offset:36864
    s_waitcnt lgkmcnt(15)
    v_mfma_f32_16x16x32_bf16 v[96:99], a[104:107], a[104:107], v[96:99]
    ds_read_b64_tr_b16 a[160:161], v46 offset:0
    ds_read_b64_tr_b16 a[162:163], v47 offset:0
    v_mfma_f32_16x16x32_bf16 v[100:103], a[104:107], a[56:59], v[100:103]
    ds_read_b64_tr_b16 a[164:165], v46 offset:12288
    ds_read_b64_tr_b16 a[166:167], v47 offset:12288
    v_mfma_f32_16x16x32_bf16 v[96:99], a[108:111], a[108:111], v[96:99]
    s_cmp_eq_u32 s0, 0
    s_cbranch_scc0 L_g41
    s_waitcnt vmcnt(7)
L_g41:
    s_add_u32 m0, s41, 4096
    s_nop 0
    buffer_load_dwordx4 v26, s[24:27], s58 offen offset:0 nt lds
    ds_read_b64_tr_b16 a[168:169], v46 offset:24576
    ds_read_b64_tr_b16 a[170:171], v47 offset:24576
    v_mfma_f32_16x16x32_bf16 v[100:103], a[108:111], a[60:63], v[100:103]
    ds_read_b64_tr_b16 a[172:173], v46 offset:36864
    ds_read_b64_tr_b16 a[174:175], v47 offset:36864
    v_mfma_f32_16x16x32_bf16 v[96:99], a[112:115], a[112:115], v[96:99]
    ds_read_b64_tr_b16 a[176:177], v48 offset:0
    ds_read_b64_tr_b16 a[178:179], v49 offset:0
    v_mfma_f32_16x16x32_bf16 v[100:103], a[112:115], a[64:67], v[100:103]
    ds_read_b64_tr_b16 a[180:181], v48 offset:12288
    ds_read_b64_tr_b16 a[182:183], v49 offset:12288
    s_waitcnt lgkmcnt(15)
    v_mfma_f32_16x16x32_bf16 v[96:99], a[116:119], a[116:119], v[96:99]
    ds_read_b64_tr_b16 a[184:185], v48 offset:24576
    ds_read_b64_tr_b16 a[186:187], v49 offset:24576
    v_mfma_f32_16x16x32_bf16 v[100:103], a[116:119], a[68:71], v[100:103]
    ds_read_b64_tr_b16 a[188:189], v48 offset:36864
    ds_read_b64_tr_b16 a[190:191], v49 offset:36864
    v_mfma_f32_16x16x32_bf16 v[92:95], a[96:99], v[52:55], v[80:83]
    v_mfma_f32_16x16x32_bf16 v[92:95], a[100:103], v[52:55], v[92:95]
    v_mfma_f32_16x16x32_bf16 v[92:95], a[104:107], v[52:55], v[92:95]
    v_mfma_f32_16x16x32_bf16 v[92:95], a[108:111], v[52:55], v[92:95]
    s_nop 1
    v_fma_f32 v96, v100, 2.0, v96
    v_fma_f32 v97, v101, 2.0, v97
    v_mfma_f32_16x16x32_bf16 v[92:95], a[112:115], v[52:55], v[92:95]
    v_fma_f32 v98, v102, 2.0, v98
    v_fma_f32 v99, v103, 2.0, v99
    v_mfma_f32_16x16x32_bf16 v[92:95], a[116:119], v[52:55], v[92:95]
    v_cndmask_b32 v3, 0, v96, s[44:45]
    v_cndmask_b32 v3, v3, v97, s[46:47]
    v_mfma_f32_16x16x32_bf16 v[88:91], a[96:99], v[136:139], v[76:79]
    s_cmp_eq_u32 s0, 0
    s_cbranch_scc0 L_g42
    s_waitcnt vmcnt(7)
L_g42:
    buffer_load_dwordx4 v27, s[24:27], s58 offen offset:1024 nt lds
    v_cndmask_b32 v3, v3, v98, s[48:49]
    v_cndmask_b32 v3, v3, v99, s[50:51]
    v_mfma_f32_16x16x32_bf16 v[88:91], a[100:103], v[140:143], v[88:91]
    s_nop 0
    s_nop 0
    v_mfma_f32_16x16x32_bf16 v[88:91], a[104:107], v[144:147], v[88:91]
    v_mfma_f32_16x16x4_f32 v[120:123], v3, v60, v[56:59]
    v_mfma_f32_16x16x32_bf16 v[88:91], a[108:111], v[148:151], v[88:91]
    v_mfma_f32_16x16x32_bf16 v[88:91], a[112:115], v[152:155], v[88:91]
    v_mfma_f32_16x16x32_bf16 v[88:91], a[116:119], v[156:159], v[88:91]
    v_mfma_f32_16x16x32_bf16 v[112:115], a[120:123], a[120:123], v[84:87]
    v_mfma_f32_16x16x32_bf16 v[116:119], a[120:123], a[48:51], 0
    v_mfma_f32_16x16x32_bf16 v[112:115], a[124:127], a[124:127], v[112:115]
    v_mfma_f32_16x16x32_bf16 v[116:119], a[124:127], a[52:55], v[116:119]
    s_nop 2
    v_fma_f32 v128, -v92, v92, v120
    v_fma_f32 v129, -v93, v93, v121
    v_mfma_f32_16x16x32_bf16 v[112:115], a[128:131], a[128:131], v[112:115]
    v_fma_f32 v130, -v94, v94, v122
    v_fma_f32 v131, -v95, v95, v123
    v_mfma_f32_16x16x32_bf16 v[116:119], a[128:131], a[56:59], v[116:119]
    s_cmp_eq_u32 s0, 0
    s_cbranch_scc0 L_g43
    s_waitcnt vmcnt(7)
L_g43:
    buffer_load_dwordx4 v28, s[24:27], s58 offen offset:2048 nt lds
    v_max_f32 v128, v128, v56
    v_max_f32 v129, v129, v56
    v_mfma_f32_16x16x32_bf16 v[112:115], a[132:135], a[132:135], v[112:115]
    v_max_f32 v130, v130, v56
    v_max_f32 v131, v131, v56
    v_mfma_f32_16x16x32_bf16 v[116:119], a[132:135], a[60:63], v[116:119]
    v_rsq_f32 v128, v128
    v_mfma_f32_16x16x32_bf16 v[112:115], a[136:139], a[136:139], v[112:115]
    v_rsq_f32 v129, v129
    v_mfma_f32_16x16x32_bf16 v[116:119], a[136:139], a[64:67], v[116:119]
    v_rsq_f32 v130, v130
    v_mfma_f32_16x16x32_bf16 v[112:115], a[140:143], a[140:143], v[112:115]
    v_rsq_f32 v131, v131
    v_mfma_f32_16x16x32_bf16 v[116:119], a[140:143], a[68:71], v[116:119]
    v_fma_f32 v88, -v92, v61, v88
    v_fma_f32 v89, -v93, v61, v89
    v_mfma_f32_16x16x32_bf16 v[108:111], a[120:123], v[52:55], v[80:83]
    v_fma_f32 v90, -v94, v61, v90
    v_fma_f32 v91, -v95, v61, v91
    v_mfma_f32_16x16x32_bf16 v[108:111], a[124:127], v[52:55], v[108:111]
    v_fma_f32 v88, v88, v128, v62
    v_fma_f32 v89, v89, v129, v62
    v_mfma_f32_16x16x32_bf16 v[108:111], a[128:131], v[52:55], v[108:111]
    v_fma_f32 v90, v90, v130, v62
    v_fma_f32 v91, v91, v131, v62
    v_mfma_f32_16x16x32_bf16 v[108:111], a[132:135], v[52:55], v[108:111]
    v_max3_f32 v1, v88, v89, v90
    v_max_f32 v1, v1, v91
    v_mfma_f32_16x16x32_bf16 v[108:111], a[136:139], v[52:55], v[108:111]
    v_cmp_lt_f32 vcc, s52, v1
    s_cbranch_vccnz L_site4
L_back4:
    v_mfma_f32_16x16x32_bf16 v[108:111], a[140:143], v[52:55], v[108:111]
    v_exp_f32 v96, v88
    v_mfma_f32_16x16x32_bf16 v[104:107], a[120:123], v[136:139], v[76:79]
    s_cmp_eq_u32 s0, 0
    s_cbranch_scc0 L_g44
    s_waitcnt vmcnt(6)
L_g44:
    buffer_load_dwordx4 v29, s[24:27], s58 offen offset:3072 nt lds
    v_exp_f32 v97, v89
    v_mfma_f32_16x16x32_bf16 v[104:107], a[124:127], v[140:143], v[104:107]
    v_exp_f32 v98, v90
    v_mfma_f32_16x16x32_bf16 v[104:107], a[128:131], v[144:147], v[104:107]
    v_exp_f32 v99, v91
    v_mfma_f32_16x16x32_bf16 v[104:107], a[132:135], v[148:151], v[104:107]
    v_mul_f32 v88, v96, v128
    v_mul_f32 v89, v97, v129
    v_mfma_f32_16x16x32_bf16 v[104:107], a[136:139], v[152:155], v[104:107]
    v_mul_f32 v90, v98, v130
    v_mul_f32 v91, v99, v131
    v_mfma_f32_16x16x32_bf16 v[104:107], a[140:143], v[156:159], v[104:107]
    v_fma_f32 v112, v116, 2.0, v112
    v_fma_f32 v113, v117, 2.0, v113
    v_fma_f32 v114, v118, 2.0, v114
    v_fma_f32 v115, v119, 2.0, v115
    v_cndmask_b32 v4, 0, v112, s[44:45]
    v_cndmask_b32 v4, v4, v113, s[46:47]
    v_cndmask_b32 v4, v4, v114, s[48:49]
    v_cndmask_b32 v4, v4, v115, s[50:51]
    v_add_f32 v63, v63, v96
    v_fmac_f32 v64, v88, v92
    v_mfma_f32_16x16x4_f32 v[124:127], v4, v60, v[56:59]
    v_add_f32 v63, v63, v97
    v_fmac_f32 v64, v89, v93
    v_add_f32 v63, v63, v98
    v_fmac_f32 v64, v90, v94
    v_add_f32 v63, v63, v99
    v_fmac_f32 v64, v91, v95
    v_add_f32 v68, v68, v88
    v_add_f32 v69, v69, v89
    v_add_f32 v70, v70, v90
    v_add_f32 v71, v71, v91
    v_add_u32 v44, -49152, v44
    v_add_u32 v45, -49152, v45
    v_add_u32 v46, -49152, v46
    v_add_u32 v47, -49152, v47
    v_add_u32 v48, -49152, v48
    v_add_u32 v49, -49152, v49
    v_fma_f32 v132, -v108, v108, v124
    v_fma_f32 v133, -v109, v109, v125
    v_fma_f32 v134, -v110, v110, v126
    v_fma_f32 v135, -v111, v111, v127
    v_max_f32 v132, v132, v56
    v_max_f32 v133, v133, v56
    v_max_f32 v134, v134, v56
    v_max_f32 v135, v135, v56
    v_rsq_f32 v132, v132
    v_rsq_f32 v133, v133
    v_rsq_f32 v134, v134
    v_rsq_f32 v135, v135
    s_cmp_eq_u32 s0, 0
    s_cbranch_scc0 L_g45
    s_waitcnt vmcnt(6)
L_g45:
    s_add_u32 m0, s41, 8192
    s_nop 0
    buffer_load_dwordx4 v30, s[24:27], s58 offen offset:0 nt lds
    v_fma_f32 v104, -v108, v61, v104
    v_fma_f32 v105, -v109, v61, v105
    v_fma_f32 v106, -v110, v61, v106
    v_fma_f32 v107, -v111, v61, v107
    v_fma_f32 v104, v104, v132, v62
    v_fma_f32 v105, v105, v133, v62
    v_fma_f32 v106, v106, v134, v62
    v_fma_f32 v107, v107, v135, v62
    v_max3_f32 v1, v104, v105, v106
    v_max_f32 v1, v1, v107
    v_cmp_lt_f32 vcc, s52, v1
    s_cbranch_vccnz L_site5
L_back5:
    v_exp_f32 v112, v104
    v_exp_f32 v113, v105
    v_exp_f32 v114, v106
    v_exp_f32 v115, v107
    v_cvt_pk_bf16_f32 v72, v88, v89
    v_cvt_pk_bf16_f32 v73, v90, v91
    v_mul_f32 v104, v112, v132
    v_mul_f32 v105, v113, v133
    v_mul_f32 v106, v114, v134
    v_mul_f32 v107, v115, v135
    v_cvt_pk_bf16_f32 v74, v104, v105
    v_cvt_pk_bf16_f32 v75, v106, v107
    ds_write_b128 v237, v[72:75] offset:0
    v_add_f32 v68, v68, v104
    v_add_f32 v69, v69, v105
    v_add_f32 v70, v70, v106
    v_add_f32 v71, v71, v107
    v_cvt_pk_bf16_f32 v66, v68, v69
    v_cvt_pk_bf16_f32 v67, v70, v71
    ds_write_b64 v238, v[66:67]
    s_cmp_eq_u32 s0, 0
    s_cbranch_scc0 L_g46
    s_waitcnt vmcnt(6)
L_g46:
    buffer_load_dwordx4 v31, s[24:27], s58 offen offset:1024 nt lds
    s_cmp_eq_u32 s0, 0
    s_cbranch_scc0 L_g47
    s_waitcnt vmcnt(6)
L_g47:
    buffer_load_dwordx4 v32, s[24:27], s58 offen offset:2048 nt lds
    s_waitcnt vmcnt(12)
    s_waitcnt vmcnt(11)
    v_cmp_ne_u32 vcc, s39, v244
    s_cbranch_vccnz L_fl_retry
L_fl_ok:
    s_waitcnt lgkmcnt(0)
    s_barrier
L_post6:
    ds_read_b32 v9, v254 offset:4096
    ds_read_b64 v[120:121], v254 offset:0
    ds_read_b64 v[122:123], v254 offset:512
    ds_read_b64 v[124:125], v254 offset:1024
    ds_read_b64 v[126:127], v254 offset:1536
    ds_read_b128 v[92:95], v253 offset:0
    ds_read_b128 v[96:99], v253 offset:1024
    ds_read_b128 v[100:103], v253 offset:2048
    ds_read_b128 v[116:119], v253 offset:3072
    ds_read_b128 a[48:51], v34 offset:0
    ds_read_b128 a[52:55], v35 offset:0
    ds_read_b128 a[56:59], v34 offset:128
    ds_read_b128 a[60:63], v35 offset:128
    ds_read_b128 a[64:67], v34 offset:256
    ds_read_b128 a[68:71], v35 offset:256
    s_waitcnt lgkmcnt(14)
    v_cmp_ne_u32 vcc, 0, v9
    s_cbranch_vccnz L_xt6
    s_waitcnt lgkmcnt(12)
    v_mfma_f32_16x16x32_bf16 a[0:3], a[72:75], v[120:123], a[0:3]
    s_cmp_eq_u32 s0, 0
    s_cbranch_scc0 L_g48
    s_waitcnt vmcnt(6)
L_g48:
    buffer_load_dwordx4 v33, s[24:27], s58 offen offset:3072 nt lds
    v_add_f32 v63, v63, v112
    v_fma_f32 v64, v104, v108, v64
    v_mfma_f32_16x16x32_bf16 a[4:7], a[80:83], v[120:123], a[4:7]
    v_add_f32 v63, v63, v113
    v_fma_f32 v64, v105, v109, v64
    v_mfma_f32_16x16x32_bf16 a[8:11], a[88:91], v[120:123], a[8:11]
    v_add_f32 v63, v63, v114
    v_fma_f32 v64, v106, v110, v64
    s_waitcnt lgkmcnt(10)
    v_mfma_f32_16x16x32_bf16 a[0:3], a[76:79], v[124:127], a[0:3]
    v_add_f32 v63, v63, v115
    v_fma_f32 v64, v107, v111, v64
    v_mfma_f32_16x16x32_bf16 a[4:7], a[84:87], v[124:127], a[4:7]
    v_mfma_f32_16x16x32_bf16 a[8:11], a[92:95], v[124:127], a[8:11]
    s_waitcnt lgkmcnt(9)
    v_mfma_f32_16x16x32_bf16 a[0:3], a[144:147], v[92:95], a[0:3]
    ds_read_b64_tr_b16 a[72:73], v36 offset:0
    ds_read_b64_tr_b16 a[74:75], v36 offset:6144
    v_mfma_f32_16x16x32_bf16 a[4:7], a[160:163], v[92:95], a[4:7]
    ds_read_b64_tr_b16 a[76:77], v36 offset:12288
    ds_read_b64_tr_b16 a[78:79], v36 offset:18432
    v_mfma_f32_16x16x32_bf16 a[8:11], a[176:179], v[92:95], a[8:11]
    ds_read_b64_tr_b16 a[80:81], v37 offset:0
    ds_read_b64_tr_b16 a[82:83], v37 offset:6144
    s_waitcnt lgkmcnt(14)
    v_mfma_f32_16x16x32_bf16 a[0:3], a[148:151], v[96:99], a[0:3]
    s_cmp_eq_u32 s0, 0
    s_cbranch_scc0 L_g49
    s_waitcnt vmcnt(6)
L_g49:
    s_add_u32 m0, s42, 0
    s_add_u32 s59, s37, 50528256
    buffer_load_dwordx4 v22, s[24:27], s59 offen offset:0 nt lds
    ds_read_b64_tr_b16 a[84:85], v37 offset:12288
    ds_read_b64_tr_b16 a[86:87], v37 offset:18432
    v_mfma_f32_16x16x32_bf16 a[4:7], a[164:167], v[96:99], a[4:7]
    ds_read_b64_tr_b16 a[88:89], v38 offset:0
    ds_read_b64_tr_b16 a[90:91], v38 offset:6144
    v_mfma_f32_16x16x32_bf16 a[8:11], a[180:183], v[96:99], a[8:11]
    ds_read_b64_tr_b16 a[92:93], v38 offset:12288
    ds_read_b64_tr_b16 a[94:95], v38 offset:18432
    s_waitcnt lgkmcnt(15)
    v_mfma_f32_16x16x32_bf16 a[0:3], a[152:155], v[100:103], a[0:3]
    v_mfma_f32_16x16x32_bf16 a[4:7], a[168:171], v[100:103], a[4:7]
    v_mfma_f32_16x16x32_bf16 a[8:11], a[184:187], v[100:103], a[8:11]
    v_mfma_f32_16x16x32_bf16 a[0:3], a[156:159], v[116:119], a[0:3]
    v_mfma_f32_16x16x32_bf16 a[4:7], a[172:175], v[116:119], a[4:7]
    v_mfma_f32_16x16x32_bf16 a[8:11], a[188:191], v[116:119], a[8:11]
    v_mfma_f32_16x16x32_bf16 v[84:87], a[48:51], a[48:51], 0
    v_mfma_f32_16x16x32_bf16 v[80:83], a[48:51], v[52:55], 0
    v_mfma_f32_16x16x32_bf16 v[84:87], a[52:55], a[52:55], v[84:87]
    v_mfma_f32_16x16x32_bf16 v[80:83], a[52:55], v[52:55], v[80:83]
    s_cmp_eq_u32 s0, 0
    s_cbranch_scc0 L_g50
    s_waitcnt vmcnt(6)
L_g50:
    buffer_load_dwordx4 v23, s[24:27], s59 offen offset:1024 nt lds
    v_mfma_f32_16x16x32_bf16 v[84:87], a[56:59], a[56:59], v[84:87]
    v_mfma_f32_16x16x32_bf16 v[80:83], a[56:59], v[52:55], v[80:83]
    s_waitcnt lgkmcnt(14)
    v_mfma_f32_16x16x32_bf16 v[84:87], a[60:63], a[60:63], v[84:87]
    v_mfma_f32_16x16x32_bf16 v[80:83], a[60:63], v[52:55], v[80:83]
    s_waitcnt lgkmcnt(13)
    v_mfma_f32_16x16x32_bf16 v[84:87], a[64:67], a[64:67], v[84:87]
    v_mfma_f32_16x16x32_bf16 v[80:83], a[64:67], v[52:55], v[80:83]
    s_waitcnt lgkmcnt(12)
    v_mfma_f32_16x16x32_bf16 v[84:87], a[68:71], a[68:71], v[84:87]
    v_mfma_f32_16x16x32_bf16 v[80:83], a[68:71], v[52:55], v[80:83]
    s_waitcnt lgkmcnt(0)
    v_mfma_f32_16x16x32_bf16 v[76:79], a[48:51], v[136:139], 0
    v_mfma_f32_16x16x32_bf16 v[76:79], a[52:55], v[140:143], v[76:79]
    v_mfma_f32_16x16x32_bf16 v[76:79], a[56:59], v[144:147], v[76:79]
    v_mfma_f32_16x16x32_bf16 v[76:79], a[60:63], v[148:151], v[76:79]
    v_mfma_f32_16x16x32_bf16 v[76:79], a[64:67], v[152:155], v[76:79]
    v_mfma_f32_16x16x32_bf16 v[76:79], a[68:71], v[156:159], v[76:79]
    s_add_u32 s61, s60, 3145728
    buffer_load_dwordx4 v[160:163], v65, s[72:75], s61 offen offset:0 sc1
    s_cmp_eq_u32 s0, 0
    s_cbranch_scc0 L_g51
    s_waitcnt vmcnt(7)
L_g51:
    buffer_load_dwordx4 v24, s[24:27], s59 offen offset:2048 nt lds
    s_cmp_eq_u32 s0, 0
    s_cbranch_scc0 L_g52
    s_waitcnt vmcnt(7)
L_g52:
    buffer_load_dwordx4 v25, s[24:27], s59 offen offset:3072 nt lds
    buffer_load_dwordx4 v[164:167], v65, s[72:75], s61 offen offset:1024 sc1
    s_cmp_eq_u32 s0, 0
    s_cbranch_scc0 L_g53
    s_waitcnt vmcnt(8)
L_g53:
    s_add_u32 m0, s42, 4096
    s_nop 0
    buffer_load_dwordx4 v26, s[24:27], s59 offen offset:0 nt lds
    s_cmp_eq_u32 s0, 0
    s_cbranch_scc0 L_g54
    s_waitcnt vmcnt(8)
L_g54:
    buffer_load_dwordx4 v27, s[24:27], s59 offen offset:1024 nt lds
    s_cmp_eq_u32 s0, 0
    s_cbranch_scc0 L_g55
    s_waitcnt vmcnt(8)
L_g55:
    buffer_load_dwordx4 v28, s[24:27], s59 offen offset:2048 nt lds
    buffer_load_dwordx4 v[168:171], v65, s[72:75], s61 offen offset:2048 sc1
    s_cmp_eq_u32 s0, 0
    s_cbranch_scc0 L_g56
    s_waitcnt vmcnt(9)
L_g56:
    buffer_load_dwordx4 v29, s[24:27], s59 offen offset:3072 nt lds
    s_waitcnt vmcnt(11)
    s_barrier
    ds_read_b128 a[96:99], v40 offset:0
    ds_read_b128 a[100:103], v41 offset:0
    ds_read_b128 a[104:107], v42 offset:0
    ds_read_b128 a[108:111], v43 offset:0
    ds_read_b128 a[112:115], v40 offset:256
    ds_read_b128 a[116:119], v41 offset:256
    ds_read_b128 a[120:123], v42 offset:256
    ds_read_b128 a[124:127], v43 offset:256
    ds_read_b128 a[128:131], v40 offset:512
    ds_read_b128 a[132:135], v41 offset:512
    ds_read_b128 a[136:139], v42 offset:512
    ds_read_b128 a[140:143], v43 offset:512
    s_waitcnt lgkmcnt(11)
    v_mfma_f32_16x16x32_bf16 v[96:99], a[96:99], a[96:99], v[84:87]
    ds_read_b64_tr_b16 a[144:145], v44 offset:0
    ds_read_b64_tr_b16 a[146:147], v45 offset:0
    v_mfma_f32_16x16x32_bf16 v[100:103], a[96:99], a[48:51], 0
    ds_read_b64_tr_b16 a[148:149], v44 offset:12288
    ds_read_b64_tr_b16 a[150:151], v45 offset:12288
    s_waitcnt lgkmcnt(14)
    v_mfma_f32_16x16x32_bf16 v[96:99], a[100:103], a[100:103], v[96:99]
    ds_read_b64_tr_b16 a[152:153], v44 offset:24576
    ds_read_b64_tr_b16 a[154:155], v45 offset:24576
    v_mfma_f32_16x16x32_bf16 v[100:103], a[100:103], a[52:55], v[100:103]
    ds_read_b64_tr_b16 a[156:157], v44 offset:36864
    ds_read_b64_tr_b16 a[158:159], v45 offset:36864
    s_waitcnt lgkmcnt(15)
    v_mfma_f32_16x16x32_bf16 v[96:99], a[104:107], a[104:107], v[96:99]
    ds_read_b64_tr_b16 a[160:161], v46 offset:0
    ds_read_b64_tr_b16 a[162:163], v47 offset:0
    v_mfma_f32_16x16x32_bf16 v[100:103], a[104:107], a[56:59], v[100:103]
    ds_read_b64_tr_b16 a[164:165], v46 offset:12288
    ds_read_b64_tr_b16 a[166:167], v47 offset:12288
    v_mfma_f32_16x16x32_bf16 v[96:99], a[108:111], a[108:111], v[96:99]
    s_cmp_eq_u32 s0, 0
    s_cbranch_scc0 L_g57
    s_waitcnt vmcnt(9)
L_g57:
    s_add_u32 m0, s42, 8192
    s_nop 0
    buffer_load_dwordx4 v30, s[24:27], s59 offen offset:0 nt lds
    ds_read_b64_tr_b16 a[168:169], v46 offset:24576
    ds_read_b64_tr_b16 a[170:171], v47 offset:24576
    v_mfma_f32_16x16x32_bf16 v[100:103], a[108:111], a[60:63], v[100:103]
    ds_read_b64_tr_b16 a[172:173], v46 offset:36864
    ds_read_b64_tr_b16 a[174:175], v47 offset:36864
    v_mfma_f32_16x16x32_bf16 v[96:99], a[112:115], a[112:115], v[96:99]
    ds_read_b64_tr_b16 a[176:177], v48 offset:0
    ds_read_b64_tr_b16 a[178:179], v49 offset:0
    v_mfma_f32_16x16x32_bf16 v[100:103], a[112:115], a[64:67], v[100:103]
    ds_read_b64_tr_b16 a[180:181], v48 offset:12288
    ds_read_b64_tr_b16 a[182:183], v49 offset:12288
    s_waitcnt lgkmcnt(15)
    v_mfma_f32_16x16x32_bf16 v[96:99], a[116:119], a[116:119], v[96:99]
    ds_read_b64_tr_b16 a[184:185], v48 offset:24576
    ds_read_b64_tr_b16 a[186:187], v49 offset:24576
    v_mfma_f32_16x16x32_bf16 v[100:103], a[116:119], a[68:71], v[100:103]
    ds_read_b64_tr_b16 a[188:189], v48 offset:36864
    ds_read_b64_tr_b16 a[190:191], v49 offset:36864
    v_mfma_f32_16x16x32_bf16 v[92:95], a[96:99], v[52:55], v[80:83]
    v_mfma_f32_16x16x32_bf16 v[92:95], a[100:103], v[52:55], v[92:95]
    v_mfma_f32_16x16x32_bf16 v[92:95], a[104:107], v[52:55], v[92:95]
    v_mfma_f32_16x16x32_bf16 v[92:95], a[108:111], v[52:55], v[92:95]
    s_nop 1
    v_fma_f32 v96, v100, 2.0, v96
    v_fma_f32 v97, v101, 2.0, v97
    v_mfma_f32_16x16x32_bf16 v[92:95], a[112:115], v[52:55], v[92:95]
    v_fma_f32 v98, v102, 2.0, v98
    v_fma_f32 v99, v103, 2.0, v99
    v_mfma_f32_16x16x32_bf16 v[92:95], a[116:119], v[52:55], v[92:95]
    v_cndmask_b32 v3, 0, v96, s[44:45]
    v_cndmask_b32 v3, v3, v97, s[46:47]
    v_mfma_f32_16x16x32_bf16 v[88:91], a[96:99], v[136:139], v[76:79]
    buffer_load_dwordx4 v[172:175], v65, s[72:75], s61 offen offset:3072 sc1
    v_cndmask_b32 v3, v3, v98, s[48:49]
    v_cndmask_b32 v3, v3, v99, s[50:51]
    v_mfma_f32_16x16x32_bf16 v[88:91], a[100:103], v[140:143], v[88:91]
    s_cmp_eq_u32 s0, 0
    s_cbranch_scc0 L_g58
    s_waitcnt vmcnt(9)
L_g58:
    buffer_load_dwordx4 v31, s[24:27], s59 offen offset:1024 nt lds
    s_nop 0
    s_nop 0
    v_mfma_f32_16x16x32_bf16 v[88:91], a[104:107], v[144:147], v[88:91]
    v_mfma_f32_16x16x4_f32 v[120:123], v3, v60, v[56:59]
    v_mfma_f32_16x16x32_bf16 v[88:91], a[108:111], v[148:151], v[88:91]
    v_mfma_f32_16x16x32_bf16 v[88:91], a[112:115], v[152:155], v[88:91]
    v_mfma_f32_16x16x32_bf16 v[88:91], a[116:119], v[156:159], v[88:91]
    v_mfma_f32_16x16x32_bf16 v[112:115], a[120:123], a[120:123], v[84:87]
    v_mfma_f32_16x16x32_bf16 v[116:119], a[120:123], a[48:51], 0
    v_mfma_f32_16x16x32_bf16 v[112:115], a[124:127], a[124:127], v[112:115]
    v_mfma_f32_16x16x32_bf16 v[116:119], a[124:127], a[52:55], v[116:119]
    s_nop 2
    v_fma_f32 v128, -v92, v92, v120
    v_fma_f32 v129, -v93, v93, v121
    v_mfma_f32_16x16x32_bf16 v[112:115], a[128:131], a[128:131], v[112:115]
    s_cmp_eq_u32 s0, 0
    s_cbranch_scc0 L_g59
    s_waitcnt vmcnt(9)
L_g59:
    buffer_load_dwordx4 v32, s[24:27], s59 offen offset:2048 nt lds
    v_fma_f32 v130, -v94, v94, v122
    v_fma_f32 v131, -v95, v95, v123
    v_mfma_f32_16x16x32_bf16 v[116:119], a[128:131], a[56:59], v[116:119]
    v_max_f32 v128, v128, v56
    v_max_f32 v129, v129, v56
    v_mfma_f32_16x16x32_bf16 v[112:115], a[132:135], a[132:135], v[112:115]
    v_max_f32 v130, v130, v56
    v_max_f32 v131, v131, v56
    v_mfma_f32_16x16x32_bf16 v[116:119], a[132:135], a[60:63], v[116:119]
    v_rsq_f32 v128, v128
    v_mfma_f32_16x16x32_bf16 v[112:115], a[136:139], a[136:139], v[112:115]
    v_rsq_f32 v129, v129
    v_mfma_f32_16x16x32_bf16 v[116:119], a[136:139], a[64:67], v[116:119]
    v_rsq_f32 v130, v130
    v_mfma_f32_16x16x32_bf16 v[112:115], a[140:143], a[140:143], v[112:115]
    v_rsq_f32 v131, v131
    v_mfma_f32_16x16x32_bf16 v[116:119], a[140:143], a[68:71], v[116:119]
    v_fma_f32 v88, -v92, v61, v88
    v_fma_f32 v89, -v93, v61, v89
    v_mfma_f32_16x16x32_bf16 v[108:111], a[120:123], v[52:55], v[80:83]
    v_fma_f32 v90, -v94, v61, v90
    v_fma_f32 v91, -v95, v61, v91
    v_mfma_f32_16x16x32_bf16 v[108:111], a[124:127], v[52:55], v[108:111]
    v_fma_f32 v88, v88, v128, v62
    v_fma_f32 v89, v89, v129, v62
    v_mfma_f32_16x16x32_bf16 v[108:111], a[128:131], v[52:55], v[108:111]
    v_fma_f32 v90, v90, v130, v62
    v_fma_f32 v91, v91, v131, v62
    v_mfma_f32_16x16x32_bf16 v[108:111], a[132:135], v[52:55], v[108:111]
    v_max3_f32 v1, v88, v89, v90
    v_max_f32 v1, v1, v91
    v_mfma_f32_16x16x32_bf16 v[108:111], a[136:139], v[52:55], v[108:111]
    buffer_load_dwordx4 v33, s[24:27], s59 offen offset:3072 nt lds
    v_cmp_lt_f32 vcc, s52, v1
    s_cbranch_vccnz L_site6
L_back6:
    v_mfma_f32_16x16x32_bf16 v[108:111], a[140:143], v[52:55], v[108:111]
    s_add_u32 s61, s60, 3149824
    buffer_load_dwordx4 v[176:179], v65, s[72:75], s61 offen offset:0 sc1
    v_exp_f32 v96, v88
    v_mfma_f32_16x16x32_bf16 v[104:107], a[120:123], v[136:139], v[76:79]
    v_exp_f32 v97, v89
    v_mfma_f32_16x16x32_bf16 v[104:107], a[124:127], v[140:143], v[104:107]
    v_exp_f32 v98, v90
    v_mfma_f32_16x16x32_bf16 v[104:107], a[128:131], v[144:147], v[104:107]
    v_exp_f32 v99, v91
    v_mfma_f32_16x16x32_bf16 v[104:107], a[132:135], v[148:151], v[104:107]
    v_mul_f32 v88, v96, v128
    v_mul_f32 v89, v97, v129
    v_mfma_f32_16x16x32_bf16 v[104:107], a[136:139], v[152:155], v[104:107]
    v_mul_f32 v90, v98, v130
    v_mul_f32 v91, v99, v131
    v_mfma_f32_16x16x32_bf16 v[104:107], a[140:143], v[156:159], v[104:107]
    v_fma_f32 v112, v116, 2.0, v112
    v_fma_f32 v113, v117, 2.0, v113
    v_fma_f32 v114, v118, 2.0, v114
    v_fma_f32 v115, v119, 2.0, v115
    v_cndmask_b32 v4, 0, v112, s[44:45]
    v_cndmask_b32 v4, v4, v113, s[46:47]
    v_cndmask_b32 v4, v4, v114, s[48:49]
    v_cndmask_b32 v4, v4, v115, s[50:51]
    v_add_f32 v63, v63, v96
    v_fmac_f32 v64, v88, v92
    v_mfma_f32_16x16x4_f32 v[124:127], v4, v60, v[56:59]
    v_add_f32 v63, v63, v97
    v_fmac_f32 v64, v89, v93
    v_add_f32 v63, v63, v98
    v_fmac_f32 v64, v90, v94
    v_add_f32 v63, v63, v99
    v_fmac_f32 v64, v91, v95
    v_mov_b32 v68, v88
    v_mov_b32 v69, v89
    v_mov_b32 v70, v90
    v_mov_b32 v71, v91
    v_add_u32 v44, 49152, v44
    v_add_u32 v45, 49152, v45
    v_add_u32 v46, 49152, v46
    v_add_u32 v47, 49152, v47
    v_add_u32 v48, 49152, v48
    v_add_u32 v49, 49152, v49
    v_fma_f32 v132, -v108, v108, v124
    v_fma_f32 v133, -v109, v109, v125
    v_fma_f32 v134, -v110, v110, v126
    v_fma_f32 v135, -v111, v111, v127
    v_max_f32 v132, v132, v56
    v_max_f32 v133, v133, v56
    v_max_f32 v134, v134, v56
    v_max_f32 v135, v135, v56
    v_rsq_f32 v132, v132
    v_rsq_f32 v133, v133
    v_rsq_f32 v134, v134
    v_rsq_f32 v135, v135
    s_add_u32 m0, s40, 0
    s_add_u32 s57, s36, 18874368
    buffer_load_dwordx4 v16, s[28:31], s57 offen offset:0 nt lds
    v_fma_f32 v104, -v108, v61, v104
    v_fma_f32 v105, -v109, v61, v105
    v_fma_f32 v106, -v110, v61, v106
    v_fma_f32 v107, -v111, v61, v107
    v_fma_f32 v104, v104, v132, v62
    v_fma_f32 v105, v105, v133, v62
    v_fma_f32 v106, v106, v134, v62
    v_fma_f32 v107, v107, v135, v62
    v_max3_f32 v1, v104, v105, v106
    v_max_f32 v1, v1, v107
    v_cmp_lt_f32 vcc, s52, v1
    s_cbranch_vccnz L_site7
L_back7:
    v_exp_f32 v112, v104
    v_exp_f32 v113, v105
    v_exp_f32 v114, v106
    v_exp_f32 v115, v107
    v_cvt_pk_bf16_f32 v72, v88, v89
    v_cvt_pk_bf16_f32 v73, v90, v91
    v_mul_f32 v104, v112, v132
    v_mul_f32 v105, v113, v133
    v_mul_f32 v106, v114, v134
    v_mul_f32 v107, v115, v135
    v_cvt_pk_bf16_f32 v74, v104, v105
    v_cvt_pk_bf16_f32 v75, v106, v107
    ds_write_b128 v237, v[72:75] offset:0
    s_waitcnt lgkmcnt(0)
    s_barrier
L_post27:
    ds_read_b32 v9, v254 offset:4096
    ds_read_b128 v[92:95], v253 offset:0
    ds_read_b128 v[96:99], v253 offset:1024
    ds_read_b128 v[100:103], v253 offset:2048
    ds_read_b128 v[116:119], v253 offset:3072
    s_waitcnt lgkmcnt(4)
    v_cmp_ne_u32 vcc, 0, v9
    s_cbranch_vccnz L_xt27
    s_waitcnt lgkmcnt(3)
    v_mfma_f32_16x16x32_bf16 a[0:3], a[144:147], v[92:95], a[0:3]
    buffer_load_dwordx4 v17, s[28:31], s57 offen offset:1024 nt lds
    v_add_f32 v68, v68, v104
    v_add_f32 v69, v69, v105
    v_mfma_f32_16x16x32_bf16 a[4:7], a[160:163], v[92:95], a[4:7]
    buffer_load_dwordx4 v[180:183], v65, s[72:75], s61 offen offset:1024 sc1
    v_add_f32 v70, v70, v106
    v_add_f32 v71, v71, v107
    v_mfma_f32_16x16x32_bf16 a[8:11], a[176:179], v[92:95], a[8:11]
    buffer_load_dwordx4 v18, s[28:31], s57 offen offset:2048 nt lds
    v_add_f32 v63, v63, v112
    v_fma_f32 v64, v104, v108, v64
    s_waitcnt lgkmcnt(2)
    v_mfma_f32_16x16x32_bf16 a[0:3], a[148:151], v[96:99], a[0:3]
    v_add_f32 v63, v63, v113
    v_fma_f32 v64, v105, v109, v64
    v_mfma_f32_16x16x32_bf16 a[4:7], a[164:167], v[96:99], a[4:7]
    v_add_f32 v63, v63, v114
    v_fma_f32 v64, v106, v110, v64
    v_mfma_f32_16x16x32_bf16 a[8:11], a[180:183], v[96:99], a[8:11]
    buffer_load_dwordx4 v19, s[28:31], s57 offen offset:3072 nt lds
    v_add_f32 v63, v63, v115
    v_fma_f32 v64, v107, v111, v64
    s_waitcnt lgkmcnt(1)
    v_mfma_f32_16x16x32_bf16 a[0:3], a[152:155], v[100:103], a[0:3]
    v_mfma_f32_16x16x32_bf16 a[4:7], a[168:171], v[100:103], a[4:7]
    v_mfma_f32_16x16x32_bf16 a[8:11], a[184:187], v[100:103], a[8:11]
    s_waitcnt lgkmcnt(0)
    v_mfma_f32_16x16x32_bf16 a[0:3], a[156:159], v[116:119], a[0:3]
    v_mfma_f32_16x16x32_bf16 a[4:7], a[172:175], v[116:119], a[4:7]
    v_mfma_f32_16x16x32_bf16 a[8:11], a[188:191], v[116:119], a[8:11]
    s_add_u32 m0, s40, 4096
    s_nop 0
    buffer_load_dwordx4 v20, s[28:31], s57 offen offset:0 nt lds
    buffer_load_dwordx4 v[184:187], v65, s[72:75], s61 offen offset:2048 sc1
    buffer_load_dwordx4 v21, s[28:31], s57 offen offset:1024 nt lds
    s_add_u32 m0, s41, 0
    s_add_u32 s58, s37, 75497472
    buffer_load_dwordx4 v224, s[24:27], s58 offen offset:0 nt lds
    buffer_load_dwordx4 v[188:191], v65, s[72:75], s61 offen offset:3072 sc1
    s_waitcnt vmcnt(11)
    s_barrier
    ds_read_b128 a[96:99], v40 offset:49152
    ds_read_b128 a[100:103], v41 offset:49152
    ds_read_b128 a[104:107], v42 offset:49152
    ds_read_b128 a[108:111], v43 offset:49152
    ds_read_b128 a[112:115], v40 offset:49408
    ds_read_b128 a[116:119], v41 offset:49408
    ds_read_b128 a[120:123], v42 offset:49408
    ds_read_b128 a[124:127], v43 offset:49408
    ds_read_b128 a[128:131], v40 offset:49664
    ds_read_b128 a[132:135], v41 offset:49664
    ds_read_b128 a[136:139], v42 offset:49664
    ds_read_b128 a[140:143], v43 offset:49664
    s_waitcnt lgkmcnt(11)
    v_mfma_f32_16x16x32_bf16 v[96:99], a[96:99], a[96:99], v[84:87]
    buffer_load_dwordx4 v225, s[24:27], s58 offen offset:1024 nt lds
    ds_read_b64_tr_b16 a[144:145], v44 offset:0
    ds_read_b64_tr_b16 a[146:147], v45 offset:0
    v_mfma_f32_16x16x32_bf16 v[100:103], a[96:99], a[48:51], 0
    ds_read_b64_tr_b16 a[148:149], v44 offset:12288
    ds_read_b64_tr_b16 a[150:151], v45 offset:12288
    s_waitcnt lgkmcnt(14)
    v_mfma_f32_16x16x32_bf16 v[96:99], a[100:103], a[100:103], v[96:99]
    ds_read_b64_tr_b16 a[152:153], v44 offset:24576
    ds_read_b64_tr_b16 a[154:155], v45 offset:24576
    v_mfma_f32_16x16x32_bf16 v[100:103], a[100:103], a[52:55], v[100:103]
    ds_read_b64_tr_b16 a[156:157], v44 offset:36864
    ds_read_b64_tr_b16 a[158:159], v45 offset:36864
    s_waitcnt lgkmcnt(15)
    v_mfma_f32_16x16x32_bf16 v[96:99], a[104:107], a[104:107], v[96:99]
    ds_read_b64_tr_b16 a[160:161], v46 offset:0
    ds_read_b64_tr_b16 a[162:163], v47 offset:0
    v_mfma_f32_16x16x32_bf16 v[100:103], a[104:107], a[56:59], v[100:103]
    s_add_u32 m0, s41, 2048
    s_add_u32 s58, s37, 75497600
    buffer_load_dwordx4 v224, s[24:27], s58 offen offset:0 nt lds
    ds_read_b64_tr_b16 a[164:165], v46 offset:12288
    ds_read_b64_tr_b16 a[166:167], v47 offset:12288
    v_mfma_f32_16x16x32_bf16 v[96:99], a[108:111], a[108:111], v[96:99]
    ds_read_b64_tr_b16 a[168:169], v46 offset:24576
    ds_read_b64_tr_b16 a[170:171], v47 offset:24576
    v_mfma_f32_16x16x32_bf16 v[100:103], a[108:111], a[60:63], v[100:103]
    ds_read_b64_tr_b16 a[172:173], v46 offset:36864
    ds_read_b64_tr_b16 a[174:175], v47 offset:36864
    v_mfma_f32_16x16x32_bf16 v[96:99], a[112:115], a[112:115], v[96:99]
    ds_read_b64_tr_b16 a[176:177], v48 offset:0
    ds_read_b64_tr_b16 a[178:179], v49 offset:0
    v_mfma_f32_16x16x32_bf16 v[100:103], a[112:115], a[64:67], v[100:103]
    ds_read_b64_tr_b16 a[180:181], v48 offset:12288
    ds_read_b64_tr_b16 a[182:183], v49 offset:12288
    s_waitcnt lgkmcnt(15)
    v_mfma_f32_16x16x32_bf16 v[96:99], a[116:119], a[116:119], v[96:99]
    ds_read_b64_tr_b16 a[184:185], v48 offset:24576
    ds_read_b64_tr_b16 a[186:187], v49 offset:24576
    v_mfma_f32_16x16x32_bf16 v[100:103], a[116:119], a[68:71], v[100:103]
    ds_read_b64_tr_b16 a[188:189], v48 offset:36864
    ds_read_b64_tr_b16 a[190:191], v49 offset:36864
    v_mfma_f32_16x16x32_bf16 v[92:95], a[96:99], v[52:55], v[80:83]
    v_mfma_f32_16x16x32_bf16 v[92:95], a[100:103], v[52:55], v[92:95]
    v_mfma_f32_16x16x32_bf16 v[92:95], a[104:107], v[52:55], v[92:95]
    v_mfma_f32_16x16x32_bf16 v[92:95], a[108:111], v[52:55], v[92:95]
    s_nop 1
    v_fma_f32 v96, v100, 2.0, v96
    v_fma_f32 v97, v101, 2.0, v97
    v_mfma_f32_16x16x32_bf16 v[92:95], a[112:115], v[52:55], v[92:95]
    buffer_load_dwordx4 v225, s[24:27], s58 offen offset:1024 nt lds
    v_fma_f32 v98, v102, 2.0, v98
    v_fma_f32 v99, v103, 2.0, v99
    v_mfma_f32_16x16x32_bf16 v[92:95], a[116:119], v[52:55], v[92:95]
    s_add_u32 s61, s60, 3153920
    buffer_load_dwordx4 v[192:195], v65, s[32:35], s61 offen offset:0 sc1
    v_cndmask_b32 v3, 0, v96, s[44:45]
    v_cndmask_b32 v3, v3, v97, s[46:47]
    v_mfma_f32_16x16x32_bf16 v[88:91], a[96:99], v[136:139], v[76:79]
    v_cndmask_b32 v3, v3, v98, s[48:49]
    v_cndmask_b32 v3, v3, v99, s[50:51]
    v_mfma_f32_16x16x32_bf16 v[88:91], a[100:103], v[140:143], v[88:91]
    s_nop 0
    s_nop 0
    v_mfma_f32_16x16x32_bf16 v[88:91], a[104:107], v[144:147], v[88:91]
    v_mfma_f32_16x16x4_f32 v[120:123], v3, v60, v[56:59]
    v_mfma_f32_16x16x32_bf16 v[88:91], a[108:111], v[148:151], v[88:91]
    v_mfma_f32_16x16x32_bf16 v[88:91], a[112:115], v[152:155], v[88:91]
    v_mfma_f32_16x16x32_bf16 v[88:91], a[116:119], v[156:159], v[88:91]
    v_mfma_f32_16x16x32_bf16 v[112:115], a[120:123], a[120:123], v[84:87]
    v_mfma_f32_16x16x32_bf16 v[116:119], a[120:123], a[48:51], 0
    v_mfma_f32_16x16x32_bf16 v[112:115], a[124:127], a[124:127], v[112:115]
    s_add_u32 m0, s41, 4096
    s_add_u32 s58, s37, 75497728
    buffer_load_dwordx4 v224, s[24:27], s58 offen offset:0 nt lds
    v_mfma_f32_16x16x32_bf16 v[116:119], a[124:127], a[52:55], v[116:119]
    v_fma_f32 v128, -v92, v92, v120
    v_fma_f32 v129, -v93, v93, v121
    v_mfma_f32_16x16x32_bf16 v[112:115], a[128:131], a[128:131], v[112:115]
    v_fma_f32 v130, -v94, v94, v122
    v_fma_f32 v131, -v95, v95, v123
    v_mfma_f32_16x16x32_bf16 v[116:119], a[128:131], a[56:59], v[116:119]
    v_max_f32 v128, v128, v56
    v_max_f32 v129, v129, v56
    v_mfma_f32_16x16x32_bf16 v[112:115], a[132:135], a[132:135], v[112:115]
    v_max_f32 v130, v130, v56
    v_max_f32 v131, v131, v56
    v_mfma_f32_16x16x32_bf16 v[116:119], a[132:135], a[60:63], v[116:119]
    v_rsq_f32 v128, v128
    v_mfma_f32_16x16x32_bf16 v[112:115], a[136:139], a[136:139], v[112:115]
    v_rsq_f32 v129, v129
    v_mfma_f32_16x16x32_bf16 v[116:119], a[136:139], a[64:67], v[116:119]
    v_rsq_f32 v130, v130
    v_mfma_f32_16x16x32_bf16 v[112:115], a[140:143], a[140:143], v[112:115]
    v_rsq_f32 v131, v131
    v_mfma_f32_16x16x32_bf16 v[116:119], a[140:143], a[68:71], v[116:119]
    v_fma_f32 v88, -v92, v61, v88
    v_fma_f32 v89, -v93, v61, v89
    v_mfma_f32_16x16x32_bf16 v[108:111], a[120:123], v[52:55], v[80:83]
    v_fma_f32 v90, -v94, v61, v90
    v_fma_f32 v91, -v95, v61, v91
    v_mfma_f32_16x16x32_bf16 v[108:111], a[124:127], v[52:55], v[108:111]
    v_fma_f32 v88, v88, v128, v62
    v_fma_f32 v89, v89, v129, v62
    v_mfma_f32_16x16x32_bf16 v[108:111], a[128:131], v[52:55], v[108:111]
    v_fma_f32 v90, v90, v130, v62
    v_fma_f32 v91, v91, v131, v62
    v_mfma_f32_16x16x32_bf16 v[108:111], a[132:135], v[52:55], v[108:111]
    buffer_load_dwordx4 v225, s[24:27], s58 offen offset:1024 nt lds
    v_max3_f32 v1, v88, v89, v90
    v_max_f32 v1, v1, v91
    v_mfma_f32_16x16x32_bf16 v[108:111], a[136:139], v[52:55], v[108:111]
    v_cmp_lt_f32 vcc, s52, v1
    s_cbranch_vccnz L_site8
L_back8:
    v_mfma_f32_16x16x32_bf16 v[108:111], a[140:143], v[52:55], v[108:111]
    v_exp_f32 v96, v88
    v_mfma_f32_16x16x32_bf16 v[104:107], a[120:123], v[136:139], v[76:79]
    v_exp_f32 v97, v89
    v_mfma_f32_16x16x32_bf16 v[104:107], a[124:127], v[140:143], v[104:107]
    v_exp_f32 v98, v90
    v_mfma_f32_16x16x32_bf16 v[104:107], a[128:131], v[144:147], v[104:107]
    v_exp_f32 v99, v91
    v_mfma_f32_16x16x32_bf16 v[104:107], a[132:135], v[148:151], v[104:107]
    v_mul_f32 v88, v96, v128
    v_mul_f32 v89, v97, v129
    v_mfma_f32_16x16x32_bf16 v[104:107], a[136:139], v[152:155], v[104:107]
    v_mul_f32 v90, v98, v130
    v_mul_f32 v91, v99, v131
    v_mfma_f32_16x16x32_bf16 v[104:107], a[140:143], v[156:159], v[104:107]
    v_fma_f32 v112, v116, 2.0, v112
    v_fma_f32 v113, v117, 2.0, v113
    v_fma_f32 v114, v118, 2.0, v114
    v_fma_f32 v115, v119, 2.0, v115
    v_cndmask_b32 v4, 0, v112, s[44:45]
    v_cndmask_b32 v4, v4, v113, s[46:47]
    v_cndmask_b32 v4, v4, v114, s[48:49]
    v_cndmask_b32 v4, v4, v115, s[50:51]
    v_add_f32 v63, v63, v96
    v_fmac_f32 v64, v88, v92
    v_mfma_f32_16x16x4_f32 v[124:127], v4, v60, v[56:59]
    v_add_f32 v63, v63, v97
    v_fmac_f32 v64, v89, v93
    v_add_f32 v63, v63, v98
    v_fmac_f32 v64, v90, v94
    v_add_f32 v63, v63, v99
    v_fmac_f32 v64, v91, v95
    v_add_f32 v68, v68, v88
    v_add_f32 v69, v69, v89
    v_add_f32 v70, v70, v90
    v_add_f32 v71, v71, v91
    v_add_u32 v44, -49152, v44
    v_add_u32 v45, -49152, v45
    v_add_u32 v46, -49152, v46
    v_add_u32 v47, -49152, v47
    v_add_u32 v48, -49152, v48
    v_add_u32 v49, -49152, v49
    v_fma_f32 v132, -v108, v108, v124
    v_fma_f32 v133, -v109, v109, v125
    v_fma_f32 v134, -v110, v110, v126
    v_fma_f32 v135, -v111, v111, v127
    v_max_f32 v132, v132, v56
    v_max_f32 v133, v133, v56
    v_max_f32 v134, v134, v56
    v_max_f32 v135, v135, v56
    v_rsq_f32 v132, v132
    v_rsq_f32 v133, v133
    v_rsq_f32 v134, v134
    v_rsq_f32 v135, v135
    buffer_load_dwordx4 v[196:199], v65, s[32:35], s61 offen offset:1024 sc1
    v_fma_f32 v104, -v108, v61, v104
    v_fma_f32 v105, -v109, v61, v105
    v_fma_f32 v106, -v110, v61, v106
    v_fma_f32 v107, -v111, v61, v107
    v_fma_f32 v104, v104, v132, v62
    v_fma_f32 v105, v105, v133, v62
    v_fma_f32 v106, v106, v134, v62
    v_fma_f32 v107, v107, v135, v62
    v_max3_f32 v1, v104, v105, v106
    v_max_f32 v1, v1, v107
    v_cmp_lt_f32 vcc, s52, v1
    s_cbranch_vccnz L_site9
L_back9:
    s_add_u32 m0, s41, 6144
    s_add_u32 s58, s37, 75497856
    buffer_load_dwordx4 v224, s[24:27], s58 offen offset:0 nt lds
    v_exp_f32 v112, v104
    v_exp_f32 v113, v105
    v_exp_f32 v114, v106
    v_exp_f32 v115, v107
    v_cvt_pk_bf16_f32 v72, v88, v89
    v_cvt_pk_bf16_f32 v73, v90, v91
    v_mul_f32 v104, v112, v132
    v_mul_f32 v105, v113, v133
    v_mul_f32 v106, v114, v134
    v_mul_f32 v107, v115, v135
    v_cvt_pk_bf16_f32 v74, v104, v105
    v_cvt_pk_bf16_f32 v75, v106, v107
    ds_write_b128 v237, v[72:75] offset:0
    v_add_f32 v68, v68, v104
    v_add_f32 v69, v69, v105
    v_add_f32 v70, v70, v106
    v_add_f32 v71, v71, v107
    v_cvt_pk_bf16_f32 v66, v68, v69
    v_cvt_pk_bf16_f32 v67, v70, v71
    ds_write_b64 v238, v[66:67]
    s_lshl_b32 s56, s3, 13
    v_lshl_add_u32 v233, v0, 7, s56
    v_min_u32 v233, L_hot - L_tail, v233
    v_add_u32 v233, L_tail - L_pc_main, v233
    global_load_dword v234, v233, s[100:101]
    s_waitcnt vmcnt(11)
    s_waitcnt lgkmcnt(0)
    s_barrier
L_post9:
    ds_read_b32 v9, v254 offset:4096
    ds_read_b64 v[120:121], v254 offset:0
    ds_read_b64 v[122:123], v254 offset:512
    ds_read_b64 v[124:125], v254 offset:1024
    ds_read_b64 v[126:127], v254 offset:1536
    ds_read_b128 v[92:95], v253 offset:0
    ds_read_b128 v[96:99], v253 offset:1024
    ds_read_b128 v[100:103], v253 offset:2048
    ds_read_b128 v[116:119], v253 offset:3072
    ds_read_b128 a[48:51], v34 offset:0
    ds_read_b128 a[52:55], v35 offset:0
    ds_read_b128 a[56:59], v34 offset:128
    ds_read_b128 a[60:63], v35 offset:128
    ds_read_b128 a[64:67], v34 offset:256
    ds_read_b128 a[68:71], v35 offset:256
    s_waitcnt lgkmcnt(14)
    v_cmp_ne_u32 vcc, 0, v9
    s_cbranch_vccnz L_xt9
    s_waitcnt lgkmcnt(12)
    v_mfma_f32_16x16x32_bf16 a[0:3], a[72:75], v[120:123], a[0:3]
    buffer_load_dwordx4 v225, s[24:27], s58 offen offset:1024 nt lds
    v_add_f32 v63, v63, v112
    v_fma_f32 v64, v104, v108, v64
    v_mfma_f32_16x16x32_bf16 a[4:7], a[80:83], v[120:123], a[4:7]
    s_add_u32 m0, s41, 8192
    s_add_u32 s58, s37, 75497984
    buffer_load_dwordx4 v224, s[24:27], s58 offen offset:0 nt lds
    v_add_f32 v63, v63, v113
    v_fma_f32 v64, v105, v109, v64
    v_mfma_f32_16x16x32_bf16 a[8:11], a[88:91], v[120:123], a[8:11]
    v_add_f32 v63, v63, v114
    v_fma_f32 v64, v106, v110, v64
    s_waitcnt lgkmcnt(10)
    v_mfma_f32_16x16x32_bf16 a[0:3], a[76:79], v[124:127], a[0:3]
    v_add_f32 v63, v63, v115
    v_fma_f32 v64, v107, v111, v64
    v_mfma_f32_16x16x32_bf16 a[4:7], a[84:87], v[124:127], a[4:7]
    v_mfma_f32_16x16x32_bf16 a[8:11], a[92:95], v[124:127], a[8:11]
    buffer_load_dwordx4 v[200:203], v65, s[32:35], s61 offen offset:2048 sc1
    s_waitcnt lgkmcnt(9)
    v_mfma_f32_16x16x32_bf16 a[0:3], a[144:147], v[92:95], a[0:3]
    ds_read_b64_tr_b16 a[72:73], v36 offset:0
    ds_read_b64_tr_b16 a[74:75], v36 offset:6144
    v_mfma_f32_16x16x32_bf16 a[4:7], a[160:163], v[92:95], a[4:7]
    ds_read_b64_tr_b16 a[76:77], v36 offset:12288
    ds_read_b64_tr_b16 a[78:79], v36 offset:18432
    v_mfma_f32_16x16x32_bf16 a[8:11], a[176:179], v[92:95], a[8:11]
    ds_read_b64_tr_b16 a[80:81], v37 offset:0
    ds_read_b64_tr_b16 a[82:83], v37 offset:6144
    s_waitcnt lgkmcnt(14)
    v_mfma_f32_16x16x32_bf16 a[0:3], a[148:151], v[96:99], a[0:3]
    ds_read_b64_tr_b16 a[84:85], v37 offset:12288
    ds_read_b64_tr_b16 a[86:87], v37 offset:18432
    v_mfma_f32_16x16x32_bf16 a[4:7], a[164:167], v[96:99], a[4:7]
    ds_read_b64_tr_b16 a[88:89], v38 offset:0
    ds_read_b64_tr_b16 a[90:91], v38 offset:6144
    v_mfma_f32_16x16x32_bf16 a[8:11], a[180:183], v[96:99], a[8:11]
    ds_read_b64_tr_b16 a[92:93], v38 offset:12288
    ds_read_b64_tr_b16 a[94:95], v38 offset:18432
    s_waitcnt lgkmcnt(15)
    v_mfma_f32_16x16x32_bf16 a[0:3], a[152:155], v[100:103], a[0:3]
    v_mfma_f32_16x16x32_bf16 a[4:7], a[168:171], v[100:103], a[4:7]
    v_mfma_f32_16x16x32_bf16 a[8:11], a[184:187], v[100:103], a[8:11]
    v_mfma_f32_16x16x32_bf16 a[0:3], a[156:159], v[116:119], a[0:3]
    v_mfma_f32_16x16x32_bf16 a[4:7], a[172:175], v[116:119], a[4:7]
    v_mfma_f32_16x16x32_bf16 a[8:11], a[188:191], v[116:119], a[8:11]
    buffer_load_dwordx4 v225, s[24:27], s58 offen offset:1024 nt lds
    v_mfma_f32_16x16x32_bf16 v[84:87], a[48:51], a[48:51], 0
    v_mfma_f32_16x16x32_bf16 v[80:83], a[48:51], v[52:55], 0
    v_mfma_f32_16x16x32_bf16 v[84:87], a[52:55], a[52:55], v[84:87]
    v_mfma_f32_16x16x32_bf16 v[80:83], a[52:55], v[52:55], v[80:83]
    v_mfma_f32_16x16x32_bf16 v[84:87], a[56:59], a[56:59], v[84:87]
    v_mfma_f32_16x16x32_bf16 v[80:83], a[56:59], v[52:55], v[80:83]
    s_waitcnt lgkmcnt(14)
    v_mfma_f32_16x16x32_bf16 v[84:87], a[60:63], a[60:63], v[84:87]
    v_mfma_f32_16x16x32_bf16 v[80:83], a[60:63], v[52:55], v[80:83]
    s_waitcnt lgkmcnt(13)
    v_mfma_f32_16x16x32_bf16 v[84:87], a[64:67], a[64:67], v[84:87]
    v_mfma_f32_16x16x32_bf16 v[80:83], a[64:67], v[52:55], v[80:83]
    s_waitcnt lgkmcnt(12)
    v_mfma_f32_16x16x32_bf16 v[84:87], a[68:71], a[68:71], v[84:87]
    v_mfma_f32_16x16x32_bf16 v[80:83], a[68:71], v[52:55], v[80:83]
    s_waitcnt lgkmcnt(0)
    v_mfma_f32_16x16x32_bf16 v[76:79], a[48:51], v[136:139], 0
    v_mfma_f32_16x16x32_bf16 v[76:79], a[52:55], v[140:143], v[76:79]
    s_add_u32 m0, s41, 10240
    s_add_u32 s58, s37, 75498112
    buffer_load_dwordx4 v224, s[24:27], s58 offen offset:0 nt lds
    v_mfma_f32_16x16x32_bf16 v[76:79], a[56:59], v[144:147], v[76:79]
    buffer_load_dwordx4 v[204:207], v65, s[32:35], s61 offen offset:3072 sc1
    v_mfma_f32_16x16x32_bf16 v[76:79], a[60:63], v[148:151], v[76:79]
    v_mfma_f32_16x16x32_bf16 v[76:79], a[64:67], v[152:155], v[76:79]
    v_mfma_f32_16x16x32_bf16 v[76:79], a[68:71], v[156:159], v[76:79]
    s_mul_i32 s28, s3, 131072
    s_and_b32 s56, s2, 7
    s_lshl_b32 s56, s56, 10
    s_add_u32 s28, s28, s56
    s_bfe_u32 s56, s2, 0x30003
    s_lshl_b32 s56, s56, 7
    s_add_u32 s28, s28, s56
    s_lshr_b32 s56, s2, 6
    s_lshl_b32 s56, s56, 13
    s_add_u32 s28, s28, s56
    s_add_u32 s28, s28, 65536
    s_sub_u32 s29, s2, 64
    s_mul_i32 s30, s29, 32768
    s_lshl_b32 s56, s3, 13
    s_add_u32 s30, s30, s56
    s_add_u32 s30, s30, 65536
    s_add_u32 s31, s30, 4096
    v_mov_b32 v28, v242
    v_bfe_u32 v1, v0, 4, 1
    v_mul_u32_u24 v2, 32768, v1
    v_mul_u32_u24 v1, 0x70, v1
    v_xor_b32 v242, v242, v1
    v_sub_u32 v242, v242, v2
    v_add_u32 v243, 32768, v242
    v_mov_b32 v232, 0x53800000
    s_mov_b32 s43, 1
    s_mov_b32 s68, s18
    s_mov_b32 s69, s19
    s_mov_b32 s70, 6144
    s_mov_b32 s71, 0x20000
L_tail:
    v_and_b32 v1, 15, v0
    v_lshlrev_b32 v1, 8, v1
    v_sub_u32 v1, v34, v1
    v_lshrrev_b32 v2, 2, v0
    v_lshlrev_b32 v2, 8, v2
    s_sub_u32 s56, s41, s40
    v_add_u32 v40, s56, v1
    v_xor_b32 v41, 64, v40
    s_sub_u32 s56, s42, s40
    v_add_u32 v42, s56, v1
    v_xor_b32 v43, 64, v42
    s_mul_i32 s56, s3, 3
    s_add_u32 s57, s56, 0
    s_lshr_b32 s57, s57, 2
    s_mul_i32 s57, s57, 1920
    s_add_u32 s57, s57, 24576
    v_sub_u32 v44, v36, v2
    v_add_u32 v44, s57, v44
    v_add_u32 v47, 49152, v44
    s_add_u32 s57, s56, 1
    s_lshr_b32 s57, s57, 2
    s_mul_i32 s57, s57, 1920
    s_add_u32 s57, s57, 24576
    v_sub_u32 v45, v37, v2
    v_add_u32 v45, s57, v45
    v_add_u32 v48, 49152, v45
    s_add_u32 s57, s56, 2
    s_lshr_b32 s57, s57, 2
    s_mul_i32 s57, s57, 1920
    s_add_u32 s57, s57, 24576
    v_sub_u32 v46, v38, v2
    v_add_u32 v46, s57, v46
    v_add_u32 v49, 49152, v46
    v_accvgpr_read_b32 v16, a0
    v_accvgpr_read_b32 v17, a1
    v_accvgpr_read_b32 v18, a2
    v_accvgpr_read_b32 v19, a3
    v_accvgpr_read_b32 v20, a4
    v_accvgpr_read_b32 v21, a5
    v_accvgpr_read_b32 v22, a6
    v_accvgpr_read_b32 v23, a7
    v_accvgpr_read_b32 v24, a8
    v_accvgpr_read_b32 v25, a9
    v_accvgpr_read_b32 v26, a10
    v_accvgpr_read_b32 v27, a11
    buffer_load_dwordx4 v225, s[24:27], s58 offen offset:1024 nt lds
    s_add_u32 m0, s42, 0
    s_add_u32 s59, s37, 75694080
    buffer_load_dwordx4 v224, s[24:27], s59 offen offset:0 nt lds
    buffer_load_dwordx4 v225, s[24:27], s59 offen offset:1024 nt lds
    s_waitcnt vmcnt(12)
    s_barrier
    ds_read_b128 a[96:99], v40 offset:0
    ds_read_b128 a[100:103], v41 offset:0
    ds_read_b128 a[104:107], v40 offset:2048
    ds_read_b128 a[108:111], v41 offset:2048
    ds_read_b128 a[112:115], v40 offset:4096
    ds_read_b128 a[116:119], v41 offset:4096
    s_waitcnt lgkmcnt(5)
    v_mfma_f32_16x16x32_bf16 v[96:99], a[96:99], a[96:99], v[84:87]
    ds_read_b64_tr_b16 a[144:145], v44 offset:0
    ds_read_b64_tr_b16 a[148:149], v44 offset:12288
    v_mfma_f32_16x16x32_bf16 v[100:103], a[96:99], a[48:51], 0
    ds_read_b64_tr_b16 a[152:153], v44 offset:24576
    ds_read_b64_tr_b16 a[156:157], v44 offset:36864
    s_waitcnt lgkmcnt(8)
    v_mfma_f32_16x16x32_bf16 v[96:99], a[100:103], a[100:103], v[96:99]
    s_add_u32 m0, s42, 2048
    s_add_u32 s59, s37, 75694208
    buffer_load_dwordx4 v224, s[24:27], s59 offen offset:0 nt lds
    ds_read_b64_tr_b16 a[160:161], v45 offset:0
    ds_read_b64_tr_b16 a[164:165], v45 offset:12288
    v_mfma_f32_16x16x32_bf16 v[100:103], a[100:103], a[52:55], v[100:103]
    buffer_load_dwordx4 v225, s[24:27], s59 offen offset:1024 nt lds
    ds_read_b64_tr_b16 a[168:169], v45 offset:24576
    ds_read_b64_tr_b16 a[172:173], v45 offset:36864
    s_waitcnt lgkmcnt(11)
    v_mfma_f32_16x16x32_bf16 v[96:99], a[104:107], a[104:107], v[96:99]
    ds_read_b64_tr_b16 a[176:177], v46 offset:0
    ds_read_b64_tr_b16 a[180:181], v46 offset:12288
    v_mfma_f32_16x16x32_bf16 v[100:103], a[104:107], a[56:59], v[100:103]
    ds_read_b64_tr_b16 a[184:185], v46 offset:24576
    ds_read_b64_tr_b16 a[188:189], v46 offset:36864
    s_waitcnt lgkmcnt(14)
    v_mfma_f32_16x16x32_bf16 v[96:99], a[108:111], a[108:111], v[96:99]
    v_mfma_f32_16x16x32_bf16 v[100:103], a[108:111], a[60:63], v[100:103]
    s_waitcnt lgkmcnt(13)
    v_mfma_f32_16x16x32_bf16 v[96:99], a[112:115], a[112:115], v[96:99]
    v_mfma_f32_16x16x32_bf16 v[100:103], a[112:115], a[64:67], v[100:103]
    s_waitcnt lgkmcnt(12)
    v_mfma_f32_16x16x32_bf16 v[96:99], a[116:119], a[116:119], v[96:99]
    v_mfma_f32_16x16x32_bf16 v[100:103], a[116:119], a[68:71], v[100:103]
    v_mfma_f32_16x16x32_bf16 v[92:95], a[96:99], v[52:55], v[80:83]
    s_add_u32 m0, s42, 4096
    s_add_u32 s59, s37, 75694336
    buffer_load_dwordx4 v224, s[24:27], s59 offen offset:0 nt lds
    v_mfma_f32_16x16x32_bf16 v[92:95], a[100:103], v[52:55], v[92:95]
    v_mfma_f32_16x16x32_bf16 v[92:95], a[104:107], v[52:55], v[92:95]
    v_mfma_f32_16x16x32_bf16 v[92:95], a[108:111], v[52:55], v[92:95]
    s_nop 0
    v_fma_f32 v96, v100, 2.0, v96
    v_fma_f32 v97, v101, 2.0, v97
    v_mfma_f32_16x16x32_bf16 v[92:95], a[112:115], v[52:55], v[92:95]
    v_fma_f32 v98, v102, 2.0, v98
    v_fma_f32 v99, v103, 2.0, v99
    v_mfma_f32_16x16x32_bf16 v[92:95], a[116:119], v[52:55], v[92:95]
    v_cndmask_b32 v3, 0, v96, s[44:45]
    v_cndmask_b32 v3, v3, v97, s[46:47]
    v_mfma_f32_16x16x32_bf16 v[88:91], a[96:99], v[136:139], v[76:79]
    v_cndmask_b32 v3, v3, v98, s[48:49]
    v_cndmask_b32 v3, v3, v99, s[50:51]
    v_mfma_f32_16x16x32_bf16 v[88:91], a[100:103], v[140:143], v[88:91]
    s_nop 0
    s_nop 0
    v_mfma_f32_16x16x32_bf16 v[88:91], a[104:107], v[144:147], v[88:91]
    v_mfma_f32_16x16x4_f32 v[120:123], v3, v60, v[56:59]
    v_mfma_f32_16x16x32_bf16 v[88:91], a[108:111], v[148:151], v[88:91]
    v_mfma_f32_16x16x32_bf16 v[88:91], a[112:115], v[152:155], v[88:91]
    v_mfma_f32_16x16x32_bf16 v[88:91], a[116:119], v[156:159], v[88:91]
    buffer_load_dwordx4 v225, s[24:27], s59 offen offset:1024 nt lds
    s_nop 5
    v_fma_f32 v128, -v92, v92, v120
    v_fma_f32 v129, -v93, v93, v121
    v_fma_f32 v130, -v94, v94, v122
    v_fma_f32 v131, -v95, v95, v123
    v_max_f32 v128, v128, v56
    v_max_f32 v129, v129, v56
    s_add_u32 m0, s42, 6144
    s_add_u32 s59, s37, 75694464
    buffer_load_dwordx4 v224, s[24:27], s59 offen offset:0 nt lds
    v_max_f32 v130, v130, v56
    v_max_f32 v131, v131, v56
    v_rsq_f32 v128, v128
    v_rsq_f32 v129, v129
    v_rsq_f32 v130, v130
    v_rsq_f32 v131, v131
    v_fma_f32 v88, -v92, v61, v88
    v_fma_f32 v89, -v93, v61, v89
    v_fma_f32 v90, -v94, v61, v90
    v_fma_f32 v91, -v95, v61, v91
    v_fma_f32 v88, v88, v128, v62
    v_fma_f32 v89, v89, v129, v62
    v_fma_f32 v90, v90, v130, v62
    v_fma_f32 v91, v91, v131, v62
    v_max3_f32 v1, v88, v89, v90
    v_max_f32 v1, v1, v91
    v_cmp_lt_f32 vcc, s52, v1
    s_cbranch_vccnz L_site10
L_back10:
    v_exp_f32 v96, v88
    v_exp_f32 v97, v89
    v_exp_f32 v98, v90
    v_exp_f32 v99, v91
    v_mul_f32 v88, v96, v128
    v_mul_f32 v89, v97, v129
    v_mul_f32 v90, v98, v130
    v_mul_f32 v91, v99, v131
    v_add_f32 v63, v63, v96
    v_fmac_f32 v64, v88, v92
    v_add_f32 v63, v63, v97
    v_fmac_f32 v64, v89, v93
    v_add_f32 v63, v63, v98
    buffer_load_dwordx4 v225, s[24:27], s59 offen offset:1024 nt lds
    v_fmac_f32 v64, v90, v94
    v_add_f32 v63, v63, v99
    v_fmac_f32 v64, v91, v95
    v_mov_b32 v68, v88
    v_mov_b32 v69, v89
    v_mov_b32 v70, v90
    v_mov_b32 v71, v91
    s_waitcnt vmcnt(14)
    ds_read_b128 a[120:123], v40 offset:6144
    ds_read_b128 a[124:127], v41 offset:6144
    s_waitcnt lgkmcnt(1)
    v_mfma_f32_16x16x32_bf16 v[112:115], a[120:123], a[120:123], v[84:87]
    v_mfma_f32_16x16x32_bf16 v[116:119], a[120:123], a[48:51], 0
    s_waitcnt lgkmcnt(0)
    v_mfma_f32_16x16x32_bf16 v[112:115], a[124:127], a[124:127], v[112:115]
    v_mfma_f32_16x16x32_bf16 v[116:119], a[124:127], a[52:55], v[116:119]
    v_mfma_f32_16x16x32_bf16 v[108:111], a[120:123], v[52:55], v[80:83]
    s_add_u32 m0, s42, 8192
    s_add_u32 s59, s37, 75694592
    buffer_load_dwordx4 v224, s[24:27], s59 offen offset:0 nt lds
    v_mfma_f32_16x16x32_bf16 v[104:107], a[120:123], v[136:139], v[76:79]
    buffer_load_dwordx4 v225, s[24:27], s59 offen offset:1024 nt lds
    s_waitcnt vmcnt(13)
    ds_read_b128 a[128:131], v40 offset:8192
    ds_read_b128 a[132:135], v41 offset:8192
    v_mfma_f32_16x16x32_bf16 v[108:111], a[124:127], v[52:55], v[108:111]
    v_mfma_f32_16x16x32_bf16 v[104:107], a[124:127], v[140:143], v[104:107]
    s_waitcnt lgkmcnt(1)
    v_mfma_f32_16x16x32_bf16 v[112:115], a[128:131], a[128:131], v[112:115]
    v_mfma_f32_16x16x32_bf16 v[116:119], a[128:131], a[56:59], v[116:119]
    s_waitcnt lgkmcnt(0)
    v_mfma_f32_16x16x32_bf16 v[112:115], a[132:135], a[132:135], v[112:115]
    v_mfma_f32_16x16x32_bf16 v[116:119], a[132:135], a[60:63], v[116:119]
    v_mfma_f32_16x16x32_bf16 v[108:111], a[128:131], v[52:55], v[108:111]
    s_add_u32 m0, s42, 10240
    s_add_u32 s59, s37, 75694720
    buffer_load_dwordx4 v224, s[24:27], s59 offen offset:0 nt lds
    v_mfma_f32_16x16x32_bf16 v[104:107], a[128:131], v[144:147], v[104:107]
    buffer_load_dwordx4 v225, s[24:27], s59 offen offset:1024 nt lds
    s_waitcnt vmcnt(12)
    ds_read_b128 a[136:139], v40 offset:10240
    ds_read_b128 a[140:143], v41 offset:10240
    s_barrier
    s_add_u32 s61, s60, 3158016
    buffer_load_dwordx4 v[208:211], v65, s[32:35], s61 offen offset:0 sc1
    v_mfma_f32_16x16x32_bf16 v[108:111], a[132:135], v[52:55], v[108:111]
    ds_read_b64_tr_b16 a[146:147], v44 offset:6144
    v_mfma_f32_16x16x32_bf16 v[104:107], a[132:135], v[148:151], v[104:107]
    ds_read_b64_tr_b16 a[150:151], v44 offset:18432
    s_waitcnt lgkmcnt(3)
    v_mfma_f32_16x16x32_bf16 v[112:115], a[136:139], a[136:139], v[112:115]
    ds_read_b64_tr_b16 a[154:155], v44 offset:30720
    v_mfma_f32_16x16x32_bf16 v[116:119], a[136:139], a[64:67], v[116:119]
    ds_read_b64_tr_b16 a[158:159], v44 offset:43008
    s_waitcnt lgkmcnt(4)
    v_mfma_f32_16x16x32_bf16 v[112:115], a[140:143], a[140:143], v[112:115]
    ds_read_b64_tr_b16 a[162:163], v45 offset:6144
    v_mfma_f32_16x16x32_bf16 v[116:119], a[140:143], a[68:71], v[116:119]
    ds_read_b64_tr_b16 a[166:167], v45 offset:18432
    v_mfma_f32_16x16x32_bf16 v[108:111], a[136:139], v[52:55], v[108:111]
    ds_read_b64_tr_b16 a[170:171], v45 offset:30720
    v_mfma_f32_16x16x32_bf16 v[108:111], a[140:143], v[52:55], v[108:111]
    ds_read_b64_tr_b16 a[174:175], v45 offset:43008
    s_nop 2
    v_fma_f32 v112, v116, 2.0, v112
    v_fma_f32 v113, v117, 2.0, v113
    v_fma_f32 v114, v118, 2.0, v114
    v_fma_f32 v115, v119, 2.0, v115
    v_cndmask_b32 v4, 0, v112, s[44:45]
    v_cndmask_b32 v4, v4, v113, s[46:47]
    v_cndmask_b32 v4, v4, v114, s[48:49]
    v_cndmask_b32 v4, v4, v115, s[50:51]
    ds_read_b64_tr_b16 a[178:179], v46 offset:6144
    ds_read_b64_tr_b16 a[182:183], v46 offset:18432
    v_mfma_f32_16x16x4_f32 v[124:127], v4, v60, v[56:59]
    ds_read_b64_tr_b16 a[186:187], v46 offset:30720
    ds_read_b64_tr_b16 a[190:191], v46 offset:43008
    buffer_load_dwordx4 v[212:215], v65, s[32:35], s61 offen offset:1024 sc1
    s_nop 5
    v_mfma_f32_16x16x32_bf16 v[104:107], a[136:139], v[152:155], v[104:107]
    v_fma_f32 v132, -v108, v108, v124
    v_fma_f32 v133, -v109, v109, v125
    v_mfma_f32_16x16x32_bf16 v[104:107], a[140:143], v[156:159], v[104:107]
    v_fma_f32 v134, -v110, v110, v126
    v_fma_f32 v135, -v111, v111, v127
    v_max_f32 v132, v132, v56
    v_max_f32 v133, v133, v56
    v_max_f32 v134, v134, v56
    v_max_f32 v135, v135, v56
    v_rsq_f32 v132, v132
    v_rsq_f32 v133, v133
    v_rsq_f32 v134, v134
    v_rsq_f32 v135, v135
    v_pk_fma_f32 v[104:105], v[108:109], v[60:61], v[104:105] op_sel:[0,1,0] neg_lo:[1,0,0] neg_hi:[1,0,0]
    v_pk_fma_f32 v[106:107], v[110:111], v[60:61], v[106:107] op_sel:[0,1,0] neg_lo:[1,0,0] neg_hi:[1,0,0]
    v_pk_fma_f32 v[104:105], v[104:105], v[132:133], v[62:63] op_sel_hi:[1,1,0]
    v_pk_fma_f32 v[106:107], v[106:107], v[134:135], v[62:63] op_sel_hi:[1,1,0]
L_back11:
    v_max3_f32 v1, v104, v105, v106
    v_max_f32 v1, v1, v107
    v_cmp_lt_f32 vcc, s52, v1
    v_exp_f32 v112, v104
    v_exp_f32 v113, v105
    v_exp_f32 v114, v106
    v_exp_f32 v115, v107
    s_cbranch_vccnz L_site11
    v_cvt_pk_bf16_f32 v72, v88, v89
    v_cvt_pk_bf16_f32 v73, v90, v91
    v_pk_mul_f32 v[104:105], v[112:113], v[132:133]
    v_pk_mul_f32 v[106:107], v[114:115], v[134:135]
    v_cvt_pk_bf16_f32 v74, v104, v105
    v_cvt_pk_bf16_f32 v75, v106, v107
    ds_write_b128 v237, v[72:75] offset:12288
    s_waitcnt lgkmcnt(0)
    s_barrier
    ds_read_b32 v9, v254 offset:4100
    ds_read_b128 a[192:195], v253 offset:12288
    ds_read_b128 a[196:199], v253 offset:13312
    ds_read_b128 a[200:203], v253 offset:14336
    ds_read_b128 a[204:207], v253 offset:15360
    buffer_load_dwordx4 v[216:219], v65, s[32:35], s61 offen offset:2048 sc1
    s_waitcnt lgkmcnt(4)
    v_cmp_ne_u32 vcc, 0, v9
    s_cbranch_vccnz L_xt11
L_post11:
    s_waitcnt lgkmcnt(3)
    v_mfma_f32_16x16x32_bf16 v[16:19], a[144:147], a[192:195], v[16:19]
    v_add_f32 v68, v68, v104
    v_add_f32 v69, v69, v105
    v_mfma_f32_16x16x32_bf16 v[20:23], a[160:163], a[192:195], v[20:23]
    v_add_f32 v70, v70, v106
    v_add_f32 v71, v71, v107
    v_mfma_f32_16x16x32_bf16 v[24:27], a[176:179], a[192:195], v[24:27]
    v_add_f32 v63, v63, v112
    v_fma_f32 v64, v104, v108, v64
    s_waitcnt lgkmcnt(2)
    v_mfma_f32_16x16x32_bf16 v[16:19], a[148:151], a[196:199], v[16:19]
    s_waitcnt vmcnt(13)
    ds_read_b128 a[96:99], v42 offset:0
    ds_read_b128 a[100:103], v43 offset:0
    v_mfma_f32_16x16x32_bf16 v[20:23], a[164:167], a[196:199], v[20:23]
    v_add_f32 v63, v63, v113
    v_fma_f32 v64, v105, v109, v64
    v_mfma_f32_16x16x32_bf16 v[24:27], a[180:183], a[196:199], v[24:27]
    v_add_f32 v63, v63, v114
    v_fma_f32 v64, v106, v110, v64
    s_waitcnt lgkmcnt(3)
    v_mfma_f32_16x16x32_bf16 v[16:19], a[152:155], a[200:203], v[16:19]
    v_add_f32 v63, v63, v115
    v_fma_f32 v64, v107, v111, v64
    v_mfma_f32_16x16x32_bf16 v[20:23], a[168:171], a[200:203], v[20:23]
    s_waitcnt vmcnt(11)
    ds_read_b128 a[104:107], v42 offset:2048
    ds_read_b128 a[108:111], v43 offset:2048
    v_mfma_f32_16x16x32_bf16 v[24:27], a[184:187], a[200:203], v[24:27]
    s_waitcnt lgkmcnt(4)
    v_mfma_f32_16x16x32_bf16 v[16:19], a[156:159], a[204:207], v[16:19]
    v_mfma_f32_16x16x32_bf16 v[20:23], a[172:175], a[204:207], v[20:23]
    v_mfma_f32_16x16x32_bf16 v[24:27], a[188:191], a[204:207], v[24:27]
    s_waitcnt lgkmcnt(3)
    v_mfma_f32_16x16x32_bf16 v[96:99], a[96:99], a[96:99], v[84:87]
    v_mfma_f32_16x16x32_bf16 v[100:103], a[96:99], a[48:51], 0
    s_waitcnt lgkmcnt(2)
    v_mfma_f32_16x16x32_bf16 v[96:99], a[100:103], a[100:103], v[96:99]
    v_mfma_f32_16x16x32_bf16 v[100:103], a[100:103], a[52:55], v[100:103]
    s_waitcnt vmcnt(9)
    ds_read_b128 a[112:115], v42 offset:4096
    ds_read_b128 a[116:119], v43 offset:4096
    s_barrier
    v_mfma_f32_16x16x32_bf16 v[92:95], a[96:99], v[52:55], v[80:83]
    buffer_load_dwordx4 v[220:223], v65, s[32:35], s61 offen offset:3072 sc1
    ds_read_b64_tr_b16 a[0:1], v47 offset:0
    v_mfma_f32_16x16x32_bf16 v[88:91], a[96:99], v[136:139], v[76:79]
    ds_read_b64_tr_b16 a[4:5], v47 offset:12288
    v_mfma_f32_16x16x32_bf16 v[92:95], a[100:103], v[52:55], v[92:95]
    ds_read_b64_tr_b16 a[8:9], v47 offset:24576
    v_mfma_f32_16x16x32_bf16 v[88:91], a[100:103], v[140:143], v[88:91]
    ds_read_b64_tr_b16 a[12:13], v47 offset:36864
    s_waitcnt lgkmcnt(7)
    v_mfma_f32_16x16x32_bf16 v[96:99], a[104:107], a[104:107], v[96:99]
    ds_read_b64_tr_b16 a[16:17], v48 offset:0
    v_mfma_f32_16x16x32_bf16 v[100:103], a[104:107], a[56:59], v[100:103]
    ds_read_b64_tr_b16 a[20:21], v48 offset:12288
    s_waitcnt lgkmcnt(8)
    v_mfma_f32_16x16x32_bf16 v[96:99], a[108:111], a[108:111], v[96:99]
    ds_read_b64_tr_b16 a[24:25], v48 offset:24576
    v_mfma_f32_16x16x32_bf16 v[100:103], a[108:111], a[60:63], v[100:103]
    ds_read_b64_tr_b16 a[28:29], v48 offset:36864
    v_mfma_f32_16x16x32_bf16 v[92:95], a[104:107], v[52:55], v[92:95]
    ds_read_b64_tr_b16 a[32:33], v49 offset:0
    v_mfma_f32_16x16x32_bf16 v[88:91], a[104:107], v[144:147], v[88:91]
    ds_read_b64_tr_b16 a[36:37], v49 offset:12288
    v_mfma_f32_16x16x32_bf16 v[92:95], a[108:111], v[52:55], v[92:95]
    ds_read_b64_tr_b16 a[40:41], v49 offset:24576
    v_mfma_f32_16x16x32_bf16 v[88:91], a[108:111], v[148:151], v[88:91]
    ds_read_b64_tr_b16 a[44:45], v49 offset:36864
    s_waitcnt lgkmcnt(13)
    v_mfma_f32_16x16x32_bf16 v[96:99], a[112:115], a[112:115], v[96:99]
    v_mfma_f32_16x16x32_bf16 v[100:103], a[112:115], a[64:67], v[100:103]
    s_waitcnt lgkmcnt(12)
    v_mfma_f32_16x16x32_bf16 v[96:99], a[116:119], a[116:119], v[96:99]
    v_mfma_f32_16x16x32_bf16 v[100:103], a[116:119], a[68:71], v[100:103]
    s_waitcnt vmcnt(8)
    ds_read_b128 a[120:123], v42 offset:6144
    ds_read_b128 a[124:127], v43 offset:6144
    v_mfma_f32_16x16x32_bf16 v[92:95], a[112:115], v[52:55], v[92:95]
    v_mfma_f32_16x16x32_bf16 v[92:95], a[116:119], v[52:55], v[92:95]
    s_nop 2
    v_fma_f32 v96, v100, 2.0, v96
    v_fma_f32 v97, v101, 2.0, v97
    v_mfma_f32_16x16x32_bf16 v[88:91], a[112:115], v[152:155], v[88:91]
    v_fma_f32 v98, v102, 2.0, v98
    v_fma_f32 v99, v103, 2.0, v99
    v_mfma_f32_16x16x32_bf16 v[88:91], a[116:119], v[156:159], v[88:91]
    v_cndmask_b32 v3, 0, v96, s[44:45]
    v_cndmask_b32 v3, v3, v97, s[46:47]
    v_cndmask_b32 v3, v3, v98, s[48:49]
    v_cndmask_b32 v3, v3, v99, s[50:51]
    s_nop 0
    s_nop 0
    v_mfma_f32_16x16x4_f32 v[120:123], v3, v60, v[56:59]
    s_waitcnt lgkmcnt(1)
    v_mfma_f32_16x16x32_bf16 v[112:115], a[120:123], a[120:123], v[84:87]
    v_mfma_f32_16x16x32_bf16 v[116:119], a[120:123], a[48:51], 0
    s_waitcnt vmcnt(6)
    ds_read_b128 a[128:131], v42 offset:8192
    ds_read_b128 a[132:135], v43 offset:8192
    s_add_u32 s61, s60, 3162112
    buffer_load_dwordx4 v[224:227], v65, s[32:35], s61 offen offset:0 sc1
    s_waitcnt lgkmcnt(2)
    v_mfma_f32_16x16x32_bf16 v[112:115], a[124:127], a[124:127], v[112:115]
    v_fma_f32 v128, -v92, v92, v120
    v_fma_f32 v129, -v93, v93, v121
    v_fma_f32 v130, -v94, v94, v122
    v_mfma_f32_16x16x32_bf16 v[116:119], a[124:127], a[52:55], v[116:119]
    v_fma_f32 v131, -v95, v95, v123
    v_max_f32 v128, v128, v56
    v_max_f32 v129, v129, v56
    v_mfma_f32_16x16x32_bf16 v[108:111], a[120:123], v[52:55], v[80:83]
    v_max_f32 v130, v130, v56
    v_max_f32 v131, v131, v56
    v_mfma_f32_16x16x32_bf16 v[104:107], a[120:123], v[136:139], v[76:79]
    v_rsq_f32 v128, v128
    v_mfma_f32_16x16x32_bf16 v[108:111], a[124:127], v[52:55], v[108:111]
    v_rsq_f32 v129, v129
    v_mfma_f32_16x16x32_bf16 v[104:107], a[124:127], v[140:143], v[104:107]
    v_rsq_f32 v130, v130
    s_waitcnt lgkmcnt(1)
    v_mfma_f32_16x16x32_bf16 v[112:115], a[128:131], a[128:131], v[112:115]
    v_rsq_f32 v131, v131
    v_fma_f32 v88, -v92, v61, v88
    v_mfma_f32_16x16x32_bf16 v[116:119], a[128:131], a[56:59], v[116:119]
    v_fma_f32 v89, -v93, v61, v89
    v_fma_f32 v90, -v94, v61, v90
    v_fma_f32 v91, -v95, v61, v91
    s_waitcnt lgkmcnt(0)
    v_mfma_f32_16x16x32_bf16 v[112:115], a[132:135], a[132:135], v[112:115]
    v_fma_f32 v88, v88, v128, v62
    v_fma_f32 v89, v89, v129, v62
    v_fma_f32 v90, v90, v130, v62
    v_mfma_f32_16x16x32_bf16 v[116:119], a[132:135], a[60:63], v[116:119]
    v_fma_f32 v91, v91, v131, v62
    v_max3_f32 v1, v88, v89, v90
    v_max_f32 v1, v1, v91
    v_mfma_f32_16x16x32_bf16 v[108:111], a[128:131], v[52:55], v[108:111]
    v_cmp_lt_f32 vcc, s52, v1
    s_cbranch_vccnz L_site12
L_back12:
    v_mfma_f32_16x16x32_bf16 v[104:107], a[128:131], v[144:147], v[104:107]
    s_waitcnt vmcnt(5)
    ds_read_b128 a[136:139], v42 offset:10240
    ds_read_b128 a[140:143], v43 offset:10240
    s_barrier
    buffer_load_dwordx4 v[228:231], v65, s[32:35], s61 offen offset:1024 sc1
    s_cmp_eq_u32 s0, 1
    s_cbranch_scc0 L_nolate
    s_add_u32 s56, s60, 3145728
    buffer_load_dwordx4 v[160:163], v65, s[32:35], s56 offen offset:0 sc1
    buffer_load_dwordx4 v[164:167], v65, s[32:35], s56 offen offset:1024 sc1
    buffer_load_dwordx4 v[168:171], v65, s[32:35], s56 offen offset:2048 sc1
    buffer_load_dwordx4 v[172:175], v65, s[32:35], s56 offen offset:3072 sc1
    s_add_u32 s56, s60, 3149824
    buffer_load_dwordx4 v[176:179], v65, s[32:35], s56 offen offset:0 sc1
    buffer_load_dwordx4 v[180:183], v65, s[32:35], s56 offen offset:1024 sc1
    buffer_load_dwordx4 v[184:187], v65, s[32:35], s56 offen offset:2048 sc1
    buffer_load_dwordx4 v[188:191], v65, s[32:35], s56 offen offset:3072 sc1
L_nolate:
    buffer_load_dword v244, v28, s[32:35], s28 offen
    v_mfma_f32_16x16x32_bf16 v[108:111], a[132:135], v[52:55], v[108:111]
    ds_read_b64_tr_b16 a[2:3], v47 offset:6144
    v_exp_f32 v96, v88
    v_mfma_f32_16x16x32_bf16 v[104:107], a[132:135], v[148:151], v[104:107]
    ds_read_b64_tr_b16 a[6:7], v47 offset:18432
    v_exp_f32 v97, v89
    s_waitcnt lgkmcnt(3)
    v_mfma_f32_16x16x32_bf16 v[112:115], a[136:139], a[136:139], v[112:115]
    ds_read_b64_tr_b16 a[10:11], v47 offset:30720
    v_exp_f32 v98, v90
    v_mfma_f32_16x16x32_bf16 v[116:119], a[136:139], a[64:67], v[116:119]
    ds_read_b64_tr_b16 a[14:15], v47 offset:43008
    v_exp_f32 v99, v91
    s_waitcnt lgkmcnt(4)
    v_mfma_f32_16x16x32_bf16 v[112:115], a[140:143], a[140:143], v[112:115]
    ds_read_b64_tr_b16 a[18:19], v48 offset:6144
    v_mul_f32 v88, v96, v128
    v_mul_f32 v89, v97, v129
    v_mfma_f32_16x16x32_bf16 v[116:119], a[140:143], a[68:71], v[116:119]
    ds_read_b64_tr_b16 a[22:23], v48 offset:18432
    v_mul_f32 v90, v98, v130
    v_mul_f32 v91, v99, v131
    v_mfma_f32_16x16x32_bf16 v[108:111], a[136:139], v[52:55], v[108:111]
    ds_read_b64_tr_b16 a[26:27], v48 offset:30720
    v_add_f32 v63, v63, v96
    v_fmac_f32 v64, v88, v92
    v_mfma_f32_16x16x32_bf16 v[108:111], a[140:143], v[52:55], v[108:111]
    ds_read_b64_tr_b16 a[30:31], v48 offset:43008
    v_add_f32 v63, v63, v97
    v_fmac_f32 v64, v89, v93
    v_add_f32 v63, v63, v98
    v_fma_f32 v112, v116, 2.0, v112
    v_fma_f32 v113, v117, 2.0, v113
    v_fma_f32 v114, v118, 2.0, v114
    v_fma_f32 v115, v119, 2.0, v115
    v_cndmask_b32 v4, 0, v112, s[44:45]
    v_cndmask_b32 v4, v4, v113, s[46:47]
    v_cndmask_b32 v4, v4, v114, s[48:49]
    v_cndmask_b32 v4, v4, v115, s[50:51]
    ds_read_b64_tr_b16 a[34:35], v49 offset:6144
    ds_read_b64_tr_b16 a[38:39], v49 offset:18432
    v_mfma_f32_16x16x4_f32 v[124:127], v4, v60, v[56:59]
    ds_read_b64_tr_b16 a[42:43], v49 offset:30720
    ds_read_b64_tr_b16 a[46:47], v49 offset:43008
    v_fmac_f32 v64, v90, v94
    v_add_f32 v63, v63, v99
    v_fmac_f32 v64, v91, v95
    v_add_f32 v68, v68, v88
    v_add_f32 v69, v69, v89
    v_add_f32 v70, v70, v90
    v_add_f32 v71, v71, v91
    v_mfma_f32_16x16x32_bf16 v[104:107], a[136:139], v[152:155], v[104:107]
    v_cvt_pk_bf16_f32 v72, v88, v89
    v_cvt_pk_bf16_f32 v73, v90, v91
    v_mfma_f32_16x16x32_bf16 v[104:107], a[140:143], v[156:159], v[104:107]
    v_fma_f32 v132, -v108, v108, v124
    v_fma_f32 v133, -v109, v109, v125
    v_fma_f32 v134, -v110, v110, v126
    v_fma_f32 v135, -v111, v111, v127
    v_max_f32 v132, v132, v56
    v_max_f32 v133, v133, v56
    v_max_f32 v134, v134, v56
    v_max_f32 v135, v135, v56
    v_rsq_f32 v132, v132
    v_rsq_f32 v133, v133
    v_rsq_f32 v134, v134
    v_rsq_f32 v135, v135
    v_pk_fma_f32 v[104:105], v[108:109], v[60:61], v[104:105] op_sel:[0,1,0] neg_lo:[1,0,0] neg_hi:[1,0,0]
    v_pk_fma_f32 v[106:107], v[110:111], v[60:61], v[106:107] op_sel:[0,1,0] neg_lo:[1,0,0] neg_hi:[1,0,0]
    v_pk_fma_f32 v[104:105], v[104:105], v[132:133], v[62:63] op_sel_hi:[1,1,0]
    v_pk_fma_f32 v[106:107], v[106:107], v[134:135], v[62:63] op_sel_hi:[1,1,0]
L_back13:
    v_max3_f32 v1, v104, v105, v106
    v_max_f32 v1, v1, v107
    v_cmp_lt_f32 vcc, s52, v1
    v_exp_f32 v112, v104
    v_exp_f32 v113, v105
    v_exp_f32 v114, v106
    v_exp_f32 v115, v107
    s_cbranch_vccnz L_site13
    v_pk_mul_f32 v[104:105], v[112:113], v[132:133]
    v_pk_mul_f32 v[106:107], v[114:115], v[134:135]
    v_cvt_pk_bf16_f32 v74, v104, v105
    v_cvt_pk_bf16_f32 v75, v106, v107
    ds_write_b128 v237, v[72:75] offset:0
    v_pk_add_f32 v[68:69], v[68:69], v[104:105]
    v_pk_add_f32 v[70:71], v[70:71], v[106:107]
    v_pk_add_f32 v[112:113], v[112:113], v[114:115]
    v_cvt_pk_bf16_f32 v66, v68, v69
    v_cvt_pk_bf16_f32 v67, v70, v71
    ds_write_b64 v238, v[66:67]
    v_pk_mul_f32 v[114:115], v[104:105], v[108:109]
    v_add_f32 v63, v63, v112
    v_pk_fma_f32 v[114:115], v[106:107], v[110:111], v[114:115]
    v_add_f32 v10, v63, v113
    v_add_f32 v64, v64, v114
    v_add_f32 v11, v64, v115
    ds_write_b64 v238, v[10:11] offset:2048
L_merge:
    s_waitcnt lgkmcnt(0)
    s_barrier
L_postx:
    ds_read_b32 v9, v254 offset:4096
    ds_read_b128 v[92:95], v253 offset:0
    ds_read_b128 v[96:99], v253 offset:1024
    ds_read_b128 v[100:103], v253 offset:2048
    ds_read_b64 v[136:137], v254 offset:2048
    ds_read_b64 v[138:139], v254 offset:2560
    ds_read_b64 v[140:141], v254 offset:3072
    ds_read_b64 v[142:143], v254 offset:3584
    ds_read_b128 v[116:119], v253 offset:3072
    ds_read_b64 v[120:121], v254 offset:0
    ds_read_b64 v[122:123], v254 offset:512
    s_waitcnt lgkmcnt(10)
    v_cmp_ne_u32 vcc, 0, v9
    s_cbranch_vccnz L_xlast
    s_waitcnt lgkmcnt(9)
    v_mfma_f32_16x16x32_bf16 v[16:19], a[0:3], v[92:95], v[16:19]
    ds_read_b64 v[124:125], v254 offset:1024
    v_mfma_f32_16x16x32_bf16 v[20:23], a[16:19], v[92:95], v[20:23]
    ds_read_b64 v[126:127], v254 offset:1536
    v_mfma_f32_16x16x32_bf16 v[24:27], a[32:35], v[92:95], v[24:27]
    s_waitcnt lgkmcnt(10)
    v_mfma_f32_16x16x32_bf16 v[16:19], a[4:7], v[96:99], v[16:19]
    v_mfma_f32_16x16x32_bf16 v[20:23], a[20:23], v[96:99], v[20:23]
    v_mfma_f32_16x16x32_bf16 v[24:27], a[36:39], v[96:99], v[24:27]
    s_waitcnt lgkmcnt(9)
    v_mfma_f32_16x16x32_bf16 v[16:19], a[8:11], v[100:103], v[16:19]
    s_waitcnt lgkmcnt(5)
    v_add_f32 v1, v136, v138
    v_add_f32 v2, v137, v139
    v_add_f32 v140, v140, v142
    v_mfma_f32_16x16x32_bf16 v[20:23], a[24:27], v[100:103], v[20:23]
    v_add_f32 v141, v141, v143
    v_add_f32 v1, v1, v140
    v_add_f32 v2, v2, v141
    v_mfma_f32_16x16x32_bf16 v[24:27], a[40:43], v[100:103], v[24:27]
    s_nop 0
    v_permlane32_swap_b32 v1, v2
    v_add_f32 v1, v1, v2
    v_mov_b32 v2, v1
    s_waitcnt lgkmcnt(4)
    v_mfma_f32_16x16x32_bf16 v[16:19], a[12:15], v[116:119], v[16:19]
    v_permlane16_swap_b32 v1, v2
    v_add_f32 v1, v1, v2
    v_mov_b32 v2, v1
    s_waitcnt lgkmcnt(2)
    v_mfma_f32_16x16x32_bf16 v[16:19], a[72:75], v[120:123], v[16:19]
    v_permlane32_swap_b32 v1, v2
    v_rcp_f32 v3, v1
    s_waitcnt lgkmcnt(0)
    v_mfma_f32_16x16x32_bf16 v[16:19], a[76:79], v[124:127], v[16:19]
    v_log_f32 v4, v1
    v_mul_f32 v5, v60, v3
    v_mfma_f32_16x16x32_bf16 v[20:23], a[28:31], v[116:119], v[20:23]
    v_mul_f32 v6, v2, v3
    v_sub_f32 v4, v4, v255
    v_mfma_f32_16x16x32_bf16 v[20:23], a[80:83], v[120:123], v[20:23]
    v_mfma_f32_16x16x32_bf16 v[20:23], a[84:87], v[124:127], v[20:23]
    v_mfma_f32_16x16x32_bf16 v[24:27], a[44:47], v[116:119], v[24:27]
    v_fma_f32 v16, v16, v5, -v6
    v_fma_f32 v17, v17, v5, -v6
    v_mfma_f32_16x16x32_bf16 v[24:27], a[88:91], v[120:123], v[24:27]
    v_fma_f32 v18, v18, v5, -v6
    v_fma_f32 v19, v19, v5, -v6
    v_mfma_f32_16x16x32_bf16 v[24:27], a[92:95], v[124:127], v[24:27]
    v_cvt_pk_bf16_f32 v66, v16, v17
    v_cvt_pk_bf16_f32 v67, v18, v19
    ds_write_b64 v236, v[66:67] offset:0
    v_pk_fma_f32 v[20:21], v[20:21], v[4:5], v[6:7] op_sel:[0,1,0] op_sel_hi:[1,1,0] neg_lo:[0,0,1] neg_hi:[0,0,1]
    v_pk_fma_f32 v[22:23], v[22:23], v[4:5], v[6:7] op_sel:[0,1,0] op_sel_hi:[1,1,0] neg_lo:[0,0,1] neg_hi:[0,0,1]
    v_cvt_pk_bf16_f32 v68, v20, v21
    v_cvt_pk_bf16_f32 v69, v22, v23
    ds_write_b64 v236, v[68:69] offset:512
    v_pk_fma_f32 v[24:25], v[24:25], v[4:5], v[6:7] op_sel:[0,1,0] op_sel_hi:[1,1,0] neg_lo:[0,0,1] neg_hi:[0,0,1]
    v_pk_fma_f32 v[26:27], v[26:27], v[4:5], v[6:7] op_sel:[0,1,0] op_sel_hi:[1,1,0] neg_lo:[0,0,1] neg_hi:[0,0,1]
    v_cvt_pk_bf16_f32 v70, v24, v25
    v_cvt_pk_bf16_f32 v71, v26, v27
    ds_write_b64 v236, v[70:71] offset:1024
    s_waitcnt lgkmcnt(0)
    s_barrier
    ds_read_b128 v[136:139], v241 offset:0
    ds_read_b128 v[140:143], v241 offset:1024
    ds_read_b128 v[144:147], v241 offset:2048
    ds_read_b128 v[148:151], v241 offset:3072
    ds_read_b128 v[152:155], v241 offset:4096
    ds_read_b128 v[156:159], v241 offset:5120
    s_waitcnt vmcnt(1)
    v_subrev_u32 v35, s39, v4
    v_add_u32 v39, s39, v4
    s_waitcnt lgkmcnt(5)
    v_mfma_f32_16x16x32_bf16 v[16:19], v[160:163], v[136:139], 0
    v_mfma_f32_16x16x32_bf16 v[20:23], v[184:187], v[136:139], 0
    v_mfma_f32_16x16x32_bf16 v[24:27], v[208:211], v[136:139], 0
    s_waitcnt lgkmcnt(4)
    v_mfma_f32_16x16x32_bf16 v[16:19], v[164:167], v[140:143], v[16:19]
    v_mfma_f32_16x16x32_bf16 v[20:23], v[188:191], v[140:143], v[20:23]
    v_mfma_f32_16x16x32_bf16 v[24:27], v[212:215], v[140:143], v[24:27]
    s_waitcnt lgkmcnt(3)
    v_mfma_f32_16x16x32_bf16 v[16:19], v[168:171], v[144:147], v[16:19]
    v_mfma_f32_16x16x32_bf16 v[20:23], v[192:195], v[144:147], v[20:23]
    v_mfma_f32_16x16x32_bf16 v[24:27], v[216:219], v[144:147], v[24:27]
    s_waitcnt lgkmcnt(2)
    v_mfma_f32_16x16x32_bf16 v[16:19], v[172:175], v[148:151], v[16:19]
    s_waitcnt lgkmcnt(1)
    v_mfma_f32_16x16x32_bf16 v[16:19], v[176:179], v[152:155], v[16:19]
    s_waitcnt lgkmcnt(0)
    v_mfma_f32_16x16x32_bf16 v[16:19], v[180:183], v[156:159], v[16:19]
    v_mfma_f32_16x16x32_bf16 v[20:23], v[196:199], v[148:151], v[20:23]
    v_mfma_f32_16x16x32_bf16 v[20:23], v[200:203], v[152:155], v[20:23]
    v_mfma_f32_16x16x32_bf16 v[20:23], v[204:207], v[156:159], v[20:23]
    v_mfma_f32_16x16x32_bf16 v[24:27], v[220:223], v[148:151], v[24:27]
    v_mfma_f32_16x16x32_bf16 v[24:27], v[224:227], v[152:155], v[24:27]
    s_nop 2
    v_cvt_pk_bf16_f32 v32, v16, v17
    v_mfma_f32_16x16x32_bf16 v[24:27], v[228:231], v[156:159], v[24:27]
    v_cvt_pk_bf16_f32 v33, v18, v19
    v_cvt_pk_bf16_f32 v34, v20, v21
    v_cvt_pk_bf16_f32 v36, v22, v23
    v_permlane16_swap_b32 v35, v39
    s_nop 0
    v_permlane16_swap_b32 v32, v36
    s_nop 1
    v_cvt_pk_bf16_f32 v37, v24, v25
    v_cvt_pk_bf16_f32 v38, v26, v27
    s_nop 0
    v_permlane16_swap_b32 v33, v37
    v_permlane16_swap_b32 v34, v38
    buffer_store_dwordx4 v[32:35], v242, s[32:35], s28 offen sc1
    buffer_store_dwordx4 v[36:39], v243, s[32:35], s28 offen sc1
    s_cmp_lt_u32 s29, 64
    s_cbranch_scc0 L_fin
    buffer_load_dwordx4 v[76:79], v65, s[32:35], s30 offen offset:0 sc1
    buffer_load_dwordx4 v[80:83], v65, s[32:35], s30 offen offset:1024 sc1
    buffer_load_dwordx4 v[84:87], v65, s[32:35], s30 offen offset:2048 sc1
    buffer_load_dwordx4 v[108:111], v65, s[32:35], s30 offen offset:3072 sc1
    buffer_load_dwordx4 v[112:115], v65, s[32:35], s31 offen offset:0 sc1
    buffer_load_dwordx4 v[128:131], v65, s[32:35], s31 offen offset:1024 sc1
    buffer_load_dwordx4 v[132:135], v65, s[32:35], s31 offen offset:2048 sc1
    buffer_load_dwordx4 v[52:55], v65, s[32:35], s31 offen offset:3072 sc1
    ds_bpermute_b32 v42, v252, v4
    v_bfe_u32 v48, v0, 2, 1
    v_cmp_eq_u32 vcc, 1, v48
    v_mov_b32 v246, s39
    s_movk_i32 s26, 0x101
    v_sub_u32 v247, 0, v246
    v_cndmask_b32 v247, v247, v246, vcc
    v_mul_lo_u32 v246, v247, -2
    v_mov_b32 v16, 0
    v_mov_b32 v17, 0
    v_mov_b32 v18, 0
    v_mov_b32 v19, 0
    v_mov_b32 v20, 0
    v_mov_b32 v21, 0
    v_mov_b32 v22, 0
    v_mov_b32 v97, 0
    s_mov_b32 s53, 0
    v_mov_b32 v160, 0x101
    v_mov_b32 v161, 0x202
    v_mov_b32 v162, 0x404
    v_mov_b32 v163, 0x808
    v_mov_b32 v164, 0x1010
    v_mov_b32 v165, 0x2020
    v_mov_b32 v166, 0x4040
    v_mov_b32 v167, 0x8080
    s_waitcnt vmcnt(0)
    v_sub_u32_dpp v136, v79, v79 row_half_mirror row_mask:0xf bank_mask:0xf
    v_sub_u32_dpp v137, v83, v83 row_half_mirror row_mask:0xf bank_mask:0xf
    v_sub_u32_dpp v138, v87, v87 row_half_mirror row_mask:0xf bank_mask:0xf
    v_sub_u32_dpp v139, v111, v111 row_half_mirror row_mask:0xf bank_mask:0xf
    v_sub_u32_dpp v140, v115, v115 row_half_mirror row_mask:0xf bank_mask:0xf
    v_sub_u32_dpp v141, v131, v131 row_half_mirror row_mask:0xf bank_mask:0xf
    v_sub_u32_dpp v142, v135, v135 row_half_mirror row_mask:0xf bank_mask:0xf
    v_sub_u32_dpp v143, v55, v55 row_half_mirror row_mask:0xf bank_mask:0xf
    v_cmp_eq_u32 s[6:7], v136, v246
    v_cmp_eq_u32 s[8:9], v137, v246
    v_cmp_eq_u32 s[10:11], v138, v246
    v_cmp_eq_u32 s[12:13], v139, v246
    v_cmp_eq_u32 s[14:15], v140, v246
    v_cmp_eq_u32 s[16:17], v141, v246
    v_cmp_eq_u32 s[36:37], v142, v246
    v_cmp_eq_u32 s[40:41], v143, v246
    v_cndmask_b32 v136, v160, 0, s[6:7]
    v_cndmask_b32 v137, v161, 0, s[8:9]
    v_cndmask_b32 v138, v162, 0, s[10:11]
    v_cndmask_b32 v139, v163, 0, s[12:13]
    v_cndmask_b32 v140, v164, 0, s[14:15]
    v_cndmask_b32 v141, v165, 0, s[16:17]
    v_cndmask_b32 v142, v166, 0, s[36:37]
    v_cndmask_b32 v143, v167, 0, s[40:41]
    v_or3_b32 v96, v136, v137, v138
    v_or3_b32 v139, v139, v140, v141
    v_or3_b32 v96, v96, v142, v143
    v_or_b32 v96, v96, v139
    v_cmp_ne_u32 vcc, 0, v96
    v_sub_u32 v168, v79, v247
    v_sub_u32 v169, v83, v247
    v_sub_u32 v170, v87, v247
    v_sub_u32 v171, v111, v247
    s_cbranch_vccz L_c_all
    v_lshrrev_b32 v48, v97, v96
    v_ffbl_b32 v48, v48
    v_add_u32 v48, v48, v97
    v_and_b32 v48, 7, v48
    v_lshl_add_u32 v51, v48, 10, v65
    v_lshlrev_b32 v88, v48, s26
    v_add_u32 v97, 1, v48
    s_mov_b64 exec, vcc
    buffer_load_dwordx4 v[136:139], v51, s[32:35], s30 offen sc1
    s_mov_b64 exec, -1
    v_lshrrev_b32 v48, v97, v96
    v_ffbl_b32 v48, v48
    v_add_u32 v48, v48, v97
    v_and_b32 v48, 7, v48
    v_lshl_add_u32 v51, v48, 10, v65
    v_lshlrev_b32 v89, v48, s26
    v_add_u32 v97, 1, v48
    s_mov_b64 exec, vcc
    buffer_load_dwordx4 v[140:143], v51, s[32:35], s30 offen sc1
    s_mov_b64 exec, -1
    v_lshrrev_b32 v48, v97, v96
    v_ffbl_b32 v48, v48
    v_add_u32 v48, v48, v97
    v_and_b32 v48, 7, v48
    v_lshl_add_u32 v51, v48, 10, v65
    v_lshlrev_b32 v90, v48, s26
    v_add_u32 v97, 1, v48
    s_mov_b64 exec, vcc
    buffer_load_dwordx4 v[144:147], v51, s[32:35], s30 offen sc1
    s_mov_b64 exec, -1
    v_lshrrev_b32 v48, v97, v96
    v_ffbl_b32 v48, v48
    v_add_u32 v48, v48, v97
    v_and_b32 v48, 7, v48
    v_lshl_add_u32 v51, v48, 10, v65
    v_lshlrev_b32 v91, v48, s26
    v_add_u32 v97, 1, v48
    s_mov_b64 exec, vcc
    buffer_load_dwordx4 v[148:151], v51, s[32:35], s30 offen sc1
    s_mov_b64 exec, -1
L_c_all:
    v_sub_u32 v172, v115, v247
    v_sub_u32 v173, v131, v247
    v_sub_u32 v174, v135, v247
    v_sub_u32 v175, v55, v247
    s_waitcnt lgkmcnt(0)
    v_sub_f32 v168, v168, v42
    v_sub_f32 v169, v169, v42
    v_sub_f32 v170, v170, v42
    v_sub_f32 v171, v171, v42
    v_sub_f32 v172, v172, v42
    v_sub_f32 v173, v173, v42
    v_sub_f32 v174, v174, v42
    v_sub_f32 v175, v175, v42
    v_exp_f32 v168, v168
    v_exp_f32 v169, v169
    v_exp_f32 v170, v170
    v_exp_f32 v171, v171
    v_exp_f32 v172, v172
    v_exp_f32 v173, v173
    v_exp_f32 v174, v174
    v_exp_f32 v175, v175
    v_cvt_pk_bf16_f32 v168, v168, 0
    v_cvt_pk_bf16_f32 v169, v169, 0
    v_cvt_pk_bf16_f32 v170, v170, 0
    v_cvt_pk_bf16_f32 v171, v171, 0
    v_cvt_pk_bf16_f32 v172, v172, 0
    v_cvt_pk_bf16_f32 v173, v173, 0
    v_cvt_pk_bf16_f32 v174, v174, 0
    v_cvt_pk_bf16_f32 v175, v175, 0
    v_lshlrev_b32 v176, 16, v168
    v_lshlrev_b32 v177, 16, v169
    v_lshlrev_b32 v178, 16, v170
    v_lshlrev_b32 v179, 16, v171
    v_lshlrev_b32 v180, 16, v172
    v_lshlrev_b32 v181, 16, v173
    v_lshlrev_b32 v182, 16, v174
    v_lshlrev_b32 v183, 16, v175
    s_mov_b64 exec, s[6:7]
    v_dot2c_f32_bf16 v16, v76, v168
    v_dot2c_f32_bf16 v18, v77, v168
    v_dot2c_f32_bf16 v20, v78, v168
    v_add_f32 v22, v22, v176
    v_dot2c_f32_bf16 v17, v76, v176
    v_dot2c_f32_bf16 v19, v77, v176
    v_dot2c_f32_bf16 v21, v78, v176
    s_mov_b64 exec, s[8:9]
    v_dot2c_f32_bf16 v16, v80, v169
    v_dot2c_f32_bf16 v18, v81, v169
    v_dot2c_f32_bf16 v20, v82, v169
    v_add_f32 v22, v22, v177
    v_dot2c_f32_bf16 v17, v80, v177
    v_dot2c_f32_bf16 v19, v81, v177
    v_dot2c_f32_bf16 v21, v82, v177
    s_mov_b64 exec, s[10:11]
    v_dot2c_f32_bf16 v16, v84, v170
    v_dot2c_f32_bf16 v18, v85, v170
    v_dot2c_f32_bf16 v20, v86, v170
    v_add_f32 v22, v22, v178
    v_dot2c_f32_bf16 v17, v84, v178
    v_dot2c_f32_bf16 v19, v85, v178
    v_dot2c_f32_bf16 v21, v86, v178
    s_mov_b64 exec, s[12:13]
    v_dot2c_f32_bf16 v16, v108, v171
    v_dot2c_f32_bf16 v18, v109, v171
    v_dot2c_f32_bf16 v20, v110, v171
    v_add_f32 v22, v22, v179
    v_dot2c_f32_bf16 v17, v108, v179
    v_dot2c_f32_bf16 v19, v109, v179
    v_dot2c_f32_bf16 v21, v110, v179
    s_mov_b64 exec, s[14:15]
    v_dot2c_f32_bf16 v16, v112, v172
    v_dot2c_f32_bf16 v18, v113, v172
    v_dot2c_f32_bf16 v20, v114, v172
    v_add_f32 v22, v22, v180
    v_dot2c_f32_bf16 v17, v112, v180
    v_dot2c_f32_bf16 v19, v113, v180
    v_dot2c_f32_bf16 v21, v114, v180
    s_mov_b64 exec, s[16:17]
    v_dot2c_f32_bf16 v16, v128, v173
    v_dot2c_f32_bf16 v18, v129, v173
    v_dot2c_f32_bf16 v20, v130, v173
    v_add_f32 v22, v22, v181
    v_dot2c_f32_bf16 v17, v128, v181
    v_dot2c_f32_bf16 v19, v129, v181
    v_dot2c_f32_bf16 v21, v130, v181
    s_mov_b64 exec, s[36:37]
    v_dot2c_f32_bf16 v16, v132, v174
    v_dot2c_f32_bf16 v18, v133, v174
    v_dot2c_f32_bf16 v20, v134, v174
    v_add_f32 v22, v22, v182
    v_dot2c_f32_bf16 v17, v132, v182
    v_dot2c_f32_bf16 v19, v133, v182
    v_dot2c_f32_bf16 v21, v134, v182
    s_mov_b64 exec, s[40:41]
    v_dot2c_f32_bf16 v16, v52, v175
    v_dot2c_f32_bf16 v18, v53, v175
    v_dot2c_f32_bf16 v20, v54, v175
    v_add_f32 v22, v22, v183
    v_dot2c_f32_bf16 v17, v52, v183
    v_dot2c_f32_bf16 v19, v53, v183
    v_dot2c_f32_bf16 v21, v54, v183
    s_mov_b64 exec, -1
    s_cbranch_vccz L_c_red
L_c_loop:
    s_waitcnt vmcnt(3)
    v_sub_u32_dpp v48, v139, v139 row_half_mirror row_mask:0xf bank_mask:0xf
    v_and_b32 v49, v88, v96
    v_cmpx_eq_u32 vcc, v48, v246
    v_cmpx_ne_u32 vcc, 0, v49
    v_xor_b32 v96, v96, v88
    v_sub_u32 v49, v139, v247
    v_sub_f32 v49, v49, v42
    v_exp_f32 v49, v49
    s_cbranch_execz L_c_s0
    v_cvt_pk_bf16_f32 v49, v49, 0
    v_lshlrev_b32 v50, 16, v49
    v_dot2c_f32_bf16 v16, v136, v49
    v_dot2c_f32_bf16 v18, v137, v49
    v_dot2c_f32_bf16 v20, v138, v49
    v_add_f32 v22, v22, v50
    v_dot2c_f32_bf16 v17, v136, v50
    v_dot2c_f32_bf16 v19, v137, v50
    v_dot2c_f32_bf16 v21, v138, v50
L_c_s0:
    s_mov_b64 exec, -1
    v_cmp_ne_u32 vcc, 0, v96
    v_lshrrev_b32 v48, v97, v96
    v_ffbl_b32 v48, v48
    s_cbranch_vccz L_c_red
    v_add_u32 v48, v48, v97
    v_and_b32 v48, 7, v48
    v_lshl_add_u32 v51, v48, 10, v65
    v_lshlrev_b32 v88, v48, s26
    v_add_u32 v97, 1, v48
    s_mov_b64 exec, vcc
    buffer_load_dwordx4 v[136:139], v51, s[32:35], s30 offen sc1
    s_mov_b64 exec, -1
    s_waitcnt vmcnt(3)
    v_sub_u32_dpp v48, v143, v143 row_half_mirror row_mask:0xf bank_mask:0xf
    v_and_b32 v49, v89, v96
    v_cmpx_eq_u32 vcc, v48, v246
    v_cmpx_ne_u32 vcc, 0, v49
    v_xor_b32 v96, v96, v89
    v_sub_u32 v49, v143, v247
    v_sub_f32 v49, v49, v42
    v_exp_f32 v49, v49
    s_cbranch_execz L_c_s1
    v_cvt_pk_bf16_f32 v49, v49, 0
    v_lshlrev_b32 v50, 16, v49
    v_dot2c_f32_bf16 v16, v140, v49
    v_dot2c_f32_bf16 v18, v141, v49
    v_dot2c_f32_bf16 v20, v142, v49
    v_add_f32 v22, v22, v50
    v_dot2c_f32_bf16 v17, v140, v50
    v_dot2c_f32_bf16 v19, v141, v50
    v_dot2c_f32_bf16 v21, v142, v50
L_c_s1:
    s_mov_b64 exec, -1
    v_cmp_ne_u32 vcc, 0, v96
    v_lshrrev_b32 v48, v97, v96
    v_ffbl_b32 v48, v48
    s_cbranch_vccz L_c_red
    v_add_u32 v48, v48, v97
    v_and_b32 v48, 7, v48
    v_lshl_add_u32 v51, v48, 10, v65
    v_lshlrev_b32 v89, v48, s26
    v_add_u32 v97, 1, v48
    s_mov_b64 exec, vcc
    buffer_load_dwordx4 v[140:143], v51, s[32:35], s30 offen sc1
    s_mov_b64 exec, -1
    s_waitcnt vmcnt(3)
    v_sub_u32_dpp v48, v147, v147 row_half_mirror row_mask:0xf bank_mask:0xf
    v_and_b32 v49, v90, v96
    v_cmpx_eq_u32 vcc, v48, v246
    v_cmpx_ne_u32 vcc, 0, v49
    v_xor_b32 v96, v96, v90
    v_sub_u32 v49, v147, v247
    v_sub_f32 v49, v49, v42
    v_exp_f32 v49, v49
    s_cbranch_execz L_c_s2
    v_cvt_pk_bf16_f32 v49, v49, 0
    v_lshlrev_b32 v50, 16, v49
    v_dot2c_f32_bf16 v16, v144, v49
    v_dot2c_f32_bf16 v18, v145, v49
    v_dot2c_f32_bf16 v20, v146, v49
    v_add_f32 v22, v22, v50
    v_dot2c_f32_bf16 v17, v144, v50
    v_dot2c_f32_bf16 v19, v145, v50
    v_dot2c_f32_bf16 v21, v146, v50
L_c_s2:
    s_mov_b64 exec, -1
    v_cmp_ne_u32 vcc, 0, v96
    v_lshrrev_b32 v48, v97, v96
    v_ffbl_b32 v48, v48
    s_cbranch_vccz L_c_red
    v_add_u32 v48, v48, v97
    v_and_b32 v48, 7, v48
    v_lshl_add_u32 v51, v48, 10, v65
    v_lshlrev_b32 v90, v48, s26
    v_add_u32 v97, 1, v48
    s_mov_b64 exec, vcc
    buffer_load_dwordx4 v[144:147], v51, s[32:35], s30 offen sc1
    s_mov_b64 exec, -1
    s_waitcnt vmcnt(3)
    v_sub_u32_dpp v48, v151, v151 row_half_mirror row_mask:0xf bank_mask:0xf
    v_and_b32 v49, v91, v96
    v_cmpx_eq_u32 vcc, v48, v246
    v_cmpx_ne_u32 vcc, 0, v49
    v_xor_b32 v96, v96, v91
    v_sub_u32 v49, v151, v247
    v_sub_f32 v49, v49, v42
    v_exp_f32 v49, v49
    s_cbranch_execz L_c_s3
    v_cvt_pk_bf16_f32 v49, v49, 0
    v_lshlrev_b32 v50, 16, v49
    v_dot2c_f32_bf16 v16, v148, v49
    v_dot2c_f32_bf16 v18, v149, v49
    v_dot2c_f32_bf16 v20, v150, v49
    v_add_f32 v22, v22, v50
    v_dot2c_f32_bf16 v17, v148, v50
    v_dot2c_f32_bf16 v19, v149, v50
    v_dot2c_f32_bf16 v21, v150, v50
L_c_s3:
    s_mov_b64 exec, -1
    v_cmp_ne_u32 vcc, 0, v96
    v_lshrrev_b32 v48, v97, v96
    v_ffbl_b32 v48, v48
    s_cbranch_vccz L_c_red
    v_add_u32 v48, v48, v97
    v_and_b32 v48, 7, v48
    v_lshl_add_u32 v51, v48, 10, v65
    v_lshlrev_b32 v91, v48, s26
    v_add_u32 v97, 1, v48
    s_mov_b64 exec, vcc
    buffer_load_dwordx4 v[148:151], v51, s[32:35], s30 offen sc1
    s_mov_b64 exec, -1
    s_add_u32 s53, s53, 1
    s_cmp_lt_u32 s53, 65536
    s_cbranch_scc1 L_c_loop
L_c_red:
    v_mov_b32 v23, v22
    v_permlane32_swap_b32 v16, v20
    v_permlane32_swap_b32 v17, v21
    v_permlane32_swap_b32 v18, v22
    v_permlane32_swap_b32 v19, v23
    v_add_f32 v16, v16, v20
    v_add_f32 v17, v17, v21
    v_add_f32 v18, v18, v22
    v_add_f32 v19, v19, v23
    s_nop 0
    v_permlane16_swap_b32 v16, v18
    v_permlane16_swap_b32 v17, v19
    v_add_f32 v16, v16, v18
    v_add_f32 v17, v17, v19
    s_nop 0
    v_add_f32_dpp v48, v16, v16 row_ror:8 row_mask:0xf bank_mask:0x3
    s_nop 1
    v_add_f32_dpp v48, v17, v17 row_ror:8 row_mask:0xf bank_mask:0xc
    ds_write_b32 v250, v48
    s_waitcnt lgkmcnt(0)
    s_barrier
    ds_read_b128 v[48:51], v251 offset:768
    ds_read_b128 v[52:55], v65
    v_lshlrev_b32 v18, 16, v249
    s_waitcnt lgkmcnt(1)
    v_add_f32 v48, v48, v49
    v_add_f32 v50, v50, v51
    v_add_f32 v48, v48, v50
    v_cmp_nlt_f32 vcc, v48, v232
    v_rcp_f32 v48, v48
    s_waitcnt lgkmcnt(0)
    s_cbranch_vccnz L_c_slow
L_c_out:
    s_cmp_lg_u32 s3, 0
    s_cbranch_scc1 L_fin
    v_add_f32 v52, v52, v53
    v_add_f32 v54, v54, v55
    v_add_f32 v52, v52, v54
    v_fmac_f32 v18, v52, v48
    v_cvt_pk_bf16_f32 v18, v18, v18
    buffer_store_short v18, v248, s[68:71], 0 offen sc1
    s_cmp_lg_u32 s29, 0
    s_cbranch_scc1 L_fin
    v_mov_b32 v48, s39
    v_mov_b32 v49, 0
    s_mov_b64 exec, 1
    buffer_store_dword v48, v49, s[32:35], 0 offen offset:0 sc1
    s_mov_b64 exec, -1
L_fin:
L_end:
    s_endpgm
L_hot:
L_prod:
    s_cmp_lg_u32 s3, 0
    s_cbranch_scc1 L_p_noq
    s_mov_b32 m0, 147456
    s_nop 0
    buffer_load_dwordx4 v16, s[72:75], 0 offen offset:0  lds
    buffer_load_dwordx4 v17, s[72:75], 0 offen offset:1024  lds
    buffer_load_dwordx4 v18, s[72:75], 0 offen offset:2048  lds
    buffer_load_dwordx4 v19, s[72:75], 0 offen offset:3072  lds
    s_mov_b32 m0, 151552
    s_nop 0
    buffer_load_dwordx4 v20, s[72:75], 0 offen offset:0  lds
    buffer_load_dwordx4 v21, s[72:75], 0 offen offset:1024  lds
L_p_noq:
    s_mul_i32 s60, s3, 18432
    s_add_u32 m0, s60, 73728
    s_nop 0
    buffer_load_dwordx4 v16, s[64:67], s60 offen offset:0  lds
    buffer_load_dwordx4 v17, s[64:67], s60 offen offset:1024  lds
    buffer_load_dwordx4 v18, s[64:67], s60 offen offset:2048  lds
    buffer_load_dwordx4 v19, s[64:67], s60 offen offset:3072  lds
    s_add_u32 m0, s60, 77824
    s_nop 0
    buffer_load_dwordx4 v20, s[64:67], s60 offen offset:0  lds
    buffer_load_dwordx4 v21, s[64:67], s60 offen offset:1024  lds
    s_add_u32 s60, s60, 6144
    s_add_u32 m0, s60, 73728
    s_nop 0
    buffer_load_dwordx4 v16, s[64:67], s60 offen offset:0  lds
    buffer_load_dwordx4 v17, s[64:67], s60 offen offset:1024  lds
    buffer_load_dwordx4 v18, s[64:67], s60 offen offset:2048  lds
    buffer_load_dwordx4 v19, s[64:67], s60 offen offset:3072  lds
    s_add_u32 m0, s60, 77824
    s_nop 0
    buffer_load_dwordx4 v20, s[64:67], s60 offen offset:0  lds
    buffer_load_dwordx4 v21, s[64:67], s60 offen offset:1024  lds
    s_add_u32 s60, s60, 6144
    s_add_u32 m0, s60, 73728
    s_nop 0
    buffer_load_dwordx4 v16, s[64:67], s60 offen offset:0  lds
    v_mov_b32 v52, 0x3f803f80
    v_mov_b32 v56, 0x3ebcbe62
    s_mov_b32 s44, 0x100001
    s_mov_b32 s45, 0x10000100
    v_mov_b32 v53, 0x3f803f80
    v_mov_b32 v57, 0x3ebcbe62
    s_mov_b32 s46, 0x200002
    buffer_load_dwordx4 v17, s[64:67], s60 offen offset:1024  lds
    s_mov_b32 s47, 0x20000200
    v_mov_b32 v54, 0x3f803f80
    v_mov_b32 v58, 0x3ebcbe62
    s_mov_b32 s48, 0x400004
    s_mov_b32 s49, 0x40000400
    v_mov_b32 v55, 0x3f803f80
    v_mov_b32 v59, 0x3ebcbe62
    buffer_load_dwordx4 v18, s[64:67], s60 offen offset:2048  lds
    s_mov_b32 s50, 0x800008
    s_mov_b32 s51, 0x80000800
    v_mov_b32 v60, 0x43400000
    v_lshrrev_b32 v1, 5, v0
    v_lshlrev_b32 v1, 8, v1
    v_and_b32 v2, 15, v0
    v_lshl_add_u32 v1, v2, 4, v1
    buffer_load_dwordx4 v19, s[64:67], s60 offen offset:3072  lds
    v_bfe_u32 v2, v0, 4, 1
    v_lshl_add_u32 v1, v2, 3, v1
    s_mul_i32 s56, s3, 1536
    s_add_u32 s56, s56, 153600
    v_add_u32 v134, s56, v1
    v_bfe_u32 v1, v0, 4, 1
    v_lshrrev_b32 v5, 5, v0
    s_add_u32 m0, s60, 77824
    s_nop 0
    buffer_load_dwordx4 v20, s[64:67], s60 offen offset:0  lds
    v_lshl_or_b32 v1, v1, 1, v5
    v_bfe_u32 v2, v0, 2, 2
    v_lshl_add_u32 v3, v1, 3, v2
    v_mul_u32_u24 v3, 384, v3
    v_and_b32 v4, 1, v0
    v_lshl_add_u32 v3, v4, 3, v3
    v_add_u32 v3, 73728, v3
    buffer_load_dwordx4 v21, s[64:67], s60 offen offset:1024  lds
    v_and_or_b32 v2, v2, 2, v5
    v_bfe_u32 v4, v0, 1, 1
    v_xor_b32 v2, v2, v4
    s_mul_i32 s56, s3, 6
    s_add_u32 s57, s56, 0
    v_xor_b32 v4, s57, v2
    v_lshl_add_u32 v124, v4, 4, v3
    s_lshl_b32 s61, s43, 2
    s_add_u32 s61, s61, s3
    s_mul_i32 s60, s61, 6144
    s_add_u32 m0, s41, 6144
    s_nop 0
    buffer_load_dwordx4 v16, s[68:71], s60 offen offset:0  lds
    v_xor_b32 v125, 64, v124
    s_add_u32 s57, s56, 2
    v_xor_b32 v4, s57, v2
    v_lshl_add_u32 v126, v4, 4, v3
    v_xor_b32 v127, 64, v126
    s_add_u32 s57, s56, 4
    v_xor_b32 v4, s57, v2
    buffer_load_dwordx4 v17, s[68:71], s60 offen offset:1024  lds
    v_lshl_add_u32 v128, v4, 4, v3
    v_xor_b32 v129, 64, v128
    v_and_b32 v2, 15, v0
    v_bfe_u32 v3, v0, 3, 1
    v_and_or_b32 v4, v0, 6, v3
    v_xor_b32 v4, v4, v1
    v_mul_u32_u24 v2, 384, v2
    buffer_load_dwordx4 v18, s[68:71], s60 offen offset:2048  lds
    v_lshl_add_u32 v2, v4, 4, v2
    v_add_u32 v132, 147456, v2
    v_xor_b32 v133, 64, v132
    s_and_b32 s56, s3, 1
    s_lshl_b32 s56, s56, 2
    s_lshr_b32 s57, s3, 1
    s_mul_i32 s57, s57, 24576
    buffer_load_dwordx4 v19, s[68:71], s60 offen offset:3072  lds
    s_add_u32 s57, s57, 30720
    v_and_b32 v1, 11, v0
    v_or_b32 v1, s56, v1
    v_and_or_b32 v2, v1, 6, v3
    v_lshrrev_b32 v3, 4, v0
    v_xor_b32 v2, v2, v3
    v_mul_u32_u24 v1, 384, v1
    s_add_u32 m0, s41, 10240
    s_nop 0
    buffer_load_dwordx4 v20, s[68:71], s60 offen offset:0  lds
    v_lshl_add_u32 v1, v2, 4, v1
    v_bfe_u32 v2, v0, 2, 1
    v_mul_u32_u24 v2, 12288, v2
    v_add3_u32 v130, s57, v1, v2
    v_xor_b32 v131, 64, v130
    v_add_u32 v135, 153600, v65
    buffer_load_dwordx4 v21, s[68:71], s60 offen offset:1024  lds
    s_waitcnt vmcnt(24)
    s_barrier
    s_load_dword s38, s[22:23], 0
    ds_read_b128 v[136:139], v132 offset:0
    ds_read_b128 v[140:143], v133 offset:0
    ds_read_b128 v[144:147], v132 offset:128
    ds_read_b128 v[148:151], v133 offset:128
    ds_read_b128 v[152:155], v132 offset:256
    ds_read_b128 v[156:159], v133 offset:256
    s_add_u32 m0, s40, 0
    s_add_u32 s57, s36, 0
    buffer_load_dwordx4 v16, s[28:31], s57 offen offset:0 nt lds
    buffer_load_dwordx4 v17, s[28:31], s57 offen offset:1024 nt lds
    buffer_load_dwordx4 v18, s[28:31], s57 offen offset:2048 nt lds
    buffer_load_dwordx4 v19, s[28:31], s57 offen offset:3072 nt lds
    s_add_u32 m0, s40, 4096
    s_nop 0
    buffer_load_dwordx4 v20, s[28:31], s57 offen offset:0 nt lds
    buffer_load_dwordx4 v21, s[28:31], s57 offen offset:1024 nt lds
    s_waitcnt lgkmcnt(0)
    v_mfma_f32_16x16x32_bf16 v[112:115], v[136:139], v[136:139], 0
    v_mfma_f32_16x16x32_bf16 v[116:119], v[52:55], v[136:139], 0
    s_add_u32 m0, s41, 0
    s_add_u32 s58, s37, 0
    buffer_load_dwordx4 v22, s[24:27], s58 offen offset:0 nt lds
    v_mfma_f32_16x16x32_bf16 v[112:115], v[140:143], v[140:143], v[112:115]
    v_mfma_f32_16x16x32_bf16 v[116:119], v[52:55], v[140:143], v[116:119]
    buffer_load_dwordx4 v23, s[24:27], s58 offen offset:1024 nt lds
    v_mfma_f32_16x16x32_bf16 v[112:115], v[144:147], v[144:147], v[112:115]
    v_mfma_f32_16x16x32_bf16 v[116:119], v[52:55], v[144:147], v[116:119]
    buffer_load_dwordx4 v24, s[24:27], s58 offen offset:2048 nt lds
    v_mfma_f32_16x16x32_bf16 v[112:115], v[148:151], v[148:151], v[112:115]
    v_mfma_f32_16x16x32_bf16 v[116:119], v[52:55], v[148:151], v[116:119]
    v_mfma_f32_16x16x32_bf16 v[112:115], v[152:155], v[152:155], v[112:115]
    v_mfma_f32_16x16x32_bf16 v[116:119], v[52:55], v[152:155], v[116:119]
    v_mfma_f32_16x16x32_bf16 v[112:115], v[156:159], v[156:159], v[112:115]
    v_mfma_f32_16x16x32_bf16 v[116:119], v[52:55], v[156:159], v[116:119]
    s_mul_i32 s39, s38, 0x9e3779b1
    s_add_u32 s39, s39, 0x7f4a7c16
    s_or_b32 s39, s39, 1
    s_lshl_b32 s61, s61, 10
    s_add_u32 s61, s61, 16384
    s_waitcnt vmcnt(15)
    s_barrier
    ds_read_b64_tr_b16 v[160:161], v124 offset:0
    ds_read_b64_tr_b16 v[162:163], v125 offset:1536
    ds_read_b64_tr_b16 v[184:185], v126 offset:0
    ds_read_b64_tr_b16 v[186:187], v127 offset:1536
    ds_read_b64_tr_b16 v[208:209], v128 offset:0
    ds_read_b64_tr_b16 v[210:211], v129 offset:1536
    ds_read_b64_tr_b16 v[164:165], v124 offset:12288
    ds_read_b64_tr_b16 v[166:167], v125 offset:13824
    ds_read_b64_tr_b16 v[188:189], v126 offset:12288
    ds_read_b64_tr_b16 v[190:191], v127 offset:13824
    ds_read_b64_tr_b16 v[212:213], v128 offset:12288
    ds_read_b64_tr_b16 v[214:215], v129 offset:13824
    v_cndmask_b32 v3, 0, v112, s[44:45]
    v_cndmask_b32 v3, v3, v113, s[46:47]
    v_cndmask_b32 v3, v3, v114, s[48:49]
    v_cndmask_b32 v3, v3, v115, s[50:51]
    v_mul_f32 v6, 0x3baaaaab, v116
    ds_read_b64_tr_b16 v[168:169], v124 offset:24576
    ds_read_b64_tr_b16 v[170:171], v125 offset:26112
    v_mfma_f32_16x16x4_f32 v[120:123], v60, v3, v[56:59]
    s_waitcnt lgkmcnt(12)
    v_mfma_f32_16x16x32_bf16 v[88:91], v[160:163], v[136:139], 0
    ds_read_b64_tr_b16 v[192:193], v126 offset:24576
    v_mfma_f32_16x16x32_bf16 v[100:103], v[160:163], v[52:55], 0
    ds_read_b64_tr_b16 v[194:195], v127 offset:26112
    s_waitcnt lgkmcnt(12)
    v_mfma_f32_16x16x32_bf16 v[92:95], v[184:187], v[136:139], 0
    ds_read_b64_tr_b16 v[216:217], v128 offset:24576
    v_mfma_f32_16x16x32_bf16 v[104:107], v[184:187], v[52:55], 0
    ds_read_b64_tr_b16 v[218:219], v129 offset:26112
    s_waitcnt lgkmcnt(12)
    v_mfma_f32_16x16x32_bf16 v[96:99], v[208:211], v[136:139], 0
    ds_read_b64_tr_b16 v[172:173], v124 offset:36864
    v_mfma_f32_16x16x32_bf16 v[108:111], v[208:211], v[52:55], 0
    ds_read_b64_tr_b16 v[174:175], v125 offset:38400
    s_waitcnt lgkmcnt(12)
    v_mfma_f32_16x16x32_bf16 v[88:91], v[164:167], v[140:143], v[88:91]
    ds_read_b64_tr_b16 v[196:197], v126 offset:36864
    v_mfma_f32_16x16x32_bf16 v[100:103], v[164:167], v[52:55], v[100:103]
    ds_read_b64_tr_b16 v[198:199], v127 offset:38400
    s_waitcnt lgkmcnt(12)
    v_mfma_f32_16x16x32_bf16 v[92:95], v[188:191], v[140:143], v[92:95]
    ds_read_b64_tr_b16 v[220:221], v128 offset:36864
    v_mfma_f32_16x16x32_bf16 v[104:107], v[188:191], v[52:55], v[104:107]
    ds_read_b64_tr_b16 v[222:223], v129 offset:38400
    s_waitcnt lgkmcnt(12)
    v_mfma_f32_16x16x32_bf16 v[96:99], v[212:215], v[140:143], v[96:99]
    ds_read_b64_tr_b16 v[176:177], v124 offset:49152
    v_mfma_f32_16x16x32_bf16 v[108:111], v[212:215], v[52:55], v[108:111]
    ds_read_b64_tr_b16 v[178:179], v125 offset:50688
    s_waitcnt lgkmcnt(12)
    v_mfma_f32_16x16x32_bf16 v[88:91], v[168:171], v[144:147], v[88:91]
    ds_read_b64_tr_b16 v[200:201], v126 offset:49152
    v_mfma_f32_16x16x32_bf16 v[100:103], v[168:171], v[52:55], v[100:103]
    ds_read_b64_tr_b16 v[202:203], v127 offset:50688
    s_waitcnt lgkmcnt(12)
    v_mfma_f32_16x16x32_bf16 v[92:95], v[192:195], v[144:147], v[92:95]
    ds_read_b64_tr_b16 v[224:225], v128 offset:49152
    v_mfma_f32_16x16x32_bf16 v[104:107], v[192:195], v[52:55], v[104:107]
    ds_read_b64_tr_b16 v[226:227], v129 offset:50688
    s_waitcnt lgkmcnt(12)
    v_mfma_f32_16x16x32_bf16 v[96:99], v[216:219], v[144:147], v[96:99]
    ds_read_b64_tr_b16 v[180:181], v124 offset:61440
    v_mfma_f32_16x16x32_bf16 v[108:111], v[216:219], v[52:55], v[108:111]
    ds_read_b64_tr_b16 v[182:183], v125 offset:62976
    s_waitcnt lgkmcnt(12)
    v_mfma_f32_16x16x32_bf16 v[88:91], v[172:175], v[148:151], v[88:91]
    ds_read_b64_tr_b16 v[204:205], v126 offset:61440
    v_mfma_f32_16x16x32_bf16 v[100:103], v[172:175], v[52:55], v[100:103]
    ds_read_b64_tr_b16 v[206:207], v127 offset:62976
    s_waitcnt lgkmcnt(12)
    v_mfma_f32_16x16x32_bf16 v[92:95], v[196:199], v[148:151], v[92:95]
    ds_read_b64_tr_b16 v[228:229], v128 offset:61440
    v_mfma_f32_16x16x32_bf16 v[104:107], v[196:199], v[52:55], v[104:107]
    ds_read_b64_tr_b16 v[230:231], v129 offset:62976
    s_waitcnt lgkmcnt(12)
    v_mfma_f32_16x16x32_bf16 v[96:99], v[220:223], v[148:151], v[96:99]
    v_fma_f32 v5, -v116, v116, v120
    v_mfma_f32_16x16x32_bf16 v[108:111], v[220:223], v[52:55], v[108:111]
    v_max_f32 v5, v5, v56
    s_waitcnt lgkmcnt(10)
    v_mfma_f32_16x16x32_bf16 v[88:91], v[176:179], v[152:155], v[88:91]
    v_rsq_f32 v5, v5
    v_mfma_f32_16x16x32_bf16 v[100:103], v[176:179], v[52:55], v[100:103]
    v_mov_b32 v122, s39
    s_waitcnt lgkmcnt(8)
    v_mfma_f32_16x16x32_bf16 v[92:95], v[200:203], v[152:155], v[92:95]
    v_mul_f32 v5, v60, v5
    v_mfma_f32_16x16x32_bf16 v[104:107], v[200:203], v[52:55], v[104:107]
    v_mov_b32 v123, s39
    s_waitcnt lgkmcnt(6)
    v_mfma_f32_16x16x32_bf16 v[96:99], v[224:227], v[152:155], v[96:99]
    v_mfma_f32_16x16x32_bf16 v[108:111], v[224:227], v[52:55], v[108:111]
    s_waitcnt lgkmcnt(4)
    v_mfma_f32_16x16x32_bf16 v[88:91], v[180:183], v[156:159], v[88:91]
    v_mfma_f32_16x16x32_bf16 v[100:103], v[180:183], v[52:55], v[100:103]
    s_waitcnt lgkmcnt(2)
    v_mfma_f32_16x16x32_bf16 v[92:95], v[204:207], v[156:159], v[92:95]
    v_mfma_f32_16x16x32_bf16 v[104:107], v[204:207], v[52:55], v[104:107]
    s_waitcnt lgkmcnt(0)
    v_mfma_f32_16x16x32_bf16 v[96:99], v[228:231], v[156:159], v[96:99]
    v_mfma_f32_16x16x32_bf16 v[108:111], v[228:231], v[52:55], v[108:111]
    s_nop 1
    v_fma_f32 v88, -v6, v100, v88
    v_fma_f32 v89, -v6, v101, v89
    v_fma_f32 v90, -v6, v102, v90
    v_fma_f32 v91, -v6, v103, v91
    v_mul_f32 v88, v88, v5
    v_mul_f32 v89, v89, v5
    v_mul_f32 v90, v90, v5
    v_mul_f32 v91, v91, v5
    v_cvt_pk_bf16_f32 v112, v88, v89
    v_cvt_pk_bf16_f32 v113, v90, v91
    ds_write_b64 v134, v[112:113] offset:0
    v_fma_f32 v92, -v6, v104, v92
    v_fma_f32 v93, -v6, v105, v93
    v_fma_f32 v94, -v6, v106, v94
    v_fma_f32 v95, -v6, v107, v95
    v_mul_f32 v92, v92, v5
    v_mul_f32 v93, v93, v5
    v_mul_f32 v94, v94, v5
    v_mul_f32 v95, v95, v5
    v_cvt_pk_bf16_f32 v114, v92, v93
    v_cvt_pk_bf16_f32 v115, v94, v95
    ds_write_b64 v134, v[114:115] offset:512
    v_fma_f32 v96, -v6, v108, v96
    v_fma_f32 v97, -v6, v109, v97
    v_fma_f32 v98, -v6, v110, v98
    v_fma_f32 v99, -v6, v111, v99
    v_mul_f32 v96, v96, v5
    v_mul_f32 v97, v97, v5
    v_mul_f32 v98, v98, v5
    v_mul_f32 v99, v99, v5
    v_cvt_pk_bf16_f32 v116, v96, v97
    v_cvt_pk_bf16_f32 v117, v98, v99
    ds_write_b64 v134, v[116:117] offset:1024
    s_waitcnt vmcnt(9)
    s_waitcnt lgkmcnt(0)
    s_barrier
    ds_read_b128 v[136:139], v135 offset:0
    ds_read_b128 a[96:99], v130 offset:0
    ds_read_b128 v[140:143], v135 offset:1024
    ds_read_b128 a[100:103], v131 offset:0
    ds_read_b128 v[144:147], v135 offset:2048
    ds_read_b128 a[104:107], v130 offset:128
    ds_read_b128 v[148:151], v135 offset:3072
    ds_read_b128 a[108:111], v131 offset:128
    ds_read_b128 v[152:155], v135 offset:4096
    ds_read_b128 a[112:115], v130 offset:256
    ds_read_b128 v[156:159], v135 offset:5120
    ds_read_b128 a[116:119], v131 offset:256
    s_waitcnt lgkmcnt(10)
    v_mfma_f32_16x16x32_bf16 v[88:91], a[96:99], v[136:139], 0
    s_waitcnt lgkmcnt(8)
    v_mfma_f32_16x16x32_bf16 v[92:95], a[100:103], v[140:143], 0
    s_waitcnt lgkmcnt(6)
    v_mfma_f32_16x16x32_bf16 v[88:91], a[104:107], v[144:147], v[88:91]
    s_waitcnt lgkmcnt(4)
    v_mfma_f32_16x16x32_bf16 v[92:95], a[108:111], v[148:151], v[92:95]
    s_waitcnt lgkmcnt(2)
    v_mfma_f32_16x16x32_bf16 v[88:91], a[112:115], v[152:155], v[88:91]
    s_waitcnt lgkmcnt(0)
    v_mfma_f32_16x16x32_bf16 v[92:95], a[116:119], v[156:159], v[92:95]
    s_nop 7
    v_add_f32 v88, v88, v92
    v_add_f32 v89, v89, v93
    v_add_f32 v90, v90, v94
    v_add_f32 v91, v91, v95
    v_mul_f32 v88, 0x419fecaf, v88
    v_mul_f32 v89, 0x419fecaf, v89
    v_mul_f32 v90, 0x419fecaf, v90
    v_mul_f32 v91, 0x419fecaf, v91
    v_cvt_pk_bf16_f32 v120, v88, v89
    v_cvt_pk_bf16_f32 v121, v90, v91
    buffer_store_dwordx4 v[120:123], v65, s[32:35], s61 offen sc1
    buffer_load_dwordx4 v25, s[24:27], s58 offen offset:3072 nt lds
    s_add_u32 m0, s41, 4096
    s_nop 0
    buffer_load_dwordx4 v26, s[24:27], s58 offen offset:0 nt lds
    buffer_load_dwordx4 v27, s[24:27], s58 offen offset:1024 nt lds
    s_barrier
    buffer_load_dwordx4 v28, s[24:27], s58 offen offset:2048 nt lds
    buffer_load_dwordx4 v29, s[24:27], s58 offen offset:3072 nt lds
    s_add_u32 m0, s41, 8192
    s_nop 0
    buffer_load_dwordx4 v30, s[24:27], s58 offen offset:0 nt lds
    buffer_load_dwordx4 v31, s[24:27], s58 offen offset:1024 nt lds
    buffer_load_dwordx4 v32, s[24:27], s58 offen offset:2048 nt lds
    buffer_load_dwordx4 v33, s[24:27], s58 offen offset:3072 nt lds
    v_and_b32 v1, 15, v0
    v_lshrrev_b32 v6, 5, v0
    v_bfe_u32 v3, v0, 4, 1
    v_lshl_or_b32 v3, v3, 1, v6
    v_lshrrev_b32 v4, 2, v0
    v_bfe_u32 v5, v0, 1, 1
    v_lshrrev_b32 v6, 3, v1
    v_and_or_b32 v6, v1, 6, v6
    v_xor_b32 v6, v6, v3
    v_mul_u32_u24 v7, 384, v1
    v_lshl_add_u32 v6, v6, 4, v7
    v_add_u32 v34, s40, v6
    v_xor_b32 v35, 64, v34
    v_lshrrev_b32 v6, 3, v1
    v_and_b32 v7, 7, v1
    v_lshl_or_b32 v6, v7, 1, v6
    v_xor_b32 v6, v6, v3
    v_mul_u32_u24 v7, 768, v1
    v_lshl_add_u32 v6, v6, 4, v7
    v_add_u32 v40, s41, v6
    v_xor_b32 v41, 0x40, v40
    v_xor_b32 v42, 0x80, v40
    v_xor_b32 v43, 0xc0, v40
    v_and_b32 v2, 1, v0
    v_lshlrev_b32 v2, 3, v2
    s_mul_i32 s56, s3, 96
    v_lshrrev_b32 v6, 3, v4
    v_and_or_b32 v6, v4, 6, v6
    v_xor_b32 v6, v6, v5
    v_lshl_add_u32 v6, v6, 4, v2
    v_mul_u32_u24 v7, 384, v4
    s_add_u32 s57, s56, 0
    v_xad_u32 v36, v6, s57, v7
    s_add_u32 s57, s56, 32
    v_xad_u32 v37, v6, s57, v7
    s_add_u32 s57, s56, 64
    v_xad_u32 v38, v6, s57, v7
    v_lshrrev_b32 v6, 3, v4
    v_and_b32 v3, 7, v4
    v_lshl_or_b32 v6, v3, 1, v6
    v_xor_b32 v6, v6, v5
    v_lshl_add_u32 v6, v6, 4, v2
    v_lshlrev_b32 v7, 1, v7
    v_add_u32 v7, 24576, v7
    s_add_u32 s57, s56, 0
    v_xad_u32 v44, v6, s57, v7
    s_add_u32 s57, s56, 384
    v_xad_u32 v45, v6, s57, v7
    s_add_u32 s57, s56, 32
    v_xad_u32 v46, v6, s57, v7
    s_add_u32 s57, s56, 416
    v_xad_u32 v47, v6, s57, v7
    s_add_u32 s57, s56, 64
    v_xad_u32 v48, v6, s57, v7
    s_add_u32 s57, s56, 448
    v_xad_u32 v49, v6, s57, v7
    v_lshrrev_b32 v1, 5, v0
    v_lshlrev_b32 v1, 8, v1
    v_and_b32 v2, 15, v0
    v_lshl_add_u32 v1, v2, 4, v1
    v_bfe_u32 v2, v0, 4, 1
    v_lshl_add_u32 v1, v2, 3, v1
    s_mul_i32 s56, s3, 1536
    s_add_u32 s56, s56, 147456
    v_add_u32 v236, s56, v1
    s_mul_i32 s56, s3, 3072
    s_add_u32 s56, s56, 24576
    v_add_u32 v237, s56, v65
    v_add_u32 v238, s41, v65
    s_lshl_b32 s56, s3, 10
    v_add_u32 v240, 159744, v65
    v_add_u32 v239, s56, v240
    v_add_u32 v241, 147456, v65
    v_bfe_u32 v1, v0, 2, 2
    v_lshrrev_b32 v2, 4, v0
    v_lshl_or_b32 v1, v1, 4, v2
    v_mul_u32_u24 v1, 32768, v1
    v_and_b32 v2, 3, v0
    v_lshl_or_b32 v242, v2, 4, v1
    v_xor_b32 v243, 0x70, v242
    s_mul_i32 s56, s3, 3
    v_min_u32 v1, 2, v0
    v_add_u32 v1, s56, v1
    v_lshlrev_b32 v245, 7, v1
    v_lshlrev_b32 v1, 3, v0
    v_add_u32 v254, 126976, v1
    s_lshl_b32 s56, s3, 9
    v_add_u32 v238, s56, v254
    v_add_u32 v253, 122880, v65
    s_lshl_b32 s56, s3, 10
    v_add_u32 v237, s56, v253
    s_mov_b32 s52, 0x41c00000
    s_add_u32 m0, s42, 0
    s_add_u32 s59, s37, 196608
    buffer_load_dwordx4 v22, s[24:27], s59 offen offset:0 nt lds
    buffer_load_dwordx4 v23, s[24:27], s59 offen offset:1024 nt lds
    buffer_load_dwordx4 v24, s[24:27], s59 offen offset:2048 nt lds
    buffer_load_dwordx4 v25, s[24:27], s59 offen offset:3072 nt lds
    s_add_u32 m0, s42, 4096
    s_nop 0
    buffer_load_dwordx4 v26, s[24:27], s59 offen offset:0 nt lds
    buffer_load_dwordx4 v27, s[24:27], s59 offen offset:1024 nt lds
    buffer_load_dwordx4 v28, s[24:27], s59 offen offset:2048 nt lds
    buffer_load_dwordx4 v29, s[24:27], s59 offen offset:3072 nt lds
    s_add_u32 m0, s42, 8192
    s_nop 0
    buffer_load_dwordx4 v30, s[24:27], s59 offen offset:0 nt lds
    buffer_load_dwordx4 v31, s[24:27], s59 offen offset:1024 nt lds
    buffer_load_dwordx4 v32, s[24:27], s59 offen offset:2048 nt lds
    buffer_load_dwordx4 v33, s[24:27], s59 offen offset:3072 nt lds
    s_mov_b32 s43, -1
    s_branch L_join
L_vprod:
    s_mul_i32 s60, s3, 18432
    s_add_u32 m0, s60, 73728
    s_nop 0
    buffer_load_dwordx4 v16, s[64:67], s60 offen offset:0  lds
    buffer_load_dwordx4 v17, s[64:67], s60 offen offset:1024  lds
    buffer_load_dwordx4 v18, s[64:67], s60 offen offset:2048  lds
    buffer_load_dwordx4 v19, s[64:67], s60 offen offset:3072  lds
    s_add_u32 m0, s60, 77824
    s_nop 0
    buffer_load_dwordx4 v20, s[64:67], s60 offen offset:0  lds
    buffer_load_dwordx4 v21, s[64:67], s60 offen offset:1024  lds
    s_add_u32 s60, s60, 6144
    s_add_u32 m0, s60, 73728
    s_nop 0
    buffer_load_dwordx4 v16, s[64:67], s60 offen offset:0  lds
    buffer_load_dwordx4 v17, s[64:67], s60 offen offset:1024  lds
    buffer_load_dwordx4 v18, s[64:67], s60 offen offset:2048  lds
    buffer_load_dwordx4 v19, s[64:67], s60 offen offset:3072  lds
    s_add_u32 m0, s60, 77824
    s_nop 0
    buffer_load_dwordx4 v20, s[64:67], s60 offen offset:0  lds
    buffer_load_dwordx4 v21, s[64:67], s60 offen offset:1024  lds
    s_add_u32 s60, s60, 6144
    s_add_u32 m0, s60, 73728
    s_nop 0
    buffer_load_dwordx4 v16, s[64:67], s60 offen offset:0  lds
    v_lshrrev_b32 v1, 4, v0
    v_and_b32 v5, 1, v1
    v_bfe_u32 v2, v0, 2, 2
    v_lshl_add_u32 v3, v1, 3, v2
    buffer_load_dwordx4 v17, s[64:67], s60 offen offset:1024  lds
    v_mul_u32_u24 v3, 384, v3
    v_and_b32 v4, 1, v0
    v_lshl_add_u32 v3, v4, 3, v3
    v_add_u32 v3, 73728, v3
    buffer_load_dwordx4 v18, s[64:67], s60 offen offset:2048  lds
    v_and_or_b32 v2, v2, 2, v5
    v_bfe_u32 v4, v0, 1, 1
    v_xor_b32 v2, v2, v4
    s_mul_i32 s56, s3, 6
    buffer_load_dwordx4 v19, s[64:67], s60 offen offset:3072  lds
    s_add_u32 s57, s56, 0
    v_xor_b32 v4, s57, v2
    v_lshl_add_u32 v136, v4, 4, v3
    v_xor_b32 v137, 64, v136
    s_add_u32 m0, s60, 77824
    s_nop 0
    buffer_load_dwordx4 v20, s[64:67], s60 offen offset:0  lds
    s_add_u32 s57, s56, 2
    v_xor_b32 v4, s57, v2
    v_lshl_add_u32 v138, v4, 4, v3
    v_xor_b32 v139, 64, v138
    buffer_load_dwordx4 v21, s[64:67], s60 offen offset:1024  lds
    s_add_u32 s57, s56, 4
    v_xor_b32 v4, s57, v2
    v_lshl_add_u32 v140, v4, 4, v3
    v_xor_b32 v141, 64, v140
    s_lshl_b32 s61, s43, 2
    s_add_u32 s61, s61, s3
    s_mul_i32 s60, s61, 6144
    s_add_u32 m0, s41, 6144
    s_nop 0
    buffer_load_dwordx4 v16, s[68:71], s60 offen offset:0  lds
    v_bfe_u32 v1, v0, 2, 1
    v_and_b32 v2, 3, v0
    v_lshl_or_b32 v2, v1, 3, v2
    v_and_or_b32 v1, v0, 2, v1
    buffer_load_dwordx4 v17, s[68:71], s60 offen offset:1024  lds
    v_lshrrev_b32 v3, 4, v0
    v_xor_b32 v1, v1, v3
    v_mul_u32_u24 v2, 384, v2
    v_lshl_add_u32 v1, v1, 4, v2
    buffer_load_dwordx4 v18, s[68:71], s60 offen offset:2048  lds
    v_bfe_u32 v2, v0, 3, 1
    v_mul_u32_u24 v2, 12288, v2
    s_mov_b32 s56, 30720
    v_add3_u32 v142, s56, v1, v2
    buffer_load_dwordx4 v19, s[68:71], s60 offen offset:3072  lds
    v_xor_b32 v143, 64, v142
    s_add_u32 m0, s41, 10240
    s_nop 0
    buffer_load_dwordx4 v20, s[68:71], s60 offen offset:0  lds
    buffer_load_dwordx4 v21, s[68:71], s60 offen offset:1024  lds
    s_load_dword s38, s[22:23], 0
    s_barrier
    s_add_u32 m0, s40, 0
    s_add_u32 s57, s36, 0
    buffer_load_dwordx4 v16, s[28:31], s57 offen offset:0 nt lds
    buffer_load_dwordx4 v17, s[28:31], s57 offen offset:1024 nt lds
    buffer_load_dwordx4 v18, s[28:31], s57 offen offset:2048 nt lds
    buffer_load_dwordx4 v19, s[28:31], s57 offen offset:3072 nt lds
    s_add_u32 m0, s40, 4096
    s_nop 0
    buffer_load_dwordx4 v20, s[28:31], s57 offen offset:0 nt lds
    buffer_load_dwordx4 v21, s[28:31], s57 offen offset:1024 nt lds
    s_add_u32 m0, s41, 0
    s_add_u32 s58, s37, 0
    buffer_load_dwordx4 v22, s[24:27], s58 offen offset:0 nt lds
    buffer_load_dwordx4 v23, s[24:27], s58 offen offset:1024 nt lds
    buffer_load_dwordx4 v24, s[24:27], s58 offen offset:2048 nt lds
    s_waitcnt vmcnt(9)
    s_barrier
    ds_read_b128 a[96:99], v142 offset:0
    ds_read_b128 a[100:103], v143 offset:0
    ds_read_b128 a[104:107], v142 offset:128
    ds_read_b128 a[108:111], v143 offset:128
    ds_read_b128 a[112:115], v142 offset:256
    ds_read_b128 a[116:119], v143 offset:256
    ds_read_b128 a[120:123], v143 offset:1536
    ds_read_b128 a[124:127], v142 offset:1536
    ds_read_b128 a[128:131], v143 offset:1664
    ds_read_b128 a[132:135], v142 offset:1664
    ds_read_b128 a[136:139], v143 offset:1792
    ds_read_b128 a[140:143], v142 offset:1792
    ds_read_b128 a[144:147], v142 offset:24576
    ds_read_b128 a[148:151], v143 offset:24576
    ds_read_b128 a[152:155], v142 offset:24704
    ds_read_b128 a[156:159], v143 offset:24704
    ds_read_b128 a[160:163], v142 offset:24832
    ds_read_b128 a[164:167], v143 offset:24832
    ds_read_b128 a[168:171], v143 offset:26112
    ds_read_b128 a[172:175], v142 offset:26112
    ds_read_b128 a[176:179], v143 offset:26240
    ds_read_b128 a[180:183], v142 offset:26240
    ds_read_b128 a[184:187], v143 offset:26368
    ds_read_b128 a[188:191], v142 offset:26368
    ds_read_b64_tr_b16 v[160:161], v136 offset:0
    ds_read_b64_tr_b16 v[162:163], v137 offset:1536
    ds_read_b64_tr_b16 v[164:165], v136 offset:12288
    ds_read_b64_tr_b16 v[166:167], v137 offset:13824
    ds_read_b64_tr_b16 v[168:169], v136 offset:24576
    ds_read_b64_tr_b16 v[170:171], v137 offset:26112
    ds_read_b64_tr_b16 v[172:173], v136 offset:36864
    ds_read_b64_tr_b16 v[174:175], v137 offset:38400
    ds_read_b64_tr_b16 v[176:177], v136 offset:49152
    ds_read_b64_tr_b16 v[178:179], v137 offset:50688
    ds_read_b64_tr_b16 v[180:181], v136 offset:61440
    ds_read_b64_tr_b16 v[182:183], v137 offset:62976
    ds_read_b64_tr_b16 v[184:185], v138 offset:0
    ds_read_b64_tr_b16 v[186:187], v139 offset:1536
    ds_read_b64_tr_b16 v[188:189], v138 offset:12288
    ds_read_b64_tr_b16 v[190:191], v139 offset:13824
    ds_read_b64_tr_b16 v[192:193], v138 offset:24576
    ds_read_b64_tr_b16 v[194:195], v139 offset:26112
    ds_read_b64_tr_b16 v[196:197], v138 offset:36864
    ds_read_b64_tr_b16 v[198:199], v139 offset:38400
    ds_read_b64_tr_b16 v[200:201], v138 offset:49152
    ds_read_b64_tr_b16 v[202:203], v139 offset:50688
    ds_read_b64_tr_b16 v[204:205], v138 offset:61440
    ds_read_b64_tr_b16 v[206:207], v139 offset:62976
    ds_read_b64_tr_b16 v[208:209], v140 offset:0
    ds_read_b64_tr_b16 v[210:211], v141 offset:1536
    ds_read_b64_tr_b16 v[212:213], v140 offset:12288
    ds_read_b64_tr_b16 v[214:215], v141 offset:13824
    ds_read_b64_tr_b16 v[216:217], v140 offset:24576
    ds_read_b64_tr_b16 v[218:219], v141 offset:26112
    ds_read_b64_tr_b16 v[220:221], v140 offset:36864
    ds_read_b64_tr_b16 v[222:223], v141 offset:38400
    ds_read_b64_tr_b16 v[224:225], v140 offset:49152
    ds_read_b64_tr_b16 v[226:227], v141 offset:50688
    ds_read_b64_tr_b16 v[228:229], v140 offset:61440
    ds_read_b64_tr_b16 v[230:231], v141 offset:62976
    s_waitcnt lgkmcnt(0)
    s_barrier
    s_mul_i32 s60, s3, 18432
    s_lshl_b32 s61, s43, 11
    s_add_u32 s60, s60, s61
    s_add_u32 s60, s60, 3145728
    v_mfma_f32_16x16x32_bf16 v[88:91], a[96:99], v[160:163], 0
    v_mfma_f32_16x16x32_bf16 v[92:95], a[120:123], v[160:163], 0
    v_mfma_f32_16x16x32_bf16 v[96:99], a[144:147], v[160:163], 0
    v_mfma_f32_16x16x32_bf16 v[100:103], a[168:171], v[160:163], 0
    buffer_load_dwordx4 v25, s[24:27], s58 offen offset:3072 nt lds
    v_mfma_f32_16x16x32_bf16 v[88:91], a[100:103], v[164:167], v[88:91]
    v_mfma_f32_16x16x32_bf16 v[92:95], a[124:127], v[164:167], v[92:95]
    v_mfma_f32_16x16x32_bf16 v[96:99], a[148:151], v[164:167], v[96:99]
    v_mfma_f32_16x16x32_bf16 v[100:103], a[172:175], v[164:167], v[100:103]
    s_add_u32 m0, s41, 4096
    s_nop 0
    buffer_load_dwordx4 v26, s[24:27], s58 offen offset:0 nt lds
    v_mfma_f32_16x16x32_bf16 v[88:91], a[104:107], v[168:171], v[88:91]
    v_mfma_f32_16x16x32_bf16 v[92:95], a[128:131], v[168:171], v[92:95]
    v_mfma_f32_16x16x32_bf16 v[96:99], a[152:155], v[168:171], v[96:99]
    v_mfma_f32_16x16x32_bf16 v[100:103], a[176:179], v[168:171], v[100:103]
    buffer_load_dwordx4 v27, s[24:27], s58 offen offset:1024 nt lds
    v_mfma_f32_16x16x32_bf16 v[88:91], a[108:111], v[172:175], v[88:91]
    v_mfma_f32_16x16x32_bf16 v[92:95], a[132:135], v[172:175], v[92:95]
    v_mfma_f32_16x16x32_bf16 v[96:99], a[156:159], v[172:175], v[96:99]
    v_mfma_f32_16x16x32_bf16 v[100:103], a[180:183], v[172:175], v[100:103]
    buffer_load_dwordx4 v28, s[24:27], s58 offen offset:2048 nt lds
    v_mfma_f32_16x16x32_bf16 v[88:91], a[112:115], v[176:179], v[88:91]
    v_mfma_f32_16x16x32_bf16 v[92:95], a[136:139], v[176:179], v[92:95]
    v_mfma_f32_16x16x32_bf16 v[96:99], a[160:163], v[176:179], v[96:99]
    v_mfma_f32_16x16x32_bf16 v[100:103], a[184:187], v[176:179], v[100:103]
    buffer_load_dwordx4 v29, s[24:27], s58 offen offset:3072 nt lds
    v_mfma_f32_16x16x32_bf16 v[88:91], a[116:119], v[180:183], v[88:91]
    v_mfma_f32_16x16x32_bf16 v[92:95], a[140:143], v[180:183], v[92:95]
    v_mfma_f32_16x16x32_bf16 v[96:99], a[164:167], v[180:183], v[96:99]
    v_mfma_f32_16x16x32_bf16 v[100:103], a[188:191], v[180:183], v[100:103]
    v_mfma_f32_16x16x32_bf16 v[104:107], a[96:99], v[184:187], 0
    v_mfma_f32_16x16x32_bf16 v[108:111], a[120:123], v[184:187], 0
    v_mfma_f32_16x16x32_bf16 v[112:115], a[144:147], v[184:187], 0
    v_mfma_f32_16x16x32_bf16 v[116:119], a[168:171], v[184:187], 0
    s_add_u32 m0, s41, 8192
    s_nop 0
    buffer_load_dwordx4 v30, s[24:27], s58 offen offset:0 nt lds
    v_mfma_f32_16x16x32_bf16 v[104:107], a[100:103], v[188:191], v[104:107]
    v_mfma_f32_16x16x32_bf16 v[108:111], a[124:127], v[188:191], v[108:111]
    v_mfma_f32_16x16x32_bf16 v[112:115], a[148:151], v[188:191], v[112:115]
    v_mfma_f32_16x16x32_bf16 v[116:119], a[172:175], v[188:191], v[116:119]
    buffer_load_dwordx4 v31, s[24:27], s58 offen offset:1024 nt lds
    v_mfma_f32_16x16x32_bf16 v[104:107], a[104:107], v[192:195], v[104:107]
    v_mfma_f32_16x16x32_bf16 v[108:111], a[128:131], v[192:195], v[108:111]
    v_mfma_f32_16x16x32_bf16 v[112:115], a[152:155], v[192:195], v[112:115]
    v_mfma_f32_16x16x32_bf16 v[116:119], a[176:179], v[192:195], v[116:119]
    buffer_load_dwordx4 v32, s[24:27], s58 offen offset:2048 nt lds
    v_cvt_pk_bf16_f32 v144, v88, v89
    v_cvt_pk_bf16_f32 v145, v90, v91
    v_cvt_pk_bf16_f32 v146, v92, v93
    v_cvt_pk_bf16_f32 v147, v94, v95
    buffer_store_dwordx4 v[144:147], v65, s[32:35], s60 offen offset:0 sc1
    v_cvt_pk_bf16_f32 v148, v96, v97
    v_cvt_pk_bf16_f32 v149, v98, v99
    v_cvt_pk_bf16_f32 v150, v100, v101
    v_cvt_pk_bf16_f32 v151, v102, v103
    buffer_store_dwordx4 v[148:151], v65, s[32:35], s60 offen offset:1024 sc1
    s_add_u32 s60, s60, 6144
    v_mfma_f32_16x16x32_bf16 v[104:107], a[108:111], v[196:199], v[104:107]
    v_mfma_f32_16x16x32_bf16 v[108:111], a[132:135], v[196:199], v[108:111]
    v_mfma_f32_16x16x32_bf16 v[112:115], a[156:159], v[196:199], v[112:115]
    v_mfma_f32_16x16x32_bf16 v[116:119], a[180:183], v[196:199], v[116:119]
    buffer_load_dwordx4 v33, s[24:27], s58 offen offset:3072 nt lds
    v_mfma_f32_16x16x32_bf16 v[104:107], a[112:115], v[200:203], v[104:107]
    v_mfma_f32_16x16x32_bf16 v[108:111], a[136:139], v[200:203], v[108:111]
    v_mfma_f32_16x16x32_bf16 v[112:115], a[160:163], v[200:203], v[112:115]
    v_mfma_f32_16x16x32_bf16 v[116:119], a[184:187], v[200:203], v[116:119]
    s_add_u32 m0, s42, 0
    s_add_u32 s59, s37, 196608
    buffer_load_dwordx4 v22, s[24:27], s59 offen offset:0 nt lds
    v_mfma_f32_16x16x32_bf16 v[104:107], a[116:119], v[204:207], v[104:107]
    v_mfma_f32_16x16x32_bf16 v[108:111], a[140:143], v[204:207], v[108:111]
    v_mfma_f32_16x16x32_bf16 v[112:115], a[164:167], v[204:207], v[112:115]
    v_mfma_f32_16x16x32_bf16 v[116:119], a[188:191], v[204:207], v[116:119]
    v_mfma_f32_16x16x32_bf16 v[120:123], a[96:99], v[208:211], 0
    v_mfma_f32_16x16x32_bf16 v[124:127], a[120:123], v[208:211], 0
    v_mfma_f32_16x16x32_bf16 v[128:131], a[144:147], v[208:211], 0
    v_mfma_f32_16x16x32_bf16 v[132:135], a[168:171], v[208:211], 0
    buffer_load_dwordx4 v23, s[24:27], s59 offen offset:1024 nt lds
    v_mfma_f32_16x16x32_bf16 v[120:123], a[100:103], v[212:215], v[120:123]
    v_mfma_f32_16x16x32_bf16 v[124:127], a[124:127], v[212:215], v[124:127]
    v_mfma_f32_16x16x32_bf16 v[128:131], a[148:151], v[212:215], v[128:131]
    v_mfma_f32_16x16x32_bf16 v[132:135], a[172:175], v[212:215], v[132:135]
    buffer_load_dwordx4 v24, s[24:27], s59 offen offset:2048 nt lds
    v_mfma_f32_16x16x32_bf16 v[120:123], a[104:107], v[216:219], v[120:123]
    v_mfma_f32_16x16x32_bf16 v[124:127], a[128:131], v[216:219], v[124:127]
    v_mfma_f32_16x16x32_bf16 v[128:131], a[152:155], v[216:219], v[128:131]
    v_mfma_f32_16x16x32_bf16 v[132:135], a[176:179], v[216:219], v[132:135]
    buffer_load_dwordx4 v25, s[24:27], s59 offen offset:3072 nt lds
    v_cvt_pk_bf16_f32 v152, v104, v105
    v_cvt_pk_bf16_f32 v153, v106, v107
    v_cvt_pk_bf16_f32 v154, v108, v109
    v_cvt_pk_bf16_f32 v155, v110, v111
    buffer_store_dwordx4 v[152:155], v65, s[32:35], s60 offen offset:0 sc1
    v_cvt_pk_bf16_f32 v156, v112, v113
    v_cvt_pk_bf16_f32 v157, v114, v115
    v_cvt_pk_bf16_f32 v158, v116, v117
    v_cvt_pk_bf16_f32 v159, v118, v119
    buffer_store_dwordx4 v[156:159], v65, s[32:35], s60 offen offset:1024 sc1
    s_add_u32 s60, s60, 6144
    v_mfma_f32_16x16x32_bf16 v[120:123], a[108:111], v[220:223], v[120:123]
    v_mfma_f32_16x16x32_bf16 v[124:127], a[132:135], v[220:223], v[124:127]
    v_mfma_f32_16x16x32_bf16 v[128:131], a[156:159], v[220:223], v[128:131]
    v_mfma_f32_16x16x32_bf16 v[132:135], a[180:183], v[220:223], v[132:135]
    s_add_u32 m0, s42, 4096
    s_nop 0
    buffer_load_dwordx4 v26, s[24:27], s59 offen offset:0 nt lds
    v_mfma_f32_16x16x32_bf16 v[120:123], a[112:115], v[224:227], v[120:123]
    v_mfma_f32_16x16x32_bf16 v[124:127], a[136:139], v[224:227], v[124:127]
    v_mfma_f32_16x16x32_bf16 v[128:131], a[160:163], v[224:227], v[128:131]
    v_mfma_f32_16x16x32_bf16 v[132:135], a[184:187], v[224:227], v[132:135]
    buffer_load_dwordx4 v27, s[24:27], s59 offen offset:1024 nt lds
    v_mfma_f32_16x16x32_bf16 v[120:123], a[116:119], v[228:231], v[120:123]
    v_mfma_f32_16x16x32_bf16 v[124:127], a[140:143], v[228:231], v[124:127]
    v_mfma_f32_16x16x32_bf16 v[128:131], a[164:167], v[228:231], v[128:131]
    v_mfma_f32_16x16x32_bf16 v[132:135], a[188:191], v[228:231], v[132:135]
    s_nop 4
    v_cvt_pk_bf16_f32 v144, v120, v121
    v_cvt_pk_bf16_f32 v145, v122, v123
    v_cvt_pk_bf16_f32 v146, v124, v125
    v_cvt_pk_bf16_f32 v147, v126, v127
    buffer_store_dwordx4 v[144:147], v65, s[32:35], s60 offen offset:0 sc1
    v_cvt_pk_bf16_f32 v148, v128, v129
    v_cvt_pk_bf16_f32 v149, v130, v131
    v_cvt_pk_bf16_f32 v150, v132, v133
    v_cvt_pk_bf16_f32 v151, v134, v135
    buffer_store_dwordx4 v[148:151], v65, s[32:35], s60 offen offset:1024 sc1
    v_and_b32 v1, 15, v0
    v_lshrrev_b32 v6, 5, v0
    v_bfe_u32 v3, v0, 4, 1
    v_lshl_or_b32 v3, v3, 1, v6
    v_lshrrev_b32 v4, 2, v0
    v_bfe_u32 v5, v0, 1, 1
    v_lshrrev_b32 v6, 3, v1
    v_and_or_b32 v6, v1, 6, v6
    v_xor_b32 v6, v6, v3
    v_mul_u32_u24 v7, 384, v1
    v_lshl_add_u32 v6, v6, 4, v7
    v_add_u32 v34, s40, v6
    v_xor_b32 v35, 64, v34
    v_lshrrev_b32 v6, 3, v1
    v_and_b32 v7, 7, v1
    v_lshl_or_b32 v6, v7, 1, v6
    v_xor_b32 v6, v6, v3
    v_mul_u32_u24 v7, 768, v1
    v_lshl_add_u32 v6, v6, 4, v7
    v_add_u32 v40, s41, v6
    v_xor_b32 v41, 0x40, v40
    v_xor_b32 v42, 0x80, v40
    v_xor_b32 v43, 0xc0, v40
    v_and_b32 v2, 1, v0
    v_lshlrev_b32 v2, 3, v2
    s_mul_i32 s56, s3, 96
    v_lshrrev_b32 v6, 3, v4
    v_and_or_b32 v6, v4, 6, v6
    v_xor_b32 v6, v6, v5
    v_lshl_add_u32 v6, v6, 4, v2
    v_mul_u32_u24 v7, 384, v4
    s_add_u32 s57, s56, 0
    v_xad_u32 v36, v6, s57, v7
    s_add_u32 s57, s56, 32
    v_xad_u32 v37, v6, s57, v7
    s_add_u32 s57, s56, 64
    v_xad_u32 v38, v6, s57, v7
    v_lshrrev_b32 v6, 3, v4
    v_and_b32 v3, 7, v4
    v_lshl_or_b32 v6, v3, 1, v6
    v_xor_b32 v6, v6, v5
    v_lshl_add_u32 v6, v6, 4, v2
    v_lshlrev_b32 v7, 1, v7
    v_add_u32 v7, 24576, v7
    s_add_u32 s57, s56, 0
    v_xad_u32 v44, v6, s57, v7
    s_add_u32 s57, s56, 384
    v_xad_u32 v45, v6, s57, v7
    s_add_u32 s57, s56, 32
    v_xad_u32 v46, v6, s57, v7
    s_add_u32 s57, s56, 416
    v_xad_u32 v47, v6, s57, v7
    s_add_u32 s57, s56, 64
    v_xad_u32 v48, v6, s57, v7
    s_add_u32 s57, s56, 448
    v_xad_u32 v49, v6, s57, v7
    v_mov_b32 v52, 0x3f803f80
    v_mov_b32 v56, 0x3ebcbe62
    s_mov_b32 s44, 0x100001
    s_mov_b32 s45, 0x10000100
    v_mov_b32 v53, 0x3f803f80
    v_mov_b32 v57, 0x3ebcbe62
    s_mov_b32 s46, 0x200002
    s_mov_b32 s47, 0x20000200
    v_mov_b32 v54, 0x3f803f80
    v_mov_b32 v58, 0x3ebcbe62
    s_mov_b32 s48, 0x400004
    s_mov_b32 s49, 0x40000400
    v_mov_b32 v55, 0x3f803f80
    v_mov_b32 v59, 0x3ebcbe62
    s_mov_b32 s50, 0x800008
    s_mov_b32 s51, 0x80000800
    v_mov_b32 v60, 0x43400000
    v_lshrrev_b32 v1, 5, v0
    v_lshlrev_b32 v1, 8, v1
    v_and_b32 v2, 15, v0
    v_lshl_add_u32 v1, v2, 4, v1
    v_bfe_u32 v2, v0, 4, 1
    v_lshl_add_u32 v1, v2, 3, v1
    s_mul_i32 s56, s3, 1536
    s_add_u32 s56, s56, 147456
    v_add_u32 v236, s56, v1
    s_mul_i32 s56, s3, 3072
    s_add_u32 s56, s56, 24576
    v_add_u32 v237, s56, v65
    v_add_u32 v238, s41, v65
    s_lshl_b32 s56, s3, 10
    v_add_u32 v240, 159744, v65
    v_add_u32 v239, s56, v240
    v_add_u32 v241, 147456, v65
    v_bfe_u32 v1, v0, 2, 2
    v_lshrrev_b32 v2, 4, v0
    v_lshl_or_b32 v1, v1, 4, v2
    v_mul_u32_u24 v1, 32768, v1
    v_and_b32 v2, 3, v0
    v_lshl_or_b32 v242, v2, 4, v1
    v_xor_b32 v243, 0x70, v242
    s_mul_i32 s56, s3, 3
    v_min_u32 v1, 2, v0
    v_add_u32 v1, s56, v1
    v_lshlrev_b32 v245, 7, v1
    v_lshlrev_b32 v1, 3, v0
    v_add_u32 v254, 126976, v1
    s_lshl_b32 s56, s3, 9
    v_add_u32 v238, s56, v254
    v_add_u32 v253, 122880, v65
    s_lshl_b32 s56, s3, 10
    v_add_u32 v237, s56, v253
    s_mov_b32 s52, 0x41c00000
    buffer_load_dwordx4 v28, s[24:27], s59 offen offset:2048 nt lds
    buffer_load_dwordx4 v29, s[24:27], s59 offen offset:3072 nt lds
    s_add_u32 m0, s42, 8192
    s_nop 0
    buffer_load_dwordx4 v30, s[24:27], s59 offen offset:0 nt lds
    buffer_load_dwordx4 v31, s[24:27], s59 offen offset:1024 nt lds
    buffer_load_dwordx4 v32, s[24:27], s59 offen offset:2048 nt lds
    buffer_load_dwordx4 v33, s[24:27], s59 offen offset:3072 nt lds
    s_branch L_join
L_xt3:
    s_call_b64 s[54:55], L_xslow
    s_branch L_post3
L_xt24:
    s_call_b64 s[54:55], L_xslow
    s_branch L_post24
L_xt6:
    s_call_b64 s[54:55], L_xslow
    s_branch L_post6
L_xt27:
    s_call_b64 s[54:55], L_xslow
    s_branch L_post27
L_xt9:
    s_call_b64 s[54:55], L_xslow
    s_branch L_post9
L_xt11:
    s_call_b64 s[54:55], L_xalt
    ds_read_b128 a[192:195], v253 offset:12288
    ds_read_b128 a[196:199], v253 offset:13312
    ds_read_b128 a[200:203], v253 offset:14336
    ds_read_b128 a[204:207], v253 offset:15360
    s_waitcnt lgkmcnt(0)
    s_branch L_post11
L_xslow:
    s_waitcnt lgkmcnt(0)
    ds_write_b32 v239, v62
    s_waitcnt lgkmcnt(0)
    s_barrier
    ds_read_b32 v12, v240 offset:0
    ds_read_b32 v13, v240 offset:1024
    ds_read_b32 v14, v240 offset:2048
    ds_read_b32 v15, v240 offset:3072
    v_mov_b32 v9, 0
    ds_write_b32 v254, v9 offset:4096
    s_waitcnt lgkmcnt(0)
    v_min3_f32 v1, v12, v13, v14
    v_min_f32 v1, v1, v15
    v_sub_f32 v2, v1, v255
    v_sub_f32 v12, v1, v62
    v_exp_f32 v2, v2
    v_exp_f32 v12, v12
    v_mov_b32 v62, v1
    v_mov_b32 v255, v1
    v_mul_f32 v88, v88, v12
    v_mul_f32 v89, v89, v12
    v_mul_f32 v90, v90, v12
    v_mul_f32 v91, v91, v12
    v_mul_f32 v104, v104, v12
    v_mul_f32 v105, v105, v12
    v_mul_f32 v106, v106, v12
    v_mul_f32 v107, v107, v12
    v_mul_f32 v68, v68, v12
    v_mul_f32 v69, v69, v12
    v_mul_f32 v70, v70, v12
    v_mul_f32 v71, v71, v12
    v_mul_f32 v112, v112, v12
    v_mul_f32 v113, v113, v12
    v_mul_f32 v114, v114, v12
    v_mul_f32 v115, v115, v12
    v_mul_f32 v63, v63, v12
    v_mul_f32 v64, v64, v12
    v_accvgpr_read_b32 v1, a0
    v_mul_f32 v1, v1, v2
    v_accvgpr_write_b32 a0, v1
    v_accvgpr_read_b32 v1, a1
    v_mul_f32 v1, v1, v2
    v_accvgpr_write_b32 a1, v1
    v_accvgpr_read_b32 v1, a2
    v_mul_f32 v1, v1, v2
    v_accvgpr_write_b32 a2, v1
    v_accvgpr_read_b32 v1, a3
    v_mul_f32 v1, v1, v2
    v_accvgpr_write_b32 a3, v1
    v_accvgpr_read_b32 v1, a4
    v_mul_f32 v1, v1, v2
    v_accvgpr_write_b32 a4, v1
    v_accvgpr_read_b32 v1, a5
    v_mul_f32 v1, v1, v2
    v_accvgpr_write_b32 a5, v1
    v_accvgpr_read_b32 v1, a6
    v_mul_f32 v1, v1, v2
    v_accvgpr_write_b32 a6, v1
    v_accvgpr_read_b32 v1, a7
    v_mul_f32 v1, v1, v2
    v_accvgpr_write_b32 a7, v1
    v_accvgpr_read_b32 v1, a8
    v_mul_f32 v1, v1, v2
    v_accvgpr_write_b32 a8, v1
    v_accvgpr_read_b32 v1, a9
    v_mul_f32 v1, v1, v2
    v_accvgpr_write_b32 a9, v1
    v_accvgpr_read_b32 v1, a10
    v_mul_f32 v1, v1, v2
    v_accvgpr_write_b32 a10, v1
    v_accvgpr_read_b32 v1, a11
    v_mul_f32 v1, v1, v2
    v_accvgpr_write_b32 a11, v1
    v_cvt_pk_bf16_f32 v72, v88, v89
    v_cvt_pk_bf16_f32 v73, v90, v91
    v_cvt_pk_bf16_f32 v74, v104, v105
    v_cvt_pk_bf16_f32 v75, v106, v107
    ds_write_b128 v237, v[72:75] offset:0
    v_cvt_pk_bf16_f32 v66, v68, v69
    v_cvt_pk_bf16_f32 v67, v70, v71
    ds_write_b64 v238, v[66:67]
    s_waitcnt lgkmcnt(0)
    s_barrier
    s_setpc_b64 s[54:55]
L_xlast:
    s_waitcnt lgkmcnt(0)
    ds_write_b32 v239, v62
    s_waitcnt lgkmcnt(0)
    s_barrier
    ds_read_b32 v12, v240 offset:0
    ds_read_b32 v13, v240 offset:1024
    ds_read_b32 v14, v240 offset:2048
    ds_read_b32 v15, v240 offset:3072
    v_mov_b32 v9, 0
    ds_write_b32 v254, v9 offset:4096
    s_waitcnt lgkmcnt(0)
    v_min3_f32 v1, v12, v13, v14
    v_min_f32 v1, v1, v15
    v_sub_f32 v2, v1, v255
    v_sub_f32 v12, v1, v62
    v_exp_f32 v2, v2
    v_exp_f32 v12, v12
    v_mov_b32 v62, v1
    v_mov_b32 v255, v1
    v_mul_f32 v88, v88, v12
    v_mul_f32 v89, v89, v12
    v_mul_f32 v90, v90, v12
    v_mul_f32 v91, v91, v12
    v_mul_f32 v104, v104, v12
    v_mul_f32 v105, v105, v12
    v_mul_f32 v106, v106, v12
    v_mul_f32 v107, v107, v12
    v_mul_f32 v68, v68, v12
    v_mul_f32 v69, v69, v12
    v_mul_f32 v70, v70, v12
    v_mul_f32 v71, v71, v12
    v_mul_f32 v10, v10, v12
    v_mul_f32 v11, v11, v12
    v_mul_f32 v16, v16, v2
    v_mul_f32 v17, v17, v2
    v_mul_f32 v18, v18, v2
    v_mul_f32 v19, v19, v2
    v_mul_f32 v20, v20, v2
    v_mul_f32 v21, v21, v2
    v_mul_f32 v22, v22, v2
    v_mul_f32 v23, v23, v2
    v_mul_f32 v24, v24, v2
    v_mul_f32 v25, v25, v2
    v_mul_f32 v26, v26, v2
    v_mul_f32 v27, v27, v2
    v_cvt_pk_bf16_f32 v72, v88, v89
    v_cvt_pk_bf16_f32 v73, v90, v91
    v_cvt_pk_bf16_f32 v74, v104, v105
    v_cvt_pk_bf16_f32 v75, v106, v107
    ds_write_b128 v237, v[72:75] offset:0
    v_cvt_pk_bf16_f32 v66, v68, v69
    v_cvt_pk_bf16_f32 v67, v70, v71
    ds_write_b64 v238, v[66:67]
    ds_write_b64 v238, v[10:11] offset:2048
    s_waitcnt lgkmcnt(0)
    s_barrier
    s_branch L_postx
L_xalt:
    s_waitcnt lgkmcnt(0)
    ds_write_b32 v239, v62
    s_waitcnt lgkmcnt(0)
    s_barrier
    ds_read_b32 v12, v240 offset:0
    ds_read_b32 v13, v240 offset:1024
    ds_read_b32 v14, v240 offset:2048
    ds_read_b32 v15, v240 offset:3072
    v_mov_b32 v9, 0
    ds_write_b32 v254, v9 offset:4100
    s_waitcnt lgkmcnt(0)
    v_min3_f32 v1, v12, v13, v14
    v_min_f32 v1, v1, v15
    v_sub_f32 v2, v1, v255
    v_sub_f32 v12, v1, v62
    v_exp_f32 v2, v2
    v_exp_f32 v12, v12
    v_mov_b32 v62, v1
    v_mov_b32 v255, v1
    v_mul_f32 v88, v88, v12
    v_mul_f32 v89, v89, v12
    v_mul_f32 v90, v90, v12
    v_mul_f32 v91, v91, v12
    v_mul_f32 v104, v104, v12
    v_mul_f32 v105, v105, v12
    v_mul_f32 v106, v106, v12
    v_mul_f32 v107, v107, v12
    v_mul_f32 v68, v68, v12
    v_mul_f32 v69, v69, v12
    v_mul_f32 v70, v70, v12
    v_mul_f32 v71, v71, v12
    v_mul_f32 v112, v112, v12
    v_mul_f32 v113, v113, v12
    v_mul_f32 v114, v114, v12
    v_mul_f32 v115, v115, v12
    v_mul_f32 v63, v63, v12
    v_mul_f32 v64, v64, v12
    v_mul_f32 v16, v16, v2
    v_mul_f32 v17, v17, v2
    v_mul_f32 v18, v18, v2
    v_mul_f32 v19, v19, v2
    v_mul_f32 v20, v20, v2
    v_mul_f32 v21, v21, v2
    v_mul_f32 v22, v22, v2
    v_mul_f32 v23, v23, v2
    v_mul_f32 v24, v24, v2
    v_mul_f32 v25, v25, v2
    v_mul_f32 v26, v26, v2
    v_mul_f32 v27, v27, v2
    v_cvt_pk_bf16_f32 v72, v88, v89
    v_cvt_pk_bf16_f32 v73, v90, v91
    v_cvt_pk_bf16_f32 v74, v104, v105
    v_cvt_pk_bf16_f32 v75, v106, v107
    ds_write_b128 v237, v[72:75] offset:12288
    s_waitcnt lgkmcnt(0)
    s_barrier
    s_setpc_b64 s[54:55]
L_c_slow:
    s_cmp_eq_u32 s43, 0
    s_cbranch_scc1 L_c_out
    s_mov_b32 s43, 0
    buffer_load_dwordx4 v[76:79], v65, s[32:35], s30 offen offset:0 sc1
    buffer_load_dwordx4 v[80:83], v65, s[32:35], s30 offen offset:1024 sc1
    buffer_load_dwordx4 v[84:87], v65, s[32:35], s30 offen offset:2048 sc1
    buffer_load_dwordx4 v[108:111], v65, s[32:35], s30 offen offset:3072 sc1
    buffer_load_dwordx4 v[112:115], v65, s[32:35], s31 offen offset:0 sc1
    buffer_load_dwordx4 v[128:131], v65, s[32:35], s31 offen offset:1024 sc1
    buffer_load_dwordx4 v[132:135], v65, s[32:35], s31 offen offset:2048 sc1
    buffer_load_dwordx4 v[52:55], v65, s[32:35], s31 offen offset:3072 sc1
    s_waitcnt vmcnt(0)
    v_sub_u32 v49, v79, v247
    v_max_f32 v42, v42, v49
    v_sub_u32 v49, v83, v247
    v_max_f32 v42, v42, v49
    v_sub_u32 v49, v87, v247
    v_max_f32 v42, v42, v49
    v_sub_u32 v49, v111, v247
    v_max_f32 v42, v42, v49
    v_sub_u32 v49, v115, v247
    v_max_f32 v42, v42, v49
    v_sub_u32 v49, v131, v247
    v_max_f32 v42, v42, v49
    v_sub_u32 v49, v135, v247
    v_max_f32 v42, v42, v49
    v_sub_u32 v49, v55, v247
    v_max_f32 v42, v42, v49
    s_nop 1
    v_max_f32_dpp v42, v42, v42 row_ror:8 row_mask:0xf bank_mask:0xf
    v_mov_b32 v48, v42
    s_nop 1
    v_permlane32_swap_b32 v42, v48
    v_max_f32 v42, v42, v48
    v_mov_b32 v48, v42
    s_nop 1
    v_permlane16_swap_b32 v42, v48
    v_max_f32 v42, v42, v48
    s_lshl_b32 s56, s3, 2
    v_add_u32 v48, s56, v251
    ds_write_b32 v48, v42 offset:1024
    s_waitcnt lgkmcnt(0)
    s_barrier
    ds_read_b128 v[48:51], v251 offset:1024
    v_mov_b32 v16, 0
    v_mov_b32 v17, 0
    v_mov_b32 v18, 0
    v_mov_b32 v19, 0
    v_mov_b32 v20, 0
    v_mov_b32 v21, 0
    v_mov_b32 v22, 0
    s_waitcnt lgkmcnt(0)
    v_max3_f32 v42, v48, v49, v50
    v_max_f32 v42, v42, v51
    v_sub_u32 v49, v79, v247
    v_sub_f32 v49, v49, v42
    v_exp_f32 v49, v49
    s_nop 0
    v_cvt_pk_bf16_f32 v49, v49, 0
    v_lshlrev_b32 v50, 16, v49
    v_dot2_f32_bf16 v16, v76, v49, v16
    v_dot2_f32_bf16 v18, v77, v49, v18
    v_dot2_f32_bf16 v20, v78, v49, v20
    v_add_f32 v22, v22, v50
    v_dot2_f32_bf16 v17, v76, v50, v17
    v_dot2_f32_bf16 v19, v77, v50, v19
    v_dot2_f32_bf16 v21, v78, v50, v21
    v_sub_u32 v49, v83, v247
    v_sub_f32 v49, v49, v42
    v_exp_f32 v49, v49
    s_nop 0
    v_cvt_pk_bf16_f32 v49, v49, 0
    v_lshlrev_b32 v50, 16, v49
    v_dot2_f32_bf16 v16, v80, v49, v16
    v_dot2_f32_bf16 v18, v81, v49, v18
    v_dot2_f32_bf16 v20, v82, v49, v20
    v_add_f32 v22, v22, v50
    v_dot2_f32_bf16 v17, v80, v50, v17
    v_dot2_f32_bf16 v19, v81, v50, v19
    v_dot2_f32_bf16 v21, v82, v50, v21
    v_sub_u32 v49, v87, v247
    v_sub_f32 v49, v49, v42
    v_exp_f32 v49, v49
    s_nop 0
    v_cvt_pk_bf16_f32 v49, v49, 0
    v_lshlrev_b32 v50, 16, v49
    v_dot2_f32_bf16 v16, v84, v49, v16
    v_dot2_f32_bf16 v18, v85, v49, v18
    v_dot2_f32_bf16 v20, v86, v49, v20
    v_add_f32 v22, v22, v50
    v_dot2_f32_bf16 v17, v84, v50, v17
    v_dot2_f32_bf16 v19, v85, v50, v19
    v_dot2_f32_bf16 v21, v86, v50, v21
    v_sub_u32 v49, v111, v247
    v_sub_f32 v49, v49, v42
    v_exp_f32 v49, v49
    s_nop 0
    v_cvt_pk_bf16_f32 v49, v49, 0
    v_lshlrev_b32 v50, 16, v49
    v_dot2_f32_bf16 v16, v108, v49, v16
    v_dot2_f32_bf16 v18, v109, v49, v18
    v_dot2_f32_bf16 v20, v110, v49, v20
    v_add_f32 v22, v22, v50
    v_dot2_f32_bf16 v17, v108, v50, v17
    v_dot2_f32_bf16 v19, v109, v50, v19
    v_dot2_f32_bf16 v21, v110, v50, v21
    v_sub_u32 v49, v115, v247
    v_sub_f32 v49, v49, v42
    v_exp_f32 v49, v49
    s_nop 0
    v_cvt_pk_bf16_f32 v49, v49, 0
    v_lshlrev_b32 v50, 16, v49
    v_dot2_f32_bf16 v16, v112, v49, v16
    v_dot2_f32_bf16 v18, v113, v49, v18
    v_dot2_f32_bf16 v20, v114, v49, v20
    v_add_f32 v22, v22, v50
    v_dot2_f32_bf16 v17, v112, v50, v17
    v_dot2_f32_bf16 v19, v113, v50, v19
    v_dot2_f32_bf16 v21, v114, v50, v21
    v_sub_u32 v49, v131, v247
    v_sub_f32 v49, v49, v42
    v_exp_f32 v49, v49
    s_nop 0
    v_cvt_pk_bf16_f32 v49, v49, 0
    v_lshlrev_b32 v50, 16, v49
    v_dot2_f32_bf16 v16, v128, v49, v16
    v_dot2_f32_bf16 v18, v129, v49, v18
    v_dot2_f32_bf16 v20, v130, v49, v20
    v_add_f32 v22, v22, v50
    v_dot2_f32_bf16 v17, v128, v50, v17
    v_dot2_f32_bf16 v19, v129, v50, v19
    v_dot2_f32_bf16 v21, v130, v50, v21
    v_sub_u32 v49, v135, v247
    v_sub_f32 v49, v49, v42
    v_exp_f32 v49, v49
    s_nop 0
    v_cvt_pk_bf16_f32 v49, v49, 0
    v_lshlrev_b32 v50, 16, v49
    v_dot2_f32_bf16 v16, v132, v49, v16
    v_dot2_f32_bf16 v18, v133, v49, v18
    v_dot2_f32_bf16 v20, v134, v49, v20
    v_add_f32 v22, v22, v50
    v_dot2_f32_bf16 v17, v132, v50, v17
    v_dot2_f32_bf16 v19, v133, v50, v19
    v_dot2_f32_bf16 v21, v134, v50, v21
    v_sub_u32 v49, v55, v247
    v_sub_f32 v49, v49, v42
    v_exp_f32 v49, v49
    s_nop 0
    v_cvt_pk_bf16_f32 v49, v49, 0
    v_lshlrev_b32 v50, 16, v49
    v_dot2_f32_bf16 v16, v52, v49, v16
    v_dot2_f32_bf16 v18, v53, v49, v18
    v_dot2_f32_bf16 v20, v54, v49, v20
    v_add_f32 v22, v22, v50
    v_dot2_f32_bf16 v17, v52, v50, v17
    v_dot2_f32_bf16 v19, v53, v50, v19
    v_dot2_f32_bf16 v21, v54, v50, v21
    s_nop 2
    s_branch L_c_red
L_qk_retry:
    s_mov_b32 s53, 0
L_qk_again:
    s_mul_i32 s56, s3, 3072
    s_add_u32 s56, s56, 16384
    buffer_load_dwordx4 v[136:139], v65, s[32:35], s56 offen offset:0 sc1
    buffer_load_dwordx4 v[140:143], v65, s[32:35], s56 offen offset:1024 sc1
    buffer_load_dwordx4 v[144:147], v65, s[32:35], s56 offen offset:2048 sc1
    s_add_u32 s53, s53, 1
    s_waitcnt vmcnt(0)
    v_xor_b32 v1, s39, v138
    v_xor_b32 v2, s39, v142
    v_xor_b32 v3, s39, v146
    v_or3_b32 v1, v1, v2, v3
    v_cmp_ne_u32 vcc, 0, v1
    s_cbranch_vccz L_qk_ok
    s_cmp_lt_u32 s53, 65536
    s_cbranch_scc1 L_qk_again
    s_branch L_qk_ok
L_fl_retry:
    s_mov_b32 s53, 0
L_fl_again:
    buffer_load_dword v244, v245, s[32:35], 0 offen offset:128 sc1
    s_add_u32 s53, s53, 1
    s_waitcnt vmcnt(0)
    v_cmp_ne_u32 vcc, s39, v244
    s_cbranch_vccz L_fl_ok
    s_cmp_lt_u32 s53, 65536
    s_cbranch_scc1 L_fl_again
    s_branch L_fl_ok
L_site0:
    s_call_b64 s[54:55], L_rare2
    s_branch L_back0
L_site1:
    s_call_b64 s[54:55], L_rare3
    s_branch L_back1
L_site2:
    s_call_b64 s[54:55], L_rare2
    s_branch L_back2
L_site3:
    s_call_b64 s[54:55], L_rare3
    s_branch L_back3
L_site4:
    s_call_b64 s[54:55], L_rare2
    s_branch L_back4
L_site5:
    s_call_b64 s[54:55], L_rare3
    s_branch L_back5
L_site6:
    s_call_b64 s[54:55], L_rare2
    s_branch L_back6
L_site7:
    s_call_b64 s[54:55], L_rare3
    s_branch L_back7
L_site8:
    s_call_b64 s[54:55], L_rare2
    s_branch L_back8
L_site9:
    s_call_b64 s[54:55], L_rare3
    s_branch L_back9
L_site10:
    s_call_b64 s[54:55], L_rare6
    s_branch L_back10
L_site11:
    s_call_b64 s[54:55], L_rare7
    s_branch L_back11
L_site12:
    s_call_b64 s[54:55], L_rare2
    s_branch L_back12
L_site13:
    s_call_b64 s[54:55], L_rare5
    s_branch L_back13
L_rare2:
    s_nop 7
    s_nop 7
    v_mov_b32 v2, v1
    s_nop 1
    v_permlane32_swap_b32 v1, v2
    v_max_f32 v1, v1, v2
    v_mov_b32 v2, v1
    s_nop 1
    v_permlane16_swap_b32 v1, v2
    v_max_f32 v1, v1, v2
    v_max_f32 v1, 0, v1
    v_sub_f32 v62, v62, v1
    v_sub_f32 v88, v88, v1
    v_sub_f32 v89, v89, v1
    v_sub_f32 v90, v90, v1
    v_sub_f32 v91, v91, v1
    v_sub_f32 v1, 0, v1
    v_exp_f32 v1, v1
    s_nop 0
    v_mul_f32 v63, v63, v1
    v_mul_f32 v64, v64, v1
    v_mul_f32 v68, v68, v1
    v_mul_f32 v69, v69, v1
    v_mul_f32 v70, v70, v1
    v_mul_f32 v71, v71, v1
    v_mov_b32 v2, 1
    ds_write_b32 v254, v2 offset:4096
    s_waitcnt lgkmcnt(0)
    s_nop 3
    s_setpc_b64 s[54:55]
L_rare3:
    s_nop 7
    s_nop 7
    v_mov_b32 v2, v1
    s_nop 1
    v_permlane32_swap_b32 v1, v2
    v_max_f32 v1, v1, v2
    v_mov_b32 v2, v1
    s_nop 1
    v_permlane16_swap_b32 v1, v2
    v_max_f32 v1, v1, v2
    v_max_f32 v1, 0, v1
    v_sub_f32 v62, v62, v1
    v_sub_f32 v104, v104, v1
    v_sub_f32 v105, v105, v1
    v_sub_f32 v106, v106, v1
    v_sub_f32 v107, v107, v1
    v_sub_f32 v1, 0, v1
    v_exp_f32 v1, v1
    s_nop 0
    v_mul_f32 v63, v63, v1
    v_mul_f32 v64, v64, v1
    v_mul_f32 v68, v68, v1
    v_mul_f32 v69, v69, v1
    v_mul_f32 v70, v70, v1
    v_mul_f32 v71, v71, v1
    v_mul_f32 v88, v88, v1
    v_mul_f32 v89, v89, v1
    v_mul_f32 v90, v90, v1
    v_mul_f32 v91, v91, v1
    v_mov_b32 v2, 1
    ds_write_b32 v254, v2 offset:4096
    s_waitcnt lgkmcnt(0)
    s_nop 3
    s_setpc_b64 s[54:55]
L_rare5:
    s_nop 7
    s_nop 7
    v_mov_b32 v2, v1
    s_nop 1
    v_permlane32_swap_b32 v1, v2
    v_max_f32 v1, v1, v2
    v_mov_b32 v2, v1
    s_nop 1
    v_permlane16_swap_b32 v1, v2
    v_max_f32 v1, v1, v2
    v_max_f32 v1, 0, v1
    v_sub_f32 v62, v62, v1
    v_sub_f32 v104, v104, v1
    v_sub_f32 v105, v105, v1
    v_sub_f32 v106, v106, v1
    v_sub_f32 v107, v107, v1
    v_sub_f32 v1, 0, v1
    v_exp_f32 v1, v1
    s_nop 0
    v_mul_f32 v63, v63, v1
    v_mul_f32 v64, v64, v1
    v_mul_f32 v68, v68, v1
    v_mul_f32 v69, v69, v1
    v_mul_f32 v70, v70, v1
    v_mul_f32 v71, v71, v1
    v_mul_f32 v88, v88, v1
    v_mul_f32 v89, v89, v1
    v_mul_f32 v90, v90, v1
    v_mul_f32 v91, v91, v1
    v_cvt_pk_bf16_f32 v72, v88, v89
    v_cvt_pk_bf16_f32 v73, v90, v91
    v_mov_b32 v2, 1
    ds_write_b32 v254, v2 offset:4096
    s_waitcnt lgkmcnt(0)
    s_nop 3
    s_setpc_b64 s[54:55]
L_rare6:
    s_nop 7
    s_nop 7
    v_mov_b32 v2, v1
    s_nop 1
    v_permlane32_swap_b32 v1, v2
    v_max_f32 v1, v1, v2
    v_mov_b32 v2, v1
    s_nop 1
    v_permlane16_swap_b32 v1, v2
    v_max_f32 v1, v1, v2
    v_max_f32 v1, 0, v1
    v_sub_f32 v62, v62, v1
    v_sub_f32 v88, v88, v1
    v_sub_f32 v89, v89, v1
    v_sub_f32 v90, v90, v1
    v_sub_f32 v91, v91, v1
    v_sub_f32 v1, 0, v1
    v_exp_f32 v1, v1
    s_nop 0
    v_mul_f32 v63, v63, v1
    v_mul_f32 v64, v64, v1
    v_mul_f32 v68, v68, v1
    v_mul_f32 v69, v69, v1
    v_mul_f32 v70, v70, v1
    v_mul_f32 v71, v71, v1
    v_mov_b32 v2, 1
    ds_write_b32 v254, v2 offset:4100
    s_waitcnt lgkmcnt(0)
    s_nop 3
    s_setpc_b64 s[54:55]
L_rare7:
    s_nop 7
    s_nop 7
    v_mov_b32 v2, v1
    s_nop 1
    v_permlane32_swap_b32 v1, v2
    v_max_f32 v1, v1, v2
    v_mov_b32 v2, v1
    s_nop 1
    v_permlane16_swap_b32 v1, v2
    v_max_f32 v1, v1, v2
    v_max_f32 v1, 0, v1
    v_sub_f32 v62, v62, v1
    v_sub_f32 v104, v104, v1
    v_sub_f32 v105, v105, v1
    v_sub_f32 v106, v106, v1
    v_sub_f32 v107, v107, v1
    v_sub_f32 v1, 0, v1
    v_exp_f32 v1, v1
    s_nop 0
    v_mul_f32 v63, v63, v1
    v_mul_f32 v64, v64, v1
    v_mul_f32 v68, v68, v1
    v_mul_f32 v69, v69, v1
    v_mul_f32 v70, v70, v1
    v_mul_f32 v71, v71, v1
    v_mul_f32 v88, v88, v1
    v_mul_f32 v89, v89, v1
    v_mul_f32 v90, v90, v1
    v_mul_f32 v91, v91, v1
    v_mov_b32 v2, 1
    ds_write_b32 v254, v2 offset:4100
    s_waitcnt lgkmcnt(0)
    s_nop 3
    s_setpc_b64 s[54:55]
L_codeend:
.section .rodata,"a"
.p2align 6
.amdhsa_kernel standalone__detection_seg_dino__vision_kernel
  .amdhsa_next_free_vgpr 464
  .amdhsa_next_free_sgpr 102
  .amdhsa_accum_offset 256
  .amdhsa_group_segment_fixed_size 0
  .amdhsa_kernarg_size 80
  .amdhsa_user_sgpr_count 2
  .amdhsa_user_sgpr_kernarg_segment_ptr 1
  .amdhsa_system_sgpr_workgroup_id_x 1
  .amdhsa_float_denorm_mode_32 3
.end_amdhsa_kernel
```

```asm
; @launch grid=(256,1,1) block=(256,1,1) lds=163840
.amdgcn_target "amdgcn-amd-amdhsa--gfx950"
.text
.globl standalone__detection_seg_dino__vision_kernel
.p2align 8
.type standalone__detection_seg_dino__vision_kernel,@function
standalone__detection_seg_dino__vision_kernel:
    s_cmp_ge_u32 s2, 256
    s_cbranch_scc1 L_end
    s_load_dwordx16 s[4:19], s[0:1], 0
    s_load_dwordx4 s[20:23], s[0:1], 64
    s_memrealtime s[44:45]
    s_getpc_b64 s[54:55]
L_pc_main:
    v_lshlrev_b32 v233, 7, v0
    v_min_u32 v233, L_codeend - L_pc_main - 4, v233
    global_load_dword v232, v233, s[54:55]
    s_mov_b64 s[100:101], s[54:55]
    v_lshrrev_b32 v1, 6, v0
    v_and_b32 v0, 63, v0
    v_readfirstlane_b32 s3, v1
    v_lshlrev_b32 v65, 4, v0
    v_lshrrev_b32 v1, 2, v0
    v_and_b32 v1, 14, v1
    s_mov_b32 s56, 0x5000
    v_bfe_u32 v2, s56, v1, 2
    v_lshlrev_b32 v2, 5, v2
    v_xor_b32 v16, v65, v2
    s_mov_b32 s56, 0xaa55
    v_bfe_u32 v2, s56, v1, 2
    v_lshlrev_b32 v2, 5, v2
    v_xor_b32 v17, v65, v2
    s_mov_b32 s56, 0xfffa
    v_bfe_u32 v2, s56, v1, 2
    v_lshlrev_b32 v2, 5, v2
    v_xor_b32 v18, v65, v2
    v_xor_b32 v19, 16, v16
    v_xor_b32 v20, 0x1010, v17
    v_xor_b32 v21, 0x1010, v18
    v_lshrrev_b32 v1, 3, v0
    v_and_b32 v1, 6, v1
    s_mov_b32 s56, 0x40
    v_bfe_u32 v2, s56, v1, 2
    v_lshlrev_b32 v2, 5, v2
    v_xor_b32 v22, v65, v2
    s_mov_b32 s56, 0xa5
    v_bfe_u32 v2, s56, v1, 2
    v_lshlrev_b32 v2, 5, v2
    v_xor_b32 v23, v65, v2
    s_mov_b32 s56, 0xfe
    v_bfe_u32 v2, s56, v1, 2
    v_lshlrev_b32 v2, 5, v2
    v_xor_b32 v24, v65, v2
    v_xor_b32 v25, 0x80, v22
    v_xor_b32 v26, 0x1080, v23
    v_xor_b32 v27, 0x1080, v24
    v_xor_b32 v28, 0x1010, v22
    v_xor_b32 v29, 0x1010, v23
    v_xor_b32 v30, 0x2010, v24
    v_xor_b32 v31, 0x2090, v22
    v_xor_b32 v32, 0x2090, v23
    v_xor_b32 v33, 0x2090, v24
    v_mov_b32 v248, 0x10000
    s_mul_i32 s36, s3, 6144
    s_mul_i32 s37, s3, 12288
    s_add_u32 s40, s36, 0
    s_add_u32 s41, s37, 24576
    s_add_u32 s42, s37, 73728
    s_and_b32 s58, s2, 7
    s_lshr_b32 s57, s2, 3
    s_lshl_b32 s58, s58, 5
    s_add_u32 s58, s58, s57
    s_lshr_b32 s56, s58, 2
    s_mul_i32 s56, s56, 196608
    s_mul_i32 s57, s58, 24576
    s_lshl1_add_u32 s56, s57, s56
    s_mov_b64 s[60:61], s[56:57]
    s_and_b32 s98, s2, 7
    s_cmp_lt_u32 s2, 48
    s_cselect_b32 s98, s98, 0
    s_mov_b32 s30, 18898944
    s_mov_b32 s31, 0x20000
    s_mov_b32 s26, 75743232
    s_mov_b32 s27, 0x20000
    s_mov_b32 s34, 16777216
    s_mov_b32 s35, 0x20000
    s_mov_b32 m0, s40
    s_and_b32 s56, s2, 7
    s_cmp_eq_u32 s56, 2
    s_cbranch_scc1 L_spec
    s_and_b32 s56, s2, 7
    s_cbranch_scc1 L_plain
L_spec:
    s_waitcnt lgkmcnt(0)
    s_add_u32 s28, s8, s61
    s_addc_u32 s29, s9, 0
    s_add_u32 s24, s6, s60
    s_addc_u32 s25, s7, 0
    s_mov_b64 s[32:33], s[22:23]
    s_lshr_b32 s43, s2, 3
    s_mul_i32 s57, s43, 2304
    v_min_u32 v1, 17, v0
    v_lshlrev_b32 v1, 7, v1
    s_mov_b32 s66, 73728
    s_mov_b32 s67, 0x20000
    s_mov_b32 s70, 73728
    s_mov_b32 s71, 0x20000
    s_mov_b32 s72, s4
    s_mov_b32 s73, s5
    s_mov_b32 s74, 6144
    s_mov_b32 s75, 0x20000
    s_bitcmp1_b32 s2, 1
    s_cselect_b64 s[64:65], s[16:17], s[10:11]
    s_cselect_b64 s[68:69], s[14:15], s[12:13]
    s_cmp_eq_u32 s3, 0
    s_cbranch_scc1 L_pf0
    s_cmp_eq_u32 s3, 1
    s_cbranch_scc0 L_pfdone
    s_lshl_b32 s58, s43, 8
    buffer_load_dword v234, v1, s[68:71], s57 offen
    v_min_u32 v2, 128, v1
    buffer_load_dword v235, v2, s[72:75], s58 offen
    s_branch L_pfdone
L_pf0:
    buffer_load_dword v234, v1, s[64:67], s57 offen
L_pfdone:
    s_cmp_ge_u32 s43, 3
    s_cbranch_scc1 L_nopf
    s_mov_b32 s0, 1
    s_bitcmp1_b32 s2, 1
    s_cbranch_scc0 L_prod
    s_branch L_vprod
L_plain:
    s_waitcnt lgkmcnt(0)
    s_cmp_eq_u32 s98, 1
    s_cbranch_scc0 L_nopf
    s_lshl2_add_u32 s20, s2, s3
    s_lshl4_add_u32 s20, s20, s44
    s_mul_i32 s20, s20, 0x9e3779b1
    s_lshr_b32 s20, s20, 11
    s_and_b32 s20, s20, 0x1fdf80
    s_bfe_u32 s56, s2, 0x10003
    s_lshl_b32 s56, s56, 13
    s_add_u32 s56, s56, 6291456
    s_add_u32 s56, s56, s20
    s_load_dword s38, s[22:23], s56
    s_memtime s[20:21]
L_nopf:
    s_add_u32 s28, s8, s61
    s_addc_u32 s29, s9, 0
    buffer_load_dwordx4 v16, s[28:31], s36 offen offset:0 nt lds
    s_add_u32 s24, s6, s60
    s_addc_u32 s25, s7, 0
    s_mov_b64 s[32:33], s[22:23]
    s_mov_b32 s0, 0
    buffer_load_dwordx4 v17, s[28:31], s36 offen offset:1024 nt lds
    buffer_load_dwordx4 v18, s[28:31], s36 offen offset:2048 nt lds
    buffer_load_dwordx4 v19, s[28:31], s36 offen offset:3072 nt lds
    s_add_u32 m0, s40, 4096
    s_nop 0
    buffer_load_dwordx4 v20, s[28:31], s36 offen offset:0 nt lds
    buffer_load_dwordx4 v21, s[28:31], s36 offen offset:1024 nt lds
    s_mov_b32 s43, -1
    s_sub_u32 s59, s2, 64
    s_cmp_ge_u32 s59, 64
    s_cbranch_scc1 L_nocs
    s_mov_b32 s64, s4
    s_mov_b32 s65, s5
    s_mov_b32 s66, 6144
    s_mov_b32 s67, 0x20000
    s_mov_b32 s68, s18
    s_mov_b32 s69, s19
    s_mov_b32 s70, 6144
    s_mov_b32 s71, 0x20000
    v_bfe_u32 v1, v0, 2, 1
    v_mul_u32_u24 v2, 7, v1
    v_xor_b32 v2, v0, v2
    v_and_b32 v2, 3, v2
    s_lshr_b32 s56, s59, 4
    s_lshl_b32 s56, s56, 2
    v_add_u32 v2, s56, v2
    v_lshlrev_b32 v252, 2, v2
    v_lshrrev_b32 v3, 4, v0
    v_mad_u32_u24 v3, v1, 3, v3
    v_lshrrev_b32 v4, 1, v3
    v_and_b32 v3, 1, v3
    v_lshlrev_b32 v3, 2, v3
    v_lshl_add_u32 v3, v4, 5, v3
    v_bfe_u32 v4, v0, 3, 1
    v_lshl_add_u32 v3, v4, 1, v3
    v_mul_u32_u24 v2, 384, v2
    s_bfe_u32 s56, s59, 0x20002
    s_mul_i32 s56, s56, 96
    s_and_b32 s57, s59, 3
    s_lshl_b32 s57, s57, 3
    s_add_u32 s56, s56, s57
    v_add3_u32 v248, s56, v2, v3
    v_cmp_gt_u32 vcc, 48, v0
    v_mov_b32 v4, 0x10000
    s_lshl_b32 s56, s3, 2
    v_cndmask_b32 v248, v4, v248, vcc
    buffer_load_ushort v249, v248, s[64:67], 0 offen
    s_or_b32 s57, s59, s3
    s_cselect_b32 s70, 0, 6144
    v_lshlrev_b32 v4, 7, v0
    buffer_load_ushort v246, v4, s[68:71], 0 offen
    v_add_u32 v250, s56, v65
    v_and_b32 v251, 0x70, v65
L_nocs:
    s_cmp_eq_u32 s98, 1
    s_cbranch_scc0 L_noprobe
    s_waitcnt lgkmcnt(0)
    s_memtime s[54:55]
    s_waitcnt lgkmcnt(0)
    s_sub_u32 s20, s54, s20
    s_add_u32 s98, s3, 1
L_noprobe:
    s_load_dword s38, s[22:23], 0
    s_add_u32 m0, s41, 0
    s_add_u32 s58, s37, 0
    buffer_load_dwordx4 v22, s[24:27], s58 offen offset:0 nt lds
    buffer_load_dwordx4 v23, s[24:27], s58 offen offset:1024 nt lds
    buffer_load_dwordx4 v24, s[24:27], s58 offen offset:2048 nt lds
    buffer_load_dwordx4 v25, s[24:27], s58 offen offset:3072 nt lds
    s_add_u32 m0, s41, 4096
    s_nop 0
    buffer_load_dwordx4 v26, s[24:27], s58 offen offset:0 nt lds
    buffer_load_dwordx4 v27, s[24:27], s58 offen offset:1024 nt lds
    buffer_load_dwordx4 v28, s[24:27], s58 offen offset:2048 nt lds
    buffer_load_dwordx4 v29, s[24:27], s58 offen offset:3072 nt lds
    s_add_u32 m0, s41, 8192
    s_nop 0
    buffer_load_dwordx4 v30, s[24:27], s58 offen offset:0 nt lds
    buffer_load_dwordx4 v31, s[24:27], s58 offen offset:1024 nt lds
    buffer_load_dwordx4 v32, s[24:27], s58 offen offset:2048 nt lds
    buffer_load_dwordx4 v33, s[24:27], s58 offen offset:3072 nt lds
    s_add_u32 m0, s42, 0
    s_add_u32 s59, s37, 196608
    buffer_load_dwordx4 v22, s[24:27], s59 offen offset:0 nt lds
    buffer_load_dwordx4 v23, s[24:27], s59 offen offset:1024 nt lds
    buffer_load_dwordx4 v24, s[24:27], s59 offen offset:2048 nt lds
    buffer_load_dwordx4 v25, s[24:27], s59 offen offset:3072 nt lds
    s_add_u32 m0, s42, 4096
    s_nop 0
    buffer_load_dwordx4 v26, s[24:27], s59 offen offset:0 nt lds
    buffer_load_dwordx4 v27, s[24:27], s59 offen offset:1024 nt lds
    buffer_load_dwordx4 v28, s[24:27], s59 offen offset:2048 nt lds
    buffer_load_dwordx4 v29, s[24:27], s59 offen offset:3072 nt lds
    s_add_u32 m0, s42, 8192
    s_nop 0
    buffer_load_dwordx4 v30, s[24:27], s59 offen offset:0 nt lds
    buffer_load_dwordx4 v31, s[24:27], s59 offen offset:1024 nt lds
    buffer_load_dwordx4 v32, s[24:27], s59 offen offset:2048 nt lds
    buffer_load_dwordx4 v33, s[24:27], s59 offen offset:3072 nt lds
    v_and_b32 v1, 15, v0
    v_lshrrev_b32 v6, 5, v0
    v_bfe_u32 v3, v0, 4, 1
    v_lshl_or_b32 v3, v3, 1, v6
    v_lshrrev_b32 v4, 2, v0
    v_bfe_u32 v5, v0, 1, 1
    v_lshrrev_b32 v6, 3, v1
    v_and_or_b32 v6, v1, 6, v6
    v_xor_b32 v6, v6, v3
    v_mul_u32_u24 v7, 384, v1
    v_lshl_add_u32 v6, v6, 4, v7
    v_add_u32 v34, s40, v6
    v_xor_b32 v35, 64, v34
    v_lshrrev_b32 v6, 3, v1
    v_and_b32 v7, 7, v1
    v_lshl_or_b32 v6, v7, 1, v6
    v_xor_b32 v6, v6, v3
    v_mul_u32_u24 v7, 768, v1
    v_lshl_add_u32 v6, v6, 4, v7
    v_add_u32 v40, s41, v6
    v_xor_b32 v41, 0x40, v40
    v_xor_b32 v42, 0x80, v40
    v_xor_b32 v43, 0xc0, v40
    v_and_b32 v2, 1, v0
    v_lshlrev_b32 v2, 3, v2
    s_mul_i32 s56, s3, 96
    v_lshrrev_b32 v6, 3, v4
    v_and_or_b32 v6, v4, 6, v6
    v_xor_b32 v6, v6, v5
    v_lshl_add_u32 v6, v6, 4, v2
    v_mul_u32_u24 v7, 384, v4
    s_add_u32 s57, s56, 0
    v_xad_u32 v36, v6, s57, v7
    s_add_u32 s57, s56, 32
    v_xad_u32 v37, v6, s57, v7
    s_add_u32 s57, s56, 64
    v_xad_u32 v38, v6, s57, v7
    v_lshrrev_b32 v6, 3, v4
    v_and_b32 v3, 7, v4
    v_lshl_or_b32 v6, v3, 1, v6
    v_xor_b32 v6, v6, v5
    v_lshl_add_u32 v6, v6, 4, v2
    v_lshlrev_b32 v7, 1, v7
    v_add_u32 v7, 24576, v7
    s_add_u32 s57, s56, 0
    v_xad_u32 v44, v6, s57, v7
    s_add_u32 s57, s56, 384
    v_xad_u32 v45, v6, s57, v7
    s_add_u32 s57, s56, 32
    v_xad_u32 v46, v6, s57, v7
    s_add_u32 s57, s56, 416
    v_xad_u32 v47, v6, s57, v7
    s_add_u32 s57, s56, 64
    v_xad_u32 v48, v6, s57, v7
    s_add_u32 s57, s56, 448
    v_xad_u32 v49, v6, s57, v7
    v_mov_b32 v52, 0x3f803f80
    v_mov_b32 v56, 0x3ebcbe62
    s_mov_b32 s44, 0x100001
    s_mov_b32 s45, 0x10000100
    v_mov_b32 v53, 0x3f803f80
    v_mov_b32 v57, 0x3ebcbe62
    s_mov_b32 s46, 0x200002
    s_mov_b32 s47, 0x20000200
    v_mov_b32 v54, 0x3f803f80
    v_mov_b32 v58, 0x3ebcbe62
    s_mov_b32 s48, 0x400004
    s_mov_b32 s49, 0x40000400
    v_mov_b32 v55, 0x3f803f80
    v_mov_b32 v59, 0x3ebcbe62
    s_mov_b32 s50, 0x800008
    s_mov_b32 s51, 0x80000800
    v_mov_b32 v60, 0x43400000
    v_lshrrev_b32 v1, 5, v0
    v_lshlrev_b32 v1, 8, v1
    v_and_b32 v2, 15, v0
    v_lshl_add_u32 v1, v2, 4, v1
    v_bfe_u32 v2, v0, 4, 1
    v_lshl_add_u32 v1, v2, 3, v1
    s_mul_i32 s56, s3, 1536
    s_add_u32 s56, s56, 147456
    v_add_u32 v236, s56, v1
    s_mul_i32 s56, s3, 3072
    s_add_u32 s56, s56, 24576
    v_add_u32 v237, s56, v65
    v_add_u32 v238, s41, v65
    s_lshl_b32 s56, s3, 10
    v_add_u32 v240, 159744, v65
    v_add_u32 v239, s56, v240
    v_add_u32 v241, 147456, v65
    v_bfe_u32 v1, v0, 2, 2
    v_lshrrev_b32 v2, 4, v0
    v_lshl_or_b32 v1, v1, 4, v2
    v_mul_u32_u24 v1, 65536, v1
    v_and_b32 v2, 3, v0
    v_lshl_or_b32 v242, v2, 4, v1
    v_xor_b32 v243, 0x70, v242
    s_mul_i32 s56, s3, 3
    v_min_u32 v1, 2, v0
    v_add_u32 v1, s56, v1
    v_min_u32 v2, 8, v0
    v_add_u32 v2, 9, v2
    v_cmp_gt_u32 vcc, 3, v0
    s_nop 1
    v_cndmask_b32 v1, v2, v1, vcc
    v_lshlrev_b32 v245, 7, v1
    v_lshlrev_b32 v1, 3, v0
    v_add_u32 v254, 126976, v1
    s_lshl_b32 s56, s3, 9
    v_add_u32 v238, s56, v254
    v_add_u32 v253, 122880, v65
    s_lshl_b32 s56, s3, 10
    v_add_u32 v237, s56, v253
    s_mov_b32 s52, 0x41c00000
L_join:
    s_mul_i32 s60, s3, 18432
    s_mov_b32 s72, s22
    s_mov_b32 s73, s23
    s_mov_b32 s74, 16777216
    s_mov_b32 s75, 0x20000
    s_cmp_eq_u32 s0, 1
    s_cselect_b32 s74, 0, s74
    s_waitcnt vmcnt(24)
    s_waitcnt lgkmcnt(0)
    s_barrier
    ds_read_b128 a[48:51], v34 offset:0
    ds_read_b128 a[52:55], v35 offset:0
    ds_read_b128 a[56:59], v34 offset:128
    ds_read_b128 a[60:63], v35 offset:128
    ds_read_b128 a[64:67], v34 offset:256
    ds_read_b128 a[68:71], v35 offset:256
    s_waitcnt lgkmcnt(5)
    v_mfma_f32_16x16x32_bf16 v[84:87], a[48:51], a[48:51], 0
    ds_read_b64_tr_b16 a[72:73], v36 offset:0
    ds_read_b64_tr_b16 a[74:75], v36 offset:6144
    v_mfma_f32_16x16x32_bf16 v[80:83], a[48:51], v[52:55], 0
    ds_read_b64_tr_b16 a[76:77], v36 offset:12288
    ds_read_b64_tr_b16 a[78:79], v36 offset:18432
    s_waitcnt lgkmcnt(8)
    v_mfma_f32_16x16x32_bf16 v[84:87], a[52:55], a[52:55], v[84:87]
    ds_read_b64_tr_b16 a[80:81], v37 offset:0
    ds_read_b64_tr_b16 a[82:83], v37 offset:6144
    v_mfma_f32_16x16x32_bf16 v[80:83], a[52:55], v[52:55], v[80:83]
    ds_read_b64_tr_b16 a[84:85], v37 offset:12288
    ds_read_b64_tr_b16 a[86:87], v37 offset:18432
    s_waitcnt lgkmcnt(11)
    v_mfma_f32_16x16x32_bf16 v[84:87], a[56:59], a[56:59], v[84:87]
    ds_read_b64_tr_b16 a[88:89], v38 offset:0
    ds_read_b64_tr_b16 a[90:91], v38 offset:6144
    v_mfma_f32_16x16x32_bf16 v[80:83], a[56:59], v[52:55], v[80:83]
    ds_read_b64_tr_b16 a[92:93], v38 offset:12288
    ds_read_b64_tr_b16 a[94:95], v38 offset:18432
    s_waitcnt lgkmcnt(14)
    v_mfma_f32_16x16x32_bf16 v[84:87], a[60:63], a[60:63], v[84:87]
    v_mfma_f32_16x16x32_bf16 v[80:83], a[60:63], v[52:55], v[80:83]
    s_waitcnt lgkmcnt(13)
    v_mfma_f32_16x16x32_bf16 v[84:87], a[64:67], a[64:67], v[84:87]
    v_mfma_f32_16x16x32_bf16 v[80:83], a[64:67], v[52:55], v[80:83]
    s_waitcnt lgkmcnt(12)
    v_mfma_f32_16x16x32_bf16 v[84:87], a[68:71], a[68:71], v[84:87]
    v_mfma_f32_16x16x32_bf16 v[80:83], a[68:71], v[52:55], v[80:83]
    s_waitcnt lgkmcnt(0)
    s_mul_i32 s39, s38, 0x9e3779b1
    s_add_u32 s39, s39, 0x7f4a7c16
    s_or_b32 s39, s39, 1
    s_mul_i32 s56, s3, 3072
    s_add_u32 s56, s56, 16384
    buffer_load_dwordx4 v[136:139], v65, s[32:35], s56 offen offset:0 sc1
    buffer_load_dwordx4 v[140:143], v65, s[32:35], s56 offen offset:1024 sc1
    buffer_load_dwordx4 v[144:147], v65, s[32:35], s56 offen offset:2048 sc1
    s_waitcnt vmcnt(15)
    s_barrier
    ds_read_b128 a[96:99], v40 offset:0
    ds_read_b128 a[100:103], v41 offset:0
    ds_read_b128 a[104:107], v42 offset:0
    ds_read_b128 a[108:111], v43 offset:0
    ds_read_b128 a[112:115], v40 offset:256
    ds_read_b128 a[116:119], v41 offset:256
    ds_read_b128 a[120:123], v42 offset:256
    ds_read_b128 a[124:127], v43 offset:256
    ds_read_b128 a[128:131], v40 offset:512
    ds_read_b128 a[132:135], v41 offset:512
    ds_read_b128 a[136:139], v42 offset:512
    ds_read_b128 a[140:143], v43 offset:512
    ds_read_b64_tr_b16 a[144:145], v44 offset:0
    ds_read_b64_tr_b16 a[146:147], v45 offset:0
    ds_read_b64_tr_b16 a[148:149], v44 offset:12288
    ds_read_b64_tr_b16 a[150:151], v45 offset:12288
    ds_read_b64_tr_b16 a[152:153], v44 offset:24576
    ds_read_b64_tr_b16 a[154:155], v45 offset:24576
    ds_read_b64_tr_b16 a[156:157], v44 offset:36864
    ds_read_b64_tr_b16 a[158:159], v45 offset:36864
    ds_read_b64_tr_b16 a[160:161], v46 offset:0
    ds_read_b64_tr_b16 a[162:163], v47 offset:0
    ds_read_b64_tr_b16 a[164:165], v46 offset:12288
    ds_read_b64_tr_b16 a[166:167], v47 offset:12288
    ds_read_b64_tr_b16 a[168:169], v46 offset:24576
    ds_read_b64_tr_b16 a[170:171], v47 offset:24576
    ds_read_b64_tr_b16 a[172:173], v46 offset:36864
    ds_read_b64_tr_b16 a[174:175], v47 offset:36864
    ds_read_b64_tr_b16 a[176:177], v48 offset:0
    ds_read_b64_tr_b16 a[178:179], v49 offset:0
    ds_read_b64_tr_b16 a[180:181], v48 offset:12288
    ds_read_b64_tr_b16 a[182:183], v49 offset:12288
    ds_read_b64_tr_b16 a[184:185], v48 offset:24576
    ds_read_b64_tr_b16 a[186:187], v49 offset:24576
    ds_read_b64_tr_b16 a[188:189], v48 offset:36864
    ds_read_b64_tr_b16 a[190:191], v49 offset:36864
    s_waitcnt lgkmcnt(0)
    s_barrier
    s_cmp_ge_u32 s43, 3
    s_cbranch_scc1 L_v_nofl
    s_mul_i32 s56, s3, 3
    s_add_u32 s56, s56, s43
    s_lshl_b32 s56, s56, 7
    v_mov_b32 v1, s39
    v_mov_b32 v2, 0
    s_mov_b64 exec, 1
    s_waitcnt vmcnt(9)
    buffer_store_dword v1, v2, s[32:35], s56 offen offset:128 sc1
    s_mov_b64 exec, -1
L_v_nofl:
    s_cmp_eq_u32 s98, 1
    s_cbranch_scc0 L_nopub
    s_lshl_b32 s56, s2, 4
    v_mov_b32 v2, s39
    v_mov_b32 v3, s20
    v_mov_b32 v1, 0
    s_mov_b64 exec, 1
    buffer_store_dwordx2 v[2:3], v1, s[32:35], s56 offen offset:1648 sc1
    s_mov_b64 exec, -1
L_nopub:
    v_mfma_f32_16x16x32_bf16 v[96:99], a[96:99], a[96:99], v[84:87]
    s_cmp_eq_u32 s0, 0
    s_cbranch_scc0 L_g1
    s_waitcnt vmcnt(11)
L_g1:
    s_add_u32 m0, s40, 0
    s_add_u32 s57, s36, 6291456
    buffer_load_dwordx4 v16, s[28:31], s57 offen offset:0 nt lds
    v_add_u32 v44, 49152, v44
    v_add_u32 v45, 49152, v45
    v_mfma_f32_16x16x32_bf16 v[100:103], a[96:99], a[48:51], 0
    s_cmp_eq_u32 s0, 0
    s_cbranch_scc0 L_g2
    s_waitcnt vmcnt(11)
L_g2:
    buffer_load_dwordx4 v17, s[28:31], s57 offen offset:1024 nt lds
    v_add_u32 v46, 49152, v46
    v_add_u32 v47, 49152, v47
    v_mfma_f32_16x16x32_bf16 v[96:99], a[100:103], a[100:103], v[96:99]
    v_add_u32 v48, 49152, v48
    v_add_u32 v49, 49152, v49
    v_mfma_f32_16x16x32_bf16 v[100:103], a[100:103], a[52:55], v[100:103]
    v_mfma_f32_16x16x32_bf16 v[96:99], a[104:107], a[104:107], v[96:99]
    v_mfma_f32_16x16x32_bf16 v[100:103], a[104:107], a[56:59], v[100:103]
    v_mfma_f32_16x16x32_bf16 v[96:99], a[108:111], a[108:111], v[96:99]
    v_mfma_f32_16x16x32_bf16 v[100:103], a[108:111], a[60:63], v[100:103]
    v_mfma_f32_16x16x32_bf16 v[96:99], a[112:115], a[112:115], v[96:99]
    v_mfma_f32_16x16x32_bf16 v[100:103], a[112:115], a[64:67], v[100:103]
    v_mfma_f32_16x16x32_bf16 v[96:99], a[116:119], a[116:119], v[96:99]
    v_mfma_f32_16x16x32_bf16 v[100:103], a[116:119], a[68:71], v[100:103]
    v_mfma_f32_16x16x32_bf16 v[92:95], a[96:99], v[52:55], v[80:83]
    v_mfma_f32_16x16x32_bf16 v[92:95], a[100:103], v[52:55], v[92:95]
    s_cmp_eq_u32 s0, 0
    s_cbranch_scc0 L_g3
    s_waitcnt vmcnt(11)
L_g3:
    buffer_load_dwordx4 v18, s[28:31], s57 offen offset:2048 nt lds
    v_mfma_f32_16x16x32_bf16 v[92:95], a[104:107], v[52:55], v[92:95]
    v_mfma_f32_16x16x32_bf16 v[92:95], a[108:111], v[52:55], v[92:95]
    v_fma_f32 v96, v100, 2.0, v96
    v_fma_f32 v97, v101, 2.0, v97
    v_mfma_f32_16x16x32_bf16 v[92:95], a[112:115], v[52:55], v[92:95]
    v_fma_f32 v98, v102, 2.0, v98
    v_fma_f32 v99, v103, 2.0, v99
    v_mfma_f32_16x16x32_bf16 v[92:95], a[116:119], v[52:55], v[92:95]
    v_cndmask_b32 v3, 0, v96, s[44:45]
    v_cndmask_b32 v3, v3, v97, s[46:47]
    v_mfma_f32_16x16x32_bf16 v[112:115], a[120:123], a[120:123], v[84:87]
    v_cndmask_b32 v3, v3, v98, s[48:49]
    v_cndmask_b32 v3, v3, v99, s[50:51]
    v_mfma_f32_16x16x32_bf16 v[116:119], a[120:123], a[48:51], 0
    s_nop 0
    s_nop 0
    v_mfma_f32_16x16x32_bf16 v[112:115], a[124:127], a[124:127], v[112:115]
    v_mfma_f32_16x16x4_f32 v[120:123], v3, v60, v[56:59]
    v_mfma_f32_16x16x32_bf16 v[116:119], a[124:127], a[52:55], v[116:119]
    v_mfma_f32_16x16x32_bf16 v[112:115], a[128:131], a[128:131], v[112:115]
    v_mfma_f32_16x16x32_bf16 v[116:119], a[128:131], a[56:59], v[116:119]
    v_mfma_f32_16x16x32_bf16 v[112:115], a[132:135], a[132:135], v[112:115]
    s_cmp_eq_u32 s0, 0
    s_cbranch_scc0 L_g4
    s_waitcnt vmcnt(11)
L_g4:
    buffer_load_dwordx4 v19, s[28:31], s57 offen offset:3072 nt lds
    s_nop 1
    v_fma_f32 v128, -v92, v92, v120
    v_fma_f32 v129, -v93, v93, v121
    v_mfma_f32_16x16x32_bf16 v[116:119], a[132:135], a[60:63], v[116:119]
    v_fma_f32 v130, -v94, v94, v122
    v_fma_f32 v131, -v95, v95, v123
    v_mfma_f32_16x16x32_bf16 v[112:115], a[136:139], a[136:139], v[112:115]
    v_max_f32 v128, v128, v56
    v_max_f32 v129, v129, v56
    v_mfma_f32_16x16x32_bf16 v[116:119], a[136:139], a[64:67], v[116:119]
    v_max_f32 v130, v130, v56
    v_max_f32 v131, v131, v56
    v_mfma_f32_16x16x32_bf16 v[112:115], a[140:143], a[140:143], v[112:115]
    v_rsq_f32 v128, v128
    v_mfma_f32_16x16x32_bf16 v[116:119], a[140:143], a[68:71], v[116:119]
    v_rsq_f32 v129, v129
    v_mfma_f32_16x16x32_bf16 v[108:111], a[120:123], v[52:55], v[80:83]
    v_rsq_f32 v130, v130
    v_mfma_f32_16x16x32_bf16 v[108:111], a[124:127], v[52:55], v[108:111]
    v_rsq_f32 v131, v131
    v_mfma_f32_16x16x32_bf16 v[108:111], a[128:131], v[52:55], v[108:111]
    v_mfma_f32_16x16x32_bf16 v[108:111], a[132:135], v[52:55], v[108:111]
    v_mfma_f32_16x16x32_bf16 v[108:111], a[136:139], v[52:55], v[108:111]
    v_fma_f32 v112, v116, 2.0, v112
    v_fma_f32 v113, v117, 2.0, v113
    v_mfma_f32_16x16x32_bf16 v[108:111], a[140:143], v[52:55], v[108:111]
    v_fma_f32 v114, v118, 2.0, v114
    v_fma_f32 v115, v119, 2.0, v115
    v_cndmask_b32 v4, 0, v112, s[44:45]
    v_cndmask_b32 v4, v4, v113, s[46:47]
    v_cndmask_b32 v4, v4, v114, s[48:49]
    v_cndmask_b32 v4, v4, v115, s[50:51]
    s_nop 0
    s_nop 0
    v_mfma_f32_16x16x4_f32 v[124:127], v4, v60, v[56:59]
    s_nop 9
    v_fma_f32 v132, -v108, v108, v124
    v_fma_f32 v133, -v109, v109, v125
    v_fma_f32 v134, -v110, v110, v126
    v_fma_f32 v135, -v111, v111, v127
    v_max_f32 v132, v132, v56
    v_max_f32 v133, v133, v56
    v_max_f32 v134, v134, v56
    v_max_f32 v135, v135, v56
    v_rsq_f32 v132, v132
    v_rsq_f32 v133, v133
    v_rsq_f32 v134, v134
    v_rsq_f32 v135, v135
    s_mul_i32 s56, s3, 1536
    v_lshlrev_b32 v5, 3, v0
    v_add_u32 v5, 153600, v5
    v_add_u32 v4, s56, v5
    s_cmp_eq_u32 s0, 0
    s_cbranch_scc0 L_g5
    s_waitcnt vmcnt(11)
L_g5:
    s_add_u32 m0, s40, 4096
    s_nop 0
    buffer_load_dwordx4 v20, s[28:31], s57 offen offset:0 nt lds
    s_cmp_eq_u32 s0, 0
    s_cbranch_scc0 L_g6
    s_waitcnt vmcnt(11)
L_g6:
    buffer_load_dwordx4 v21, s[28:31], s57 offen offset:1024 nt lds
    s_cmp_eq_u32 s0, 0
    s_cbranch_scc0 L_g7
    s_waitcnt vmcnt(11)
L_g7:
    s_add_u32 m0, s41, 0
    s_add_u32 s58, s37, 25165824
    buffer_load_dwordx4 v22, s[24:27], s58 offen offset:0 nt lds
    s_cmp_eq_u32 s0, 0
    s_cbranch_scc0 L_g8
    s_waitcnt vmcnt(11)
L_g8:
    buffer_load_dwordx4 v23, s[24:27], s58 offen offset:1024 nt lds
    s_cmp_eq_u32 s0, 0
    s_cbranch_scc0 L_g9
    s_waitcnt vmcnt(7)
L_g9:
    buffer_load_dwordx4 v24, s[24:27], s58 offen offset:2048 nt lds
    s_cmp_eq_u32 s0, 0
    s_cbranch_scc0 L_g10
    s_waitcnt vmcnt(7)
L_g10:
    buffer_load_dwordx4 v25, s[24:27], s58 offen offset:3072 nt lds
    s_cmp_eq_u32 s0, 0
    s_cbranch_scc0 L_g11
    s_waitcnt vmcnt(7)
L_g11:
    s_add_u32 m0, s41, 4096
    s_nop 0
    buffer_load_dwordx4 v26, s[24:27], s58 offen offset:0 nt lds
    s_waitcnt vmcnt(11)
    v_xor_b32 v1, s39, v138
    v_xor_b32 v2, s39, v142
    v_xor_b32 v3, s39, v146
    v_or3_b32 v1, v1, v2, v3
    v_cmp_ne_u32 vcc, 0, v1
    s_cbranch_vccnz L_qk_retry
L_qk_ok:
    ds_write_b64 v4, v[136:137] offset:0
    ds_write_b64 v4, v[140:141] offset:512
    ds_write_b64 v4, v[144:145] offset:1024
    s_waitcnt lgkmcnt(0)
    s_barrier
    ds_read2st64_b64 v[136:139], v5 offset0:0 offset1:1
    ds_read2st64_b64 v[140:143], v5 offset0:2 offset1:3
    ds_read2st64_b64 v[144:147], v5 offset0:4 offset1:5
    ds_read2st64_b64 v[148:151], v5 offset0:6 offset1:7
    ds_read2st64_b64 v[152:155], v5 offset0:8 offset1:9
    ds_read2st64_b64 v[156:159], v5 offset0:10 offset1:11
    s_waitcnt lgkmcnt(5)
    v_mfma_f32_16x16x32_bf16 v[120:123], v[52:55], v[136:139], 0
    v_mfma_f32_16x16x32_bf16 v[76:79], a[48:51], v[136:139], 0
    s_waitcnt lgkmcnt(4)
    v_mfma_f32_16x16x32_bf16 v[120:123], v[52:55], v[140:143], v[120:123]
    v_mfma_f32_16x16x32_bf16 v[76:79], a[52:55], v[140:143], v[76:79]
    s_waitcnt lgkmcnt(3)
    v_mfma_f32_16x16x32_bf16 v[120:123], v[52:55], v[144:147], v[120:123]
    v_mfma_f32_16x16x32_bf16 v[76:79], a[56:59], v[144:147], v[76:79]
    s_waitcnt lgkmcnt(2)
    v_mfma_f32_16x16x32_bf16 v[120:123], v[52:55], v[148:151], v[120:123]
    v_mfma_f32_16x16x32_bf16 v[76:79], a[60:63], v[148:151], v[76:79]
    s_cmp_eq_u32 s0, 0
    s_cbranch_scc0 L_g12
    s_waitcnt vmcnt(7)
L_g12:
    buffer_load_dwordx4 v27, s[24:27], s58 offen offset:1024 nt lds
    s_waitcnt lgkmcnt(1)
    v_mfma_f32_16x16x32_bf16 v[120:123], v[52:55], v[152:155], v[120:123]
    v_mfma_f32_16x16x32_bf16 v[76:79], a[64:67], v[152:155], v[76:79]
    s_waitcnt lgkmcnt(0)
    v_mfma_f32_16x16x32_bf16 v[120:123], v[52:55], v[156:159], v[120:123]
    v_mfma_f32_16x16x32_bf16 v[76:79], a[68:71], v[156:159], v[76:79]
    s_nop 6
    v_mul_f32 v61, 0x3baaaaab, v120
    v_mfma_f32_16x16x32_bf16 v[88:91], a[96:99], v[136:139], v[76:79]
    v_mov_b32 v9, 0
    v_mfma_f32_16x16x32_bf16 v[88:91], a[100:103], v[140:143], v[88:91]
    v_mfma_f32_16x16x32_bf16 v[88:91], a[104:107], v[144:147], v[88:91]
    v_mfma_f32_16x16x32_bf16 v[88:91], a[108:111], v[148:151], v[88:91]
    v_mfma_f32_16x16x32_bf16 v[88:91], a[112:115], v[152:155], v[88:91]
    v_mfma_f32_16x16x32_bf16 v[88:91], a[116:119], v[156:159], v[88:91]
    ds_write_b32 v254, v9 offset:4096
    ds_write_b32 v254, v9 offset:4100
    v_mfma_f32_16x16x32_bf16 v[104:107], a[120:123], v[136:139], v[76:79]
    v_mfma_f32_16x16x32_bf16 v[104:107], a[124:127], v[140:143], v[104:107]
    v_mfma_f32_16x16x32_bf16 v[104:107], a[128:131], v[144:147], v[104:107]
    v_mfma_f32_16x16x32_bf16 v[104:107], a[132:135], v[148:151], v[104:107]
    s_cmp_eq_u32 s0, 0
    s_cbranch_scc0 L_g13
    s_waitcnt vmcnt(7)
L_g13:
    buffer_load_dwordx4 v28, s[24:27], s58 offen offset:2048 nt lds
    v_fma_f32 v88, -v92, v61, v88
    v_fma_f32 v89, -v93, v61, v89
    v_mfma_f32_16x16x32_bf16 v[104:107], a[136:139], v[152:155], v[104:107]
    v_fma_f32 v90, -v94, v61, v90
    v_fma_f32 v91, -v95, v61, v91
    v_mfma_f32_16x16x32_bf16 v[104:107], a[140:143], v[156:159], v[104:107]
    v_mul_f32 v88, v88, v128
    v_mul_f32 v89, v89, v129
    v_mul_f32 v90, v90, v130
    v_mul_f32 v91, v91, v131
    v_max3_f32 v1, v88, v89, v90
    v_max_f32 v1, v1, v91
    s_nop 1
    v_fma_f32 v104, -v108, v61, v104
    v_fma_f32 v105, -v109, v61, v105
    v_fma_f32 v106, -v110, v61, v106
    v_fma_f32 v107, -v111, v61, v107
    v_mul_f32 v104, v104, v132
    v_mul_f32 v105, v105, v133
    v_mul_f32 v106, v106, v134
    v_mul_f32 v107, v107, v135
    v_max3_f32 v1, v1, v104, v105
    v_max3_f32 v1, v1, v106, v107
    v_mov_b32 v2, v1
    s_nop 1
    v_permlane32_swap_b32 v1, v2
    v_max_f32 v1, v1, v2
    v_mov_b32 v2, v1
    s_nop 1
    v_permlane16_swap_b32 v1, v2
    v_max_f32 v1, v1, v2
    ds_write_b32 v239, v1
    s_waitcnt lgkmcnt(0)
    s_barrier
    ds_read_b32 v12, v240 offset:0
    ds_read_b32 v13, v240 offset:1024
    ds_read_b32 v14, v240 offset:2048
    ds_read_b32 v15, v240 offset:3072
    s_cmp_eq_u32 s0, 0
    s_cbranch_scc0 L_g14
    s_waitcnt vmcnt(7)
L_g14:
    buffer_load_dwordx4 v29, s[24:27], s58 offen offset:3072 nt lds
    s_waitcnt lgkmcnt(0)
    v_max3_f32 v1, v12, v13, v14
    v_max_f32 v1, v1, v15
    v_sub_f32 v88, v88, v1
    v_sub_f32 v89, v89, v1
    v_sub_f32 v90, v90, v1
    v_sub_f32 v91, v91, v1
    v_sub_f32 v104, v104, v1
    v_sub_f32 v105, v105, v1
    v_sub_f32 v106, v106, v1
    v_sub_f32 v107, v107, v1
    v_sub_f32 v62, 0, v1
    v_sub_f32 v255, 0, v1
    v_exp_f32 v96, v88
    v_exp_f32 v97, v89
    v_exp_f32 v98, v90
    v_exp_f32 v99, v91
    v_mul_f32 v88, v96, v128
    v_mul_f32 v89, v97, v129
    v_mul_f32 v90, v98, v130
    v_mul_f32 v91, v99, v131
    s_cmp_eq_u32 s0, 0
    s_cbranch_scc0 L_g15
    s_waitcnt vmcnt(7)
L_g15:
    s_add_u32 m0, s41, 8192
    s_nop 0
    buffer_load_dwordx4 v30, s[24:27], s58 offen offset:0 nt lds
    v_exp_f32 v112, v104
    v_exp_f32 v113, v105
    v_exp_f32 v114, v106
    v_exp_f32 v115, v107
    v_cvt_pk_bf16_f32 v72, v88, v89
    v_cvt_pk_bf16_f32 v73, v90, v91
    v_mul_f32 v104, v112, v132
    v_mul_f32 v105, v113, v133
    v_mul_f32 v106, v114, v134
    v_mul_f32 v107, v115, v135
    v_cvt_pk_bf16_f32 v74, v104, v105
    v_cvt_pk_bf16_f32 v75, v106, v107
    ds_write_b128 v237, v[72:75] offset:0
    v_mov_b32 v63, v96
    v_mul_f32 v64, v88, v92
    v_add_f32 v63, v63, v97
    v_fmac_f32 v64, v89, v93
    v_add_f32 v63, v63, v98
    v_fmac_f32 v64, v90, v94
    v_add_f32 v63, v63, v99
    v_fmac_f32 v64, v91, v95
    v_mov_b32 v68, v88
    v_mov_b32 v69, v89
    v_mov_b32 v70, v90
    v_mov_b32 v71, v91
    s_waitcnt lgkmcnt(0)
    s_barrier
    ds_read_b128 v[92:95], v253 offset:0
    ds_read_b128 v[96:99], v253 offset:1024
    ds_read_b128 v[100:103], v253 offset:2048
    ds_read_b128 v[116:119], v253 offset:3072
    s_waitcnt lgkmcnt(3)
    v_mfma_f32_16x16x32_bf16 a[0:3], a[144:147], v[92:95], 0
    s_cmp_eq_u32 s0, 0
    s_cbranch_scc0 L_g16
    s_waitcnt vmcnt(7)
L_g16:
    buffer_load_dwordx4 v31, s[24:27], s58 offen offset:1024 nt lds
    v_add_f32 v68, v68, v104
    v_add_f32 v69, v69, v105
    v_mfma_f32_16x16x32_bf16 a[4:7], a[160:163], v[92:95], 0
    v_add_f32 v70, v70, v106
    v_add_f32 v71, v71, v107
    v_mfma_f32_16x16x32_bf16 a[8:11], a[176:179], v[92:95], 0
    v_add_f32 v63, v63, v112
    v_fma_f32 v64, v104, v108, v64
    s_waitcnt lgkmcnt(2)
    v_mfma_f32_16x16x32_bf16 a[0:3], a[148:151], v[96:99], a[0:3]
    v_add_f32 v63, v63, v113
    v_fma_f32 v64, v105, v109, v64
    v_mfma_f32_16x16x32_bf16 a[4:7], a[164:167], v[96:99], a[4:7]
    v_add_f32 v63, v63, v114
    v_fma_f32 v64, v106, v110, v64
    v_mfma_f32_16x16x32_bf16 a[8:11], a[180:183], v[96:99], a[8:11]
    s_cmp_eq_u32 s0, 0
    s_cbranch_scc0 L_g17
    s_waitcnt vmcnt(7)
L_g17:
    buffer_load_dwordx4 v32, s[24:27], s58 offen offset:2048 nt lds
    v_add_f32 v63, v63, v115
    v_fma_f32 v64, v107, v111, v64
    s_waitcnt lgkmcnt(1)
    v_mfma_f32_16x16x32_bf16 a[0:3], a[152:155], v[100:103], a[0:3]
    v_mfma_f32_16x16x32_bf16 a[4:7], a[168:171], v[100:103], a[4:7]
    v_mfma_f32_16x16x32_bf16 a[8:11], a[184:187], v[100:103], a[8:11]
    s_waitcnt lgkmcnt(0)
    v_mfma_f32_16x16x32_bf16 a[0:3], a[156:159], v[116:119], a[0:3]
    v_mfma_f32_16x16x32_bf16 a[4:7], a[172:175], v[116:119], a[4:7]
    v_mfma_f32_16x16x32_bf16 a[8:11], a[188:191], v[116:119], a[8:11]
    s_barrier
    ds_read_b128 a[96:99], v40 offset:49152
    ds_read_b128 a[100:103], v41 offset:49152
    ds_read_b128 a[104:107], v42 offset:49152
    ds_read_b128 a[108:111], v43 offset:49152
    ds_read_b128 a[112:115], v40 offset:49408
    ds_read_b128 a[116:119], v41 offset:49408
    ds_read_b128 a[120:123], v42 offset:49408
    ds_read_b128 a[124:127], v43 offset:49408
    ds_read_b128 a[128:131], v40 offset:49664
    ds_read_b128 a[132:135], v41 offset:49664
    ds_read_b128 a[136:139], v42 offset:49664
    ds_read_b128 a[140:143], v43 offset:49664
    s_waitcnt lgkmcnt(11)
    v_mfma_f32_16x16x32_bf16 v[96:99], a[96:99], a[96:99], v[84:87]
    s_cmp_eq_u32 s0, 0
    s_cbranch_scc0 L_g18
    s_waitcnt vmcnt(7)
L_g18:
    buffer_load_dwordx4 v33, s[24:27], s58 offen offset:3072 nt lds
    ds_read_b64_tr_b16 a[144:145], v44 offset:0
    ds_read_b64_tr_b16 a[146:147], v45 offset:0
    v_mfma_f32_16x16x32_bf16 v[100:103], a[96:99], a[48:51], 0
    ds_read_b64_tr_b16 a[148:149], v44 offset:12288
    ds_read_b64_tr_b16 a[150:151], v45 offset:12288
    s_waitcnt lgkmcnt(14)
    v_mfma_f32_16x16x32_bf16 v[96:99], a[100:103], a[100:103], v[96:99]
    ds_read_b64_tr_b16 a[152:153], v44 offset:24576
    ds_read_b64_tr_b16 a[154:155], v45 offset:24576
    v_mfma_f32_16x16x32_bf16 v[100:103], a[100:103], a[52:55], v[100:103]
    ds_read_b64_tr_b16 a[156:157], v44 offset:36864
    ds_read_b64_tr_b16 a[158:159], v45 offset:36864
    s_waitcnt lgkmcnt(15)
    v_mfma_f32_16x16x32_bf16 v[96:99], a[104:107], a[104:107], v[96:99]
    ds_read_b64_tr_b16 a[160:161], v46 offset:0
    ds_read_b64_tr_b16 a[162:163], v47 offset:0
    v_mfma_f32_16x16x32_bf16 v[100:103], a[104:107], a[56:59], v[100:103]
    ds_read_b64_tr_b16 a[164:165], v46 offset:12288
    ds_read_b64_tr_b16 a[166:167], v47 offset:12288
    v_mfma_f32_16x16x32_bf16 v[96:99], a[108:111], a[108:111], v[96:99]
    ds_read_b64_tr_b16 a[168:169], v46 offset:24576
    ds_read_b64_tr_b16 a[170:171], v47 offset:24576
    v_mfma_f32_16x16x32_bf16 v[100:103], a[108:111], a[60:63], v[100:103]
    ds_read_b64_tr_b16 a[172:173], v46 offset:36864
    ds_read_b64_tr_b16 a[174:175], v47 offset:36864
    v_mfma_f32_16x16x32_bf16 v[96:99], a[112:115], a[112:115], v[96:99]
    ds_read_b64_tr_b16 a[176:177], v48 offset:0
    ds_read_b64_tr_b16 a[178:179], v49 offset:0
    v_mfma_f32_16x16x32_bf16 v[100:103], a[112:115], a[64:67], v[100:103]
    ds_read_b64_tr_b16 a[180:181], v48 offset:12288
    ds_read_b64_tr_b16 a[182:183], v49 offset:12288
    s_waitcnt lgkmcnt(15)
    v_mfma_f32_16x16x32_bf16 v[96:99], a[116:119], a[116:119], v[96:99]
    ds_read_b64_tr_b16 a[184:185], v48 offset:24576
    ds_read_b64_tr_b16 a[186:187], v49 offset:24576
    v_mfma_f32_16x16x32_bf16 v[100:103], a[116:119], a[68:71], v[100:103]
    ds_read_b64_tr_b16 a[188:189], v48 offset:36864
    ds_read_b64_tr_b16 a[190:191], v49 offset:36864
    v_mfma_f32_16x16x32_bf16 v[92:95], a[96:99], v[52:55], v[80:83]
    v_mfma_f32_16x16x32_bf16 v[92:95], a[100:103], v[52:55], v[92:95]
    v_mfma_f32_16x16x32_bf16 v[92:95], a[104:107], v[52:55], v[92:95]
    v_mfma_f32_16x16x32_bf16 v[92:95], a[108:111], v[52:55], v[92:95]
    s_nop 1
    v_fma_f32 v96, v100, 2.0, v96
    v_fma_f32 v97, v101, 2.0, v97
    v_mfma_f32_16x16x32_bf16 v[92:95], a[112:115], v[52:55], v[92:95]
    v_fma_f32 v98, v102, 2.0, v98
    v_fma_f32 v99, v103, 2.0, v99
    v_mfma_f32_16x16x32_bf16 v[92:95], a[116:119], v[52:55], v[92:95]
    v_cndmask_b32 v3, 0, v96, s[44:45]
    v_cndmask_b32 v3, v3, v97, s[46:47]
    v_mfma_f32_16x16x32_bf16 v[88:91], a[96:99], v[136:139], v[76:79]
    v_cndmask_b32 v3, v3, v98, s[48:49]
    v_cndmask_b32 v3, v3, v99, s[50:51]
    v_mfma_f32_16x16x32_bf16 v[88:91], a[100:103], v[140:143], v[88:91]
    s_nop 0
    s_nop 0
    v_mfma_f32_16x16x32_bf16 v[88:91], a[104:107], v[144:147], v[88:91]
    v_mfma_f32_16x16x4_f32 v[120:123], v3, v60, v[56:59]
    v_mfma_f32_16x16x32_bf16 v[88:91], a[108:111], v[148:151], v[88:91]
    v_mfma_f32_16x16x32_bf16 v[88:91], a[112:115], v[152:155], v[88:91]
    v_mfma_f32_16x16x32_bf16 v[88:91], a[116:119], v[156:159], v[88:91]
    s_waitcnt lgkmcnt(0)
    s_barrier
    v_mfma_f32_16x16x32_bf16 v[112:115], a[120:123], a[120:123], v[84:87]
    s_cmp_eq_u32 s0, 0
    s_cbranch_scc0 L_g19
    s_waitcnt vmcnt(7)
L_g19:
    s_add_u32 m0, s42, 0
    s_add_u32 s59, s37, 25362432
    buffer_load_dwordx4 v22, s[24:27], s59 offen offset:0 nt lds
    v_mfma_f32_16x16x32_bf16 v[116:119], a[120:123], a[48:51], 0
    s_cmp_eq_u32 s0, 0
    s_cbranch_scc0 L_g20
    s_waitcnt vmcnt(7)
L_g20:
    buffer_load_dwordx4 v23, s[24:27], s59 offen offset:1024 nt lds
    v_mfma_f32_16x16x32_bf16 v[112:115], a[124:127], a[124:127], v[112:115]
    v_mfma_f32_16x16x32_bf16 v[116:119], a[124:127], a[52:55], v[116:119]
    v_fma_f32 v128, -v92, v92, v120
    v_fma_f32 v129, -v93, v93, v121
    v_mfma_f32_16x16x32_bf16 v[112:115], a[128:131], a[128:131], v[112:115]
    v_fma_f32 v130, -v94, v94, v122
    v_fma_f32 v131, -v95, v95, v123
    v_mfma_f32_16x16x32_bf16 v[116:119], a[128:131], a[56:59], v[116:119]
    v_max_f32 v128, v128, v56
    v_max_f32 v129, v129, v56
    v_mfma_f32_16x16x32_bf16 v[112:115], a[132:135], a[132:135], v[112:115]
    s_cmp_eq_u32 s0, 0
    s_cbranch_scc0 L_g21
    s_waitcnt vmcnt(7)
L_g21:
    buffer_load_dwordx4 v24, s[24:27], s59 offen offset:2048 nt lds
    v_max_f32 v130, v130, v56
    v_max_f32 v131, v131, v56
    v_mfma_f32_16x16x32_bf16 v[116:119], a[132:135], a[60:63], v[116:119]
    v_rsq_f32 v128, v128
    v_mfma_f32_16x16x32_bf16 v[112:115], a[136:139], a[136:139], v[112:115]
    v_rsq_f32 v129, v129
    v_mfma_f32_16x16x32_bf16 v[116:119], a[136:139], a[64:67], v[116:119]
    v_rsq_f32 v130, v130
    v_mfma_f32_16x16x32_bf16 v[112:115], a[140:143], a[140:143], v[112:115]
    v_rsq_f32 v131, v131
    v_mfma_f32_16x16x32_bf16 v[116:119], a[140:143], a[68:71], v[116:119]
    v_fma_f32 v88, -v92, v61, v88
    v_fma_f32 v89, -v93, v61, v89
    v_mfma_f32_16x16x32_bf16 v[108:111], a[120:123], v[52:55], v[80:83]
    v_fma_f32 v90, -v94, v61, v90
    v_fma_f32 v91, -v95, v61, v91
    v_mfma_f32_16x16x32_bf16 v[108:111], a[124:127], v[52:55], v[108:111]
    v_fma_f32 v88, v88, v128, v62
    v_fma_f32 v89, v89, v129, v62
    v_mfma_f32_16x16x32_bf16 v[108:111], a[128:131], v[52:55], v[108:111]
    v_fma_f32 v90, v90, v130, v62
    v_fma_f32 v91, v91, v131, v62
    v_mfma_f32_16x16x32_bf16 v[108:111], a[132:135], v[52:55], v[108:111]
    v_max3_f32 v1, v88, v89, v90
    v_max_f32 v1, v1, v91
    v_mfma_f32_16x16x32_bf16 v[108:111], a[136:139], v[52:55], v[108:111]
    v_cmp_lt_f32 vcc, s52, v1
    s_cbranch_vccnz L_site0
L_back0:
    v_mfma_f32_16x16x32_bf16 v[108:111], a[140:143], v[52:55], v[108:111]
    v_exp_f32 v96, v88
    v_mfma_f32_16x16x32_bf16 v[104:107], a[120:123], v[136:139], v[76:79]
    v_exp_f32 v97, v89
    v_mfma_f32_16x16x32_bf16 v[104:107], a[124:127], v[140:143], v[104:107]
    s_cmp_eq_u32 s0, 0
    s_cbranch_scc0 L_g22
    s_waitcnt vmcnt(7)
L_g22:
    buffer_load_dwordx4 v25, s[24:27], s59 offen offset:3072 nt lds
    v_exp_f32 v98, v90
    v_mfma_f32_16x16x32_bf16 v[104:107], a[128:131], v[144:147], v[104:107]
    v_exp_f32 v99, v91
    v_mfma_f32_16x16x32_bf16 v[104:107], a[132:135], v[148:151], v[104:107]
    v_mul_f32 v88, v96, v128
    v_mul_f32 v89, v97, v129
    v_mfma_f32_16x16x32_bf16 v[104:107], a[136:139], v[152:155], v[104:107]
    v_mul_f32 v90, v98, v130
    v_mul_f32 v91, v99, v131
    v_mfma_f32_16x16x32_bf16 v[104:107], a[140:143], v[156:159], v[104:107]
    v_fma_f32 v112, v116, 2.0, v112
    v_fma_f32 v113, v117, 2.0, v113
    v_fma_f32 v114, v118, 2.0, v114
    v_fma_f32 v115, v119, 2.0, v115
    v_cndmask_b32 v4, 0, v112, s[44:45]
    v_cndmask_b32 v4, v4, v113, s[46:47]
    v_cndmask_b32 v4, v4, v114, s[48:49]
    v_cndmask_b32 v4, v4, v115, s[50:51]
    v_add_f32 v63, v63, v96
    v_fmac_f32 v64, v88, v92
    v_mfma_f32_16x16x4_f32 v[124:127], v4, v60, v[56:59]
    v_add_f32 v63, v63, v97
    v_fmac_f32 v64, v89, v93
    v_add_f32 v63, v63, v98
    v_fmac_f32 v64, v90, v94
    v_add_f32 v63, v63, v99
    v_fmac_f32 v64, v91, v95
    v_add_f32 v68, v68, v88
    v_add_f32 v69, v69, v89
    v_add_f32 v70, v70, v90
    v_add_f32 v71, v71, v91
    v_add_u32 v44, -49152, v44
    v_add_u32 v45, -49152, v45
    v_add_u32 v46, -49152, v46
    v_add_u32 v47, -49152, v47
    v_add_u32 v48, -49152, v48
    v_add_u32 v49, -49152, v49
    v_fma_f32 v132, -v108, v108, v124
    v_fma_f32 v133, -v109, v109, v125
    v_fma_f32 v134, -v110, v110, v126
    v_fma_f32 v135, -v111, v111, v127
    v_max_f32 v132, v132, v56
    v_max_f32 v133, v133, v56
    v_max_f32 v134, v134, v56
    v_max_f32 v135, v135, v56
    v_rsq_f32 v132, v132
    v_rsq_f32 v133, v133
    v_rsq_f32 v134, v134
    v_rsq_f32 v135, v135
    s_cmp_eq_u32 s0, 0
    s_cbranch_scc0 L_g23
    s_waitcnt vmcnt(7)
L_g23:
    s_add_u32 m0, s42, 4096
    s_nop 0
    buffer_load_dwordx4 v26, s[24:27], s59 offen offset:0 nt lds
    v_fma_f32 v104, -v108, v61, v104
    v_fma_f32 v105, -v109, v61, v105
    v_fma_f32 v106, -v110, v61, v106
    v_fma_f32 v107, -v111, v61, v107
    v_fma_f32 v104, v104, v132, v62
    v_fma_f32 v105, v105, v133, v62
    v_fma_f32 v106, v106, v134, v62
    v_fma_f32 v107, v107, v135, v62
    v_max3_f32 v1, v104, v105, v106
    v_max_f32 v1, v1, v107
    v_cmp_lt_f32 vcc, s52, v1
    s_cbranch_vccnz L_site1
L_back1:
    v_exp_f32 v112, v104
    v_exp_f32 v113, v105
    v_exp_f32 v114, v106
    v_exp_f32 v115, v107
    v_cvt_pk_bf16_f32 v72, v88, v89
    v_cvt_pk_bf16_f32 v73, v90, v91
    v_mul_f32 v104, v112, v132
    v_mul_f32 v105, v113, v133
    v_mul_f32 v106, v114, v134
    v_mul_f32 v107, v115, v135
    v_cvt_pk_bf16_f32 v74, v104, v105
    v_cvt_pk_bf16_f32 v75, v106, v107
    ds_write_b128 v237, v[72:75] offset:0
    v_add_f32 v68, v68, v104
    v_add_f32 v69, v69, v105
    v_add_f32 v70, v70, v106
    v_add_f32 v71, v71, v107
    v_cvt_pk_bf16_f32 v66, v68, v69
    v_cvt_pk_bf16_f32 v67, v70, v71
    ds_write_b64 v238, v[66:67]
    s_cmp_eq_u32 s0, 0
    s_cbranch_scc0 L_g24
    s_waitcnt vmcnt(7)
L_g24:
    buffer_load_dwordx4 v27, s[24:27], s59 offen offset:1024 nt lds
    s_waitcnt vmcnt(18)
    s_waitcnt lgkmcnt(0)
    s_barrier
L_post3:
    ds_read_b32 v9, v254 offset:4096
    ds_read_b64 v[120:121], v254 offset:0
    ds_read_b64 v[122:123], v254 offset:512
    ds_read_b64 v[124:125], v254 offset:1024
    ds_read_b64 v[126:127], v254 offset:1536
    ds_read_b128 v[92:95], v253 offset:0
    ds_read_b128 v[96:99], v253 offset:1024
    ds_read_b128 v[100:103], v253 offset:2048
    ds_read_b128 v[116:119], v253 offset:3072
    ds_read_b128 a[48:51], v34 offset:0
    ds_read_b128 a[52:55], v35 offset:0
    ds_read_b128 a[56:59], v34 offset:128
    ds_read_b128 a[60:63], v35 offset:128
    ds_read_b128 a[64:67], v34 offset:256
    ds_read_b128 a[68:71], v35 offset:256
    s_waitcnt lgkmcnt(14)
    v_cmp_ne_u32 vcc, 0, v9
    s_cbranch_vccnz L_xt3
    s_waitcnt lgkmcnt(12)
    v_mfma_f32_16x16x32_bf16 a[0:3], a[72:75], v[120:123], a[0:3]
    v_add_f32 v63, v63, v112
    v_fma_f32 v64, v104, v108, v64
    v_mfma_f32_16x16x32_bf16 a[4:7], a[80:83], v[120:123], a[4:7]
    s_cmp_eq_u32 s0, 0
    s_cbranch_scc0 L_g25
    s_waitcnt vmcnt(7)
L_g25:
    buffer_load_dwordx4 v28, s[24:27], s59 offen offset:2048 nt lds
    v_add_f32 v63, v63, v113
    v_fma_f32 v64, v105, v109, v64
    v_mfma_f32_16x16x32_bf16 a[8:11], a[88:91], v[120:123], a[8:11]
    v_add_f32 v63, v63, v114
    v_fma_f32 v64, v106, v110, v64
    s_waitcnt lgkmcnt(10)
    v_mfma_f32_16x16x32_bf16 a[0:3], a[76:79], v[124:127], a[0:3]
    v_add_f32 v63, v63, v115
    v_fma_f32 v64, v107, v111, v64
    v_mfma_f32_16x16x32_bf16 a[4:7], a[84:87], v[124:127], a[4:7]
    v_mfma_f32_16x16x32_bf16 a[8:11], a[92:95], v[124:127], a[8:11]
    s_waitcnt lgkmcnt(9)
    v_mfma_f32_16x16x32_bf16 a[0:3], a[144:147], v[92:95], a[0:3]
    ds_read_b64_tr_b16 a[72:73], v36 offset:0
    ds_read_b64_tr_b16 a[74:75], v36 offset:6144
    v_mfma_f32_16x16x32_bf16 a[4:7], a[160:163], v[92:95], a[4:7]
    ds_read_b64_tr_b16 a[76:77], v36 offset:12288
    ds_read_b64_tr_b16 a[78:79], v36 offset:18432
    v_mfma_f32_16x16x32_bf16 a[8:11], a[176:179], v[92:95], a[8:11]
    ds_read_b64_tr_b16 a[80:81], v37 offset:0
    ds_read_b64_tr_b16 a[82:83], v37 offset:6144
    s_waitcnt lgkmcnt(14)
    v_mfma_f32_16x16x32_bf16 a[0:3], a[148:151], v[96:99], a[0:3]
    ds_read_b64_tr_b16 a[84:85], v37 offset:12288
    ds_read_b64_tr_b16 a[86:87], v37 offset:18432
    v_mfma_f32_16x16x32_bf16 a[4:7], a[164:167], v[96:99], a[4:7]
    ds_read_b64_tr_b16 a[88:89], v38 offset:0
    ds_read_b64_tr_b16 a[90:91], v38 offset:6144
    v_mfma_f32_16x16x32_bf16 a[8:11], a[180:183], v[96:99], a[8:11]
    ds_read_b64_tr_b16 a[92:93], v38 offset:12288
    ds_read_b64_tr_b16 a[94:95], v38 offset:18432
    s_waitcnt lgkmcnt(15)
    v_mfma_f32_16x16x32_bf16 a[0:3], a[152:155], v[100:103], a[0:3]
    s_cmp_eq_u32 s0, 0
    s_cbranch_scc0 L_g26
    s_waitcnt vmcnt(7)
L_g26:
    buffer_load_dwordx4 v29, s[24:27], s59 offen offset:3072 nt lds
    v_mfma_f32_16x16x32_bf16 a[4:7], a[168:171], v[100:103], a[4:7]
    v_mfma_f32_16x16x32_bf16 a[8:11], a[184:187], v[100:103], a[8:11]
    v_mfma_f32_16x16x32_bf16 a[0:3], a[156:159], v[116:119], a[0:3]
    v_mfma_f32_16x16x32_bf16 a[4:7], a[172:175], v[116:119], a[4:7]
    v_mfma_f32_16x16x32_bf16 a[8:11], a[188:191], v[116:119], a[8:11]
    v_mfma_f32_16x16x32_bf16 v[84:87], a[48:51], a[48:51], 0
    v_mfma_f32_16x16x32_bf16 v[80:83], a[48:51], v[52:55], 0
    v_mfma_f32_16x16x32_bf16 v[84:87], a[52:55], a[52:55], v[84:87]
    v_mfma_f32_16x16x32_bf16 v[80:83], a[52:55], v[52:55], v[80:83]
    v_mfma_f32_16x16x32_bf16 v[84:87], a[56:59], a[56:59], v[84:87]
    v_mfma_f32_16x16x32_bf16 v[80:83], a[56:59], v[52:55], v[80:83]
    s_waitcnt lgkmcnt(14)
    v_mfma_f32_16x16x32_bf16 v[84:87], a[60:63], a[60:63], v[84:87]
    v_mfma_f32_16x16x32_bf16 v[80:83], a[60:63], v[52:55], v[80:83]
    s_cmp_eq_u32 s0, 0
    s_cbranch_scc0 L_g27
    s_waitcnt vmcnt(7)
L_g27:
    s_add_u32 m0, s42, 8192
    s_nop 0
    buffer_load_dwordx4 v30, s[24:27], s59 offen offset:0 nt lds
    s_waitcnt lgkmcnt(13)
    v_mfma_f32_16x16x32_bf16 v[84:87], a[64:67], a[64:67], v[84:87]
    v_mfma_f32_16x16x32_bf16 v[80:83], a[64:67], v[52:55], v[80:83]
    s_waitcnt lgkmcnt(12)
    v_mfma_f32_16x16x32_bf16 v[84:87], a[68:71], a[68:71], v[84:87]
    v_mfma_f32_16x16x32_bf16 v[80:83], a[68:71], v[52:55], v[80:83]
    s_waitcnt lgkmcnt(0)
    v_mfma_f32_16x16x32_bf16 v[76:79], a[48:51], v[136:139], 0
    v_mfma_f32_16x16x32_bf16 v[76:79], a[52:55], v[140:143], v[76:79]
    v_mfma_f32_16x16x32_bf16 v[76:79], a[56:59], v[144:147], v[76:79]
    v_mfma_f32_16x16x32_bf16 v[76:79], a[60:63], v[148:151], v[76:79]
    v_mfma_f32_16x16x32_bf16 v[76:79], a[64:67], v[152:155], v[76:79]
    v_mfma_f32_16x16x32_bf16 v[76:79], a[68:71], v[156:159], v[76:79]
    v_lshrrev_b32 v1, 3, v0
    v_and_b32 v2, 6, v1
    v_xor_b32 v2, v0, v2
    v_and_b32 v2, 7, v2
    v_mul_u32_u24 v1, 768, v1
    v_lshl_add_u32 v224, v2, 4, v1
    v_xor_b32 v225, 16, v224
    v_add_u32 v225, 5120, v225
    s_cmp_eq_u32 s0, 0
    s_cbranch_scc0 L_g28
    s_waitcnt vmcnt(7)
L_g28:
    buffer_load_dwordx4 v31, s[24:27], s59 offen offset:1024 nt lds
    s_cmp_eq_u32 s0, 0
    s_cbranch_scc0 L_g29
    s_waitcnt vmcnt(7)
L_g29:
    buffer_load_dwordx4 v32, s[24:27], s59 offen offset:2048 nt lds
    s_waitcnt vmcnt(11)
    s_barrier
    ds_read_b128 a[96:99], v40 offset:0
    ds_read_b128 a[100:103], v41 offset:0
    ds_read_b128 a[104:107], v42 offset:0
    ds_read_b128 a[108:111], v43 offset:0
    ds_read_b128 a[112:115], v40 offset:256
    ds_read_b128 a[116:119], v41 offset:256
    ds_read_b128 a[120:123], v42 offset:256
    ds_read_b128 a[124:127], v43 offset:256
    ds_read_b128 a[128:131], v40 offset:512
    ds_read_b128 a[132:135], v41 offset:512
    ds_read_b128 a[136:139], v42 offset:512
    ds_read_b128 a[140:143], v43 offset:512
    s_waitcnt lgkmcnt(11)
    v_mfma_f32_16x16x32_bf16 v[96:99], a[96:99], a[96:99], v[84:87]
    ds_read_b64_tr_b16 a[144:145], v44 offset:0
    ds_read_b64_tr_b16 a[146:147], v45 offset:0
    v_mfma_f32_16x16x32_bf16 v[100:103], a[96:99], a[48:51], 0
    ds_read_b64_tr_b16 a[148:149], v44 offset:12288
    ds_read_b64_tr_b16 a[150:151], v45 offset:12288
    s_waitcnt lgkmcnt(14)
    v_mfma_f32_16x16x32_bf16 v[96:99], a[100:103], a[100:103], v[96:99]
    ds_read_b64_tr_b16 a[152:153], v44 offset:24576
    ds_read_b64_tr_b16 a[154:155], v45 offset:24576
    v_mfma_f32_16x16x32_bf16 v[100:103], a[100:103], a[52:55], v[100:103]
    ds_read_b64_tr_b16 a[156:157], v44 offset:36864
    ds_read_b64_tr_b16 a[158:159], v45 offset:36864
    s_waitcnt lgkmcnt(15)
    v_mfma_f32_16x16x32_bf16 v[96:99], a[104:107], a[104:107], v[96:99]
    ds_read_b64_tr_b16 a[160:161], v46 offset:0
    ds_read_b64_tr_b16 a[162:163], v47 offset:0
    v_mfma_f32_16x16x32_bf16 v[100:103], a[104:107], a[56:59], v[100:103]
    ds_read_b64_tr_b16 a[164:165], v46 offset:12288
    ds_read_b64_tr_b16 a[166:167], v47 offset:12288
    v_mfma_f32_16x16x32_bf16 v[96:99], a[108:111], a[108:111], v[96:99]
    s_cmp_eq_u32 s0, 0
    s_cbranch_scc0 L_g30
    s_waitcnt vmcnt(7)
L_g30:
    buffer_load_dwordx4 v33, s[24:27], s59 offen offset:3072 nt lds
    ds_read_b64_tr_b16 a[168:169], v46 offset:24576
    ds_read_b64_tr_b16 a[170:171], v47 offset:24576
    v_mfma_f32_16x16x32_bf16 v[100:103], a[108:111], a[60:63], v[100:103]
    ds_read_b64_tr_b16 a[172:173], v46 offset:36864
    ds_read_b64_tr_b16 a[174:175], v47 offset:36864
    v_mfma_f32_16x16x32_bf16 v[96:99], a[112:115], a[112:115], v[96:99]
    ds_read_b64_tr_b16 a[176:177], v48 offset:0
    ds_read_b64_tr_b16 a[178:179], v49 offset:0
    v_mfma_f32_16x16x32_bf16 v[100:103], a[112:115], a[64:67], v[100:103]
    ds_read_b64_tr_b16 a[180:181], v48 offset:12288
    ds_read_b64_tr_b16 a[182:183], v49 offset:12288
    s_waitcnt lgkmcnt(15)
    v_mfma_f32_16x16x32_bf16 v[96:99], a[116:119], a[116:119], v[96:99]
    ds_read_b64_tr_b16 a[184:185], v48 offset:24576
    ds_read_b64_tr_b16 a[186:187], v49 offset:24576
    v_mfma_f32_16x16x32_bf16 v[100:103], a[116:119], a[68:71], v[100:103]
    ds_read_b64_tr_b16 a[188:189], v48 offset:36864
    ds_read_b64_tr_b16 a[190:191], v49 offset:36864
    v_mfma_f32_16x16x32_bf16 v[92:95], a[96:99], v[52:55], v[80:83]
    v_mfma_f32_16x16x32_bf16 v[92:95], a[100:103], v[52:55], v[92:95]
    v_mfma_f32_16x16x32_bf16 v[92:95], a[104:107], v[52:55], v[92:95]
    v_mfma_f32_16x16x32_bf16 v[92:95], a[108:111], v[52:55], v[92:95]
    s_nop 1
    v_fma_f32 v96, v100, 2.0, v96
    v_fma_f32 v97, v101, 2.0, v97
    v_mfma_f32_16x16x32_bf16 v[92:95], a[112:115], v[52:55], v[92:95]
    v_fma_f32 v98, v102, 2.0, v98
    v_fma_f32 v99, v103, 2.0, v99
    v_mfma_f32_16x16x32_bf16 v[92:95], a[116:119], v[52:55], v[92:95]
    v_cndmask_b32 v3, 0, v96, s[44:45]
    v_cndmask_b32 v3, v3, v97, s[46:47]
    v_mfma_f32_16x16x32_bf16 v[88:91], a[96:99], v[136:139], v[76:79]
    s_cmp_eq_u32 s0, 0
    s_cbranch_scc0 L_g31
    s_waitcnt vmcnt(7)
L_g31:
    s_add_u32 m0, s40, 0
    s_add_u32 s57, s36, 12582912
    buffer_load_dwordx4 v16, s[28:31], s57 offen offset:0 nt lds
    v_cndmask_b32 v3, v3, v98, s[48:49]
    v_cndmask_b32 v3, v3, v99, s[50:51]
    v_mfma_f32_16x16x32_bf16 v[88:91], a[100:103], v[140:143], v[88:91]
    s_nop 0
    s_nop 0
    v_mfma_f32_16x16x32_bf16 v[88:91], a[104:107], v[144:147], v[88:91]
    v_mfma_f32_16x16x4_f32 v[120:123], v3, v60, v[56:59]
    v_mfma_f32_16x16x32_bf16 v[88:91], a[108:111], v[148:151], v[88:91]
    v_mfma_f32_16x16x32_bf16 v[88:91], a[112:115], v[152:155], v[88:91]
    v_mfma_f32_16x16x32_bf16 v[88:91], a[116:119], v[156:159], v[88:91]
    v_mfma_f32_16x16x32_bf16 v[112:115], a[120:123], a[120:123], v[84:87]
    v_mfma_f32_16x16x32_bf16 v[116:119], a[120:123], a[48:51], 0
    v_mfma_f32_16x16x32_bf16 v[112:115], a[124:127], a[124:127], v[112:115]
    v_mfma_f32_16x16x32_bf16 v[116:119], a[124:127], a[52:55], v[116:119]
    s_nop 2
    v_fma_f32 v128, -v92, v92, v120
    v_fma_f32 v129, -v93, v93, v121
    v_mfma_f32_16x16x32_bf16 v[112:115], a[128:131], a[128:131], v[112:115]
    v_fma_f32 v130, -v94, v94, v122
    v_fma_f32 v131, -v95, v95, v123
    v_mfma_f32_16x16x32_bf16 v[116:119], a[128:131], a[56:59], v[116:119]
    s_cmp_eq_u32 s0, 0
    s_cbranch_scc0 L_g32
    s_waitcnt vmcnt(7)
L_g32:
    buffer_load_dwordx4 v17, s[28:31], s57 offen offset:1024 nt lds
    v_max_f32 v128, v128, v56
    v_max_f32 v129, v129, v56
    v_mfma_f32_16x16x32_bf16 v[112:115], a[132:135], a[132:135], v[112:115]
    v_max_f32 v130, v130, v56
    v_max_f32 v131, v131, v56
    v_mfma_f32_16x16x32_bf16 v[116:119], a[132:135], a[60:63], v[116:119]
    v_rsq_f32 v128, v128
    v_mfma_f32_16x16x32_bf16 v[112:115], a[136:139], a[136:139], v[112:115]
    v_rsq_f32 v129, v129
    v_mfma_f32_16x16x32_bf16 v[116:119], a[136:139], a[64:67], v[116:119]
    v_rsq_f32 v130, v130
    v_mfma_f32_16x16x32_bf16 v[112:115], a[140:143], a[140:143], v[112:115]
    v_rsq_f32 v131, v131
    v_mfma_f32_16x16x32_bf16 v[116:119], a[140:143], a[68:71], v[116:119]
    v_fma_f32 v88, -v92, v61, v88
    v_fma_f32 v89, -v93, v61, v89
    v_mfma_f32_16x16x32_bf16 v[108:111], a[120:123], v[52:55], v[80:83]
    v_fma_f32 v90, -v94, v61, v90
    v_fma_f32 v91, -v95, v61, v91
    v_mfma_f32_16x16x32_bf16 v[108:111], a[124:127], v[52:55], v[108:111]
    v_fma_f32 v88, v88, v128, v62
    v_fma_f32 v89, v89, v129, v62
    v_mfma_f32_16x16x32_bf16 v[108:111], a[128:131], v[52:55], v[108:111]
    v_fma_f32 v90, v90, v130, v62
    v_fma_f32 v91, v91, v131, v62
    v_mfma_f32_16x16x32_bf16 v[108:111], a[132:135], v[52:55], v[108:111]
    v_max3_f32 v1, v88, v89, v90
    v_max_f32 v1, v1, v91
    v_mfma_f32_16x16x32_bf16 v[108:111], a[136:139], v[52:55], v[108:111]
    v_cmp_lt_f32 vcc, s52, v1
    s_cbranch_vccnz L_site2
L_back2:
    v_mfma_f32_16x16x32_bf16 v[108:111], a[140:143], v[52:55], v[108:111]
    s_cmp_eq_u32 s0, 0
    s_cbranch_scc0 L_g33
    s_waitcnt vmcnt(7)
L_g33:
    buffer_load_dwordx4 v18, s[28:31], s57 offen offset:2048 nt lds
    v_exp_f32 v96, v88
    v_mfma_f32_16x16x32_bf16 v[104:107], a[120:123], v[136:139], v[76:79]
    v_exp_f32 v97, v89
    v_mfma_f32_16x16x32_bf16 v[104:107], a[124:127], v[140:143], v[104:107]
    v_exp_f32 v98, v90
    v_mfma_f32_16x16x32_bf16 v[104:107], a[128:131], v[144:147], v[104:107]
    v_exp_f32 v99, v91
    v_mfma_f32_16x16x32_bf16 v[104:107], a[132:135], v[148:151], v[104:107]
    v_mul_f32 v88, v96, v128
    v_mul_f32 v89, v97, v129
    v_mfma_f32_16x16x32_bf16 v[104:107], a[136:139], v[152:155], v[104:107]
    v_mul_f32 v90, v98, v130
    v_mul_f32 v91, v99, v131
    v_mfma_f32_16x16x32_bf16 v[104:107], a[140:143], v[156:159], v[104:107]
    v_fma_f32 v112, v116, 2.0, v112
    v_fma_f32 v113, v117, 2.0, v113
    v_fma_f32 v114, v118, 2.0, v114
    v_fma_f32 v115, v119, 2.0, v115
    v_cndmask_b32 v4, 0, v112, s[44:45]
    v_cndmask_b32 v4, v4, v113, s[46:47]
    v_cndmask_b32 v4, v4, v114, s[48:49]
    v_cndmask_b32 v4, v4, v115, s[50:51]
    v_add_f32 v63, v63, v96
    v_fmac_f32 v64, v88, v92
    v_mfma_f32_16x16x4_f32 v[124:127], v4, v60, v[56:59]
    v_add_f32 v63, v63, v97
    v_fmac_f32 v64, v89, v93
    v_add_f32 v63, v63, v98
    v_fmac_f32 v64, v90, v94
    v_add_f32 v63, v63, v99
    v_fmac_f32 v64, v91, v95
    v_mov_b32 v68, v88
    v_mov_b32 v69, v89
    v_mov_b32 v70, v90
    v_mov_b32 v71, v91
    v_add_u32 v44, 49152, v44
    v_add_u32 v45, 49152, v45
    v_add_u32 v46, 49152, v46
    v_add_u32 v47, 49152, v47
    v_add_u32 v48, 49152, v48
    v_add_u32 v49, 49152, v49
    v_fma_f32 v132, -v108, v108, v124
    v_fma_f32 v133, -v109, v109, v125
    v_fma_f32 v134, -v110, v110, v126
    v_fma_f32 v135, -v111, v111, v127
    v_max_f32 v132, v132, v56
    v_max_f32 v133, v133, v56
    v_max_f32 v134, v134, v56
    v_max_f32 v135, v135, v56
    v_rsq_f32 v132, v132
    v_rsq_f32 v133, v133
    v_rsq_f32 v134, v134
    v_rsq_f32 v135, v135
    s_cmp_eq_u32 s0, 0
    s_cbranch_scc0 L_g34
    s_waitcnt vmcnt(7)
L_g34:
    buffer_load_dwordx4 v19, s[28:31], s57 offen offset:3072 nt lds
    v_fma_f32 v104, -v108, v61, v104
    v_fma_f32 v105, -v109, v61, v105
    v_fma_f32 v106, -v110, v61, v106
    v_fma_f32 v107, -v111, v61, v107
    v_fma_f32 v104, v104, v132, v62
    v_fma_f32 v105, v105, v133, v62
    v_fma_f32 v106, v106, v134, v62
    v_fma_f32 v107, v107, v135, v62
    v_max3_f32 v1, v104, v105, v106
    v_max_f32 v1, v1, v107
    v_cmp_lt_f32 vcc, s52, v1
    s_cbranch_vccnz L_site3
L_back3:
    v_exp_f32 v112, v104
    v_exp_f32 v113, v105
    v_exp_f32 v114, v106
    v_exp_f32 v115, v107
    v_cvt_pk_bf16_f32 v72, v88, v89
    v_cvt_pk_bf16_f32 v73, v90, v91
    v_mul_f32 v104, v112, v132
    v_mul_f32 v105, v113, v133
    v_mul_f32 v106, v114, v134
    v_mul_f32 v107, v115, v135
    v_cvt_pk_bf16_f32 v74, v104, v105
    v_cvt_pk_bf16_f32 v75, v106, v107
    ds_write_b128 v237, v[72:75] offset:0
    s_waitcnt lgkmcnt(0)
    s_barrier
L_post24:
    ds_read_b32 v9, v254 offset:4096
    ds_read_b128 v[92:95], v253 offset:0
    ds_read_b128 v[96:99], v253 offset:1024
    ds_read_b128 v[100:103], v253 offset:2048
    ds_read_b128 v[116:119], v253 offset:3072
    s_waitcnt lgkmcnt(4)
    v_cmp_ne_u32 vcc, 0, v9
    s_cbranch_vccnz L_xt24
    s_waitcnt lgkmcnt(3)
    v_mfma_f32_16x16x32_bf16 a[0:3], a[144:147], v[92:95], a[0:3]
    s_cmp_eq_u32 s0, 0
    s_cbranch_scc0 L_g35
    s_waitcnt vmcnt(7)
L_g35:
    s_add_u32 m0, s40, 4096
    s_nop 0
    buffer_load_dwordx4 v20, s[28:31], s57 offen offset:0 nt lds
    v_add_f32 v68, v68, v104
    v_add_f32 v69, v69, v105
    v_mfma_f32_16x16x32_bf16 a[4:7], a[160:163], v[92:95], a[4:7]
    s_cmp_eq_u32 s0, 0
    s_cbranch_scc0 L_g36
    s_waitcnt vmcnt(5)
L_g36:
    buffer_load_dwordx4 v21, s[28:31], s57 offen offset:1024 nt lds
    v_add_f32 v70, v70, v106
    v_add_f32 v71, v71, v107
    v_mfma_f32_16x16x32_bf16 a[8:11], a[176:179], v[92:95], a[8:11]
    v_add_f32 v63, v63, v112
    v_fma_f32 v64, v104, v108, v64
    s_waitcnt lgkmcnt(2)
    v_mfma_f32_16x16x32_bf16 a[0:3], a[148:151], v[96:99], a[0:3]
    v_add_f32 v63, v63, v113
    v_fma_f32 v64, v105, v109, v64
    v_mfma_f32_16x16x32_bf16 a[4:7], a[164:167], v[96:99], a[4:7]
    v_add_f32 v63, v63, v114
    v_fma_f32 v64, v106, v110, v64
    v_mfma_f32_16x16x32_bf16 a[8:11], a[180:183], v[96:99], a[8:11]
    v_add_f32 v63, v63, v115
    v_fma_f32 v64, v107, v111, v64
    s_waitcnt lgkmcnt(1)
    v_mfma_f32_16x16x32_bf16 a[0:3], a[152:155], v[100:103], a[0:3]
    v_mfma_f32_16x16x32_bf16 a[4:7], a[168:171], v[100:103], a[4:7]
    v_mfma_f32_16x16x32_bf16 a[8:11], a[184:187], v[100:103], a[8:11]
    s_waitcnt lgkmcnt(0)
    v_mfma_f32_16x16x32_bf16 a[0:3], a[156:159], v[116:119], a[0:3]
    buffer_load_dwordx2 v[234:235], v245, s[32:35], 0 offen offset:128 sc1
    v_mfma_f32_16x16x32_bf16 a[4:7], a[172:175], v[116:119], a[4:7]
    v_mfma_f32_16x16x32_bf16 a[8:11], a[188:191], v[116:119], a[8:11]
    s_cmp_eq_u32 s0, 0
    s_cbranch_scc0 L_g37
    s_waitcnt vmcnt(6)
L_g37:
    s_add_u32 m0, s41, 0
    s_add_u32 s58, s37, 50331648
    buffer_load_dwordx4 v22, s[24:27], s58 offen offset:0 nt lds
    s_cmp_eq_u32 s0, 0
    s_cbranch_scc0 L_g38
    s_waitcnt vmcnt(6)
L_g38:
    buffer_load_dwordx4 v23, s[24:27], s58 offen offset:1024 nt lds
    s_cmp_eq_u32 s0, 0
    s_cbranch_scc0 L_g39
    s_waitcnt vmcnt(6)
L_g39:
    buffer_load_dwordx4 v24, s[24:27], s58 offen offset:2048 nt lds
    s_cmp_eq_u32 s0, 0
    s_cbranch_scc0 L_g40
    s_waitcnt vmcnt(6)
L_g40:
    buffer_load_dwordx4 v25, s[24:27], s58 offen offset:3072 nt lds
    s_waitcnt vmcnt(11)
    s_barrier
    ds_read_b128 a[96:99], v40 offset:49152
    ds_read_b128 a[100:103], v41 offset:49152
    ds_read_b128 a[104:107], v42 offset:49152
    ds_read_b128 a[108:111], v43 offset:49152
    ds_read_b128 a[112:115], v40 offset:49408
    ds_read_b128 a[116:119], v41 offset:49408
    ds_read_b128 a[120:123], v42 offset:49408
    ds_read_b128 a[124:127], v43 offset:49408
    ds_read_b128 a[128:131], v40 offset:49664
    ds_read_b128 a[132:135], v41 offset:49664
    ds_read_b128 a[136:139], v42 offset:49664
    ds_read_b128 a[140:143], v43 offset:49664
    s_waitcnt lgkmcnt(11)
    v_mfma_f32_16x16x32_bf16 v[96:99], a[96:99], a[96:99], v[84:87]
    ds_read_b64_tr_b16 a[144:145], v44 offset:0
    ds_read_b64_tr_b16 a[146:147], v45 offset:0
    v_mfma_f32_16x16x32_bf16 v[100:103], a[96:99], a[48:51], 0
    ds_read_b64_tr_b16 a[148:149], v44 offset:12288
    ds_read_b64_tr_b16 a[150:151], v45 offset:12288
    s_waitcnt lgkmcnt(14)
    v_mfma_f32_16x16x32_bf16 v[96:99], a[100:103], a[100:103], v[96:99]
    ds_read_b64_tr_b16 a[152:153], v44 offset:24576
    ds_read_b64_tr_b16 a[154:155], v45 offset:24576
    v_mfma_f32_16x16x32_bf16 v[100:103], a[100:103], a[52:55], v[100:103]
    ds_read_b64_tr_b16 a[156:157], v44 offset:36864
    ds_read_b64_tr_b16 a[158:159], v45 offset:36864
    s_waitcnt lgkmcnt(15)
    v_mfma_f32_16x16x32_bf16 v[96:99], a[104:107], a[104:107], v[96:99]
    ds_read_b64_tr_b16 a[160:161], v46 offset:0
    ds_read_b64_tr_b16 a[162:163], v47 offset:0
    v_mfma_f32_16x16x32_bf16 v[100:103], a[104:107], a[56:59], v[100:103]
    ds_read_b64_tr_b16 a[164:165], v46 offset:12288
    ds_read_b64_tr_b16 a[166:167], v47 offset:12288
    v_mfma_f32_16x16x32_bf16 v[96:99], a[108:111], a[108:111], v[96:99]
    s_cmp_eq_u32 s0, 0
    s_cbranch_scc0 L_g41
    s_waitcnt vmcnt(6)
L_g41:
    s_add_u32 m0, s41, 4096
    s_nop 0
    buffer_load_dwordx4 v26, s[24:27], s58 offen offset:0 nt lds
    ds_read_b64_tr_b16 a[168:169], v46 offset:24576
    ds_read_b64_tr_b16 a[170:171], v47 offset:24576
    v_mfma_f32_16x16x32_bf16 v[100:103], a[108:111], a[60:63], v[100:103]
    ds_read_b64_tr_b16 a[172:173], v46 offset:36864
    ds_read_b64_tr_b16 a[174:175], v47 offset:36864
    v_mfma_f32_16x16x32_bf16 v[96:99], a[112:115], a[112:115], v[96:99]
    ds_read_b64_tr_b16 a[176:177], v48 offset:0
    ds_read_b64_tr_b16 a[178:179], v49 offset:0
    v_mfma_f32_16x16x32_bf16 v[100:103], a[112:115], a[64:67], v[100:103]
    ds_read_b64_tr_b16 a[180:181], v48 offset:12288
    ds_read_b64_tr_b16 a[182:183], v49 offset:12288
    s_waitcnt lgkmcnt(15)
    v_mfma_f32_16x16x32_bf16 v[96:99], a[116:119], a[116:119], v[96:99]
    ds_read_b64_tr_b16 a[184:185], v48 offset:24576
    ds_read_b64_tr_b16 a[186:187], v49 offset:24576
    v_mfma_f32_16x16x32_bf16 v[100:103], a[116:119], a[68:71], v[100:103]
    ds_read_b64_tr_b16 a[188:189], v48 offset:36864
    ds_read_b64_tr_b16 a[190:191], v49 offset:36864
    v_mfma_f32_16x16x32_bf16 v[92:95], a[96:99], v[52:55], v[80:83]
    v_mfma_f32_16x16x32_bf16 v[92:95], a[100:103], v[52:55], v[92:95]
    v_mfma_f32_16x16x32_bf16 v[92:95], a[104:107], v[52:55], v[92:95]
    v_mfma_f32_16x16x32_bf16 v[92:95], a[108:111], v[52:55], v[92:95]
    s_nop 1
    v_fma_f32 v96, v100, 2.0, v96
    v_fma_f32 v97, v101, 2.0, v97
    v_mfma_f32_16x16x32_bf16 v[92:95], a[112:115], v[52:55], v[92:95]
    v_fma_f32 v98, v102, 2.0, v98
    v_fma_f32 v99, v103, 2.0, v99
    v_mfma_f32_16x16x32_bf16 v[92:95], a[116:119], v[52:55], v[92:95]
    v_cndmask_b32 v3, 0, v96, s[44:45]
    v_cndmask_b32 v3, v3, v97, s[46:47]
    v_mfma_f32_16x16x32_bf16 v[88:91], a[96:99], v[136:139], v[76:79]
    s_cmp_eq_u32 s0, 0
    s_cbranch_scc0 L_g42
    s_waitcnt vmcnt(6)
L_g42:
    buffer_load_dwordx4 v27, s[24:27], s58 offen offset:1024 nt lds
    v_cndmask_b32 v3, v3, v98, s[48:49]
    v_cndmask_b32 v3, v3, v99, s[50:51]
    v_mfma_f32_16x16x32_bf16 v[88:91], a[100:103], v[140:143], v[88:91]
    s_nop 0
    s_nop 0
    v_mfma_f32_16x16x32_bf16 v[88:91], a[104:107], v[144:147], v[88:91]
    v_mfma_f32_16x16x4_f32 v[120:123], v3, v60, v[56:59]
    v_mfma_f32_16x16x32_bf16 v[88:91], a[108:111], v[148:151], v[88:91]
    v_mfma_f32_16x16x32_bf16 v[88:91], a[112:115], v[152:155], v[88:91]
    v_mfma_f32_16x16x32_bf16 v[88:91], a[116:119], v[156:159], v[88:91]
    v_mfma_f32_16x16x32_bf16 v[112:115], a[120:123], a[120:123], v[84:87]
    v_mfma_f32_16x16x32_bf16 v[116:119], a[120:123], a[48:51], 0
    v_mfma_f32_16x16x32_bf16 v[112:115], a[124:127], a[124:127], v[112:115]
    v_mfma_f32_16x16x32_bf16 v[116:119], a[124:127], a[52:55], v[116:119]
    s_nop 2
    v_fma_f32 v128, -v92, v92, v120
    v_fma_f32 v129, -v93, v93, v121
    v_mfma_f32_16x16x32_bf16 v[112:115], a[128:131], a[128:131], v[112:115]
    v_fma_f32 v130, -v94, v94, v122
    v_fma_f32 v131, -v95, v95, v123
    v_mfma_f32_16x16x32_bf16 v[116:119], a[128:131], a[56:59], v[116:119]
    s_cmp_eq_u32 s0, 0
    s_cbranch_scc0 L_g43
    s_waitcnt vmcnt(5)
L_g43:
    buffer_load_dwordx4 v28, s[24:27], s58 offen offset:2048 nt lds
    v_max_f32 v128, v128, v56
    v_max_f32 v129, v129, v56
    v_mfma_f32_16x16x32_bf16 v[112:115], a[132:135], a[132:135], v[112:115]
    v_max_f32 v130, v130, v56
    v_max_f32 v131, v131, v56
    v_mfma_f32_16x16x32_bf16 v[116:119], a[132:135], a[60:63], v[116:119]
    v_rsq_f32 v128, v128
    v_mfma_f32_16x16x32_bf16 v[112:115], a[136:139], a[136:139], v[112:115]
    v_rsq_f32 v129, v129
    v_mfma_f32_16x16x32_bf16 v[116:119], a[136:139], a[64:67], v[116:119]
    v_rsq_f32 v130, v130
    v_mfma_f32_16x16x32_bf16 v[112:115], a[140:143], a[140:143], v[112:115]
    v_rsq_f32 v131, v131
    v_mfma_f32_16x16x32_bf16 v[116:119], a[140:143], a[68:71], v[116:119]
    v_fma_f32 v88, -v92, v61, v88
    v_fma_f32 v89, -v93, v61, v89
    v_mfma_f32_16x16x32_bf16 v[108:111], a[120:123], v[52:55], v[80:83]
    v_fma_f32 v90, -v94, v61, v90
    v_fma_f32 v91, -v95, v61, v91
    v_mfma_f32_16x16x32_bf16 v[108:111], a[124:127], v[52:55], v[108:111]
    v_fma_f32 v88, v88, v128, v62
    v_fma_f32 v89, v89, v129, v62
    v_mfma_f32_16x16x32_bf16 v[108:111], a[128:131], v[52:55], v[108:111]
    v_fma_f32 v90, v90, v130, v62
    v_fma_f32 v91, v91, v131, v62
    v_mfma_f32_16x16x32_bf16 v[108:111], a[132:135], v[52:55], v[108:111]
    v_max3_f32 v1, v88, v89, v90
    v_max_f32 v1, v1, v91
    v_mfma_f32_16x16x32_bf16 v[108:111], a[136:139], v[52:55], v[108:111]
    v_cmp_lt_f32 vcc, s52, v1
    s_cbranch_vccnz L_site4
L_back4:
    v_mfma_f32_16x16x32_bf16 v[108:111], a[140:143], v[52:55], v[108:111]
    v_exp_f32 v96, v88
    v_mfma_f32_16x16x32_bf16 v[104:107], a[120:123], v[136:139], v[76:79]
    s_cmp_eq_u32 s0, 0
    s_cbranch_scc0 L_g44
    s_waitcnt vmcnt(5)
L_g44:
    buffer_load_dwordx4 v29, s[24:27], s58 offen offset:3072 nt lds
    v_exp_f32 v97, v89
    v_mfma_f32_16x16x32_bf16 v[104:107], a[124:127], v[140:143], v[104:107]
    v_exp_f32 v98, v90
    v_mfma_f32_16x16x32_bf16 v[104:107], a[128:131], v[144:147], v[104:107]
    v_exp_f32 v99, v91
    v_mfma_f32_16x16x32_bf16 v[104:107], a[132:135], v[148:151], v[104:107]
    v_mul_f32 v88, v96, v128
    v_mul_f32 v89, v97, v129
    v_mfma_f32_16x16x32_bf16 v[104:107], a[136:139], v[152:155], v[104:107]
    v_mul_f32 v90, v98, v130
    v_mul_f32 v91, v99, v131
    v_mfma_f32_16x16x32_bf16 v[104:107], a[140:143], v[156:159], v[104:107]
    v_fma_f32 v112, v116, 2.0, v112
    v_fma_f32 v113, v117, 2.0, v113
    v_fma_f32 v114, v118, 2.0, v114
    v_fma_f32 v115, v119, 2.0, v115
    v_cndmask_b32 v4, 0, v112, s[44:45]
    v_cndmask_b32 v4, v4, v113, s[46:47]
    v_cndmask_b32 v4, v4, v114, s[48:49]
    v_cndmask_b32 v4, v4, v115, s[50:51]
    v_add_f32 v63, v63, v96
    v_fmac_f32 v64, v88, v92
    v_mfma_f32_16x16x4_f32 v[124:127], v4, v60, v[56:59]
    v_add_f32 v63, v63, v97
    v_fmac_f32 v64, v89, v93
    v_add_f32 v63, v63, v98
    v_fmac_f32 v64, v90, v94
    v_add_f32 v63, v63, v99
    v_fmac_f32 v64, v91, v95
    v_add_f32 v68, v68, v88
    v_add_f32 v69, v69, v89
    v_add_f32 v70, v70, v90
    v_add_f32 v71, v71, v91
    v_add_u32 v44, -49152, v44
    v_add_u32 v45, -49152, v45
    v_add_u32 v46, -49152, v46
    v_add_u32 v47, -49152, v47
    v_add_u32 v48, -49152, v48
    v_add_u32 v49, -49152, v49
    v_fma_f32 v132, -v108, v108, v124
    v_fma_f32 v133, -v109, v109, v125
    v_fma_f32 v134, -v110, v110, v126
    v_fma_f32 v135, -v111, v111, v127
    v_max_f32 v132, v132, v56
    v_max_f32 v133, v133, v56
    v_max_f32 v134, v134, v56
    v_max_f32 v135, v135, v56
    v_rsq_f32 v132, v132
    v_rsq_f32 v133, v133
    v_rsq_f32 v134, v134
    v_rsq_f32 v135, v135
    s_cmp_eq_u32 s0, 0
    s_cbranch_scc0 L_g45
    s_waitcnt vmcnt(5)
L_g45:
    s_add_u32 m0, s41, 8192
    s_nop 0
    buffer_load_dwordx4 v30, s[24:27], s58 offen offset:0 nt lds
    v_fma_f32 v104, -v108, v61, v104
    v_fma_f32 v105, -v109, v61, v105
    v_fma_f32 v106, -v110, v61, v106
    v_fma_f32 v107, -v111, v61, v107
    v_fma_f32 v104, v104, v132, v62
    v_fma_f32 v105, v105, v133, v62
    v_fma_f32 v106, v106, v134, v62
    v_fma_f32 v107, v107, v135, v62
    v_max3_f32 v1, v104, v105, v106
    v_max_f32 v1, v1, v107
    v_cmp_lt_f32 vcc, s52, v1
    s_cbranch_vccnz L_site5
L_back5:
    v_exp_f32 v112, v104
    v_exp_f32 v113, v105
    v_exp_f32 v114, v106
    v_exp_f32 v115, v107
    v_cvt_pk_bf16_f32 v72, v88, v89
    v_cvt_pk_bf16_f32 v73, v90, v91
    v_mul_f32 v104, v112, v132
    v_mul_f32 v105, v113, v133
    v_mul_f32 v106, v114, v134
    v_mul_f32 v107, v115, v135
    v_cvt_pk_bf16_f32 v74, v104, v105
    v_cvt_pk_bf16_f32 v75, v106, v107
    ds_write_b128 v237, v[72:75] offset:0
    v_add_f32 v68, v68, v104
    v_add_f32 v69, v69, v105
    v_add_f32 v70, v70, v106
    v_add_f32 v71, v71, v107
    v_cvt_pk_bf16_f32 v66, v68, v69
    v_cvt_pk_bf16_f32 v67, v70, v71
    ds_write_b64 v238, v[66:67]
    s_cmp_eq_u32 s0, 0
    s_cbranch_scc0 L_g46
    s_waitcnt vmcnt(5)
L_g46:
    buffer_load_dwordx4 v31, s[24:27], s58 offen offset:1024 nt lds
    s_cmp_eq_u32 s0, 0
    s_cbranch_scc0 L_g47
    s_waitcnt vmcnt(5)
L_g47:
    buffer_load_dwordx4 v32, s[24:27], s58 offen offset:2048 nt lds
    s_waitcnt vmcnt(12)
    s_waitcnt vmcnt(11)
    v_cmp_ne_u32 vcc, s39, v234
    s_cbranch_vccnz L_fl_retry
L_fl_ok:
    v_readlane_b32 s20, v235, 3
    v_readlane_b32 s21, v235, 4
    s_sub_u32 s20, s20, s21
    v_readlane_b32 s21, v235, 5
    s_add_u32 s20, s20, s21
    v_readlane_b32 s21, v235, 6
    s_sub_u32 s20, s20, s21
    v_readlane_b32 s21, v235, 7
    s_add_u32 s20, s20, s21
    v_readlane_b32 s21, v235, 8
    s_sub_u32 s20, s20, s21
    s_lshr_b32 s1, s20, 31
    s_waitcnt lgkmcnt(0)
    s_barrier
L_post6:
    ds_read_b32 v9, v254 offset:4096
    ds_read_b64 v[120:121], v254 offset:0
    ds_read_b64 v[122:123], v254 offset:512
    ds_read_b64 v[124:125], v254 offset:1024
    ds_read_b64 v[126:127], v254 offset:1536
    ds_read_b128 v[92:95], v253 offset:0
    ds_read_b128 v[96:99], v253 offset:1024
    ds_read_b128 v[100:103], v253 offset:2048
    ds_read_b128 v[116:119], v253 offset:3072
    ds_read_b128 a[48:51], v34 offset:0
    ds_read_b128 a[52:55], v35 offset:0
    ds_read_b128 a[56:59], v34 offset:128
    ds_read_b128 a[60:63], v35 offset:128
    ds_read_b128 a[64:67], v34 offset:256
    ds_read_b128 a[68:71], v35 offset:256
    s_waitcnt lgkmcnt(14)
    v_cmp_ne_u32 vcc, 0, v9
    s_cbranch_vccnz L_xt6
    s_waitcnt lgkmcnt(12)
    v_mfma_f32_16x16x32_bf16 a[0:3], a[72:75], v[120:123], a[0:3]
    s_cmp_eq_u32 s0, 0
    s_cbranch_scc0 L_g48
    s_waitcnt vmcnt(5)
L_g48:
    buffer_load_dwordx4 v33, s[24:27], s58 offen offset:3072 nt lds
    v_add_f32 v63, v63, v112
    v_fma_f32 v64, v104, v108, v64
    v_mfma_f32_16x16x32_bf16 a[4:7], a[80:83], v[120:123], a[4:7]
    v_add_f32 v63, v63, v113
    v_fma_f32 v64, v105, v109, v64
    v_mfma_f32_16x16x32_bf16 a[8:11], a[88:91], v[120:123], a[8:11]
    v_add_f32 v63, v63, v114
    v_fma_f32 v64, v106, v110, v64
    s_waitcnt lgkmcnt(10)
    v_mfma_f32_16x16x32_bf16 a[0:3], a[76:79], v[124:127], a[0:3]
    v_add_f32 v63, v63, v115
    v_fma_f32 v64, v107, v111, v64
    v_mfma_f32_16x16x32_bf16 a[4:7], a[84:87], v[124:127], a[4:7]
    v_mfma_f32_16x16x32_bf16 a[8:11], a[92:95], v[124:127], a[8:11]
    s_waitcnt lgkmcnt(9)
    v_mfma_f32_16x16x32_bf16 a[0:3], a[144:147], v[92:95], a[0:3]
    ds_read_b64_tr_b16 a[72:73], v36 offset:0
    ds_read_b64_tr_b16 a[74:75], v36 offset:6144
    v_mfma_f32_16x16x32_bf16 a[4:7], a[160:163], v[92:95], a[4:7]
    s_cmp_eq_u32 s0, 0
    s_cbranch_scc0 L_g49
    s_waitcnt vmcnt(5)
L_g49:
    s_add_u32 m0, s42, 0
    s_add_u32 s59, s37, 50528256
    buffer_load_dwordx4 v22, s[24:27], s59 offen offset:0 nt lds
    ds_read_b64_tr_b16 a[76:77], v36 offset:12288
    ds_read_b64_tr_b16 a[78:79], v36 offset:18432
    v_mfma_f32_16x16x32_bf16 a[8:11], a[176:179], v[92:95], a[8:11]
    ds_read_b64_tr_b16 a[80:81], v37 offset:0
    ds_read_b64_tr_b16 a[82:83], v37 offset:6144
    s_waitcnt lgkmcnt(14)
    v_mfma_f32_16x16x32_bf16 a[0:3], a[148:151], v[96:99], a[0:3]
    ds_read_b64_tr_b16 a[84:85], v37 offset:12288
    ds_read_b64_tr_b16 a[86:87], v37 offset:18432
    v_mfma_f32_16x16x32_bf16 a[4:7], a[164:167], v[96:99], a[4:7]
    ds_read_b64_tr_b16 a[88:89], v38 offset:0
    ds_read_b64_tr_b16 a[90:91], v38 offset:6144
    v_mfma_f32_16x16x32_bf16 a[8:11], a[180:183], v[96:99], a[8:11]
    ds_read_b64_tr_b16 a[92:93], v38 offset:12288
    ds_read_b64_tr_b16 a[94:95], v38 offset:18432
    s_waitcnt lgkmcnt(15)
    v_mfma_f32_16x16x32_bf16 a[0:3], a[152:155], v[100:103], a[0:3]
    v_mfma_f32_16x16x32_bf16 a[4:7], a[168:171], v[100:103], a[4:7]
    v_mfma_f32_16x16x32_bf16 a[8:11], a[184:187], v[100:103], a[8:11]
    v_mfma_f32_16x16x32_bf16 a[0:3], a[156:159], v[116:119], a[0:3]
    v_mfma_f32_16x16x32_bf16 a[4:7], a[172:175], v[116:119], a[4:7]
    v_mfma_f32_16x16x32_bf16 a[8:11], a[188:191], v[116:119], a[8:11]
    v_mfma_f32_16x16x32_bf16 v[84:87], a[48:51], a[48:51], 0
    s_cmp_eq_u32 s0, 0
    s_cbranch_scc0 L_g50
    s_waitcnt vmcnt(5)
L_g50:
    buffer_load_dwordx4 v23, s[24:27], s59 offen offset:1024 nt lds
    v_mfma_f32_16x16x32_bf16 v[80:83], a[48:51], v[52:55], 0
    v_mfma_f32_16x16x32_bf16 v[84:87], a[52:55], a[52:55], v[84:87]
    v_mfma_f32_16x16x32_bf16 v[80:83], a[52:55], v[52:55], v[80:83]
    v_mfma_f32_16x16x32_bf16 v[84:87], a[56:59], a[56:59], v[84:87]
    v_mfma_f32_16x16x32_bf16 v[80:83], a[56:59], v[52:55], v[80:83]
    s_waitcnt lgkmcnt(14)
    v_mfma_f32_16x16x32_bf16 v[84:87], a[60:63], a[60:63], v[84:87]
    v_mfma_f32_16x16x32_bf16 v[80:83], a[60:63], v[52:55], v[80:83]
    s_waitcnt lgkmcnt(13)
    v_mfma_f32_16x16x32_bf16 v[84:87], a[64:67], a[64:67], v[84:87]
    v_mfma_f32_16x16x32_bf16 v[80:83], a[64:67], v[52:55], v[80:83]
    s_waitcnt lgkmcnt(12)
    v_mfma_f32_16x16x32_bf16 v[84:87], a[68:71], a[68:71], v[84:87]
    v_mfma_f32_16x16x32_bf16 v[80:83], a[68:71], v[52:55], v[80:83]
    s_waitcnt lgkmcnt(0)
    v_mfma_f32_16x16x32_bf16 v[76:79], a[48:51], v[136:139], 0
    v_mfma_f32_16x16x32_bf16 v[76:79], a[52:55], v[140:143], v[76:79]
    v_mfma_f32_16x16x32_bf16 v[76:79], a[56:59], v[144:147], v[76:79]
    s_add_u32 s61, s60, 3145728
    buffer_load_dwordx4 v[160:163], v65, s[72:75], s61 offen offset:0 sc1
    v_mfma_f32_16x16x32_bf16 v[76:79], a[60:63], v[148:151], v[76:79]
    v_mfma_f32_16x16x32_bf16 v[76:79], a[64:67], v[152:155], v[76:79]
    v_mfma_f32_16x16x32_bf16 v[76:79], a[68:71], v[156:159], v[76:79]
    s_cmp_eq_u32 s0, 0
    s_cbranch_scc0 L_g51
    s_waitcnt vmcnt(6)
L_g51:
    buffer_load_dwordx4 v24, s[24:27], s59 offen offset:2048 nt lds
    s_cmp_eq_u32 s0, 0
    s_cbranch_scc0 L_g52
    s_waitcnt vmcnt(6)
L_g52:
    buffer_load_dwordx4 v25, s[24:27], s59 offen offset:3072 nt lds
    buffer_load_dwordx4 v[164:167], v65, s[72:75], s61 offen offset:1024 sc1
    s_cmp_eq_u32 s0, 0
    s_cbranch_scc0 L_g53
    s_waitcnt vmcnt(7)
L_g53:
    s_add_u32 m0, s42, 4096
    s_nop 0
    buffer_load_dwordx4 v26, s[24:27], s59 offen offset:0 nt lds
    s_cmp_eq_u32 s0, 0
    s_cbranch_scc0 L_g54
    s_waitcnt vmcnt(7)
L_g54:
    buffer_load_dwordx4 v27, s[24:27], s59 offen offset:1024 nt lds
    s_cmp_eq_u32 s0, 0
    s_cbranch_scc0 L_g55
    s_waitcnt vmcnt(7)
L_g55:
    buffer_load_dwordx4 v28, s[24:27], s59 offen offset:2048 nt lds
    buffer_load_dwordx4 v[168:171], v65, s[72:75], s61 offen offset:2048 sc1
    s_cmp_eq_u32 s0, 0
    s_cbranch_scc0 L_g56
    s_waitcnt vmcnt(8)
L_g56:
    buffer_load_dwordx4 v29, s[24:27], s59 offen offset:3072 nt lds
    s_waitcnt vmcnt(11)
    s_barrier
    ds_read_b128 a[96:99], v40 offset:0
    ds_read_b128 a[100:103], v41 offset:0
    ds_read_b128 a[104:107], v42 offset:0
    ds_read_b128 a[108:111], v43 offset:0
    ds_read_b128 a[112:115], v40 offset:256
    ds_read_b128 a[116:119], v41 offset:256
    ds_read_b128 a[120:123], v42 offset:256
    ds_read_b128 a[124:127], v43 offset:256
    ds_read_b128 a[128:131], v40 offset:512
    ds_read_b128 a[132:135], v41 offset:512
    ds_read_b128 a[136:139], v42 offset:512
    ds_read_b128 a[140:143], v43 offset:512
    s_waitcnt lgkmcnt(11)
    v_mfma_f32_16x16x32_bf16 v[96:99], a[96:99], a[96:99], v[84:87]
    ds_read_b64_tr_b16 a[144:145], v44 offset:0
    ds_read_b64_tr_b16 a[146:147], v45 offset:0
    v_mfma_f32_16x16x32_bf16 v[100:103], a[96:99], a[48:51], 0
    ds_read_b64_tr_b16 a[148:149], v44 offset:12288
    ds_read_b64_tr_b16 a[150:151], v45 offset:12288
    s_waitcnt lgkmcnt(14)
    v_mfma_f32_16x16x32_bf16 v[96:99], a[100:103], a[100:103], v[96:99]
    ds_read_b64_tr_b16 a[152:153], v44 offset:24576
    ds_read_b64_tr_b16 a[154:155], v45 offset:24576
    v_mfma_f32_16x16x32_bf16 v[100:103], a[100:103], a[52:55], v[100:103]
    ds_read_b64_tr_b16 a[156:157], v44 offset:36864
    ds_read_b64_tr_b16 a[158:159], v45 offset:36864
    s_waitcnt lgkmcnt(15)
    v_mfma_f32_16x16x32_bf16 v[96:99], a[104:107], a[104:107], v[96:99]
    ds_read_b64_tr_b16 a[160:161], v46 offset:0
    ds_read_b64_tr_b16 a[162:163], v47 offset:0
    v_mfma_f32_16x16x32_bf16 v[100:103], a[104:107], a[56:59], v[100:103]
    ds_read_b64_tr_b16 a[164:165], v46 offset:12288
    ds_read_b64_tr_b16 a[166:167], v47 offset:12288
    v_mfma_f32_16x16x32_bf16 v[96:99], a[108:111], a[108:111], v[96:99]
    s_cmp_eq_u32 s0, 0
    s_cbranch_scc0 L_g57
    s_waitcnt vmcnt(7)
L_g57:
    s_add_u32 m0, s42, 8192
    s_nop 0
    buffer_load_dwordx4 v30, s[24:27], s59 offen offset:0 nt lds
    ds_read_b64_tr_b16 a[168:169], v46 offset:24576
    ds_read_b64_tr_b16 a[170:171], v47 offset:24576
    v_mfma_f32_16x16x32_bf16 v[100:103], a[108:111], a[60:63], v[100:103]
    ds_read_b64_tr_b16 a[172:173], v46 offset:36864
    ds_read_b64_tr_b16 a[174:175], v47 offset:36864
    v_mfma_f32_16x16x32_bf16 v[96:99], a[112:115], a[112:115], v[96:99]
    ds_read_b64_tr_b16 a[176:177], v48 offset:0
    ds_read_b64_tr_b16 a[178:179], v49 offset:0
    v_mfma_f32_16x16x32_bf16 v[100:103], a[112:115], a[64:67], v[100:103]
    ds_read_b64_tr_b16 a[180:181], v48 offset:12288
    ds_read_b64_tr_b16 a[182:183], v49 offset:12288
    s_waitcnt lgkmcnt(15)
    v_mfma_f32_16x16x32_bf16 v[96:99], a[116:119], a[116:119], v[96:99]
    ds_read_b64_tr_b16 a[184:185], v48 offset:24576
    ds_read_b64_tr_b16 a[186:187], v49 offset:24576
    v_mfma_f32_16x16x32_bf16 v[100:103], a[116:119], a[68:71], v[100:103]
    ds_read_b64_tr_b16 a[188:189], v48 offset:36864
    ds_read_b64_tr_b16 a[190:191], v49 offset:36864
    v_mfma_f32_16x16x32_bf16 v[92:95], a[96:99], v[52:55], v[80:83]
    v_mfma_f32_16x16x32_bf16 v[92:95], a[100:103], v[52:55], v[92:95]
    v_mfma_f32_16x16x32_bf16 v[92:95], a[104:107], v[52:55], v[92:95]
    v_mfma_f32_16x16x32_bf16 v[92:95], a[108:111], v[52:55], v[92:95]
    s_nop 1
    v_fma_f32 v96, v100, 2.0, v96
    v_fma_f32 v97, v101, 2.0, v97
    v_mfma_f32_16x16x32_bf16 v[92:95], a[112:115], v[52:55], v[92:95]
    v_fma_f32 v98, v102, 2.0, v98
    v_fma_f32 v99, v103, 2.0, v99
    v_mfma_f32_16x16x32_bf16 v[92:95], a[116:119], v[52:55], v[92:95]
    v_cndmask_b32 v3, 0, v96, s[44:45]
    v_cndmask_b32 v3, v3, v97, s[46:47]
    v_mfma_f32_16x16x32_bf16 v[88:91], a[96:99], v[136:139], v[76:79]
    buffer_load_dwordx4 v[172:175], v65, s[72:75], s61 offen offset:3072 sc1
    v_cndmask_b32 v3, v3, v98, s[48:49]
    v_cndmask_b32 v3, v3, v99, s[50:51]
    v_mfma_f32_16x16x32_bf16 v[88:91], a[100:103], v[140:143], v[88:91]
    s_cmp_eq_u32 s0, 0
    s_cbranch_scc0 L_g58
    s_waitcnt vmcnt(8)
L_g58:
    buffer_load_dwordx4 v31, s[24:27], s59 offen offset:1024 nt lds
    s_nop 0
    s_nop 0
    v_mfma_f32_16x16x32_bf16 v[88:91], a[104:107], v[144:147], v[88:91]
    v_mfma_f32_16x16x4_f32 v[120:123], v3, v60, v[56:59]
    v_mfma_f32_16x16x32_bf16 v[88:91], a[108:111], v[148:151], v[88:91]
    v_mfma_f32_16x16x32_bf16 v[88:91], a[112:115], v[152:155], v[88:91]
    v_mfma_f32_16x16x32_bf16 v[88:91], a[116:119], v[156:159], v[88:91]
    v_mfma_f32_16x16x32_bf16 v[112:115], a[120:123], a[120:123], v[84:87]
    v_mfma_f32_16x16x32_bf16 v[116:119], a[120:123], a[48:51], 0
    v_mfma_f32_16x16x32_bf16 v[112:115], a[124:127], a[124:127], v[112:115]
    v_mfma_f32_16x16x32_bf16 v[116:119], a[124:127], a[52:55], v[116:119]
    s_nop 2
    v_fma_f32 v128, -v92, v92, v120
    v_fma_f32 v129, -v93, v93, v121
    v_mfma_f32_16x16x32_bf16 v[112:115], a[128:131], a[128:131], v[112:115]
    s_cmp_eq_u32 s0, 0
    s_cbranch_scc0 L_g59
    s_waitcnt vmcnt(7)
L_g59:
    buffer_load_dwordx4 v32, s[24:27], s59 offen offset:2048 nt lds
    v_fma_f32 v130, -v94, v94, v122
    v_fma_f32 v131, -v95, v95, v123
    v_mfma_f32_16x16x32_bf16 v[116:119], a[128:131], a[56:59], v[116:119]
    v_max_f32 v128, v128, v56
    v_max_f32 v129, v129, v56
    v_mfma_f32_16x16x32_bf16 v[112:115], a[132:135], a[132:135], v[112:115]
    v_max_f32 v130, v130, v56
    v_max_f32 v131, v131, v56
    v_mfma_f32_16x16x32_bf16 v[116:119], a[132:135], a[60:63], v[116:119]
    v_rsq_f32 v128, v128
    v_mfma_f32_16x16x32_bf16 v[112:115], a[136:139], a[136:139], v[112:115]
    v_rsq_f32 v129, v129
    v_mfma_f32_16x16x32_bf16 v[116:119], a[136:139], a[64:67], v[116:119]
    v_rsq_f32 v130, v130
    v_mfma_f32_16x16x32_bf16 v[112:115], a[140:143], a[140:143], v[112:115]
    v_rsq_f32 v131, v131
    v_mfma_f32_16x16x32_bf16 v[116:119], a[140:143], a[68:71], v[116:119]
    v_fma_f32 v88, -v92, v61, v88
    v_fma_f32 v89, -v93, v61, v89
    v_mfma_f32_16x16x32_bf16 v[108:111], a[120:123], v[52:55], v[80:83]
    v_fma_f32 v90, -v94, v61, v90
    v_fma_f32 v91, -v95, v61, v91
    v_mfma_f32_16x16x32_bf16 v[108:111], a[124:127], v[52:55], v[108:111]
    v_fma_f32 v88, v88, v128, v62
    v_fma_f32 v89, v89, v129, v62
    v_mfma_f32_16x16x32_bf16 v[108:111], a[128:131], v[52:55], v[108:111]
    v_fma_f32 v90, v90, v130, v62
    v_fma_f32 v91, v91, v131, v62
    v_mfma_f32_16x16x32_bf16 v[108:111], a[132:135], v[52:55], v[108:111]
    v_max3_f32 v1, v88, v89, v90
    v_max_f32 v1, v1, v91
    v_mfma_f32_16x16x32_bf16 v[108:111], a[136:139], v[52:55], v[108:111]
    buffer_load_dwordx4 v33, s[24:27], s59 offen offset:3072 nt lds
    v_cmp_lt_f32 vcc, s52, v1
    s_cbranch_vccnz L_site6
L_back6:
    v_mfma_f32_16x16x32_bf16 v[108:111], a[140:143], v[52:55], v[108:111]
    s_add_u32 s61, s60, 3149824
    buffer_load_dwordx4 v[176:179], v65, s[72:75], s61 offen offset:0 sc1
    v_exp_f32 v96, v88
    v_mfma_f32_16x16x32_bf16 v[104:107], a[120:123], v[136:139], v[76:79]
    v_exp_f32 v97, v89
    v_mfma_f32_16x16x32_bf16 v[104:107], a[124:127], v[140:143], v[104:107]
    v_exp_f32 v98, v90
    v_mfma_f32_16x16x32_bf16 v[104:107], a[128:131], v[144:147], v[104:107]
    v_exp_f32 v99, v91
    v_mfma_f32_16x16x32_bf16 v[104:107], a[132:135], v[148:151], v[104:107]
    v_mul_f32 v88, v96, v128
    v_mul_f32 v89, v97, v129
    v_mfma_f32_16x16x32_bf16 v[104:107], a[136:139], v[152:155], v[104:107]
    v_mul_f32 v90, v98, v130
    v_mul_f32 v91, v99, v131
    v_mfma_f32_16x16x32_bf16 v[104:107], a[140:143], v[156:159], v[104:107]
    v_fma_f32 v112, v116, 2.0, v112
    v_fma_f32 v113, v117, 2.0, v113
    v_fma_f32 v114, v118, 2.0, v114
    v_fma_f32 v115, v119, 2.0, v115
    v_cndmask_b32 v4, 0, v112, s[44:45]
    v_cndmask_b32 v4, v4, v113, s[46:47]
    v_cndmask_b32 v4, v4, v114, s[48:49]
    v_cndmask_b32 v4, v4, v115, s[50:51]
    v_add_f32 v63, v63, v96
    v_fmac_f32 v64, v88, v92
    v_mfma_f32_16x16x4_f32 v[124:127], v4, v60, v[56:59]
    v_add_f32 v63, v63, v97
    v_fmac_f32 v64, v89, v93
    v_add_f32 v63, v63, v98
    v_fmac_f32 v64, v90, v94
    v_add_f32 v63, v63, v99
    v_fmac_f32 v64, v91, v95
    v_mov_b32 v68, v88
    v_mov_b32 v69, v89
    v_mov_b32 v70, v90
    v_mov_b32 v71, v91
    v_add_u32 v44, 49152, v44
    v_add_u32 v45, 49152, v45
    v_add_u32 v46, 49152, v46
    v_add_u32 v47, 49152, v47
    v_add_u32 v48, 49152, v48
    v_add_u32 v49, 49152, v49
    v_fma_f32 v132, -v108, v108, v124
    v_fma_f32 v133, -v109, v109, v125
    v_fma_f32 v134, -v110, v110, v126
    v_fma_f32 v135, -v111, v111, v127
    v_max_f32 v132, v132, v56
    v_max_f32 v133, v133, v56
    v_max_f32 v134, v134, v56
    v_max_f32 v135, v135, v56
    v_rsq_f32 v132, v132
    v_rsq_f32 v133, v133
    v_rsq_f32 v134, v134
    v_rsq_f32 v135, v135
    s_add_u32 m0, s40, 0
    s_add_u32 s57, s36, 18874368
    buffer_load_dwordx4 v16, s[28:31], s57 offen offset:0 nt lds
    v_fma_f32 v104, -v108, v61, v104
    v_fma_f32 v105, -v109, v61, v105
    v_fma_f32 v106, -v110, v61, v106
    v_fma_f32 v107, -v111, v61, v107
    v_fma_f32 v104, v104, v132, v62
    v_fma_f32 v105, v105, v133, v62
    v_fma_f32 v106, v106, v134, v62
    v_fma_f32 v107, v107, v135, v62
    v_max3_f32 v1, v104, v105, v106
    v_max_f32 v1, v1, v107
    v_cmp_lt_f32 vcc, s52, v1
    s_cbranch_vccnz L_site7
L_back7:
    v_exp_f32 v112, v104
    v_exp_f32 v113, v105
    v_exp_f32 v114, v106
    v_exp_f32 v115, v107
    v_cvt_pk_bf16_f32 v72, v88, v89
    v_cvt_pk_bf16_f32 v73, v90, v91
    v_mul_f32 v104, v112, v132
    v_mul_f32 v105, v113, v133
    v_mul_f32 v106, v114, v134
    v_mul_f32 v107, v115, v135
    v_cvt_pk_bf16_f32 v74, v104, v105
    v_cvt_pk_bf16_f32 v75, v106, v107
    ds_write_b128 v237, v[72:75] offset:0
    s_waitcnt lgkmcnt(0)
    s_barrier
L_post27:
    ds_read_b32 v9, v254 offset:4096
    ds_read_b128 v[92:95], v253 offset:0
    ds_read_b128 v[96:99], v253 offset:1024
    ds_read_b128 v[100:103], v253 offset:2048
    ds_read_b128 v[116:119], v253 offset:3072
    s_waitcnt lgkmcnt(4)
    v_cmp_ne_u32 vcc, 0, v9
    s_cbranch_vccnz L_xt27
    s_waitcnt lgkmcnt(3)
    v_mfma_f32_16x16x32_bf16 a[0:3], a[144:147], v[92:95], a[0:3]
    buffer_load_dwordx4 v17, s[28:31], s57 offen offset:1024 nt lds
    v_add_f32 v68, v68, v104
    v_add_f32 v69, v69, v105
    v_mfma_f32_16x16x32_bf16 a[4:7], a[160:163], v[92:95], a[4:7]
    buffer_load_dwordx4 v[180:183], v65, s[72:75], s61 offen offset:1024 sc1
    v_add_f32 v70, v70, v106
    v_add_f32 v71, v71, v107
    v_mfma_f32_16x16x32_bf16 a[8:11], a[176:179], v[92:95], a[8:11]
    buffer_load_dwordx4 v18, s[28:31], s57 offen offset:2048 nt lds
    v_add_f32 v63, v63, v112
    v_fma_f32 v64, v104, v108, v64
    s_waitcnt lgkmcnt(2)
    v_mfma_f32_16x16x32_bf16 a[0:3], a[148:151], v[96:99], a[0:3]
    v_add_f32 v63, v63, v113
    v_fma_f32 v64, v105, v109, v64
    v_mfma_f32_16x16x32_bf16 a[4:7], a[164:167], v[96:99], a[4:7]
    v_add_f32 v63, v63, v114
    v_fma_f32 v64, v106, v110, v64
    v_mfma_f32_16x16x32_bf16 a[8:11], a[180:183], v[96:99], a[8:11]
    buffer_load_dwordx4 v19, s[28:31], s57 offen offset:3072 nt lds
    v_add_f32 v63, v63, v115
    v_fma_f32 v64, v107, v111, v64
    s_waitcnt lgkmcnt(1)
    v_mfma_f32_16x16x32_bf16 a[0:3], a[152:155], v[100:103], a[0:3]
    v_mfma_f32_16x16x32_bf16 a[4:7], a[168:171], v[100:103], a[4:7]
    v_mfma_f32_16x16x32_bf16 a[8:11], a[184:187], v[100:103], a[8:11]
    s_waitcnt lgkmcnt(0)
    v_mfma_f32_16x16x32_bf16 a[0:3], a[156:159], v[116:119], a[0:3]
    v_mfma_f32_16x16x32_bf16 a[4:7], a[172:175], v[116:119], a[4:7]
    v_mfma_f32_16x16x32_bf16 a[8:11], a[188:191], v[116:119], a[8:11]
    s_add_u32 m0, s40, 4096
    s_nop 0
    buffer_load_dwordx4 v20, s[28:31], s57 offen offset:0 nt lds
    buffer_load_dwordx4 v[184:187], v65, s[72:75], s61 offen offset:2048 sc1
    buffer_load_dwordx4 v21, s[28:31], s57 offen offset:1024 nt lds
    s_add_u32 m0, s41, 0
    s_add_u32 s58, s37, 75497472
    buffer_load_dwordx4 v224, s[24:27], s58 offen offset:0 nt lds
    buffer_load_dwordx4 v[188:191], v65, s[72:75], s61 offen offset:3072 sc1
    s_waitcnt vmcnt(11)
    s_barrier
    ds_read_b128 a[96:99], v40 offset:49152
    ds_read_b128 a[100:103], v41 offset:49152
    ds_read_b128 a[104:107], v42 offset:49152
    ds_read_b128 a[108:111], v43 offset:49152
    ds_read_b128 a[112:115], v40 offset:49408
    ds_read_b128 a[116:119], v41 offset:49408
    ds_read_b128 a[120:123], v42 offset:49408
    ds_read_b128 a[124:127], v43 offset:49408
    ds_read_b128 a[128:131], v40 offset:49664
    ds_read_b128 a[132:135], v41 offset:49664
    ds_read_b128 a[136:139], v42 offset:49664
    ds_read_b128 a[140:143], v43 offset:49664
    s_waitcnt lgkmcnt(11)
    v_mfma_f32_16x16x32_bf16 v[96:99], a[96:99], a[96:99], v[84:87]
    buffer_load_dwordx4 v225, s[24:27], s58 offen offset:1024 nt lds
    ds_read_b64_tr_b16 a[144:145], v44 offset:0
    ds_read_b64_tr_b16 a[146:147], v45 offset:0
    v_mfma_f32_16x16x32_bf16 v[100:103], a[96:99], a[48:51], 0
    ds_read_b64_tr_b16 a[148:149], v44 offset:12288
    ds_read_b64_tr_b16 a[150:151], v45 offset:12288
    s_waitcnt lgkmcnt(14)
    v_mfma_f32_16x16x32_bf16 v[96:99], a[100:103], a[100:103], v[96:99]
    ds_read_b64_tr_b16 a[152:153], v44 offset:24576
    ds_read_b64_tr_b16 a[154:155], v45 offset:24576
    v_mfma_f32_16x16x32_bf16 v[100:103], a[100:103], a[52:55], v[100:103]
    ds_read_b64_tr_b16 a[156:157], v44 offset:36864
    ds_read_b64_tr_b16 a[158:159], v45 offset:36864
    s_waitcnt lgkmcnt(15)
    v_mfma_f32_16x16x32_bf16 v[96:99], a[104:107], a[104:107], v[96:99]
    ds_read_b64_tr_b16 a[160:161], v46 offset:0
    ds_read_b64_tr_b16 a[162:163], v47 offset:0
    v_mfma_f32_16x16x32_bf16 v[100:103], a[104:107], a[56:59], v[100:103]
    s_add_u32 m0, s41, 2048
    s_add_u32 s58, s37, 75497600
    buffer_load_dwordx4 v224, s[24:27], s58 offen offset:0 nt lds
    ds_read_b64_tr_b16 a[164:165], v46 offset:12288
    ds_read_b64_tr_b16 a[166:167], v47 offset:12288
    v_mfma_f32_16x16x32_bf16 v[96:99], a[108:111], a[108:111], v[96:99]
    ds_read_b64_tr_b16 a[168:169], v46 offset:24576
    ds_read_b64_tr_b16 a[170:171], v47 offset:24576
    v_mfma_f32_16x16x32_bf16 v[100:103], a[108:111], a[60:63], v[100:103]
    ds_read_b64_tr_b16 a[172:173], v46 offset:36864
    ds_read_b64_tr_b16 a[174:175], v47 offset:36864
    v_mfma_f32_16x16x32_bf16 v[96:99], a[112:115], a[112:115], v[96:99]
    ds_read_b64_tr_b16 a[176:177], v48 offset:0
    ds_read_b64_tr_b16 a[178:179], v49 offset:0
    v_mfma_f32_16x16x32_bf16 v[100:103], a[112:115], a[64:67], v[100:103]
    ds_read_b64_tr_b16 a[180:181], v48 offset:12288
    ds_read_b64_tr_b16 a[182:183], v49 offset:12288
    s_waitcnt lgkmcnt(15)
    v_mfma_f32_16x16x32_bf16 v[96:99], a[116:119], a[116:119], v[96:99]
    ds_read_b64_tr_b16 a[184:185], v48 offset:24576
    ds_read_b64_tr_b16 a[186:187], v49 offset:24576
    v_mfma_f32_16x16x32_bf16 v[100:103], a[116:119], a[68:71], v[100:103]
    ds_read_b64_tr_b16 a[188:189], v48 offset:36864
    ds_read_b64_tr_b16 a[190:191], v49 offset:36864
    v_mfma_f32_16x16x32_bf16 v[92:95], a[96:99], v[52:55], v[80:83]
    v_mfma_f32_16x16x32_bf16 v[92:95], a[100:103], v[52:55], v[92:95]
    v_mfma_f32_16x16x32_bf16 v[92:95], a[104:107], v[52:55], v[92:95]
    v_mfma_f32_16x16x32_bf16 v[92:95], a[108:111], v[52:55], v[92:95]
    s_nop 1
    v_fma_f32 v96, v100, 2.0, v96
    v_fma_f32 v97, v101, 2.0, v97
    v_mfma_f32_16x16x32_bf16 v[92:95], a[112:115], v[52:55], v[92:95]
    buffer_load_dwordx4 v225, s[24:27], s58 offen offset:1024 nt lds
    v_fma_f32 v98, v102, 2.0, v98
    v_fma_f32 v99, v103, 2.0, v99
    v_mfma_f32_16x16x32_bf16 v[92:95], a[116:119], v[52:55], v[92:95]
    s_add_u32 s61, s60, 3153920
    buffer_load_dwordx4 v[192:195], v65, s[32:35], s61 offen offset:0 sc1
    v_cndmask_b32 v3, 0, v96, s[44:45]
    v_cndmask_b32 v3, v3, v97, s[46:47]
    v_mfma_f32_16x16x32_bf16 v[88:91], a[96:99], v[136:139], v[76:79]
    v_cndmask_b32 v3, v3, v98, s[48:49]
    v_cndmask_b32 v3, v3, v99, s[50:51]
    v_mfma_f32_16x16x32_bf16 v[88:91], a[100:103], v[140:143], v[88:91]
    s_nop 0
    s_nop 0
    v_mfma_f32_16x16x32_bf16 v[88:91], a[104:107], v[144:147], v[88:91]
    v_mfma_f32_16x16x4_f32 v[120:123], v3, v60, v[56:59]
    v_mfma_f32_16x16x32_bf16 v[88:91], a[108:111], v[148:151], v[88:91]
    v_mfma_f32_16x16x32_bf16 v[88:91], a[112:115], v[152:155], v[88:91]
    v_mfma_f32_16x16x32_bf16 v[88:91], a[116:119], v[156:159], v[88:91]
    v_mfma_f32_16x16x32_bf16 v[112:115], a[120:123], a[120:123], v[84:87]
    v_mfma_f32_16x16x32_bf16 v[116:119], a[120:123], a[48:51], 0
    v_mfma_f32_16x16x32_bf16 v[112:115], a[124:127], a[124:127], v[112:115]
    s_add_u32 m0, s41, 4096
    s_add_u32 s58, s37, 75497728
    buffer_load_dwordx4 v224, s[24:27], s58 offen offset:0 nt lds
    v_mfma_f32_16x16x32_bf16 v[116:119], a[124:127], a[52:55], v[116:119]
    v_fma_f32 v128, -v92, v92, v120
    v_fma_f32 v129, -v93, v93, v121
    v_mfma_f32_16x16x32_bf16 v[112:115], a[128:131], a[128:131], v[112:115]
    v_fma_f32 v130, -v94, v94, v122
    v_fma_f32 v131, -v95, v95, v123
    v_mfma_f32_16x16x32_bf16 v[116:119], a[128:131], a[56:59], v[116:119]
    v_max_f32 v128, v128, v56
    v_max_f32 v129, v129, v56
    v_mfma_f32_16x16x32_bf16 v[112:115], a[132:135], a[132:135], v[112:115]
    v_max_f32 v130, v130, v56
    v_max_f32 v131, v131, v56
    v_mfma_f32_16x16x32_bf16 v[116:119], a[132:135], a[60:63], v[116:119]
    v_rsq_f32 v128, v128
    v_mfma_f32_16x16x32_bf16 v[112:115], a[136:139], a[136:139], v[112:115]
    v_rsq_f32 v129, v129
    v_mfma_f32_16x16x32_bf16 v[116:119], a[136:139], a[64:67], v[116:119]
    v_rsq_f32 v130, v130
    v_mfma_f32_16x16x32_bf16 v[112:115], a[140:143], a[140:143], v[112:115]
    v_rsq_f32 v131, v131
    v_mfma_f32_16x16x32_bf16 v[116:119], a[140:143], a[68:71], v[116:119]
    v_fma_f32 v88, -v92, v61, v88
    v_fma_f32 v89, -v93, v61, v89
    v_mfma_f32_16x16x32_bf16 v[108:111], a[120:123], v[52:55], v[80:83]
    v_fma_f32 v90, -v94, v61, v90
    v_fma_f32 v91, -v95, v61, v91
    v_mfma_f32_16x16x32_bf16 v[108:111], a[124:127], v[52:55], v[108:111]
    v_fma_f32 v88, v88, v128, v62
    v_fma_f32 v89, v89, v129, v62
    v_mfma_f32_16x16x32_bf16 v[108:111], a[128:131], v[52:55], v[108:111]
    v_fma_f32 v90, v90, v130, v62
    v_fma_f32 v91, v91, v131, v62
    v_mfma_f32_16x16x32_bf16 v[108:111], a[132:135], v[52:55], v[108:111]
    buffer_load_dwordx4 v225, s[24:27], s58 offen offset:1024 nt lds
    v_max3_f32 v1, v88, v89, v90
    v_max_f32 v1, v1, v91
    v_mfma_f32_16x16x32_bf16 v[108:111], a[136:139], v[52:55], v[108:111]
    v_cmp_lt_f32 vcc, s52, v1
    s_cbranch_vccnz L_site8
L_back8:
    v_mfma_f32_16x16x32_bf16 v[108:111], a[140:143], v[52:55], v[108:111]
    v_exp_f32 v96, v88
    v_mfma_f32_16x16x32_bf16 v[104:107], a[120:123], v[136:139], v[76:79]
    v_exp_f32 v97, v89
    v_mfma_f32_16x16x32_bf16 v[104:107], a[124:127], v[140:143], v[104:107]
    v_exp_f32 v98, v90
    v_mfma_f32_16x16x32_bf16 v[104:107], a[128:131], v[144:147], v[104:107]
    v_exp_f32 v99, v91
    v_mfma_f32_16x16x32_bf16 v[104:107], a[132:135], v[148:151], v[104:107]
    v_mul_f32 v88, v96, v128
    v_mul_f32 v89, v97, v129
    v_mfma_f32_16x16x32_bf16 v[104:107], a[136:139], v[152:155], v[104:107]
    v_mul_f32 v90, v98, v130
    v_mul_f32 v91, v99, v131
    v_mfma_f32_16x16x32_bf16 v[104:107], a[140:143], v[156:159], v[104:107]
    v_fma_f32 v112, v116, 2.0, v112
    v_fma_f32 v113, v117, 2.0, v113
    v_fma_f32 v114, v118, 2.0, v114
    v_fma_f32 v115, v119, 2.0, v115
    v_cndmask_b32 v4, 0, v112, s[44:45]
    v_cndmask_b32 v4, v4, v113, s[46:47]
    v_cndmask_b32 v4, v4, v114, s[48:49]
    v_cndmask_b32 v4, v4, v115, s[50:51]
    v_add_f32 v63, v63, v96
    v_fmac_f32 v64, v88, v92
    v_mfma_f32_16x16x4_f32 v[124:127], v4, v60, v[56:59]
    v_add_f32 v63, v63, v97
    v_fmac_f32 v64, v89, v93
    v_add_f32 v63, v63, v98
    v_fmac_f32 v64, v90, v94
    v_add_f32 v63, v63, v99
    v_fmac_f32 v64, v91, v95
    v_add_f32 v68, v68, v88
    v_add_f32 v69, v69, v89
    v_add_f32 v70, v70, v90
    v_add_f32 v71, v71, v91
    v_add_u32 v44, -49152, v44
    v_add_u32 v45, -49152, v45
    v_add_u32 v46, -49152, v46
    v_add_u32 v47, -49152, v47
    v_add_u32 v48, -49152, v48
    v_add_u32 v49, -49152, v49
    v_fma_f32 v132, -v108, v108, v124
    v_fma_f32 v133, -v109, v109, v125
    v_fma_f32 v134, -v110, v110, v126
    v_fma_f32 v135, -v111, v111, v127
    v_max_f32 v132, v132, v56
    v_max_f32 v133, v133, v56
    v_max_f32 v134, v134, v56
    v_max_f32 v135, v135, v56
    v_rsq_f32 v132, v132
    v_rsq_f32 v133, v133
    v_rsq_f32 v134, v134
    v_rsq_f32 v135, v135
    buffer_load_dwordx4 v[196:199], v65, s[32:35], s61 offen offset:1024 sc1
    v_fma_f32 v104, -v108, v61, v104
    v_fma_f32 v105, -v109, v61, v105
    v_fma_f32 v106, -v110, v61, v106
    v_fma_f32 v107, -v111, v61, v107
    v_fma_f32 v104, v104, v132, v62
    v_fma_f32 v105, v105, v133, v62
    v_fma_f32 v106, v106, v134, v62
    v_fma_f32 v107, v107, v135, v62
    v_max3_f32 v1, v104, v105, v106
    v_max_f32 v1, v1, v107
    v_cmp_lt_f32 vcc, s52, v1
    s_cbranch_vccnz L_site9
L_back9:
    s_add_u32 m0, s41, 6144
    s_add_u32 s58, s37, 75497856
    buffer_load_dwordx4 v224, s[24:27], s58 offen offset:0 nt lds
    v_exp_f32 v112, v104
    v_exp_f32 v113, v105
    v_exp_f32 v114, v106
    v_exp_f32 v115, v107
    v_cvt_pk_bf16_f32 v72, v88, v89
    v_cvt_pk_bf16_f32 v73, v90, v91
    v_mul_f32 v104, v112, v132
    v_mul_f32 v105, v113, v133
    v_mul_f32 v106, v114, v134
    v_mul_f32 v107, v115, v135
    v_cvt_pk_bf16_f32 v74, v104, v105
    v_cvt_pk_bf16_f32 v75, v106, v107
    ds_write_b128 v237, v[72:75] offset:0
    v_add_f32 v68, v68, v104
    v_add_f32 v69, v69, v105
    v_add_f32 v70, v70, v106
    v_add_f32 v71, v71, v107
    v_cvt_pk_bf16_f32 v66, v68, v69
    v_cvt_pk_bf16_f32 v67, v70, v71
    ds_write_b64 v238, v[66:67]
    s_lshl_b32 s56, s3, 13
    v_lshl_add_u32 v233, v0, 7, s56
    v_min_u32 v233, L_hot - L_tail, v233
    v_add_u32 v233, L_tail - L_pc_main, v233
    global_load_dword v234, v233, s[100:101]
    s_waitcnt vmcnt(11)
    s_waitcnt lgkmcnt(0)
    s_barrier
L_post9:
    ds_read_b32 v9, v254 offset:4096
    ds_read_b64 v[120:121], v254 offset:0
    ds_read_b64 v[122:123], v254 offset:512
    ds_read_b64 v[124:125], v254 offset:1024
    ds_read_b64 v[126:127], v254 offset:1536
    ds_read_b128 v[92:95], v253 offset:0
    ds_read_b128 v[96:99], v253 offset:1024
    ds_read_b128 v[100:103], v253 offset:2048
    ds_read_b128 v[116:119], v253 offset:3072
    ds_read_b128 a[48:51], v34 offset:0
    ds_read_b128 a[52:55], v35 offset:0
    ds_read_b128 a[56:59], v34 offset:128
    ds_read_b128 a[60:63], v35 offset:128
    ds_read_b128 a[64:67], v34 offset:256
    ds_read_b128 a[68:71], v35 offset:256
    s_waitcnt lgkmcnt(14)
    v_cmp_ne_u32 vcc, 0, v9
    s_cbranch_vccnz L_xt9
    s_waitcnt lgkmcnt(12)
    v_mfma_f32_16x16x32_bf16 a[0:3], a[72:75], v[120:123], a[0:3]
    buffer_load_dwordx4 v225, s[24:27], s58 offen offset:1024 nt lds
    v_add_f32 v63, v63, v112
    v_fma_f32 v64, v104, v108, v64
    v_mfma_f32_16x16x32_bf16 a[4:7], a[80:83], v[120:123], a[4:7]
    s_add_u32 m0, s41, 8192
    s_add_u32 s58, s37, 75497984
    buffer_load_dwordx4 v224, s[24:27], s58 offen offset:0 nt lds
    v_add_f32 v63, v63, v113
    v_fma_f32 v64, v105, v109, v64
    v_mfma_f32_16x16x32_bf16 a[8:11], a[88:91], v[120:123], a[8:11]
    v_add_f32 v63, v63, v114
    v_fma_f32 v64, v106, v110, v64
    s_waitcnt lgkmcnt(10)
    v_mfma_f32_16x16x32_bf16 a[0:3], a[76:79], v[124:127], a[0:3]
    v_add_f32 v63, v63, v115
    v_fma_f32 v64, v107, v111, v64
    v_mfma_f32_16x16x32_bf16 a[4:7], a[84:87], v[124:127], a[4:7]
    v_mfma_f32_16x16x32_bf16 a[8:11], a[92:95], v[124:127], a[8:11]
    buffer_load_dwordx4 v[200:203], v65, s[32:35], s61 offen offset:2048 sc1
    s_waitcnt lgkmcnt(9)
    v_mfma_f32_16x16x32_bf16 a[0:3], a[144:147], v[92:95], a[0:3]
    ds_read_b64_tr_b16 a[72:73], v36 offset:0
    ds_read_b64_tr_b16 a[74:75], v36 offset:6144
    v_mfma_f32_16x16x32_bf16 a[4:7], a[160:163], v[92:95], a[4:7]
    ds_read_b64_tr_b16 a[76:77], v36 offset:12288
    ds_read_b64_tr_b16 a[78:79], v36 offset:18432
    v_mfma_f32_16x16x32_bf16 a[8:11], a[176:179], v[92:95], a[8:11]
    ds_read_b64_tr_b16 a[80:81], v37 offset:0
    ds_read_b64_tr_b16 a[82:83], v37 offset:6144
    s_waitcnt lgkmcnt(14)
    v_mfma_f32_16x16x32_bf16 a[0:3], a[148:151], v[96:99], a[0:3]
    ds_read_b64_tr_b16 a[84:85], v37 offset:12288
    ds_read_b64_tr_b16 a[86:87], v37 offset:18432
    v_mfma_f32_16x16x32_bf16 a[4:7], a[164:167], v[96:99], a[4:7]
    ds_read_b64_tr_b16 a[88:89], v38 offset:0
    ds_read_b64_tr_b16 a[90:91], v38 offset:6144
    v_mfma_f32_16x16x32_bf16 a[8:11], a[180:183], v[96:99], a[8:11]
    ds_read_b64_tr_b16 a[92:93], v38 offset:12288
    ds_read_b64_tr_b16 a[94:95], v38 offset:18432
    s_waitcnt lgkmcnt(15)
    v_mfma_f32_16x16x32_bf16 a[0:3], a[152:155], v[100:103], a[0:3]
    v_mfma_f32_16x16x32_bf16 a[4:7], a[168:171], v[100:103], a[4:7]
    v_mfma_f32_16x16x32_bf16 a[8:11], a[184:187], v[100:103], a[8:11]
    v_mfma_f32_16x16x32_bf16 a[0:3], a[156:159], v[116:119], a[0:3]
    v_mfma_f32_16x16x32_bf16 a[4:7], a[172:175], v[116:119], a[4:7]
    v_mfma_f32_16x16x32_bf16 a[8:11], a[188:191], v[116:119], a[8:11]
    buffer_load_dwordx4 v225, s[24:27], s58 offen offset:1024 nt lds
    v_mfma_f32_16x16x32_bf16 v[84:87], a[48:51], a[48:51], 0
    v_mfma_f32_16x16x32_bf16 v[80:83], a[48:51], v[52:55], 0
    v_mfma_f32_16x16x32_bf16 v[84:87], a[52:55], a[52:55], v[84:87]
    v_mfma_f32_16x16x32_bf16 v[80:83], a[52:55], v[52:55], v[80:83]
    v_mfma_f32_16x16x32_bf16 v[84:87], a[56:59], a[56:59], v[84:87]
    v_mfma_f32_16x16x32_bf16 v[80:83], a[56:59], v[52:55], v[80:83]
    s_waitcnt lgkmcnt(14)
    v_mfma_f32_16x16x32_bf16 v[84:87], a[60:63], a[60:63], v[84:87]
    v_mfma_f32_16x16x32_bf16 v[80:83], a[60:63], v[52:55], v[80:83]
    s_waitcnt lgkmcnt(13)
    v_mfma_f32_16x16x32_bf16 v[84:87], a[64:67], a[64:67], v[84:87]
    v_mfma_f32_16x16x32_bf16 v[80:83], a[64:67], v[52:55], v[80:83]
    s_waitcnt lgkmcnt(12)
    v_mfma_f32_16x16x32_bf16 v[84:87], a[68:71], a[68:71], v[84:87]
    v_mfma_f32_16x16x32_bf16 v[80:83], a[68:71], v[52:55], v[80:83]
    s_waitcnt lgkmcnt(0)
    v_mfma_f32_16x16x32_bf16 v[76:79], a[48:51], v[136:139], 0
    v_mfma_f32_16x16x32_bf16 v[76:79], a[52:55], v[140:143], v[76:79]
    s_add_u32 m0, s41, 10240
    s_add_u32 s58, s37, 75498112
    buffer_load_dwordx4 v224, s[24:27], s58 offen offset:0 nt lds
    v_mfma_f32_16x16x32_bf16 v[76:79], a[56:59], v[144:147], v[76:79]
    buffer_load_dwordx4 v[204:207], v65, s[32:35], s61 offen offset:3072 sc1
    v_mfma_f32_16x16x32_bf16 v[76:79], a[60:63], v[148:151], v[76:79]
    v_mfma_f32_16x16x32_bf16 v[76:79], a[64:67], v[152:155], v[76:79]
    v_mfma_f32_16x16x32_bf16 v[76:79], a[68:71], v[156:159], v[76:79]
    s_mul_i32 s28, s3, 262144
    s_and_b32 s56, s2, 7
    s_lshl_b32 s56, s56, 10
    s_add_u32 s28, s28, s56
    s_bfe_u32 s56, s2, 0x30003
    s_lshl_b32 s56, s56, 7
    s_add_u32 s28, s28, s56
    s_lshr_b32 s56, s2, 6
    s_lshl_b32 s56, s56, 14
    s_add_u32 s28, s28, s56
    s_add_u32 s28, s28, 8388608
    v_lshrrev_b32 v1, 3, v0
    s_xor_b32 s56, s1, s3
    v_xor_b32 v1, s56, v1
    v_and_b32 v1, 1, v1
    v_lshl_or_b32 v242, v1, 13, v242
    s_sub_u32 s29, s2, 64
    s_mul_i32 s30, s29, 65536
    s_lshl_b32 s56, s3, 14
    s_add_u32 s30, s30, s56
    s_add_u32 s30, s30, 8388608
    s_lshr_b32 s56, s29, 5
    s_xor_b32 s56, s56, s1
    s_lshr_b32 s57, s29, 2
    s_xor_b32 s56, s56, s57
    s_and_b32 s56, s56, 1
    s_lshl_b32 s56, s56, 13
    s_add_u32 s30, s30, s56
    s_add_u32 s31, s30, 4096
    v_mov_b32 v28, v242
    v_bfe_u32 v1, v0, 4, 1
    v_mul_u32_u24 v2, 65536, v1
    v_mul_u32_u24 v1, 0x70, v1
    v_xor_b32 v242, v242, v1
    v_sub_u32 v242, v242, v2
    v_add_u32 v243, 65536, v242
    v_mov_b32 v232, 0x53800000
    s_mov_b32 s43, 1
    s_mov_b32 s68, s18
    s_mov_b32 s69, s19
    s_mov_b32 s70, 6144
    s_mov_b32 s71, 0x20000
L_tail:
    v_and_b32 v1, 15, v0
    v_lshlrev_b32 v1, 8, v1
    v_sub_u32 v1, v34, v1
    v_lshrrev_b32 v2, 2, v0
    v_lshlrev_b32 v2, 8, v2
    s_sub_u32 s56, s41, s40
    v_add_u32 v40, s56, v1
    v_xor_b32 v41, 64, v40
    s_sub_u32 s56, s42, s40
    v_add_u32 v42, s56, v1
    v_xor_b32 v43, 64, v42
    s_mul_i32 s56, s3, 3
    s_add_u32 s57, s56, 0
    s_lshr_b32 s57, s57, 2
    s_mul_i32 s57, s57, 1920
    s_add_u32 s57, s57, 24576
    v_sub_u32 v44, v36, v2
    v_add_u32 v44, s57, v44
    v_add_u32 v47, 49152, v44
    s_add_u32 s57, s56, 1
    s_lshr_b32 s57, s57, 2
    s_mul_i32 s57, s57, 1920
    s_add_u32 s57, s57, 24576
    v_sub_u32 v45, v37, v2
    v_add_u32 v45, s57, v45
    v_add_u32 v48, 49152, v45
    s_add_u32 s57, s56, 2
    s_lshr_b32 s57, s57, 2
    s_mul_i32 s57, s57, 1920
    s_add_u32 s57, s57, 24576
    v_sub_u32 v46, v38, v2
    v_add_u32 v46, s57, v46
    v_add_u32 v49, 49152, v46
    v_accvgpr_read_b32 v16, a0
    v_accvgpr_read_b32 v17, a1
    v_accvgpr_read_b32 v18, a2
    v_accvgpr_read_b32 v19, a3
    v_accvgpr_read_b32 v20, a4
    v_accvgpr_read_b32 v21, a5
    v_accvgpr_read_b32 v22, a6
    v_accvgpr_read_b32 v23, a7
    v_accvgpr_read_b32 v24, a8
    v_accvgpr_read_b32 v25, a9
    v_accvgpr_read_b32 v26, a10
    v_accvgpr_read_b32 v27, a11
    buffer_load_dwordx4 v225, s[24:27], s58 offen offset:1024 nt lds
    s_add_u32 m0, s42, 0
    s_add_u32 s59, s37, 75694080
    buffer_load_dwordx4 v224, s[24:27], s59 offen offset:0 nt lds
    buffer_load_dwordx4 v225, s[24:27], s59 offen offset:1024 nt lds
    s_waitcnt vmcnt(12)
    s_barrier
    ds_read_b128 a[96:99], v40 offset:0
    ds_read_b128 a[100:103], v41 offset:0
    ds_read_b128 a[104:107], v40 offset:2048
    ds_read_b128 a[108:111], v41 offset:2048
    ds_read_b128 a[112:115], v40 offset:4096
    ds_read_b128 a[116:119], v41 offset:4096
    s_waitcnt lgkmcnt(5)
    v_mfma_f32_16x16x32_bf16 v[96:99], a[96:99], a[96:99], v[84:87]
    s_add_u32 m0, s42, 2048
    s_add_u32 s59, s37, 75694208
    buffer_load_dwordx4 v224, s[24:27], s59 offen offset:0 nt lds
    ds_read_b64_tr_b16 a[144:145], v44 offset:0
    ds_read_b64_tr_b16 a[148:149], v44 offset:12288
    v_mfma_f32_16x16x32_bf16 v[100:103], a[96:99], a[48:51], 0
    buffer_load_dwordx4 v225, s[24:27], s59 offen offset:1024 nt lds
    ds_read_b64_tr_b16 a[152:153], v44 offset:24576
    ds_read_b64_tr_b16 a[156:157], v44 offset:36864
    s_waitcnt lgkmcnt(8)
    v_mfma_f32_16x16x32_bf16 v[96:99], a[100:103], a[100:103], v[96:99]
    ds_read_b64_tr_b16 a[160:161], v45 offset:0
    ds_read_b64_tr_b16 a[164:165], v45 offset:12288
    v_mfma_f32_16x16x32_bf16 v[100:103], a[100:103], a[52:55], v[100:103]
    ds_read_b64_tr_b16 a[168:169], v45 offset:24576
    ds_read_b64_tr_b16 a[172:173], v45 offset:36864
    s_waitcnt lgkmcnt(11)
    v_mfma_f32_16x16x32_bf16 v[96:99], a[104:107], a[104:107], v[96:99]
    ds_read_b64_tr_b16 a[176:177], v46 offset:0
    ds_read_b64_tr_b16 a[180:181], v46 offset:12288
    v_mfma_f32_16x16x32_bf16 v[100:103], a[104:107], a[56:59], v[100:103]
    ds_read_b64_tr_b16 a[184:185], v46 offset:24576
    ds_read_b64_tr_b16 a[188:189], v46 offset:36864
    s_waitcnt lgkmcnt(14)
    v_mfma_f32_16x16x32_bf16 v[96:99], a[108:111], a[108:111], v[96:99]
    v_mfma_f32_16x16x32_bf16 v[100:103], a[108:111], a[60:63], v[100:103]
    s_waitcnt lgkmcnt(13)
    v_mfma_f32_16x16x32_bf16 v[96:99], a[112:115], a[112:115], v[96:99]
    v_mfma_f32_16x16x32_bf16 v[100:103], a[112:115], a[64:67], v[100:103]
    s_add_u32 m0, s42, 4096
    s_add_u32 s59, s37, 75694336
    buffer_load_dwordx4 v224, s[24:27], s59 offen offset:0 nt lds
    s_waitcnt lgkmcnt(12)
    v_mfma_f32_16x16x32_bf16 v[96:99], a[116:119], a[116:119], v[96:99]
    v_mfma_f32_16x16x32_bf16 v[100:103], a[116:119], a[68:71], v[100:103]
    v_mfma_f32_16x16x32_bf16 v[92:95], a[96:99], v[52:55], v[80:83]
    v_mfma_f32_16x16x32_bf16 v[92:95], a[100:103], v[52:55], v[92:95]
    v_mfma_f32_16x16x32_bf16 v[92:95], a[104:107], v[52:55], v[92:95]
    v_mfma_f32_16x16x32_bf16 v[92:95], a[108:111], v[52:55], v[92:95]
    s_nop 3
    v_fma_f32 v96, v100, 2.0, v96
    v_fma_f32 v97, v101, 2.0, v97
    v_mfma_f32_16x16x32_bf16 v[92:95], a[112:115], v[52:55], v[92:95]
    v_fma_f32 v98, v102, 2.0, v98
    v_fma_f32 v99, v103, 2.0, v99
    v_mfma_f32_16x16x32_bf16 v[92:95], a[116:119], v[52:55], v[92:95]
    v_cndmask_b32 v3, 0, v96, s[44:45]
    v_cndmask_b32 v3, v3, v97, s[46:47]
    v_mfma_f32_16x16x32_bf16 v[88:91], a[96:99], v[136:139], v[76:79]
    v_cndmask_b32 v3, v3, v98, s[48:49]
    v_cndmask_b32 v3, v3, v99, s[50:51]
    v_mfma_f32_16x16x32_bf16 v[88:91], a[100:103], v[140:143], v[88:91]
    s_nop 0
    s_nop 0
    v_mfma_f32_16x16x32_bf16 v[88:91], a[104:107], v[144:147], v[88:91]
    v_mfma_f32_16x16x4_f32 v[120:123], v3, v60, v[56:59]
    v_mfma_f32_16x16x32_bf16 v[88:91], a[108:111], v[148:151], v[88:91]
    buffer_load_dwordx4 v225, s[24:27], s59 offen offset:1024 nt lds
    v_mfma_f32_16x16x32_bf16 v[88:91], a[112:115], v[152:155], v[88:91]
    s_add_u32 m0, s42, 6144
    s_add_u32 s59, s37, 75694464
    buffer_load_dwordx4 v224, s[24:27], s59 offen offset:0 nt lds
    v_mfma_f32_16x16x32_bf16 v[88:91], a[116:119], v[156:159], v[88:91]
    s_nop 2
    v_fma_f32 v128, -v92, v92, v120
    v_fma_f32 v129, -v93, v93, v121
    v_fma_f32 v130, -v94, v94, v122
    v_fma_f32 v131, -v95, v95, v123
    v_max_f32 v128, v128, v56
    v_max_f32 v129, v129, v56
    v_max_f32 v130, v130, v56
    v_max_f32 v131, v131, v56
    v_rsq_f32 v128, v128
    v_rsq_f32 v129, v129
    v_rsq_f32 v130, v130
    v_rsq_f32 v131, v131
    v_fma_f32 v88, -v92, v61, v88
    v_fma_f32 v89, -v93, v61, v89
    v_fma_f32 v90, -v94, v61, v90
    v_fma_f32 v91, -v95, v61, v91
    v_fma_f32 v88, v88, v128, v62
    v_fma_f32 v89, v89, v129, v62
    v_fma_f32 v90, v90, v130, v62
    v_fma_f32 v91, v91, v131, v62
    v_max3_f32 v1, v88, v89, v90
    v_max_f32 v1, v1, v91
    v_cmp_lt_f32 vcc, s52, v1
    s_cbranch_vccnz L_site10
L_back10:
    v_exp_f32 v96, v88
    v_exp_f32 v97, v89
    v_exp_f32 v98, v90
    v_exp_f32 v99, v91
    v_mul_f32 v88, v96, v128
    v_mul_f32 v89, v97, v129
    v_mul_f32 v90, v98, v130
    buffer_load_dwordx4 v225, s[24:27], s59 offen offset:1024 nt lds
    v_mul_f32 v91, v99, v131
    v_add_f32 v63, v63, v96
    v_fmac_f32 v64, v88, v92
    v_add_f32 v63, v63, v97
    v_fmac_f32 v64, v89, v93
    v_add_f32 v63, v63, v98
    v_fmac_f32 v64, v90, v94
    v_add_f32 v63, v63, v99
    v_fmac_f32 v64, v91, v95
    v_mov_b32 v68, v88
    v_mov_b32 v69, v89
    v_mov_b32 v70, v90
    v_mov_b32 v71, v91
    s_waitcnt vmcnt(14)
    ds_read_b128 a[120:123], v40 offset:6144
    ds_read_b128 a[124:127], v41 offset:6144
    s_waitcnt lgkmcnt(1)
    v_mfma_f32_16x16x32_bf16 v[112:115], a[120:123], a[120:123], v[84:87]
    v_mfma_f32_16x16x32_bf16 v[116:119], a[120:123], a[48:51], 0
    s_add_u32 m0, s42, 8192
    s_add_u32 s59, s37, 75694592
    buffer_load_dwordx4 v224, s[24:27], s59 offen offset:0 nt lds
    s_waitcnt lgkmcnt(0)
    v_mfma_f32_16x16x32_bf16 v[112:115], a[124:127], a[124:127], v[112:115]
    buffer_load_dwordx4 v225, s[24:27], s59 offen offset:1024 nt lds
    v_mfma_f32_16x16x32_bf16 v[116:119], a[124:127], a[52:55], v[116:119]
    v_mfma_f32_16x16x32_bf16 v[108:111], a[120:123], v[52:55], v[80:83]
    v_mfma_f32_16x16x32_bf16 v[104:107], a[120:123], v[136:139], v[76:79]
    s_waitcnt vmcnt(13)
    ds_read_b128 a[128:131], v40 offset:8192
    ds_read_b128 a[132:135], v41 offset:8192
    v_mfma_f32_16x16x32_bf16 v[108:111], a[124:127], v[52:55], v[108:111]
    v_mfma_f32_16x16x32_bf16 v[104:107], a[124:127], v[140:143], v[104:107]
    s_waitcnt lgkmcnt(1)
    v_mfma_f32_16x16x32_bf16 v[112:115], a[128:131], a[128:131], v[112:115]
    v_mfma_f32_16x16x32_bf16 v[116:119], a[128:131], a[56:59], v[116:119]
    s_waitcnt lgkmcnt(0)
    v_mfma_f32_16x16x32_bf16 v[112:115], a[132:135], a[132:135], v[112:115]
    v_mfma_f32_16x16x32_bf16 v[116:119], a[132:135], a[60:63], v[116:119]
    v_mfma_f32_16x16x32_bf16 v[108:111], a[128:131], v[52:55], v[108:111]
    s_add_u32 m0, s42, 10240
    s_add_u32 s59, s37, 75694720
    buffer_load_dwordx4 v224, s[24:27], s59 offen offset:0 nt lds
    v_mfma_f32_16x16x32_bf16 v[104:107], a[128:131], v[144:147], v[104:107]
    buffer_load_dwordx4 v225, s[24:27], s59 offen offset:1024 nt lds
    s_waitcnt vmcnt(12)
    ds_read_b128 a[136:139], v40 offset:10240
    ds_read_b128 a[140:143], v41 offset:10240
    s_barrier
    s_add_u32 s61, s60, 3158016
    buffer_load_dwordx4 v[208:211], v65, s[32:35], s61 offen offset:0 sc1
    v_mfma_f32_16x16x32_bf16 v[108:111], a[132:135], v[52:55], v[108:111]
    ds_read_b64_tr_b16 a[146:147], v44 offset:6144
    v_mfma_f32_16x16x32_bf16 v[104:107], a[132:135], v[148:151], v[104:107]
    ds_read_b64_tr_b16 a[150:151], v44 offset:18432
    s_waitcnt lgkmcnt(3)
    v_mfma_f32_16x16x32_bf16 v[112:115], a[136:139], a[136:139], v[112:115]
    ds_read_b64_tr_b16 a[154:155], v44 offset:30720
    v_mfma_f32_16x16x32_bf16 v[116:119], a[136:139], a[64:67], v[116:119]
    ds_read_b64_tr_b16 a[158:159], v44 offset:43008
    s_waitcnt lgkmcnt(4)
    v_mfma_f32_16x16x32_bf16 v[112:115], a[140:143], a[140:143], v[112:115]
    ds_read_b64_tr_b16 a[162:163], v45 offset:6144
    v_mfma_f32_16x16x32_bf16 v[116:119], a[140:143], a[68:71], v[116:119]
    ds_read_b64_tr_b16 a[166:167], v45 offset:18432
    v_mfma_f32_16x16x32_bf16 v[108:111], a[136:139], v[52:55], v[108:111]
    ds_read_b64_tr_b16 a[170:171], v45 offset:30720
    v_mfma_f32_16x16x32_bf16 v[108:111], a[140:143], v[52:55], v[108:111]
    ds_read_b64_tr_b16 a[174:175], v45 offset:43008
    s_nop 2
    v_fma_f32 v112, v116, 2.0, v112
    v_fma_f32 v113, v117, 2.0, v113
    v_fma_f32 v114, v118, 2.0, v114
    v_fma_f32 v115, v119, 2.0, v115
    v_cndmask_b32 v4, 0, v112, s[44:45]
    v_cndmask_b32 v4, v4, v113, s[46:47]
    v_cndmask_b32 v4, v4, v114, s[48:49]
    v_cndmask_b32 v4, v4, v115, s[50:51]
    ds_read_b64_tr_b16 a[178:179], v46 offset:6144
    ds_read_b64_tr_b16 a[182:183], v46 offset:18432
    v_mfma_f32_16x16x4_f32 v[124:127], v4, v60, v[56:59]
    ds_read_b64_tr_b16 a[186:187], v46 offset:30720
    ds_read_b64_tr_b16 a[190:191], v46 offset:43008
    buffer_load_dwordx4 v[212:215], v65, s[32:35], s61 offen offset:1024 sc1
    s_nop 5
    v_mfma_f32_16x16x32_bf16 v[104:107], a[136:139], v[152:155], v[104:107]
    v_fma_f32 v132, -v108, v108, v124
    v_fma_f32 v133, -v109, v109, v125
    v_mfma_f32_16x16x32_bf16 v[104:107], a[140:143], v[156:159], v[104:107]
    v_fma_f32 v134, -v110, v110, v126
    v_fma_f32 v135, -v111, v111, v127
    v_max_f32 v132, v132, v56
    v_max_f32 v133, v133, v56
    v_max_f32 v134, v134, v56
    v_max_f32 v135, v135, v56
    v_rsq_f32 v132, v132
    v_rsq_f32 v133, v133
    v_rsq_f32 v134, v134
    v_rsq_f32 v135, v135
    v_pk_fma_f32 v[104:105], v[108:109], v[60:61], v[104:105] op_sel:[0,1,0] neg_lo:[1,0,0] neg_hi:[1,0,0]
    v_pk_fma_f32 v[106:107], v[110:111], v[60:61], v[106:107] op_sel:[0,1,0] neg_lo:[1,0,0] neg_hi:[1,0,0]
    v_pk_fma_f32 v[104:105], v[104:105], v[132:133], v[62:63] op_sel_hi:[1,1,0]
    v_pk_fma_f32 v[106:107], v[106:107], v[134:135], v[62:63] op_sel_hi:[1,1,0]
L_back11:
    v_max3_f32 v1, v104, v105, v106
    v_max_f32 v1, v1, v107
    v_cmp_lt_f32 vcc, s52, v1
    v_exp_f32 v112, v104
    v_exp_f32 v113, v105
    v_exp_f32 v114, v106
    v_exp_f32 v115, v107
    s_cbranch_vccnz L_site11
    v_cvt_pk_bf16_f32 v72, v88, v89
    v_cvt_pk_bf16_f32 v73, v90, v91
    v_pk_mul_f32 v[104:105], v[112:113], v[132:133]
    v_pk_mul_f32 v[106:107], v[114:115], v[134:135]
    v_cvt_pk_bf16_f32 v74, v104, v105
    v_cvt_pk_bf16_f32 v75, v106, v107
    ds_write_b128 v237, v[72:75] offset:12288
    s_waitcnt lgkmcnt(0)
    s_barrier
    ds_read_b32 v9, v254 offset:4100
    ds_read_b128 a[192:195], v253 offset:12288
    ds_read_b128 a[196:199], v253 offset:13312
    ds_read_b128 a[200:203], v253 offset:14336
    ds_read_b128 a[204:207], v253 offset:15360
    buffer_load_dwordx4 v[216:219], v65, s[32:35], s61 offen offset:2048 sc1
    s_waitcnt lgkmcnt(4)
    v_cmp_ne_u32 vcc, 0, v9
    s_cbranch_vccnz L_xt11
L_post11:
    s_waitcnt lgkmcnt(3)
    v_mfma_f32_16x16x32_bf16 v[16:19], a[144:147], a[192:195], v[16:19]
    v_add_f32 v68, v68, v104
    v_add_f32 v69, v69, v105
    v_mfma_f32_16x16x32_bf16 v[20:23], a[160:163], a[192:195], v[20:23]
    v_add_f32 v70, v70, v106
    v_add_f32 v71, v71, v107
    v_mfma_f32_16x16x32_bf16 v[24:27], a[176:179], a[192:195], v[24:27]
    v_add_f32 v63, v63, v112
    v_fma_f32 v64, v104, v108, v64
    s_waitcnt lgkmcnt(2)
    v_mfma_f32_16x16x32_bf16 v[16:19], a[148:151], a[196:199], v[16:19]
    s_waitcnt vmcnt(13)
    ds_read_b128 a[96:99], v42 offset:0
    ds_read_b128 a[100:103], v43 offset:0
    v_mfma_f32_16x16x32_bf16 v[20:23], a[164:167], a[196:199], v[20:23]
    v_add_f32 v63, v63, v113
    v_fma_f32 v64, v105, v109, v64
    v_mfma_f32_16x16x32_bf16 v[24:27], a[180:183], a[196:199], v[24:27]
    v_add_f32 v63, v63, v114
    v_fma_f32 v64, v106, v110, v64
    s_waitcnt lgkmcnt(3)
    v_mfma_f32_16x16x32_bf16 v[16:19], a[152:155], a[200:203], v[16:19]
    v_add_f32 v63, v63, v115
    v_fma_f32 v64, v107, v111, v64
    v_mfma_f32_16x16x32_bf16 v[20:23], a[168:171], a[200:203], v[20:23]
    s_waitcnt vmcnt(11)
    ds_read_b128 a[104:107], v42 offset:2048
    ds_read_b128 a[108:111], v43 offset:2048
    v_mfma_f32_16x16x32_bf16 v[24:27], a[184:187], a[200:203], v[24:27]
    s_waitcnt lgkmcnt(4)
    v_mfma_f32_16x16x32_bf16 v[16:19], a[156:159], a[204:207], v[16:19]
    v_mfma_f32_16x16x32_bf16 v[20:23], a[172:175], a[204:207], v[20:23]
    v_mfma_f32_16x16x32_bf16 v[24:27], a[188:191], a[204:207], v[24:27]
    s_waitcnt lgkmcnt(3)
    v_mfma_f32_16x16x32_bf16 v[96:99], a[96:99], a[96:99], v[84:87]
    v_mfma_f32_16x16x32_bf16 v[100:103], a[96:99], a[48:51], 0
    s_waitcnt lgkmcnt(2)
    v_mfma_f32_16x16x32_bf16 v[96:99], a[100:103], a[100:103], v[96:99]
    v_mfma_f32_16x16x32_bf16 v[100:103], a[100:103], a[52:55], v[100:103]
    s_waitcnt vmcnt(9)
    ds_read_b128 a[112:115], v42 offset:4096
    ds_read_b128 a[116:119], v43 offset:4096
    s_barrier
    v_mfma_f32_16x16x32_bf16 v[92:95], a[96:99], v[52:55], v[80:83]
    buffer_load_dwordx4 v[220:223], v65, s[32:35], s61 offen offset:3072 sc1
    ds_read_b64_tr_b16 a[0:1], v47 offset:0
    v_mfma_f32_16x16x32_bf16 v[88:91], a[96:99], v[136:139], v[76:79]
    ds_read_b64_tr_b16 a[4:5], v47 offset:12288
    v_mfma_f32_16x16x32_bf16 v[92:95], a[100:103], v[52:55], v[92:95]
    ds_read_b64_tr_b16 a[8:9], v47 offset:24576
    v_mfma_f32_16x16x32_bf16 v[88:91], a[100:103], v[140:143], v[88:91]
    ds_read_b64_tr_b16 a[12:13], v47 offset:36864
    s_waitcnt lgkmcnt(7)
    v_mfma_f32_16x16x32_bf16 v[96:99], a[104:107], a[104:107], v[96:99]
    ds_read_b64_tr_b16 a[16:17], v48 offset:0
    v_mfma_f32_16x16x32_bf16 v[100:103], a[104:107], a[56:59], v[100:103]
    ds_read_b64_tr_b16 a[20:21], v48 offset:12288
    s_waitcnt lgkmcnt(8)
    v_mfma_f32_16x16x32_bf16 v[96:99], a[108:111], a[108:111], v[96:99]
    ds_read_b64_tr_b16 a[24:25], v48 offset:24576
    v_mfma_f32_16x16x32_bf16 v[100:103], a[108:111], a[60:63], v[100:103]
    ds_read_b64_tr_b16 a[28:29], v48 offset:36864
    v_mfma_f32_16x16x32_bf16 v[92:95], a[104:107], v[52:55], v[92:95]
    ds_read_b64_tr_b16 a[32:33], v49 offset:0
    v_mfma_f32_16x16x32_bf16 v[88:91], a[104:107], v[144:147], v[88:91]
    ds_read_b64_tr_b16 a[36:37], v49 offset:12288
    v_mfma_f32_16x16x32_bf16 v[92:95], a[108:111], v[52:55], v[92:95]
    ds_read_b64_tr_b16 a[40:41], v49 offset:24576
    v_mfma_f32_16x16x32_bf16 v[88:91], a[108:111], v[148:151], v[88:91]
    ds_read_b64_tr_b16 a[44:45], v49 offset:36864
    s_waitcnt lgkmcnt(13)
    v_mfma_f32_16x16x32_bf16 v[96:99], a[112:115], a[112:115], v[96:99]
    v_mfma_f32_16x16x32_bf16 v[100:103], a[112:115], a[64:67], v[100:103]
    s_waitcnt lgkmcnt(12)
    v_mfma_f32_16x16x32_bf16 v[96:99], a[116:119], a[116:119], v[96:99]
    v_mfma_f32_16x16x32_bf16 v[100:103], a[116:119], a[68:71], v[100:103]
    s_waitcnt vmcnt(8)
    ds_read_b128 a[120:123], v42 offset:6144
    ds_read_b128 a[124:127], v43 offset:6144
    v_mfma_f32_16x16x32_bf16 v[92:95], a[112:115], v[52:55], v[92:95]
    v_mfma_f32_16x16x32_bf16 v[92:95], a[116:119], v[52:55], v[92:95]
    s_nop 2
    v_fma_f32 v96, v100, 2.0, v96
    v_fma_f32 v97, v101, 2.0, v97
    v_mfma_f32_16x16x32_bf16 v[88:91], a[112:115], v[152:155], v[88:91]
    v_fma_f32 v98, v102, 2.0, v98
    v_fma_f32 v99, v103, 2.0, v99
    v_mfma_f32_16x16x32_bf16 v[88:91], a[116:119], v[156:159], v[88:91]
    v_cndmask_b32 v3, 0, v96, s[44:45]
    v_cndmask_b32 v3, v3, v97, s[46:47]
    v_cndmask_b32 v3, v3, v98, s[48:49]
    v_cndmask_b32 v3, v3, v99, s[50:51]
    s_nop 0
    s_nop 0
    v_mfma_f32_16x16x4_f32 v[120:123], v3, v60, v[56:59]
    s_waitcnt lgkmcnt(1)
    v_mfma_f32_16x16x32_bf16 v[112:115], a[120:123], a[120:123], v[84:87]
    v_mfma_f32_16x16x32_bf16 v[116:119], a[120:123], a[48:51], 0
    s_waitcnt vmcnt(6)
    ds_read_b128 a[128:131], v42 offset:8192
    ds_read_b128 a[132:135], v43 offset:8192
    s_add_u32 s61, s60, 3162112
    buffer_load_dwordx4 v[224:227], v65, s[32:35], s61 offen offset:0 sc1
    s_waitcnt lgkmcnt(2)
    v_mfma_f32_16x16x32_bf16 v[112:115], a[124:127], a[124:127], v[112:115]
    v_fma_f32 v128, -v92, v92, v120
    v_fma_f32 v129, -v93, v93, v121
    v_fma_f32 v130, -v94, v94, v122
    v_mfma_f32_16x16x32_bf16 v[116:119], a[124:127], a[52:55], v[116:119]
    v_fma_f32 v131, -v95, v95, v123
    v_max_f32 v128, v128, v56
    v_max_f32 v129, v129, v56
    v_mfma_f32_16x16x32_bf16 v[108:111], a[120:123], v[52:55], v[80:83]
    v_max_f32 v130, v130, v56
    v_max_f32 v131, v131, v56
    v_mfma_f32_16x16x32_bf16 v[104:107], a[120:123], v[136:139], v[76:79]
    v_rsq_f32 v128, v128
    v_mfma_f32_16x16x32_bf16 v[108:111], a[124:127], v[52:55], v[108:111]
    v_rsq_f32 v129, v129
    v_mfma_f32_16x16x32_bf16 v[104:107], a[124:127], v[140:143], v[104:107]
    v_rsq_f32 v130, v130
    s_waitcnt lgkmcnt(1)
    v_mfma_f32_16x16x32_bf16 v[112:115], a[128:131], a[128:131], v[112:115]
    v_rsq_f32 v131, v131
    v_fma_f32 v88, -v92, v61, v88
    v_mfma_f32_16x16x32_bf16 v[116:119], a[128:131], a[56:59], v[116:119]
    v_fma_f32 v89, -v93, v61, v89
    v_fma_f32 v90, -v94, v61, v90
    v_fma_f32 v91, -v95, v61, v91
    s_waitcnt lgkmcnt(0)
    v_mfma_f32_16x16x32_bf16 v[112:115], a[132:135], a[132:135], v[112:115]
    v_fma_f32 v88, v88, v128, v62
    v_fma_f32 v89, v89, v129, v62
    v_fma_f32 v90, v90, v130, v62
    v_mfma_f32_16x16x32_bf16 v[116:119], a[132:135], a[60:63], v[116:119]
    v_fma_f32 v91, v91, v131, v62
    v_max3_f32 v1, v88, v89, v90
    v_max_f32 v1, v1, v91
    v_mfma_f32_16x16x32_bf16 v[108:111], a[128:131], v[52:55], v[108:111]
    v_cmp_lt_f32 vcc, s52, v1
    s_cbranch_vccnz L_site12
L_back12:
    v_mfma_f32_16x16x32_bf16 v[104:107], a[128:131], v[144:147], v[104:107]
    s_waitcnt vmcnt(5)
    ds_read_b128 a[136:139], v42 offset:10240
    ds_read_b128 a[140:143], v43 offset:10240
    s_barrier
    buffer_load_dwordx4 v[228:231], v65, s[32:35], s61 offen offset:1024 sc1
    s_cmp_eq_u32 s0, 1
    s_cbranch_scc0 L_nolate
    s_add_u32 s56, s60, 3145728
    buffer_load_dwordx4 v[160:163], v65, s[32:35], s56 offen offset:0 sc1
    buffer_load_dwordx4 v[164:167], v65, s[32:35], s56 offen offset:1024 sc1
    buffer_load_dwordx4 v[168:171], v65, s[32:35], s56 offen offset:2048 sc1
    buffer_load_dwordx4 v[172:175], v65, s[32:35], s56 offen offset:3072 sc1
    s_add_u32 s56, s60, 3149824
    buffer_load_dwordx4 v[176:179], v65, s[32:35], s56 offen offset:0 sc1
    buffer_load_dwordx4 v[180:183], v65, s[32:35], s56 offen offset:1024 sc1
    buffer_load_dwordx4 v[184:187], v65, s[32:35], s56 offen offset:2048 sc1
    buffer_load_dwordx4 v[188:191], v65, s[32:35], s56 offen offset:3072 sc1
L_nolate:
    buffer_load_dword v244, v28, s[32:35], s28 offen
    v_mfma_f32_16x16x32_bf16 v[108:111], a[132:135], v[52:55], v[108:111]
    ds_read_b64_tr_b16 a[2:3], v47 offset:6144
    v_exp_f32 v96, v88
    v_mfma_f32_16x16x32_bf16 v[104:107], a[132:135], v[148:151], v[104:107]
    ds_read_b64_tr_b16 a[6:7], v47 offset:18432
    v_exp_f32 v97, v89
    s_waitcnt lgkmcnt(3)
    v_mfma_f32_16x16x32_bf16 v[112:115], a[136:139], a[136:139], v[112:115]
    ds_read_b64_tr_b16 a[10:11], v47 offset:30720
    v_exp_f32 v98, v90
    v_mfma_f32_16x16x32_bf16 v[116:119], a[136:139], a[64:67], v[116:119]
    ds_read_b64_tr_b16 a[14:15], v47 offset:43008
    v_exp_f32 v99, v91
    s_waitcnt lgkmcnt(4)
    v_mfma_f32_16x16x32_bf16 v[112:115], a[140:143], a[140:143], v[112:115]
    ds_read_b64_tr_b16 a[18:19], v48 offset:6144
    v_mul_f32 v88, v96, v128
    v_mul_f32 v89, v97, v129
    v_mfma_f32_16x16x32_bf16 v[116:119], a[140:143], a[68:71], v[116:119]
    ds_read_b64_tr_b16 a[22:23], v48 offset:18432
    v_mul_f32 v90, v98, v130
    v_mul_f32 v91, v99, v131
    v_mfma_f32_16x16x32_bf16 v[108:111], a[136:139], v[52:55], v[108:111]
    ds_read_b64_tr_b16 a[26:27], v48 offset:30720
    v_add_f32 v63, v63, v96
    v_fmac_f32 v64, v88, v92
    v_mfma_f32_16x16x32_bf16 v[108:111], a[140:143], v[52:55], v[108:111]
    ds_read_b64_tr_b16 a[30:31], v48 offset:43008
    v_add_f32 v63, v63, v97
    v_fmac_f32 v64, v89, v93
    v_add_f32 v63, v63, v98
    v_fma_f32 v112, v116, 2.0, v112
    v_fma_f32 v113, v117, 2.0, v113
    v_fma_f32 v114, v118, 2.0, v114
    v_fma_f32 v115, v119, 2.0, v115
    v_cndmask_b32 v4, 0, v112, s[44:45]
    v_cndmask_b32 v4, v4, v113, s[46:47]
    v_cndmask_b32 v4, v4, v114, s[48:49]
    v_cndmask_b32 v4, v4, v115, s[50:51]
    ds_read_b64_tr_b16 a[34:35], v49 offset:6144
    ds_read_b64_tr_b16 a[38:39], v49 offset:18432
    v_mfma_f32_16x16x4_f32 v[124:127], v4, v60, v[56:59]
    ds_read_b64_tr_b16 a[42:43], v49 offset:30720
    ds_read_b64_tr_b16 a[46:47], v49 offset:43008
    v_fmac_f32 v64, v90, v94
    v_add_f32 v63, v63, v99
    v_fmac_f32 v64, v91, v95
    v_add_f32 v68, v68, v88
    v_add_f32 v69, v69, v89
    v_add_f32 v70, v70, v90
    v_add_f32 v71, v71, v91
    v_mfma_f32_16x16x32_bf16 v[104:107], a[136:139], v[152:155], v[104:107]
    v_cvt_pk_bf16_f32 v72, v88, v89
    v_cvt_pk_bf16_f32 v73, v90, v91
    v_mfma_f32_16x16x32_bf16 v[104:107], a[140:143], v[156:159], v[104:107]
    v_fma_f32 v132, -v108, v108, v124
    v_fma_f32 v133, -v109, v109, v125
    v_fma_f32 v134, -v110, v110, v126
    v_fma_f32 v135, -v111, v111, v127
    v_max_f32 v132, v132, v56
    v_max_f32 v133, v133, v56
    v_max_f32 v134, v134, v56
    v_max_f32 v135, v135, v56
    v_rsq_f32 v132, v132
    v_rsq_f32 v133, v133
    v_rsq_f32 v134, v134
    v_rsq_f32 v135, v135
    v_pk_fma_f32 v[104:105], v[108:109], v[60:61], v[104:105] op_sel:[0,1,0] neg_lo:[1,0,0] neg_hi:[1,0,0]
    v_pk_fma_f32 v[106:107], v[110:111], v[60:61], v[106:107] op_sel:[0,1,0] neg_lo:[1,0,0] neg_hi:[1,0,0]
    v_pk_fma_f32 v[104:105], v[104:105], v[132:133], v[62:63] op_sel_hi:[1,1,0]
    v_pk_fma_f32 v[106:107], v[106:107], v[134:135], v[62:63] op_sel_hi:[1,1,0]
L_back13:
    v_max3_f32 v1, v104, v105, v106
    v_max_f32 v1, v1, v107
    v_cmp_lt_f32 vcc, s52, v1
    v_exp_f32 v112, v104
    v_exp_f32 v113, v105
    v_exp_f32 v114, v106
    v_exp_f32 v115, v107
    s_cbranch_vccnz L_site13
    v_pk_mul_f32 v[104:105], v[112:113], v[132:133]
    v_pk_mul_f32 v[106:107], v[114:115], v[134:135]
    v_cvt_pk_bf16_f32 v74, v104, v105
    v_cvt_pk_bf16_f32 v75, v106, v107
    ds_write_b128 v237, v[72:75] offset:0
    v_pk_add_f32 v[68:69], v[68:69], v[104:105]
    v_pk_add_f32 v[70:71], v[70:71], v[106:107]
    v_pk_add_f32 v[112:113], v[112:113], v[114:115]
    v_cvt_pk_bf16_f32 v66, v68, v69
    v_cvt_pk_bf16_f32 v67, v70, v71
    ds_write_b64 v238, v[66:67]
    v_pk_mul_f32 v[114:115], v[104:105], v[108:109]
    v_add_f32 v63, v63, v112
    v_pk_fma_f32 v[114:115], v[106:107], v[110:111], v[114:115]
    v_add_f32 v10, v63, v113
    v_add_f32 v64, v64, v114
    v_add_f32 v11, v64, v115
    ds_write_b64 v238, v[10:11] offset:2048
L_merge:
    s_waitcnt lgkmcnt(0)
    s_barrier
L_postx:
    ds_read_b32 v9, v254 offset:4096
    ds_read_b128 v[92:95], v253 offset:0
    ds_read_b128 v[96:99], v253 offset:1024
    ds_read_b128 v[100:103], v253 offset:2048
    ds_read_b64 v[136:137], v254 offset:2048
    ds_read_b64 v[138:139], v254 offset:2560
    ds_read_b64 v[140:141], v254 offset:3072
    ds_read_b64 v[142:143], v254 offset:3584
    ds_read_b128 v[116:119], v253 offset:3072
    ds_read_b64 v[120:121], v254 offset:0
    ds_read_b64 v[122:123], v254 offset:512
    s_waitcnt lgkmcnt(10)
    v_cmp_ne_u32 vcc, 0, v9
    s_cbranch_vccnz L_xlast
    s_waitcnt lgkmcnt(9)
    v_mfma_f32_16x16x32_bf16 v[16:19], a[0:3], v[92:95], v[16:19]
    ds_read_b64 v[124:125], v254 offset:1024
    v_mfma_f32_16x16x32_bf16 v[20:23], a[16:19], v[92:95], v[20:23]
    ds_read_b64 v[126:127], v254 offset:1536
    v_mfma_f32_16x16x32_bf16 v[24:27], a[32:35], v[92:95], v[24:27]
    s_waitcnt lgkmcnt(10)
    v_mfma_f32_16x16x32_bf16 v[16:19], a[4:7], v[96:99], v[16:19]
    v_mfma_f32_16x16x32_bf16 v[20:23], a[20:23], v[96:99], v[20:23]
    v_mfma_f32_16x16x32_bf16 v[24:27], a[36:39], v[96:99], v[24:27]
    s_waitcnt lgkmcnt(9)
    v_mfma_f32_16x16x32_bf16 v[16:19], a[8:11], v[100:103], v[16:19]
    s_waitcnt lgkmcnt(5)
    v_add_f32 v1, v136, v138
    v_add_f32 v2, v137, v139
    v_add_f32 v140, v140, v142
    v_mfma_f32_16x16x32_bf16 v[20:23], a[24:27], v[100:103], v[20:23]
    v_add_f32 v141, v141, v143
    v_add_f32 v1, v1, v140
    v_add_f32 v2, v2, v141
    v_mfma_f32_16x16x32_bf16 v[24:27], a[40:43], v[100:103], v[24:27]
    s_nop 0
    v_permlane32_swap_b32 v1, v2
    v_add_f32 v1, v1, v2
    v_mov_b32 v2, v1
    s_waitcnt lgkmcnt(4)
    v_mfma_f32_16x16x32_bf16 v[16:19], a[12:15], v[116:119], v[16:19]
    v_permlane16_swap_b32 v1, v2
    v_add_f32 v1, v1, v2
    v_mov_b32 v2, v1
    s_waitcnt lgkmcnt(2)
    v_mfma_f32_16x16x32_bf16 v[16:19], a[72:75], v[120:123], v[16:19]
    v_permlane32_swap_b32 v1, v2
    v_rcp_f32 v3, v1
    s_waitcnt lgkmcnt(0)
    v_mfma_f32_16x16x32_bf16 v[16:19], a[76:79], v[124:127], v[16:19]
    v_log_f32 v4, v1
    v_mul_f32 v5, v60, v3
    v_mfma_f32_16x16x32_bf16 v[20:23], a[28:31], v[116:119], v[20:23]
    v_mul_f32 v6, v2, v3
    v_sub_f32 v4, v4, v255
    v_mfma_f32_16x16x32_bf16 v[20:23], a[80:83], v[120:123], v[20:23]
    v_mfma_f32_16x16x32_bf16 v[20:23], a[84:87], v[124:127], v[20:23]
    v_mfma_f32_16x16x32_bf16 v[24:27], a[44:47], v[116:119], v[24:27]
    v_fma_f32 v16, v16, v5, -v6
    v_fma_f32 v17, v17, v5, -v6
    v_mfma_f32_16x16x32_bf16 v[24:27], a[88:91], v[120:123], v[24:27]
    v_fma_f32 v18, v18, v5, -v6
    v_fma_f32 v19, v19, v5, -v6
    v_mfma_f32_16x16x32_bf16 v[24:27], a[92:95], v[124:127], v[24:27]
    v_cvt_pk_bf16_f32 v66, v16, v17
    v_cvt_pk_bf16_f32 v67, v18, v19
    ds_write_b64 v236, v[66:67] offset:0
    v_pk_fma_f32 v[20:21], v[20:21], v[4:5], v[6:7] op_sel:[0,1,0] op_sel_hi:[1,1,0] neg_lo:[0,0,1] neg_hi:[0,0,1]
    v_pk_fma_f32 v[22:23], v[22:23], v[4:5], v[6:7] op_sel:[0,1,0] op_sel_hi:[1,1,0] neg_lo:[0,0,1] neg_hi:[0,0,1]
    v_cvt_pk_bf16_f32 v68, v20, v21
    v_cvt_pk_bf16_f32 v69, v22, v23
    ds_write_b64 v236, v[68:69] offset:512
    v_pk_fma_f32 v[24:25], v[24:25], v[4:5], v[6:7] op_sel:[0,1,0] op_sel_hi:[1,1,0] neg_lo:[0,0,1] neg_hi:[0,0,1]
    v_pk_fma_f32 v[26:27], v[26:27], v[4:5], v[6:7] op_sel:[0,1,0] op_sel_hi:[1,1,0] neg_lo:[0,0,1] neg_hi:[0,0,1]
    v_cvt_pk_bf16_f32 v70, v24, v25
    v_cvt_pk_bf16_f32 v71, v26, v27
    ds_write_b64 v236, v[70:71] offset:1024
    s_waitcnt lgkmcnt(0)
    s_barrier
    ds_read_b128 v[136:139], v241 offset:0
    ds_read_b128 v[140:143], v241 offset:1024
    ds_read_b128 v[144:147], v241 offset:2048
    ds_read_b128 v[148:151], v241 offset:3072
    ds_read_b128 v[152:155], v241 offset:4096
    ds_read_b128 v[156:159], v241 offset:5120
    s_waitcnt vmcnt(1)
    v_subrev_u32 v35, s39, v4
    v_add_u32 v39, s39, v4
    s_waitcnt lgkmcnt(5)
    v_mfma_f32_16x16x32_bf16 v[16:19], v[160:163], v[136:139], 0
    v_mfma_f32_16x16x32_bf16 v[20:23], v[184:187], v[136:139], 0
    v_mfma_f32_16x16x32_bf16 v[24:27], v[208:211], v[136:139], 0
    s_waitcnt lgkmcnt(4)
    v_mfma_f32_16x16x32_bf16 v[16:19], v[164:167], v[140:143], v[16:19]
    v_mfma_f32_16x16x32_bf16 v[20:23], v[188:191], v[140:143], v[20:23]
    v_mfma_f32_16x16x32_bf16 v[24:27], v[212:215], v[140:143], v[24:27]
    s_waitcnt lgkmcnt(3)
    v_mfma_f32_16x16x32_bf16 v[16:19], v[168:171], v[144:147], v[16:19]
    v_mfma_f32_16x16x32_bf16 v[20:23], v[192:195], v[144:147], v[20:23]
    v_mfma_f32_16x16x32_bf16 v[24:27], v[216:219], v[144:147], v[24:27]
    s_waitcnt lgkmcnt(2)
    v_mfma_f32_16x16x32_bf16 v[16:19], v[172:175], v[148:151], v[16:19]
    s_waitcnt lgkmcnt(1)
    v_mfma_f32_16x16x32_bf16 v[16:19], v[176:179], v[152:155], v[16:19]
    s_waitcnt lgkmcnt(0)
    v_mfma_f32_16x16x32_bf16 v[16:19], v[180:183], v[156:159], v[16:19]
    v_mfma_f32_16x16x32_bf16 v[20:23], v[196:199], v[148:151], v[20:23]
    v_mfma_f32_16x16x32_bf16 v[20:23], v[200:203], v[152:155], v[20:23]
    v_mfma_f32_16x16x32_bf16 v[20:23], v[204:207], v[156:159], v[20:23]
    v_mfma_f32_16x16x32_bf16 v[24:27], v[220:223], v[148:151], v[24:27]
    v_mfma_f32_16x16x32_bf16 v[24:27], v[224:227], v[152:155], v[24:27]
    s_nop 2
    v_cvt_pk_bf16_f32 v32, v16, v17
    v_mfma_f32_16x16x32_bf16 v[24:27], v[228:231], v[156:159], v[24:27]
    v_cvt_pk_bf16_f32 v33, v18, v19
    v_cvt_pk_bf16_f32 v34, v20, v21
    v_cvt_pk_bf16_f32 v36, v22, v23
    v_permlane16_swap_b32 v35, v39
    s_nop 0
    v_permlane16_swap_b32 v32, v36
    s_nop 1
    v_cvt_pk_bf16_f32 v37, v24, v25
    v_cvt_pk_bf16_f32 v38, v26, v27
    s_nop 0
    v_permlane16_swap_b32 v33, v37
    v_permlane16_swap_b32 v34, v38
    buffer_store_dwordx4 v[32:35], v242, s[32:35], s28 offen sc1
    buffer_store_dwordx4 v[36:39], v243, s[32:35], s28 offen sc1
    s_cmp_lt_u32 s29, 64
    s_cbranch_scc0 L_fin
    buffer_load_dwordx4 v[76:79], v65, s[32:35], s30 offen offset:0 sc1
    buffer_load_dwordx4 v[80:83], v65, s[32:35], s30 offen offset:1024 sc1
    buffer_load_dwordx4 v[84:87], v65, s[32:35], s30 offen offset:2048 sc1
    buffer_load_dwordx4 v[108:111], v65, s[32:35], s30 offen offset:3072 sc1
    buffer_load_dwordx4 v[112:115], v65, s[32:35], s31 offen offset:0 sc1
    buffer_load_dwordx4 v[128:131], v65, s[32:35], s31 offen offset:1024 sc1
    buffer_load_dwordx4 v[132:135], v65, s[32:35], s31 offen offset:2048 sc1
    buffer_load_dwordx4 v[52:55], v65, s[32:35], s31 offen offset:3072 sc1
    ds_bpermute_b32 v42, v252, v4
    v_bfe_u32 v48, v0, 2, 1
    v_cmp_eq_u32 vcc, 1, v48
    v_mov_b32 v246, s39
    s_movk_i32 s26, 0x101
    v_sub_u32 v247, 0, v246
    v_cndmask_b32 v247, v247, v246, vcc
    v_mul_lo_u32 v246, v247, -2
    v_mov_b32 v16, 0
    v_mov_b32 v17, 0
    v_mov_b32 v18, 0
    v_mov_b32 v19, 0
    v_mov_b32 v20, 0
    v_mov_b32 v21, 0
    v_mov_b32 v22, 0
    v_mov_b32 v97, 0
    s_mov_b32 s53, 0
    v_mov_b32 v160, 0x101
    v_mov_b32 v161, 0x202
    v_mov_b32 v162, 0x404
    v_mov_b32 v163, 0x808
    v_mov_b32 v164, 0x1010
    v_mov_b32 v165, 0x2020
    v_mov_b32 v166, 0x4040
    v_mov_b32 v167, 0x8080
    s_waitcnt vmcnt(0)
    v_sub_u32_dpp v136, v79, v79 row_half_mirror row_mask:0xf bank_mask:0xf
    v_sub_u32_dpp v137, v83, v83 row_half_mirror row_mask:0xf bank_mask:0xf
    v_sub_u32_dpp v138, v87, v87 row_half_mirror row_mask:0xf bank_mask:0xf
    v_sub_u32_dpp v139, v111, v111 row_half_mirror row_mask:0xf bank_mask:0xf
    v_sub_u32_dpp v140, v115, v115 row_half_mirror row_mask:0xf bank_mask:0xf
    v_sub_u32_dpp v141, v131, v131 row_half_mirror row_mask:0xf bank_mask:0xf
    v_sub_u32_dpp v142, v135, v135 row_half_mirror row_mask:0xf bank_mask:0xf
    v_sub_u32_dpp v143, v55, v55 row_half_mirror row_mask:0xf bank_mask:0xf
    v_cmp_eq_u32 s[6:7], v136, v246
    v_cmp_eq_u32 s[8:9], v137, v246
    v_cmp_eq_u32 s[10:11], v138, v246
    v_cmp_eq_u32 s[12:13], v139, v246
    v_cmp_eq_u32 s[14:15], v140, v246
    v_cmp_eq_u32 s[16:17], v141, v246
    v_cmp_eq_u32 s[36:37], v142, v246
    v_cmp_eq_u32 s[40:41], v143, v246
    v_cndmask_b32 v136, v160, 0, s[6:7]
    v_cndmask_b32 v137, v161, 0, s[8:9]
    v_cndmask_b32 v138, v162, 0, s[10:11]
    v_cndmask_b32 v139, v163, 0, s[12:13]
    v_cndmask_b32 v140, v164, 0, s[14:15]
    v_cndmask_b32 v141, v165, 0, s[16:17]
    v_cndmask_b32 v142, v166, 0, s[36:37]
    v_cndmask_b32 v143, v167, 0, s[40:41]
    v_or3_b32 v96, v136, v137, v138
    v_or3_b32 v139, v139, v140, v141
    v_or3_b32 v96, v96, v142, v143
    v_or_b32 v96, v96, v139
    v_cmp_ne_u32 vcc, 0, v96
    v_sub_u32 v168, v79, v247
    v_sub_u32 v169, v83, v247
    v_sub_u32 v170, v87, v247
    v_sub_u32 v171, v111, v247
    s_cbranch_vccz L_c_all
    v_lshrrev_b32 v48, v97, v96
    v_ffbl_b32 v48, v48
    v_add_u32 v48, v48, v97
    v_and_b32 v48, 7, v48
    v_lshl_add_u32 v51, v48, 10, v65
    v_lshlrev_b32 v88, v48, s26
    v_add_u32 v97, 1, v48
    s_mov_b64 exec, vcc
    buffer_load_dwordx4 v[136:139], v51, s[32:35], s30 offen sc1
    s_mov_b64 exec, -1
    v_lshrrev_b32 v48, v97, v96
    v_ffbl_b32 v48, v48
    v_add_u32 v48, v48, v97
    v_and_b32 v48, 7, v48
    v_lshl_add_u32 v51, v48, 10, v65
    v_lshlrev_b32 v89, v48, s26
    v_add_u32 v97, 1, v48
    s_mov_b64 exec, vcc
    buffer_load_dwordx4 v[140:143], v51, s[32:35], s30 offen sc1
    s_mov_b64 exec, -1
    v_lshrrev_b32 v48, v97, v96
    v_ffbl_b32 v48, v48
    v_add_u32 v48, v48, v97
    v_and_b32 v48, 7, v48
    v_lshl_add_u32 v51, v48, 10, v65
    v_lshlrev_b32 v90, v48, s26
    v_add_u32 v97, 1, v48
    s_mov_b64 exec, vcc
    buffer_load_dwordx4 v[144:147], v51, s[32:35], s30 offen sc1
    s_mov_b64 exec, -1
    v_lshrrev_b32 v48, v97, v96
    v_ffbl_b32 v48, v48
    v_add_u32 v48, v48, v97
    v_and_b32 v48, 7, v48
    v_lshl_add_u32 v51, v48, 10, v65
    v_lshlrev_b32 v91, v48, s26
    v_add_u32 v97, 1, v48
    s_mov_b64 exec, vcc
    buffer_load_dwordx4 v[148:151], v51, s[32:35], s30 offen sc1
    s_mov_b64 exec, -1
L_c_all:
    v_sub_u32 v172, v115, v247
    v_sub_u32 v173, v131, v247
    v_sub_u32 v174, v135, v247
    v_sub_u32 v175, v55, v247
    s_waitcnt lgkmcnt(0)
    v_sub_f32 v168, v168, v42
    v_sub_f32 v169, v169, v42
    v_sub_f32 v170, v170, v42
    v_sub_f32 v171, v171, v42
    v_sub_f32 v172, v172, v42
    v_sub_f32 v173, v173, v42
    v_sub_f32 v174, v174, v42
    v_sub_f32 v175, v175, v42
    v_exp_f32 v168, v168
    v_exp_f32 v169, v169
    v_exp_f32 v170, v170
    v_exp_f32 v171, v171
    v_exp_f32 v172, v172
    v_exp_f32 v173, v173
    v_exp_f32 v174, v174
    v_exp_f32 v175, v175
    v_cvt_pk_bf16_f32 v168, v168, 0
    v_cvt_pk_bf16_f32 v169, v169, 0
    v_cvt_pk_bf16_f32 v170, v170, 0
    v_cvt_pk_bf16_f32 v171, v171, 0
    v_cvt_pk_bf16_f32 v172, v172, 0
    v_cvt_pk_bf16_f32 v173, v173, 0
    v_cvt_pk_bf16_f32 v174, v174, 0
    v_cvt_pk_bf16_f32 v175, v175, 0
    v_lshlrev_b32 v176, 16, v168
    v_lshlrev_b32 v177, 16, v169
    v_lshlrev_b32 v178, 16, v170
    v_lshlrev_b32 v179, 16, v171
    v_lshlrev_b32 v180, 16, v172
    v_lshlrev_b32 v181, 16, v173
    v_lshlrev_b32 v182, 16, v174
    v_lshlrev_b32 v183, 16, v175
    s_mov_b64 exec, s[6:7]
    v_dot2c_f32_bf16 v16, v76, v168
    v_dot2c_f32_bf16 v18, v77, v168
    v_dot2c_f32_bf16 v20, v78, v168
    v_add_f32 v22, v22, v176
    v_dot2c_f32_bf16 v17, v76, v176
    v_dot2c_f32_bf16 v19, v77, v176
    v_dot2c_f32_bf16 v21, v78, v176
    s_mov_b64 exec, s[8:9]
    v_dot2c_f32_bf16 v16, v80, v169
    v_dot2c_f32_bf16 v18, v81, v169
    v_dot2c_f32_bf16 v20, v82, v169
    v_add_f32 v22, v22, v177
    v_dot2c_f32_bf16 v17, v80, v177
    v_dot2c_f32_bf16 v19, v81, v177
    v_dot2c_f32_bf16 v21, v82, v177
    s_mov_b64 exec, s[10:11]
    v_dot2c_f32_bf16 v16, v84, v170
    v_dot2c_f32_bf16 v18, v85, v170
    v_dot2c_f32_bf16 v20, v86, v170
    v_add_f32 v22, v22, v178
    v_dot2c_f32_bf16 v17, v84, v178
    v_dot2c_f32_bf16 v19, v85, v178
    v_dot2c_f32_bf16 v21, v86, v178
    s_mov_b64 exec, s[12:13]
    v_dot2c_f32_bf16 v16, v108, v171
    v_dot2c_f32_bf16 v18, v109, v171
    v_dot2c_f32_bf16 v20, v110, v171
    v_add_f32 v22, v22, v179
    v_dot2c_f32_bf16 v17, v108, v179
    v_dot2c_f32_bf16 v19, v109, v179
    v_dot2c_f32_bf16 v21, v110, v179
    s_mov_b64 exec, s[14:15]
    v_dot2c_f32_bf16 v16, v112, v172
    v_dot2c_f32_bf16 v18, v113, v172
    v_dot2c_f32_bf16 v20, v114, v172
    v_add_f32 v22, v22, v180
    v_dot2c_f32_bf16 v17, v112, v180
    v_dot2c_f32_bf16 v19, v113, v180
    v_dot2c_f32_bf16 v21, v114, v180
    s_mov_b64 exec, s[16:17]
    v_dot2c_f32_bf16 v16, v128, v173
    v_dot2c_f32_bf16 v18, v129, v173
    v_dot2c_f32_bf16 v20, v130, v173
    v_add_f32 v22, v22, v181
    v_dot2c_f32_bf16 v17, v128, v181
    v_dot2c_f32_bf16 v19, v129, v181
    v_dot2c_f32_bf16 v21, v130, v181
    s_mov_b64 exec, s[36:37]
    v_dot2c_f32_bf16 v16, v132, v174
    v_dot2c_f32_bf16 v18, v133, v174
    v_dot2c_f32_bf16 v20, v134, v174
    v_add_f32 v22, v22, v182
    v_dot2c_f32_bf16 v17, v132, v182
    v_dot2c_f32_bf16 v19, v133, v182
    v_dot2c_f32_bf16 v21, v134, v182
    s_mov_b64 exec, s[40:41]
    v_dot2c_f32_bf16 v16, v52, v175
    v_dot2c_f32_bf16 v18, v53, v175
    v_dot2c_f32_bf16 v20, v54, v175
    v_add_f32 v22, v22, v183
    v_dot2c_f32_bf16 v17, v52, v183
    v_dot2c_f32_bf16 v19, v53, v183
    v_dot2c_f32_bf16 v21, v54, v183
    s_mov_b64 exec, -1
    s_cbranch_vccz L_c_red
L_c_loop:
    s_waitcnt vmcnt(3)
    v_sub_u32_dpp v48, v139, v139 row_half_mirror row_mask:0xf bank_mask:0xf
    v_and_b32 v49, v88, v96
    v_cmpx_eq_u32 vcc, v48, v246
    v_cmpx_ne_u32 vcc, 0, v49
    v_xor_b32 v96, v96, v88
    v_sub_u32 v49, v139, v247
    v_sub_f32 v49, v49, v42
    v_exp_f32 v49, v49
    s_cbranch_execz L_c_s0
    v_cvt_pk_bf16_f32 v49, v49, 0
    v_lshlrev_b32 v50, 16, v49
    v_dot2c_f32_bf16 v16, v136, v49
    v_dot2c_f32_bf16 v18, v137, v49
    v_dot2c_f32_bf16 v20, v138, v49
    v_add_f32 v22, v22, v50
    v_dot2c_f32_bf16 v17, v136, v50
    v_dot2c_f32_bf16 v19, v137, v50
    v_dot2c_f32_bf16 v21, v138, v50
L_c_s0:
    s_mov_b64 exec, -1
    v_cmp_ne_u32 vcc, 0, v96
    v_lshrrev_b32 v48, v97, v96
    v_ffbl_b32 v48, v48
    s_cbranch_vccz L_c_red
    v_add_u32 v48, v48, v97
    v_and_b32 v48, 7, v48
    v_lshl_add_u32 v51, v48, 10, v65
    v_lshlrev_b32 v88, v48, s26
    v_add_u32 v97, 1, v48
    s_mov_b64 exec, vcc
    buffer_load_dwordx4 v[136:139], v51, s[32:35], s30 offen sc1
    s_mov_b64 exec, -1
    s_waitcnt vmcnt(3)
    v_sub_u32_dpp v48, v143, v143 row_half_mirror row_mask:0xf bank_mask:0xf
    v_and_b32 v49, v89, v96
    v_cmpx_eq_u32 vcc, v48, v246
    v_cmpx_ne_u32 vcc, 0, v49
    v_xor_b32 v96, v96, v89
    v_sub_u32 v49, v143, v247
    v_sub_f32 v49, v49, v42
    v_exp_f32 v49, v49
    s_cbranch_execz L_c_s1
    v_cvt_pk_bf16_f32 v49, v49, 0
    v_lshlrev_b32 v50, 16, v49
    v_dot2c_f32_bf16 v16, v140, v49
    v_dot2c_f32_bf16 v18, v141, v49
    v_dot2c_f32_bf16 v20, v142, v49
    v_add_f32 v22, v22, v50
    v_dot2c_f32_bf16 v17, v140, v50
    v_dot2c_f32_bf16 v19, v141, v50
    v_dot2c_f32_bf16 v21, v142, v50
L_c_s1:
    s_mov_b64 exec, -1
    v_cmp_ne_u32 vcc, 0, v96
    v_lshrrev_b32 v48, v97, v96
    v_ffbl_b32 v48, v48
    s_cbranch_vccz L_c_red
    v_add_u32 v48, v48, v97
    v_and_b32 v48, 7, v48
    v_lshl_add_u32 v51, v48, 10, v65
    v_lshlrev_b32 v89, v48, s26
    v_add_u32 v97, 1, v48
    s_mov_b64 exec, vcc
    buffer_load_dwordx4 v[140:143], v51, s[32:35], s30 offen sc1
    s_mov_b64 exec, -1
    s_waitcnt vmcnt(3)
    v_sub_u32_dpp v48, v147, v147 row_half_mirror row_mask:0xf bank_mask:0xf
    v_and_b32 v49, v90, v96
    v_cmpx_eq_u32 vcc, v48, v246
    v_cmpx_ne_u32 vcc, 0, v49
    v_xor_b32 v96, v96, v90
    v_sub_u32 v49, v147, v247
    v_sub_f32 v49, v49, v42
    v_exp_f32 v49, v49
    s_cbranch_execz L_c_s2
    v_cvt_pk_bf16_f32 v49, v49, 0
    v_lshlrev_b32 v50, 16, v49
    v_dot2c_f32_bf16 v16, v144, v49
    v_dot2c_f32_bf16 v18, v145, v49
    v_dot2c_f32_bf16 v20, v146, v49
    v_add_f32 v22, v22, v50
    v_dot2c_f32_bf16 v17, v144, v50
    v_dot2c_f32_bf16 v19, v145, v50
    v_dot2c_f32_bf16 v21, v146, v50
L_c_s2:
    s_mov_b64 exec, -1
    v_cmp_ne_u32 vcc, 0, v96
    v_lshrrev_b32 v48, v97, v96
    v_ffbl_b32 v48, v48
    s_cbranch_vccz L_c_red
    v_add_u32 v48, v48, v97
    v_and_b32 v48, 7, v48
    v_lshl_add_u32 v51, v48, 10, v65
    v_lshlrev_b32 v90, v48, s26
    v_add_u32 v97, 1, v48
    s_mov_b64 exec, vcc
    buffer_load_dwordx4 v[144:147], v51, s[32:35], s30 offen sc1
    s_mov_b64 exec, -1
    s_waitcnt vmcnt(3)
    v_sub_u32_dpp v48, v151, v151 row_half_mirror row_mask:0xf bank_mask:0xf
    v_and_b32 v49, v91, v96
    v_cmpx_eq_u32 vcc, v48, v246
    v_cmpx_ne_u32 vcc, 0, v49
    v_xor_b32 v96, v96, v91
    v_sub_u32 v49, v151, v247
    v_sub_f32 v49, v49, v42
    v_exp_f32 v49, v49
    s_cbranch_execz L_c_s3
    v_cvt_pk_bf16_f32 v49, v49, 0
    v_lshlrev_b32 v50, 16, v49
    v_dot2c_f32_bf16 v16, v148, v49
    v_dot2c_f32_bf16 v18, v149, v49
    v_dot2c_f32_bf16 v20, v150, v49
    v_add_f32 v22, v22, v50
    v_dot2c_f32_bf16 v17, v148, v50
    v_dot2c_f32_bf16 v19, v149, v50
    v_dot2c_f32_bf16 v21, v150, v50
L_c_s3:
    s_mov_b64 exec, -1
    v_cmp_ne_u32 vcc, 0, v96
    v_lshrrev_b32 v48, v97, v96
    v_ffbl_b32 v48, v48
    s_cbranch_vccz L_c_red
    v_add_u32 v48, v48, v97
    v_and_b32 v48, 7, v48
    v_lshl_add_u32 v51, v48, 10, v65
    v_lshlrev_b32 v91, v48, s26
    v_add_u32 v97, 1, v48
    s_mov_b64 exec, vcc
    buffer_load_dwordx4 v[148:151], v51, s[32:35], s30 offen sc1
    s_mov_b64 exec, -1
    s_add_u32 s53, s53, 1
    s_cmp_lt_u32 s53, 65536
    s_cbranch_scc1 L_c_loop
L_c_red:
    v_mov_b32 v23, v22
    v_permlane32_swap_b32 v16, v20
    v_permlane32_swap_b32 v17, v21
    v_permlane32_swap_b32 v18, v22
    v_permlane32_swap_b32 v19, v23
    v_add_f32 v16, v16, v20
    v_add_f32 v17, v17, v21
    v_add_f32 v18, v18, v22
    v_add_f32 v19, v19, v23
    s_nop 0
    v_permlane16_swap_b32 v16, v18
    v_permlane16_swap_b32 v17, v19
    v_add_f32 v16, v16, v18
    v_add_f32 v17, v17, v19
    s_nop 0
    v_add_f32_dpp v48, v16, v16 row_ror:8 row_mask:0xf bank_mask:0x3
    s_nop 1
    v_add_f32_dpp v48, v17, v17 row_ror:8 row_mask:0xf bank_mask:0xc
    ds_write_b32 v250, v48
    s_waitcnt lgkmcnt(0)
    s_barrier
    ds_read_b128 v[48:51], v251 offset:768
    ds_read_b128 v[52:55], v65
    v_lshlrev_b32 v18, 16, v249
    s_waitcnt lgkmcnt(1)
    v_add_f32 v48, v48, v49
    v_add_f32 v50, v50, v51
    v_add_f32 v48, v48, v50
    v_cmp_nlt_f32 vcc, v48, v232
    v_rcp_f32 v48, v48
    s_waitcnt lgkmcnt(0)
    s_cbranch_vccnz L_c_slow
L_c_out:
    s_cmp_lg_u32 s3, 0
    s_cbranch_scc1 L_fin
    v_add_f32 v52, v52, v53
    v_add_f32 v54, v54, v55
    v_add_f32 v52, v52, v54
    v_fmac_f32 v18, v52, v48
    v_cvt_pk_bf16_f32 v18, v18, v18
    buffer_store_short v18, v248, s[68:71], 0 offen sc1
    s_cmp_lg_u32 s29, 0
    s_cbranch_scc1 L_fin
    v_mov_b32 v48, s39
    v_mov_b32 v49, 0
    s_mov_b64 exec, 1
    buffer_store_dword v48, v49, s[32:35], 0 offen offset:0 sc1
    s_mov_b64 exec, -1
L_fin:
L_end:
    s_endpgm
L_hot:
L_prod:
    s_cmp_lg_u32 s3, 0
    s_cbranch_scc1 L_p_noq
    s_mov_b32 m0, 147456
    s_nop 0
    buffer_load_dwordx4 v16, s[72:75], 0 offen offset:0  lds
    buffer_load_dwordx4 v17, s[72:75], 0 offen offset:1024  lds
    buffer_load_dwordx4 v18, s[72:75], 0 offen offset:2048  lds
    buffer_load_dwordx4 v19, s[72:75], 0 offen offset:3072  lds
    s_mov_b32 m0, 151552
    s_nop 0
    buffer_load_dwordx4 v20, s[72:75], 0 offen offset:0  lds
    buffer_load_dwordx4 v21, s[72:75], 0 offen offset:1024  lds
L_p_noq:
    s_mul_i32 s60, s3, 18432
    s_add_u32 m0, s60, 73728
    s_nop 0
    buffer_load_dwordx4 v16, s[64:67], s60 offen offset:0  lds
    buffer_load_dwordx4 v17, s[64:67], s60 offen offset:1024  lds
    buffer_load_dwordx4 v18, s[64:67], s60 offen offset:2048  lds
    buffer_load_dwordx4 v19, s[64:67], s60 offen offset:3072  lds
    s_add_u32 m0, s60, 77824
    s_nop 0
    buffer_load_dwordx4 v20, s[64:67], s60 offen offset:0  lds
    buffer_load_dwordx4 v21, s[64:67], s60 offen offset:1024  lds
    s_add_u32 s60, s60, 6144
    s_add_u32 m0, s60, 73728
    s_nop 0
    buffer_load_dwordx4 v16, s[64:67], s60 offen offset:0  lds
    buffer_load_dwordx4 v17, s[64:67], s60 offen offset:1024  lds
    buffer_load_dwordx4 v18, s[64:67], s60 offen offset:2048  lds
    buffer_load_dwordx4 v19, s[64:67], s60 offen offset:3072  lds
    s_add_u32 m0, s60, 77824
    s_nop 0
    buffer_load_dwordx4 v20, s[64:67], s60 offen offset:0  lds
    buffer_load_dwordx4 v21, s[64:67], s60 offen offset:1024  lds
    s_add_u32 s60, s60, 6144
    s_add_u32 m0, s60, 73728
    s_nop 0
    buffer_load_dwordx4 v16, s[64:67], s60 offen offset:0  lds
    v_mov_b32 v52, 0x3f803f80
    v_mov_b32 v56, 0x3ebcbe62
    s_mov_b32 s44, 0x100001
    s_mov_b32 s45, 0x10000100
    v_mov_b32 v53, 0x3f803f80
    v_mov_b32 v57, 0x3ebcbe62
    s_mov_b32 s46, 0x200002
    buffer_load_dwordx4 v17, s[64:67], s60 offen offset:1024  lds
    s_mov_b32 s47, 0x20000200
    v_mov_b32 v54, 0x3f803f80
    v_mov_b32 v58, 0x3ebcbe62
    s_mov_b32 s48, 0x400004
    s_mov_b32 s49, 0x40000400
    v_mov_b32 v55, 0x3f803f80
    v_mov_b32 v59, 0x3ebcbe62
    buffer_load_dwordx4 v18, s[64:67], s60 offen offset:2048  lds
    s_mov_b32 s50, 0x800008
    s_mov_b32 s51, 0x80000800
    v_mov_b32 v60, 0x43400000
    v_lshrrev_b32 v1, 5, v0
    v_lshlrev_b32 v1, 8, v1
    v_and_b32 v2, 15, v0
    v_lshl_add_u32 v1, v2, 4, v1
    buffer_load_dwordx4 v19, s[64:67], s60 offen offset:3072  lds
    v_bfe_u32 v2, v0, 4, 1
    v_lshl_add_u32 v1, v2, 3, v1
    s_mul_i32 s56, s3, 1536
    s_add_u32 s56, s56, 153600
    v_add_u32 v134, s56, v1
    v_bfe_u32 v1, v0, 4, 1
    v_lshrrev_b32 v5, 5, v0
    s_add_u32 m0, s60, 77824
    s_nop 0
    buffer_load_dwordx4 v20, s[64:67], s60 offen offset:0  lds
    v_lshl_or_b32 v1, v1, 1, v5
    v_bfe_u32 v2, v0, 2, 2
    v_lshl_add_u32 v3, v1, 3, v2
    v_mul_u32_u24 v3, 384, v3
    v_and_b32 v4, 1, v0
    v_lshl_add_u32 v3, v4, 3, v3
    v_add_u32 v3, 73728, v3
    buffer_load_dwordx4 v21, s[64:67], s60 offen offset:1024  lds
    v_and_or_b32 v2, v2, 2, v5
    v_bfe_u32 v4, v0, 1, 1
    v_xor_b32 v2, v2, v4
    s_mul_i32 s56, s3, 6
    s_add_u32 s57, s56, 0
    v_xor_b32 v4, s57, v2
    v_lshl_add_u32 v124, v4, 4, v3
    s_lshl_b32 s61, s43, 2
    s_add_u32 s61, s61, s3
    s_mul_i32 s60, s61, 6144
    s_add_u32 m0, s41, 6144
    s_nop 0
    buffer_load_dwordx4 v16, s[68:71], s60 offen offset:0  lds
    v_xor_b32 v125, 64, v124
    s_add_u32 s57, s56, 2
    v_xor_b32 v4, s57, v2
    v_lshl_add_u32 v126, v4, 4, v3
    v_xor_b32 v127, 64, v126
    s_add_u32 s57, s56, 4
    v_xor_b32 v4, s57, v2
    buffer_load_dwordx4 v17, s[68:71], s60 offen offset:1024  lds
    v_lshl_add_u32 v128, v4, 4, v3
    v_xor_b32 v129, 64, v128
    v_and_b32 v2, 15, v0
    v_bfe_u32 v3, v0, 3, 1
    v_and_or_b32 v4, v0, 6, v3
    v_xor_b32 v4, v4, v1
    v_mul_u32_u24 v2, 384, v2
    buffer_load_dwordx4 v18, s[68:71], s60 offen offset:2048  lds
    v_lshl_add_u32 v2, v4, 4, v2
    v_add_u32 v132, 147456, v2
    v_xor_b32 v133, 64, v132
    s_and_b32 s56, s3, 1
    s_lshl_b32 s56, s56, 2
    s_lshr_b32 s57, s3, 1
    s_mul_i32 s57, s57, 24576
    buffer_load_dwordx4 v19, s[68:71], s60 offen offset:3072  lds
    s_add_u32 s57, s57, 30720
    v_and_b32 v1, 11, v0
    v_or_b32 v1, s56, v1
    v_and_or_b32 v2, v1, 6, v3
    v_lshrrev_b32 v3, 4, v0
    v_xor_b32 v2, v2, v3
    v_mul_u32_u24 v1, 384, v1
    s_add_u32 m0, s41, 10240
    s_nop 0
    buffer_load_dwordx4 v20, s[68:71], s60 offen offset:0  lds
    v_lshl_add_u32 v1, v2, 4, v1
    v_bfe_u32 v2, v0, 2, 1
    v_mul_u32_u24 v2, 12288, v2
    v_add3_u32 v130, s57, v1, v2
    v_xor_b32 v131, 64, v130
    v_add_u32 v135, 153600, v65
    buffer_load_dwordx4 v21, s[68:71], s60 offen offset:1024  lds
    s_waitcnt vmcnt(24)
    s_barrier
    s_load_dword s38, s[22:23], 0
    ds_read_b128 v[136:139], v132 offset:0
    ds_read_b128 v[140:143], v133 offset:0
    ds_read_b128 v[144:147], v132 offset:128
    ds_read_b128 v[148:151], v133 offset:128
    ds_read_b128 v[152:155], v132 offset:256
    ds_read_b128 v[156:159], v133 offset:256
    s_add_u32 m0, s40, 0
    s_add_u32 s57, s36, 0
    buffer_load_dwordx4 v16, s[28:31], s57 offen offset:0 nt lds
    buffer_load_dwordx4 v17, s[28:31], s57 offen offset:1024 nt lds
    buffer_load_dwordx4 v18, s[28:31], s57 offen offset:2048 nt lds
    buffer_load_dwordx4 v19, s[28:31], s57 offen offset:3072 nt lds
    s_add_u32 m0, s40, 4096
    s_nop 0
    buffer_load_dwordx4 v20, s[28:31], s57 offen offset:0 nt lds
    buffer_load_dwordx4 v21, s[28:31], s57 offen offset:1024 nt lds
    s_waitcnt lgkmcnt(0)
    v_mfma_f32_16x16x32_bf16 v[112:115], v[136:139], v[136:139], 0
    v_mfma_f32_16x16x32_bf16 v[116:119], v[52:55], v[136:139], 0
    s_add_u32 m0, s41, 0
    s_add_u32 s58, s37, 0
    buffer_load_dwordx4 v22, s[24:27], s58 offen offset:0 nt lds
    v_mfma_f32_16x16x32_bf16 v[112:115], v[140:143], v[140:143], v[112:115]
    v_mfma_f32_16x16x32_bf16 v[116:119], v[52:55], v[140:143], v[116:119]
    buffer_load_dwordx4 v23, s[24:27], s58 offen offset:1024 nt lds
    v_mfma_f32_16x16x32_bf16 v[112:115], v[144:147], v[144:147], v[112:115]
    v_mfma_f32_16x16x32_bf16 v[116:119], v[52:55], v[144:147], v[116:119]
    buffer_load_dwordx4 v24, s[24:27], s58 offen offset:2048 nt lds
    v_mfma_f32_16x16x32_bf16 v[112:115], v[148:151], v[148:151], v[112:115]
    v_mfma_f32_16x16x32_bf16 v[116:119], v[52:55], v[148:151], v[116:119]
    v_mfma_f32_16x16x32_bf16 v[112:115], v[152:155], v[152:155], v[112:115]
    v_mfma_f32_16x16x32_bf16 v[116:119], v[52:55], v[152:155], v[116:119]
    v_mfma_f32_16x16x32_bf16 v[112:115], v[156:159], v[156:159], v[112:115]
    v_mfma_f32_16x16x32_bf16 v[116:119], v[52:55], v[156:159], v[116:119]
    s_mul_i32 s39, s38, 0x9e3779b1
    s_add_u32 s39, s39, 0x7f4a7c16
    s_or_b32 s39, s39, 1
    s_lshl_b32 s61, s61, 10
    s_add_u32 s61, s61, 16384
    s_waitcnt vmcnt(15)
    s_barrier
    ds_read_b64_tr_b16 v[160:161], v124 offset:0
    ds_read_b64_tr_b16 v[162:163], v125 offset:1536
    ds_read_b64_tr_b16 v[184:185], v126 offset:0
    ds_read_b64_tr_b16 v[186:187], v127 offset:1536
    ds_read_b64_tr_b16 v[208:209], v128 offset:0
    ds_read_b64_tr_b16 v[210:211], v129 offset:1536
    ds_read_b64_tr_b16 v[164:165], v124 offset:12288
    ds_read_b64_tr_b16 v[166:167], v125 offset:13824
    ds_read_b64_tr_b16 v[188:189], v126 offset:12288
    ds_read_b64_tr_b16 v[190:191], v127 offset:13824
    ds_read_b64_tr_b16 v[212:213], v128 offset:12288
    ds_read_b64_tr_b16 v[214:215], v129 offset:13824
    v_cndmask_b32 v3, 0, v112, s[44:45]
    v_cndmask_b32 v3, v3, v113, s[46:47]
    v_cndmask_b32 v3, v3, v114, s[48:49]
    v_cndmask_b32 v3, v3, v115, s[50:51]
    v_mul_f32 v6, 0x3baaaaab, v116
    ds_read_b64_tr_b16 v[168:169], v124 offset:24576
    ds_read_b64_tr_b16 v[170:171], v125 offset:26112
    v_mfma_f32_16x16x4_f32 v[120:123], v60, v3, v[56:59]
    s_waitcnt lgkmcnt(12)
    v_mfma_f32_16x16x32_bf16 v[88:91], v[160:163], v[136:139], 0
    ds_read_b64_tr_b16 v[192:193], v126 offset:24576
    v_mfma_f32_16x16x32_bf16 v[100:103], v[160:163], v[52:55], 0
    ds_read_b64_tr_b16 v[194:195], v127 offset:26112
    s_waitcnt lgkmcnt(12)
    v_mfma_f32_16x16x32_bf16 v[92:95], v[184:187], v[136:139], 0
    ds_read_b64_tr_b16 v[216:217], v128 offset:24576
    v_mfma_f32_16x16x32_bf16 v[104:107], v[184:187], v[52:55], 0
    ds_read_b64_tr_b16 v[218:219], v129 offset:26112
    s_waitcnt lgkmcnt(12)
    v_mfma_f32_16x16x32_bf16 v[96:99], v[208:211], v[136:139], 0
    ds_read_b64_tr_b16 v[172:173], v124 offset:36864
    v_mfma_f32_16x16x32_bf16 v[108:111], v[208:211], v[52:55], 0
    ds_read_b64_tr_b16 v[174:175], v125 offset:38400
    s_waitcnt lgkmcnt(12)
    v_mfma_f32_16x16x32_bf16 v[88:91], v[164:167], v[140:143], v[88:91]
    ds_read_b64_tr_b16 v[196:197], v126 offset:36864
    v_mfma_f32_16x16x32_bf16 v[100:103], v[164:167], v[52:55], v[100:103]
    ds_read_b64_tr_b16 v[198:199], v127 offset:38400
    s_waitcnt lgkmcnt(12)
    v_mfma_f32_16x16x32_bf16 v[92:95], v[188:191], v[140:143], v[92:95]
    ds_read_b64_tr_b16 v[220:221], v128 offset:36864
    v_mfma_f32_16x16x32_bf16 v[104:107], v[188:191], v[52:55], v[104:107]
    ds_read_b64_tr_b16 v[222:223], v129 offset:38400
    s_waitcnt lgkmcnt(12)
    v_mfma_f32_16x16x32_bf16 v[96:99], v[212:215], v[140:143], v[96:99]
    ds_read_b64_tr_b16 v[176:177], v124 offset:49152
    v_mfma_f32_16x16x32_bf16 v[108:111], v[212:215], v[52:55], v[108:111]
    ds_read_b64_tr_b16 v[178:179], v125 offset:50688
    s_waitcnt lgkmcnt(12)
    v_mfma_f32_16x16x32_bf16 v[88:91], v[168:171], v[144:147], v[88:91]
    ds_read_b64_tr_b16 v[200:201], v126 offset:49152
    v_mfma_f32_16x16x32_bf16 v[100:103], v[168:171], v[52:55], v[100:103]
    ds_read_b64_tr_b16 v[202:203], v127 offset:50688
    s_waitcnt lgkmcnt(12)
    v_mfma_f32_16x16x32_bf16 v[92:95], v[192:195], v[144:147], v[92:95]
    ds_read_b64_tr_b16 v[224:225], v128 offset:49152
    v_mfma_f32_16x16x32_bf16 v[104:107], v[192:195], v[52:55], v[104:107]
    ds_read_b64_tr_b16 v[226:227], v129 offset:50688
    s_waitcnt lgkmcnt(12)
    v_mfma_f32_16x16x32_bf16 v[96:99], v[216:219], v[144:147], v[96:99]
    ds_read_b64_tr_b16 v[180:181], v124 offset:61440
    v_mfma_f32_16x16x32_bf16 v[108:111], v[216:219], v[52:55], v[108:111]
    ds_read_b64_tr_b16 v[182:183], v125 offset:62976
    s_waitcnt lgkmcnt(12)
    v_mfma_f32_16x16x32_bf16 v[88:91], v[172:175], v[148:151], v[88:91]
    ds_read_b64_tr_b16 v[204:205], v126 offset:61440
    v_mfma_f32_16x16x32_bf16 v[100:103], v[172:175], v[52:55], v[100:103]
    ds_read_b64_tr_b16 v[206:207], v127 offset:62976
    s_waitcnt lgkmcnt(12)
    v_mfma_f32_16x16x32_bf16 v[92:95], v[196:199], v[148:151], v[92:95]
    ds_read_b64_tr_b16 v[228:229], v128 offset:61440
    v_mfma_f32_16x16x32_bf16 v[104:107], v[196:199], v[52:55], v[104:107]
    ds_read_b64_tr_b16 v[230:231], v129 offset:62976
    s_waitcnt lgkmcnt(12)
    v_mfma_f32_16x16x32_bf16 v[96:99], v[220:223], v[148:151], v[96:99]
    v_fma_f32 v5, -v116, v116, v120
    v_mfma_f32_16x16x32_bf16 v[108:111], v[220:223], v[52:55], v[108:111]
    v_max_f32 v5, v5, v56
    s_waitcnt lgkmcnt(10)
    v_mfma_f32_16x16x32_bf16 v[88:91], v[176:179], v[152:155], v[88:91]
    v_rsq_f32 v5, v5
    v_mfma_f32_16x16x32_bf16 v[100:103], v[176:179], v[52:55], v[100:103]
    v_mov_b32 v122, s39
    s_waitcnt lgkmcnt(8)
    v_mfma_f32_16x16x32_bf16 v[92:95], v[200:203], v[152:155], v[92:95]
    v_mul_f32 v5, v60, v5
    v_mfma_f32_16x16x32_bf16 v[104:107], v[200:203], v[52:55], v[104:107]
    v_mov_b32 v123, s39
    s_waitcnt lgkmcnt(6)
    v_mfma_f32_16x16x32_bf16 v[96:99], v[224:227], v[152:155], v[96:99]
    v_mfma_f32_16x16x32_bf16 v[108:111], v[224:227], v[52:55], v[108:111]
    s_waitcnt lgkmcnt(4)
    v_mfma_f32_16x16x32_bf16 v[88:91], v[180:183], v[156:159], v[88:91]
    v_mfma_f32_16x16x32_bf16 v[100:103], v[180:183], v[52:55], v[100:103]
    s_waitcnt lgkmcnt(2)
    v_mfma_f32_16x16x32_bf16 v[92:95], v[204:207], v[156:159], v[92:95]
    v_mfma_f32_16x16x32_bf16 v[104:107], v[204:207], v[52:55], v[104:107]
    s_waitcnt lgkmcnt(0)
    v_mfma_f32_16x16x32_bf16 v[96:99], v[228:231], v[156:159], v[96:99]
    v_mfma_f32_16x16x32_bf16 v[108:111], v[228:231], v[52:55], v[108:111]
    s_nop 1
    v_fma_f32 v88, -v6, v100, v88
    v_fma_f32 v89, -v6, v101, v89
    v_fma_f32 v90, -v6, v102, v90
    v_fma_f32 v91, -v6, v103, v91
    v_mul_f32 v88, v88, v5
    v_mul_f32 v89, v89, v5
    v_mul_f32 v90, v90, v5
    v_mul_f32 v91, v91, v5
    v_cvt_pk_bf16_f32 v112, v88, v89
    v_cvt_pk_bf16_f32 v113, v90, v91
    ds_write_b64 v134, v[112:113] offset:0
    v_fma_f32 v92, -v6, v104, v92
    v_fma_f32 v93, -v6, v105, v93
    v_fma_f32 v94, -v6, v106, v94
    v_fma_f32 v95, -v6, v107, v95
    v_mul_f32 v92, v92, v5
    v_mul_f32 v93, v93, v5
    v_mul_f32 v94, v94, v5
    v_mul_f32 v95, v95, v5
    v_cvt_pk_bf16_f32 v114, v92, v93
    v_cvt_pk_bf16_f32 v115, v94, v95
    ds_write_b64 v134, v[114:115] offset:512
    v_fma_f32 v96, -v6, v108, v96
    v_fma_f32 v97, -v6, v109, v97
    v_fma_f32 v98, -v6, v110, v98
    v_fma_f32 v99, -v6, v111, v99
    v_mul_f32 v96, v96, v5
    v_mul_f32 v97, v97, v5
    v_mul_f32 v98, v98, v5
    v_mul_f32 v99, v99, v5
    v_cvt_pk_bf16_f32 v116, v96, v97
    v_cvt_pk_bf16_f32 v117, v98, v99
    ds_write_b64 v134, v[116:117] offset:1024
    s_waitcnt vmcnt(9)
    s_waitcnt lgkmcnt(0)
    s_barrier
    ds_read_b128 v[136:139], v135 offset:0
    ds_read_b128 a[96:99], v130 offset:0
    ds_read_b128 v[140:143], v135 offset:1024
    ds_read_b128 a[100:103], v131 offset:0
    ds_read_b128 v[144:147], v135 offset:2048
    ds_read_b128 a[104:107], v130 offset:128
    ds_read_b128 v[148:151], v135 offset:3072
    ds_read_b128 a[108:111], v131 offset:128
    ds_read_b128 v[152:155], v135 offset:4096
    ds_read_b128 a[112:115], v130 offset:256
    ds_read_b128 v[156:159], v135 offset:5120
    ds_read_b128 a[116:119], v131 offset:256
    s_waitcnt lgkmcnt(10)
    v_mfma_f32_16x16x32_bf16 v[88:91], a[96:99], v[136:139], 0
    s_waitcnt lgkmcnt(8)
    v_mfma_f32_16x16x32_bf16 v[92:95], a[100:103], v[140:143], 0
    s_waitcnt lgkmcnt(6)
    v_mfma_f32_16x16x32_bf16 v[88:91], a[104:107], v[144:147], v[88:91]
    s_waitcnt lgkmcnt(4)
    v_mfma_f32_16x16x32_bf16 v[92:95], a[108:111], v[148:151], v[92:95]
    s_waitcnt lgkmcnt(2)
    v_mfma_f32_16x16x32_bf16 v[88:91], a[112:115], v[152:155], v[88:91]
    s_waitcnt lgkmcnt(0)
    v_mfma_f32_16x16x32_bf16 v[92:95], a[116:119], v[156:159], v[92:95]
    s_nop 7
    v_add_f32 v88, v88, v92
    v_add_f32 v89, v89, v93
    v_add_f32 v90, v90, v94
    v_add_f32 v91, v91, v95
    v_mul_f32 v88, 0x419fecaf, v88
    v_mul_f32 v89, 0x419fecaf, v89
    v_mul_f32 v90, 0x419fecaf, v90
    v_mul_f32 v91, 0x419fecaf, v91
    v_cvt_pk_bf16_f32 v120, v88, v89
    v_cvt_pk_bf16_f32 v121, v90, v91
    buffer_store_dwordx4 v[120:123], v65, s[32:35], s61 offen sc1
    buffer_load_dwordx4 v25, s[24:27], s58 offen offset:3072 nt lds
    s_add_u32 m0, s41, 4096
    s_nop 0
    buffer_load_dwordx4 v26, s[24:27], s58 offen offset:0 nt lds
    buffer_load_dwordx4 v27, s[24:27], s58 offen offset:1024 nt lds
    s_barrier
    buffer_load_dwordx4 v28, s[24:27], s58 offen offset:2048 nt lds
    buffer_load_dwordx4 v29, s[24:27], s58 offen offset:3072 nt lds
    s_add_u32 m0, s41, 8192
    s_nop 0
    buffer_load_dwordx4 v30, s[24:27], s58 offen offset:0 nt lds
    buffer_load_dwordx4 v31, s[24:27], s58 offen offset:1024 nt lds
    buffer_load_dwordx4 v32, s[24:27], s58 offen offset:2048 nt lds
    buffer_load_dwordx4 v33, s[24:27], s58 offen offset:3072 nt lds
    v_and_b32 v1, 15, v0
    v_lshrrev_b32 v6, 5, v0
    v_bfe_u32 v3, v0, 4, 1
    v_lshl_or_b32 v3, v3, 1, v6
    v_lshrrev_b32 v4, 2, v0
    v_bfe_u32 v5, v0, 1, 1
    v_lshrrev_b32 v6, 3, v1
    v_and_or_b32 v6, v1, 6, v6
    v_xor_b32 v6, v6, v3
    v_mul_u32_u24 v7, 384, v1
    v_lshl_add_u32 v6, v6, 4, v7
    v_add_u32 v34, s40, v6
    v_xor_b32 v35, 64, v34
    v_lshrrev_b32 v6, 3, v1
    v_and_b32 v7, 7, v1
    v_lshl_or_b32 v6, v7, 1, v6
    v_xor_b32 v6, v6, v3
    v_mul_u32_u24 v7, 768, v1
    v_lshl_add_u32 v6, v6, 4, v7
    v_add_u32 v40, s41, v6
    v_xor_b32 v41, 0x40, v40
    v_xor_b32 v42, 0x80, v40
    v_xor_b32 v43, 0xc0, v40
    v_and_b32 v2, 1, v0
    v_lshlrev_b32 v2, 3, v2
    s_mul_i32 s56, s3, 96
    v_lshrrev_b32 v6, 3, v4
    v_and_or_b32 v6, v4, 6, v6
    v_xor_b32 v6, v6, v5
    v_lshl_add_u32 v6, v6, 4, v2
    v_mul_u32_u24 v7, 384, v4
    s_add_u32 s57, s56, 0
    v_xad_u32 v36, v6, s57, v7
    s_add_u32 s57, s56, 32
    v_xad_u32 v37, v6, s57, v7
    s_add_u32 s57, s56, 64
    v_xad_u32 v38, v6, s57, v7
    v_lshrrev_b32 v6, 3, v4
    v_and_b32 v3, 7, v4
    v_lshl_or_b32 v6, v3, 1, v6
    v_xor_b32 v6, v6, v5
    v_lshl_add_u32 v6, v6, 4, v2
    v_lshlrev_b32 v7, 1, v7
    v_add_u32 v7, 24576, v7
    s_add_u32 s57, s56, 0
    v_xad_u32 v44, v6, s57, v7
    s_add_u32 s57, s56, 384
    v_xad_u32 v45, v6, s57, v7
    s_add_u32 s57, s56, 32
    v_xad_u32 v46, v6, s57, v7
    s_add_u32 s57, s56, 416
    v_xad_u32 v47, v6, s57, v7
    s_add_u32 s57, s56, 64
    v_xad_u32 v48, v6, s57, v7
    s_add_u32 s57, s56, 448
    v_xad_u32 v49, v6, s57, v7
    v_lshrrev_b32 v1, 5, v0
    v_lshlrev_b32 v1, 8, v1
    v_and_b32 v2, 15, v0
    v_lshl_add_u32 v1, v2, 4, v1
    v_bfe_u32 v2, v0, 4, 1
    v_lshl_add_u32 v1, v2, 3, v1
    s_mul_i32 s56, s3, 1536
    s_add_u32 s56, s56, 147456
    v_add_u32 v236, s56, v1
    s_mul_i32 s56, s3, 3072
    s_add_u32 s56, s56, 24576
    v_add_u32 v237, s56, v65
    v_add_u32 v238, s41, v65
    s_lshl_b32 s56, s3, 10
    v_add_u32 v240, 159744, v65
    v_add_u32 v239, s56, v240
    v_add_u32 v241, 147456, v65
    v_bfe_u32 v1, v0, 2, 2
    v_lshrrev_b32 v2, 4, v0
    v_lshl_or_b32 v1, v1, 4, v2
    v_mul_u32_u24 v1, 65536, v1
    v_and_b32 v2, 3, v0
    v_lshl_or_b32 v242, v2, 4, v1
    v_xor_b32 v243, 0x70, v242
    s_mul_i32 s56, s3, 3
    v_min_u32 v1, 2, v0
    v_add_u32 v1, s56, v1
    v_min_u32 v2, 8, v0
    v_add_u32 v2, 9, v2
    v_cmp_gt_u32 vcc, 3, v0
    s_nop 1
    v_cndmask_b32 v1, v2, v1, vcc
    v_lshlrev_b32 v245, 7, v1
    v_lshlrev_b32 v1, 3, v0
    v_add_u32 v254, 126976, v1
    s_lshl_b32 s56, s3, 9
    v_add_u32 v238, s56, v254
    v_add_u32 v253, 122880, v65
    s_lshl_b32 s56, s3, 10
    v_add_u32 v237, s56, v253
    s_mov_b32 s52, 0x41c00000
    s_add_u32 m0, s42, 0
    s_add_u32 s59, s37, 196608
    buffer_load_dwordx4 v22, s[24:27], s59 offen offset:0 nt lds
    buffer_load_dwordx4 v23, s[24:27], s59 offen offset:1024 nt lds
    buffer_load_dwordx4 v24, s[24:27], s59 offen offset:2048 nt lds
    buffer_load_dwordx4 v25, s[24:27], s59 offen offset:3072 nt lds
    s_add_u32 m0, s42, 4096
    s_nop 0
    buffer_load_dwordx4 v26, s[24:27], s59 offen offset:0 nt lds
    buffer_load_dwordx4 v27, s[24:27], s59 offen offset:1024 nt lds
    buffer_load_dwordx4 v28, s[24:27], s59 offen offset:2048 nt lds
    buffer_load_dwordx4 v29, s[24:27], s59 offen offset:3072 nt lds
    s_add_u32 m0, s42, 8192
    s_nop 0
    buffer_load_dwordx4 v30, s[24:27], s59 offen offset:0 nt lds
    buffer_load_dwordx4 v31, s[24:27], s59 offen offset:1024 nt lds
    buffer_load_dwordx4 v32, s[24:27], s59 offen offset:2048 nt lds
    buffer_load_dwordx4 v33, s[24:27], s59 offen offset:3072 nt lds
    s_mov_b32 s43, -1
    s_branch L_join
L_vprod:
    s_mul_i32 s60, s3, 18432
    s_add_u32 m0, s60, 73728
    s_nop 0
    buffer_load_dwordx4 v16, s[64:67], s60 offen offset:0  lds
    buffer_load_dwordx4 v17, s[64:67], s60 offen offset:1024  lds
    buffer_load_dwordx4 v18, s[64:67], s60 offen offset:2048  lds
    buffer_load_dwordx4 v19, s[64:67], s60 offen offset:3072  lds
    s_add_u32 m0, s60, 77824
    s_nop 0
    buffer_load_dwordx4 v20, s[64:67], s60 offen offset:0  lds
    buffer_load_dwordx4 v21, s[64:67], s60 offen offset:1024  lds
    s_add_u32 s60, s60, 6144
    s_add_u32 m0, s60, 73728
    s_nop 0
    buffer_load_dwordx4 v16, s[64:67], s60 offen offset:0  lds
    buffer_load_dwordx4 v17, s[64:67], s60 offen offset:1024  lds
    buffer_load_dwordx4 v18, s[64:67], s60 offen offset:2048  lds
    buffer_load_dwordx4 v19, s[64:67], s60 offen offset:3072  lds
    s_add_u32 m0, s60, 77824
    s_nop 0
    buffer_load_dwordx4 v20, s[64:67], s60 offen offset:0  lds
    buffer_load_dwordx4 v21, s[64:67], s60 offen offset:1024  lds
    s_add_u32 s60, s60, 6144
    s_add_u32 m0, s60, 73728
    s_nop 0
    buffer_load_dwordx4 v16, s[64:67], s60 offen offset:0  lds
    v_lshrrev_b32 v1, 4, v0
    v_and_b32 v5, 1, v1
    v_bfe_u32 v2, v0, 2, 2
    v_lshl_add_u32 v3, v1, 3, v2
    buffer_load_dwordx4 v17, s[64:67], s60 offen offset:1024  lds
    v_mul_u32_u24 v3, 384, v3
    v_and_b32 v4, 1, v0
    v_lshl_add_u32 v3, v4, 3, v3
    v_add_u32 v3, 73728, v3
    buffer_load_dwordx4 v18, s[64:67], s60 offen offset:2048  lds
    v_and_or_b32 v2, v2, 2, v5
    v_bfe_u32 v4, v0, 1, 1
    v_xor_b32 v2, v2, v4
    s_mul_i32 s56, s3, 6
    buffer_load_dwordx4 v19, s[64:67], s60 offen offset:3072  lds
    s_add_u32 s57, s56, 0
    v_xor_b32 v4, s57, v2
    v_lshl_add_u32 v136, v4, 4, v3
    v_xor_b32 v137, 64, v136
    s_add_u32 m0, s60, 77824
    s_nop 0
    buffer_load_dwordx4 v20, s[64:67], s60 offen offset:0  lds
    s_add_u32 s57, s56, 2
    v_xor_b32 v4, s57, v2
    v_lshl_add_u32 v138, v4, 4, v3
    v_xor_b32 v139, 64, v138
    buffer_load_dwordx4 v21, s[64:67], s60 offen offset:1024  lds
    s_add_u32 s57, s56, 4
    v_xor_b32 v4, s57, v2
    v_lshl_add_u32 v140, v4, 4, v3
    v_xor_b32 v141, 64, v140
    s_lshl_b32 s61, s43, 2
    s_add_u32 s61, s61, s3
    s_mul_i32 s60, s61, 6144
    s_add_u32 m0, s41, 6144
    s_nop 0
    buffer_load_dwordx4 v16, s[68:71], s60 offen offset:0  lds
    v_bfe_u32 v1, v0, 2, 1
    v_and_b32 v2, 3, v0
    v_lshl_or_b32 v2, v1, 3, v2
    v_and_or_b32 v1, v0, 2, v1
    buffer_load_dwordx4 v17, s[68:71], s60 offen offset:1024  lds
    v_lshrrev_b32 v3, 4, v0
    v_xor_b32 v1, v1, v3
    v_mul_u32_u24 v2, 384, v2
    v_lshl_add_u32 v1, v1, 4, v2
    buffer_load_dwordx4 v18, s[68:71], s60 offen offset:2048  lds
    v_bfe_u32 v2, v0, 3, 1
    v_mul_u32_u24 v2, 12288, v2
    s_mov_b32 s56, 30720
    v_add3_u32 v142, s56, v1, v2
    buffer_load_dwordx4 v19, s[68:71], s60 offen offset:3072  lds
    v_xor_b32 v143, 64, v142
    s_add_u32 m0, s41, 10240
    s_nop 0
    buffer_load_dwordx4 v20, s[68:71], s60 offen offset:0  lds
    buffer_load_dwordx4 v21, s[68:71], s60 offen offset:1024  lds
    s_load_dword s38, s[22:23], 0
    s_barrier
    s_add_u32 m0, s40, 0
    s_add_u32 s57, s36, 0
    buffer_load_dwordx4 v16, s[28:31], s57 offen offset:0 nt lds
    buffer_load_dwordx4 v17, s[28:31], s57 offen offset:1024 nt lds
    buffer_load_dwordx4 v18, s[28:31], s57 offen offset:2048 nt lds
    buffer_load_dwordx4 v19, s[28:31], s57 offen offset:3072 nt lds
    s_add_u32 m0, s40, 4096
    s_nop 0
    buffer_load_dwordx4 v20, s[28:31], s57 offen offset:0 nt lds
    buffer_load_dwordx4 v21, s[28:31], s57 offen offset:1024 nt lds
    s_add_u32 m0, s41, 0
    s_add_u32 s58, s37, 0
    buffer_load_dwordx4 v22, s[24:27], s58 offen offset:0 nt lds
    buffer_load_dwordx4 v23, s[24:27], s58 offen offset:1024 nt lds
    buffer_load_dwordx4 v24, s[24:27], s58 offen offset:2048 nt lds
    s_waitcnt vmcnt(9)
    s_barrier
    ds_read_b128 a[96:99], v142 offset:0
    ds_read_b128 a[100:103], v143 offset:0
    ds_read_b128 a[104:107], v142 offset:128
    ds_read_b128 a[108:111], v143 offset:128
    ds_read_b128 a[112:115], v142 offset:256
    ds_read_b128 a[116:119], v143 offset:256
    ds_read_b128 a[120:123], v143 offset:1536
    ds_read_b128 a[124:127], v142 offset:1536
    ds_read_b128 a[128:131], v143 offset:1664
    ds_read_b128 a[132:135], v142 offset:1664
    ds_read_b128 a[136:139], v143 offset:1792
    ds_read_b128 a[140:143], v142 offset:1792
    ds_read_b128 a[144:147], v142 offset:24576
    ds_read_b128 a[148:151], v143 offset:24576
    ds_read_b128 a[152:155], v142 offset:24704
    ds_read_b128 a[156:159], v143 offset:24704
    ds_read_b128 a[160:163], v142 offset:24832
    ds_read_b128 a[164:167], v143 offset:24832
    ds_read_b128 a[168:171], v143 offset:26112
    ds_read_b128 a[172:175], v142 offset:26112
    ds_read_b128 a[176:179], v143 offset:26240
    ds_read_b128 a[180:183], v142 offset:26240
    ds_read_b128 a[184:187], v143 offset:26368
    ds_read_b128 a[188:191], v142 offset:26368
    ds_read_b64_tr_b16 v[160:161], v136 offset:0
    ds_read_b64_tr_b16 v[162:163], v137 offset:1536
    ds_read_b64_tr_b16 v[164:165], v136 offset:12288
    ds_read_b64_tr_b16 v[166:167], v137 offset:13824
    ds_read_b64_tr_b16 v[168:169], v136 offset:24576
    ds_read_b64_tr_b16 v[170:171], v137 offset:26112
    ds_read_b64_tr_b16 v[172:173], v136 offset:36864
    ds_read_b64_tr_b16 v[174:175], v137 offset:38400
    ds_read_b64_tr_b16 v[176:177], v136 offset:49152
    ds_read_b64_tr_b16 v[178:179], v137 offset:50688
    ds_read_b64_tr_b16 v[180:181], v136 offset:61440
    ds_read_b64_tr_b16 v[182:183], v137 offset:62976
    ds_read_b64_tr_b16 v[184:185], v138 offset:0
    ds_read_b64_tr_b16 v[186:187], v139 offset:1536
    ds_read_b64_tr_b16 v[188:189], v138 offset:12288
    ds_read_b64_tr_b16 v[190:191], v139 offset:13824
    ds_read_b64_tr_b16 v[192:193], v138 offset:24576
    ds_read_b64_tr_b16 v[194:195], v139 offset:26112
    ds_read_b64_tr_b16 v[196:197], v138 offset:36864
    ds_read_b64_tr_b16 v[198:199], v139 offset:38400
    ds_read_b64_tr_b16 v[200:201], v138 offset:49152
    ds_read_b64_tr_b16 v[202:203], v139 offset:50688
    ds_read_b64_tr_b16 v[204:205], v138 offset:61440
    ds_read_b64_tr_b16 v[206:207], v139 offset:62976
    ds_read_b64_tr_b16 v[208:209], v140 offset:0
    ds_read_b64_tr_b16 v[210:211], v141 offset:1536
    ds_read_b64_tr_b16 v[212:213], v140 offset:12288
    ds_read_b64_tr_b16 v[214:215], v141 offset:13824
    ds_read_b64_tr_b16 v[216:217], v140 offset:24576
    ds_read_b64_tr_b16 v[218:219], v141 offset:26112
    ds_read_b64_tr_b16 v[220:221], v140 offset:36864
    ds_read_b64_tr_b16 v[222:223], v141 offset:38400
    ds_read_b64_tr_b16 v[224:225], v140 offset:49152
    ds_read_b64_tr_b16 v[226:227], v141 offset:50688
    ds_read_b64_tr_b16 v[228:229], v140 offset:61440
    ds_read_b64_tr_b16 v[230:231], v141 offset:62976
    s_waitcnt lgkmcnt(0)
    s_barrier
    s_mul_i32 s60, s3, 18432
    s_lshl_b32 s61, s43, 11
    s_add_u32 s60, s60, s61
    s_add_u32 s60, s60, 3145728
    v_mfma_f32_16x16x32_bf16 v[88:91], a[96:99], v[160:163], 0
    v_mfma_f32_16x16x32_bf16 v[92:95], a[120:123], v[160:163], 0
    v_mfma_f32_16x16x32_bf16 v[96:99], a[144:147], v[160:163], 0
    v_mfma_f32_16x16x32_bf16 v[100:103], a[168:171], v[160:163], 0
    buffer_load_dwordx4 v25, s[24:27], s58 offen offset:3072 nt lds
    v_mfma_f32_16x16x32_bf16 v[88:91], a[100:103], v[164:167], v[88:91]
    v_mfma_f32_16x16x32_bf16 v[92:95], a[124:127], v[164:167], v[92:95]
    v_mfma_f32_16x16x32_bf16 v[96:99], a[148:151], v[164:167], v[96:99]
    v_mfma_f32_16x16x32_bf16 v[100:103], a[172:175], v[164:167], v[100:103]
    s_add_u32 m0, s41, 4096
    s_nop 0
    buffer_load_dwordx4 v26, s[24:27], s58 offen offset:0 nt lds
    v_mfma_f32_16x16x32_bf16 v[88:91], a[104:107], v[168:171], v[88:91]
    v_mfma_f32_16x16x32_bf16 v[92:95], a[128:131], v[168:171], v[92:95]
    v_mfma_f32_16x16x32_bf16 v[96:99], a[152:155], v[168:171], v[96:99]
    v_mfma_f32_16x16x32_bf16 v[100:103], a[176:179], v[168:171], v[100:103]
    buffer_load_dwordx4 v27, s[24:27], s58 offen offset:1024 nt lds
    v_mfma_f32_16x16x32_bf16 v[88:91], a[108:111], v[172:175], v[88:91]
    v_mfma_f32_16x16x32_bf16 v[92:95], a[132:135], v[172:175], v[92:95]
    v_mfma_f32_16x16x32_bf16 v[96:99], a[156:159], v[172:175], v[96:99]
    v_mfma_f32_16x16x32_bf16 v[100:103], a[180:183], v[172:175], v[100:103]
    buffer_load_dwordx4 v28, s[24:27], s58 offen offset:2048 nt lds
    v_mfma_f32_16x16x32_bf16 v[88:91], a[112:115], v[176:179], v[88:91]
    v_mfma_f32_16x16x32_bf16 v[92:95], a[136:139], v[176:179], v[92:95]
    v_mfma_f32_16x16x32_bf16 v[96:99], a[160:163], v[176:179], v[96:99]
    v_mfma_f32_16x16x32_bf16 v[100:103], a[184:187], v[176:179], v[100:103]
    buffer_load_dwordx4 v29, s[24:27], s58 offen offset:3072 nt lds
    v_mfma_f32_16x16x32_bf16 v[88:91], a[116:119], v[180:183], v[88:91]
    v_mfma_f32_16x16x32_bf16 v[92:95], a[140:143], v[180:183], v[92:95]
    v_mfma_f32_16x16x32_bf16 v[96:99], a[164:167], v[180:183], v[96:99]
    v_mfma_f32_16x16x32_bf16 v[100:103], a[188:191], v[180:183], v[100:103]
    v_mfma_f32_16x16x32_bf16 v[104:107], a[96:99], v[184:187], 0
    v_mfma_f32_16x16x32_bf16 v[108:111], a[120:123], v[184:187], 0
    v_mfma_f32_16x16x32_bf16 v[112:115], a[144:147], v[184:187], 0
    v_mfma_f32_16x16x32_bf16 v[116:119], a[168:171], v[184:187], 0
    s_add_u32 m0, s41, 8192
    s_nop 0
    buffer_load_dwordx4 v30, s[24:27], s58 offen offset:0 nt lds
    v_mfma_f32_16x16x32_bf16 v[104:107], a[100:103], v[188:191], v[104:107]
    v_mfma_f32_16x16x32_bf16 v[108:111], a[124:127], v[188:191], v[108:111]
    v_mfma_f32_16x16x32_bf16 v[112:115], a[148:151], v[188:191], v[112:115]
    v_mfma_f32_16x16x32_bf16 v[116:119], a[172:175], v[188:191], v[116:119]
    buffer_load_dwordx4 v31, s[24:27], s58 offen offset:1024 nt lds
    v_mfma_f32_16x16x32_bf16 v[104:107], a[104:107], v[192:195], v[104:107]
    v_mfma_f32_16x16x32_bf16 v[108:111], a[128:131], v[192:195], v[108:111]
    v_mfma_f32_16x16x32_bf16 v[112:115], a[152:155], v[192:195], v[112:115]
    v_mfma_f32_16x16x32_bf16 v[116:119], a[176:179], v[192:195], v[116:119]
    buffer_load_dwordx4 v32, s[24:27], s58 offen offset:2048 nt lds
    v_cvt_pk_bf16_f32 v144, v88, v89
    v_cvt_pk_bf16_f32 v145, v90, v91
    v_cvt_pk_bf16_f32 v146, v92, v93
    v_cvt_pk_bf16_f32 v147, v94, v95
    buffer_store_dwordx4 v[144:147], v65, s[32:35], s60 offen offset:0 sc1
    v_cvt_pk_bf16_f32 v148, v96, v97
    v_cvt_pk_bf16_f32 v149, v98, v99
    v_cvt_pk_bf16_f32 v150, v100, v101
    v_cvt_pk_bf16_f32 v151, v102, v103
    buffer_store_dwordx4 v[148:151], v65, s[32:35], s60 offen offset:1024 sc1
    s_add_u32 s60, s60, 6144
    v_mfma_f32_16x16x32_bf16 v[104:107], a[108:111], v[196:199], v[104:107]
    v_mfma_f32_16x16x32_bf16 v[108:111], a[132:135], v[196:199], v[108:111]
    v_mfma_f32_16x16x32_bf16 v[112:115], a[156:159], v[196:199], v[112:115]
    v_mfma_f32_16x16x32_bf16 v[116:119], a[180:183], v[196:199], v[116:119]
    buffer_load_dwordx4 v33, s[24:27], s58 offen offset:3072 nt lds
    v_mfma_f32_16x16x32_bf16 v[104:107], a[112:115], v[200:203], v[104:107]
    v_mfma_f32_16x16x32_bf16 v[108:111], a[136:139], v[200:203], v[108:111]
    v_mfma_f32_16x16x32_bf16 v[112:115], a[160:163], v[200:203], v[112:115]
    v_mfma_f32_16x16x32_bf16 v[116:119], a[184:187], v[200:203], v[116:119]
    s_add_u32 m0, s42, 0
    s_add_u32 s59, s37, 196608
    buffer_load_dwordx4 v22, s[24:27], s59 offen offset:0 nt lds
    v_mfma_f32_16x16x32_bf16 v[104:107], a[116:119], v[204:207], v[104:107]
    v_mfma_f32_16x16x32_bf16 v[108:111], a[140:143], v[204:207], v[108:111]
    v_mfma_f32_16x16x32_bf16 v[112:115], a[164:167], v[204:207], v[112:115]
    v_mfma_f32_16x16x32_bf16 v[116:119], a[188:191], v[204:207], v[116:119]
    v_mfma_f32_16x16x32_bf16 v[120:123], a[96:99], v[208:211], 0
    v_mfma_f32_16x16x32_bf16 v[124:127], a[120:123], v[208:211], 0
    v_mfma_f32_16x16x32_bf16 v[128:131], a[144:147], v[208:211], 0
    v_mfma_f32_16x16x32_bf16 v[132:135], a[168:171], v[208:211], 0
    buffer_load_dwordx4 v23, s[24:27], s59 offen offset:1024 nt lds
    v_mfma_f32_16x16x32_bf16 v[120:123], a[100:103], v[212:215], v[120:123]
    v_mfma_f32_16x16x32_bf16 v[124:127], a[124:127], v[212:215], v[124:127]
    v_mfma_f32_16x16x32_bf16 v[128:131], a[148:151], v[212:215], v[128:131]
    v_mfma_f32_16x16x32_bf16 v[132:135], a[172:175], v[212:215], v[132:135]
    buffer_load_dwordx4 v24, s[24:27], s59 offen offset:2048 nt lds
    v_mfma_f32_16x16x32_bf16 v[120:123], a[104:107], v[216:219], v[120:123]
    v_mfma_f32_16x16x32_bf16 v[124:127], a[128:131], v[216:219], v[124:127]
    v_mfma_f32_16x16x32_bf16 v[128:131], a[152:155], v[216:219], v[128:131]
    v_mfma_f32_16x16x32_bf16 v[132:135], a[176:179], v[216:219], v[132:135]
    buffer_load_dwordx4 v25, s[24:27], s59 offen offset:3072 nt lds
    v_cvt_pk_bf16_f32 v152, v104, v105
    v_cvt_pk_bf16_f32 v153, v106, v107
    v_cvt_pk_bf16_f32 v154, v108, v109
    v_cvt_pk_bf16_f32 v155, v110, v111
    buffer_store_dwordx4 v[152:155], v65, s[32:35], s60 offen offset:0 sc1
    v_cvt_pk_bf16_f32 v156, v112, v113
    v_cvt_pk_bf16_f32 v157, v114, v115
    v_cvt_pk_bf16_f32 v158, v116, v117
    v_cvt_pk_bf16_f32 v159, v118, v119
    buffer_store_dwordx4 v[156:159], v65, s[32:35], s60 offen offset:1024 sc1
    s_add_u32 s60, s60, 6144
    v_mfma_f32_16x16x32_bf16 v[120:123], a[108:111], v[220:223], v[120:123]
    v_mfma_f32_16x16x32_bf16 v[124:127], a[132:135], v[220:223], v[124:127]
    v_mfma_f32_16x16x32_bf16 v[128:131], a[156:159], v[220:223], v[128:131]
    v_mfma_f32_16x16x32_bf16 v[132:135], a[180:183], v[220:223], v[132:135]
    s_add_u32 m0, s42, 4096
    s_nop 0
    buffer_load_dwordx4 v26, s[24:27], s59 offen offset:0 nt lds
    v_mfma_f32_16x16x32_bf16 v[120:123], a[112:115], v[224:227], v[120:123]
    v_mfma_f32_16x16x32_bf16 v[124:127], a[136:139], v[224:227], v[124:127]
    v_mfma_f32_16x16x32_bf16 v[128:131], a[160:163], v[224:227], v[128:131]
    v_mfma_f32_16x16x32_bf16 v[132:135], a[184:187], v[224:227], v[132:135]
    buffer_load_dwordx4 v27, s[24:27], s59 offen offset:1024 nt lds
    v_mfma_f32_16x16x32_bf16 v[120:123], a[116:119], v[228:231], v[120:123]
    v_mfma_f32_16x16x32_bf16 v[124:127], a[140:143], v[228:231], v[124:127]
    v_mfma_f32_16x16x32_bf16 v[128:131], a[164:167], v[228:231], v[128:131]
    v_mfma_f32_16x16x32_bf16 v[132:135], a[188:191], v[228:231], v[132:135]
    s_nop 4
    v_cvt_pk_bf16_f32 v144, v120, v121
    v_cvt_pk_bf16_f32 v145, v122, v123
    v_cvt_pk_bf16_f32 v146, v124, v125
    v_cvt_pk_bf16_f32 v147, v126, v127
    buffer_store_dwordx4 v[144:147], v65, s[32:35], s60 offen offset:0 sc1
    v_cvt_pk_bf16_f32 v148, v128, v129
    v_cvt_pk_bf16_f32 v149, v130, v131
    v_cvt_pk_bf16_f32 v150, v132, v133
    v_cvt_pk_bf16_f32 v151, v134, v135
    buffer_store_dwordx4 v[148:151], v65, s[32:35], s60 offen offset:1024 sc1
    v_and_b32 v1, 15, v0
    v_lshrrev_b32 v6, 5, v0
    v_bfe_u32 v3, v0, 4, 1
    v_lshl_or_b32 v3, v3, 1, v6
    v_lshrrev_b32 v4, 2, v0
    v_bfe_u32 v5, v0, 1, 1
    v_lshrrev_b32 v6, 3, v1
    v_and_or_b32 v6, v1, 6, v6
    v_xor_b32 v6, v6, v3
    v_mul_u32_u24 v7, 384, v1
    v_lshl_add_u32 v6, v6, 4, v7
    v_add_u32 v34, s40, v6
    v_xor_b32 v35, 64, v34
    v_lshrrev_b32 v6, 3, v1
    v_and_b32 v7, 7, v1
    v_lshl_or_b32 v6, v7, 1, v6
    v_xor_b32 v6, v6, v3
    v_mul_u32_u24 v7, 768, v1
    v_lshl_add_u32 v6, v6, 4, v7
    v_add_u32 v40, s41, v6
    v_xor_b32 v41, 0x40, v40
    v_xor_b32 v42, 0x80, v40
    v_xor_b32 v43, 0xc0, v40
    v_and_b32 v2, 1, v0
    v_lshlrev_b32 v2, 3, v2
    s_mul_i32 s56, s3, 96
    v_lshrrev_b32 v6, 3, v4
    v_and_or_b32 v6, v4, 6, v6
    v_xor_b32 v6, v6, v5
    v_lshl_add_u32 v6, v6, 4, v2
    v_mul_u32_u24 v7, 384, v4
    s_add_u32 s57, s56, 0
    v_xad_u32 v36, v6, s57, v7
    s_add_u32 s57, s56, 32
    v_xad_u32 v37, v6, s57, v7
    s_add_u32 s57, s56, 64
    v_xad_u32 v38, v6, s57, v7
    v_lshrrev_b32 v6, 3, v4
    v_and_b32 v3, 7, v4
    v_lshl_or_b32 v6, v3, 1, v6
    v_xor_b32 v6, v6, v5
    v_lshl_add_u32 v6, v6, 4, v2
    v_lshlrev_b32 v7, 1, v7
    v_add_u32 v7, 24576, v7
    s_add_u32 s57, s56, 0
    v_xad_u32 v44, v6, s57, v7
    s_add_u32 s57, s56, 384
    v_xad_u32 v45, v6, s57, v7
    s_add_u32 s57, s56, 32
    v_xad_u32 v46, v6, s57, v7
    s_add_u32 s57, s56, 416
    v_xad_u32 v47, v6, s57, v7
    s_add_u32 s57, s56, 64
    v_xad_u32 v48, v6, s57, v7
    s_add_u32 s57, s56, 448
    v_xad_u32 v49, v6, s57, v7
    v_mov_b32 v52, 0x3f803f80
    v_mov_b32 v56, 0x3ebcbe62
    s_mov_b32 s44, 0x100001
    s_mov_b32 s45, 0x10000100
    v_mov_b32 v53, 0x3f803f80
    v_mov_b32 v57, 0x3ebcbe62
    s_mov_b32 s46, 0x200002
    s_mov_b32 s47, 0x20000200
    v_mov_b32 v54, 0x3f803f80
    v_mov_b32 v58, 0x3ebcbe62
    s_mov_b32 s48, 0x400004
    s_mov_b32 s49, 0x40000400
    v_mov_b32 v55, 0x3f803f80
    v_mov_b32 v59, 0x3ebcbe62
    s_mov_b32 s50, 0x800008
    s_mov_b32 s51, 0x80000800
    v_mov_b32 v60, 0x43400000
    v_lshrrev_b32 v1, 5, v0
    v_lshlrev_b32 v1, 8, v1
    v_and_b32 v2, 15, v0
    v_lshl_add_u32 v1, v2, 4, v1
    v_bfe_u32 v2, v0, 4, 1
    v_lshl_add_u32 v1, v2, 3, v1
    s_mul_i32 s56, s3, 1536
    s_add_u32 s56, s56, 147456
    v_add_u32 v236, s56, v1
    s_mul_i32 s56, s3, 3072
    s_add_u32 s56, s56, 24576
    v_add_u32 v237, s56, v65
    v_add_u32 v238, s41, v65
    s_lshl_b32 s56, s3, 10
    v_add_u32 v240, 159744, v65
    v_add_u32 v239, s56, v240
    v_add_u32 v241, 147456, v65
    v_bfe_u32 v1, v0, 2, 2
    v_lshrrev_b32 v2, 4, v0
    v_lshl_or_b32 v1, v1, 4, v2
    v_mul_u32_u24 v1, 65536, v1
    v_and_b32 v2, 3, v0
    v_lshl_or_b32 v242, v2, 4, v1
    v_xor_b32 v243, 0x70, v242
    s_mul_i32 s56, s3, 3
    v_min_u32 v1, 2, v0
    v_add_u32 v1, s56, v1
    v_min_u32 v2, 8, v0
    v_add_u32 v2, 9, v2
    v_cmp_gt_u32 vcc, 3, v0
    s_nop 1
    v_cndmask_b32 v1, v2, v1, vcc
    v_lshlrev_b32 v245, 7, v1
    v_lshlrev_b32 v1, 3, v0
    v_add_u32 v254, 126976, v1
    s_lshl_b32 s56, s3, 9
    v_add_u32 v238, s56, v254
    v_add_u32 v253, 122880, v65
    s_lshl_b32 s56, s3, 10
    v_add_u32 v237, s56, v253
    s_mov_b32 s52, 0x41c00000
    buffer_load_dwordx4 v28, s[24:27], s59 offen offset:2048 nt lds
    buffer_load_dwordx4 v29, s[24:27], s59 offen offset:3072 nt lds
    s_add_u32 m0, s42, 8192
    s_nop 0
    buffer_load_dwordx4 v30, s[24:27], s59 offen offset:0 nt lds
    buffer_load_dwordx4 v31, s[24:27], s59 offen offset:1024 nt lds
    buffer_load_dwordx4 v32, s[24:27], s59 offen offset:2048 nt lds
    buffer_load_dwordx4 v33, s[24:27], s59 offen offset:3072 nt lds
    s_branch L_join
L_xt3:
    s_call_b64 s[54:55], L_xslow
    s_branch L_post3
L_xt24:
    s_call_b64 s[54:55], L_xslow
    s_branch L_post24
L_xt6:
    s_call_b64 s[54:55], L_xslow
    s_branch L_post6
L_xt27:
    s_call_b64 s[54:55], L_xslow
    s_branch L_post27
L_xt9:
    s_call_b64 s[54:55], L_xslow
    s_branch L_post9
L_xt11:
    s_call_b64 s[54:55], L_xalt
    ds_read_b128 a[192:195], v253 offset:12288
    ds_read_b128 a[196:199], v253 offset:13312
    ds_read_b128 a[200:203], v253 offset:14336
    ds_read_b128 a[204:207], v253 offset:15360
    s_waitcnt lgkmcnt(0)
    s_branch L_post11
L_xslow:
    s_waitcnt lgkmcnt(0)
    ds_write_b32 v239, v62
    s_waitcnt lgkmcnt(0)
    s_barrier
    ds_read_b32 v12, v240 offset:0
    ds_read_b32 v13, v240 offset:1024
    ds_read_b32 v14, v240 offset:2048
    ds_read_b32 v15, v240 offset:3072
    v_mov_b32 v9, 0
    ds_write_b32 v254, v9 offset:4096
    s_waitcnt lgkmcnt(0)
    v_min3_f32 v1, v12, v13, v14
    v_min_f32 v1, v1, v15
    v_sub_f32 v2, v1, v255
    v_sub_f32 v12, v1, v62
    v_exp_f32 v2, v2
    v_exp_f32 v12, v12
    v_mov_b32 v62, v1
    v_mov_b32 v255, v1
    v_mul_f32 v88, v88, v12
    v_mul_f32 v89, v89, v12
    v_mul_f32 v90, v90, v12
    v_mul_f32 v91, v91, v12
    v_mul_f32 v104, v104, v12
    v_mul_f32 v105, v105, v12
    v_mul_f32 v106, v106, v12
    v_mul_f32 v107, v107, v12
    v_mul_f32 v68, v68, v12
    v_mul_f32 v69, v69, v12
    v_mul_f32 v70, v70, v12
    v_mul_f32 v71, v71, v12
    v_mul_f32 v112, v112, v12
    v_mul_f32 v113, v113, v12
    v_mul_f32 v114, v114, v12
    v_mul_f32 v115, v115, v12
    v_mul_f32 v63, v63, v12
    v_mul_f32 v64, v64, v12
    v_accvgpr_read_b32 v1, a0
    v_mul_f32 v1, v1, v2
    v_accvgpr_write_b32 a0, v1
    v_accvgpr_read_b32 v1, a1
    v_mul_f32 v1, v1, v2
    v_accvgpr_write_b32 a1, v1
    v_accvgpr_read_b32 v1, a2
    v_mul_f32 v1, v1, v2
    v_accvgpr_write_b32 a2, v1
    v_accvgpr_read_b32 v1, a3
    v_mul_f32 v1, v1, v2
    v_accvgpr_write_b32 a3, v1
    v_accvgpr_read_b32 v1, a4
    v_mul_f32 v1, v1, v2
    v_accvgpr_write_b32 a4, v1
    v_accvgpr_read_b32 v1, a5
    v_mul_f32 v1, v1, v2
    v_accvgpr_write_b32 a5, v1
    v_accvgpr_read_b32 v1, a6
    v_mul_f32 v1, v1, v2
    v_accvgpr_write_b32 a6, v1
    v_accvgpr_read_b32 v1, a7
    v_mul_f32 v1, v1, v2
    v_accvgpr_write_b32 a7, v1
    v_accvgpr_read_b32 v1, a8
    v_mul_f32 v1, v1, v2
    v_accvgpr_write_b32 a8, v1
    v_accvgpr_read_b32 v1, a9
    v_mul_f32 v1, v1, v2
    v_accvgpr_write_b32 a9, v1
    v_accvgpr_read_b32 v1, a10
    v_mul_f32 v1, v1, v2
    v_accvgpr_write_b32 a10, v1
    v_accvgpr_read_b32 v1, a11
    v_mul_f32 v1, v1, v2
    v_accvgpr_write_b32 a11, v1
    v_cvt_pk_bf16_f32 v72, v88, v89
    v_cvt_pk_bf16_f32 v73, v90, v91
    v_cvt_pk_bf16_f32 v74, v104, v105
    v_cvt_pk_bf16_f32 v75, v106, v107
    ds_write_b128 v237, v[72:75] offset:0
    v_cvt_pk_bf16_f32 v66, v68, v69
    v_cvt_pk_bf16_f32 v67, v70, v71
    ds_write_b64 v238, v[66:67]
    s_waitcnt lgkmcnt(0)
    s_barrier
    s_setpc_b64 s[54:55]
L_xlast:
    s_waitcnt lgkmcnt(0)
    ds_write_b32 v239, v62
    s_waitcnt lgkmcnt(0)
    s_barrier
    ds_read_b32 v12, v240 offset:0
    ds_read_b32 v13, v240 offset:1024
    ds_read_b32 v14, v240 offset:2048
    ds_read_b32 v15, v240 offset:3072
    v_mov_b32 v9, 0
    ds_write_b32 v254, v9 offset:4096
    s_waitcnt lgkmcnt(0)
    v_min3_f32 v1, v12, v13, v14
    v_min_f32 v1, v1, v15
    v_sub_f32 v2, v1, v255
    v_sub_f32 v12, v1, v62
    v_exp_f32 v2, v2
    v_exp_f32 v12, v12
    v_mov_b32 v62, v1
    v_mov_b32 v255, v1
    v_mul_f32 v88, v88, v12
    v_mul_f32 v89, v89, v12
    v_mul_f32 v90, v90, v12
    v_mul_f32 v91, v91, v12
    v_mul_f32 v104, v104, v12
    v_mul_f32 v105, v105, v12
    v_mul_f32 v106, v106, v12
    v_mul_f32 v107, v107, v12
    v_mul_f32 v68, v68, v12
    v_mul_f32 v69, v69, v12
    v_mul_f32 v70, v70, v12
    v_mul_f32 v71, v71, v12
    v_mul_f32 v10, v10, v12
    v_mul_f32 v11, v11, v12
    v_mul_f32 v16, v16, v2
    v_mul_f32 v17, v17, v2
    v_mul_f32 v18, v18, v2
    v_mul_f32 v19, v19, v2
    v_mul_f32 v20, v20, v2
    v_mul_f32 v21, v21, v2
    v_mul_f32 v22, v22, v2
    v_mul_f32 v23, v23, v2
    v_mul_f32 v24, v24, v2
    v_mul_f32 v25, v25, v2
    v_mul_f32 v26, v26, v2
    v_mul_f32 v27, v27, v2
    v_cvt_pk_bf16_f32 v72, v88, v89
    v_cvt_pk_bf16_f32 v73, v90, v91
    v_cvt_pk_bf16_f32 v74, v104, v105
    v_cvt_pk_bf16_f32 v75, v106, v107
    ds_write_b128 v237, v[72:75] offset:0
    v_cvt_pk_bf16_f32 v66, v68, v69
    v_cvt_pk_bf16_f32 v67, v70, v71
    ds_write_b64 v238, v[66:67]
    ds_write_b64 v238, v[10:11] offset:2048
    s_waitcnt lgkmcnt(0)
    s_barrier
    s_branch L_postx
L_xalt:
    s_waitcnt lgkmcnt(0)
    ds_write_b32 v239, v62
    s_waitcnt lgkmcnt(0)
    s_barrier
    ds_read_b32 v12, v240 offset:0
    ds_read_b32 v13, v240 offset:1024
    ds_read_b32 v14, v240 offset:2048
    ds_read_b32 v15, v240 offset:3072
    v_mov_b32 v9, 0
    ds_write_b32 v254, v9 offset:4100
    s_waitcnt lgkmcnt(0)
    v_min3_f32 v1, v12, v13, v14
    v_min_f32 v1, v1, v15
    v_sub_f32 v2, v1, v255
    v_sub_f32 v12, v1, v62
    v_exp_f32 v2, v2
    v_exp_f32 v12, v12
    v_mov_b32 v62, v1
    v_mov_b32 v255, v1
    v_mul_f32 v88, v88, v12
    v_mul_f32 v89, v89, v12
    v_mul_f32 v90, v90, v12
    v_mul_f32 v91, v91, v12
    v_mul_f32 v104, v104, v12
    v_mul_f32 v105, v105, v12
    v_mul_f32 v106, v106, v12
    v_mul_f32 v107, v107, v12
    v_mul_f32 v68, v68, v12
    v_mul_f32 v69, v69, v12
    v_mul_f32 v70, v70, v12
    v_mul_f32 v71, v71, v12
    v_mul_f32 v112, v112, v12
    v_mul_f32 v113, v113, v12
    v_mul_f32 v114, v114, v12
    v_mul_f32 v115, v115, v12
    v_mul_f32 v63, v63, v12
    v_mul_f32 v64, v64, v12
    v_mul_f32 v16, v16, v2
    v_mul_f32 v17, v17, v2
    v_mul_f32 v18, v18, v2
    v_mul_f32 v19, v19, v2
    v_mul_f32 v20, v20, v2
    v_mul_f32 v21, v21, v2
    v_mul_f32 v22, v22, v2
    v_mul_f32 v23, v23, v2
    v_mul_f32 v24, v24, v2
    v_mul_f32 v25, v25, v2
    v_mul_f32 v26, v26, v2
    v_mul_f32 v27, v27, v2
    v_cvt_pk_bf16_f32 v72, v88, v89
    v_cvt_pk_bf16_f32 v73, v90, v91
    v_cvt_pk_bf16_f32 v74, v104, v105
    v_cvt_pk_bf16_f32 v75, v106, v107
    ds_write_b128 v237, v[72:75] offset:12288
    s_waitcnt lgkmcnt(0)
    s_barrier
    s_setpc_b64 s[54:55]
L_c_slow:
    s_cmp_eq_u32 s43, 0
    s_cbranch_scc1 L_c_out
    s_mov_b32 s43, 0
    buffer_load_dwordx4 v[76:79], v65, s[32:35], s30 offen offset:0 sc1
    buffer_load_dwordx4 v[80:83], v65, s[32:35], s30 offen offset:1024 sc1
    buffer_load_dwordx4 v[84:87], v65, s[32:35], s30 offen offset:2048 sc1
    buffer_load_dwordx4 v[108:111], v65, s[32:35], s30 offen offset:3072 sc1
    buffer_load_dwordx4 v[112:115], v65, s[32:35], s31 offen offset:0 sc1
    buffer_load_dwordx4 v[128:131], v65, s[32:35], s31 offen offset:1024 sc1
    buffer_load_dwordx4 v[132:135], v65, s[32:35], s31 offen offset:2048 sc1
    buffer_load_dwordx4 v[52:55], v65, s[32:35], s31 offen offset:3072 sc1
    s_waitcnt vmcnt(0)
    v_sub_u32 v49, v79, v247
    v_max_f32 v42, v42, v49
    v_sub_u32 v49, v83, v247
    v_max_f32 v42, v42, v49
    v_sub_u32 v49, v87, v247
    v_max_f32 v42, v42, v49
    v_sub_u32 v49, v111, v247
    v_max_f32 v42, v42, v49
    v_sub_u32 v49, v115, v247
    v_max_f32 v42, v42, v49
    v_sub_u32 v49, v131, v247
    v_max_f32 v42, v42, v49
    v_sub_u32 v49, v135, v247
    v_max_f32 v42, v42, v49
    v_sub_u32 v49, v55, v247
    v_max_f32 v42, v42, v49
    s_nop 1
    v_max_f32_dpp v42, v42, v42 row_ror:8 row_mask:0xf bank_mask:0xf
    v_mov_b32 v48, v42
    s_nop 1
    v_permlane32_swap_b32 v42, v48
    v_max_f32 v42, v42, v48
    v_mov_b32 v48, v42
    s_nop 1
    v_permlane16_swap_b32 v42, v48
    v_max_f32 v42, v42, v48
    s_lshl_b32 s56, s3, 2
    v_add_u32 v48, s56, v251
    ds_write_b32 v48, v42 offset:1024
    s_waitcnt lgkmcnt(0)
    s_barrier
    ds_read_b128 v[48:51], v251 offset:1024
    v_mov_b32 v16, 0
    v_mov_b32 v17, 0
    v_mov_b32 v18, 0
    v_mov_b32 v19, 0
    v_mov_b32 v20, 0
    v_mov_b32 v21, 0
    v_mov_b32 v22, 0
    s_waitcnt lgkmcnt(0)
    v_max3_f32 v42, v48, v49, v50
    v_max_f32 v42, v42, v51
    v_sub_u32 v49, v79, v247
    v_sub_f32 v49, v49, v42
    v_exp_f32 v49, v49
    s_nop 0
    v_cvt_pk_bf16_f32 v49, v49, 0
    v_lshlrev_b32 v50, 16, v49
    v_dot2_f32_bf16 v16, v76, v49, v16
    v_dot2_f32_bf16 v18, v77, v49, v18
    v_dot2_f32_bf16 v20, v78, v49, v20
    v_add_f32 v22, v22, v50
    v_dot2_f32_bf16 v17, v76, v50, v17
    v_dot2_f32_bf16 v19, v77, v50, v19
    v_dot2_f32_bf16 v21, v78, v50, v21
    v_sub_u32 v49, v83, v247
    v_sub_f32 v49, v49, v42
    v_exp_f32 v49, v49
    s_nop 0
    v_cvt_pk_bf16_f32 v49, v49, 0
    v_lshlrev_b32 v50, 16, v49
    v_dot2_f32_bf16 v16, v80, v49, v16
    v_dot2_f32_bf16 v18, v81, v49, v18
    v_dot2_f32_bf16 v20, v82, v49, v20
    v_add_f32 v22, v22, v50
    v_dot2_f32_bf16 v17, v80, v50, v17
    v_dot2_f32_bf16 v19, v81, v50, v19
    v_dot2_f32_bf16 v21, v82, v50, v21
    v_sub_u32 v49, v87, v247
    v_sub_f32 v49, v49, v42
    v_exp_f32 v49, v49
    s_nop 0
    v_cvt_pk_bf16_f32 v49, v49, 0
    v_lshlrev_b32 v50, 16, v49
    v_dot2_f32_bf16 v16, v84, v49, v16
    v_dot2_f32_bf16 v18, v85, v49, v18
    v_dot2_f32_bf16 v20, v86, v49, v20
    v_add_f32 v22, v22, v50
    v_dot2_f32_bf16 v17, v84, v50, v17
    v_dot2_f32_bf16 v19, v85, v50, v19
    v_dot2_f32_bf16 v21, v86, v50, v21
    v_sub_u32 v49, v111, v247
    v_sub_f32 v49, v49, v42
    v_exp_f32 v49, v49
    s_nop 0
    v_cvt_pk_bf16_f32 v49, v49, 0
    v_lshlrev_b32 v50, 16, v49
    v_dot2_f32_bf16 v16, v108, v49, v16
    v_dot2_f32_bf16 v18, v109, v49, v18
    v_dot2_f32_bf16 v20, v110, v49, v20
    v_add_f32 v22, v22, v50
    v_dot2_f32_bf16 v17, v108, v50, v17
    v_dot2_f32_bf16 v19, v109, v50, v19
    v_dot2_f32_bf16 v21, v110, v50, v21
    v_sub_u32 v49, v115, v247
    v_sub_f32 v49, v49, v42
    v_exp_f32 v49, v49
    s_nop 0
    v_cvt_pk_bf16_f32 v49, v49, 0
    v_lshlrev_b32 v50, 16, v49
    v_dot2_f32_bf16 v16, v112, v49, v16
    v_dot2_f32_bf16 v18, v113, v49, v18
    v_dot2_f32_bf16 v20, v114, v49, v20
    v_add_f32 v22, v22, v50
    v_dot2_f32_bf16 v17, v112, v50, v17
    v_dot2_f32_bf16 v19, v113, v50, v19
    v_dot2_f32_bf16 v21, v114, v50, v21
    v_sub_u32 v49, v131, v247
    v_sub_f32 v49, v49, v42
    v_exp_f32 v49, v49
    s_nop 0
    v_cvt_pk_bf16_f32 v49, v49, 0
    v_lshlrev_b32 v50, 16, v49
    v_dot2_f32_bf16 v16, v128, v49, v16
    v_dot2_f32_bf16 v18, v129, v49, v18
    v_dot2_f32_bf16 v20, v130, v49, v20
    v_add_f32 v22, v22, v50
    v_dot2_f32_bf16 v17, v128, v50, v17
    v_dot2_f32_bf16 v19, v129, v50, v19
    v_dot2_f32_bf16 v21, v130, v50, v21
    v_sub_u32 v49, v135, v247
    v_sub_f32 v49, v49, v42
    v_exp_f32 v49, v49
    s_nop 0
    v_cvt_pk_bf16_f32 v49, v49, 0
    v_lshlrev_b32 v50, 16, v49
    v_dot2_f32_bf16 v16, v132, v49, v16
    v_dot2_f32_bf16 v18, v133, v49, v18
    v_dot2_f32_bf16 v20, v134, v49, v20
    v_add_f32 v22, v22, v50
    v_dot2_f32_bf16 v17, v132, v50, v17
    v_dot2_f32_bf16 v19, v133, v50, v19
    v_dot2_f32_bf16 v21, v134, v50, v21
    v_sub_u32 v49, v55, v247
    v_sub_f32 v49, v49, v42
    v_exp_f32 v49, v49
    s_nop 0
    v_cvt_pk_bf16_f32 v49, v49, 0
    v_lshlrev_b32 v50, 16, v49
    v_dot2_f32_bf16 v16, v52, v49, v16
    v_dot2_f32_bf16 v18, v53, v49, v18
    v_dot2_f32_bf16 v20, v54, v49, v20
    v_add_f32 v22, v22, v50
    v_dot2_f32_bf16 v17, v52, v50, v17
    v_dot2_f32_bf16 v19, v53, v50, v19
    v_dot2_f32_bf16 v21, v54, v50, v21
    s_nop 2
    s_branch L_c_red
L_qk_retry:
    s_mov_b32 s53, 0
L_qk_again:
    s_mul_i32 s56, s3, 3072
    s_add_u32 s56, s56, 16384
    buffer_load_dwordx4 v[136:139], v65, s[32:35], s56 offen offset:0 sc1
    buffer_load_dwordx4 v[140:143], v65, s[32:35], s56 offen offset:1024 sc1
    buffer_load_dwordx4 v[144:147], v65, s[32:35], s56 offen offset:2048 sc1
    s_add_u32 s53, s53, 1
    s_waitcnt vmcnt(0)
    v_xor_b32 v1, s39, v138
    v_xor_b32 v2, s39, v142
    v_xor_b32 v3, s39, v146
    v_or3_b32 v1, v1, v2, v3
    v_cmp_ne_u32 vcc, 0, v1
    s_cbranch_vccz L_qk_ok
    s_cmp_lt_u32 s53, 65536
    s_cbranch_scc1 L_qk_again
    s_branch L_qk_ok
L_fl_retry:
    s_mov_b32 s53, 0
L_fl_again:
    buffer_load_dwordx2 v[234:235], v245, s[32:35], 0 offen offset:128 sc1
    s_add_u32 s53, s53, 1
    s_waitcnt vmcnt(0)
    v_cmp_ne_u32 vcc, s39, v234
    s_cbranch_vccz L_fl_ok
    s_cmp_lt_u32 s53, 65536
    s_cbranch_scc1 L_fl_again
    s_branch L_fl_ok
L_site0:
    s_call_b64 s[54:55], L_rare2
    s_branch L_back0
L_site1:
    s_call_b64 s[54:55], L_rare3
    s_branch L_back1
L_site2:
    s_call_b64 s[54:55], L_rare2
    s_branch L_back2
L_site3:
    s_call_b64 s[54:55], L_rare3
    s_branch L_back3
L_site4:
    s_call_b64 s[54:55], L_rare2
    s_branch L_back4
L_site5:
    s_call_b64 s[54:55], L_rare3
    s_branch L_back5
L_site6:
    s_call_b64 s[54:55], L_rare2
    s_branch L_back6
L_site7:
    s_call_b64 s[54:55], L_rare3
    s_branch L_back7
L_site8:
    s_call_b64 s[54:55], L_rare2
    s_branch L_back8
L_site9:
    s_call_b64 s[54:55], L_rare3
    s_branch L_back9
L_site10:
    s_call_b64 s[54:55], L_rare6
    s_branch L_back10
L_site11:
    s_call_b64 s[54:55], L_rare7
    s_branch L_back11
L_site12:
    s_call_b64 s[54:55], L_rare2
    s_branch L_back12
L_site13:
    s_call_b64 s[54:55], L_rare5
    s_branch L_back13
L_rare2:
    s_nop 7
    s_nop 7
    v_mov_b32 v2, v1
    s_nop 1
    v_permlane32_swap_b32 v1, v2
    v_max_f32 v1, v1, v2
    v_mov_b32 v2, v1
    s_nop 1
    v_permlane16_swap_b32 v1, v2
    v_max_f32 v1, v1, v2
    v_max_f32 v1, 0, v1
    v_sub_f32 v62, v62, v1
    v_sub_f32 v88, v88, v1
    v_sub_f32 v89, v89, v1
    v_sub_f32 v90, v90, v1
    v_sub_f32 v91, v91, v1
    v_sub_f32 v1, 0, v1
    v_exp_f32 v1, v1
    s_nop 0
    v_mul_f32 v63, v63, v1
    v_mul_f32 v64, v64, v1
    v_mul_f32 v68, v68, v1
    v_mul_f32 v69, v69, v1
    v_mul_f32 v70, v70, v1
    v_mul_f32 v71, v71, v1
    v_mov_b32 v2, 1
    ds_write_b32 v254, v2 offset:4096
    s_waitcnt lgkmcnt(0)
    s_nop 3
    s_setpc_b64 s[54:55]
L_rare3:
    s_nop 7
    s_nop 7
    v_mov_b32 v2, v1
    s_nop 1
    v_permlane32_swap_b32 v1, v2
    v_max_f32 v1, v1, v2
    v_mov_b32 v2, v1
    s_nop 1
    v_permlane16_swap_b32 v1, v2
    v_max_f32 v1, v1, v2
    v_max_f32 v1, 0, v1
    v_sub_f32 v62, v62, v1
    v_sub_f32 v104, v104, v1
    v_sub_f32 v105, v105, v1
    v_sub_f32 v106, v106, v1
    v_sub_f32 v107, v107, v1
    v_sub_f32 v1, 0, v1
    v_exp_f32 v1, v1
    s_nop 0
    v_mul_f32 v63, v63, v1
    v_mul_f32 v64, v64, v1
    v_mul_f32 v68, v68, v1
    v_mul_f32 v69, v69, v1
    v_mul_f32 v70, v70, v1
    v_mul_f32 v71, v71, v1
    v_mul_f32 v88, v88, v1
    v_mul_f32 v89, v89, v1
    v_mul_f32 v90, v90, v1
    v_mul_f32 v91, v91, v1
    v_mov_b32 v2, 1
    ds_write_b32 v254, v2 offset:4096
    s_waitcnt lgkmcnt(0)
    s_nop 3
    s_setpc_b64 s[54:55]
L_rare5:
    s_nop 7
    s_nop 7
    v_mov_b32 v2, v1
    s_nop 1
    v_permlane32_swap_b32 v1, v2
    v_max_f32 v1, v1, v2
    v_mov_b32 v2, v1
    s_nop 1
    v_permlane16_swap_b32 v1, v2
    v_max_f32 v1, v1, v2
    v_max_f32 v1, 0, v1
    v_sub_f32 v62, v62, v1
    v_sub_f32 v104, v104, v1
    v_sub_f32 v105, v105, v1
    v_sub_f32 v106, v106, v1
    v_sub_f32 v107, v107, v1
    v_sub_f32 v1, 0, v1
    v_exp_f32 v1, v1
    s_nop 0
    v_mul_f32 v63, v63, v1
    v_mul_f32 v64, v64, v1
    v_mul_f32 v68, v68, v1
    v_mul_f32 v69, v69, v1
    v_mul_f32 v70, v70, v1
    v_mul_f32 v71, v71, v1
    v_mul_f32 v88, v88, v1
    v_mul_f32 v89, v89, v1
    v_mul_f32 v90, v90, v1
    v_mul_f32 v91, v91, v1
    v_cvt_pk_bf16_f32 v72, v88, v89
    v_cvt_pk_bf16_f32 v73, v90, v91
    v_mov_b32 v2, 1
    ds_write_b32 v254, v2 offset:4096
    s_waitcnt lgkmcnt(0)
    s_nop 3
    s_setpc_b64 s[54:55]
L_rare6:
    s_nop 7
    s_nop 7
    v_mov_b32 v2, v1
    s_nop 1
    v_permlane32_swap_b32 v1, v2
    v_max_f32 v1, v1, v2
    v_mov_b32 v2, v1
    s_nop 1
    v_permlane16_swap_b32 v1, v2
    v_max_f32 v1, v1, v2
    v_max_f32 v1, 0, v1
    v_sub_f32 v62, v62, v1
    v_sub_f32 v88, v88, v1
    v_sub_f32 v89, v89, v1
    v_sub_f32 v90, v90, v1
    v_sub_f32 v91, v91, v1
    v_sub_f32 v1, 0, v1
    v_exp_f32 v1, v1
    s_nop 0
    v_mul_f32 v63, v63, v1
    v_mul_f32 v64, v64, v1
    v_mul_f32 v68, v68, v1
    v_mul_f32 v69, v69, v1
    v_mul_f32 v70, v70, v1
    v_mul_f32 v71, v71, v1
    v_mov_b32 v2, 1
    ds_write_b32 v254, v2 offset:4100
    s_waitcnt lgkmcnt(0)
    s_nop 3
    s_setpc_b64 s[54:55]
L_rare7:
    s_nop 7
    s_nop 7
    v_mov_b32 v2, v1
    s_nop 1
    v_permlane32_swap_b32 v1, v2
    v_max_f32 v1, v1, v2
    v_mov_b32 v2, v1
    s_nop 1
    v_permlane16_swap_b32 v1, v2
    v_max_f32 v1, v1, v2
    v_max_f32 v1, 0, v1
    v_sub_f32 v62, v62, v1
    v_sub_f32 v104, v104, v1
    v_sub_f32 v105, v105, v1
    v_sub_f32 v106, v106, v1
    v_sub_f32 v107, v107, v1
    v_sub_f32 v1, 0, v1
    v_exp_f32 v1, v1
    s_nop 0
    v_mul_f32 v63, v63, v1
    v_mul_f32 v64, v64, v1
    v_mul_f32 v68, v68, v1
    v_mul_f32 v69, v69, v1
    v_mul_f32 v70, v70, v1
    v_mul_f32 v71, v71, v1
    v_mul_f32 v88, v88, v1
    v_mul_f32 v89, v89, v1
    v_mul_f32 v90, v90, v1
    v_mul_f32 v91, v91, v1
    v_mov_b32 v2, 1
    ds_write_b32 v254, v2 offset:4100
    s_waitcnt lgkmcnt(0)
    s_nop 3
    s_setpc_b64 s[54:55]
L_codeend:
.section .rodata,"a"
.p2align 6
.amdhsa_kernel standalone__detection_seg_dino__vision_kernel
  .amdhsa_next_free_vgpr 464
  .amdhsa_next_free_sgpr 102
  .amdhsa_accum_offset 256
  .amdhsa_group_segment_fixed_size 0
  .amdhsa_kernarg_size 80
  .amdhsa_user_sgpr_count 2
  .amdhsa_user_sgpr_kernarg_segment_ptr 1
  .amdhsa_system_sgpr_workgroup_id_x 1
  .amdhsa_float_denorm_mode_32 3
.end_amdhsa_kernel
```

```asm
; @launch grid=(256,1,1) block=(256,1,1) lds=163840
.amdgcn_target "amdgcn-amd-amdhsa--gfx950"
.text
.globl standalone__detection_seg_dino__vision_kernel
.p2align 8
.type standalone__detection_seg_dino__vision_kernel,@function
standalone__detection_seg_dino__vision_kernel:
    s_cmp_ge_u32 s2, 256
    s_cbranch_scc1 L_end
    s_load_dwordx16 s[4:19], s[0:1], 0
    s_load_dwordx4 s[20:23], s[0:1], 64
    s_memrealtime s[44:45]
    s_getpc_b64 s[54:55]
L_pc_main:
    v_lshlrev_b32 v233, 7, v0
    v_min_u32 v233, L_codeend - L_pc_main - 4, v233
    global_load_dword v232, v233, s[54:55]
    s_mov_b64 s[100:101], s[54:55]
    v_lshrrev_b32 v1, 6, v0
    v_and_b32 v0, 63, v0
    v_readfirstlane_b32 s3, v1
    v_lshlrev_b32 v65, 4, v0
    v_lshrrev_b32 v1, 2, v0
    v_and_b32 v1, 14, v1
    s_mov_b32 s56, 0x5000
    v_bfe_u32 v2, s56, v1, 2
    v_lshlrev_b32 v2, 5, v2
    v_xor_b32 v16, v65, v2
    s_mov_b32 s56, 0xaa55
    v_bfe_u32 v2, s56, v1, 2
    v_lshlrev_b32 v2, 5, v2
    v_xor_b32 v17, v65, v2
    s_mov_b32 s56, 0xfffa
    v_bfe_u32 v2, s56, v1, 2
    v_lshlrev_b32 v2, 5, v2
    v_xor_b32 v18, v65, v2
    v_xor_b32 v19, 16, v16
    v_xor_b32 v20, 0x1010, v17
    v_xor_b32 v21, 0x1010, v18
    v_lshrrev_b32 v1, 3, v0
    v_and_b32 v1, 6, v1
    s_mov_b32 s56, 0x40
    v_bfe_u32 v2, s56, v1, 2
    v_lshlrev_b32 v2, 5, v2
    v_xor_b32 v22, v65, v2
    s_mov_b32 s56, 0xa5
    v_bfe_u32 v2, s56, v1, 2
    v_lshlrev_b32 v2, 5, v2
    v_xor_b32 v23, v65, v2
    s_mov_b32 s56, 0xfe
    v_bfe_u32 v2, s56, v1, 2
    v_lshlrev_b32 v2, 5, v2
    v_xor_b32 v24, v65, v2
    v_xor_b32 v25, 0x80, v22
    v_xor_b32 v26, 0x1080, v23
    v_xor_b32 v27, 0x1080, v24
    v_xor_b32 v28, 0x1010, v22
    v_xor_b32 v29, 0x1010, v23
    v_xor_b32 v30, 0x2010, v24
    v_xor_b32 v31, 0x2090, v22
    v_xor_b32 v32, 0x2090, v23
    v_xor_b32 v33, 0x2090, v24
    v_mov_b32 v248, 0x10000
    s_mul_i32 s36, s3, 6144
    s_mul_i32 s37, s3, 12288
    s_add_u32 s40, s36, 0
    s_add_u32 s41, s37, 24576
    s_add_u32 s42, s37, 73728
    s_and_b32 s58, s2, 7
    s_lshr_b32 s57, s2, 3
    s_lshl_b32 s58, s58, 5
    s_add_u32 s58, s58, s57
    s_lshr_b32 s56, s58, 2
    s_mul_i32 s56, s56, 196608
    s_mul_i32 s57, s58, 24576
    s_lshl1_add_u32 s56, s57, s56
    s_mov_b64 s[60:61], s[56:57]
    s_and_b32 s98, s2, 7
    s_cmp_lt_u32 s2, 48
    s_cselect_b32 s98, s98, 0
    s_mov_b32 s30, 18898944
    s_mov_b32 s31, 0x20000
    s_mov_b32 s26, 75743232
    s_mov_b32 s27, 0x20000
    s_mov_b32 s34, 16777216
    s_mov_b32 s35, 0x20000
    s_mov_b32 m0, s40
    s_and_b32 s56, s2, 7
    s_cmp_eq_u32 s56, 2
    s_cbranch_scc1 L_spec
    s_and_b32 s56, s2, 7
    s_cbranch_scc1 L_plain
L_spec:
    s_waitcnt lgkmcnt(0)
    s_add_u32 s28, s8, s61
    s_addc_u32 s29, s9, 0
    s_add_u32 s24, s6, s60
    s_addc_u32 s25, s7, 0
    s_mov_b64 s[32:33], s[22:23]
    s_lshr_b32 s43, s2, 3
    s_mul_i32 s57, s43, 2304
    v_min_u32 v1, 17, v0
    v_lshlrev_b32 v1, 7, v1
    s_mov_b32 s66, 73728
    s_mov_b32 s67, 0x20000
    s_mov_b32 s70, 73728
    s_mov_b32 s71, 0x20000
    s_mov_b32 s72, s4
    s_mov_b32 s73, s5
    s_mov_b32 s74, 6144
    s_mov_b32 s75, 0x20000
    s_bitcmp1_b32 s2, 1
    s_cselect_b64 s[64:65], s[16:17], s[10:11]
    s_cselect_b64 s[68:69], s[14:15], s[12:13]
    s_cmp_eq_u32 s3, 0
    s_cbranch_scc1 L_pf0
    s_cmp_eq_u32 s3, 1
    s_cbranch_scc0 L_pfdone
    s_lshl_b32 s58, s43, 8
    buffer_load_dword v234, v1, s[68:71], s57 offen
    v_min_u32 v2, 128, v1
    buffer_load_dword v235, v2, s[72:75], s58 offen
    s_branch L_pfdone
L_pf0:
    buffer_load_dword v234, v1, s[64:67], s57 offen
L_pfdone:
    s_cmp_ge_u32 s43, 3
    s_cbranch_scc1 L_nopf
    s_mov_b32 s0, 1
    s_bitcmp1_b32 s2, 1
    s_cbranch_scc0 L_prod
    s_branch L_vprod
L_plain:
    s_waitcnt lgkmcnt(0)
    s_cmp_eq_u32 s98, 1
    s_cbranch_scc0 L_nopf
    s_lshl2_add_u32 s20, s2, s3
    s_lshl4_add_u32 s20, s20, s44
    s_mul_i32 s20, s20, 0x9e3779b1
    s_lshr_b32 s20, s20, 11
    s_and_b32 s20, s20, 0x1fdf80
    s_bfe_u32 s56, s2, 0x10003
    s_lshl_b32 s56, s56, 13
    s_add_u32 s56, s56, 6291456
    s_add_u32 s56, s56, s20
    s_load_dword s38, s[22:23], s56
    s_memtime s[20:21]
L_nopf:
    s_add_u32 s28, s8, s61
    s_addc_u32 s29, s9, 0
    buffer_load_dwordx4 v16, s[28:31], s36 offen offset:0 nt lds
    s_add_u32 s24, s6, s60
    s_addc_u32 s25, s7, 0
    s_mov_b64 s[32:33], s[22:23]
    s_mov_b32 s0, 0
    buffer_load_dwordx4 v17, s[28:31], s36 offen offset:1024 nt lds
    buffer_load_dwordx4 v18, s[28:31], s36 offen offset:2048 nt lds
    buffer_load_dwordx4 v19, s[28:31], s36 offen offset:3072 nt lds
    s_add_u32 m0, s40, 4096
    s_nop 0
    buffer_load_dwordx4 v20, s[28:31], s36 offen offset:0 nt lds
    buffer_load_dwordx4 v21, s[28:31], s36 offen offset:1024 nt lds
    s_mov_b32 s43, -1
    s_sub_u32 s59, s2, 64
    s_lshr_b32 s59, s59, 4
    s_and_b32 s56, s2, 7
    s_lshl3_add_u32 s59, s59, s56
    s_cmp_ge_u32 s59, 64
    s_cbranch_scc1 L_nocs
    s_mov_b32 s64, s4
    s_mov_b32 s65, s5
    s_mov_b32 s66, 6144
    s_mov_b32 s67, 0x20000
    s_mov_b32 s68, s18
    s_mov_b32 s69, s19
    s_mov_b32 s70, 6144
    s_mov_b32 s71, 0x20000
    v_and_b32 v1, 1, v0
    v_bfe_u32 v2, v0, 1, 1
    s_bfe_u32 s57, s2, 0x10003
    s_lshr_b32 s56, s59, 4
    s_lshl2_add_u32 s56, s56, s57
    s_add_u32 s56, s56, s57
    v_add_u32 v2, s56, v2
    v_lshlrev_b32 v252, 2, v2
    v_lshrrev_b32 v3, 4, v0
    v_mad_u32_u24 v3, v1, 3, v3
    v_lshrrev_b32 v4, 1, v3
    v_and_b32 v3, 1, v3
    v_lshlrev_b32 v3, 2, v3
    v_lshl_add_u32 v3, v4, 5, v3
    v_bfe_u32 v4, v0, 3, 1
    v_lshl_add_u32 v3, v4, 1, v3
    v_mul_u32_u24 v2, 384, v2
    s_bfe_u32 s56, s59, 0x20002
    s_mul_i32 s56, s56, 96
    s_and_b32 s57, s59, 3
    s_lshl_b32 s57, s57, 3
    s_add_u32 s56, s56, s57
    v_add3_u32 v248, s56, v2, v3
    v_and_b32 v3, 4, v0
    v_cmp_eq_u32 vcc, 4, v3
    s_nop 1
    v_cndmask_b32 v3, 63, v0, vcc
    v_cmp_gt_u32 vcc, 48, v3
    v_mov_b32 v4, 0x10000
    s_lshl_b32 s56, s3, 2
    v_cndmask_b32 v248, v4, v248, vcc
    buffer_load_ushort v249, v248, s[64:67], 0 offen
    s_xor_b32 s59, s2, 64
    s_or_b32 s57, s59, s3
    s_cselect_b32 s70, 0, 6144
    v_lshlrev_b32 v4, 7, v0
    buffer_load_ushort v246, v4, s[68:71], 0 offen
    v_add_u32 v250, s56, v65
    v_and_b32 v251, 0x70, v65
L_nocs:
    s_cmp_eq_u32 s98, 1
    s_cbranch_scc0 L_noprobe
    s_waitcnt lgkmcnt(0)
    s_memtime s[54:55]
    s_waitcnt lgkmcnt(0)
    s_sub_u32 s20, s54, s20
    s_add_u32 s98, s3, 1
L_noprobe:
    s_load_dword s38, s[22:23], 0
    s_add_u32 m0, s41, 0
    s_add_u32 s58, s37, 0
    buffer_load_dwordx4 v22, s[24:27], s58 offen offset:0 nt lds
    buffer_load_dwordx4 v23, s[24:27], s58 offen offset:1024 nt lds
    buffer_load_dwordx4 v24, s[24:27], s58 offen offset:2048 nt lds
    buffer_load_dwordx4 v25, s[24:27], s58 offen offset:3072 nt lds
    s_add_u32 m0, s41, 4096
    s_nop 0
    buffer_load_dwordx4 v26, s[24:27], s58 offen offset:0 nt lds
    buffer_load_dwordx4 v27, s[24:27], s58 offen offset:1024 nt lds
    buffer_load_dwordx4 v28, s[24:27], s58 offen offset:2048 nt lds
    buffer_load_dwordx4 v29, s[24:27], s58 offen offset:3072 nt lds
    s_add_u32 m0, s41, 8192
    s_nop 0
    buffer_load_dwordx4 v30, s[24:27], s58 offen offset:0 nt lds
    buffer_load_dwordx4 v31, s[24:27], s58 offen offset:1024 nt lds
    buffer_load_dwordx4 v32, s[24:27], s58 offen offset:2048 nt lds
    buffer_load_dwordx4 v33, s[24:27], s58 offen offset:3072 nt lds
    s_add_u32 m0, s42, 0
    s_add_u32 s59, s37, 196608
    buffer_load_dwordx4 v22, s[24:27], s59 offen offset:0 nt lds
    buffer_load_dwordx4 v23, s[24:27], s59 offen offset:1024 nt lds
    buffer_load_dwordx4 v24, s[24:27], s59 offen offset:2048 nt lds
    buffer_load_dwordx4 v25, s[24:27], s59 offen offset:3072 nt lds
    s_add_u32 m0, s42, 4096
    s_nop 0
    buffer_load_dwordx4 v26, s[24:27], s59 offen offset:0 nt lds
    buffer_load_dwordx4 v27, s[24:27], s59 offen offset:1024 nt lds
    buffer_load_dwordx4 v28, s[24:27], s59 offen offset:2048 nt lds
    buffer_load_dwordx4 v29, s[24:27], s59 offen offset:3072 nt lds
    s_add_u32 m0, s42, 8192
    s_nop 0
    buffer_load_dwordx4 v30, s[24:27], s59 offen offset:0 nt lds
    buffer_load_dwordx4 v31, s[24:27], s59 offen offset:1024 nt lds
    buffer_load_dwordx4 v32, s[24:27], s59 offen offset:2048 nt lds
    buffer_load_dwordx4 v33, s[24:27], s59 offen offset:3072 nt lds
    v_and_b32 v1, 15, v0
    v_lshrrev_b32 v6, 5, v0
    v_bfe_u32 v3, v0, 4, 1
    v_lshl_or_b32 v3, v3, 1, v6
    v_lshrrev_b32 v4, 2, v0
    v_bfe_u32 v5, v0, 1, 1
    v_lshrrev_b32 v6, 3, v1
    v_and_or_b32 v6, v1, 6, v6
    v_xor_b32 v6, v6, v3
    v_mul_u32_u24 v7, 384, v1
    v_lshl_add_u32 v6, v6, 4, v7
    v_add_u32 v34, s40, v6
    v_xor_b32 v35, 64, v34
    v_lshrrev_b32 v6, 3, v1
    v_and_b32 v7, 7, v1
    v_lshl_or_b32 v6, v7, 1, v6
    v_xor_b32 v6, v6, v3
    v_mul_u32_u24 v7, 768, v1
    v_lshl_add_u32 v6, v6, 4, v7
    v_add_u32 v40, s41, v6
    v_xor_b32 v41, 0x40, v40
    v_xor_b32 v42, 0x80, v40
    v_xor_b32 v43, 0xc0, v40
    v_and_b32 v2, 1, v0
    v_lshlrev_b32 v2, 3, v2
    s_mul_i32 s56, s3, 96
    v_lshrrev_b32 v6, 3, v4
    v_and_or_b32 v6, v4, 6, v6
    v_xor_b32 v6, v6, v5
    v_lshl_add_u32 v6, v6, 4, v2
    v_mul_u32_u24 v7, 384, v4
    s_add_u32 s57, s56, 0
    v_xad_u32 v36, v6, s57, v7
    s_add_u32 s57, s56, 32
    v_xad_u32 v37, v6, s57, v7
    s_add_u32 s57, s56, 64
    v_xad_u32 v38, v6, s57, v7
    v_lshrrev_b32 v6, 3, v4
    v_and_b32 v3, 7, v4
    v_lshl_or_b32 v6, v3, 1, v6
    v_xor_b32 v6, v6, v5
    v_lshl_add_u32 v6, v6, 4, v2
    v_lshlrev_b32 v7, 1, v7
    v_add_u32 v7, 24576, v7
    s_add_u32 s57, s56, 0
    v_xad_u32 v44, v6, s57, v7
    s_add_u32 s57, s56, 384
    v_xad_u32 v45, v6, s57, v7
    s_add_u32 s57, s56, 32
    v_xad_u32 v46, v6, s57, v7
    s_add_u32 s57, s56, 416
    v_xad_u32 v47, v6, s57, v7
    s_add_u32 s57, s56, 64
    v_xad_u32 v48, v6, s57, v7
    s_add_u32 s57, s56, 448
    v_xad_u32 v49, v6, s57, v7
    v_mov_b32 v52, 0x3f803f80
    v_mov_b32 v56, 0x3ebcbe62
    s_mov_b32 s44, 0x100001
    s_mov_b32 s45, 0x10000100
    v_mov_b32 v53, 0x3f803f80
    v_mov_b32 v57, 0x3ebcbe62
    s_mov_b32 s46, 0x200002
    s_mov_b32 s47, 0x20000200
    v_mov_b32 v54, 0x3f803f80
    v_mov_b32 v58, 0x3ebcbe62
    s_mov_b32 s48, 0x400004
    s_mov_b32 s49, 0x40000400
    v_mov_b32 v55, 0x3f803f80
    v_mov_b32 v59, 0x3ebcbe62
    s_mov_b32 s50, 0x800008
    s_mov_b32 s51, 0x80000800
    v_mov_b32 v60, 0x43400000
    v_lshrrev_b32 v1, 5, v0
    v_lshlrev_b32 v1, 8, v1
    v_and_b32 v2, 15, v0
    v_lshl_add_u32 v1, v2, 4, v1
    v_bfe_u32 v2, v0, 4, 1
    v_lshl_add_u32 v1, v2, 3, v1
    s_mul_i32 s56, s3, 1536
    s_add_u32 s56, s56, 147456
    v_add_u32 v236, s56, v1
    s_mul_i32 s56, s3, 3072
    s_add_u32 s56, s56, 24576
    v_add_u32 v237, s56, v65
    v_add_u32 v238, s41, v65
    s_lshl_b32 s56, s3, 10
    v_add_u32 v240, 159744, v65
    v_add_u32 v239, s56, v240
    v_add_u32 v241, 147456, v65
    v_bfe_u32 v1, v0, 2, 2
    v_lshrrev_b32 v2, 4, v0
    v_lshl_or_b32 v1, v1, 4, v2
    v_mul_u32_u24 v1, 65536, v1
    v_and_b32 v2, 3, v0
    v_lshl_or_b32 v242, v2, 5, v1
    v_xor_b32 v243, 0x70, v242
    s_mul_i32 s56, s3, 3
    v_min_u32 v1, 2, v0
    v_add_u32 v1, s56, v1
    v_min_u32 v2, 8, v0
    v_add_u32 v2, 9, v2
    v_cmp_gt_u32 vcc, 3, v0
    s_nop 1
    v_cndmask_b32 v1, v2, v1, vcc
    v_lshlrev_b32 v245, 7, v1
    v_lshlrev_b32 v1, 3, v0
    v_add_u32 v254, 126976, v1
    s_lshl_b32 s56, s3, 9
    v_add_u32 v238, s56, v254
    v_add_u32 v253, 122880, v65
    s_lshl_b32 s56, s3, 10
    v_add_u32 v237, s56, v253
    s_mov_b32 s52, 0x41c00000
L_join:
    s_mul_i32 s60, s3, 18432
    s_mov_b32 s72, s22
    s_mov_b32 s73, s23
    s_mov_b32 s74, 16777216
    s_mov_b32 s75, 0x20000
    s_cmp_eq_u32 s0, 1
    s_cselect_b32 s74, 0, s74
    s_waitcnt vmcnt(24)
    s_waitcnt lgkmcnt(0)
    s_barrier
    ds_read_b128 a[48:51], v34 offset:0
    ds_read_b128 a[52:55], v35 offset:0
    ds_read_b128 a[56:59], v34 offset:128
    ds_read_b128 a[60:63], v35 offset:128
    ds_read_b128 a[64:67], v34 offset:256
    ds_read_b128 a[68:71], v35 offset:256
    s_waitcnt lgkmcnt(5)
    v_mfma_f32_16x16x32_bf16 v[84:87], a[48:51], a[48:51], 0
    ds_read_b64_tr_b16 a[72:73], v36 offset:0
    ds_read_b64_tr_b16 a[74:75], v36 offset:6144
    v_mfma_f32_16x16x32_bf16 v[80:83], a[48:51], v[52:55], 0
    ds_read_b64_tr_b16 a[76:77], v36 offset:12288
    ds_read_b64_tr_b16 a[78:79], v36 offset:18432
    s_waitcnt lgkmcnt(8)
    v_mfma_f32_16x16x32_bf16 v[84:87], a[52:55], a[52:55], v[84:87]
    ds_read_b64_tr_b16 a[80:81], v37 offset:0
    ds_read_b64_tr_b16 a[82:83], v37 offset:6144
    v_mfma_f32_16x16x32_bf16 v[80:83], a[52:55], v[52:55], v[80:83]
    ds_read_b64_tr_b16 a[84:85], v37 offset:12288
    ds_read_b64_tr_b16 a[86:87], v37 offset:18432
    s_waitcnt lgkmcnt(11)
    v_mfma_f32_16x16x32_bf16 v[84:87], a[56:59], a[56:59], v[84:87]
    ds_read_b64_tr_b16 a[88:89], v38 offset:0
    ds_read_b64_tr_b16 a[90:91], v38 offset:6144
    v_mfma_f32_16x16x32_bf16 v[80:83], a[56:59], v[52:55], v[80:83]
    ds_read_b64_tr_b16 a[92:93], v38 offset:12288
    ds_read_b64_tr_b16 a[94:95], v38 offset:18432
    s_waitcnt lgkmcnt(14)
    v_mfma_f32_16x16x32_bf16 v[84:87], a[60:63], a[60:63], v[84:87]
    v_mfma_f32_16x16x32_bf16 v[80:83], a[60:63], v[52:55], v[80:83]
    s_waitcnt lgkmcnt(13)
    v_mfma_f32_16x16x32_bf16 v[84:87], a[64:67], a[64:67], v[84:87]
    v_mfma_f32_16x16x32_bf16 v[80:83], a[64:67], v[52:55], v[80:83]
    s_waitcnt lgkmcnt(12)
    v_mfma_f32_16x16x32_bf16 v[84:87], a[68:71], a[68:71], v[84:87]
    v_mfma_f32_16x16x32_bf16 v[80:83], a[68:71], v[52:55], v[80:83]
    s_waitcnt lgkmcnt(0)
    s_mul_i32 s39, s38, 0x9e3779b1
    s_add_u32 s39, s39, 0x7f4a7c16
    s_or_b32 s39, s39, 1
    s_mul_i32 s56, s3, 3072
    s_add_u32 s56, s56, 16384
    buffer_load_dwordx4 v[136:139], v65, s[32:35], s56 offen offset:0 sc1
    buffer_load_dwordx4 v[140:143], v65, s[32:35], s56 offen offset:1024 sc1
    buffer_load_dwordx4 v[144:147], v65, s[32:35], s56 offen offset:2048 sc1
    s_waitcnt vmcnt(15)
    s_barrier
    ds_read_b128 a[96:99], v40 offset:0
    ds_read_b128 a[100:103], v41 offset:0
    ds_read_b128 a[104:107], v42 offset:0
    ds_read_b128 a[108:111], v43 offset:0
    ds_read_b128 a[112:115], v40 offset:256
    ds_read_b128 a[116:119], v41 offset:256
    ds_read_b128 a[120:123], v42 offset:256
    ds_read_b128 a[124:127], v43 offset:256
    ds_read_b128 a[128:131], v40 offset:512
    ds_read_b128 a[132:135], v41 offset:512
    ds_read_b128 a[136:139], v42 offset:512
    ds_read_b128 a[140:143], v43 offset:512
    ds_read_b64_tr_b16 a[144:145], v44 offset:0
    ds_read_b64_tr_b16 a[146:147], v45 offset:0
    ds_read_b64_tr_b16 a[148:149], v44 offset:12288
    ds_read_b64_tr_b16 a[150:151], v45 offset:12288
    ds_read_b64_tr_b16 a[152:153], v44 offset:24576
    ds_read_b64_tr_b16 a[154:155], v45 offset:24576
    ds_read_b64_tr_b16 a[156:157], v44 offset:36864
    ds_read_b64_tr_b16 a[158:159], v45 offset:36864
    ds_read_b64_tr_b16 a[160:161], v46 offset:0
    ds_read_b64_tr_b16 a[162:163], v47 offset:0
    ds_read_b64_tr_b16 a[164:165], v46 offset:12288
    ds_read_b64_tr_b16 a[166:167], v47 offset:12288
    ds_read_b64_tr_b16 a[168:169], v46 offset:24576
    ds_read_b64_tr_b16 a[170:171], v47 offset:24576
    ds_read_b64_tr_b16 a[172:173], v46 offset:36864
    ds_read_b64_tr_b16 a[174:175], v47 offset:36864
    ds_read_b64_tr_b16 a[176:177], v48 offset:0
    ds_read_b64_tr_b16 a[178:179], v49 offset:0
    ds_read_b64_tr_b16 a[180:181], v48 offset:12288
    ds_read_b64_tr_b16 a[182:183], v49 offset:12288
    ds_read_b64_tr_b16 a[184:185], v48 offset:24576
    ds_read_b64_tr_b16 a[186:187], v49 offset:24576
    ds_read_b64_tr_b16 a[188:189], v48 offset:36864
    ds_read_b64_tr_b16 a[190:191], v49 offset:36864
    s_waitcnt lgkmcnt(0)
    s_barrier
    s_cmp_ge_u32 s43, 3
    s_cbranch_scc1 L_v_nofl
    s_mul_i32 s56, s3, 3
    s_add_u32 s56, s56, s43
    s_lshl_b32 s56, s56, 7
    v_mov_b32 v1, s39
    v_mov_b32 v2, 0
    s_mov_b64 exec, 1
    s_waitcnt vmcnt(9)
    buffer_store_dword v1, v2, s[32:35], s56 offen offset:128 sc1
    s_mov_b64 exec, -1
L_v_nofl:
    s_cmp_eq_u32 s98, 1
    s_cbranch_scc0 L_nopub
    s_lshl_b32 s56, s2, 4
    v_mov_b32 v2, s39
    v_mov_b32 v3, s20
    v_mov_b32 v1, 0
    s_mov_b64 exec, 1
    buffer_store_dwordx2 v[2:3], v1, s[32:35], s56 offen offset:1648 sc1
    s_mov_b64 exec, -1
L_nopub:
    v_mfma_f32_16x16x32_bf16 v[96:99], a[96:99], a[96:99], v[84:87]
    s_cmp_eq_u32 s0, 0
    s_cbranch_scc0 L_g1
    s_waitcnt vmcnt(11)
L_g1:
    s_add_u32 m0, s40, 0
    s_add_u32 s57, s36, 6291456
    buffer_load_dwordx4 v16, s[28:31], s57 offen offset:0 nt lds
    v_add_u32 v44, 49152, v44
    v_add_u32 v45, 49152, v45
    v_mfma_f32_16x16x32_bf16 v[100:103], a[96:99], a[48:51], 0
    s_cmp_eq_u32 s0, 0
    s_cbranch_scc0 L_g2
    s_waitcnt vmcnt(11)
L_g2:
    buffer_load_dwordx4 v17, s[28:31], s57 offen offset:1024 nt lds
    v_add_u32 v46, 49152, v46
    v_add_u32 v47, 49152, v47
    v_mfma_f32_16x16x32_bf16 v[96:99], a[100:103], a[100:103], v[96:99]
    v_add_u32 v48, 49152, v48
    v_add_u32 v49, 49152, v49
    v_mfma_f32_16x16x32_bf16 v[100:103], a[100:103], a[52:55], v[100:103]
    v_mfma_f32_16x16x32_bf16 v[96:99], a[104:107], a[104:107], v[96:99]
    v_mfma_f32_16x16x32_bf16 v[100:103], a[104:107], a[56:59], v[100:103]
    v_mfma_f32_16x16x32_bf16 v[96:99], a[108:111], a[108:111], v[96:99]
    v_mfma_f32_16x16x32_bf16 v[100:103], a[108:111], a[60:63], v[100:103]
    v_mfma_f32_16x16x32_bf16 v[96:99], a[112:115], a[112:115], v[96:99]
    v_mfma_f32_16x16x32_bf16 v[100:103], a[112:115], a[64:67], v[100:103]
    v_mfma_f32_16x16x32_bf16 v[96:99], a[116:119], a[116:119], v[96:99]
    v_mfma_f32_16x16x32_bf16 v[100:103], a[116:119], a[68:71], v[100:103]
    v_mfma_f32_16x16x32_bf16 v[92:95], a[96:99], v[52:55], v[80:83]
    v_mfma_f32_16x16x32_bf16 v[92:95], a[100:103], v[52:55], v[92:95]
    s_cmp_eq_u32 s0, 0
    s_cbranch_scc0 L_g3
    s_waitcnt vmcnt(11)
L_g3:
    buffer_load_dwordx4 v18, s[28:31], s57 offen offset:2048 nt lds
    v_mfma_f32_16x16x32_bf16 v[92:95], a[104:107], v[52:55], v[92:95]
    v_mfma_f32_16x16x32_bf16 v[92:95], a[108:111], v[52:55], v[92:95]
    v_fma_f32 v96, v100, 2.0, v96
    v_fma_f32 v97, v101, 2.0, v97
    v_mfma_f32_16x16x32_bf16 v[92:95], a[112:115], v[52:55], v[92:95]
    v_fma_f32 v98, v102, 2.0, v98
    v_fma_f32 v99, v103, 2.0, v99
    v_mfma_f32_16x16x32_bf16 v[92:95], a[116:119], v[52:55], v[92:95]
    v_cndmask_b32 v3, 0, v96, s[44:45]
    v_cndmask_b32 v3, v3, v97, s[46:47]
    v_mfma_f32_16x16x32_bf16 v[112:115], a[120:123], a[120:123], v[84:87]
    v_cndmask_b32 v3, v3, v98, s[48:49]
    v_cndmask_b32 v3, v3, v99, s[50:51]
    v_mfma_f32_16x16x32_bf16 v[116:119], a[120:123], a[48:51], 0
    s_nop 0
    s_nop 0
    v_mfma_f32_16x16x32_bf16 v[112:115], a[124:127], a[124:127], v[112:115]
    v_mfma_f32_16x16x4_f32 v[120:123], v3, v60, v[56:59]
    v_mfma_f32_16x16x32_bf16 v[116:119], a[124:127], a[52:55], v[116:119]
    v_mfma_f32_16x16x32_bf16 v[112:115], a[128:131], a[128:131], v[112:115]
    v_mfma_f32_16x16x32_bf16 v[116:119], a[128:131], a[56:59], v[116:119]
    v_mfma_f32_16x16x32_bf16 v[112:115], a[132:135], a[132:135], v[112:115]
    s_cmp_eq_u32 s0, 0
    s_cbranch_scc0 L_g4
    s_waitcnt vmcnt(11)
L_g4:
    buffer_load_dwordx4 v19, s[28:31], s57 offen offset:3072 nt lds
    s_nop 1
    v_fma_f32 v128, -v92, v92, v120
    v_fma_f32 v129, -v93, v93, v121
    v_mfma_f32_16x16x32_bf16 v[116:119], a[132:135], a[60:63], v[116:119]
    v_fma_f32 v130, -v94, v94, v122
    v_fma_f32 v131, -v95, v95, v123
    v_mfma_f32_16x16x32_bf16 v[112:115], a[136:139], a[136:139], v[112:115]
    v_max_f32 v128, v128, v56
    v_max_f32 v129, v129, v56
    v_mfma_f32_16x16x32_bf16 v[116:119], a[136:139], a[64:67], v[116:119]
    v_max_f32 v130, v130, v56
    v_max_f32 v131, v131, v56
    v_mfma_f32_16x16x32_bf16 v[112:115], a[140:143], a[140:143], v[112:115]
    v_rsq_f32 v128, v128
    v_mfma_f32_16x16x32_bf16 v[116:119], a[140:143], a[68:71], v[116:119]
    v_rsq_f32 v129, v129
    v_mfma_f32_16x16x32_bf16 v[108:111], a[120:123], v[52:55], v[80:83]
    v_rsq_f32 v130, v130
    v_mfma_f32_16x16x32_bf16 v[108:111], a[124:127], v[52:55], v[108:111]
    v_rsq_f32 v131, v131
    v_mfma_f32_16x16x32_bf16 v[108:111], a[128:131], v[52:55], v[108:111]
    v_mfma_f32_16x16x32_bf16 v[108:111], a[132:135], v[52:55], v[108:111]
    v_mfma_f32_16x16x32_bf16 v[108:111], a[136:139], v[52:55], v[108:111]
    v_fma_f32 v112, v116, 2.0, v112
    v_fma_f32 v113, v117, 2.0, v113
    v_mfma_f32_16x16x32_bf16 v[108:111], a[140:143], v[52:55], v[108:111]
    v_fma_f32 v114, v118, 2.0, v114
    v_fma_f32 v115, v119, 2.0, v115
    v_cndmask_b32 v4, 0, v112, s[44:45]
    v_cndmask_b32 v4, v4, v113, s[46:47]
    v_cndmask_b32 v4, v4, v114, s[48:49]
    v_cndmask_b32 v4, v4, v115, s[50:51]
    s_nop 0
    s_nop 0
    v_mfma_f32_16x16x4_f32 v[124:127], v4, v60, v[56:59]
    s_nop 9
    v_fma_f32 v132, -v108, v108, v124
    v_fma_f32 v133, -v109, v109, v125
    v_fma_f32 v134, -v110, v110, v126
    v_fma_f32 v135, -v111, v111, v127
    v_max_f32 v132, v132, v56
    v_max_f32 v133, v133, v56
    v_max_f32 v134, v134, v56
    v_max_f32 v135, v135, v56
    v_rsq_f32 v132, v132
    v_rsq_f32 v133, v133
    v_rsq_f32 v134, v134
    v_rsq_f32 v135, v135
    s_mul_i32 s56, s3, 1536
    v_lshlrev_b32 v5, 3, v0
    v_add_u32 v5, 153600, v5
    v_add_u32 v4, s56, v5
    s_cmp_eq_u32 s0, 0
    s_cbranch_scc0 L_g5
    s_waitcnt vmcnt(11)
L_g5:
    s_add_u32 m0, s40, 4096
    s_nop 0
    buffer_load_dwordx4 v20, s[28:31], s57 offen offset:0 nt lds
    s_cmp_eq_u32 s0, 0
    s_cbranch_scc0 L_g6
    s_waitcnt vmcnt(11)
L_g6:
    buffer_load_dwordx4 v21, s[28:31], s57 offen offset:1024 nt lds
    s_cmp_eq_u32 s0, 0
    s_cbranch_scc0 L_g7
    s_waitcnt vmcnt(11)
L_g7:
    s_add_u32 m0, s41, 0
    s_add_u32 s58, s37, 25165824
    buffer_load_dwordx4 v22, s[24:27], s58 offen offset:0 nt lds
    s_cmp_eq_u32 s0, 0
    s_cbranch_scc0 L_g8
    s_waitcnt vmcnt(11)
L_g8:
    buffer_load_dwordx4 v23, s[24:27], s58 offen offset:1024 nt lds
    s_cmp_eq_u32 s0, 0
    s_cbranch_scc0 L_g9
    s_waitcnt vmcnt(7)
L_g9:
    buffer_load_dwordx4 v24, s[24:27], s58 offen offset:2048 nt lds
    s_cmp_eq_u32 s0, 0
    s_cbranch_scc0 L_g10
    s_waitcnt vmcnt(7)
L_g10:
    buffer_load_dwordx4 v25, s[24:27], s58 offen offset:3072 nt lds
    s_cmp_eq_u32 s0, 0
    s_cbranch_scc0 L_g11
    s_waitcnt vmcnt(7)
L_g11:
    s_add_u32 m0, s41, 4096
    s_nop 0
    buffer_load_dwordx4 v26, s[24:27], s58 offen offset:0 nt lds
    s_waitcnt vmcnt(11)
    v_xor_b32 v1, s39, v138
    v_xor_b32 v2, s39, v142
    v_xor_b32 v3, s39, v146
    v_or3_b32 v1, v1, v2, v3
    v_cmp_ne_u32 vcc, 0, v1
    s_cbranch_vccnz L_qk_retry
L_qk_ok:
    ds_write_b64 v4, v[136:137] offset:0
    ds_write_b64 v4, v[140:141] offset:512
    ds_write_b64 v4, v[144:145] offset:1024
    s_waitcnt lgkmcnt(0)
    s_barrier
    ds_read2st64_b64 v[136:139], v5 offset0:0 offset1:1
    ds_read2st64_b64 v[140:143], v5 offset0:2 offset1:3
    ds_read2st64_b64 v[144:147], v5 offset0:4 offset1:5
    ds_read2st64_b64 v[148:151], v5 offset0:6 offset1:7
    ds_read2st64_b64 v[152:155], v5 offset0:8 offset1:9
    ds_read2st64_b64 v[156:159], v5 offset0:10 offset1:11
    s_waitcnt lgkmcnt(5)
    v_mfma_f32_16x16x32_bf16 v[120:123], v[52:55], v[136:139], 0
    v_mfma_f32_16x16x32_bf16 v[76:79], a[48:51], v[136:139], 0
    s_waitcnt lgkmcnt(4)
    v_mfma_f32_16x16x32_bf16 v[120:123], v[52:55], v[140:143], v[120:123]
    v_mfma_f32_16x16x32_bf16 v[76:79], a[52:55], v[140:143], v[76:79]
    s_waitcnt lgkmcnt(3)
    v_mfma_f32_16x16x32_bf16 v[120:123], v[52:55], v[144:147], v[120:123]
    v_mfma_f32_16x16x32_bf16 v[76:79], a[56:59], v[144:147], v[76:79]
    s_waitcnt lgkmcnt(2)
    v_mfma_f32_16x16x32_bf16 v[120:123], v[52:55], v[148:151], v[120:123]
    v_mfma_f32_16x16x32_bf16 v[76:79], a[60:63], v[148:151], v[76:79]
    s_cmp_eq_u32 s0, 0
    s_cbranch_scc0 L_g12
    s_waitcnt vmcnt(7)
L_g12:
    buffer_load_dwordx4 v27, s[24:27], s58 offen offset:1024 nt lds
    s_waitcnt lgkmcnt(1)
    v_mfma_f32_16x16x32_bf16 v[120:123], v[52:55], v[152:155], v[120:123]
    v_mfma_f32_16x16x32_bf16 v[76:79], a[64:67], v[152:155], v[76:79]
    s_waitcnt lgkmcnt(0)
    v_mfma_f32_16x16x32_bf16 v[120:123], v[52:55], v[156:159], v[120:123]
    v_mfma_f32_16x16x32_bf16 v[76:79], a[68:71], v[156:159], v[76:79]
    s_nop 6
    v_mul_f32 v61, 0x3baaaaab, v120
    v_mfma_f32_16x16x32_bf16 v[88:91], a[96:99], v[136:139], v[76:79]
    v_mov_b32 v9, 0
    v_mfma_f32_16x16x32_bf16 v[88:91], a[100:103], v[140:143], v[88:91]
    v_mfma_f32_16x16x32_bf16 v[88:91], a[104:107], v[144:147], v[88:91]
    v_mfma_f32_16x16x32_bf16 v[88:91], a[108:111], v[148:151], v[88:91]
    v_mfma_f32_16x16x32_bf16 v[88:91], a[112:115], v[152:155], v[88:91]
    v_mfma_f32_16x16x32_bf16 v[88:91], a[116:119], v[156:159], v[88:91]
    ds_write_b32 v254, v9 offset:4096
    ds_write_b32 v254, v9 offset:4100
    v_mfma_f32_16x16x32_bf16 v[104:107], a[120:123], v[136:139], v[76:79]
    v_mfma_f32_16x16x32_bf16 v[104:107], a[124:127], v[140:143], v[104:107]
    v_mfma_f32_16x16x32_bf16 v[104:107], a[128:131], v[144:147], v[104:107]
    v_mfma_f32_16x16x32_bf16 v[104:107], a[132:135], v[148:151], v[104:107]
    s_cmp_eq_u32 s0, 0
    s_cbranch_scc0 L_g13
    s_waitcnt vmcnt(7)
L_g13:
    buffer_load_dwordx4 v28, s[24:27], s58 offen offset:2048 nt lds
    v_fma_f32 v88, -v92, v61, v88
    v_fma_f32 v89, -v93, v61, v89
    v_mfma_f32_16x16x32_bf16 v[104:107], a[136:139], v[152:155], v[104:107]
    v_fma_f32 v90, -v94, v61, v90
    v_fma_f32 v91, -v95, v61, v91
    v_mfma_f32_16x16x32_bf16 v[104:107], a[140:143], v[156:159], v[104:107]
    v_mul_f32 v88, v88, v128
    v_mul_f32 v89, v89, v129
    v_mul_f32 v90, v90, v130
    v_mul_f32 v91, v91, v131
    v_max3_f32 v1, v88, v89, v90
    v_max_f32 v1, v1, v91
    s_nop 1
    v_fma_f32 v104, -v108, v61, v104
    v_fma_f32 v105, -v109, v61, v105
    v_fma_f32 v106, -v110, v61, v106
    v_fma_f32 v107, -v111, v61, v107
    v_mul_f32 v104, v104, v132
    v_mul_f32 v105, v105, v133
    v_mul_f32 v106, v106, v134
    v_mul_f32 v107, v107, v135
    v_max3_f32 v1, v1, v104, v105
    v_max3_f32 v1, v1, v106, v107
    v_mov_b32 v2, v1
    s_nop 1
    v_permlane32_swap_b32 v1, v2
    v_max_f32 v1, v1, v2
    v_mov_b32 v2, v1
    s_nop 1
    v_permlane16_swap_b32 v1, v2
    v_max_f32 v1, v1, v2
    ds_write_b32 v239, v1
    s_waitcnt lgkmcnt(0)
    s_barrier
    ds_read_b32 v12, v240 offset:0
    ds_read_b32 v13, v240 offset:1024
    ds_read_b32 v14, v240 offset:2048
    ds_read_b32 v15, v240 offset:3072
    s_cmp_eq_u32 s0, 0
    s_cbranch_scc0 L_g14
    s_waitcnt vmcnt(7)
L_g14:
    buffer_load_dwordx4 v29, s[24:27], s58 offen offset:3072 nt lds
    s_waitcnt lgkmcnt(0)
    v_max3_f32 v1, v12, v13, v14
    v_max_f32 v1, v1, v15
    v_sub_f32 v88, v88, v1
    v_sub_f32 v89, v89, v1
    v_sub_f32 v90, v90, v1
    v_sub_f32 v91, v91, v1
    v_sub_f32 v104, v104, v1
    v_sub_f32 v105, v105, v1
    v_sub_f32 v106, v106, v1
    v_sub_f32 v107, v107, v1
    v_sub_f32 v62, 0, v1
    v_sub_f32 v255, 0, v1
    v_exp_f32 v96, v88
    v_exp_f32 v97, v89
    v_exp_f32 v98, v90
    v_exp_f32 v99, v91
    v_mul_f32 v88, v96, v128
    v_mul_f32 v89, v97, v129
    v_mul_f32 v90, v98, v130
    v_mul_f32 v91, v99, v131
    s_cmp_eq_u32 s0, 0
    s_cbranch_scc0 L_g15
    s_waitcnt vmcnt(7)
L_g15:
    s_add_u32 m0, s41, 8192
    s_nop 0
    buffer_load_dwordx4 v30, s[24:27], s58 offen offset:0 nt lds
    v_exp_f32 v112, v104
    v_exp_f32 v113, v105
    v_exp_f32 v114, v106
    v_exp_f32 v115, v107
    v_cvt_pk_bf16_f32 v72, v88, v89
    v_cvt_pk_bf16_f32 v73, v90, v91
    v_mul_f32 v104, v112, v132
    v_mul_f32 v105, v113, v133
    v_mul_f32 v106, v114, v134
    v_mul_f32 v107, v115, v135
    v_cvt_pk_bf16_f32 v74, v104, v105
    v_cvt_pk_bf16_f32 v75, v106, v107
    ds_write_b128 v237, v[72:75] offset:0
    v_mov_b32 v63, v96
    v_mul_f32 v64, v88, v92
    v_add_f32 v63, v63, v97
    v_fmac_f32 v64, v89, v93
    v_add_f32 v63, v63, v98
    v_fmac_f32 v64, v90, v94
    v_add_f32 v63, v63, v99
    v_fmac_f32 v64, v91, v95
    v_mov_b32 v68, v88
    v_mov_b32 v69, v89
    v_mov_b32 v70, v90
    v_mov_b32 v71, v91
    s_waitcnt lgkmcnt(0)
    s_barrier
    ds_read_b128 v[92:95], v253 offset:0
    ds_read_b128 v[96:99], v253 offset:1024
    ds_read_b128 v[100:103], v253 offset:2048
    ds_read_b128 v[116:119], v253 offset:3072
    s_waitcnt lgkmcnt(3)
    v_mfma_f32_16x16x32_bf16 a[0:3], a[144:147], v[92:95], 0
    s_cmp_eq_u32 s0, 0
    s_cbranch_scc0 L_g16
    s_waitcnt vmcnt(7)
L_g16:
    buffer_load_dwordx4 v31, s[24:27], s58 offen offset:1024 nt lds
    v_add_f32 v68, v68, v104
    v_add_f32 v69, v69, v105
    v_mfma_f32_16x16x32_bf16 a[4:7], a[160:163], v[92:95], 0
    v_add_f32 v70, v70, v106
    v_add_f32 v71, v71, v107
    v_mfma_f32_16x16x32_bf16 a[8:11], a[176:179], v[92:95], 0
    v_add_f32 v63, v63, v112
    v_fma_f32 v64, v104, v108, v64
    s_waitcnt lgkmcnt(2)
    v_mfma_f32_16x16x32_bf16 a[0:3], a[148:151], v[96:99], a[0:3]
    v_add_f32 v63, v63, v113
    v_fma_f32 v64, v105, v109, v64
    v_mfma_f32_16x16x32_bf16 a[4:7], a[164:167], v[96:99], a[4:7]
    v_add_f32 v63, v63, v114
    v_fma_f32 v64, v106, v110, v64
    v_mfma_f32_16x16x32_bf16 a[8:11], a[180:183], v[96:99], a[8:11]
    s_cmp_eq_u32 s0, 0
    s_cbranch_scc0 L_g17
    s_waitcnt vmcnt(7)
L_g17:
    buffer_load_dwordx4 v32, s[24:27], s58 offen offset:2048 nt lds
    v_add_f32 v63, v63, v115
    v_fma_f32 v64, v107, v111, v64
    s_waitcnt lgkmcnt(1)
    v_mfma_f32_16x16x32_bf16 a[0:3], a[152:155], v[100:103], a[0:3]
    v_mfma_f32_16x16x32_bf16 a[4:7], a[168:171], v[100:103], a[4:7]
    v_mfma_f32_16x16x32_bf16 a[8:11], a[184:187], v[100:103], a[8:11]
    s_waitcnt lgkmcnt(0)
    v_mfma_f32_16x16x32_bf16 a[0:3], a[156:159], v[116:119], a[0:3]
    v_mfma_f32_16x16x32_bf16 a[4:7], a[172:175], v[116:119], a[4:7]
    v_mfma_f32_16x16x32_bf16 a[8:11], a[188:191], v[116:119], a[8:11]
    s_barrier
    ds_read_b128 a[96:99], v40 offset:49152
    ds_read_b128 a[100:103], v41 offset:49152
    ds_read_b128 a[104:107], v42 offset:49152
    ds_read_b128 a[108:111], v43 offset:49152
    ds_read_b128 a[112:115], v40 offset:49408
    ds_read_b128 a[116:119], v41 offset:49408
    ds_read_b128 a[120:123], v42 offset:49408
    ds_read_b128 a[124:127], v43 offset:49408
    ds_read_b128 a[128:131], v40 offset:49664
    ds_read_b128 a[132:135], v41 offset:49664
    ds_read_b128 a[136:139], v42 offset:49664
    ds_read_b128 a[140:143], v43 offset:49664
    s_waitcnt lgkmcnt(11)
    v_mfma_f32_16x16x32_bf16 v[96:99], a[96:99], a[96:99], v[84:87]
    s_cmp_eq_u32 s0, 0
    s_cbranch_scc0 L_g18
    s_waitcnt vmcnt(7)
L_g18:
    buffer_load_dwordx4 v33, s[24:27], s58 offen offset:3072 nt lds
    ds_read_b64_tr_b16 a[144:145], v44 offset:0
    ds_read_b64_tr_b16 a[146:147], v45 offset:0
    v_mfma_f32_16x16x32_bf16 v[100:103], a[96:99], a[48:51], 0
    ds_read_b64_tr_b16 a[148:149], v44 offset:12288
    ds_read_b64_tr_b16 a[150:151], v45 offset:12288
    s_waitcnt lgkmcnt(14)
    v_mfma_f32_16x16x32_bf16 v[96:99], a[100:103], a[100:103], v[96:99]
    ds_read_b64_tr_b16 a[152:153], v44 offset:24576
    ds_read_b64_tr_b16 a[154:155], v45 offset:24576
    v_mfma_f32_16x16x32_bf16 v[100:103], a[100:103], a[52:55], v[100:103]
    ds_read_b64_tr_b16 a[156:157], v44 offset:36864
    ds_read_b64_tr_b16 a[158:159], v45 offset:36864
    s_waitcnt lgkmcnt(15)
    v_mfma_f32_16x16x32_bf16 v[96:99], a[104:107], a[104:107], v[96:99]
    ds_read_b64_tr_b16 a[160:161], v46 offset:0
    ds_read_b64_tr_b16 a[162:163], v47 offset:0
    v_mfma_f32_16x16x32_bf16 v[100:103], a[104:107], a[56:59], v[100:103]
    ds_read_b64_tr_b16 a[164:165], v46 offset:12288
    ds_read_b64_tr_b16 a[166:167], v47 offset:12288
    v_mfma_f32_16x16x32_bf16 v[96:99], a[108:111], a[108:111], v[96:99]
    ds_read_b64_tr_b16 a[168:169], v46 offset:24576
    ds_read_b64_tr_b16 a[170:171], v47 offset:24576
    v_mfma_f32_16x16x32_bf16 v[100:103], a[108:111], a[60:63], v[100:103]
    ds_read_b64_tr_b16 a[172:173], v46 offset:36864
    ds_read_b64_tr_b16 a[174:175], v47 offset:36864
    v_mfma_f32_16x16x32_bf16 v[96:99], a[112:115], a[112:115], v[96:99]
    ds_read_b64_tr_b16 a[176:177], v48 offset:0
    ds_read_b64_tr_b16 a[178:179], v49 offset:0
    v_mfma_f32_16x16x32_bf16 v[100:103], a[112:115], a[64:67], v[100:103]
    ds_read_b64_tr_b16 a[180:181], v48 offset:12288
    ds_read_b64_tr_b16 a[182:183], v49 offset:12288
    s_waitcnt lgkmcnt(15)
    v_mfma_f32_16x16x32_bf16 v[96:99], a[116:119], a[116:119], v[96:99]
    ds_read_b64_tr_b16 a[184:185], v48 offset:24576
    ds_read_b64_tr_b16 a[186:187], v49 offset:24576
    v_mfma_f32_16x16x32_bf16 v[100:103], a[116:119], a[68:71], v[100:103]
    ds_read_b64_tr_b16 a[188:189], v48 offset:36864
    ds_read_b64_tr_b16 a[190:191], v49 offset:36864
    v_mfma_f32_16x16x32_bf16 v[92:95], a[96:99], v[52:55], v[80:83]
    v_mfma_f32_16x16x32_bf16 v[92:95], a[100:103], v[52:55], v[92:95]
    v_mfma_f32_16x16x32_bf16 v[92:95], a[104:107], v[52:55], v[92:95]
    v_mfma_f32_16x16x32_bf16 v[92:95], a[108:111], v[52:55], v[92:95]
    s_nop 1
    v_fma_f32 v96, v100, 2.0, v96
    v_fma_f32 v97, v101, 2.0, v97
    v_mfma_f32_16x16x32_bf16 v[92:95], a[112:115], v[52:55], v[92:95]
    v_fma_f32 v98, v102, 2.0, v98
    v_fma_f32 v99, v103, 2.0, v99
    v_mfma_f32_16x16x32_bf16 v[92:95], a[116:119], v[52:55], v[92:95]
    v_cndmask_b32 v3, 0, v96, s[44:45]
    v_cndmask_b32 v3, v3, v97, s[46:47]
    v_mfma_f32_16x16x32_bf16 v[88:91], a[96:99], v[136:139], v[76:79]
    v_cndmask_b32 v3, v3, v98, s[48:49]
    v_cndmask_b32 v3, v3, v99, s[50:51]
    v_mfma_f32_16x16x32_bf16 v[88:91], a[100:103], v[140:143], v[88:91]
    s_nop 0
    s_nop 0
    v_mfma_f32_16x16x32_bf16 v[88:91], a[104:107], v[144:147], v[88:91]
    v_mfma_f32_16x16x4_f32 v[120:123], v3, v60, v[56:59]
    v_mfma_f32_16x16x32_bf16 v[88:91], a[108:111], v[148:151], v[88:91]
    v_mfma_f32_16x16x32_bf16 v[88:91], a[112:115], v[152:155], v[88:91]
    v_mfma_f32_16x16x32_bf16 v[88:91], a[116:119], v[156:159], v[88:91]
    s_waitcnt lgkmcnt(0)
    s_barrier
    v_mfma_f32_16x16x32_bf16 v[112:115], a[120:123], a[120:123], v[84:87]
    s_cmp_eq_u32 s0, 0
    s_cbranch_scc0 L_g19
    s_waitcnt vmcnt(7)
L_g19:
    s_add_u32 m0, s42, 0
    s_add_u32 s59, s37, 25362432
    buffer_load_dwordx4 v22, s[24:27], s59 offen offset:0 nt lds
    v_mfma_f32_16x16x32_bf16 v[116:119], a[120:123], a[48:51], 0
    s_cmp_eq_u32 s0, 0
    s_cbranch_scc0 L_g20
    s_waitcnt vmcnt(7)
L_g20:
    buffer_load_dwordx4 v23, s[24:27], s59 offen offset:1024 nt lds
    v_mfma_f32_16x16x32_bf16 v[112:115], a[124:127], a[124:127], v[112:115]
    v_mfma_f32_16x16x32_bf16 v[116:119], a[124:127], a[52:55], v[116:119]
    v_fma_f32 v128, -v92, v92, v120
    v_fma_f32 v129, -v93, v93, v121
    v_mfma_f32_16x16x32_bf16 v[112:115], a[128:131], a[128:131], v[112:115]
    v_fma_f32 v130, -v94, v94, v122
    v_fma_f32 v131, -v95, v95, v123
    v_mfma_f32_16x16x32_bf16 v[116:119], a[128:131], a[56:59], v[116:119]
    v_max_f32 v128, v128, v56
    v_max_f32 v129, v129, v56
    v_mfma_f32_16x16x32_bf16 v[112:115], a[132:135], a[132:135], v[112:115]
    s_cmp_eq_u32 s0, 0
    s_cbranch_scc0 L_g21
    s_waitcnt vmcnt(7)
L_g21:
    buffer_load_dwordx4 v24, s[24:27], s59 offen offset:2048 nt lds
    v_max_f32 v130, v130, v56
    v_max_f32 v131, v131, v56
    v_mfma_f32_16x16x32_bf16 v[116:119], a[132:135], a[60:63], v[116:119]
    v_rsq_f32 v128, v128
    v_mfma_f32_16x16x32_bf16 v[112:115], a[136:139], a[136:139], v[112:115]
    v_rsq_f32 v129, v129
    v_mfma_f32_16x16x32_bf16 v[116:119], a[136:139], a[64:67], v[116:119]
    v_rsq_f32 v130, v130
    v_mfma_f32_16x16x32_bf16 v[112:115], a[140:143], a[140:143], v[112:115]
    v_rsq_f32 v131, v131
    v_mfma_f32_16x16x32_bf16 v[116:119], a[140:143], a[68:71], v[116:119]
    v_fma_f32 v88, -v92, v61, v88
    v_fma_f32 v89, -v93, v61, v89
    v_mfma_f32_16x16x32_bf16 v[108:111], a[120:123], v[52:55], v[80:83]
    v_fma_f32 v90, -v94, v61, v90
    v_fma_f32 v91, -v95, v61, v91
    v_mfma_f32_16x16x32_bf16 v[108:111], a[124:127], v[52:55], v[108:111]
    v_fma_f32 v88, v88, v128, v62
    v_fma_f32 v89, v89, v129, v62
    v_mfma_f32_16x16x32_bf16 v[108:111], a[128:131], v[52:55], v[108:111]
    v_fma_f32 v90, v90, v130, v62
    v_fma_f32 v91, v91, v131, v62
    v_mfma_f32_16x16x32_bf16 v[108:111], a[132:135], v[52:55], v[108:111]
    v_max3_f32 v1, v88, v89, v90
    v_max_f32 v1, v1, v91
    v_mfma_f32_16x16x32_bf16 v[108:111], a[136:139], v[52:55], v[108:111]
    v_cmp_lt_f32 vcc, s52, v1
    s_cbranch_vccnz L_site0
L_back0:
    v_mfma_f32_16x16x32_bf16 v[108:111], a[140:143], v[52:55], v[108:111]
    v_exp_f32 v96, v88
    v_mfma_f32_16x16x32_bf16 v[104:107], a[120:123], v[136:139], v[76:79]
    v_exp_f32 v97, v89
    v_mfma_f32_16x16x32_bf16 v[104:107], a[124:127], v[140:143], v[104:107]
    s_cmp_eq_u32 s0, 0
    s_cbranch_scc0 L_g22
    s_waitcnt vmcnt(7)
L_g22:
    buffer_load_dwordx4 v25, s[24:27], s59 offen offset:3072 nt lds
    v_exp_f32 v98, v90
    v_mfma_f32_16x16x32_bf16 v[104:107], a[128:131], v[144:147], v[104:107]
    v_exp_f32 v99, v91
    v_mfma_f32_16x16x32_bf16 v[104:107], a[132:135], v[148:151], v[104:107]
    v_mul_f32 v88, v96, v128
    v_mul_f32 v89, v97, v129
    v_mfma_f32_16x16x32_bf16 v[104:107], a[136:139], v[152:155], v[104:107]
    v_mul_f32 v90, v98, v130
    v_mul_f32 v91, v99, v131
    v_mfma_f32_16x16x32_bf16 v[104:107], a[140:143], v[156:159], v[104:107]
    v_fma_f32 v112, v116, 2.0, v112
    v_fma_f32 v113, v117, 2.0, v113
    v_fma_f32 v114, v118, 2.0, v114
    v_fma_f32 v115, v119, 2.0, v115
    v_cndmask_b32 v4, 0, v112, s[44:45]
    v_cndmask_b32 v4, v4, v113, s[46:47]
    v_cndmask_b32 v4, v4, v114, s[48:49]
    v_cndmask_b32 v4, v4, v115, s[50:51]
    v_add_f32 v63, v63, v96
    v_fmac_f32 v64, v88, v92
    v_mfma_f32_16x16x4_f32 v[124:127], v4, v60, v[56:59]
    v_add_f32 v63, v63, v97
    v_fmac_f32 v64, v89, v93
    v_add_f32 v63, v63, v98
    v_fmac_f32 v64, v90, v94
    v_add_f32 v63, v63, v99
    v_fmac_f32 v64, v91, v95
    v_add_f32 v68, v68, v88
    v_add_f32 v69, v69, v89
    v_add_f32 v70, v70, v90
    v_add_f32 v71, v71, v91
    v_add_u32 v44, -49152, v44
    v_add_u32 v45, -49152, v45
    v_add_u32 v46, -49152, v46
    v_add_u32 v47, -49152, v47
    v_add_u32 v48, -49152, v48
    v_add_u32 v49, -49152, v49
    v_fma_f32 v132, -v108, v108, v124
    v_fma_f32 v133, -v109, v109, v125
    v_fma_f32 v134, -v110, v110, v126
    v_fma_f32 v135, -v111, v111, v127
    v_max_f32 v132, v132, v56
    v_max_f32 v133, v133, v56
    v_max_f32 v134, v134, v56
    v_max_f32 v135, v135, v56
    v_rsq_f32 v132, v132
    v_rsq_f32 v133, v133
    v_rsq_f32 v134, v134
    v_rsq_f32 v135, v135
    s_cmp_eq_u32 s0, 0
    s_cbranch_scc0 L_g23
    s_waitcnt vmcnt(7)
L_g23:
    s_add_u32 m0, s42, 4096
    s_nop 0
    buffer_load_dwordx4 v26, s[24:27], s59 offen offset:0 nt lds
    v_fma_f32 v104, -v108, v61, v104
    v_fma_f32 v105, -v109, v61, v105
    v_fma_f32 v106, -v110, v61, v106
    v_fma_f32 v107, -v111, v61, v107
    v_fma_f32 v104, v104, v132, v62
    v_fma_f32 v105, v105, v133, v62
    v_fma_f32 v106, v106, v134, v62
    v_fma_f32 v107, v107, v135, v62
    v_max3_f32 v1, v104, v105, v106
    v_max_f32 v1, v1, v107
    v_cmp_lt_f32 vcc, s52, v1
    s_cbranch_vccnz L_site1
L_back1:
    v_exp_f32 v112, v104
    v_exp_f32 v113, v105
    v_exp_f32 v114, v106
    v_exp_f32 v115, v107
    v_cvt_pk_bf16_f32 v72, v88, v89
    v_cvt_pk_bf16_f32 v73, v90, v91
    v_mul_f32 v104, v112, v132
    v_mul_f32 v105, v113, v133
    v_mul_f32 v106, v114, v134
    v_mul_f32 v107, v115, v135
    v_cvt_pk_bf16_f32 v74, v104, v105
    v_cvt_pk_bf16_f32 v75, v106, v107
    ds_write_b128 v237, v[72:75] offset:0
    v_add_f32 v68, v68, v104
    v_add_f32 v69, v69, v105
    v_add_f32 v70, v70, v106
    v_add_f32 v71, v71, v107
    v_cvt_pk_bf16_f32 v66, v68, v69
    v_cvt_pk_bf16_f32 v67, v70, v71
    ds_write_b64 v238, v[66:67]
    s_cmp_eq_u32 s0, 0
    s_cbranch_scc0 L_g24
    s_waitcnt vmcnt(7)
L_g24:
    buffer_load_dwordx4 v27, s[24:27], s59 offen offset:1024 nt lds
    s_waitcnt vmcnt(18)
    s_waitcnt lgkmcnt(0)
    s_barrier
L_post3:
    ds_read_b32 v9, v254 offset:4096
    ds_read_b64 v[120:121], v254 offset:0
    ds_read_b64 v[122:123], v254 offset:512
    ds_read_b64 v[124:125], v254 offset:1024
    ds_read_b64 v[126:127], v254 offset:1536
    ds_read_b128 v[92:95], v253 offset:0
    ds_read_b128 v[96:99], v253 offset:1024
    ds_read_b128 v[100:103], v253 offset:2048
    ds_read_b128 v[116:119], v253 offset:3072
    ds_read_b128 a[48:51], v34 offset:0
    ds_read_b128 a[52:55], v35 offset:0
    ds_read_b128 a[56:59], v34 offset:128
    ds_read_b128 a[60:63], v35 offset:128
    ds_read_b128 a[64:67], v34 offset:256
    ds_read_b128 a[68:71], v35 offset:256
    s_waitcnt lgkmcnt(14)
    v_cmp_ne_u32 vcc, 0, v9
    s_cbranch_vccnz L_xt3
    s_waitcnt lgkmcnt(12)
    v_mfma_f32_16x16x32_bf16 a[0:3], a[72:75], v[120:123], a[0:3]
    v_add_f32 v63, v63, v112
    v_fma_f32 v64, v104, v108, v64
    v_mfma_f32_16x16x32_bf16 a[4:7], a[80:83], v[120:123], a[4:7]
    s_cmp_eq_u32 s0, 0
    s_cbranch_scc0 L_g25
    s_waitcnt vmcnt(7)
L_g25:
    buffer_load_dwordx4 v28, s[24:27], s59 offen offset:2048 nt lds
    v_add_f32 v63, v63, v113
    v_fma_f32 v64, v105, v109, v64
    v_mfma_f32_16x16x32_bf16 a[8:11], a[88:91], v[120:123], a[8:11]
    v_add_f32 v63, v63, v114
    v_fma_f32 v64, v106, v110, v64
    s_waitcnt lgkmcnt(10)
    v_mfma_f32_16x16x32_bf16 a[0:3], a[76:79], v[124:127], a[0:3]
    v_add_f32 v63, v63, v115
    v_fma_f32 v64, v107, v111, v64
    v_mfma_f32_16x16x32_bf16 a[4:7], a[84:87], v[124:127], a[4:7]
    v_mfma_f32_16x16x32_bf16 a[8:11], a[92:95], v[124:127], a[8:11]
    s_waitcnt lgkmcnt(9)
    v_mfma_f32_16x16x32_bf16 a[0:3], a[144:147], v[92:95], a[0:3]
    ds_read_b64_tr_b16 a[72:73], v36 offset:0
    ds_read_b64_tr_b16 a[74:75], v36 offset:6144
    v_mfma_f32_16x16x32_bf16 a[4:7], a[160:163], v[92:95], a[4:7]
    ds_read_b64_tr_b16 a[76:77], v36 offset:12288
    ds_read_b64_tr_b16 a[78:79], v36 offset:18432
    v_mfma_f32_16x16x32_bf16 a[8:11], a[176:179], v[92:95], a[8:11]
    ds_read_b64_tr_b16 a[80:81], v37 offset:0
    ds_read_b64_tr_b16 a[82:83], v37 offset:6144
    s_waitcnt lgkmcnt(14)
    v_mfma_f32_16x16x32_bf16 a[0:3], a[148:151], v[96:99], a[0:3]
    ds_read_b64_tr_b16 a[84:85], v37 offset:12288
    ds_read_b64_tr_b16 a[86:87], v37 offset:18432
    v_mfma_f32_16x16x32_bf16 a[4:7], a[164:167], v[96:99], a[4:7]
    ds_read_b64_tr_b16 a[88:89], v38 offset:0
    ds_read_b64_tr_b16 a[90:91], v38 offset:6144
    v_mfma_f32_16x16x32_bf16 a[8:11], a[180:183], v[96:99], a[8:11]
    ds_read_b64_tr_b16 a[92:93], v38 offset:12288
    ds_read_b64_tr_b16 a[94:95], v38 offset:18432
    s_waitcnt lgkmcnt(15)
    v_mfma_f32_16x16x32_bf16 a[0:3], a[152:155], v[100:103], a[0:3]
    s_cmp_eq_u32 s0, 0
    s_cbranch_scc0 L_g26
    s_waitcnt vmcnt(7)
L_g26:
    buffer_load_dwordx4 v29, s[24:27], s59 offen offset:3072 nt lds
    v_mfma_f32_16x16x32_bf16 a[4:7], a[168:171], v[100:103], a[4:7]
    v_mfma_f32_16x16x32_bf16 a[8:11], a[184:187], v[100:103], a[8:11]
    v_mfma_f32_16x16x32_bf16 a[0:3], a[156:159], v[116:119], a[0:3]
    v_mfma_f32_16x16x32_bf16 a[4:7], a[172:175], v[116:119], a[4:7]
    v_mfma_f32_16x16x32_bf16 a[8:11], a[188:191], v[116:119], a[8:11]
    v_mfma_f32_16x16x32_bf16 v[84:87], a[48:51], a[48:51], 0
    v_mfma_f32_16x16x32_bf16 v[80:83], a[48:51], v[52:55], 0
    v_mfma_f32_16x16x32_bf16 v[84:87], a[52:55], a[52:55], v[84:87]
    v_mfma_f32_16x16x32_bf16 v[80:83], a[52:55], v[52:55], v[80:83]
    v_mfma_f32_16x16x32_bf16 v[84:87], a[56:59], a[56:59], v[84:87]
    v_mfma_f32_16x16x32_bf16 v[80:83], a[56:59], v[52:55], v[80:83]
    s_waitcnt lgkmcnt(14)
    v_mfma_f32_16x16x32_bf16 v[84:87], a[60:63], a[60:63], v[84:87]
    v_mfma_f32_16x16x32_bf16 v[80:83], a[60:63], v[52:55], v[80:83]
    s_cmp_eq_u32 s0, 0
    s_cbranch_scc0 L_g27
    s_waitcnt vmcnt(7)
L_g27:
    s_add_u32 m0, s42, 8192
    s_nop 0
    buffer_load_dwordx4 v30, s[24:27], s59 offen offset:0 nt lds
    s_waitcnt lgkmcnt(13)
    v_mfma_f32_16x16x32_bf16 v[84:87], a[64:67], a[64:67], v[84:87]
    v_mfma_f32_16x16x32_bf16 v[80:83], a[64:67], v[52:55], v[80:83]
    s_waitcnt lgkmcnt(12)
    v_mfma_f32_16x16x32_bf16 v[84:87], a[68:71], a[68:71], v[84:87]
    v_mfma_f32_16x16x32_bf16 v[80:83], a[68:71], v[52:55], v[80:83]
    s_waitcnt lgkmcnt(0)
    v_mfma_f32_16x16x32_bf16 v[76:79], a[48:51], v[136:139], 0
    v_mfma_f32_16x16x32_bf16 v[76:79], a[52:55], v[140:143], v[76:79]
    v_mfma_f32_16x16x32_bf16 v[76:79], a[56:59], v[144:147], v[76:79]
    v_mfma_f32_16x16x32_bf16 v[76:79], a[60:63], v[148:151], v[76:79]
    v_mfma_f32_16x16x32_bf16 v[76:79], a[64:67], v[152:155], v[76:79]
    v_mfma_f32_16x16x32_bf16 v[76:79], a[68:71], v[156:159], v[76:79]
    v_lshrrev_b32 v1, 3, v0
    v_and_b32 v2, 6, v1
    v_xor_b32 v2, v0, v2
    v_and_b32 v2, 7, v2
    v_mul_u32_u24 v1, 768, v1
    v_lshl_add_u32 v224, v2, 4, v1
    v_xor_b32 v225, 16, v224
    v_add_u32 v225, 5120, v225
    s_cmp_eq_u32 s0, 0
    s_cbranch_scc0 L_g28
    s_waitcnt vmcnt(7)
L_g28:
    buffer_load_dwordx4 v31, s[24:27], s59 offen offset:1024 nt lds
    s_cmp_eq_u32 s0, 0
    s_cbranch_scc0 L_g29
    s_waitcnt vmcnt(7)
L_g29:
    buffer_load_dwordx4 v32, s[24:27], s59 offen offset:2048 nt lds
    s_waitcnt vmcnt(11)
    s_barrier
    ds_read_b128 a[96:99], v40 offset:0
    ds_read_b128 a[100:103], v41 offset:0
    ds_read_b128 a[104:107], v42 offset:0
    ds_read_b128 a[108:111], v43 offset:0
    ds_read_b128 a[112:115], v40 offset:256
    ds_read_b128 a[116:119], v41 offset:256
    ds_read_b128 a[120:123], v42 offset:256
    ds_read_b128 a[124:127], v43 offset:256
    ds_read_b128 a[128:131], v40 offset:512
    ds_read_b128 a[132:135], v41 offset:512
    ds_read_b128 a[136:139], v42 offset:512
    ds_read_b128 a[140:143], v43 offset:512
    s_waitcnt lgkmcnt(11)
    v_mfma_f32_16x16x32_bf16 v[96:99], a[96:99], a[96:99], v[84:87]
    ds_read_b64_tr_b16 a[144:145], v44 offset:0
    ds_read_b64_tr_b16 a[146:147], v45 offset:0
    v_mfma_f32_16x16x32_bf16 v[100:103], a[96:99], a[48:51], 0
    ds_read_b64_tr_b16 a[148:149], v44 offset:12288
    ds_read_b64_tr_b16 a[150:151], v45 offset:12288
    s_waitcnt lgkmcnt(14)
    v_mfma_f32_16x16x32_bf16 v[96:99], a[100:103], a[100:103], v[96:99]
    ds_read_b64_tr_b16 a[152:153], v44 offset:24576
    ds_read_b64_tr_b16 a[154:155], v45 offset:24576
    v_mfma_f32_16x16x32_bf16 v[100:103], a[100:103], a[52:55], v[100:103]
    ds_read_b64_tr_b16 a[156:157], v44 offset:36864
    ds_read_b64_tr_b16 a[158:159], v45 offset:36864
    s_waitcnt lgkmcnt(15)
    v_mfma_f32_16x16x32_bf16 v[96:99], a[104:107], a[104:107], v[96:99]
    ds_read_b64_tr_b16 a[160:161], v46 offset:0
    ds_read_b64_tr_b16 a[162:163], v47 offset:0
    v_mfma_f32_16x16x32_bf16 v[100:103], a[104:107], a[56:59], v[100:103]
    ds_read_b64_tr_b16 a[164:165], v46 offset:12288
    ds_read_b64_tr_b16 a[166:167], v47 offset:12288
    v_mfma_f32_16x16x32_bf16 v[96:99], a[108:111], a[108:111], v[96:99]
    s_cmp_eq_u32 s0, 0
    s_cbranch_scc0 L_g30
    s_waitcnt vmcnt(7)
L_g30:
    buffer_load_dwordx4 v33, s[24:27], s59 offen offset:3072 nt lds
    ds_read_b64_tr_b16 a[168:169], v46 offset:24576
    ds_read_b64_tr_b16 a[170:171], v47 offset:24576
    v_mfma_f32_16x16x32_bf16 v[100:103], a[108:111], a[60:63], v[100:103]
    ds_read_b64_tr_b16 a[172:173], v46 offset:36864
    ds_read_b64_tr_b16 a[174:175], v47 offset:36864
    v_mfma_f32_16x16x32_bf16 v[96:99], a[112:115], a[112:115], v[96:99]
    ds_read_b64_tr_b16 a[176:177], v48 offset:0
    ds_read_b64_tr_b16 a[178:179], v49 offset:0
    v_mfma_f32_16x16x32_bf16 v[100:103], a[112:115], a[64:67], v[100:103]
    ds_read_b64_tr_b16 a[180:181], v48 offset:12288
    ds_read_b64_tr_b16 a[182:183], v49 offset:12288
    s_waitcnt lgkmcnt(15)
    v_mfma_f32_16x16x32_bf16 v[96:99], a[116:119], a[116:119], v[96:99]
    ds_read_b64_tr_b16 a[184:185], v48 offset:24576
    ds_read_b64_tr_b16 a[186:187], v49 offset:24576
    v_mfma_f32_16x16x32_bf16 v[100:103], a[116:119], a[68:71], v[100:103]
    ds_read_b64_tr_b16 a[188:189], v48 offset:36864
    ds_read_b64_tr_b16 a[190:191], v49 offset:36864
    v_mfma_f32_16x16x32_bf16 v[92:95], a[96:99], v[52:55], v[80:83]
    v_mfma_f32_16x16x32_bf16 v[92:95], a[100:103], v[52:55], v[92:95]
    v_mfma_f32_16x16x32_bf16 v[92:95], a[104:107], v[52:55], v[92:95]
    v_mfma_f32_16x16x32_bf16 v[92:95], a[108:111], v[52:55], v[92:95]
    s_nop 1
    v_fma_f32 v96, v100, 2.0, v96
    v_fma_f32 v97, v101, 2.0, v97
    v_mfma_f32_16x16x32_bf16 v[92:95], a[112:115], v[52:55], v[92:95]
    v_fma_f32 v98, v102, 2.0, v98
    v_fma_f32 v99, v103, 2.0, v99
    v_mfma_f32_16x16x32_bf16 v[92:95], a[116:119], v[52:55], v[92:95]
    v_cndmask_b32 v3, 0, v96, s[44:45]
    v_cndmask_b32 v3, v3, v97, s[46:47]
    v_mfma_f32_16x16x32_bf16 v[88:91], a[96:99], v[136:139], v[76:79]
    s_cmp_eq_u32 s0, 0
    s_cbranch_scc0 L_g31
    s_waitcnt vmcnt(7)
L_g31:
    s_add_u32 m0, s40, 0
    s_add_u32 s57, s36, 12582912
    buffer_load_dwordx4 v16, s[28:31], s57 offen offset:0 nt lds
    v_cndmask_b32 v3, v3, v98, s[48:49]
    v_cndmask_b32 v3, v3, v99, s[50:51]
    v_mfma_f32_16x16x32_bf16 v[88:91], a[100:103], v[140:143], v[88:91]
    s_nop 0
    s_nop 0
    v_mfma_f32_16x16x32_bf16 v[88:91], a[104:107], v[144:147], v[88:91]
    v_mfma_f32_16x16x4_f32 v[120:123], v3, v60, v[56:59]
    v_mfma_f32_16x16x32_bf16 v[88:91], a[108:111], v[148:151], v[88:91]
    v_mfma_f32_16x16x32_bf16 v[88:91], a[112:115], v[152:155], v[88:91]
    v_mfma_f32_16x16x32_bf16 v[88:91], a[116:119], v[156:159], v[88:91]
    v_mfma_f32_16x16x32_bf16 v[112:115], a[120:123], a[120:123], v[84:87]
    v_mfma_f32_16x16x32_bf16 v[116:119], a[120:123], a[48:51], 0
    v_mfma_f32_16x16x32_bf16 v[112:115], a[124:127], a[124:127], v[112:115]
    v_mfma_f32_16x16x32_bf16 v[116:119], a[124:127], a[52:55], v[116:119]
    s_nop 2
    v_fma_f32 v128, -v92, v92, v120
    v_fma_f32 v129, -v93, v93, v121
    v_mfma_f32_16x16x32_bf16 v[112:115], a[128:131], a[128:131], v[112:115]
    v_fma_f32 v130, -v94, v94, v122
    v_fma_f32 v131, -v95, v95, v123
    v_mfma_f32_16x16x32_bf16 v[116:119], a[128:131], a[56:59], v[116:119]
    s_cmp_eq_u32 s0, 0
    s_cbranch_scc0 L_g32
    s_waitcnt vmcnt(7)
L_g32:
    buffer_load_dwordx4 v17, s[28:31], s57 offen offset:1024 nt lds
    v_max_f32 v128, v128, v56
    v_max_f32 v129, v129, v56
    v_mfma_f32_16x16x32_bf16 v[112:115], a[132:135], a[132:135], v[112:115]
    v_max_f32 v130, v130, v56
    v_max_f32 v131, v131, v56
    v_mfma_f32_16x16x32_bf16 v[116:119], a[132:135], a[60:63], v[116:119]
    v_rsq_f32 v128, v128
    v_mfma_f32_16x16x32_bf16 v[112:115], a[136:139], a[136:139], v[112:115]
    v_rsq_f32 v129, v129
    v_mfma_f32_16x16x32_bf16 v[116:119], a[136:139], a[64:67], v[116:119]
    v_rsq_f32 v130, v130
    v_mfma_f32_16x16x32_bf16 v[112:115], a[140:143], a[140:143], v[112:115]
    v_rsq_f32 v131, v131
    v_mfma_f32_16x16x32_bf16 v[116:119], a[140:143], a[68:71], v[116:119]
    v_fma_f32 v88, -v92, v61, v88
    v_fma_f32 v89, -v93, v61, v89
    v_mfma_f32_16x16x32_bf16 v[108:111], a[120:123], v[52:55], v[80:83]
    v_fma_f32 v90, -v94, v61, v90
    v_fma_f32 v91, -v95, v61, v91
    v_mfma_f32_16x16x32_bf16 v[108:111], a[124:127], v[52:55], v[108:111]
    v_fma_f32 v88, v88, v128, v62
    v_fma_f32 v89, v89, v129, v62
    v_mfma_f32_16x16x32_bf16 v[108:111], a[128:131], v[52:55], v[108:111]
    v_fma_f32 v90, v90, v130, v62
    v_fma_f32 v91, v91, v131, v62
    v_mfma_f32_16x16x32_bf16 v[108:111], a[132:135], v[52:55], v[108:111]
    v_max3_f32 v1, v88, v89, v90
    v_max_f32 v1, v1, v91
    v_mfma_f32_16x16x32_bf16 v[108:111], a[136:139], v[52:55], v[108:111]
    v_cmp_lt_f32 vcc, s52, v1
    s_cbranch_vccnz L_site2
L_back2:
    v_mfma_f32_16x16x32_bf16 v[108:111], a[140:143], v[52:55], v[108:111]
    s_cmp_eq_u32 s0, 0
    s_cbranch_scc0 L_g33
    s_waitcnt vmcnt(7)
L_g33:
    buffer_load_dwordx4 v18, s[28:31], s57 offen offset:2048 nt lds
    v_exp_f32 v96, v88
    v_mfma_f32_16x16x32_bf16 v[104:107], a[120:123], v[136:139], v[76:79]
    v_exp_f32 v97, v89
    v_mfma_f32_16x16x32_bf16 v[104:107], a[124:127], v[140:143], v[104:107]
    v_exp_f32 v98, v90
    v_mfma_f32_16x16x32_bf16 v[104:107], a[128:131], v[144:147], v[104:107]
    v_exp_f32 v99, v91
    v_mfma_f32_16x16x32_bf16 v[104:107], a[132:135], v[148:151], v[104:107]
    v_mul_f32 v88, v96, v128
    v_mul_f32 v89, v97, v129
    v_mfma_f32_16x16x32_bf16 v[104:107], a[136:139], v[152:155], v[104:107]
    v_mul_f32 v90, v98, v130
    v_mul_f32 v91, v99, v131
    v_mfma_f32_16x16x32_bf16 v[104:107], a[140:143], v[156:159], v[104:107]
    v_fma_f32 v112, v116, 2.0, v112
    v_fma_f32 v113, v117, 2.0, v113
    v_fma_f32 v114, v118, 2.0, v114
    v_fma_f32 v115, v119, 2.0, v115
    v_cndmask_b32 v4, 0, v112, s[44:45]
    v_cndmask_b32 v4, v4, v113, s[46:47]
    v_cndmask_b32 v4, v4, v114, s[48:49]
    v_cndmask_b32 v4, v4, v115, s[50:51]
    v_add_f32 v63, v63, v96
    v_fmac_f32 v64, v88, v92
    v_mfma_f32_16x16x4_f32 v[124:127], v4, v60, v[56:59]
    v_add_f32 v63, v63, v97
    v_fmac_f32 v64, v89, v93
    v_add_f32 v63, v63, v98
    v_fmac_f32 v64, v90, v94
    v_add_f32 v63, v63, v99
    v_fmac_f32 v64, v91, v95
    v_mov_b32 v68, v88
    v_mov_b32 v69, v89
    v_mov_b32 v70, v90
    v_mov_b32 v71, v91
    v_add_u32 v44, 49152, v44
    v_add_u32 v45, 49152, v45
    v_add_u32 v46, 49152, v46
    v_add_u32 v47, 49152, v47
    v_add_u32 v48, 49152, v48
    v_add_u32 v49, 49152, v49
    v_fma_f32 v132, -v108, v108, v124
    v_fma_f32 v133, -v109, v109, v125
    v_fma_f32 v134, -v110, v110, v126
    v_fma_f32 v135, -v111, v111, v127
    v_max_f32 v132, v132, v56
    v_max_f32 v133, v133, v56
    v_max_f32 v134, v134, v56
    v_max_f32 v135, v135, v56
    v_rsq_f32 v132, v132
    v_rsq_f32 v133, v133
    v_rsq_f32 v134, v134
    v_rsq_f32 v135, v135
    s_cmp_eq_u32 s0, 0
    s_cbranch_scc0 L_g34
    s_waitcnt vmcnt(7)
L_g34:
    buffer_load_dwordx4 v19, s[28:31], s57 offen offset:3072 nt lds
    v_fma_f32 v104, -v108, v61, v104
    v_fma_f32 v105, -v109, v61, v105
    v_fma_f32 v106, -v110, v61, v106
    v_fma_f32 v107, -v111, v61, v107
    v_fma_f32 v104, v104, v132, v62
    v_fma_f32 v105, v105, v133, v62
    v_fma_f32 v106, v106, v134, v62
    v_fma_f32 v107, v107, v135, v62
    v_max3_f32 v1, v104, v105, v106
    v_max_f32 v1, v1, v107
    v_cmp_lt_f32 vcc, s52, v1
    s_cbranch_vccnz L_site3
L_back3:
    v_exp_f32 v112, v104
    v_exp_f32 v113, v105
    v_exp_f32 v114, v106
    v_exp_f32 v115, v107
    v_cvt_pk_bf16_f32 v72, v88, v89
    v_cvt_pk_bf16_f32 v73, v90, v91
    v_mul_f32 v104, v112, v132
    v_mul_f32 v105, v113, v133
    v_mul_f32 v106, v114, v134
    v_mul_f32 v107, v115, v135
    v_cvt_pk_bf16_f32 v74, v104, v105
    v_cvt_pk_bf16_f32 v75, v106, v107
    ds_write_b128 v237, v[72:75] offset:0
    s_waitcnt lgkmcnt(0)
    s_barrier
L_post24:
    ds_read_b32 v9, v254 offset:4096
    ds_read_b128 v[92:95], v253 offset:0
    ds_read_b128 v[96:99], v253 offset:1024
    ds_read_b128 v[100:103], v253 offset:2048
    ds_read_b128 v[116:119], v253 offset:3072
    s_waitcnt lgkmcnt(4)
    v_cmp_ne_u32 vcc, 0, v9
    s_cbranch_vccnz L_xt24
    s_waitcnt lgkmcnt(3)
    v_mfma_f32_16x16x32_bf16 a[0:3], a[144:147], v[92:95], a[0:3]
    s_cmp_eq_u32 s0, 0
    s_cbranch_scc0 L_g35
    s_waitcnt vmcnt(7)
L_g35:
    s_add_u32 m0, s40, 4096
    s_nop 0
    buffer_load_dwordx4 v20, s[28:31], s57 offen offset:0 nt lds
    v_add_f32 v68, v68, v104
    v_add_f32 v69, v69, v105
    v_mfma_f32_16x16x32_bf16 a[4:7], a[160:163], v[92:95], a[4:7]
    s_cmp_eq_u32 s0, 0
    s_cbranch_scc0 L_g36
    s_waitcnt vmcnt(5)
L_g36:
    buffer_load_dwordx4 v21, s[28:31], s57 offen offset:1024 nt lds
    v_add_f32 v70, v70, v106
    v_add_f32 v71, v71, v107
    v_mfma_f32_16x16x32_bf16 a[8:11], a[176:179], v[92:95], a[8:11]
    v_add_f32 v63, v63, v112
    v_fma_f32 v64, v104, v108, v64
    s_waitcnt lgkmcnt(2)
    v_mfma_f32_16x16x32_bf16 a[0:3], a[148:151], v[96:99], a[0:3]
    v_add_f32 v63, v63, v113
    v_fma_f32 v64, v105, v109, v64
    v_mfma_f32_16x16x32_bf16 a[4:7], a[164:167], v[96:99], a[4:7]
    v_add_f32 v63, v63, v114
    v_fma_f32 v64, v106, v110, v64
    v_mfma_f32_16x16x32_bf16 a[8:11], a[180:183], v[96:99], a[8:11]
    v_add_f32 v63, v63, v115
    v_fma_f32 v64, v107, v111, v64
    s_waitcnt lgkmcnt(1)
    v_mfma_f32_16x16x32_bf16 a[0:3], a[152:155], v[100:103], a[0:3]
    v_mfma_f32_16x16x32_bf16 a[4:7], a[168:171], v[100:103], a[4:7]
    v_mfma_f32_16x16x32_bf16 a[8:11], a[184:187], v[100:103], a[8:11]
    s_waitcnt lgkmcnt(0)
    v_mfma_f32_16x16x32_bf16 a[0:3], a[156:159], v[116:119], a[0:3]
    buffer_load_dwordx2 v[234:235], v245, s[32:35], 0 offen offset:128 sc1
    v_mfma_f32_16x16x32_bf16 a[4:7], a[172:175], v[116:119], a[4:7]
    v_mfma_f32_16x16x32_bf16 a[8:11], a[188:191], v[116:119], a[8:11]
    s_cmp_eq_u32 s0, 0
    s_cbranch_scc0 L_g37
    s_waitcnt vmcnt(6)
L_g37:
    s_add_u32 m0, s41, 0
    s_add_u32 s58, s37, 50331648
    buffer_load_dwordx4 v22, s[24:27], s58 offen offset:0 nt lds
    s_cmp_eq_u32 s0, 0
    s_cbranch_scc0 L_g38
    s_waitcnt vmcnt(6)
L_g38:
    buffer_load_dwordx4 v23, s[24:27], s58 offen offset:1024 nt lds
    s_cmp_eq_u32 s0, 0
    s_cbranch_scc0 L_g39
    s_waitcnt vmcnt(6)
L_g39:
    buffer_load_dwordx4 v24, s[24:27], s58 offen offset:2048 nt lds
    s_cmp_eq_u32 s0, 0
    s_cbranch_scc0 L_g40
    s_waitcnt vmcnt(6)
L_g40:
    buffer_load_dwordx4 v25, s[24:27], s58 offen offset:3072 nt lds
    s_waitcnt vmcnt(11)
    s_barrier
    ds_read_b128 a[96:99], v40 offset:49152
    ds_read_b128 a[100:103], v41 offset:49152
    ds_read_b128 a[104:107], v42 offset:49152
    ds_read_b128 a[108:111], v43 offset:49152
    ds_read_b128 a[112:115], v40 offset:49408
    ds_read_b128 a[116:119], v41 offset:49408
    ds_read_b128 a[120:123], v42 offset:49408
    ds_read_b128 a[124:127], v43 offset:49408
    ds_read_b128 a[128:131], v40 offset:49664
    ds_read_b128 a[132:135], v41 offset:49664
    ds_read_b128 a[136:139], v42 offset:49664
    ds_read_b128 a[140:143], v43 offset:49664
    s_waitcnt lgkmcnt(11)
    v_mfma_f32_16x16x32_bf16 v[96:99], a[96:99], a[96:99], v[84:87]
    ds_read_b64_tr_b16 a[144:145], v44 offset:0
    ds_read_b64_tr_b16 a[146:147], v45 offset:0
    v_mfma_f32_16x16x32_bf16 v[100:103], a[96:99], a[48:51], 0
    ds_read_b64_tr_b16 a[148:149], v44 offset:12288
    ds_read_b64_tr_b16 a[150:151], v45 offset:12288
    s_waitcnt lgkmcnt(14)
    v_mfma_f32_16x16x32_bf16 v[96:99], a[100:103], a[100:103], v[96:99]
    ds_read_b64_tr_b16 a[152:153], v44 offset:24576
    ds_read_b64_tr_b16 a[154:155], v45 offset:24576
    v_mfma_f32_16x16x32_bf16 v[100:103], a[100:103], a[52:55], v[100:103]
    ds_read_b64_tr_b16 a[156:157], v44 offset:36864
    ds_read_b64_tr_b16 a[158:159], v45 offset:36864
    s_waitcnt lgkmcnt(15)
    v_mfma_f32_16x16x32_bf16 v[96:99], a[104:107], a[104:107], v[96:99]
    ds_read_b64_tr_b16 a[160:161], v46 offset:0
    ds_read_b64_tr_b16 a[162:163], v47 offset:0
    v_mfma_f32_16x16x32_bf16 v[100:103], a[104:107], a[56:59], v[100:103]
    ds_read_b64_tr_b16 a[164:165], v46 offset:12288
    ds_read_b64_tr_b16 a[166:167], v47 offset:12288
    v_mfma_f32_16x16x32_bf16 v[96:99], a[108:111], a[108:111], v[96:99]
    s_cmp_eq_u32 s0, 0
    s_cbranch_scc0 L_g41
    s_waitcnt vmcnt(6)
L_g41:
    s_add_u32 m0, s41, 4096
    s_nop 0
    buffer_load_dwordx4 v26, s[24:27], s58 offen offset:0 nt lds
    ds_read_b64_tr_b16 a[168:169], v46 offset:24576
    ds_read_b64_tr_b16 a[170:171], v47 offset:24576
    v_mfma_f32_16x16x32_bf16 v[100:103], a[108:111], a[60:63], v[100:103]
    ds_read_b64_tr_b16 a[172:173], v46 offset:36864
    ds_read_b64_tr_b16 a[174:175], v47 offset:36864
    v_mfma_f32_16x16x32_bf16 v[96:99], a[112:115], a[112:115], v[96:99]
    ds_read_b64_tr_b16 a[176:177], v48 offset:0
    ds_read_b64_tr_b16 a[178:179], v49 offset:0
    v_mfma_f32_16x16x32_bf16 v[100:103], a[112:115], a[64:67], v[100:103]
    ds_read_b64_tr_b16 a[180:181], v48 offset:12288
    ds_read_b64_tr_b16 a[182:183], v49 offset:12288
    s_waitcnt lgkmcnt(15)
    v_mfma_f32_16x16x32_bf16 v[96:99], a[116:119], a[116:119], v[96:99]
    ds_read_b64_tr_b16 a[184:185], v48 offset:24576
    ds_read_b64_tr_b16 a[186:187], v49 offset:24576
    v_mfma_f32_16x16x32_bf16 v[100:103], a[116:119], a[68:71], v[100:103]
    ds_read_b64_tr_b16 a[188:189], v48 offset:36864
    ds_read_b64_tr_b16 a[190:191], v49 offset:36864
    v_mfma_f32_16x16x32_bf16 v[92:95], a[96:99], v[52:55], v[80:83]
    v_mfma_f32_16x16x32_bf16 v[92:95], a[100:103], v[52:55], v[92:95]
    v_mfma_f32_16x16x32_bf16 v[92:95], a[104:107], v[52:55], v[92:95]
    v_mfma_f32_16x16x32_bf16 v[92:95], a[108:111], v[52:55], v[92:95]
    s_nop 1
    v_fma_f32 v96, v100, 2.0, v96
    v_fma_f32 v97, v101, 2.0, v97
    v_mfma_f32_16x16x32_bf16 v[92:95], a[112:115], v[52:55], v[92:95]
    v_fma_f32 v98, v102, 2.0, v98
    v_fma_f32 v99, v103, 2.0, v99
    v_mfma_f32_16x16x32_bf16 v[92:95], a[116:119], v[52:55], v[92:95]
    v_cndmask_b32 v3, 0, v96, s[44:45]
    v_cndmask_b32 v3, v3, v97, s[46:47]
    v_mfma_f32_16x16x32_bf16 v[88:91], a[96:99], v[136:139], v[76:79]
    s_cmp_eq_u32 s0, 0
    s_cbranch_scc0 L_g42
    s_waitcnt vmcnt(6)
L_g42:
    buffer_load_dwordx4 v27, s[24:27], s58 offen offset:1024 nt lds
    v_cndmask_b32 v3, v3, v98, s[48:49]
    v_cndmask_b32 v3, v3, v99, s[50:51]
    v_mfma_f32_16x16x32_bf16 v[88:91], a[100:103], v[140:143], v[88:91]
    s_nop 0
    s_nop 0
    v_mfma_f32_16x16x32_bf16 v[88:91], a[104:107], v[144:147], v[88:91]
    v_mfma_f32_16x16x4_f32 v[120:123], v3, v60, v[56:59]
    v_mfma_f32_16x16x32_bf16 v[88:91], a[108:111], v[148:151], v[88:91]
    v_mfma_f32_16x16x32_bf16 v[88:91], a[112:115], v[152:155], v[88:91]
    v_mfma_f32_16x16x32_bf16 v[88:91], a[116:119], v[156:159], v[88:91]
    v_mfma_f32_16x16x32_bf16 v[112:115], a[120:123], a[120:123], v[84:87]
    v_mfma_f32_16x16x32_bf16 v[116:119], a[120:123], a[48:51], 0
    v_mfma_f32_16x16x32_bf16 v[112:115], a[124:127], a[124:127], v[112:115]
    v_mfma_f32_16x16x32_bf16 v[116:119], a[124:127], a[52:55], v[116:119]
    s_nop 2
    v_fma_f32 v128, -v92, v92, v120
    v_fma_f32 v129, -v93, v93, v121
    v_mfma_f32_16x16x32_bf16 v[112:115], a[128:131], a[128:131], v[112:115]
    v_fma_f32 v130, -v94, v94, v122
    v_fma_f32 v131, -v95, v95, v123
    v_mfma_f32_16x16x32_bf16 v[116:119], a[128:131], a[56:59], v[116:119]
    s_cmp_eq_u32 s0, 0
    s_cbranch_scc0 L_g43
    s_waitcnt vmcnt(5)
L_g43:
    buffer_load_dwordx4 v28, s[24:27], s58 offen offset:2048 nt lds
    v_max_f32 v128, v128, v56
    v_max_f32 v129, v129, v56
    v_mfma_f32_16x16x32_bf16 v[112:115], a[132:135], a[132:135], v[112:115]
    v_max_f32 v130, v130, v56
    v_max_f32 v131, v131, v56
    v_mfma_f32_16x16x32_bf16 v[116:119], a[132:135], a[60:63], v[116:119]
    v_rsq_f32 v128, v128
    v_mfma_f32_16x16x32_bf16 v[112:115], a[136:139], a[136:139], v[112:115]
    v_rsq_f32 v129, v129
    v_mfma_f32_16x16x32_bf16 v[116:119], a[136:139], a[64:67], v[116:119]
    v_rsq_f32 v130, v130
    v_mfma_f32_16x16x32_bf16 v[112:115], a[140:143], a[140:143], v[112:115]
    v_rsq_f32 v131, v131
    v_mfma_f32_16x16x32_bf16 v[116:119], a[140:143], a[68:71], v[116:119]
    v_fma_f32 v88, -v92, v61, v88
    v_fma_f32 v89, -v93, v61, v89
    v_mfma_f32_16x16x32_bf16 v[108:111], a[120:123], v[52:55], v[80:83]
    v_fma_f32 v90, -v94, v61, v90
    v_fma_f32 v91, -v95, v61, v91
    v_mfma_f32_16x16x32_bf16 v[108:111], a[124:127], v[52:55], v[108:111]
    v_fma_f32 v88, v88, v128, v62
    v_fma_f32 v89, v89, v129, v62
    v_mfma_f32_16x16x32_bf16 v[108:111], a[128:131], v[52:55], v[108:111]
    v_fma_f32 v90, v90, v130, v62
    v_fma_f32 v91, v91, v131, v62
    v_mfma_f32_16x16x32_bf16 v[108:111], a[132:135], v[52:55], v[108:111]
    v_max3_f32 v1, v88, v89, v90
    v_max_f32 v1, v1, v91
    v_mfma_f32_16x16x32_bf16 v[108:111], a[136:139], v[52:55], v[108:111]
    v_cmp_lt_f32 vcc, s52, v1
    s_cbranch_vccnz L_site4
L_back4:
    v_mfma_f32_16x16x32_bf16 v[108:111], a[140:143], v[52:55], v[108:111]
    v_exp_f32 v96, v88
    v_mfma_f32_16x16x32_bf16 v[104:107], a[120:123], v[136:139], v[76:79]
    s_cmp_eq_u32 s0, 0
    s_cbranch_scc0 L_g44
    s_waitcnt vmcnt(5)
L_g44:
    buffer_load_dwordx4 v29, s[24:27], s58 offen offset:3072 nt lds
    v_exp_f32 v97, v89
    v_mfma_f32_16x16x32_bf16 v[104:107], a[124:127], v[140:143], v[104:107]
    v_exp_f32 v98, v90
    v_mfma_f32_16x16x32_bf16 v[104:107], a[128:131], v[144:147], v[104:107]
    v_exp_f32 v99, v91
    v_mfma_f32_16x16x32_bf16 v[104:107], a[132:135], v[148:151], v[104:107]
    v_mul_f32 v88, v96, v128
    v_mul_f32 v89, v97, v129
    v_mfma_f32_16x16x32_bf16 v[104:107], a[136:139], v[152:155], v[104:107]
    v_mul_f32 v90, v98, v130
    v_mul_f32 v91, v99, v131
    v_mfma_f32_16x16x32_bf16 v[104:107], a[140:143], v[156:159], v[104:107]
    v_fma_f32 v112, v116, 2.0, v112
    v_fma_f32 v113, v117, 2.0, v113
    v_fma_f32 v114, v118, 2.0, v114
    v_fma_f32 v115, v119, 2.0, v115
    v_cndmask_b32 v4, 0, v112, s[44:45]
    v_cndmask_b32 v4, v4, v113, s[46:47]
    v_cndmask_b32 v4, v4, v114, s[48:49]
    v_cndmask_b32 v4, v4, v115, s[50:51]
    v_add_f32 v63, v63, v96
    v_fmac_f32 v64, v88, v92
    v_mfma_f32_16x16x4_f32 v[124:127], v4, v60, v[56:59]
    v_add_f32 v63, v63, v97
    v_fmac_f32 v64, v89, v93
    v_add_f32 v63, v63, v98
    v_fmac_f32 v64, v90, v94
    v_add_f32 v63, v63, v99
    v_fmac_f32 v64, v91, v95
    v_add_f32 v68, v68, v88
    v_add_f32 v69, v69, v89
    v_add_f32 v70, v70, v90
    v_add_f32 v71, v71, v91
    v_add_u32 v44, -49152, v44
    v_add_u32 v45, -49152, v45
    v_add_u32 v46, -49152, v46
    v_add_u32 v47, -49152, v47
    v_add_u32 v48, -49152, v48
    v_add_u32 v49, -49152, v49
    v_fma_f32 v132, -v108, v108, v124
    v_fma_f32 v133, -v109, v109, v125
    v_fma_f32 v134, -v110, v110, v126
    v_fma_f32 v135, -v111, v111, v127
    v_max_f32 v132, v132, v56
    v_max_f32 v133, v133, v56
    v_max_f32 v134, v134, v56
    v_max_f32 v135, v135, v56
    v_rsq_f32 v132, v132
    v_rsq_f32 v133, v133
    v_rsq_f32 v134, v134
    v_rsq_f32 v135, v135
    s_cmp_eq_u32 s0, 0
    s_cbranch_scc0 L_g45
    s_waitcnt vmcnt(5)
L_g45:
    s_add_u32 m0, s41, 8192
    s_nop 0
    buffer_load_dwordx4 v30, s[24:27], s58 offen offset:0 nt lds
    v_fma_f32 v104, -v108, v61, v104
    v_fma_f32 v105, -v109, v61, v105
    v_fma_f32 v106, -v110, v61, v106
    v_fma_f32 v107, -v111, v61, v107
    v_fma_f32 v104, v104, v132, v62
    v_fma_f32 v105, v105, v133, v62
    v_fma_f32 v106, v106, v134, v62
    v_fma_f32 v107, v107, v135, v62
    v_max3_f32 v1, v104, v105, v106
    v_max_f32 v1, v1, v107
    v_cmp_lt_f32 vcc, s52, v1
    s_cbranch_vccnz L_site5
L_back5:
    v_exp_f32 v112, v104
    v_exp_f32 v113, v105
    v_exp_f32 v114, v106
    v_exp_f32 v115, v107
    v_cvt_pk_bf16_f32 v72, v88, v89
    v_cvt_pk_bf16_f32 v73, v90, v91
    v_mul_f32 v104, v112, v132
    v_mul_f32 v105, v113, v133
    v_mul_f32 v106, v114, v134
    v_mul_f32 v107, v115, v135
    v_cvt_pk_bf16_f32 v74, v104, v105
    v_cvt_pk_bf16_f32 v75, v106, v107
    ds_write_b128 v237, v[72:75] offset:0
    v_add_f32 v68, v68, v104
    v_add_f32 v69, v69, v105
    v_add_f32 v70, v70, v106
    v_add_f32 v71, v71, v107
    v_cvt_pk_bf16_f32 v66, v68, v69
    v_cvt_pk_bf16_f32 v67, v70, v71
    ds_write_b64 v238, v[66:67]
    s_cmp_eq_u32 s0, 0
    s_cbranch_scc0 L_g46
    s_waitcnt vmcnt(5)
L_g46:
    buffer_load_dwordx4 v31, s[24:27], s58 offen offset:1024 nt lds
    s_cmp_eq_u32 s0, 0
    s_cbranch_scc0 L_g47
    s_waitcnt vmcnt(5)
L_g47:
    buffer_load_dwordx4 v32, s[24:27], s58 offen offset:2048 nt lds
    s_waitcnt vmcnt(12)
    s_waitcnt vmcnt(11)
    v_cmp_ne_u32 vcc, s39, v234
    s_cbranch_vccnz L_fl_retry
L_fl_ok:
    v_readlane_b32 s20, v235, 3
    v_readlane_b32 s21, v235, 4
    s_sub_u32 s20, s20, s21
    v_readlane_b32 s21, v235, 5
    s_add_u32 s20, s20, s21
    v_readlane_b32 s21, v235, 6
    s_sub_u32 s20, s20, s21
    v_readlane_b32 s21, v235, 7
    s_add_u32 s20, s20, s21
    v_readlane_b32 s21, v235, 8
    s_sub_u32 s20, s20, s21
    s_lshr_b32 s1, s20, 31
    s_waitcnt lgkmcnt(0)
    s_barrier
L_post6:
    ds_read_b32 v9, v254 offset:4096
    ds_read_b64 v[120:121], v254 offset:0
    ds_read_b64 v[122:123], v254 offset:512
    ds_read_b64 v[124:125], v254 offset:1024
    ds_read_b64 v[126:127], v254 offset:1536
    ds_read_b128 v[92:95], v253 offset:0
    ds_read_b128 v[96:99], v253 offset:1024
    ds_read_b128 v[100:103], v253 offset:2048
    ds_read_b128 v[116:119], v253 offset:3072
    ds_read_b128 a[48:51], v34 offset:0
    ds_read_b128 a[52:55], v35 offset:0
    ds_read_b128 a[56:59], v34 offset:128
    ds_read_b128 a[60:63], v35 offset:128
    ds_read_b128 a[64:67], v34 offset:256
    ds_read_b128 a[68:71], v35 offset:256
    s_waitcnt lgkmcnt(14)
    v_cmp_ne_u32 vcc, 0, v9
    s_cbranch_vccnz L_xt6
    s_waitcnt lgkmcnt(12)
    v_mfma_f32_16x16x32_bf16 a[0:3], a[72:75], v[120:123], a[0:3]
    s_cmp_eq_u32 s0, 0
    s_cbranch_scc0 L_g48
    s_waitcnt vmcnt(5)
L_g48:
    buffer_load_dwordx4 v33, s[24:27], s58 offen offset:3072 nt lds
    v_add_f32 v63, v63, v112
    v_fma_f32 v64, v104, v108, v64
    v_mfma_f32_16x16x32_bf16 a[4:7], a[80:83], v[120:123], a[4:7]
    v_add_f32 v63, v63, v113
    v_fma_f32 v64, v105, v109, v64
    v_mfma_f32_16x16x32_bf16 a[8:11], a[88:91], v[120:123], a[8:11]
    v_add_f32 v63, v63, v114
    v_fma_f32 v64, v106, v110, v64
    s_waitcnt lgkmcnt(10)
    v_mfma_f32_16x16x32_bf16 a[0:3], a[76:79], v[124:127], a[0:3]
    v_add_f32 v63, v63, v115
    v_fma_f32 v64, v107, v111, v64
    v_mfma_f32_16x16x32_bf16 a[4:7], a[84:87], v[124:127], a[4:7]
    v_mfma_f32_16x16x32_bf16 a[8:11], a[92:95], v[124:127], a[8:11]
    s_waitcnt lgkmcnt(9)
    v_mfma_f32_16x16x32_bf16 a[0:3], a[144:147], v[92:95], a[0:3]
    ds_read_b64_tr_b16 a[72:73], v36 offset:0
    ds_read_b64_tr_b16 a[74:75], v36 offset:6144
    v_mfma_f32_16x16x32_bf16 a[4:7], a[160:163], v[92:95], a[4:7]
    s_cmp_eq_u32 s0, 0
    s_cbranch_scc0 L_g49
    s_waitcnt vmcnt(5)
L_g49:
    s_add_u32 m0, s42, 0
    s_add_u32 s59, s37, 50528256
    buffer_load_dwordx4 v22, s[24:27], s59 offen offset:0 nt lds
    ds_read_b64_tr_b16 a[76:77], v36 offset:12288
    ds_read_b64_tr_b16 a[78:79], v36 offset:18432
    v_mfma_f32_16x16x32_bf16 a[8:11], a[176:179], v[92:95], a[8:11]
    ds_read_b64_tr_b16 a[80:81], v37 offset:0
    ds_read_b64_tr_b16 a[82:83], v37 offset:6144
    s_waitcnt lgkmcnt(14)
    v_mfma_f32_16x16x32_bf16 a[0:3], a[148:151], v[96:99], a[0:3]
    ds_read_b64_tr_b16 a[84:85], v37 offset:12288
    ds_read_b64_tr_b16 a[86:87], v37 offset:18432
    v_mfma_f32_16x16x32_bf16 a[4:7], a[164:167], v[96:99], a[4:7]
    ds_read_b64_tr_b16 a[88:89], v38 offset:0
    ds_read_b64_tr_b16 a[90:91], v38 offset:6144
    v_mfma_f32_16x16x32_bf16 a[8:11], a[180:183], v[96:99], a[8:11]
    ds_read_b64_tr_b16 a[92:93], v38 offset:12288
    ds_read_b64_tr_b16 a[94:95], v38 offset:18432
    s_waitcnt lgkmcnt(15)
    v_mfma_f32_16x16x32_bf16 a[0:3], a[152:155], v[100:103], a[0:3]
    v_mfma_f32_16x16x32_bf16 a[4:7], a[168:171], v[100:103], a[4:7]
    v_mfma_f32_16x16x32_bf16 a[8:11], a[184:187], v[100:103], a[8:11]
    v_mfma_f32_16x16x32_bf16 a[0:3], a[156:159], v[116:119], a[0:3]
    v_mfma_f32_16x16x32_bf16 a[4:7], a[172:175], v[116:119], a[4:7]
    v_mfma_f32_16x16x32_bf16 a[8:11], a[188:191], v[116:119], a[8:11]
    v_mfma_f32_16x16x32_bf16 v[84:87], a[48:51], a[48:51], 0
    s_cmp_eq_u32 s0, 0
    s_cbranch_scc0 L_g50
    s_waitcnt vmcnt(5)
L_g50:
    buffer_load_dwordx4 v23, s[24:27], s59 offen offset:1024 nt lds
    v_mfma_f32_16x16x32_bf16 v[80:83], a[48:51], v[52:55], 0
    v_mfma_f32_16x16x32_bf16 v[84:87], a[52:55], a[52:55], v[84:87]
    v_mfma_f32_16x16x32_bf16 v[80:83], a[52:55], v[52:55], v[80:83]
    v_mfma_f32_16x16x32_bf16 v[84:87], a[56:59], a[56:59], v[84:87]
    v_mfma_f32_16x16x32_bf16 v[80:83], a[56:59], v[52:55], v[80:83]
    s_waitcnt lgkmcnt(14)
    v_mfma_f32_16x16x32_bf16 v[84:87], a[60:63], a[60:63], v[84:87]
    v_mfma_f32_16x16x32_bf16 v[80:83], a[60:63], v[52:55], v[80:83]
    s_waitcnt lgkmcnt(13)
    v_mfma_f32_16x16x32_bf16 v[84:87], a[64:67], a[64:67], v[84:87]
    v_mfma_f32_16x16x32_bf16 v[80:83], a[64:67], v[52:55], v[80:83]
    s_waitcnt lgkmcnt(12)
    v_mfma_f32_16x16x32_bf16 v[84:87], a[68:71], a[68:71], v[84:87]
    v_mfma_f32_16x16x32_bf16 v[80:83], a[68:71], v[52:55], v[80:83]
    s_waitcnt lgkmcnt(0)
    v_mfma_f32_16x16x32_bf16 v[76:79], a[48:51], v[136:139], 0
    v_mfma_f32_16x16x32_bf16 v[76:79], a[52:55], v[140:143], v[76:79]
    v_mfma_f32_16x16x32_bf16 v[76:79], a[56:59], v[144:147], v[76:79]
    s_add_u32 s61, s60, 3145728
    buffer_load_dwordx4 v[160:163], v65, s[72:75], s61 offen offset:0 sc1
    v_mfma_f32_16x16x32_bf16 v[76:79], a[60:63], v[148:151], v[76:79]
    v_mfma_f32_16x16x32_bf16 v[76:79], a[64:67], v[152:155], v[76:79]
    v_mfma_f32_16x16x32_bf16 v[76:79], a[68:71], v[156:159], v[76:79]
    s_cmp_eq_u32 s0, 0
    s_cbranch_scc0 L_g51
    s_waitcnt vmcnt(6)
L_g51:
    buffer_load_dwordx4 v24, s[24:27], s59 offen offset:2048 nt lds
    s_cmp_eq_u32 s0, 0
    s_cbranch_scc0 L_g52
    s_waitcnt vmcnt(6)
L_g52:
    buffer_load_dwordx4 v25, s[24:27], s59 offen offset:3072 nt lds
    buffer_load_dwordx4 v[164:167], v65, s[72:75], s61 offen offset:1024 sc1
    s_cmp_eq_u32 s0, 0
    s_cbranch_scc0 L_g53
    s_waitcnt vmcnt(7)
L_g53:
    s_add_u32 m0, s42, 4096
    s_nop 0
    buffer_load_dwordx4 v26, s[24:27], s59 offen offset:0 nt lds
    s_cmp_eq_u32 s0, 0
    s_cbranch_scc0 L_g54
    s_waitcnt vmcnt(7)
L_g54:
    buffer_load_dwordx4 v27, s[24:27], s59 offen offset:1024 nt lds
    s_cmp_eq_u32 s0, 0
    s_cbranch_scc0 L_g55
    s_waitcnt vmcnt(7)
L_g55:
    buffer_load_dwordx4 v28, s[24:27], s59 offen offset:2048 nt lds
    buffer_load_dwordx4 v[168:171], v65, s[72:75], s61 offen offset:2048 sc1
    s_cmp_eq_u32 s0, 0
    s_cbranch_scc0 L_g56
    s_waitcnt vmcnt(8)
L_g56:
    buffer_load_dwordx4 v29, s[24:27], s59 offen offset:3072 nt lds
    s_waitcnt vmcnt(11)
    s_barrier
    ds_read_b128 a[96:99], v40 offset:0
    ds_read_b128 a[100:103], v41 offset:0
    ds_read_b128 a[104:107], v42 offset:0
    ds_read_b128 a[108:111], v43 offset:0
    ds_read_b128 a[112:115], v40 offset:256
    ds_read_b128 a[116:119], v41 offset:256
    ds_read_b128 a[120:123], v42 offset:256
    ds_read_b128 a[124:127], v43 offset:256
    ds_read_b128 a[128:131], v40 offset:512
    ds_read_b128 a[132:135], v41 offset:512
    ds_read_b128 a[136:139], v42 offset:512
    ds_read_b128 a[140:143], v43 offset:512
    s_waitcnt lgkmcnt(11)
    v_mfma_f32_16x16x32_bf16 v[96:99], a[96:99], a[96:99], v[84:87]
    ds_read_b64_tr_b16 a[144:145], v44 offset:0
    ds_read_b64_tr_b16 a[146:147], v45 offset:0
    v_mfma_f32_16x16x32_bf16 v[100:103], a[96:99], a[48:51], 0
    ds_read_b64_tr_b16 a[148:149], v44 offset:12288
    ds_read_b64_tr_b16 a[150:151], v45 offset:12288
    s_waitcnt lgkmcnt(14)
    v_mfma_f32_16x16x32_bf16 v[96:99], a[100:103], a[100:103], v[96:99]
    ds_read_b64_tr_b16 a[152:153], v44 offset:24576
    ds_read_b64_tr_b16 a[154:155], v45 offset:24576
    v_mfma_f32_16x16x32_bf16 v[100:103], a[100:103], a[52:55], v[100:103]
    ds_read_b64_tr_b16 a[156:157], v44 offset:36864
    ds_read_b64_tr_b16 a[158:159], v45 offset:36864
    s_waitcnt lgkmcnt(15)
    v_mfma_f32_16x16x32_bf16 v[96:99], a[104:107], a[104:107], v[96:99]
    ds_read_b64_tr_b16 a[160:161], v46 offset:0
    ds_read_b64_tr_b16 a[162:163], v47 offset:0
    v_mfma_f32_16x16x32_bf16 v[100:103], a[104:107], a[56:59], v[100:103]
    ds_read_b64_tr_b16 a[164:165], v46 offset:12288
    ds_read_b64_tr_b16 a[166:167], v47 offset:12288
    v_mfma_f32_16x16x32_bf16 v[96:99], a[108:111], a[108:111], v[96:99]
    s_cmp_eq_u32 s0, 0
    s_cbranch_scc0 L_g57
    s_waitcnt vmcnt(7)
L_g57:
    s_add_u32 m0, s42, 8192
    s_nop 0
    buffer_load_dwordx4 v30, s[24:27], s59 offen offset:0 nt lds
    ds_read_b64_tr_b16 a[168:169], v46 offset:24576
    ds_read_b64_tr_b16 a[170:171], v47 offset:24576
    v_mfma_f32_16x16x32_bf16 v[100:103], a[108:111], a[60:63], v[100:103]
    ds_read_b64_tr_b16 a[172:173], v46 offset:36864
    ds_read_b64_tr_b16 a[174:175], v47 offset:36864
    v_mfma_f32_16x16x32_bf16 v[96:99], a[112:115], a[112:115], v[96:99]
    ds_read_b64_tr_b16 a[176:177], v48 offset:0
    ds_read_b64_tr_b16 a[178:179], v49 offset:0
    v_mfma_f32_16x16x32_bf16 v[100:103], a[112:115], a[64:67], v[100:103]
    ds_read_b64_tr_b16 a[180:181], v48 offset:12288
    ds_read_b64_tr_b16 a[182:183], v49 offset:12288
    s_waitcnt lgkmcnt(15)
    v_mfma_f32_16x16x32_bf16 v[96:99], a[116:119], a[116:119], v[96:99]
    ds_read_b64_tr_b16 a[184:185], v48 offset:24576
    ds_read_b64_tr_b16 a[186:187], v49 offset:24576
    v_mfma_f32_16x16x32_bf16 v[100:103], a[116:119], a[68:71], v[100:103]
    ds_read_b64_tr_b16 a[188:189], v48 offset:36864
    ds_read_b64_tr_b16 a[190:191], v49 offset:36864
    v_mfma_f32_16x16x32_bf16 v[92:95], a[96:99], v[52:55], v[80:83]
    v_mfma_f32_16x16x32_bf16 v[92:95], a[100:103], v[52:55], v[92:95]
    v_mfma_f32_16x16x32_bf16 v[92:95], a[104:107], v[52:55], v[92:95]
    v_mfma_f32_16x16x32_bf16 v[92:95], a[108:111], v[52:55], v[92:95]
    s_nop 1
    v_fma_f32 v96, v100, 2.0, v96
    v_fma_f32 v97, v101, 2.0, v97
    v_mfma_f32_16x16x32_bf16 v[92:95], a[112:115], v[52:55], v[92:95]
    v_fma_f32 v98, v102, 2.0, v98
    v_fma_f32 v99, v103, 2.0, v99
    v_mfma_f32_16x16x32_bf16 v[92:95], a[116:119], v[52:55], v[92:95]
    v_cndmask_b32 v3, 0, v96, s[44:45]
    v_cndmask_b32 v3, v3, v97, s[46:47]
    v_mfma_f32_16x16x32_bf16 v[88:91], a[96:99], v[136:139], v[76:79]
    buffer_load_dwordx4 v[172:175], v65, s[72:75], s61 offen offset:3072 sc1
    v_cndmask_b32 v3, v3, v98, s[48:49]
    v_cndmask_b32 v3, v3, v99, s[50:51]
    v_mfma_f32_16x16x32_bf16 v[88:91], a[100:103], v[140:143], v[88:91]
    s_cmp_eq_u32 s0, 0
    s_cbranch_scc0 L_g58
    s_waitcnt vmcnt(8)
L_g58:
    buffer_load_dwordx4 v31, s[24:27], s59 offen offset:1024 nt lds
    s_nop 0
    s_nop 0
    v_mfma_f32_16x16x32_bf16 v[88:91], a[104:107], v[144:147], v[88:91]
    v_mfma_f32_16x16x4_f32 v[120:123], v3, v60, v[56:59]
    v_mfma_f32_16x16x32_bf16 v[88:91], a[108:111], v[148:151], v[88:91]
    v_mfma_f32_16x16x32_bf16 v[88:91], a[112:115], v[152:155], v[88:91]
    v_mfma_f32_16x16x32_bf16 v[88:91], a[116:119], v[156:159], v[88:91]
    v_mfma_f32_16x16x32_bf16 v[112:115], a[120:123], a[120:123], v[84:87]
    v_mfma_f32_16x16x32_bf16 v[116:119], a[120:123], a[48:51], 0
    v_mfma_f32_16x16x32_bf16 v[112:115], a[124:127], a[124:127], v[112:115]
    v_mfma_f32_16x16x32_bf16 v[116:119], a[124:127], a[52:55], v[116:119]
    s_nop 2
    v_fma_f32 v128, -v92, v92, v120
    v_fma_f32 v129, -v93, v93, v121
    v_mfma_f32_16x16x32_bf16 v[112:115], a[128:131], a[128:131], v[112:115]
    s_cmp_eq_u32 s0, 0
    s_cbranch_scc0 L_g59
    s_waitcnt vmcnt(7)
L_g59:
    buffer_load_dwordx4 v32, s[24:27], s59 offen offset:2048 nt lds
    v_fma_f32 v130, -v94, v94, v122
    v_fma_f32 v131, -v95, v95, v123
    v_mfma_f32_16x16x32_bf16 v[116:119], a[128:131], a[56:59], v[116:119]
    v_max_f32 v128, v128, v56
    v_max_f32 v129, v129, v56
    v_mfma_f32_16x16x32_bf16 v[112:115], a[132:135], a[132:135], v[112:115]
    v_max_f32 v130, v130, v56
    v_max_f32 v131, v131, v56
    v_mfma_f32_16x16x32_bf16 v[116:119], a[132:135], a[60:63], v[116:119]
    v_rsq_f32 v128, v128
    v_mfma_f32_16x16x32_bf16 v[112:115], a[136:139], a[136:139], v[112:115]
    v_rsq_f32 v129, v129
    v_mfma_f32_16x16x32_bf16 v[116:119], a[136:139], a[64:67], v[116:119]
    v_rsq_f32 v130, v130
    v_mfma_f32_16x16x32_bf16 v[112:115], a[140:143], a[140:143], v[112:115]
    v_rsq_f32 v131, v131
    v_mfma_f32_16x16x32_bf16 v[116:119], a[140:143], a[68:71], v[116:119]
    v_fma_f32 v88, -v92, v61, v88
    v_fma_f32 v89, -v93, v61, v89
    v_mfma_f32_16x16x32_bf16 v[108:111], a[120:123], v[52:55], v[80:83]
    v_fma_f32 v90, -v94, v61, v90
    v_fma_f32 v91, -v95, v61, v91
    v_mfma_f32_16x16x32_bf16 v[108:111], a[124:127], v[52:55], v[108:111]
    v_fma_f32 v88, v88, v128, v62
    v_fma_f32 v89, v89, v129, v62
    v_mfma_f32_16x16x32_bf16 v[108:111], a[128:131], v[52:55], v[108:111]
    v_fma_f32 v90, v90, v130, v62
    v_fma_f32 v91, v91, v131, v62
    v_mfma_f32_16x16x32_bf16 v[108:111], a[132:135], v[52:55], v[108:111]
    v_max3_f32 v1, v88, v89, v90
    v_max_f32 v1, v1, v91
    v_mfma_f32_16x16x32_bf16 v[108:111], a[136:139], v[52:55], v[108:111]
    buffer_load_dwordx4 v33, s[24:27], s59 offen offset:3072 nt lds
    v_cmp_lt_f32 vcc, s52, v1
    s_cbranch_vccnz L_site6
L_back6:
    v_mfma_f32_16x16x32_bf16 v[108:111], a[140:143], v[52:55], v[108:111]
    s_add_u32 s61, s60, 3149824
    buffer_load_dwordx4 v[176:179], v65, s[72:75], s61 offen offset:0 sc1
    v_exp_f32 v96, v88
    v_mfma_f32_16x16x32_bf16 v[104:107], a[120:123], v[136:139], v[76:79]
    v_exp_f32 v97, v89
    v_mfma_f32_16x16x32_bf16 v[104:107], a[124:127], v[140:143], v[104:107]
    v_exp_f32 v98, v90
    v_mfma_f32_16x16x32_bf16 v[104:107], a[128:131], v[144:147], v[104:107]
    v_exp_f32 v99, v91
    v_mfma_f32_16x16x32_bf16 v[104:107], a[132:135], v[148:151], v[104:107]
    v_mul_f32 v88, v96, v128
    v_mul_f32 v89, v97, v129
    v_mfma_f32_16x16x32_bf16 v[104:107], a[136:139], v[152:155], v[104:107]
    v_mul_f32 v90, v98, v130
    v_mul_f32 v91, v99, v131
    v_mfma_f32_16x16x32_bf16 v[104:107], a[140:143], v[156:159], v[104:107]
    v_fma_f32 v112, v116, 2.0, v112
    v_fma_f32 v113, v117, 2.0, v113
    v_fma_f32 v114, v118, 2.0, v114
    v_fma_f32 v115, v119, 2.0, v115
    v_cndmask_b32 v4, 0, v112, s[44:45]
    v_cndmask_b32 v4, v4, v113, s[46:47]
    v_cndmask_b32 v4, v4, v114, s[48:49]
    v_cndmask_b32 v4, v4, v115, s[50:51]
    v_add_f32 v63, v63, v96
    v_fmac_f32 v64, v88, v92
    v_mfma_f32_16x16x4_f32 v[124:127], v4, v60, v[56:59]
    v_add_f32 v63, v63, v97
    v_fmac_f32 v64, v89, v93
    v_add_f32 v63, v63, v98
    v_fmac_f32 v64, v90, v94
    v_add_f32 v63, v63, v99
    v_fmac_f32 v64, v91, v95
    v_mov_b32 v68, v88
    v_mov_b32 v69, v89
    v_mov_b32 v70, v90
    v_mov_b32 v71, v91
    v_add_u32 v44, 49152, v44
    v_add_u32 v45, 49152, v45
    v_add_u32 v46, 49152, v46
    v_add_u32 v47, 49152, v47
    v_add_u32 v48, 49152, v48
    v_add_u32 v49, 49152, v49
    v_fma_f32 v132, -v108, v108, v124
    v_fma_f32 v133, -v109, v109, v125
    v_fma_f32 v134, -v110, v110, v126
    v_fma_f32 v135, -v111, v111, v127
    v_max_f32 v132, v132, v56
    v_max_f32 v133, v133, v56
    v_max_f32 v134, v134, v56
    v_max_f32 v135, v135, v56
    v_rsq_f32 v132, v132
    v_rsq_f32 v133, v133
    v_rsq_f32 v134, v134
    v_rsq_f32 v135, v135
    s_add_u32 m0, s40, 0
    s_add_u32 s57, s36, 18874368
    buffer_load_dwordx4 v16, s[28:31], s57 offen offset:0 nt lds
    v_fma_f32 v104, -v108, v61, v104
    v_fma_f32 v105, -v109, v61, v105
    v_fma_f32 v106, -v110, v61, v106
    v_fma_f32 v107, -v111, v61, v107
    v_fma_f32 v104, v104, v132, v62
    v_fma_f32 v105, v105, v133, v62
    v_fma_f32 v106, v106, v134, v62
    v_fma_f32 v107, v107, v135, v62
    v_max3_f32 v1, v104, v105, v106
    v_max_f32 v1, v1, v107
    v_cmp_lt_f32 vcc, s52, v1
    s_cbranch_vccnz L_site7
L_back7:
    v_exp_f32 v112, v104
    v_exp_f32 v113, v105
    v_exp_f32 v114, v106
    v_exp_f32 v115, v107
    v_cvt_pk_bf16_f32 v72, v88, v89
    v_cvt_pk_bf16_f32 v73, v90, v91
    v_mul_f32 v104, v112, v132
    v_mul_f32 v105, v113, v133
    v_mul_f32 v106, v114, v134
    v_mul_f32 v107, v115, v135
    v_cvt_pk_bf16_f32 v74, v104, v105
    v_cvt_pk_bf16_f32 v75, v106, v107
    ds_write_b128 v237, v[72:75] offset:0
    s_waitcnt lgkmcnt(0)
    s_barrier
L_post27:
    ds_read_b32 v9, v254 offset:4096
    ds_read_b128 v[92:95], v253 offset:0
    ds_read_b128 v[96:99], v253 offset:1024
    ds_read_b128 v[100:103], v253 offset:2048
    ds_read_b128 v[116:119], v253 offset:3072
    s_waitcnt lgkmcnt(4)
    v_cmp_ne_u32 vcc, 0, v9
    s_cbranch_vccnz L_xt27
    s_waitcnt lgkmcnt(3)
    v_mfma_f32_16x16x32_bf16 a[0:3], a[144:147], v[92:95], a[0:3]
    buffer_load_dwordx4 v17, s[28:31], s57 offen offset:1024 nt lds
    v_add_f32 v68, v68, v104
    v_add_f32 v69, v69, v105
    v_mfma_f32_16x16x32_bf16 a[4:7], a[160:163], v[92:95], a[4:7]
    buffer_load_dwordx4 v[180:183], v65, s[72:75], s61 offen offset:1024 sc1
    v_add_f32 v70, v70, v106
    v_add_f32 v71, v71, v107
    v_mfma_f32_16x16x32_bf16 a[8:11], a[176:179], v[92:95], a[8:11]
    buffer_load_dwordx4 v18, s[28:31], s57 offen offset:2048 nt lds
    v_add_f32 v63, v63, v112
    v_fma_f32 v64, v104, v108, v64
    s_waitcnt lgkmcnt(2)
    v_mfma_f32_16x16x32_bf16 a[0:3], a[148:151], v[96:99], a[0:3]
    v_add_f32 v63, v63, v113
    v_fma_f32 v64, v105, v109, v64
    v_mfma_f32_16x16x32_bf16 a[4:7], a[164:167], v[96:99], a[4:7]
    v_add_f32 v63, v63, v114
    v_fma_f32 v64, v106, v110, v64
    v_mfma_f32_16x16x32_bf16 a[8:11], a[180:183], v[96:99], a[8:11]
    buffer_load_dwordx4 v19, s[28:31], s57 offen offset:3072 nt lds
    v_add_f32 v63, v63, v115
    v_fma_f32 v64, v107, v111, v64
    s_waitcnt lgkmcnt(1)
    v_mfma_f32_16x16x32_bf16 a[0:3], a[152:155], v[100:103], a[0:3]
    v_mfma_f32_16x16x32_bf16 a[4:7], a[168:171], v[100:103], a[4:7]
    v_mfma_f32_16x16x32_bf16 a[8:11], a[184:187], v[100:103], a[8:11]
    s_waitcnt lgkmcnt(0)
    v_mfma_f32_16x16x32_bf16 a[0:3], a[156:159], v[116:119], a[0:3]
    v_mfma_f32_16x16x32_bf16 a[4:7], a[172:175], v[116:119], a[4:7]
    v_mfma_f32_16x16x32_bf16 a[8:11], a[188:191], v[116:119], a[8:11]
    s_add_u32 m0, s40, 4096
    s_nop 0
    buffer_load_dwordx4 v20, s[28:31], s57 offen offset:0 nt lds
    buffer_load_dwordx4 v[184:187], v65, s[72:75], s61 offen offset:2048 sc1
    buffer_load_dwordx4 v21, s[28:31], s57 offen offset:1024 nt lds
    s_add_u32 m0, s41, 0
    s_add_u32 s58, s37, 75497472
    buffer_load_dwordx4 v224, s[24:27], s58 offen offset:0 nt lds
    buffer_load_dwordx4 v[188:191], v65, s[72:75], s61 offen offset:3072 sc1
    s_waitcnt vmcnt(11)
    s_barrier
    ds_read_b128 a[96:99], v40 offset:49152
    ds_read_b128 a[100:103], v41 offset:49152
    ds_read_b128 a[104:107], v42 offset:49152
    ds_read_b128 a[108:111], v43 offset:49152
    ds_read_b128 a[112:115], v40 offset:49408
    ds_read_b128 a[116:119], v41 offset:49408
    ds_read_b128 a[120:123], v42 offset:49408
    ds_read_b128 a[124:127], v43 offset:49408
    ds_read_b128 a[128:131], v40 offset:49664
    ds_read_b128 a[132:135], v41 offset:49664
    ds_read_b128 a[136:139], v42 offset:49664
    ds_read_b128 a[140:143], v43 offset:49664
    s_waitcnt lgkmcnt(11)
    v_mfma_f32_16x16x32_bf16 v[96:99], a[96:99], a[96:99], v[84:87]
    buffer_load_dwordx4 v225, s[24:27], s58 offen offset:1024 nt lds
    ds_read_b64_tr_b16 a[144:145], v44 offset:0
    ds_read_b64_tr_b16 a[146:147], v45 offset:0
    v_mfma_f32_16x16x32_bf16 v[100:103], a[96:99], a[48:51], 0
    ds_read_b64_tr_b16 a[148:149], v44 offset:12288
    ds_read_b64_tr_b16 a[150:151], v45 offset:12288
    s_waitcnt lgkmcnt(14)
    v_mfma_f32_16x16x32_bf16 v[96:99], a[100:103], a[100:103], v[96:99]
    ds_read_b64_tr_b16 a[152:153], v44 offset:24576
    ds_read_b64_tr_b16 a[154:155], v45 offset:24576
    v_mfma_f32_16x16x32_bf16 v[100:103], a[100:103], a[52:55], v[100:103]
    ds_read_b64_tr_b16 a[156:157], v44 offset:36864
    ds_read_b64_tr_b16 a[158:159], v45 offset:36864
    s_waitcnt lgkmcnt(15)
    v_mfma_f32_16x16x32_bf16 v[96:99], a[104:107], a[104:107], v[96:99]
    ds_read_b64_tr_b16 a[160:161], v46 offset:0
    ds_read_b64_tr_b16 a[162:163], v47 offset:0
    v_mfma_f32_16x16x32_bf16 v[100:103], a[104:107], a[56:59], v[100:103]
    s_add_u32 m0, s41, 2048
    s_add_u32 s58, s37, 75497600
    buffer_load_dwordx4 v224, s[24:27], s58 offen offset:0 nt lds
    ds_read_b64_tr_b16 a[164:165], v46 offset:12288
    ds_read_b64_tr_b16 a[166:167], v47 offset:12288
    v_mfma_f32_16x16x32_bf16 v[96:99], a[108:111], a[108:111], v[96:99]
    ds_read_b64_tr_b16 a[168:169], v46 offset:24576
    ds_read_b64_tr_b16 a[170:171], v47 offset:24576
    v_mfma_f32_16x16x32_bf16 v[100:103], a[108:111], a[60:63], v[100:103]
    ds_read_b64_tr_b16 a[172:173], v46 offset:36864
    ds_read_b64_tr_b16 a[174:175], v47 offset:36864
    v_mfma_f32_16x16x32_bf16 v[96:99], a[112:115], a[112:115], v[96:99]
    ds_read_b64_tr_b16 a[176:177], v48 offset:0
    ds_read_b64_tr_b16 a[178:179], v49 offset:0
    v_mfma_f32_16x16x32_bf16 v[100:103], a[112:115], a[64:67], v[100:103]
    ds_read_b64_tr_b16 a[180:181], v48 offset:12288
    ds_read_b64_tr_b16 a[182:183], v49 offset:12288
    s_waitcnt lgkmcnt(15)
    v_mfma_f32_16x16x32_bf16 v[96:99], a[116:119], a[116:119], v[96:99]
    ds_read_b64_tr_b16 a[184:185], v48 offset:24576
    ds_read_b64_tr_b16 a[186:187], v49 offset:24576
    v_mfma_f32_16x16x32_bf16 v[100:103], a[116:119], a[68:71], v[100:103]
    ds_read_b64_tr_b16 a[188:189], v48 offset:36864
    ds_read_b64_tr_b16 a[190:191], v49 offset:36864
    v_mfma_f32_16x16x32_bf16 v[92:95], a[96:99], v[52:55], v[80:83]
    v_mfma_f32_16x16x32_bf16 v[92:95], a[100:103], v[52:55], v[92:95]
    v_mfma_f32_16x16x32_bf16 v[92:95], a[104:107], v[52:55], v[92:95]
    v_mfma_f32_16x16x32_bf16 v[92:95], a[108:111], v[52:55], v[92:95]
    s_nop 1
    v_fma_f32 v96, v100, 2.0, v96
    v_fma_f32 v97, v101, 2.0, v97
    v_mfma_f32_16x16x32_bf16 v[92:95], a[112:115], v[52:55], v[92:95]
    buffer_load_dwordx4 v225, s[24:27], s58 offen offset:1024 nt lds
    v_fma_f32 v98, v102, 2.0, v98
    v_fma_f32 v99, v103, 2.0, v99
    v_mfma_f32_16x16x32_bf16 v[92:95], a[116:119], v[52:55], v[92:95]
    s_add_u32 s61, s60, 3153920
    buffer_load_dwordx4 v[192:195], v65, s[72:75], s61 offen offset:0 sc1
    v_cndmask_b32 v3, 0, v96, s[44:45]
    v_cndmask_b32 v3, v3, v97, s[46:47]
    v_mfma_f32_16x16x32_bf16 v[88:91], a[96:99], v[136:139], v[76:79]
    v_cndmask_b32 v3, v3, v98, s[48:49]
    v_cndmask_b32 v3, v3, v99, s[50:51]
    v_mfma_f32_16x16x32_bf16 v[88:91], a[100:103], v[140:143], v[88:91]
    s_nop 0
    s_nop 0
    v_mfma_f32_16x16x32_bf16 v[88:91], a[104:107], v[144:147], v[88:91]
    v_mfma_f32_16x16x4_f32 v[120:123], v3, v60, v[56:59]
    v_mfma_f32_16x16x32_bf16 v[88:91], a[108:111], v[148:151], v[88:91]
    v_mfma_f32_16x16x32_bf16 v[88:91], a[112:115], v[152:155], v[88:91]
    v_mfma_f32_16x16x32_bf16 v[88:91], a[116:119], v[156:159], v[88:91]
    v_mfma_f32_16x16x32_bf16 v[112:115], a[120:123], a[120:123], v[84:87]
    v_mfma_f32_16x16x32_bf16 v[116:119], a[120:123], a[48:51], 0
    v_mfma_f32_16x16x32_bf16 v[112:115], a[124:127], a[124:127], v[112:115]
    s_add_u32 m0, s41, 4096
    s_add_u32 s58, s37, 75497728
    buffer_load_dwordx4 v224, s[24:27], s58 offen offset:0 nt lds
    v_mfma_f32_16x16x32_bf16 v[116:119], a[124:127], a[52:55], v[116:119]
    v_fma_f32 v128, -v92, v92, v120
    v_fma_f32 v129, -v93, v93, v121
    v_mfma_f32_16x16x32_bf16 v[112:115], a[128:131], a[128:131], v[112:115]
    v_fma_f32 v130, -v94, v94, v122
    v_fma_f32 v131, -v95, v95, v123
    v_mfma_f32_16x16x32_bf16 v[116:119], a[128:131], a[56:59], v[116:119]
    v_max_f32 v128, v128, v56
    v_max_f32 v129, v129, v56
    v_mfma_f32_16x16x32_bf16 v[112:115], a[132:135], a[132:135], v[112:115]
    v_max_f32 v130, v130, v56
    v_max_f32 v131, v131, v56
    v_mfma_f32_16x16x32_bf16 v[116:119], a[132:135], a[60:63], v[116:119]
    v_rsq_f32 v128, v128
    v_mfma_f32_16x16x32_bf16 v[112:115], a[136:139], a[136:139], v[112:115]
    v_rsq_f32 v129, v129
    v_mfma_f32_16x16x32_bf16 v[116:119], a[136:139], a[64:67], v[116:119]
    v_rsq_f32 v130, v130
    v_mfma_f32_16x16x32_bf16 v[112:115], a[140:143], a[140:143], v[112:115]
    v_rsq_f32 v131, v131
    v_mfma_f32_16x16x32_bf16 v[116:119], a[140:143], a[68:71], v[116:119]
    v_fma_f32 v88, -v92, v61, v88
    v_fma_f32 v89, -v93, v61, v89
    v_mfma_f32_16x16x32_bf16 v[108:111], a[120:123], v[52:55], v[80:83]
    v_fma_f32 v90, -v94, v61, v90
    v_fma_f32 v91, -v95, v61, v91
    v_mfma_f32_16x16x32_bf16 v[108:111], a[124:127], v[52:55], v[108:111]
    v_fma_f32 v88, v88, v128, v62
    v_fma_f32 v89, v89, v129, v62
    v_mfma_f32_16x16x32_bf16 v[108:111], a[128:131], v[52:55], v[108:111]
    v_fma_f32 v90, v90, v130, v62
    v_fma_f32 v91, v91, v131, v62
    v_mfma_f32_16x16x32_bf16 v[108:111], a[132:135], v[52:55], v[108:111]
    buffer_load_dwordx4 v225, s[24:27], s58 offen offset:1024 nt lds
    v_max3_f32 v1, v88, v89, v90
    v_max_f32 v1, v1, v91
    v_mfma_f32_16x16x32_bf16 v[108:111], a[136:139], v[52:55], v[108:111]
    v_cmp_lt_f32 vcc, s52, v1
    s_cbranch_vccnz L_site8
L_back8:
    v_mfma_f32_16x16x32_bf16 v[108:111], a[140:143], v[52:55], v[108:111]
    v_exp_f32 v96, v88
    v_mfma_f32_16x16x32_bf16 v[104:107], a[120:123], v[136:139], v[76:79]
    v_exp_f32 v97, v89
    v_mfma_f32_16x16x32_bf16 v[104:107], a[124:127], v[140:143], v[104:107]
    v_exp_f32 v98, v90
    v_mfma_f32_16x16x32_bf16 v[104:107], a[128:131], v[144:147], v[104:107]
    v_exp_f32 v99, v91
    v_mfma_f32_16x16x32_bf16 v[104:107], a[132:135], v[148:151], v[104:107]
    v_mul_f32 v88, v96, v128
    v_mul_f32 v89, v97, v129
    v_mfma_f32_16x16x32_bf16 v[104:107], a[136:139], v[152:155], v[104:107]
    v_mul_f32 v90, v98, v130
    v_mul_f32 v91, v99, v131
    v_mfma_f32_16x16x32_bf16 v[104:107], a[140:143], v[156:159], v[104:107]
    v_fma_f32 v112, v116, 2.0, v112
    v_fma_f32 v113, v117, 2.0, v113
    v_fma_f32 v114, v118, 2.0, v114
    v_fma_f32 v115, v119, 2.0, v115
    v_cndmask_b32 v4, 0, v112, s[44:45]
    v_cndmask_b32 v4, v4, v113, s[46:47]
    v_cndmask_b32 v4, v4, v114, s[48:49]
    v_cndmask_b32 v4, v4, v115, s[50:51]
    v_add_f32 v63, v63, v96
    v_fmac_f32 v64, v88, v92
    v_mfma_f32_16x16x4_f32 v[124:127], v4, v60, v[56:59]
    v_add_f32 v63, v63, v97
    v_fmac_f32 v64, v89, v93
    v_add_f32 v63, v63, v98
    v_fmac_f32 v64, v90, v94
    v_add_f32 v63, v63, v99
    v_fmac_f32 v64, v91, v95
    v_add_f32 v68, v68, v88
    v_add_f32 v69, v69, v89
    v_add_f32 v70, v70, v90
    v_add_f32 v71, v71, v91
    v_add_u32 v44, -49152, v44
    v_add_u32 v45, -49152, v45
    v_add_u32 v46, -49152, v46
    v_add_u32 v47, -49152, v47
    v_add_u32 v48, -49152, v48
    v_add_u32 v49, -49152, v49
    v_fma_f32 v132, -v108, v108, v124
    v_fma_f32 v133, -v109, v109, v125
    v_fma_f32 v134, -v110, v110, v126
    v_fma_f32 v135, -v111, v111, v127
    v_max_f32 v132, v132, v56
    v_max_f32 v133, v133, v56
    v_max_f32 v134, v134, v56
    v_max_f32 v135, v135, v56
    v_rsq_f32 v132, v132
    v_rsq_f32 v133, v133
    v_rsq_f32 v134, v134
    v_rsq_f32 v135, v135
    buffer_load_dwordx4 v[196:199], v65, s[72:75], s61 offen offset:1024 sc1
    v_fma_f32 v104, -v108, v61, v104
    v_fma_f32 v105, -v109, v61, v105
    v_fma_f32 v106, -v110, v61, v106
    v_fma_f32 v107, -v111, v61, v107
    v_fma_f32 v104, v104, v132, v62
    v_fma_f32 v105, v105, v133, v62
    v_fma_f32 v106, v106, v134, v62
    v_fma_f32 v107, v107, v135, v62
    v_max3_f32 v1, v104, v105, v106
    v_max_f32 v1, v1, v107
    v_cmp_lt_f32 vcc, s52, v1
    s_cbranch_vccnz L_site9
L_back9:
    s_add_u32 m0, s41, 6144
    s_add_u32 s58, s37, 75497856
    buffer_load_dwordx4 v224, s[24:27], s58 offen offset:0 nt lds
    v_exp_f32 v112, v104
    v_exp_f32 v113, v105
    v_exp_f32 v114, v106
    v_exp_f32 v115, v107
    v_cvt_pk_bf16_f32 v72, v88, v89
    v_cvt_pk_bf16_f32 v73, v90, v91
    v_mul_f32 v104, v112, v132
    v_mul_f32 v105, v113, v133
    v_mul_f32 v106, v114, v134
    v_mul_f32 v107, v115, v135
    v_cvt_pk_bf16_f32 v74, v104, v105
    v_cvt_pk_bf16_f32 v75, v106, v107
    ds_write_b128 v237, v[72:75] offset:0
    v_add_f32 v68, v68, v104
    v_add_f32 v69, v69, v105
    v_add_f32 v70, v70, v106
    v_add_f32 v71, v71, v107
    v_cvt_pk_bf16_f32 v66, v68, v69
    v_cvt_pk_bf16_f32 v67, v70, v71
    ds_write_b64 v238, v[66:67]
    s_lshl_b32 s56, s3, 13
    v_lshl_add_u32 v233, v0, 7, s56
    v_min_u32 v233, L_hot - L_tail, v233
    v_add_u32 v233, L_tail - L_pc_main, v233
    global_load_dword v234, v233, s[100:101]
    s_waitcnt vmcnt(11)
    s_waitcnt lgkmcnt(0)
    s_barrier
L_post9:
    ds_read_b32 v9, v254 offset:4096
    ds_read_b64 v[120:121], v254 offset:0
    ds_read_b64 v[122:123], v254 offset:512
    ds_read_b64 v[124:125], v254 offset:1024
    ds_read_b64 v[126:127], v254 offset:1536
    ds_read_b128 v[92:95], v253 offset:0
    ds_read_b128 v[96:99], v253 offset:1024
    ds_read_b128 v[100:103], v253 offset:2048
    ds_read_b128 v[116:119], v253 offset:3072
    ds_read_b128 a[48:51], v34 offset:0
    ds_read_b128 a[52:55], v35 offset:0
    ds_read_b128 a[56:59], v34 offset:128
    ds_read_b128 a[60:63], v35 offset:128
    ds_read_b128 a[64:67], v34 offset:256
    ds_read_b128 a[68:71], v35 offset:256
    s_waitcnt lgkmcnt(14)
    v_cmp_ne_u32 vcc, 0, v9
    s_cbranch_vccnz L_xt9
    s_waitcnt lgkmcnt(12)
    v_mfma_f32_16x16x32_bf16 a[0:3], a[72:75], v[120:123], a[0:3]
    buffer_load_dwordx4 v225, s[24:27], s58 offen offset:1024 nt lds
    v_add_f32 v63, v63, v112
    v_fma_f32 v64, v104, v108, v64
    v_mfma_f32_16x16x32_bf16 a[4:7], a[80:83], v[120:123], a[4:7]
    s_add_u32 m0, s41, 8192
    s_add_u32 s58, s37, 75497984
    buffer_load_dwordx4 v224, s[24:27], s58 offen offset:0 nt lds
    v_add_f32 v63, v63, v113
    v_fma_f32 v64, v105, v109, v64
    v_mfma_f32_16x16x32_bf16 a[8:11], a[88:91], v[120:123], a[8:11]
    v_add_f32 v63, v63, v114
    v_fma_f32 v64, v106, v110, v64
    s_waitcnt lgkmcnt(10)
    v_mfma_f32_16x16x32_bf16 a[0:3], a[76:79], v[124:127], a[0:3]
    v_add_f32 v63, v63, v115
    v_fma_f32 v64, v107, v111, v64
    v_mfma_f32_16x16x32_bf16 a[4:7], a[84:87], v[124:127], a[4:7]
    v_mfma_f32_16x16x32_bf16 a[8:11], a[92:95], v[124:127], a[8:11]
    buffer_load_dwordx4 v[200:203], v65, s[72:75], s61 offen offset:2048 sc1
    s_waitcnt lgkmcnt(9)
    v_mfma_f32_16x16x32_bf16 a[0:3], a[144:147], v[92:95], a[0:3]
    ds_read_b64_tr_b16 a[72:73], v36 offset:0
    ds_read_b64_tr_b16 a[74:75], v36 offset:6144
    v_mfma_f32_16x16x32_bf16 a[4:7], a[160:163], v[92:95], a[4:7]
    ds_read_b64_tr_b16 a[76:77], v36 offset:12288
    ds_read_b64_tr_b16 a[78:79], v36 offset:18432
    v_mfma_f32_16x16x32_bf16 a[8:11], a[176:179], v[92:95], a[8:11]
    ds_read_b64_tr_b16 a[80:81], v37 offset:0
    ds_read_b64_tr_b16 a[82:83], v37 offset:6144
    s_waitcnt lgkmcnt(14)
    v_mfma_f32_16x16x32_bf16 a[0:3], a[148:151], v[96:99], a[0:3]
    ds_read_b64_tr_b16 a[84:85], v37 offset:12288
    ds_read_b64_tr_b16 a[86:87], v37 offset:18432
    v_mfma_f32_16x16x32_bf16 a[4:7], a[164:167], v[96:99], a[4:7]
    ds_read_b64_tr_b16 a[88:89], v38 offset:0
    ds_read_b64_tr_b16 a[90:91], v38 offset:6144
    v_mfma_f32_16x16x32_bf16 a[8:11], a[180:183], v[96:99], a[8:11]
    ds_read_b64_tr_b16 a[92:93], v38 offset:12288
    ds_read_b64_tr_b16 a[94:95], v38 offset:18432
    s_waitcnt lgkmcnt(15)
    v_mfma_f32_16x16x32_bf16 a[0:3], a[152:155], v[100:103], a[0:3]
    v_mfma_f32_16x16x32_bf16 a[4:7], a[168:171], v[100:103], a[4:7]
    v_mfma_f32_16x16x32_bf16 a[8:11], a[184:187], v[100:103], a[8:11]
    v_mfma_f32_16x16x32_bf16 a[0:3], a[156:159], v[116:119], a[0:3]
    v_mfma_f32_16x16x32_bf16 a[4:7], a[172:175], v[116:119], a[4:7]
    v_mfma_f32_16x16x32_bf16 a[8:11], a[188:191], v[116:119], a[8:11]
    buffer_load_dwordx4 v225, s[24:27], s58 offen offset:1024 nt lds
    v_mfma_f32_16x16x32_bf16 v[84:87], a[48:51], a[48:51], 0
    v_mfma_f32_16x16x32_bf16 v[80:83], a[48:51], v[52:55], 0
    v_mfma_f32_16x16x32_bf16 v[84:87], a[52:55], a[52:55], v[84:87]
    v_mfma_f32_16x16x32_bf16 v[80:83], a[52:55], v[52:55], v[80:83]
    v_mfma_f32_16x16x32_bf16 v[84:87], a[56:59], a[56:59], v[84:87]
    v_mfma_f32_16x16x32_bf16 v[80:83], a[56:59], v[52:55], v[80:83]
    s_waitcnt lgkmcnt(14)
    v_mfma_f32_16x16x32_bf16 v[84:87], a[60:63], a[60:63], v[84:87]
    v_mfma_f32_16x16x32_bf16 v[80:83], a[60:63], v[52:55], v[80:83]
    s_waitcnt lgkmcnt(13)
    v_mfma_f32_16x16x32_bf16 v[84:87], a[64:67], a[64:67], v[84:87]
    v_mfma_f32_16x16x32_bf16 v[80:83], a[64:67], v[52:55], v[80:83]
    s_waitcnt lgkmcnt(12)
    v_mfma_f32_16x16x32_bf16 v[84:87], a[68:71], a[68:71], v[84:87]
    v_mfma_f32_16x16x32_bf16 v[80:83], a[68:71], v[52:55], v[80:83]
    s_waitcnt lgkmcnt(0)
    v_mfma_f32_16x16x32_bf16 v[76:79], a[48:51], v[136:139], 0
    v_mfma_f32_16x16x32_bf16 v[76:79], a[52:55], v[140:143], v[76:79]
    s_add_u32 m0, s41, 10240
    s_add_u32 s58, s37, 75498112
    buffer_load_dwordx4 v224, s[24:27], s58 offen offset:0 nt lds
    v_mfma_f32_16x16x32_bf16 v[76:79], a[56:59], v[144:147], v[76:79]
    buffer_load_dwordx4 v[204:207], v65, s[72:75], s61 offen offset:3072 sc1
    v_mfma_f32_16x16x32_bf16 v[76:79], a[60:63], v[148:151], v[76:79]
    v_mfma_f32_16x16x32_bf16 v[76:79], a[64:67], v[152:155], v[76:79]
    v_mfma_f32_16x16x32_bf16 v[76:79], a[68:71], v[156:159], v[76:79]
    s_mul_i32 s28, s3, 262144
    s_and_b32 s56, s2, 7
    s_lshl_b32 s56, s56, 10
    s_add_u32 s28, s28, s56
    s_bfe_u32 s56, s2, 0x30003
    s_lshl_b32 s56, s56, 7
    s_add_u32 s28, s28, s56
    s_lshr_b32 s56, s2, 6
    s_lshl_b32 s56, s56, 14
    s_add_u32 s28, s28, s56
    s_add_u32 s28, s28, 8388608
    v_lshrrev_b32 v1, 3, v0
    s_xor_b32 s56, s1, s3
    v_xor_b32 v1, s56, v1
    v_and_b32 v1, 1, v1
    v_lshl_or_b32 v242, v1, 13, v242
    s_sub_u32 s29, s2, 64
    s_lshr_b32 s29, s29, 4
    s_and_b32 s56, s2, 7
    s_lshl3_add_u32 s29, s29, s56
    s_mul_i32 s30, s29, 65536
    s_lshl_b32 s56, s3, 14
    s_add_u32 s30, s30, s56
    s_add_u32 s30, s30, 8388608
    s_lshr_b32 s56, s29, 5
    s_xor_b32 s56, s56, s1
    s_lshr_b32 s57, s29, 2
    s_xor_b32 s56, s56, s57
    s_and_b32 s56, s56, 1
    s_lshl_b32 s56, s56, 13
    s_add_u32 s30, s30, s56
    s_add_u32 s31, s30, 4096
    v_mov_b32 v28, v242
    v_bfe_u32 v1, v0, 4, 1
    v_mul_u32_u24 v2, 65536, v1
    v_mul_u32_u24 v1, 0x10, v1
    v_xor_b32 v242, v242, v1
    v_sub_u32 v242, v242, v2
    v_add_u32 v243, 65536, v242
    s_bfe_u32 s56, s2, 0x10003
    s_lshl_b32 s56, s56, 6
    v_lshrrev_b32 v1, 2, v0
    v_and_b32 v2, 48, v65
    v_lshl_add_u32 v1, v1, 7, v2
    v_add_u32 v29, s56, v1
    v_mov_b32 v232, 0x53800000
    s_mov_b32 s43, 1
    s_mov_b32 s68, s18
    s_mov_b32 s69, s19
    s_mov_b32 s70, 6144
    s_mov_b32 s71, 0x20000
L_tail:
    v_and_b32 v1, 15, v0
    v_lshlrev_b32 v1, 8, v1
    v_sub_u32 v1, v34, v1
    v_lshrrev_b32 v2, 2, v0
    v_lshlrev_b32 v2, 8, v2
    s_sub_u32 s56, s41, s40
    v_add_u32 v40, s56, v1
    v_xor_b32 v41, 64, v40
    s_sub_u32 s56, s42, s40
    v_add_u32 v42, s56, v1
    v_xor_b32 v43, 64, v42
    s_mul_i32 s56, s3, 3
    s_add_u32 s57, s56, 0
    s_lshr_b32 s57, s57, 2
    s_mul_i32 s57, s57, 1920
    s_add_u32 s57, s57, 24576
    v_sub_u32 v44, v36, v2
    v_add_u32 v44, s57, v44
    v_add_u32 v47, 49152, v44
    s_add_u32 s57, s56, 1
    s_lshr_b32 s57, s57, 2
    s_mul_i32 s57, s57, 1920
    s_add_u32 s57, s57, 24576
    v_sub_u32 v45, v37, v2
    v_add_u32 v45, s57, v45
    v_add_u32 v48, 49152, v45
    s_add_u32 s57, s56, 2
    s_lshr_b32 s57, s57, 2
    s_mul_i32 s57, s57, 1920
    s_add_u32 s57, s57, 24576
    v_sub_u32 v46, v38, v2
    v_add_u32 v46, s57, v46
    v_add_u32 v49, 49152, v46
    v_accvgpr_read_b32 v16, a0
    v_accvgpr_read_b32 v17, a1
    v_accvgpr_read_b32 v18, a2
    v_accvgpr_read_b32 v19, a3
    v_accvgpr_read_b32 v20, a4
    v_accvgpr_read_b32 v21, a5
    v_accvgpr_read_b32 v22, a6
    v_accvgpr_read_b32 v23, a7
    v_accvgpr_read_b32 v24, a8
    v_accvgpr_read_b32 v25, a9
    v_accvgpr_read_b32 v26, a10
    v_accvgpr_read_b32 v27, a11
    buffer_load_dwordx4 v225, s[24:27], s58 offen offset:1024 nt lds
    s_add_u32 m0, s42, 0
    s_add_u32 s59, s37, 75694080
    buffer_load_dwordx4 v224, s[24:27], s59 offen offset:0 nt lds
    buffer_load_dwordx4 v225, s[24:27], s59 offen offset:1024 nt lds
    s_waitcnt vmcnt(12)
    s_barrier
    ds_read_b128 a[96:99], v40 offset:0
    ds_read_b128 a[100:103], v41 offset:0
    ds_read_b128 a[104:107], v40 offset:2048
    ds_read_b128 a[108:111], v41 offset:2048
    ds_read_b128 a[112:115], v40 offset:4096
    ds_read_b128 a[116:119], v41 offset:4096
    s_waitcnt lgkmcnt(5)
    v_mfma_f32_16x16x32_bf16 v[96:99], a[96:99], a[96:99], v[84:87]
    s_add_u32 m0, s42, 2048
    s_add_u32 s59, s37, 75694208
    buffer_load_dwordx4 v224, s[24:27], s59 offen offset:0 nt lds
    ds_read_b64_tr_b16 a[144:145], v44 offset:0
    ds_read_b64_tr_b16 a[148:149], v44 offset:12288
    v_mfma_f32_16x16x32_bf16 v[100:103], a[96:99], a[48:51], 0
    buffer_load_dwordx4 v225, s[24:27], s59 offen offset:1024 nt lds
    ds_read_b64_tr_b16 a[152:153], v44 offset:24576
    ds_read_b64_tr_b16 a[156:157], v44 offset:36864
    s_waitcnt lgkmcnt(8)
    v_mfma_f32_16x16x32_bf16 v[96:99], a[100:103], a[100:103], v[96:99]
    ds_read_b64_tr_b16 a[160:161], v45 offset:0
    ds_read_b64_tr_b16 a[164:165], v45 offset:12288
    v_mfma_f32_16x16x32_bf16 v[100:103], a[100:103], a[52:55], v[100:103]
    ds_read_b64_tr_b16 a[168:169], v45 offset:24576
    ds_read_b64_tr_b16 a[172:173], v45 offset:36864
    s_waitcnt lgkmcnt(11)
    v_mfma_f32_16x16x32_bf16 v[96:99], a[104:107], a[104:107], v[96:99]
    ds_read_b64_tr_b16 a[176:177], v46 offset:0
    ds_read_b64_tr_b16 a[180:181], v46 offset:12288
    v_mfma_f32_16x16x32_bf16 v[100:103], a[104:107], a[56:59], v[100:103]
    ds_read_b64_tr_b16 a[184:185], v46 offset:24576
    ds_read_b64_tr_b16 a[188:189], v46 offset:36864
    s_waitcnt lgkmcnt(14)
    v_mfma_f32_16x16x32_bf16 v[96:99], a[108:111], a[108:111], v[96:99]
    s_add_u32 m0, s42, 4096
    s_add_u32 s59, s37, 75694336
    buffer_load_dwordx4 v224, s[24:27], s59 offen offset:0 nt lds
    v_mfma_f32_16x16x32_bf16 v[100:103], a[108:111], a[60:63], v[100:103]
    s_waitcnt lgkmcnt(13)
    v_mfma_f32_16x16x32_bf16 v[96:99], a[112:115], a[112:115], v[96:99]
    v_mfma_f32_16x16x32_bf16 v[100:103], a[112:115], a[64:67], v[100:103]
    s_waitcnt lgkmcnt(12)
    v_mfma_f32_16x16x32_bf16 v[96:99], a[116:119], a[116:119], v[96:99]
    v_mfma_f32_16x16x32_bf16 v[100:103], a[116:119], a[68:71], v[100:103]
    v_mfma_f32_16x16x32_bf16 v[92:95], a[96:99], v[52:55], v[80:83]
    v_mfma_f32_16x16x32_bf16 v[92:95], a[100:103], v[52:55], v[92:95]
    v_mfma_f32_16x16x32_bf16 v[92:95], a[104:107], v[52:55], v[92:95]
    v_mfma_f32_16x16x32_bf16 v[92:95], a[108:111], v[52:55], v[92:95]
    s_nop 3
    v_fma_f32 v96, v100, 2.0, v96
    v_fma_f32 v97, v101, 2.0, v97
    v_mfma_f32_16x16x32_bf16 v[92:95], a[112:115], v[52:55], v[92:95]
    v_fma_f32 v98, v102, 2.0, v98
    v_fma_f32 v99, v103, 2.0, v99
    v_mfma_f32_16x16x32_bf16 v[92:95], a[116:119], v[52:55], v[92:95]
    v_cndmask_b32 v3, 0, v96, s[44:45]
    v_cndmask_b32 v3, v3, v97, s[46:47]
    v_mfma_f32_16x16x32_bf16 v[88:91], a[96:99], v[136:139], v[76:79]
    v_cndmask_b32 v3, v3, v98, s[48:49]
    v_cndmask_b32 v3, v3, v99, s[50:51]
    v_mfma_f32_16x16x32_bf16 v[88:91], a[100:103], v[140:143], v[88:91]
    buffer_load_dwordx4 v225, s[24:27], s59 offen offset:1024 nt lds
    s_nop 0
    s_nop 0
    v_mfma_f32_16x16x32_bf16 v[88:91], a[104:107], v[144:147], v[88:91]
    s_add_u32 m0, s42, 6144
    s_add_u32 s59, s37, 75694464
    buffer_load_dwordx4 v224, s[24:27], s59 offen offset:0 nt lds
    v_mfma_f32_16x16x4_f32 v[120:123], v3, v60, v[56:59]
    v_mfma_f32_16x16x32_bf16 v[88:91], a[108:111], v[148:151], v[88:91]
    v_mfma_f32_16x16x32_bf16 v[88:91], a[112:115], v[152:155], v[88:91]
    v_mfma_f32_16x16x32_bf16 v[88:91], a[116:119], v[156:159], v[88:91]
    s_nop 6
    v_fma_f32 v128, -v92, v92, v120
    v_fma_f32 v129, -v93, v93, v121
    v_fma_f32 v130, -v94, v94, v122
    v_fma_f32 v131, -v95, v95, v123
    v_max_f32 v128, v128, v56
    v_max_f32 v129, v129, v56
    v_max_f32 v130, v130, v56
    v_max_f32 v131, v131, v56
    v_rsq_f32 v128, v128
    v_rsq_f32 v129, v129
    v_rsq_f32 v130, v130
    v_rsq_f32 v131, v131
    v_fma_f32 v88, -v92, v61, v88
    v_fma_f32 v89, -v93, v61, v89
    v_fma_f32 v90, -v94, v61, v90
    v_fma_f32 v91, -v95, v61, v91
    v_fma_f32 v88, v88, v128, v62
    v_fma_f32 v89, v89, v129, v62
    buffer_load_dwordx4 v225, s[24:27], s59 offen offset:1024 nt lds
    v_fma_f32 v90, v90, v130, v62
    v_fma_f32 v91, v91, v131, v62
    v_max3_f32 v1, v88, v89, v90
    v_max_f32 v1, v1, v91
    v_cmp_lt_f32 vcc, s52, v1
    s_cbranch_vccnz L_site10
L_back10:
    v_exp_f32 v96, v88
    v_exp_f32 v97, v89
    v_exp_f32 v98, v90
    v_exp_f32 v99, v91
    v_mul_f32 v88, v96, v128
    v_mul_f32 v89, v97, v129
    v_mul_f32 v90, v98, v130
    v_mul_f32 v91, v99, v131
    v_add_f32 v63, v63, v96
    v_fmac_f32 v64, v88, v92
    v_add_f32 v63, v63, v97
    v_fmac_f32 v64, v89, v93
    v_add_f32 v63, v63, v98
    v_fmac_f32 v64, v90, v94
    v_add_f32 v63, v63, v99
    v_fmac_f32 v64, v91, v95
    v_mov_b32 v68, v88
    v_mov_b32 v69, v89
    v_mov_b32 v70, v90
    v_mov_b32 v71, v91
    s_waitcnt vmcnt(14)
    ds_read_b128 a[120:123], v40 offset:6144
    ds_read_b128 a[124:127], v41 offset:6144
    s_waitcnt lgkmcnt(1)
    v_mfma_f32_16x16x32_bf16 v[112:115], a[120:123], a[120:123], v[84:87]
    s_add_u32 m0, s42, 8192
    s_add_u32 s59, s37, 75694592
    buffer_load_dwordx4 v224, s[24:27], s59 offen offset:0 nt lds
    v_mfma_f32_16x16x32_bf16 v[116:119], a[120:123], a[48:51], 0
    buffer_load_dwordx4 v225, s[24:27], s59 offen offset:1024 nt lds
    s_waitcnt lgkmcnt(0)
    v_mfma_f32_16x16x32_bf16 v[112:115], a[124:127], a[124:127], v[112:115]
    v_mfma_f32_16x16x32_bf16 v[116:119], a[124:127], a[52:55], v[116:119]
    v_mfma_f32_16x16x32_bf16 v[108:111], a[120:123], v[52:55], v[80:83]
    v_mfma_f32_16x16x32_bf16 v[104:107], a[120:123], v[136:139], v[76:79]
    s_waitcnt vmcnt(13)
    ds_read_b128 a[128:131], v40 offset:8192
    ds_read_b128 a[132:135], v41 offset:8192
    v_mfma_f32_16x16x32_bf16 v[108:111], a[124:127], v[52:55], v[108:111]
    v_mfma_f32_16x16x32_bf16 v[104:107], a[124:127], v[140:143], v[104:107]
    s_waitcnt lgkmcnt(1)
    v_mfma_f32_16x16x32_bf16 v[112:115], a[128:131], a[128:131], v[112:115]
    v_mfma_f32_16x16x32_bf16 v[116:119], a[128:131], a[56:59], v[116:119]
    s_waitcnt lgkmcnt(0)
    v_mfma_f32_16x16x32_bf16 v[112:115], a[132:135], a[132:135], v[112:115]
    v_mfma_f32_16x16x32_bf16 v[116:119], a[132:135], a[60:63], v[116:119]
    v_mfma_f32_16x16x32_bf16 v[108:111], a[128:131], v[52:55], v[108:111]
    s_add_u32 m0, s42, 10240
    s_add_u32 s59, s37, 75694720
    buffer_load_dwordx4 v224, s[24:27], s59 offen offset:0 nt lds
    v_mfma_f32_16x16x32_bf16 v[104:107], a[128:131], v[144:147], v[104:107]
    buffer_load_dwordx4 v225, s[24:27], s59 offen offset:1024 nt lds
    s_waitcnt vmcnt(12)
    ds_read_b128 a[136:139], v40 offset:10240
    ds_read_b128 a[140:143], v41 offset:10240
    s_barrier
    s_add_u32 s61, s60, 3158016
    buffer_load_dwordx4 v[208:211], v65, s[32:35], s61 offen offset:0 sc1
    v_mfma_f32_16x16x32_bf16 v[108:111], a[132:135], v[52:55], v[108:111]
    ds_read_b64_tr_b16 a[146:147], v44 offset:6144
    v_mfma_f32_16x16x32_bf16 v[104:107], a[132:135], v[148:151], v[104:107]
    ds_read_b64_tr_b16 a[150:151], v44 offset:18432
    s_waitcnt lgkmcnt(3)
    v_mfma_f32_16x16x32_bf16 v[112:115], a[136:139], a[136:139], v[112:115]
    ds_read_b64_tr_b16 a[154:155], v44 offset:30720
    v_mfma_f32_16x16x32_bf16 v[116:119], a[136:139], a[64:67], v[116:119]
    ds_read_b64_tr_b16 a[158:159], v44 offset:43008
    s_waitcnt lgkmcnt(4)
    v_mfma_f32_16x16x32_bf16 v[112:115], a[140:143], a[140:143], v[112:115]
    ds_read_b64_tr_b16 a[162:163], v45 offset:6144
    v_mfma_f32_16x16x32_bf16 v[116:119], a[140:143], a[68:71], v[116:119]
    ds_read_b64_tr_b16 a[166:167], v45 offset:18432
    v_mfma_f32_16x16x32_bf16 v[108:111], a[136:139], v[52:55], v[108:111]
    ds_read_b64_tr_b16 a[170:171], v45 offset:30720
    v_mfma_f32_16x16x32_bf16 v[108:111], a[140:143], v[52:55], v[108:111]
    ds_read_b64_tr_b16 a[174:175], v45 offset:43008
    s_nop 2
    v_fma_f32 v112, v116, 2.0, v112
    v_fma_f32 v113, v117, 2.0, v113
    v_fma_f32 v114, v118, 2.0, v114
    v_fma_f32 v115, v119, 2.0, v115
    v_cndmask_b32 v4, 0, v112, s[44:45]
    v_cndmask_b32 v4, v4, v113, s[46:47]
    v_cndmask_b32 v4, v4, v114, s[48:49]
    v_cndmask_b32 v4, v4, v115, s[50:51]
    ds_read_b64_tr_b16 a[178:179], v46 offset:6144
    ds_read_b64_tr_b16 a[182:183], v46 offset:18432
    v_mfma_f32_16x16x4_f32 v[124:127], v4, v60, v[56:59]
    ds_read_b64_tr_b16 a[186:187], v46 offset:30720
    ds_read_b64_tr_b16 a[190:191], v46 offset:43008
    buffer_load_dwordx4 v[212:215], v65, s[32:35], s61 offen offset:1024 sc1
    s_nop 5
    v_mfma_f32_16x16x32_bf16 v[104:107], a[136:139], v[152:155], v[104:107]
    v_fma_f32 v132, -v108, v108, v124
    v_fma_f32 v133, -v109, v109, v125
    v_mfma_f32_16x16x32_bf16 v[104:107], a[140:143], v[156:159], v[104:107]
    v_fma_f32 v134, -v110, v110, v126
    v_fma_f32 v135, -v111, v111, v127
    v_max_f32 v132, v132, v56
    v_max_f32 v133, v133, v56
    v_max_f32 v134, v134, v56
    v_max_f32 v135, v135, v56
    v_rsq_f32 v132, v132
    v_rsq_f32 v133, v133
    v_rsq_f32 v134, v134
    v_rsq_f32 v135, v135
    v_pk_fma_f32 v[104:105], v[108:109], v[60:61], v[104:105] op_sel:[0,1,0] neg_lo:[1,0,0] neg_hi:[1,0,0]
    v_pk_fma_f32 v[106:107], v[110:111], v[60:61], v[106:107] op_sel:[0,1,0] neg_lo:[1,0,0] neg_hi:[1,0,0]
    v_pk_fma_f32 v[104:105], v[104:105], v[132:133], v[62:63] op_sel_hi:[1,1,0]
    v_pk_fma_f32 v[106:107], v[106:107], v[134:135], v[62:63] op_sel_hi:[1,1,0]
L_back11:
    v_max3_f32 v1, v104, v105, v106
    v_max_f32 v1, v1, v107
    v_cmp_lt_f32 vcc, s52, v1
    v_exp_f32 v112, v104
    v_exp_f32 v113, v105
    v_exp_f32 v114, v106
    v_exp_f32 v115, v107
    s_cbranch_vccnz L_site11
    v_cvt_pk_bf16_f32 v72, v88, v89
    v_cvt_pk_bf16_f32 v73, v90, v91
    v_pk_mul_f32 v[104:105], v[112:113], v[132:133]
    v_pk_mul_f32 v[106:107], v[114:115], v[134:135]
    v_cvt_pk_bf16_f32 v74, v104, v105
    v_cvt_pk_bf16_f32 v75, v106, v107
    ds_write_b128 v237, v[72:75] offset:12288
    s_waitcnt lgkmcnt(0)
    s_barrier
    ds_read_b32 v9, v254 offset:4100
    ds_read_b128 a[192:195], v253 offset:12288
    ds_read_b128 a[196:199], v253 offset:13312
    ds_read_b128 a[200:203], v253 offset:14336
    ds_read_b128 a[204:207], v253 offset:15360
    buffer_load_dwordx4 v[216:219], v65, s[32:35], s61 offen offset:2048 sc1
    s_waitcnt lgkmcnt(4)
    v_cmp_ne_u32 vcc, 0, v9
    s_cbranch_vccnz L_xt11
L_post11:
    s_waitcnt lgkmcnt(3)
    v_mfma_f32_16x16x32_bf16 v[16:19], a[144:147], a[192:195], v[16:19]
    v_add_f32 v68, v68, v104
    v_add_f32 v69, v69, v105
    v_mfma_f32_16x16x32_bf16 v[20:23], a[160:163], a[192:195], v[20:23]
    v_add_f32 v70, v70, v106
    v_add_f32 v71, v71, v107
    v_mfma_f32_16x16x32_bf16 v[24:27], a[176:179], a[192:195], v[24:27]
    v_add_f32 v63, v63, v112
    v_fma_f32 v64, v104, v108, v64
    s_waitcnt lgkmcnt(2)
    v_mfma_f32_16x16x32_bf16 v[16:19], a[148:151], a[196:199], v[16:19]
    s_waitcnt vmcnt(13)
    ds_read_b128 a[96:99], v42 offset:0
    ds_read_b128 a[100:103], v43 offset:0
    v_mfma_f32_16x16x32_bf16 v[20:23], a[164:167], a[196:199], v[20:23]
    v_add_f32 v63, v63, v113
    v_fma_f32 v64, v105, v109, v64
    v_mfma_f32_16x16x32_bf16 v[24:27], a[180:183], a[196:199], v[24:27]
    v_add_f32 v63, v63, v114
    v_fma_f32 v64, v106, v110, v64
    s_waitcnt lgkmcnt(3)
    v_mfma_f32_16x16x32_bf16 v[16:19], a[152:155], a[200:203], v[16:19]
    v_add_f32 v63, v63, v115
    v_fma_f32 v64, v107, v111, v64
    v_mfma_f32_16x16x32_bf16 v[20:23], a[168:171], a[200:203], v[20:23]
    s_waitcnt vmcnt(11)
    ds_read_b128 a[104:107], v42 offset:2048
    ds_read_b128 a[108:111], v43 offset:2048
    v_mfma_f32_16x16x32_bf16 v[24:27], a[184:187], a[200:203], v[24:27]
    s_waitcnt lgkmcnt(4)
    v_mfma_f32_16x16x32_bf16 v[16:19], a[156:159], a[204:207], v[16:19]
    v_mfma_f32_16x16x32_bf16 v[20:23], a[172:175], a[204:207], v[20:23]
    v_mfma_f32_16x16x32_bf16 v[24:27], a[188:191], a[204:207], v[24:27]
    s_waitcnt lgkmcnt(3)
    v_mfma_f32_16x16x32_bf16 v[96:99], a[96:99], a[96:99], v[84:87]
    v_mfma_f32_16x16x32_bf16 v[100:103], a[96:99], a[48:51], 0
    s_waitcnt lgkmcnt(2)
    v_mfma_f32_16x16x32_bf16 v[96:99], a[100:103], a[100:103], v[96:99]
    v_mfma_f32_16x16x32_bf16 v[100:103], a[100:103], a[52:55], v[100:103]
    s_waitcnt vmcnt(9)
    ds_read_b128 a[112:115], v42 offset:4096
    ds_read_b128 a[116:119], v43 offset:4096
    s_barrier
    v_mfma_f32_16x16x32_bf16 v[92:95], a[96:99], v[52:55], v[80:83]
    buffer_load_dwordx4 v[220:223], v65, s[32:35], s61 offen offset:3072 sc1
    ds_read_b64_tr_b16 a[0:1], v47 offset:0
    v_mfma_f32_16x16x32_bf16 v[88:91], a[96:99], v[136:139], v[76:79]
    ds_read_b64_tr_b16 a[4:5], v47 offset:12288
    v_mfma_f32_16x16x32_bf16 v[92:95], a[100:103], v[52:55], v[92:95]
    ds_read_b64_tr_b16 a[8:9], v47 offset:24576
    v_mfma_f32_16x16x32_bf16 v[88:91], a[100:103], v[140:143], v[88:91]
    ds_read_b64_tr_b16 a[12:13], v47 offset:36864
    s_waitcnt lgkmcnt(7)
    v_mfma_f32_16x16x32_bf16 v[96:99], a[104:107], a[104:107], v[96:99]
    ds_read_b64_tr_b16 a[16:17], v48 offset:0
    v_mfma_f32_16x16x32_bf16 v[100:103], a[104:107], a[56:59], v[100:103]
    ds_read_b64_tr_b16 a[20:21], v48 offset:12288
    s_waitcnt lgkmcnt(8)
    v_mfma_f32_16x16x32_bf16 v[96:99], a[108:111], a[108:111], v[96:99]
    ds_read_b64_tr_b16 a[24:25], v48 offset:24576
    v_mfma_f32_16x16x32_bf16 v[100:103], a[108:111], a[60:63], v[100:103]
    ds_read_b64_tr_b16 a[28:29], v48 offset:36864
    v_mfma_f32_16x16x32_bf16 v[92:95], a[104:107], v[52:55], v[92:95]
    ds_read_b64_tr_b16 a[32:33], v49 offset:0
    v_mfma_f32_16x16x32_bf16 v[88:91], a[104:107], v[144:147], v[88:91]
    ds_read_b64_tr_b16 a[36:37], v49 offset:12288
    v_mfma_f32_16x16x32_bf16 v[92:95], a[108:111], v[52:55], v[92:95]
    ds_read_b64_tr_b16 a[40:41], v49 offset:24576
    v_mfma_f32_16x16x32_bf16 v[88:91], a[108:111], v[148:151], v[88:91]
    ds_read_b64_tr_b16 a[44:45], v49 offset:36864
    s_waitcnt lgkmcnt(13)
    v_mfma_f32_16x16x32_bf16 v[96:99], a[112:115], a[112:115], v[96:99]
    v_mfma_f32_16x16x32_bf16 v[100:103], a[112:115], a[64:67], v[100:103]
    s_waitcnt lgkmcnt(12)
    v_mfma_f32_16x16x32_bf16 v[96:99], a[116:119], a[116:119], v[96:99]
    v_mfma_f32_16x16x32_bf16 v[100:103], a[116:119], a[68:71], v[100:103]
    s_waitcnt vmcnt(8)
    ds_read_b128 a[120:123], v42 offset:6144
    ds_read_b128 a[124:127], v43 offset:6144
    v_mfma_f32_16x16x32_bf16 v[92:95], a[112:115], v[52:55], v[92:95]
    v_mfma_f32_16x16x32_bf16 v[92:95], a[116:119], v[52:55], v[92:95]
    s_nop 2
    v_fma_f32 v96, v100, 2.0, v96
    v_fma_f32 v97, v101, 2.0, v97
    v_mfma_f32_16x16x32_bf16 v[88:91], a[112:115], v[152:155], v[88:91]
    v_fma_f32 v98, v102, 2.0, v98
    v_fma_f32 v99, v103, 2.0, v99
    v_mfma_f32_16x16x32_bf16 v[88:91], a[116:119], v[156:159], v[88:91]
    v_cndmask_b32 v3, 0, v96, s[44:45]
    v_cndmask_b32 v3, v3, v97, s[46:47]
    v_cndmask_b32 v3, v3, v98, s[48:49]
    v_cndmask_b32 v3, v3, v99, s[50:51]
    s_nop 0
    s_nop 0
    v_mfma_f32_16x16x4_f32 v[120:123], v3, v60, v[56:59]
    s_waitcnt lgkmcnt(1)
    v_mfma_f32_16x16x32_bf16 v[112:115], a[120:123], a[120:123], v[84:87]
    v_mfma_f32_16x16x32_bf16 v[116:119], a[120:123], a[48:51], 0
    s_waitcnt vmcnt(6)
    ds_read_b128 a[128:131], v42 offset:8192
    ds_read_b128 a[132:135], v43 offset:8192
    s_add_u32 s61, s60, 3162112
    buffer_load_dwordx4 v[224:227], v65, s[32:35], s61 offen offset:0 sc1
    s_waitcnt lgkmcnt(2)
    v_mfma_f32_16x16x32_bf16 v[112:115], a[124:127], a[124:127], v[112:115]
    v_fma_f32 v128, -v92, v92, v120
    v_fma_f32 v129, -v93, v93, v121
    v_fma_f32 v130, -v94, v94, v122
    v_mfma_f32_16x16x32_bf16 v[116:119], a[124:127], a[52:55], v[116:119]
    v_fma_f32 v131, -v95, v95, v123
    v_max_f32 v128, v128, v56
    v_max_f32 v129, v129, v56
    v_mfma_f32_16x16x32_bf16 v[108:111], a[120:123], v[52:55], v[80:83]
    v_max_f32 v130, v130, v56
    v_max_f32 v131, v131, v56
    v_mfma_f32_16x16x32_bf16 v[104:107], a[120:123], v[136:139], v[76:79]
    v_rsq_f32 v128, v128
    v_mfma_f32_16x16x32_bf16 v[108:111], a[124:127], v[52:55], v[108:111]
    v_rsq_f32 v129, v129
    v_mfma_f32_16x16x32_bf16 v[104:107], a[124:127], v[140:143], v[104:107]
    v_rsq_f32 v130, v130
    s_waitcnt lgkmcnt(1)
    v_mfma_f32_16x16x32_bf16 v[112:115], a[128:131], a[128:131], v[112:115]
    v_rsq_f32 v131, v131
    v_fma_f32 v88, -v92, v61, v88
    v_mfma_f32_16x16x32_bf16 v[116:119], a[128:131], a[56:59], v[116:119]
    v_fma_f32 v89, -v93, v61, v89
    v_fma_f32 v90, -v94, v61, v90
    v_fma_f32 v91, -v95, v61, v91
    s_waitcnt lgkmcnt(0)
    v_mfma_f32_16x16x32_bf16 v[112:115], a[132:135], a[132:135], v[112:115]
    v_fma_f32 v88, v88, v128, v62
    v_fma_f32 v89, v89, v129, v62
    v_fma_f32 v90, v90, v130, v62
    v_mfma_f32_16x16x32_bf16 v[116:119], a[132:135], a[60:63], v[116:119]
    v_fma_f32 v91, v91, v131, v62
    v_max3_f32 v1, v88, v89, v90
    v_max_f32 v1, v1, v91
    v_mfma_f32_16x16x32_bf16 v[108:111], a[128:131], v[52:55], v[108:111]
    v_cmp_lt_f32 vcc, s52, v1
    s_cbranch_vccnz L_site12
L_back12:
    v_mfma_f32_16x16x32_bf16 v[104:107], a[128:131], v[144:147], v[104:107]
    s_waitcnt vmcnt(5)
    ds_read_b128 a[136:139], v42 offset:10240
    ds_read_b128 a[140:143], v43 offset:10240
    s_barrier
    buffer_load_dwordx4 v[228:231], v65, s[32:35], s61 offen offset:1024 sc1
    s_cmp_eq_u32 s0, 1
    s_cbranch_scc0 L_nolate
    s_add_u32 s56, s60, 3145728
    buffer_load_dwordx4 v[160:163], v65, s[32:35], s56 offen offset:0 sc1
    buffer_load_dwordx4 v[164:167], v65, s[32:35], s56 offen offset:1024 sc1
    buffer_load_dwordx4 v[168:171], v65, s[32:35], s56 offen offset:2048 sc1
    buffer_load_dwordx4 v[172:175], v65, s[32:35], s56 offen offset:3072 sc1
    s_add_u32 s56, s60, 3149824
    buffer_load_dwordx4 v[176:179], v65, s[32:35], s56 offen offset:0 sc1
    buffer_load_dwordx4 v[180:183], v65, s[32:35], s56 offen offset:1024 sc1
    buffer_load_dwordx4 v[184:187], v65, s[32:35], s56 offen offset:2048 sc1
    buffer_load_dwordx4 v[188:191], v65, s[32:35], s56 offen offset:3072 sc1
    s_add_u32 s56, s60, 3153920
    buffer_load_dwordx4 v[192:195], v65, s[32:35], s56 offen offset:0 sc1
    buffer_load_dwordx4 v[196:199], v65, s[32:35], s56 offen offset:1024 sc1
    buffer_load_dwordx4 v[200:203], v65, s[32:35], s56 offen offset:2048 sc1
    buffer_load_dwordx4 v[204:207], v65, s[32:35], s56 offen offset:3072 sc1
L_nolate:
    buffer_load_dword v244, v28, s[32:35], s28 offen
    v_mfma_f32_16x16x32_bf16 v[108:111], a[132:135], v[52:55], v[108:111]
    ds_read_b64_tr_b16 a[2:3], v47 offset:6144
    v_exp_f32 v96, v88
    v_mfma_f32_16x16x32_bf16 v[104:107], a[132:135], v[148:151], v[104:107]
    ds_read_b64_tr_b16 a[6:7], v47 offset:18432
    v_exp_f32 v97, v89
    s_waitcnt lgkmcnt(3)
    v_mfma_f32_16x16x32_bf16 v[112:115], a[136:139], a[136:139], v[112:115]
    ds_read_b64_tr_b16 a[10:11], v47 offset:30720
    v_exp_f32 v98, v90
    v_mfma_f32_16x16x32_bf16 v[116:119], a[136:139], a[64:67], v[116:119]
    ds_read_b64_tr_b16 a[14:15], v47 offset:43008
    v_exp_f32 v99, v91
    s_waitcnt lgkmcnt(4)
    v_mfma_f32_16x16x32_bf16 v[112:115], a[140:143], a[140:143], v[112:115]
    ds_read_b64_tr_b16 a[18:19], v48 offset:6144
    v_mul_f32 v88, v96, v128
    v_mul_f32 v89, v97, v129
    v_mfma_f32_16x16x32_bf16 v[116:119], a[140:143], a[68:71], v[116:119]
    ds_read_b64_tr_b16 a[22:23], v48 offset:18432
    v_mul_f32 v90, v98, v130
    v_mul_f32 v91, v99, v131
    v_mfma_f32_16x16x32_bf16 v[108:111], a[136:139], v[52:55], v[108:111]
    ds_read_b64_tr_b16 a[26:27], v48 offset:30720
    v_add_f32 v63, v63, v96
    v_fmac_f32 v64, v88, v92
    v_mfma_f32_16x16x32_bf16 v[108:111], a[140:143], v[52:55], v[108:111]
    ds_read_b64_tr_b16 a[30:31], v48 offset:43008
    v_add_f32 v63, v63, v97
    v_fmac_f32 v64, v89, v93
    v_add_f32 v63, v63, v98
    v_fma_f32 v112, v116, 2.0, v112
    v_fma_f32 v113, v117, 2.0, v113
    v_fma_f32 v114, v118, 2.0, v114
    v_fma_f32 v115, v119, 2.0, v115
    v_cndmask_b32 v4, 0, v112, s[44:45]
    v_cndmask_b32 v4, v4, v113, s[46:47]
    v_cndmask_b32 v4, v4, v114, s[48:49]
    v_cndmask_b32 v4, v4, v115, s[50:51]
    ds_read_b64_tr_b16 a[34:35], v49 offset:6144
    ds_read_b64_tr_b16 a[38:39], v49 offset:18432
    v_mfma_f32_16x16x4_f32 v[124:127], v4, v60, v[56:59]
    ds_read_b64_tr_b16 a[42:43], v49 offset:30720
    ds_read_b64_tr_b16 a[46:47], v49 offset:43008
    v_fmac_f32 v64, v90, v94
    v_add_f32 v63, v63, v99
    v_fmac_f32 v64, v91, v95
    v_add_f32 v68, v68, v88
    v_add_f32 v69, v69, v89
    v_add_f32 v70, v70, v90
    v_add_f32 v71, v71, v91
    v_mfma_f32_16x16x32_bf16 v[104:107], a[136:139], v[152:155], v[104:107]
    v_cvt_pk_bf16_f32 v72, v88, v89
    v_cvt_pk_bf16_f32 v73, v90, v91
    v_mfma_f32_16x16x32_bf16 v[104:107], a[140:143], v[156:159], v[104:107]
    v_fma_f32 v132, -v108, v108, v124
    v_fma_f32 v133, -v109, v109, v125
    v_fma_f32 v134, -v110, v110, v126
    v_fma_f32 v135, -v111, v111, v127
    v_max_f32 v132, v132, v56
    v_max_f32 v133, v133, v56
    v_max_f32 v134, v134, v56
    v_max_f32 v135, v135, v56
    v_rsq_f32 v132, v132
    v_rsq_f32 v133, v133
    v_rsq_f32 v134, v134
    v_rsq_f32 v135, v135
    v_pk_fma_f32 v[104:105], v[108:109], v[60:61], v[104:105] op_sel:[0,1,0] neg_lo:[1,0,0] neg_hi:[1,0,0]
    v_pk_fma_f32 v[106:107], v[110:111], v[60:61], v[106:107] op_sel:[0,1,0] neg_lo:[1,0,0] neg_hi:[1,0,0]
    v_pk_fma_f32 v[104:105], v[104:105], v[132:133], v[62:63] op_sel_hi:[1,1,0]
    v_pk_fma_f32 v[106:107], v[106:107], v[134:135], v[62:63] op_sel_hi:[1,1,0]
L_back13:
    v_max3_f32 v1, v104, v105, v106
    v_max_f32 v1, v1, v107
    v_cmp_lt_f32 vcc, s52, v1
    v_exp_f32 v112, v104
    v_exp_f32 v113, v105
    v_exp_f32 v114, v106
    v_exp_f32 v115, v107
    s_cbranch_vccnz L_site13
    v_pk_mul_f32 v[104:105], v[112:113], v[132:133]
    v_pk_mul_f32 v[106:107], v[114:115], v[134:135]
    v_cvt_pk_bf16_f32 v74, v104, v105
    v_cvt_pk_bf16_f32 v75, v106, v107
    ds_write_b128 v237, v[72:75] offset:0
    v_pk_add_f32 v[68:69], v[68:69], v[104:105]
    v_pk_add_f32 v[70:71], v[70:71], v[106:107]
    v_pk_add_f32 v[112:113], v[112:113], v[114:115]
    v_cvt_pk_bf16_f32 v66, v68, v69
    v_cvt_pk_bf16_f32 v67, v70, v71
    ds_write_b64 v238, v[66:67]
    v_pk_mul_f32 v[114:115], v[104:105], v[108:109]
    v_add_f32 v63, v63, v112
    v_pk_fma_f32 v[114:115], v[106:107], v[110:111], v[114:115]
    v_add_f32 v10, v63, v113
    v_add_f32 v64, v64, v114
    v_add_f32 v11, v64, v115
    ds_write_b64 v238, v[10:11] offset:2048
L_merge:
    s_waitcnt lgkmcnt(0)
    s_barrier
L_postx:
    ds_read_b32 v9, v254 offset:4096
    ds_read_b128 v[92:95], v253 offset:0
    ds_read_b128 v[96:99], v253 offset:1024
    ds_read_b128 v[100:103], v253 offset:2048
    ds_read_b64 v[136:137], v254 offset:2048
    ds_read_b64 v[138:139], v254 offset:2560
    ds_read_b64 v[140:141], v254 offset:3072
    ds_read_b64 v[142:143], v254 offset:3584
    ds_read_b128 v[116:119], v253 offset:3072
    ds_read_b64 v[120:121], v254 offset:0
    ds_read_b64 v[122:123], v254 offset:512
    s_waitcnt lgkmcnt(10)
    v_cmp_ne_u32 vcc, 0, v9
    s_cbranch_vccnz L_xlast
    s_waitcnt lgkmcnt(9)
    v_mfma_f32_16x16x32_bf16 v[16:19], a[0:3], v[92:95], v[16:19]
    ds_read_b64 v[124:125], v254 offset:1024
    v_mfma_f32_16x16x32_bf16 v[20:23], a[16:19], v[92:95], v[20:23]
    ds_read_b64 v[126:127], v254 offset:1536
    v_mfma_f32_16x16x32_bf16 v[24:27], a[32:35], v[92:95], v[24:27]
    s_waitcnt lgkmcnt(10)
    v_mfma_f32_16x16x32_bf16 v[16:19], a[4:7], v[96:99], v[16:19]
    v_mfma_f32_16x16x32_bf16 v[20:23], a[20:23], v[96:99], v[20:23]
    v_mfma_f32_16x16x32_bf16 v[24:27], a[36:39], v[96:99], v[24:27]
    s_waitcnt lgkmcnt(9)
    v_mfma_f32_16x16x32_bf16 v[16:19], a[8:11], v[100:103], v[16:19]
    s_waitcnt lgkmcnt(5)
    v_add_f32 v1, v136, v138
    v_add_f32 v2, v137, v139
    v_add_f32 v140, v140, v142
    v_mfma_f32_16x16x32_bf16 v[20:23], a[24:27], v[100:103], v[20:23]
    v_add_f32 v141, v141, v143
    v_add_f32 v1, v1, v140
    v_add_f32 v2, v2, v141
    v_mfma_f32_16x16x32_bf16 v[24:27], a[40:43], v[100:103], v[24:27]
    s_nop 0
    v_permlane32_swap_b32 v1, v2
    v_add_f32 v1, v1, v2
    v_mov_b32 v2, v1
    s_waitcnt lgkmcnt(4)
    v_mfma_f32_16x16x32_bf16 v[16:19], a[12:15], v[116:119], v[16:19]
    v_permlane16_swap_b32 v1, v2
    v_add_f32 v1, v1, v2
    v_mov_b32 v2, v1
    s_waitcnt lgkmcnt(2)
    v_mfma_f32_16x16x32_bf16 v[16:19], a[72:75], v[120:123], v[16:19]
    v_permlane32_swap_b32 v1, v2
    v_rcp_f32 v3, v1
    s_waitcnt lgkmcnt(0)
    v_mfma_f32_16x16x32_bf16 v[16:19], a[76:79], v[124:127], v[16:19]
    v_log_f32 v4, v1
    v_mul_f32 v5, v60, v3
    v_mfma_f32_16x16x32_bf16 v[20:23], a[28:31], v[116:119], v[20:23]
    v_mul_f32 v6, v2, v3
    v_sub_f32 v4, v4, v255
    v_mfma_f32_16x16x32_bf16 v[20:23], a[80:83], v[120:123], v[20:23]
    v_mfma_f32_16x16x32_bf16 v[20:23], a[84:87], v[124:127], v[20:23]
    v_mfma_f32_16x16x32_bf16 v[24:27], a[44:47], v[116:119], v[24:27]
    v_fma_f32 v16, v16, v5, -v6
    v_fma_f32 v17, v17, v5, -v6
    v_mfma_f32_16x16x32_bf16 v[24:27], a[88:91], v[120:123], v[24:27]
    v_fma_f32 v18, v18, v5, -v6
    v_fma_f32 v19, v19, v5, -v6
    v_mfma_f32_16x16x32_bf16 v[24:27], a[92:95], v[124:127], v[24:27]
    v_cvt_pk_bf16_f32 v66, v16, v17
    v_cvt_pk_bf16_f32 v67, v18, v19
    ds_write_b64 v236, v[66:67] offset:0
    v_pk_fma_f32 v[20:21], v[20:21], v[4:5], v[6:7] op_sel:[0,1,0] op_sel_hi:[1,1,0] neg_lo:[0,0,1] neg_hi:[0,0,1]
    v_pk_fma_f32 v[22:23], v[22:23], v[4:5], v[6:7] op_sel:[0,1,0] op_sel_hi:[1,1,0] neg_lo:[0,0,1] neg_hi:[0,0,1]
    v_cvt_pk_bf16_f32 v68, v20, v21
    v_cvt_pk_bf16_f32 v69, v22, v23
    ds_write_b64 v236, v[68:69] offset:512
    v_pk_fma_f32 v[24:25], v[24:25], v[4:5], v[6:7] op_sel:[0,1,0] op_sel_hi:[1,1,0] neg_lo:[0,0,1] neg_hi:[0,0,1]
    v_pk_fma_f32 v[26:27], v[26:27], v[4:5], v[6:7] op_sel:[0,1,0] op_sel_hi:[1,1,0] neg_lo:[0,0,1] neg_hi:[0,0,1]
    v_cvt_pk_bf16_f32 v70, v24, v25
    v_cvt_pk_bf16_f32 v71, v26, v27
    ds_write_b64 v236, v[70:71] offset:1024
    s_waitcnt lgkmcnt(0)
    s_barrier
    ds_read_b128 v[136:139], v241 offset:0
    ds_read_b128 v[140:143], v241 offset:1024
    ds_read_b128 v[144:147], v241 offset:2048
    ds_read_b128 v[148:151], v241 offset:3072
    ds_read_b128 v[152:155], v241 offset:4096
    ds_read_b128 v[156:159], v241 offset:5120
    s_waitcnt vmcnt(1)
    v_subrev_u32 v35, s39, v4
    v_add_u32 v39, s39, v4
    s_waitcnt lgkmcnt(5)
    v_mfma_f32_16x16x32_bf16 v[16:19], v[160:163], v[136:139], 0
    v_mfma_f32_16x16x32_bf16 v[20:23], v[184:187], v[136:139], 0
    v_mfma_f32_16x16x32_bf16 v[24:27], v[208:211], v[136:139], 0
    s_waitcnt lgkmcnt(4)
    v_mfma_f32_16x16x32_bf16 v[16:19], v[164:167], v[140:143], v[16:19]
    v_mfma_f32_16x16x32_bf16 v[20:23], v[188:191], v[140:143], v[20:23]
    v_mfma_f32_16x16x32_bf16 v[24:27], v[212:215], v[140:143], v[24:27]
    s_waitcnt lgkmcnt(3)
    v_mfma_f32_16x16x32_bf16 v[16:19], v[168:171], v[144:147], v[16:19]
    v_mfma_f32_16x16x32_bf16 v[20:23], v[192:195], v[144:147], v[20:23]
    v_mfma_f32_16x16x32_bf16 v[24:27], v[216:219], v[144:147], v[24:27]
    s_waitcnt lgkmcnt(2)
    v_mfma_f32_16x16x32_bf16 v[16:19], v[172:175], v[148:151], v[16:19]
    s_waitcnt lgkmcnt(1)
    v_mfma_f32_16x16x32_bf16 v[16:19], v[176:179], v[152:155], v[16:19]
    s_waitcnt lgkmcnt(0)
    v_mfma_f32_16x16x32_bf16 v[16:19], v[180:183], v[156:159], v[16:19]
    v_mfma_f32_16x16x32_bf16 v[20:23], v[196:199], v[148:151], v[20:23]
    v_mfma_f32_16x16x32_bf16 v[20:23], v[200:203], v[152:155], v[20:23]
    v_mfma_f32_16x16x32_bf16 v[20:23], v[204:207], v[156:159], v[20:23]
    v_mfma_f32_16x16x32_bf16 v[24:27], v[220:223], v[148:151], v[24:27]
    v_mfma_f32_16x16x32_bf16 v[24:27], v[224:227], v[152:155], v[24:27]
    s_nop 2
    v_cvt_pk_bf16_f32 v32, v16, v17
    v_mfma_f32_16x16x32_bf16 v[24:27], v[228:231], v[156:159], v[24:27]
    v_cvt_pk_bf16_f32 v33, v18, v19
    v_cvt_pk_bf16_f32 v34, v20, v21
    v_cvt_pk_bf16_f32 v36, v22, v23
    v_permlane16_swap_b32 v35, v39
    s_nop 0
    v_permlane16_swap_b32 v32, v36
    s_nop 1
    v_cvt_pk_bf16_f32 v37, v24, v25
    v_cvt_pk_bf16_f32 v38, v26, v27
    s_nop 0
    v_permlane16_swap_b32 v33, v37
    v_permlane16_swap_b32 v34, v38
    buffer_store_dwordx4 v[32:35], v242, s[32:35], s28 offen sc1
    buffer_store_dwordx4 v[36:39], v243, s[32:35], s28 offen sc1
    s_cmp_lt_u32 s29, 64
    s_cbranch_scc0 L_fin
    buffer_load_dwordx4 v[76:79], v29, s[32:35], s30 offen offset:0 sc1
    buffer_load_dwordx4 v[80:83], v29, s[32:35], s30 offen offset:2048 sc1
    buffer_load_dwordx4 v[84:87], v29, s[32:35], s31 offen offset:0 sc1
    buffer_load_dwordx4 v[108:111], v29, s[32:35], s31 offen offset:2048 sc1
    ds_bpermute_b32 v42, v252, v4
    v_bfe_u32 v48, v0, 0, 1
    v_cmp_eq_u32 vcc, 1, v48
    v_mov_b32 v246, s39
    s_movk_i32 s26, 0x11
    v_sub_u32 v247, 0, v246
    v_cndmask_b32 v247, v247, v246, vcc
    v_mul_lo_u32 v246, v247, -2
    v_mov_b32 v16, 0
    v_mov_b32 v17, 0
    v_mov_b32 v18, 0
    v_mov_b32 v19, 0
    v_mov_b32 v20, 0
    v_mov_b32 v21, 0
    v_mov_b32 v22, 0
    v_mov_b32 v97, 0
    s_mov_b32 s53, 0
    v_mov_b32 v160, 0x11
    v_mov_b32 v161, 0x22
    v_mov_b32 v162, 0x44
    v_mov_b32 v163, 0x88
    s_waitcnt vmcnt(0)
    v_sub_u32_dpp v136, v79, v79 quad_perm:[1,0,3,2] row_mask:0xf bank_mask:0xf
    v_sub_u32_dpp v137, v83, v83 quad_perm:[1,0,3,2] row_mask:0xf bank_mask:0xf
    v_sub_u32_dpp v138, v87, v87 quad_perm:[1,0,3,2] row_mask:0xf bank_mask:0xf
    v_sub_u32_dpp v139, v111, v111 quad_perm:[1,0,3,2] row_mask:0xf bank_mask:0xf
    v_cmp_eq_u32 s[6:7], v136, v246
    v_cmp_eq_u32 s[8:9], v137, v246
    v_cmp_eq_u32 s[10:11], v138, v246
    v_cmp_eq_u32 s[12:13], v139, v246
    v_cndmask_b32 v136, v160, 0, s[6:7]
    v_cndmask_b32 v137, v161, 0, s[8:9]
    v_cndmask_b32 v138, v162, 0, s[10:11]
    v_cndmask_b32 v139, v163, 0, s[12:13]
    v_or3_b32 v96, v136, v137, v138
    v_or_b32 v96, v96, v139
    v_cmp_ne_u32 vcc, 0, v96
    v_sub_u32 v168, v79, v247
    v_sub_u32 v169, v83, v247
    s_cbranch_vccz L_c_all
    v_lshrrev_b32 v48, v97, v96
    v_ffbl_b32 v48, v48
    v_add_u32 v48, v48, v97
    v_and_b32 v48, 3, v48
    v_lshl_add_u32 v51, v48, 11, v29
    v_lshlrev_b32 v88, v48, s26
    v_add_u32 v97, 1, v48
    s_mov_b64 exec, vcc
    buffer_load_dwordx4 v[136:139], v51, s[32:35], s30 offen sc1
    s_mov_b64 exec, -1
    v_lshrrev_b32 v48, v97, v96
    v_ffbl_b32 v48, v48
    v_add_u32 v48, v48, v97
    v_and_b32 v48, 3, v48
    v_lshl_add_u32 v51, v48, 11, v29
    v_lshlrev_b32 v89, v48, s26
    v_add_u32 v97, 1, v48
    s_mov_b64 exec, vcc
    buffer_load_dwordx4 v[140:143], v51, s[32:35], s30 offen sc1
    s_mov_b64 exec, -1
L_c_all:
    v_sub_u32 v170, v87, v247
    v_sub_u32 v171, v111, v247
    s_waitcnt lgkmcnt(0)
    v_sub_f32 v168, v168, v42
    v_sub_f32 v169, v169, v42
    v_sub_f32 v170, v170, v42
    v_sub_f32 v171, v171, v42
    v_exp_f32 v168, v168
    v_exp_f32 v169, v169
    v_exp_f32 v170, v170
    v_exp_f32 v171, v171
    v_cvt_pk_bf16_f32 v168, v168, 0
    v_cvt_pk_bf16_f32 v169, v169, 0
    v_cvt_pk_bf16_f32 v170, v170, 0
    v_cvt_pk_bf16_f32 v171, v171, 0
    v_lshlrev_b32 v176, 16, v168
    v_lshlrev_b32 v177, 16, v169
    v_lshlrev_b32 v178, 16, v170
    v_lshlrev_b32 v179, 16, v171
    s_mov_b64 exec, s[6:7]
    v_dot2c_f32_bf16 v16, v76, v168
    v_dot2c_f32_bf16 v18, v77, v168
    v_dot2c_f32_bf16 v20, v78, v168
    v_add_f32 v22, v22, v176
    v_dot2c_f32_bf16 v17, v76, v176
    v_dot2c_f32_bf16 v19, v77, v176
    v_dot2c_f32_bf16 v21, v78, v176
    s_mov_b64 exec, s[8:9]
    v_dot2c_f32_bf16 v16, v80, v169
    v_dot2c_f32_bf16 v18, v81, v169
    v_dot2c_f32_bf16 v20, v82, v169
    v_add_f32 v22, v22, v177
    v_dot2c_f32_bf16 v17, v80, v177
    v_dot2c_f32_bf16 v19, v81, v177
    v_dot2c_f32_bf16 v21, v82, v177
    s_mov_b64 exec, s[10:11]
    v_dot2c_f32_bf16 v16, v84, v170
    v_dot2c_f32_bf16 v18, v85, v170
    v_dot2c_f32_bf16 v20, v86, v170
    v_add_f32 v22, v22, v178
    v_dot2c_f32_bf16 v17, v84, v178
    v_dot2c_f32_bf16 v19, v85, v178
    v_dot2c_f32_bf16 v21, v86, v178
    s_mov_b64 exec, s[12:13]
    v_dot2c_f32_bf16 v16, v108, v171
    v_dot2c_f32_bf16 v18, v109, v171
    v_dot2c_f32_bf16 v20, v110, v171
    v_add_f32 v22, v22, v179
    v_dot2c_f32_bf16 v17, v108, v179
    v_dot2c_f32_bf16 v19, v109, v179
    v_dot2c_f32_bf16 v21, v110, v179
    s_mov_b64 exec, -1
    s_cbranch_vccz L_c_red
L_c_loop:
    s_waitcnt vmcnt(1)
    v_sub_u32_dpp v48, v139, v139 quad_perm:[1,0,3,2] row_mask:0xf bank_mask:0xf
    v_and_b32 v49, v88, v96
    v_cmpx_eq_u32 vcc, v48, v246
    v_cmpx_ne_u32 vcc, 0, v49
    v_xor_b32 v96, v96, v88
    v_sub_u32 v49, v139, v247
    v_sub_f32 v49, v49, v42
    v_exp_f32 v49, v49
    s_cbranch_execz L_c_s0
    v_cvt_pk_bf16_f32 v49, v49, 0
    v_lshlrev_b32 v50, 16, v49
    v_dot2c_f32_bf16 v16, v136, v49
    v_dot2c_f32_bf16 v18, v137, v49
    v_dot2c_f32_bf16 v20, v138, v49
    v_add_f32 v22, v22, v50
    v_dot2c_f32_bf16 v17, v136, v50
    v_dot2c_f32_bf16 v19, v137, v50
    v_dot2c_f32_bf16 v21, v138, v50
L_c_s0:
    s_mov_b64 exec, -1
    v_cmp_ne_u32 vcc, 0, v96
    v_lshrrev_b32 v48, v97, v96
    v_ffbl_b32 v48, v48
    s_cbranch_vccz L_c_red
    v_add_u32 v48, v48, v97
    v_and_b32 v48, 3, v48
    v_lshl_add_u32 v51, v48, 11, v29
    v_lshlrev_b32 v88, v48, s26
    v_add_u32 v97, 1, v48
    s_mov_b64 exec, vcc
    buffer_load_dwordx4 v[136:139], v51, s[32:35], s30 offen sc1
    s_mov_b64 exec, -1
    s_waitcnt vmcnt(1)
    v_sub_u32_dpp v48, v143, v143 quad_perm:[1,0,3,2] row_mask:0xf bank_mask:0xf
    v_and_b32 v49, v89, v96
    v_cmpx_eq_u32 vcc, v48, v246
    v_cmpx_ne_u32 vcc, 0, v49
    v_xor_b32 v96, v96, v89
    v_sub_u32 v49, v143, v247
    v_sub_f32 v49, v49, v42
    v_exp_f32 v49, v49
    s_cbranch_execz L_c_s1
    v_cvt_pk_bf16_f32 v49, v49, 0
    v_lshlrev_b32 v50, 16, v49
    v_dot2c_f32_bf16 v16, v140, v49
    v_dot2c_f32_bf16 v18, v141, v49
    v_dot2c_f32_bf16 v20, v142, v49
    v_add_f32 v22, v22, v50
    v_dot2c_f32_bf16 v17, v140, v50
    v_dot2c_f32_bf16 v19, v141, v50
    v_dot2c_f32_bf16 v21, v142, v50
L_c_s1:
    s_mov_b64 exec, -1
    v_cmp_ne_u32 vcc, 0, v96
    v_lshrrev_b32 v48, v97, v96
    v_ffbl_b32 v48, v48
    s_cbranch_vccz L_c_red
    v_add_u32 v48, v48, v97
    v_and_b32 v48, 3, v48
    v_lshl_add_u32 v51, v48, 11, v29
    v_lshlrev_b32 v89, v48, s26
    v_add_u32 v97, 1, v48
    s_mov_b64 exec, vcc
    buffer_load_dwordx4 v[140:143], v51, s[32:35], s30 offen sc1
    s_mov_b64 exec, -1
    s_add_u32 s53, s53, 1
    s_cmp_lt_u32 s53, 65536
    s_cbranch_scc1 L_c_loop
L_c_red:
    v_mov_b32 v23, v22
    v_permlane32_swap_b32 v16, v20
    v_permlane32_swap_b32 v17, v21
    v_permlane32_swap_b32 v18, v22
    v_permlane32_swap_b32 v19, v23
    v_add_f32 v16, v16, v20
    v_add_f32 v17, v17, v21
    v_add_f32 v18, v18, v22
    v_add_f32 v19, v19, v23
    s_nop 0
    v_permlane16_swap_b32 v16, v18
    v_permlane16_swap_b32 v17, v19
    v_add_f32 v16, v16, v18
    v_add_f32 v17, v17, v19
    s_nop 0
    v_add_f32_dpp v48, v16, v16 row_ror:8 row_mask:0xf bank_mask:0x3
    s_nop 1
    v_add_f32_dpp v48, v17, v17 row_ror:8 row_mask:0xf bank_mask:0xc
    s_nop 1
    v_add_f32_dpp v48, v48, v48 row_shr:4 row_mask:0xf bank_mask:0xa
    ds_write_b32 v250, v48
    s_waitcnt lgkmcnt(0)
    s_barrier
    ds_read_b128 v[48:51], v251 offset:768
    ds_read_b128 v[52:55], v65
    v_lshlrev_b32 v18, 16, v249
    s_waitcnt lgkmcnt(1)
    v_add_f32 v48, v48, v49
    v_add_f32 v50, v50, v51
    v_add_f32 v48, v48, v50
    v_cmp_nlt_f32 vcc, v48, v232
    v_rcp_f32 v48, v48
    s_waitcnt lgkmcnt(0)
    s_cbranch_vccnz L_c_slow
L_c_out:
    s_cmp_lg_u32 s3, 0
    s_cbranch_scc1 L_fin
    v_add_f32 v52, v52, v53
    v_add_f32 v54, v54, v55
    v_add_f32 v52, v52, v54
    v_fmac_f32 v18, v52, v48
    v_cvt_pk_bf16_f32 v18, v18, v18
    buffer_store_short v18, v248, s[68:71], 0 offen sc1
    s_cmp_lg_u32 s2, 64
    s_cbranch_scc1 L_fin
    v_mov_b32 v48, s39
    v_mov_b32 v49, 0
    s_mov_b64 exec, 1
    buffer_store_dword v48, v49, s[32:35], 0 offen offset:0 sc1
    s_mov_b64 exec, -1
L_fin:
L_end:
    s_endpgm
L_hot:
L_prod:
    s_cmp_lg_u32 s3, 0
    s_cbranch_scc1 L_p_noq
    s_mov_b32 m0, 147456
    s_nop 0
    buffer_load_dwordx4 v16, s[72:75], 0 offen offset:0  lds
    buffer_load_dwordx4 v17, s[72:75], 0 offen offset:1024  lds
    buffer_load_dwordx4 v18, s[72:75], 0 offen offset:2048  lds
    buffer_load_dwordx4 v19, s[72:75], 0 offen offset:3072  lds
    s_mov_b32 m0, 151552
    s_nop 0
    buffer_load_dwordx4 v20, s[72:75], 0 offen offset:0  lds
    buffer_load_dwordx4 v21, s[72:75], 0 offen offset:1024  lds
L_p_noq:
    s_mul_i32 s60, s3, 18432
    s_add_u32 m0, s60, 73728
    s_nop 0
    buffer_load_dwordx4 v16, s[64:67], s60 offen offset:0  lds
    buffer_load_dwordx4 v17, s[64:67], s60 offen offset:1024  lds
    buffer_load_dwordx4 v18, s[64:67], s60 offen offset:2048  lds
    buffer_load_dwordx4 v19, s[64:67], s60 offen offset:3072  lds
    s_add_u32 m0, s60, 77824
    s_nop 0
    buffer_load_dwordx4 v20, s[64:67], s60 offen offset:0  lds
    buffer_load_dwordx4 v21, s[64:67], s60 offen offset:1024  lds
    s_add_u32 s60, s60, 6144
    s_add_u32 m0, s60, 73728
    s_nop 0
    buffer_load_dwordx4 v16, s[64:67], s60 offen offset:0  lds
    buffer_load_dwordx4 v17, s[64:67], s60 offen offset:1024  lds
    buffer_load_dwordx4 v18, s[64:67], s60 offen offset:2048  lds
    buffer_load_dwordx4 v19, s[64:67], s60 offen offset:3072  lds
    s_add_u32 m0, s60, 77824
    s_nop 0
    buffer_load_dwordx4 v20, s[64:67], s60 offen offset:0  lds
    buffer_load_dwordx4 v21, s[64:67], s60 offen offset:1024  lds
    s_add_u32 s60, s60, 6144
    s_add_u32 m0, s60, 73728
    s_nop 0
    buffer_load_dwordx4 v16, s[64:67], s60 offen offset:0  lds
    v_mov_b32 v52, 0x3f803f80
    v_mov_b32 v56, 0x3ebcbe62
    s_mov_b32 s44, 0x100001
    s_mov_b32 s45, 0x10000100
    v_mov_b32 v53, 0x3f803f80
    v_mov_b32 v57, 0x3ebcbe62
    s_mov_b32 s46, 0x200002
    buffer_load_dwordx4 v17, s[64:67], s60 offen offset:1024  lds
    s_mov_b32 s47, 0x20000200
    v_mov_b32 v54, 0x3f803f80
    v_mov_b32 v58, 0x3ebcbe62
    s_mov_b32 s48, 0x400004
    s_mov_b32 s49, 0x40000400
    v_mov_b32 v55, 0x3f803f80
    v_mov_b32 v59, 0x3ebcbe62
    buffer_load_dwordx4 v18, s[64:67], s60 offen offset:2048  lds
    s_mov_b32 s50, 0x800008
    s_mov_b32 s51, 0x80000800
    v_mov_b32 v60, 0x43400000
    v_lshrrev_b32 v1, 5, v0
    v_lshlrev_b32 v1, 8, v1
    v_and_b32 v2, 15, v0
    v_lshl_add_u32 v1, v2, 4, v1
    buffer_load_dwordx4 v19, s[64:67], s60 offen offset:3072  lds
    v_bfe_u32 v2, v0, 4, 1
    v_lshl_add_u32 v1, v2, 3, v1
    s_mul_i32 s56, s3, 1536
    s_add_u32 s56, s56, 153600
    v_add_u32 v134, s56, v1
    v_bfe_u32 v1, v0, 4, 1
    v_lshrrev_b32 v5, 5, v0
    s_add_u32 m0, s60, 77824
    s_nop 0
    buffer_load_dwordx4 v20, s[64:67], s60 offen offset:0  lds
    v_lshl_or_b32 v1, v1, 1, v5
    v_bfe_u32 v2, v0, 2, 2
    v_lshl_add_u32 v3, v1, 3, v2
    v_mul_u32_u24 v3, 384, v3
    v_and_b32 v4, 1, v0
    v_lshl_add_u32 v3, v4, 3, v3
    v_add_u32 v3, 73728, v3
    buffer_load_dwordx4 v21, s[64:67], s60 offen offset:1024  lds
    v_and_or_b32 v2, v2, 2, v5
    v_bfe_u32 v4, v0, 1, 1
    v_xor_b32 v2, v2, v4
    s_mul_i32 s56, s3, 6
    s_add_u32 s57, s56, 0
    v_xor_b32 v4, s57, v2
    v_lshl_add_u32 v124, v4, 4, v3
    s_lshl_b32 s61, s43, 2
    s_add_u32 s61, s61, s3
    s_mul_i32 s60, s61, 6144
    s_add_u32 m0, s41, 6144
    s_nop 0
    buffer_load_dwordx4 v16, s[68:71], s60 offen offset:0  lds
    v_xor_b32 v125, 64, v124
    s_add_u32 s57, s56, 2
    v_xor_b32 v4, s57, v2
    v_lshl_add_u32 v126, v4, 4, v3
    v_xor_b32 v127, 64, v126
    s_add_u32 s57, s56, 4
    v_xor_b32 v4, s57, v2
    buffer_load_dwordx4 v17, s[68:71], s60 offen offset:1024  lds
    v_lshl_add_u32 v128, v4, 4, v3
    v_xor_b32 v129, 64, v128
    v_and_b32 v2, 15, v0
    v_bfe_u32 v3, v0, 3, 1
    v_and_or_b32 v4, v0, 6, v3
    v_xor_b32 v4, v4, v1
    v_mul_u32_u24 v2, 384, v2
    buffer_load_dwordx4 v18, s[68:71], s60 offen offset:2048  lds
    v_lshl_add_u32 v2, v4, 4, v2
    v_add_u32 v132, 147456, v2
    v_xor_b32 v133, 64, v132
    s_and_b32 s56, s3, 1
    s_lshl_b32 s56, s56, 2
    s_lshr_b32 s57, s3, 1
    s_mul_i32 s57, s57, 24576
    buffer_load_dwordx4 v19, s[68:71], s60 offen offset:3072  lds
    s_add_u32 s57, s57, 30720
    v_and_b32 v1, 11, v0
    v_or_b32 v1, s56, v1
    v_and_or_b32 v2, v1, 6, v3
    v_lshrrev_b32 v3, 4, v0
    v_xor_b32 v2, v2, v3
    v_mul_u32_u24 v1, 384, v1
    s_add_u32 m0, s41, 10240
    s_nop 0
    buffer_load_dwordx4 v20, s[68:71], s60 offen offset:0  lds
    v_lshl_add_u32 v1, v2, 4, v1
    v_bfe_u32 v2, v0, 2, 1
    v_mul_u32_u24 v2, 12288, v2
    v_add3_u32 v130, s57, v1, v2
    v_xor_b32 v131, 64, v130
    v_add_u32 v135, 153600, v65
    buffer_load_dwordx4 v21, s[68:71], s60 offen offset:1024  lds
    s_waitcnt vmcnt(24)
    s_barrier
    s_load_dword s38, s[22:23], 0
    ds_read_b128 v[136:139], v132 offset:0
    ds_read_b128 v[140:143], v133 offset:0
    ds_read_b128 v[144:147], v132 offset:128
    ds_read_b128 v[148:151], v133 offset:128
    ds_read_b128 v[152:155], v132 offset:256
    ds_read_b128 v[156:159], v133 offset:256
    s_add_u32 m0, s40, 0
    s_add_u32 s57, s36, 0
    buffer_load_dwordx4 v16, s[28:31], s57 offen offset:0 nt lds
    buffer_load_dwordx4 v17, s[28:31], s57 offen offset:1024 nt lds
    buffer_load_dwordx4 v18, s[28:31], s57 offen offset:2048 nt lds
    buffer_load_dwordx4 v19, s[28:31], s57 offen offset:3072 nt lds
    s_add_u32 m0, s40, 4096
    s_nop 0
    buffer_load_dwordx4 v20, s[28:31], s57 offen offset:0 nt lds
    buffer_load_dwordx4 v21, s[28:31], s57 offen offset:1024 nt lds
    s_waitcnt lgkmcnt(0)
    v_mfma_f32_16x16x32_bf16 v[112:115], v[136:139], v[136:139], 0
    v_mfma_f32_16x16x32_bf16 v[116:119], v[52:55], v[136:139], 0
    s_add_u32 m0, s41, 0
    s_add_u32 s58, s37, 0
    buffer_load_dwordx4 v22, s[24:27], s58 offen offset:0 nt lds
    v_mfma_f32_16x16x32_bf16 v[112:115], v[140:143], v[140:143], v[112:115]
    v_mfma_f32_16x16x32_bf16 v[116:119], v[52:55], v[140:143], v[116:119]
    buffer_load_dwordx4 v23, s[24:27], s58 offen offset:1024 nt lds
    v_mfma_f32_16x16x32_bf16 v[112:115], v[144:147], v[144:147], v[112:115]
    v_mfma_f32_16x16x32_bf16 v[116:119], v[52:55], v[144:147], v[116:119]
    buffer_load_dwordx4 v24, s[24:27], s58 offen offset:2048 nt lds
    v_mfma_f32_16x16x32_bf16 v[112:115], v[148:151], v[148:151], v[112:115]
    v_mfma_f32_16x16x32_bf16 v[116:119], v[52:55], v[148:151], v[116:119]
    v_mfma_f32_16x16x32_bf16 v[112:115], v[152:155], v[152:155], v[112:115]
    v_mfma_f32_16x16x32_bf16 v[116:119], v[52:55], v[152:155], v[116:119]
    v_mfma_f32_16x16x32_bf16 v[112:115], v[156:159], v[156:159], v[112:115]
    v_mfma_f32_16x16x32_bf16 v[116:119], v[52:55], v[156:159], v[116:119]
    s_mul_i32 s39, s38, 0x9e3779b1
    s_add_u32 s39, s39, 0x7f4a7c16
    s_or_b32 s39, s39, 1
    s_lshl_b32 s61, s61, 10
    s_add_u32 s61, s61, 16384
    s_waitcnt vmcnt(15)
    s_barrier
    ds_read_b64_tr_b16 v[160:161], v124 offset:0
    ds_read_b64_tr_b16 v[162:163], v125 offset:1536
    ds_read_b64_tr_b16 v[184:185], v126 offset:0
    ds_read_b64_tr_b16 v[186:187], v127 offset:1536
    ds_read_b64_tr_b16 v[208:209], v128 offset:0
    ds_read_b64_tr_b16 v[210:211], v129 offset:1536
    ds_read_b64_tr_b16 v[164:165], v124 offset:12288
    ds_read_b64_tr_b16 v[166:167], v125 offset:13824
    ds_read_b64_tr_b16 v[188:189], v126 offset:12288
    ds_read_b64_tr_b16 v[190:191], v127 offset:13824
    ds_read_b64_tr_b16 v[212:213], v128 offset:12288
    ds_read_b64_tr_b16 v[214:215], v129 offset:13824
    v_cndmask_b32 v3, 0, v112, s[44:45]
    v_cndmask_b32 v3, v3, v113, s[46:47]
    v_cndmask_b32 v3, v3, v114, s[48:49]
    v_cndmask_b32 v3, v3, v115, s[50:51]
    v_mul_f32 v6, 0x3baaaaab, v116
    ds_read_b64_tr_b16 v[168:169], v124 offset:24576
    ds_read_b64_tr_b16 v[170:171], v125 offset:26112
    v_mfma_f32_16x16x4_f32 v[120:123], v60, v3, v[56:59]
    s_waitcnt lgkmcnt(12)
    v_mfma_f32_16x16x32_bf16 v[88:91], v[160:163], v[136:139], 0
    ds_read_b64_tr_b16 v[192:193], v126 offset:24576
    v_mfma_f32_16x16x32_bf16 v[100:103], v[160:163], v[52:55], 0
    ds_read_b64_tr_b16 v[194:195], v127 offset:26112
    s_waitcnt lgkmcnt(12)
    v_mfma_f32_16x16x32_bf16 v[92:95], v[184:187], v[136:139], 0
    ds_read_b64_tr_b16 v[216:217], v128 offset:24576
    v_mfma_f32_16x16x32_bf16 v[104:107], v[184:187], v[52:55], 0
    ds_read_b64_tr_b16 v[218:219], v129 offset:26112
    s_waitcnt lgkmcnt(12)
    v_mfma_f32_16x16x32_bf16 v[96:99], v[208:211], v[136:139], 0
    ds_read_b64_tr_b16 v[172:173], v124 offset:36864
    v_mfma_f32_16x16x32_bf16 v[108:111], v[208:211], v[52:55], 0
    ds_read_b64_tr_b16 v[174:175], v125 offset:38400
    s_waitcnt lgkmcnt(12)
    v_mfma_f32_16x16x32_bf16 v[88:91], v[164:167], v[140:143], v[88:91]
    ds_read_b64_tr_b16 v[196:197], v126 offset:36864
    v_mfma_f32_16x16x32_bf16 v[100:103], v[164:167], v[52:55], v[100:103]
    ds_read_b64_tr_b16 v[198:199], v127 offset:38400
    s_waitcnt lgkmcnt(12)
    v_mfma_f32_16x16x32_bf16 v[92:95], v[188:191], v[140:143], v[92:95]
    ds_read_b64_tr_b16 v[220:221], v128 offset:36864
    v_mfma_f32_16x16x32_bf16 v[104:107], v[188:191], v[52:55], v[104:107]
    ds_read_b64_tr_b16 v[222:223], v129 offset:38400
    s_waitcnt lgkmcnt(12)
    v_mfma_f32_16x16x32_bf16 v[96:99], v[212:215], v[140:143], v[96:99]
    ds_read_b64_tr_b16 v[176:177], v124 offset:49152
    v_mfma_f32_16x16x32_bf16 v[108:111], v[212:215], v[52:55], v[108:111]
    ds_read_b64_tr_b16 v[178:179], v125 offset:50688
    s_waitcnt lgkmcnt(12)
    v_mfma_f32_16x16x32_bf16 v[88:91], v[168:171], v[144:147], v[88:91]
    ds_read_b64_tr_b16 v[200:201], v126 offset:49152
    v_mfma_f32_16x16x32_bf16 v[100:103], v[168:171], v[52:55], v[100:103]
    ds_read_b64_tr_b16 v[202:203], v127 offset:50688
    s_waitcnt lgkmcnt(12)
    v_mfma_f32_16x16x32_bf16 v[92:95], v[192:195], v[144:147], v[92:95]
    ds_read_b64_tr_b16 v[224:225], v128 offset:49152
    v_mfma_f32_16x16x32_bf16 v[104:107], v[192:195], v[52:55], v[104:107]
    ds_read_b64_tr_b16 v[226:227], v129 offset:50688
    s_waitcnt lgkmcnt(12)
    v_mfma_f32_16x16x32_bf16 v[96:99], v[216:219], v[144:147], v[96:99]
    ds_read_b64_tr_b16 v[180:181], v124 offset:61440
    v_mfma_f32_16x16x32_bf16 v[108:111], v[216:219], v[52:55], v[108:111]
    ds_read_b64_tr_b16 v[182:183], v125 offset:62976
    s_waitcnt lgkmcnt(12)
    v_mfma_f32_16x16x32_bf16 v[88:91], v[172:175], v[148:151], v[88:91]
    ds_read_b64_tr_b16 v[204:205], v126 offset:61440
    v_mfma_f32_16x16x32_bf16 v[100:103], v[172:175], v[52:55], v[100:103]
    ds_read_b64_tr_b16 v[206:207], v127 offset:62976
    s_waitcnt lgkmcnt(12)
    v_mfma_f32_16x16x32_bf16 v[92:95], v[196:199], v[148:151], v[92:95]
    ds_read_b64_tr_b16 v[228:229], v128 offset:61440
    v_mfma_f32_16x16x32_bf16 v[104:107], v[196:199], v[52:55], v[104:107]
    ds_read_b64_tr_b16 v[230:231], v129 offset:62976
    s_waitcnt lgkmcnt(12)
    v_mfma_f32_16x16x32_bf16 v[96:99], v[220:223], v[148:151], v[96:99]
    v_fma_f32 v5, -v116, v116, v120
    v_mfma_f32_16x16x32_bf16 v[108:111], v[220:223], v[52:55], v[108:111]
    v_max_f32 v5, v5, v56
    s_waitcnt lgkmcnt(10)
    v_mfma_f32_16x16x32_bf16 v[88:91], v[176:179], v[152:155], v[88:91]
    v_rsq_f32 v5, v5
    v_mfma_f32_16x16x32_bf16 v[100:103], v[176:179], v[52:55], v[100:103]
    v_mov_b32 v122, s39
    s_waitcnt lgkmcnt(8)
    v_mfma_f32_16x16x32_bf16 v[92:95], v[200:203], v[152:155], v[92:95]
    v_mul_f32 v5, v60, v5
    v_mfma_f32_16x16x32_bf16 v[104:107], v[200:203], v[52:55], v[104:107]
    v_mov_b32 v123, s39
    s_waitcnt lgkmcnt(6)
    v_mfma_f32_16x16x32_bf16 v[96:99], v[224:227], v[152:155], v[96:99]
    v_mfma_f32_16x16x32_bf16 v[108:111], v[224:227], v[52:55], v[108:111]
    s_waitcnt lgkmcnt(4)
    v_mfma_f32_16x16x32_bf16 v[88:91], v[180:183], v[156:159], v[88:91]
    v_mfma_f32_16x16x32_bf16 v[100:103], v[180:183], v[52:55], v[100:103]
    s_waitcnt lgkmcnt(2)
    v_mfma_f32_16x16x32_bf16 v[92:95], v[204:207], v[156:159], v[92:95]
    v_mfma_f32_16x16x32_bf16 v[104:107], v[204:207], v[52:55], v[104:107]
    s_waitcnt lgkmcnt(0)
    v_mfma_f32_16x16x32_bf16 v[96:99], v[228:231], v[156:159], v[96:99]
    v_mfma_f32_16x16x32_bf16 v[108:111], v[228:231], v[52:55], v[108:111]
    s_nop 1
    v_fma_f32 v88, -v6, v100, v88
    v_fma_f32 v89, -v6, v101, v89
    v_fma_f32 v90, -v6, v102, v90
    v_fma_f32 v91, -v6, v103, v91
    v_mul_f32 v88, v88, v5
    v_mul_f32 v89, v89, v5
    v_mul_f32 v90, v90, v5
    v_mul_f32 v91, v91, v5
    v_cvt_pk_bf16_f32 v112, v88, v89
    v_cvt_pk_bf16_f32 v113, v90, v91
    ds_write_b64 v134, v[112:113] offset:0
    v_fma_f32 v92, -v6, v104, v92
    v_fma_f32 v93, -v6, v105, v93
    v_fma_f32 v94, -v6, v106, v94
    v_fma_f32 v95, -v6, v107, v95
    v_mul_f32 v92, v92, v5
    v_mul_f32 v93, v93, v5
    v_mul_f32 v94, v94, v5
    v_mul_f32 v95, v95, v5
    v_cvt_pk_bf16_f32 v114, v92, v93
    v_cvt_pk_bf16_f32 v115, v94, v95
    ds_write_b64 v134, v[114:115] offset:512
    v_fma_f32 v96, -v6, v108, v96
    v_fma_f32 v97, -v6, v109, v97
    v_fma_f32 v98, -v6, v110, v98
    v_fma_f32 v99, -v6, v111, v99
    v_mul_f32 v96, v96, v5
    v_mul_f32 v97, v97, v5
    v_mul_f32 v98, v98, v5
    v_mul_f32 v99, v99, v5
    v_cvt_pk_bf16_f32 v116, v96, v97
    v_cvt_pk_bf16_f32 v117, v98, v99
    ds_write_b64 v134, v[116:117] offset:1024
    s_waitcnt vmcnt(9)
    s_waitcnt lgkmcnt(0)
    s_barrier
    ds_read_b128 v[136:139], v135 offset:0
    ds_read_b128 a[96:99], v130 offset:0
    ds_read_b128 v[140:143], v135 offset:1024
    ds_read_b128 a[100:103], v131 offset:0
    ds_read_b128 v[144:147], v135 offset:2048
    ds_read_b128 a[104:107], v130 offset:128
    ds_read_b128 v[148:151], v135 offset:3072
    ds_read_b128 a[108:111], v131 offset:128
    ds_read_b128 v[152:155], v135 offset:4096
    ds_read_b128 a[112:115], v130 offset:256
    ds_read_b128 v[156:159], v135 offset:5120
    ds_read_b128 a[116:119], v131 offset:256
    s_waitcnt lgkmcnt(10)
    v_mfma_f32_16x16x32_bf16 v[88:91], a[96:99], v[136:139], 0
    s_waitcnt lgkmcnt(8)
    v_mfma_f32_16x16x32_bf16 v[92:95], a[100:103], v[140:143], 0
    s_waitcnt lgkmcnt(6)
    v_mfma_f32_16x16x32_bf16 v[88:91], a[104:107], v[144:147], v[88:91]
    s_waitcnt lgkmcnt(4)
    v_mfma_f32_16x16x32_bf16 v[92:95], a[108:111], v[148:151], v[92:95]
    s_waitcnt lgkmcnt(2)
    v_mfma_f32_16x16x32_bf16 v[88:91], a[112:115], v[152:155], v[88:91]
    s_waitcnt lgkmcnt(0)
    v_mfma_f32_16x16x32_bf16 v[92:95], a[116:119], v[156:159], v[92:95]
    s_nop 7
    v_add_f32 v88, v88, v92
    v_add_f32 v89, v89, v93
    v_add_f32 v90, v90, v94
    v_add_f32 v91, v91, v95
    v_mul_f32 v88, 0x419fecaf, v88
    v_mul_f32 v89, 0x419fecaf, v89
    v_mul_f32 v90, 0x419fecaf, v90
    v_mul_f32 v91, 0x419fecaf, v91
    v_cvt_pk_bf16_f32 v120, v88, v89
    v_cvt_pk_bf16_f32 v121, v90, v91
    buffer_store_dwordx4 v[120:123], v65, s[32:35], s61 offen sc1
    buffer_load_dwordx4 v25, s[24:27], s58 offen offset:3072 nt lds
    s_add_u32 m0, s41, 4096
    s_nop 0
    buffer_load_dwordx4 v26, s[24:27], s58 offen offset:0 nt lds
    buffer_load_dwordx4 v27, s[24:27], s58 offen offset:1024 nt lds
    s_barrier
    buffer_load_dwordx4 v28, s[24:27], s58 offen offset:2048 nt lds
    buffer_load_dwordx4 v29, s[24:27], s58 offen offset:3072 nt lds
    s_add_u32 m0, s41, 8192
    s_nop 0
    buffer_load_dwordx4 v30, s[24:27], s58 offen offset:0 nt lds
    buffer_load_dwordx4 v31, s[24:27], s58 offen offset:1024 nt lds
    buffer_load_dwordx4 v32, s[24:27], s58 offen offset:2048 nt lds
    buffer_load_dwordx4 v33, s[24:27], s58 offen offset:3072 nt lds
    v_and_b32 v1, 15, v0
    v_lshrrev_b32 v6, 5, v0
    v_bfe_u32 v3, v0, 4, 1
    v_lshl_or_b32 v3, v3, 1, v6
    v_lshrrev_b32 v4, 2, v0
    v_bfe_u32 v5, v0, 1, 1
    v_lshrrev_b32 v6, 3, v1
    v_and_or_b32 v6, v1, 6, v6
    v_xor_b32 v6, v6, v3
    v_mul_u32_u24 v7, 384, v1
    v_lshl_add_u32 v6, v6, 4, v7
    v_add_u32 v34, s40, v6
    v_xor_b32 v35, 64, v34
    v_lshrrev_b32 v6, 3, v1
    v_and_b32 v7, 7, v1
    v_lshl_or_b32 v6, v7, 1, v6
    v_xor_b32 v6, v6, v3
    v_mul_u32_u24 v7, 768, v1
    v_lshl_add_u32 v6, v6, 4, v7
    v_add_u32 v40, s41, v6
    v_xor_b32 v41, 0x40, v40
    v_xor_b32 v42, 0x80, v40
    v_xor_b32 v43, 0xc0, v40
    v_and_b32 v2, 1, v0
    v_lshlrev_b32 v2, 3, v2
    s_mul_i32 s56, s3, 96
    v_lshrrev_b32 v6, 3, v4
    v_and_or_b32 v6, v4, 6, v6
    v_xor_b32 v6, v6, v5
    v_lshl_add_u32 v6, v6, 4, v2
    v_mul_u32_u24 v7, 384, v4
    s_add_u32 s57, s56, 0
    v_xad_u32 v36, v6, s57, v7
    s_add_u32 s57, s56, 32
    v_xad_u32 v37, v6, s57, v7
    s_add_u32 s57, s56, 64
    v_xad_u32 v38, v6, s57, v7
    v_lshrrev_b32 v6, 3, v4
    v_and_b32 v3, 7, v4
    v_lshl_or_b32 v6, v3, 1, v6
    v_xor_b32 v6, v6, v5
    v_lshl_add_u32 v6, v6, 4, v2
    v_lshlrev_b32 v7, 1, v7
    v_add_u32 v7, 24576, v7
    s_add_u32 s57, s56, 0
    v_xad_u32 v44, v6, s57, v7
    s_add_u32 s57, s56, 384
    v_xad_u32 v45, v6, s57, v7
    s_add_u32 s57, s56, 32
    v_xad_u32 v46, v6, s57, v7
    s_add_u32 s57, s56, 416
    v_xad_u32 v47, v6, s57, v7
    s_add_u32 s57, s56, 64
    v_xad_u32 v48, v6, s57, v7
    s_add_u32 s57, s56, 448
    v_xad_u32 v49, v6, s57, v7
    v_lshrrev_b32 v1, 5, v0
    v_lshlrev_b32 v1, 8, v1
    v_and_b32 v2, 15, v0
    v_lshl_add_u32 v1, v2, 4, v1
    v_bfe_u32 v2, v0, 4, 1
    v_lshl_add_u32 v1, v2, 3, v1
    s_mul_i32 s56, s3, 1536
    s_add_u32 s56, s56, 147456
    v_add_u32 v236, s56, v1
    s_mul_i32 s56, s3, 3072
    s_add_u32 s56, s56, 24576
    v_add_u32 v237, s56, v65
    v_add_u32 v238, s41, v65
    s_lshl_b32 s56, s3, 10
    v_add_u32 v240, 159744, v65
    v_add_u32 v239, s56, v240
    v_add_u32 v241, 147456, v65
    v_bfe_u32 v1, v0, 2, 2
    v_lshrrev_b32 v2, 4, v0
    v_lshl_or_b32 v1, v1, 4, v2
    v_mul_u32_u24 v1, 65536, v1
    v_and_b32 v2, 3, v0
    v_lshl_or_b32 v242, v2, 5, v1
    v_xor_b32 v243, 0x70, v242
    s_mul_i32 s56, s3, 3
    v_min_u32 v1, 2, v0
    v_add_u32 v1, s56, v1
    v_min_u32 v2, 8, v0
    v_add_u32 v2, 9, v2
    v_cmp_gt_u32 vcc, 3, v0
    s_nop 1
    v_cndmask_b32 v1, v2, v1, vcc
    v_lshlrev_b32 v245, 7, v1
    v_lshlrev_b32 v1, 3, v0
    v_add_u32 v254, 126976, v1
    s_lshl_b32 s56, s3, 9
    v_add_u32 v238, s56, v254
    v_add_u32 v253, 122880, v65
    s_lshl_b32 s56, s3, 10
    v_add_u32 v237, s56, v253
    s_mov_b32 s52, 0x41c00000
    s_add_u32 m0, s42, 0
    s_add_u32 s59, s37, 196608
    buffer_load_dwordx4 v22, s[24:27], s59 offen offset:0 nt lds
    buffer_load_dwordx4 v23, s[24:27], s59 offen offset:1024 nt lds
    buffer_load_dwordx4 v24, s[24:27], s59 offen offset:2048 nt lds
    buffer_load_dwordx4 v25, s[24:27], s59 offen offset:3072 nt lds
    s_add_u32 m0, s42, 4096
    s_nop 0
    buffer_load_dwordx4 v26, s[24:27], s59 offen offset:0 nt lds
    buffer_load_dwordx4 v27, s[24:27], s59 offen offset:1024 nt lds
    buffer_load_dwordx4 v28, s[24:27], s59 offen offset:2048 nt lds
    buffer_load_dwordx4 v29, s[24:27], s59 offen offset:3072 nt lds
    s_add_u32 m0, s42, 8192
    s_nop 0
    buffer_load_dwordx4 v30, s[24:27], s59 offen offset:0 nt lds
    buffer_load_dwordx4 v31, s[24:27], s59 offen offset:1024 nt lds
    buffer_load_dwordx4 v32, s[24:27], s59 offen offset:2048 nt lds
    buffer_load_dwordx4 v33, s[24:27], s59 offen offset:3072 nt lds
    s_mov_b32 s43, -1
    s_branch L_join
L_vprod:
    s_mul_i32 s60, s3, 18432
    s_add_u32 m0, s60, 73728
    s_nop 0
    buffer_load_dwordx4 v16, s[64:67], s60 offen offset:0  lds
    buffer_load_dwordx4 v17, s[64:67], s60 offen offset:1024  lds
    buffer_load_dwordx4 v18, s[64:67], s60 offen offset:2048  lds
    buffer_load_dwordx4 v19, s[64:67], s60 offen offset:3072  lds
    s_add_u32 m0, s60, 77824
    s_nop 0
    buffer_load_dwordx4 v20, s[64:67], s60 offen offset:0  lds
    buffer_load_dwordx4 v21, s[64:67], s60 offen offset:1024  lds
    s_add_u32 s60, s60, 6144
    s_add_u32 m0, s60, 73728
    s_nop 0
    buffer_load_dwordx4 v16, s[64:67], s60 offen offset:0  lds
    buffer_load_dwordx4 v17, s[64:67], s60 offen offset:1024  lds
    buffer_load_dwordx4 v18, s[64:67], s60 offen offset:2048  lds
    buffer_load_dwordx4 v19, s[64:67], s60 offen offset:3072  lds
    s_add_u32 m0, s60, 77824
    s_nop 0
    buffer_load_dwordx4 v20, s[64:67], s60 offen offset:0  lds
    buffer_load_dwordx4 v21, s[64:67], s60 offen offset:1024  lds
    s_add_u32 s60, s60, 6144
    s_add_u32 m0, s60, 73728
    s_nop 0
    buffer_load_dwordx4 v16, s[64:67], s60 offen offset:0  lds
    v_lshrrev_b32 v1, 4, v0
    v_and_b32 v5, 1, v1
    v_bfe_u32 v2, v0, 2, 2
    v_lshl_add_u32 v3, v1, 3, v2
    buffer_load_dwordx4 v17, s[64:67], s60 offen offset:1024  lds
    v_mul_u32_u24 v3, 384, v3
    v_and_b32 v4, 1, v0
    v_lshl_add_u32 v3, v4, 3, v3
    v_add_u32 v3, 73728, v3
    buffer_load_dwordx4 v18, s[64:67], s60 offen offset:2048  lds
    v_and_or_b32 v2, v2, 2, v5
    v_bfe_u32 v4, v0, 1, 1
    v_xor_b32 v2, v2, v4
    s_mul_i32 s56, s3, 6
    buffer_load_dwordx4 v19, s[64:67], s60 offen offset:3072  lds
    s_add_u32 s57, s56, 0
    v_xor_b32 v4, s57, v2
    v_lshl_add_u32 v136, v4, 4, v3
    v_xor_b32 v137, 64, v136
    s_add_u32 m0, s60, 77824
    s_nop 0
    buffer_load_dwordx4 v20, s[64:67], s60 offen offset:0  lds
    s_add_u32 s57, s56, 2
    v_xor_b32 v4, s57, v2
    v_lshl_add_u32 v138, v4, 4, v3
    v_xor_b32 v139, 64, v138
    buffer_load_dwordx4 v21, s[64:67], s60 offen offset:1024  lds
    s_add_u32 s57, s56, 4
    v_xor_b32 v4, s57, v2
    v_lshl_add_u32 v140, v4, 4, v3
    v_xor_b32 v141, 64, v140
    s_lshl_b32 s61, s43, 2
    s_add_u32 s61, s61, s3
    s_mul_i32 s60, s61, 6144
    s_add_u32 m0, s41, 6144
    s_nop 0
    buffer_load_dwordx4 v16, s[68:71], s60 offen offset:0  lds
    v_bfe_u32 v1, v0, 2, 1
    v_and_b32 v2, 3, v0
    v_lshl_or_b32 v2, v1, 3, v2
    v_and_or_b32 v1, v0, 2, v1
    buffer_load_dwordx4 v17, s[68:71], s60 offen offset:1024  lds
    v_lshrrev_b32 v3, 4, v0
    v_xor_b32 v1, v1, v3
    v_mul_u32_u24 v2, 384, v2
    v_lshl_add_u32 v1, v1, 4, v2
    buffer_load_dwordx4 v18, s[68:71], s60 offen offset:2048  lds
    v_bfe_u32 v2, v0, 3, 1
    v_mul_u32_u24 v2, 12288, v2
    s_mov_b32 s56, 30720
    v_add3_u32 v142, s56, v1, v2
    buffer_load_dwordx4 v19, s[68:71], s60 offen offset:3072  lds
    v_xor_b32 v143, 64, v142
    s_add_u32 m0, s41, 10240
    s_nop 0
    buffer_load_dwordx4 v20, s[68:71], s60 offen offset:0  lds
    buffer_load_dwordx4 v21, s[68:71], s60 offen offset:1024  lds
    s_load_dword s38, s[22:23], 0
    s_barrier
    s_add_u32 m0, s40, 0
    s_add_u32 s57, s36, 0
    buffer_load_dwordx4 v16, s[28:31], s57 offen offset:0 nt lds
    buffer_load_dwordx4 v17, s[28:31], s57 offen offset:1024 nt lds
    buffer_load_dwordx4 v18, s[28:31], s57 offen offset:2048 nt lds
    buffer_load_dwordx4 v19, s[28:31], s57 offen offset:3072 nt lds
    s_add_u32 m0, s40, 4096
    s_nop 0
    buffer_load_dwordx4 v20, s[28:31], s57 offen offset:0 nt lds
    buffer_load_dwordx4 v21, s[28:31], s57 offen offset:1024 nt lds
    s_add_u32 m0, s41, 0
    s_add_u32 s58, s37, 0
    buffer_load_dwordx4 v22, s[24:27], s58 offen offset:0 nt lds
    buffer_load_dwordx4 v23, s[24:27], s58 offen offset:1024 nt lds
    buffer_load_dwordx4 v24, s[24:27], s58 offen offset:2048 nt lds
    s_waitcnt vmcnt(9)
    s_barrier
    ds_read_b128 a[96:99], v142 offset:0
    ds_read_b128 a[100:103], v143 offset:0
    ds_read_b128 a[104:107], v142 offset:128
    ds_read_b128 a[108:111], v143 offset:128
    ds_read_b128 a[112:115], v142 offset:256
    ds_read_b128 a[116:119], v143 offset:256
    ds_read_b128 a[120:123], v143 offset:1536
    ds_read_b128 a[124:127], v142 offset:1536
    ds_read_b128 a[128:131], v143 offset:1664
    ds_read_b128 a[132:135], v142 offset:1664
    ds_read_b128 a[136:139], v143 offset:1792
    ds_read_b128 a[140:143], v142 offset:1792
    ds_read_b128 a[144:147], v142 offset:24576
    ds_read_b128 a[148:151], v143 offset:24576
    ds_read_b128 a[152:155], v142 offset:24704
    ds_read_b128 a[156:159], v143 offset:24704
    ds_read_b128 a[160:163], v142 offset:24832
    ds_read_b128 a[164:167], v143 offset:24832
    ds_read_b128 a[168:171], v143 offset:26112
    ds_read_b128 a[172:175], v142 offset:26112
    ds_read_b128 a[176:179], v143 offset:26240
    ds_read_b128 a[180:183], v142 offset:26240
    ds_read_b128 a[184:187], v143 offset:26368
    ds_read_b128 a[188:191], v142 offset:26368
    ds_read_b64_tr_b16 v[160:161], v136 offset:0
    ds_read_b64_tr_b16 v[162:163], v137 offset:1536
    ds_read_b64_tr_b16 v[164:165], v136 offset:12288
    ds_read_b64_tr_b16 v[166:167], v137 offset:13824
    ds_read_b64_tr_b16 v[168:169], v136 offset:24576
    ds_read_b64_tr_b16 v[170:171], v137 offset:26112
    ds_read_b64_tr_b16 v[172:173], v136 offset:36864
    ds_read_b64_tr_b16 v[174:175], v137 offset:38400
    ds_read_b64_tr_b16 v[176:177], v136 offset:49152
    ds_read_b64_tr_b16 v[178:179], v137 offset:50688
    ds_read_b64_tr_b16 v[180:181], v136 offset:61440
    ds_read_b64_tr_b16 v[182:183], v137 offset:62976
    ds_read_b64_tr_b16 v[184:185], v138 offset:0
    ds_read_b64_tr_b16 v[186:187], v139 offset:1536
    ds_read_b64_tr_b16 v[188:189], v138 offset:12288
    ds_read_b64_tr_b16 v[190:191], v139 offset:13824
    ds_read_b64_tr_b16 v[192:193], v138 offset:24576
    ds_read_b64_tr_b16 v[194:195], v139 offset:26112
    ds_read_b64_tr_b16 v[196:197], v138 offset:36864
    ds_read_b64_tr_b16 v[198:199], v139 offset:38400
    ds_read_b64_tr_b16 v[200:201], v138 offset:49152
    ds_read_b64_tr_b16 v[202:203], v139 offset:50688
    ds_read_b64_tr_b16 v[204:205], v138 offset:61440
    ds_read_b64_tr_b16 v[206:207], v139 offset:62976
    ds_read_b64_tr_b16 v[208:209], v140 offset:0
    ds_read_b64_tr_b16 v[210:211], v141 offset:1536
    ds_read_b64_tr_b16 v[212:213], v140 offset:12288
    ds_read_b64_tr_b16 v[214:215], v141 offset:13824
    ds_read_b64_tr_b16 v[216:217], v140 offset:24576
    ds_read_b64_tr_b16 v[218:219], v141 offset:26112
    ds_read_b64_tr_b16 v[220:221], v140 offset:36864
    ds_read_b64_tr_b16 v[222:223], v141 offset:38400
    ds_read_b64_tr_b16 v[224:225], v140 offset:49152
    ds_read_b64_tr_b16 v[226:227], v141 offset:50688
    ds_read_b64_tr_b16 v[228:229], v140 offset:61440
    ds_read_b64_tr_b16 v[230:231], v141 offset:62976
    s_waitcnt lgkmcnt(0)
    s_barrier
    s_mul_i32 s60, s3, 18432
    s_lshl_b32 s61, s43, 11
    s_add_u32 s60, s60, s61
    s_add_u32 s60, s60, 3145728
    v_mfma_f32_16x16x32_bf16 v[88:91], a[96:99], v[160:163], 0
    v_mfma_f32_16x16x32_bf16 v[92:95], a[120:123], v[160:163], 0
    v_mfma_f32_16x16x32_bf16 v[96:99], a[144:147], v[160:163], 0
    v_mfma_f32_16x16x32_bf16 v[100:103], a[168:171], v[160:163], 0
    buffer_load_dwordx4 v25, s[24:27], s58 offen offset:3072 nt lds
    v_mfma_f32_16x16x32_bf16 v[88:91], a[100:103], v[164:167], v[88:91]
    v_mfma_f32_16x16x32_bf16 v[92:95], a[124:127], v[164:167], v[92:95]
    v_mfma_f32_16x16x32_bf16 v[96:99], a[148:151], v[164:167], v[96:99]
    v_mfma_f32_16x16x32_bf16 v[100:103], a[172:175], v[164:167], v[100:103]
    s_add_u32 m0, s41, 4096
    s_nop 0
    buffer_load_dwordx4 v26, s[24:27], s58 offen offset:0 nt lds
    v_mfma_f32_16x16x32_bf16 v[88:91], a[104:107], v[168:171], v[88:91]
    v_mfma_f32_16x16x32_bf16 v[92:95], a[128:131], v[168:171], v[92:95]
    v_mfma_f32_16x16x32_bf16 v[96:99], a[152:155], v[168:171], v[96:99]
    v_mfma_f32_16x16x32_bf16 v[100:103], a[176:179], v[168:171], v[100:103]
    buffer_load_dwordx4 v27, s[24:27], s58 offen offset:1024 nt lds
    v_mfma_f32_16x16x32_bf16 v[88:91], a[108:111], v[172:175], v[88:91]
    v_mfma_f32_16x16x32_bf16 v[92:95], a[132:135], v[172:175], v[92:95]
    v_mfma_f32_16x16x32_bf16 v[96:99], a[156:159], v[172:175], v[96:99]
    v_mfma_f32_16x16x32_bf16 v[100:103], a[180:183], v[172:175], v[100:103]
    buffer_load_dwordx4 v28, s[24:27], s58 offen offset:2048 nt lds
    v_mfma_f32_16x16x32_bf16 v[88:91], a[112:115], v[176:179], v[88:91]
    v_mfma_f32_16x16x32_bf16 v[92:95], a[136:139], v[176:179], v[92:95]
    v_mfma_f32_16x16x32_bf16 v[96:99], a[160:163], v[176:179], v[96:99]
    v_mfma_f32_16x16x32_bf16 v[100:103], a[184:187], v[176:179], v[100:103]
    buffer_load_dwordx4 v29, s[24:27], s58 offen offset:3072 nt lds
    v_mfma_f32_16x16x32_bf16 v[88:91], a[116:119], v[180:183], v[88:91]
    v_mfma_f32_16x16x32_bf16 v[92:95], a[140:143], v[180:183], v[92:95]
    v_mfma_f32_16x16x32_bf16 v[96:99], a[164:167], v[180:183], v[96:99]
    v_mfma_f32_16x16x32_bf16 v[100:103], a[188:191], v[180:183], v[100:103]
    v_mfma_f32_16x16x32_bf16 v[104:107], a[96:99], v[184:187], 0
    v_mfma_f32_16x16x32_bf16 v[108:111], a[120:123], v[184:187], 0
    v_mfma_f32_16x16x32_bf16 v[112:115], a[144:147], v[184:187], 0
    v_mfma_f32_16x16x32_bf16 v[116:119], a[168:171], v[184:187], 0
    s_add_u32 m0, s41, 8192
    s_nop 0
    buffer_load_dwordx4 v30, s[24:27], s58 offen offset:0 nt lds
    v_mfma_f32_16x16x32_bf16 v[104:107], a[100:103], v[188:191], v[104:107]
    v_mfma_f32_16x16x32_bf16 v[108:111], a[124:127], v[188:191], v[108:111]
    v_mfma_f32_16x16x32_bf16 v[112:115], a[148:151], v[188:191], v[112:115]
    v_mfma_f32_16x16x32_bf16 v[116:119], a[172:175], v[188:191], v[116:119]
    buffer_load_dwordx4 v31, s[24:27], s58 offen offset:1024 nt lds
    v_mfma_f32_16x16x32_bf16 v[104:107], a[104:107], v[192:195], v[104:107]
    v_mfma_f32_16x16x32_bf16 v[108:111], a[128:131], v[192:195], v[108:111]
    v_mfma_f32_16x16x32_bf16 v[112:115], a[152:155], v[192:195], v[112:115]
    v_mfma_f32_16x16x32_bf16 v[116:119], a[176:179], v[192:195], v[116:119]
    buffer_load_dwordx4 v32, s[24:27], s58 offen offset:2048 nt lds
    v_cvt_pk_bf16_f32 v144, v88, v89
    v_cvt_pk_bf16_f32 v145, v90, v91
    v_cvt_pk_bf16_f32 v146, v92, v93
    v_cvt_pk_bf16_f32 v147, v94, v95
    buffer_store_dwordx4 v[144:147], v65, s[32:35], s60 offen offset:0 sc1
    v_cvt_pk_bf16_f32 v148, v96, v97
    v_cvt_pk_bf16_f32 v149, v98, v99
    v_cvt_pk_bf16_f32 v150, v100, v101
    v_cvt_pk_bf16_f32 v151, v102, v103
    buffer_store_dwordx4 v[148:151], v65, s[32:35], s60 offen offset:1024 sc1
    s_add_u32 s60, s60, 6144
    v_mfma_f32_16x16x32_bf16 v[104:107], a[108:111], v[196:199], v[104:107]
    v_mfma_f32_16x16x32_bf16 v[108:111], a[132:135], v[196:199], v[108:111]
    v_mfma_f32_16x16x32_bf16 v[112:115], a[156:159], v[196:199], v[112:115]
    v_mfma_f32_16x16x32_bf16 v[116:119], a[180:183], v[196:199], v[116:119]
    buffer_load_dwordx4 v33, s[24:27], s58 offen offset:3072 nt lds
    v_mfma_f32_16x16x32_bf16 v[104:107], a[112:115], v[200:203], v[104:107]
    v_mfma_f32_16x16x32_bf16 v[108:111], a[136:139], v[200:203], v[108:111]
    v_mfma_f32_16x16x32_bf16 v[112:115], a[160:163], v[200:203], v[112:115]
    v_mfma_f32_16x16x32_bf16 v[116:119], a[184:187], v[200:203], v[116:119]
    s_add_u32 m0, s42, 0
    s_add_u32 s59, s37, 196608
    buffer_load_dwordx4 v22, s[24:27], s59 offen offset:0 nt lds
    v_mfma_f32_16x16x32_bf16 v[104:107], a[116:119], v[204:207], v[104:107]
    v_mfma_f32_16x16x32_bf16 v[108:111], a[140:143], v[204:207], v[108:111]
    v_mfma_f32_16x16x32_bf16 v[112:115], a[164:167], v[204:207], v[112:115]
    v_mfma_f32_16x16x32_bf16 v[116:119], a[188:191], v[204:207], v[116:119]
    v_mfma_f32_16x16x32_bf16 v[120:123], a[96:99], v[208:211], 0
    v_mfma_f32_16x16x32_bf16 v[124:127], a[120:123], v[208:211], 0
    v_mfma_f32_16x16x32_bf16 v[128:131], a[144:147], v[208:211], 0
    v_mfma_f32_16x16x32_bf16 v[132:135], a[168:171], v[208:211], 0
    buffer_load_dwordx4 v23, s[24:27], s59 offen offset:1024 nt lds
    v_mfma_f32_16x16x32_bf16 v[120:123], a[100:103], v[212:215], v[120:123]
    v_mfma_f32_16x16x32_bf16 v[124:127], a[124:127], v[212:215], v[124:127]
    v_mfma_f32_16x16x32_bf16 v[128:131], a[148:151], v[212:215], v[128:131]
    v_mfma_f32_16x16x32_bf16 v[132:135], a[172:175], v[212:215], v[132:135]
    buffer_load_dwordx4 v24, s[24:27], s59 offen offset:2048 nt lds
    v_mfma_f32_16x16x32_bf16 v[120:123], a[104:107], v[216:219], v[120:123]
    v_mfma_f32_16x16x32_bf16 v[124:127], a[128:131], v[216:219], v[124:127]
    v_mfma_f32_16x16x32_bf16 v[128:131], a[152:155], v[216:219], v[128:131]
    v_mfma_f32_16x16x32_bf16 v[132:135], a[176:179], v[216:219], v[132:135]
    buffer_load_dwordx4 v25, s[24:27], s59 offen offset:3072 nt lds
    v_cvt_pk_bf16_f32 v152, v104, v105
    v_cvt_pk_bf16_f32 v153, v106, v107
    v_cvt_pk_bf16_f32 v154, v108, v109
    v_cvt_pk_bf16_f32 v155, v110, v111
    buffer_store_dwordx4 v[152:155], v65, s[32:35], s60 offen offset:0 sc1
    v_cvt_pk_bf16_f32 v156, v112, v113
    v_cvt_pk_bf16_f32 v157, v114, v115
    v_cvt_pk_bf16_f32 v158, v116, v117
    v_cvt_pk_bf16_f32 v159, v118, v119
    buffer_store_dwordx4 v[156:159], v65, s[32:35], s60 offen offset:1024 sc1
    s_add_u32 s60, s60, 6144
    v_mfma_f32_16x16x32_bf16 v[120:123], a[108:111], v[220:223], v[120:123]
    v_mfma_f32_16x16x32_bf16 v[124:127], a[132:135], v[220:223], v[124:127]
    v_mfma_f32_16x16x32_bf16 v[128:131], a[156:159], v[220:223], v[128:131]
    v_mfma_f32_16x16x32_bf16 v[132:135], a[180:183], v[220:223], v[132:135]
    s_add_u32 m0, s42, 4096
    s_nop 0
    buffer_load_dwordx4 v26, s[24:27], s59 offen offset:0 nt lds
    v_mfma_f32_16x16x32_bf16 v[120:123], a[112:115], v[224:227], v[120:123]
    v_mfma_f32_16x16x32_bf16 v[124:127], a[136:139], v[224:227], v[124:127]
    v_mfma_f32_16x16x32_bf16 v[128:131], a[160:163], v[224:227], v[128:131]
    v_mfma_f32_16x16x32_bf16 v[132:135], a[184:187], v[224:227], v[132:135]
    buffer_load_dwordx4 v27, s[24:27], s59 offen offset:1024 nt lds
    v_mfma_f32_16x16x32_bf16 v[120:123], a[116:119], v[228:231], v[120:123]
    v_mfma_f32_16x16x32_bf16 v[124:127], a[140:143], v[228:231], v[124:127]
    v_mfma_f32_16x16x32_bf16 v[128:131], a[164:167], v[228:231], v[128:131]
    v_mfma_f32_16x16x32_bf16 v[132:135], a[188:191], v[228:231], v[132:135]
    s_nop 4
    v_cvt_pk_bf16_f32 v144, v120, v121
    v_cvt_pk_bf16_f32 v145, v122, v123
    v_cvt_pk_bf16_f32 v146, v124, v125
    v_cvt_pk_bf16_f32 v147, v126, v127
    buffer_store_dwordx4 v[144:147], v65, s[32:35], s60 offen offset:0 sc1
    v_cvt_pk_bf16_f32 v148, v128, v129
    v_cvt_pk_bf16_f32 v149, v130, v131
    v_cvt_pk_bf16_f32 v150, v132, v133
    v_cvt_pk_bf16_f32 v151, v134, v135
    buffer_store_dwordx4 v[148:151], v65, s[32:35], s60 offen offset:1024 sc1
    v_and_b32 v1, 15, v0
    v_lshrrev_b32 v6, 5, v0
    v_bfe_u32 v3, v0, 4, 1
    v_lshl_or_b32 v3, v3, 1, v6
    v_lshrrev_b32 v4, 2, v0
    v_bfe_u32 v5, v0, 1, 1
    v_lshrrev_b32 v6, 3, v1
    v_and_or_b32 v6, v1, 6, v6
    v_xor_b32 v6, v6, v3
    v_mul_u32_u24 v7, 384, v1
    v_lshl_add_u32 v6, v6, 4, v7
    v_add_u32 v34, s40, v6
    v_xor_b32 v35, 64, v34
    v_lshrrev_b32 v6, 3, v1
    v_and_b32 v7, 7, v1
    v_lshl_or_b32 v6, v7, 1, v6
    v_xor_b32 v6, v6, v3
    v_mul_u32_u24 v7, 768, v1
    v_lshl_add_u32 v6, v6, 4, v7
    v_add_u32 v40, s41, v6
    v_xor_b32 v41, 0x40, v40
    v_xor_b32 v42, 0x80, v40
    v_xor_b32 v43, 0xc0, v40
    v_and_b32 v2, 1, v0
    v_lshlrev_b32 v2, 3, v2
    s_mul_i32 s56, s3, 96
    v_lshrrev_b32 v6, 3, v4
    v_and_or_b32 v6, v4, 6, v6
    v_xor_b32 v6, v6, v5
    v_lshl_add_u32 v6, v6, 4, v2
    v_mul_u32_u24 v7, 384, v4
    s_add_u32 s57, s56, 0
    v_xad_u32 v36, v6, s57, v7
    s_add_u32 s57, s56, 32
    v_xad_u32 v37, v6, s57, v7
    s_add_u32 s57, s56, 64
    v_xad_u32 v38, v6, s57, v7
    v_lshrrev_b32 v6, 3, v4
    v_and_b32 v3, 7, v4
    v_lshl_or_b32 v6, v3, 1, v6
    v_xor_b32 v6, v6, v5
    v_lshl_add_u32 v6, v6, 4, v2
    v_lshlrev_b32 v7, 1, v7
    v_add_u32 v7, 24576, v7
    s_add_u32 s57, s56, 0
    v_xad_u32 v44, v6, s57, v7
    s_add_u32 s57, s56, 384
    v_xad_u32 v45, v6, s57, v7
    s_add_u32 s57, s56, 32
    v_xad_u32 v46, v6, s57, v7
    s_add_u32 s57, s56, 416
    v_xad_u32 v47, v6, s57, v7
    s_add_u32 s57, s56, 64
    v_xad_u32 v48, v6, s57, v7
    s_add_u32 s57, s56, 448
    v_xad_u32 v49, v6, s57, v7
    v_mov_b32 v52, 0x3f803f80
    v_mov_b32 v56, 0x3ebcbe62
    s_mov_b32 s44, 0x100001
    s_mov_b32 s45, 0x10000100
    v_mov_b32 v53, 0x3f803f80
    v_mov_b32 v57, 0x3ebcbe62
    s_mov_b32 s46, 0x200002
    s_mov_b32 s47, 0x20000200
    v_mov_b32 v54, 0x3f803f80
    v_mov_b32 v58, 0x3ebcbe62
    s_mov_b32 s48, 0x400004
    s_mov_b32 s49, 0x40000400
    v_mov_b32 v55, 0x3f803f80
    v_mov_b32 v59, 0x3ebcbe62
    s_mov_b32 s50, 0x800008
    s_mov_b32 s51, 0x80000800
    v_mov_b32 v60, 0x43400000
    v_lshrrev_b32 v1, 5, v0
    v_lshlrev_b32 v1, 8, v1
    v_and_b32 v2, 15, v0
    v_lshl_add_u32 v1, v2, 4, v1
    v_bfe_u32 v2, v0, 4, 1
    v_lshl_add_u32 v1, v2, 3, v1
    s_mul_i32 s56, s3, 1536
    s_add_u32 s56, s56, 147456
    v_add_u32 v236, s56, v1
    s_mul_i32 s56, s3, 3072
    s_add_u32 s56, s56, 24576
    v_add_u32 v237, s56, v65
    v_add_u32 v238, s41, v65
    s_lshl_b32 s56, s3, 10
    v_add_u32 v240, 159744, v65
    v_add_u32 v239, s56, v240
    v_add_u32 v241, 147456, v65
    v_bfe_u32 v1, v0, 2, 2
    v_lshrrev_b32 v2, 4, v0
    v_lshl_or_b32 v1, v1, 4, v2
    v_mul_u32_u24 v1, 65536, v1
    v_and_b32 v2, 3, v0
    v_lshl_or_b32 v242, v2, 5, v1
    v_xor_b32 v243, 0x70, v242
    s_mul_i32 s56, s3, 3
    v_min_u32 v1, 2, v0
    v_add_u32 v1, s56, v1
    v_min_u32 v2, 8, v0
    v_add_u32 v2, 9, v2
    v_cmp_gt_u32 vcc, 3, v0
    s_nop 1
    v_cndmask_b32 v1, v2, v1, vcc
    v_lshlrev_b32 v245, 7, v1
    v_lshlrev_b32 v1, 3, v0
    v_add_u32 v254, 126976, v1
    s_lshl_b32 s56, s3, 9
    v_add_u32 v238, s56, v254
    v_add_u32 v253, 122880, v65
    s_lshl_b32 s56, s3, 10
    v_add_u32 v237, s56, v253
    s_mov_b32 s52, 0x41c00000
    buffer_load_dwordx4 v28, s[24:27], s59 offen offset:2048 nt lds
    buffer_load_dwordx4 v29, s[24:27], s59 offen offset:3072 nt lds
    s_add_u32 m0, s42, 8192
    s_nop 0
    buffer_load_dwordx4 v30, s[24:27], s59 offen offset:0 nt lds
    buffer_load_dwordx4 v31, s[24:27], s59 offen offset:1024 nt lds
    buffer_load_dwordx4 v32, s[24:27], s59 offen offset:2048 nt lds
    buffer_load_dwordx4 v33, s[24:27], s59 offen offset:3072 nt lds
    s_branch L_join
L_xt3:
    s_call_b64 s[54:55], L_xslow
    s_branch L_post3
L_xt24:
    s_call_b64 s[54:55], L_xslow
    s_branch L_post24
L_xt6:
    s_call_b64 s[54:55], L_xslow
    s_branch L_post6
L_xt27:
    s_call_b64 s[54:55], L_xslow
    s_branch L_post27
L_xt9:
    s_call_b64 s[54:55], L_xslow
    s_branch L_post9
L_xt11:
    s_call_b64 s[54:55], L_xalt
    ds_read_b128 a[192:195], v253 offset:12288
    ds_read_b128 a[196:199], v253 offset:13312
    ds_read_b128 a[200:203], v253 offset:14336
    ds_read_b128 a[204:207], v253 offset:15360
    s_waitcnt lgkmcnt(0)
    s_branch L_post11
L_xslow:
    s_waitcnt lgkmcnt(0)
    ds_write_b32 v239, v62
    s_waitcnt lgkmcnt(0)
    s_barrier
    ds_read_b32 v12, v240 offset:0
    ds_read_b32 v13, v240 offset:1024
    ds_read_b32 v14, v240 offset:2048
    ds_read_b32 v15, v240 offset:3072
    v_mov_b32 v9, 0
    ds_write_b32 v254, v9 offset:4096
    s_waitcnt lgkmcnt(0)
    v_min3_f32 v1, v12, v13, v14
    v_min_f32 v1, v1, v15
    v_sub_f32 v2, v1, v255
    v_sub_f32 v12, v1, v62
    v_exp_f32 v2, v2
    v_exp_f32 v12, v12
    v_mov_b32 v62, v1
    v_mov_b32 v255, v1
    v_mul_f32 v88, v88, v12
    v_mul_f32 v89, v89, v12
    v_mul_f32 v90, v90, v12
    v_mul_f32 v91, v91, v12
    v_mul_f32 v104, v104, v12
    v_mul_f32 v105, v105, v12
    v_mul_f32 v106, v106, v12
    v_mul_f32 v107, v107, v12
    v_mul_f32 v68, v68, v12
    v_mul_f32 v69, v69, v12
    v_mul_f32 v70, v70, v12
    v_mul_f32 v71, v71, v12
    v_mul_f32 v112, v112, v12
    v_mul_f32 v113, v113, v12
    v_mul_f32 v114, v114, v12
    v_mul_f32 v115, v115, v12
    v_mul_f32 v63, v63, v12
    v_mul_f32 v64, v64, v12
    v_accvgpr_read_b32 v1, a0
    v_mul_f32 v1, v1, v2
    v_accvgpr_write_b32 a0, v1
    v_accvgpr_read_b32 v1, a1
    v_mul_f32 v1, v1, v2
    v_accvgpr_write_b32 a1, v1
    v_accvgpr_read_b32 v1, a2
    v_mul_f32 v1, v1, v2
    v_accvgpr_write_b32 a2, v1
    v_accvgpr_read_b32 v1, a3
    v_mul_f32 v1, v1, v2
    v_accvgpr_write_b32 a3, v1
    v_accvgpr_read_b32 v1, a4
    v_mul_f32 v1, v1, v2
    v_accvgpr_write_b32 a4, v1
    v_accvgpr_read_b32 v1, a5
    v_mul_f32 v1, v1, v2
    v_accvgpr_write_b32 a5, v1
    v_accvgpr_read_b32 v1, a6
    v_mul_f32 v1, v1, v2
    v_accvgpr_write_b32 a6, v1
    v_accvgpr_read_b32 v1, a7
    v_mul_f32 v1, v1, v2
    v_accvgpr_write_b32 a7, v1
    v_accvgpr_read_b32 v1, a8
    v_mul_f32 v1, v1, v2
    v_accvgpr_write_b32 a8, v1
    v_accvgpr_read_b32 v1, a9
    v_mul_f32 v1, v1, v2
    v_accvgpr_write_b32 a9, v1
    v_accvgpr_read_b32 v1, a10
    v_mul_f32 v1, v1, v2
    v_accvgpr_write_b32 a10, v1
    v_accvgpr_read_b32 v1, a11
    v_mul_f32 v1, v1, v2
    v_accvgpr_write_b32 a11, v1
    v_cvt_pk_bf16_f32 v72, v88, v89
    v_cvt_pk_bf16_f32 v73, v90, v91
    v_cvt_pk_bf16_f32 v74, v104, v105
    v_cvt_pk_bf16_f32 v75, v106, v107
    ds_write_b128 v237, v[72:75] offset:0
    v_cvt_pk_bf16_f32 v66, v68, v69
    v_cvt_pk_bf16_f32 v67, v70, v71
    ds_write_b64 v238, v[66:67]
    s_waitcnt lgkmcnt(0)
    s_barrier
    s_setpc_b64 s[54:55]
L_xlast:
    s_waitcnt lgkmcnt(0)
    ds_write_b32 v239, v62
    s_waitcnt lgkmcnt(0)
    s_barrier
    ds_read_b32 v12, v240 offset:0
    ds_read_b32 v13, v240 offset:1024
    ds_read_b32 v14, v240 offset:2048
    ds_read_b32 v15, v240 offset:3072
    v_mov_b32 v9, 0
    ds_write_b32 v254, v9 offset:4096
    s_waitcnt lgkmcnt(0)
    v_min3_f32 v1, v12, v13, v14
    v_min_f32 v1, v1, v15
    v_sub_f32 v2, v1, v255
    v_sub_f32 v12, v1, v62
    v_exp_f32 v2, v2
    v_exp_f32 v12, v12
    v_mov_b32 v62, v1
    v_mov_b32 v255, v1
    v_mul_f32 v88, v88, v12
    v_mul_f32 v89, v89, v12
    v_mul_f32 v90, v90, v12
    v_mul_f32 v91, v91, v12
    v_mul_f32 v104, v104, v12
    v_mul_f32 v105, v105, v12
    v_mul_f32 v106, v106, v12
    v_mul_f32 v107, v107, v12
    v_mul_f32 v68, v68, v12
    v_mul_f32 v69, v69, v12
    v_mul_f32 v70, v70, v12
    v_mul_f32 v71, v71, v12
    v_mul_f32 v10, v10, v12
    v_mul_f32 v11, v11, v12
    v_mul_f32 v16, v16, v2
    v_mul_f32 v17, v17, v2
    v_mul_f32 v18, v18, v2
    v_mul_f32 v19, v19, v2
    v_mul_f32 v20, v20, v2
    v_mul_f32 v21, v21, v2
    v_mul_f32 v22, v22, v2
    v_mul_f32 v23, v23, v2
    v_mul_f32 v24, v24, v2
    v_mul_f32 v25, v25, v2
    v_mul_f32 v26, v26, v2
    v_mul_f32 v27, v27, v2
    v_cvt_pk_bf16_f32 v72, v88, v89
    v_cvt_pk_bf16_f32 v73, v90, v91
    v_cvt_pk_bf16_f32 v74, v104, v105
    v_cvt_pk_bf16_f32 v75, v106, v107
    ds_write_b128 v237, v[72:75] offset:0
    v_cvt_pk_bf16_f32 v66, v68, v69
    v_cvt_pk_bf16_f32 v67, v70, v71
    ds_write_b64 v238, v[66:67]
    ds_write_b64 v238, v[10:11] offset:2048
    s_waitcnt lgkmcnt(0)
    s_barrier
    s_branch L_postx
L_xalt:
    s_waitcnt lgkmcnt(0)
    ds_write_b32 v239, v62
    s_waitcnt lgkmcnt(0)
    s_barrier
    ds_read_b32 v12, v240 offset:0
    ds_read_b32 v13, v240 offset:1024
    ds_read_b32 v14, v240 offset:2048
    ds_read_b32 v15, v240 offset:3072
    v_mov_b32 v9, 0
    ds_write_b32 v254, v9 offset:4100
    s_waitcnt lgkmcnt(0)
    v_min3_f32 v1, v12, v13, v14
    v_min_f32 v1, v1, v15
    v_sub_f32 v2, v1, v255
    v_sub_f32 v12, v1, v62
    v_exp_f32 v2, v2
    v_exp_f32 v12, v12
    v_mov_b32 v62, v1
    v_mov_b32 v255, v1
    v_mul_f32 v88, v88, v12
    v_mul_f32 v89, v89, v12
    v_mul_f32 v90, v90, v12
    v_mul_f32 v91, v91, v12
    v_mul_f32 v104, v104, v12
    v_mul_f32 v105, v105, v12
    v_mul_f32 v106, v106, v12
    v_mul_f32 v107, v107, v12
    v_mul_f32 v68, v68, v12
    v_mul_f32 v69, v69, v12
    v_mul_f32 v70, v70, v12
    v_mul_f32 v71, v71, v12
    v_mul_f32 v112, v112, v12
    v_mul_f32 v113, v113, v12
    v_mul_f32 v114, v114, v12
    v_mul_f32 v115, v115, v12
    v_mul_f32 v63, v63, v12
    v_mul_f32 v64, v64, v12
    v_mul_f32 v16, v16, v2
    v_mul_f32 v17, v17, v2
    v_mul_f32 v18, v18, v2
    v_mul_f32 v19, v19, v2
    v_mul_f32 v20, v20, v2
    v_mul_f32 v21, v21, v2
    v_mul_f32 v22, v22, v2
    v_mul_f32 v23, v23, v2
    v_mul_f32 v24, v24, v2
    v_mul_f32 v25, v25, v2
    v_mul_f32 v26, v26, v2
    v_mul_f32 v27, v27, v2
    v_cvt_pk_bf16_f32 v72, v88, v89
    v_cvt_pk_bf16_f32 v73, v90, v91
    v_cvt_pk_bf16_f32 v74, v104, v105
    v_cvt_pk_bf16_f32 v75, v106, v107
    ds_write_b128 v237, v[72:75] offset:12288
    s_waitcnt lgkmcnt(0)
    s_barrier
    s_setpc_b64 s[54:55]
L_c_slow:
    s_cmp_eq_u32 s43, 0
    s_cbranch_scc1 L_c_out
    s_mov_b32 s43, 0
    buffer_load_dwordx4 v[76:79], v29, s[32:35], s30 offen offset:0 sc1
    buffer_load_dwordx4 v[80:83], v29, s[32:35], s30 offen offset:2048 sc1
    buffer_load_dwordx4 v[84:87], v29, s[32:35], s31 offen offset:0 sc1
    buffer_load_dwordx4 v[108:111], v29, s[32:35], s31 offen offset:2048 sc1
    s_waitcnt vmcnt(0)
    v_sub_u32 v49, v79, v247
    v_max_f32 v42, v42, v49
    v_sub_u32 v49, v83, v247
    v_max_f32 v42, v42, v49
    v_sub_u32 v49, v87, v247
    v_max_f32 v42, v42, v49
    v_sub_u32 v49, v111, v247
    v_max_f32 v42, v42, v49
    s_nop 1
    v_max_f32_dpp v42, v42, v42 row_ror:8 row_mask:0xf bank_mask:0xf
    v_mov_b32 v48, v42
    s_nop 1
    v_max_f32_dpp v42, v48, v48 row_shr:4 row_mask:0xf bank_mask:0xa
    s_nop 1
    v_max_f32_dpp v42, v48, v48 row_shl:4 row_mask:0xf bank_mask:0x5
    v_mov_b32 v48, v42
    s_nop 1
    v_permlane32_swap_b32 v42, v48
    v_max_f32 v42, v42, v48
    v_mov_b32 v48, v42
    s_nop 1
    v_permlane16_swap_b32 v42, v48
    v_max_f32 v42, v42, v48
    s_lshl_b32 s56, s3, 2
    v_add_u32 v48, s56, v251
    ds_write_b32 v48, v42 offset:1024
    s_waitcnt lgkmcnt(0)
    s_barrier
    ds_read_b128 v[48:51], v251 offset:1024
    v_mov_b32 v16, 0
    v_mov_b32 v17, 0
    v_mov_b32 v18, 0
    v_mov_b32 v19, 0
    v_mov_b32 v20, 0
    v_mov_b32 v21, 0
    v_mov_b32 v22, 0
    s_waitcnt lgkmcnt(0)
    v_max3_f32 v42, v48, v49, v50
    v_max_f32 v42, v42, v51
    v_sub_u32 v49, v79, v247
    v_sub_f32 v49, v49, v42
    v_exp_f32 v49, v49
    s_nop 0
    v_cvt_pk_bf16_f32 v49, v49, 0
    v_lshlrev_b32 v50, 16, v49
    v_dot2_f32_bf16 v16, v76, v49, v16
    v_dot2_f32_bf16 v18, v77, v49, v18
    v_dot2_f32_bf16 v20, v78, v49, v20
    v_add_f32 v22, v22, v50
    v_dot2_f32_bf16 v17, v76, v50, v17
    v_dot2_f32_bf16 v19, v77, v50, v19
    v_dot2_f32_bf16 v21, v78, v50, v21
    v_sub_u32 v49, v83, v247
    v_sub_f32 v49, v49, v42
    v_exp_f32 v49, v49
    s_nop 0
    v_cvt_pk_bf16_f32 v49, v49, 0
    v_lshlrev_b32 v50, 16, v49
    v_dot2_f32_bf16 v16, v80, v49, v16
    v_dot2_f32_bf16 v18, v81, v49, v18
    v_dot2_f32_bf16 v20, v82, v49, v20
    v_add_f32 v22, v22, v50
    v_dot2_f32_bf16 v17, v80, v50, v17
    v_dot2_f32_bf16 v19, v81, v50, v19
    v_dot2_f32_bf16 v21, v82, v50, v21
    v_sub_u32 v49, v87, v247
    v_sub_f32 v49, v49, v42
    v_exp_f32 v49, v49
    s_nop 0
    v_cvt_pk_bf16_f32 v49, v49, 0
    v_lshlrev_b32 v50, 16, v49
    v_dot2_f32_bf16 v16, v84, v49, v16
    v_dot2_f32_bf16 v18, v85, v49, v18
    v_dot2_f32_bf16 v20, v86, v49, v20
    v_add_f32 v22, v22, v50
    v_dot2_f32_bf16 v17, v84, v50, v17
    v_dot2_f32_bf16 v19, v85, v50, v19
    v_dot2_f32_bf16 v21, v86, v50, v21
    v_sub_u32 v49, v111, v247
    v_sub_f32 v49, v49, v42
    v_exp_f32 v49, v49
    s_nop 0
    v_cvt_pk_bf16_f32 v49, v49, 0
    v_lshlrev_b32 v50, 16, v49
    v_dot2_f32_bf16 v16, v108, v49, v16
    v_dot2_f32_bf16 v18, v109, v49, v18
    v_dot2_f32_bf16 v20, v110, v49, v20
    v_add_f32 v22, v22, v50
    v_dot2_f32_bf16 v17, v108, v50, v17
    v_dot2_f32_bf16 v19, v109, v50, v19
    v_dot2_f32_bf16 v21, v110, v50, v21
    s_nop 2
    s_branch L_c_red
L_qk_retry:
    s_mov_b32 s53, 0
L_qk_again:
    s_mul_i32 s56, s3, 3072
    s_add_u32 s56, s56, 16384
    buffer_load_dwordx4 v[136:139], v65, s[32:35], s56 offen offset:0 sc1
    buffer_load_dwordx4 v[140:143], v65, s[32:35], s56 offen offset:1024 sc1
    buffer_load_dwordx4 v[144:147], v65, s[32:35], s56 offen offset:2048 sc1
    s_add_u32 s53, s53, 1
    s_waitcnt vmcnt(0)
    v_xor_b32 v1, s39, v138
    v_xor_b32 v2, s39, v142
    v_xor_b32 v3, s39, v146
    v_or3_b32 v1, v1, v2, v3
    v_cmp_ne_u32 vcc, 0, v1
    s_cbranch_vccz L_qk_ok
    s_cmp_lt_u32 s53, 65536
    s_cbranch_scc1 L_qk_again
    s_branch L_qk_ok
L_fl_retry:
    s_mov_b32 s53, 0
L_fl_again:
    buffer_load_dwordx2 v[234:235], v245, s[32:35], 0 offen offset:128 sc1
    s_add_u32 s53, s53, 1
    s_waitcnt vmcnt(0)
    v_cmp_ne_u32 vcc, s39, v234
    s_cbranch_vccz L_fl_ok
    s_cmp_lt_u32 s53, 65536
    s_cbranch_scc1 L_fl_again
    s_branch L_fl_ok
L_site0:
    s_call_b64 s[54:55], L_rare2
    s_branch L_back0
L_site1:
    s_call_b64 s[54:55], L_rare3
    s_branch L_back1
L_site2:
    s_call_b64 s[54:55], L_rare2
    s_branch L_back2
L_site3:
    s_call_b64 s[54:55], L_rare3
    s_branch L_back3
L_site4:
    s_call_b64 s[54:55], L_rare2
    s_branch L_back4
L_site5:
    s_call_b64 s[54:55], L_rare3
    s_branch L_back5
L_site6:
    s_call_b64 s[54:55], L_rare2
    s_branch L_back6
L_site7:
    s_call_b64 s[54:55], L_rare3
    s_branch L_back7
L_site8:
    s_call_b64 s[54:55], L_rare2
    s_branch L_back8
L_site9:
    s_call_b64 s[54:55], L_rare3
    s_branch L_back9
L_site10:
    s_call_b64 s[54:55], L_rare6
    s_branch L_back10
L_site11:
    s_call_b64 s[54:55], L_rare7
    s_branch L_back11
L_site12:
    s_call_b64 s[54:55], L_rare2
    s_branch L_back12
L_site13:
    s_call_b64 s[54:55], L_rare5
    s_branch L_back13
L_rare2:
    s_nop 7
    s_nop 7
    v_mov_b32 v2, v1
    s_nop 1
    v_permlane32_swap_b32 v1, v2
    v_max_f32 v1, v1, v2
    v_mov_b32 v2, v1
    s_nop 1
    v_permlane16_swap_b32 v1, v2
    v_max_f32 v1, v1, v2
    v_max_f32 v1, 0, v1
    v_sub_f32 v62, v62, v1
    v_sub_f32 v88, v88, v1
    v_sub_f32 v89, v89, v1
    v_sub_f32 v90, v90, v1
    v_sub_f32 v91, v91, v1
    v_sub_f32 v1, 0, v1
    v_exp_f32 v1, v1
    s_nop 0
    v_mul_f32 v63, v63, v1
    v_mul_f32 v64, v64, v1
    v_mul_f32 v68, v68, v1
    v_mul_f32 v69, v69, v1
    v_mul_f32 v70, v70, v1
    v_mul_f32 v71, v71, v1
    v_mov_b32 v2, 1
    ds_write_b32 v254, v2 offset:4096
    s_waitcnt lgkmcnt(0)
    s_nop 3
    s_setpc_b64 s[54:55]
L_rare3:
    s_nop 7
    s_nop 7
    v_mov_b32 v2, v1
    s_nop 1
    v_permlane32_swap_b32 v1, v2
    v_max_f32 v1, v1, v2
    v_mov_b32 v2, v1
    s_nop 1
    v_permlane16_swap_b32 v1, v2
    v_max_f32 v1, v1, v2
    v_max_f32 v1, 0, v1
    v_sub_f32 v62, v62, v1
    v_sub_f32 v104, v104, v1
    v_sub_f32 v105, v105, v1
    v_sub_f32 v106, v106, v1
    v_sub_f32 v107, v107, v1
    v_sub_f32 v1, 0, v1
    v_exp_f32 v1, v1
    s_nop 0
    v_mul_f32 v63, v63, v1
    v_mul_f32 v64, v64, v1
    v_mul_f32 v68, v68, v1
    v_mul_f32 v69, v69, v1
    v_mul_f32 v70, v70, v1
    v_mul_f32 v71, v71, v1
    v_mul_f32 v88, v88, v1
    v_mul_f32 v89, v89, v1
    v_mul_f32 v90, v90, v1
    v_mul_f32 v91, v91, v1
    v_mov_b32 v2, 1
    ds_write_b32 v254, v2 offset:4096
    s_waitcnt lgkmcnt(0)
    s_nop 3
    s_setpc_b64 s[54:55]
L_rare5:
    s_nop 7
    s_nop 7
    v_mov_b32 v2, v1
    s_nop 1
    v_permlane32_swap_b32 v1, v2
    v_max_f32 v1, v1, v2
    v_mov_b32 v2, v1
    s_nop 1
    v_permlane16_swap_b32 v1, v2
    v_max_f32 v1, v1, v2
    v_max_f32 v1, 0, v1
    v_sub_f32 v62, v62, v1
    v_sub_f32 v104, v104, v1
    v_sub_f32 v105, v105, v1
    v_sub_f32 v106, v106, v1
    v_sub_f32 v107, v107, v1
    v_sub_f32 v1, 0, v1
    v_exp_f32 v1, v1
    s_nop 0
    v_mul_f32 v63, v63, v1
    v_mul_f32 v64, v64, v1
    v_mul_f32 v68, v68, v1
    v_mul_f32 v69, v69, v1
    v_mul_f32 v70, v70, v1
    v_mul_f32 v71, v71, v1
    v_mul_f32 v88, v88, v1
    v_mul_f32 v89, v89, v1
    v_mul_f32 v90, v90, v1
    v_mul_f32 v91, v91, v1
    v_cvt_pk_bf16_f32 v72, v88, v89
    v_cvt_pk_bf16_f32 v73, v90, v91
    v_mov_b32 v2, 1
    ds_write_b32 v254, v2 offset:4096
    s_waitcnt lgkmcnt(0)
    s_nop 3
    s_setpc_b64 s[54:55]
L_rare6:
    s_nop 7
    s_nop 7
    v_mov_b32 v2, v1
    s_nop 1
    v_permlane32_swap_b32 v1, v2
    v_max_f32 v1, v1, v2
    v_mov_b32 v2, v1
    s_nop 1
    v_permlane16_swap_b32 v1, v2
    v_max_f32 v1, v1, v2
    v_max_f32 v1, 0, v1
    v_sub_f32 v62, v62, v1
    v_sub_f32 v88, v88, v1
    v_sub_f32 v89, v89, v1
    v_sub_f32 v90, v90, v1
    v_sub_f32 v91, v91, v1
    v_sub_f32 v1, 0, v1
    v_exp_f32 v1, v1
    s_nop 0
    v_mul_f32 v63, v63, v1
    v_mul_f32 v64, v64, v1
    v_mul_f32 v68, v68, v1
    v_mul_f32 v69, v69, v1
    v_mul_f32 v70, v70, v1
    v_mul_f32 v71, v71, v1
    v_mov_b32 v2, 1
    ds_write_b32 v254, v2 offset:4100
    s_waitcnt lgkmcnt(0)
    s_nop 3
    s_setpc_b64 s[54:55]
L_rare7:
    s_nop 7
    s_nop 7
    v_mov_b32 v2, v1
    s_nop 1
    v_permlane32_swap_b32 v1, v2
    v_max_f32 v1, v1, v2
    v_mov_b32 v2, v1
    s_nop 1
    v_permlane16_swap_b32 v1, v2
    v_max_f32 v1, v1, v2
    v_max_f32 v1, 0, v1
    v_sub_f32 v62, v62, v1
    v_sub_f32 v104, v104, v1
    v_sub_f32 v105, v105, v1
    v_sub_f32 v106, v106, v1
    v_sub_f32 v107, v107, v1
    v_sub_f32 v1, 0, v1
    v_exp_f32 v1, v1
    s_nop 0
    v_mul_f32 v63, v63, v1
    v_mul_f32 v64, v64, v1
    v_mul_f32 v68, v68, v1
    v_mul_f32 v69, v69, v1
    v_mul_f32 v70, v70, v1
    v_mul_f32 v71, v71, v1
    v_mul_f32 v88, v88, v1
    v_mul_f32 v89, v89, v1
    v_mul_f32 v90, v90, v1
    v_mul_f32 v91, v91, v1
    v_mov_b32 v2, 1
    ds_write_b32 v254, v2 offset:4100
    s_waitcnt lgkmcnt(0)
    s_nop 3
    s_setpc_b64 s[54:55]
L_codeend:
.section .rodata,"a"
.p2align 6
.amdhsa_kernel standalone__detection_seg_dino__vision_kernel
  .amdhsa_next_free_vgpr 464
  .amdhsa_next_free_sgpr 102
  .amdhsa_accum_offset 256
  .amdhsa_group_segment_fixed_size 0
  .amdhsa_kernarg_size 80
  .amdhsa_user_sgpr_count 2
  .amdhsa_user_sgpr_kernarg_segment_ptr 1
  .amdhsa_system_sgpr_workgroup_id_x 1
  .amdhsa_float_denorm_mode_32 3
.end_amdhsa_kernel
```

```asm
; @launch grid=(256,1,1) block=(256,1,1) lds=163840
.amdgcn_target "amdgcn-amd-amdhsa--gfx950"
.text
.globl standalone__detection_seg_dino__vision_kernel
.p2align 8
.type standalone__detection_seg_dino__vision_kernel,@function
standalone__detection_seg_dino__vision_kernel:
    s_cmp_ge_u32 s2, 256
    s_cbranch_scc1 L_end
    s_load_dwordx16 s[4:19], s[0:1], 0
    s_load_dwordx4 s[20:23], s[0:1], 64
    s_memrealtime s[44:45]
    s_getpc_b64 s[54:55]
L_pc_main:
    v_lshlrev_b32 v233, 7, v0
    v_min_u32 v233, L_codeend - L_pc_main - 4, v233
    global_load_dword v232, v233, s[54:55]
    s_mov_b64 s[100:101], s[54:55]
    v_lshrrev_b32 v1, 6, v0
    v_and_b32 v0, 63, v0
    v_readfirstlane_b32 s3, v1
    v_lshlrev_b32 v65, 4, v0
    v_lshrrev_b32 v1, 2, v0
    v_and_b32 v1, 14, v1
    s_mov_b32 s56, 0x5000
    v_bfe_u32 v2, s56, v1, 2
    v_lshlrev_b32 v2, 5, v2
    v_xor_b32 v16, v65, v2
    s_mov_b32 s56, 0xaa55
    v_bfe_u32 v2, s56, v1, 2
    v_lshlrev_b32 v2, 5, v2
    v_xor_b32 v17, v65, v2
    s_mov_b32 s56, 0xfffa
    v_bfe_u32 v2, s56, v1, 2
    v_lshlrev_b32 v2, 5, v2
    v_xor_b32 v18, v65, v2
    v_xor_b32 v19, 16, v16
    v_xor_b32 v20, 0x1010, v17
    v_xor_b32 v21, 0x1010, v18
    v_lshrrev_b32 v1, 3, v0
    v_and_b32 v1, 6, v1
    s_mov_b32 s56, 0x40
    v_bfe_u32 v2, s56, v1, 2
    v_lshlrev_b32 v2, 5, v2
    v_xor_b32 v22, v65, v2
    s_mov_b32 s56, 0xa5
    v_bfe_u32 v2, s56, v1, 2
    v_lshlrev_b32 v2, 5, v2
    v_xor_b32 v23, v65, v2
    s_mov_b32 s56, 0xfe
    v_bfe_u32 v2, s56, v1, 2
    v_lshlrev_b32 v2, 5, v2
    v_xor_b32 v24, v65, v2
    v_xor_b32 v25, 0x80, v22
    v_xor_b32 v26, 0x1080, v23
    v_xor_b32 v27, 0x1080, v24
    v_xor_b32 v28, 0x1010, v22
    v_xor_b32 v29, 0x1010, v23
    v_xor_b32 v30, 0x2010, v24
    v_xor_b32 v31, 0x2090, v22
    v_xor_b32 v32, 0x2090, v23
    v_xor_b32 v33, 0x2090, v24
    v_mov_b32 v248, 0x10000
    s_mul_i32 s36, s3, 6144
    s_mul_i32 s37, s3, 12288
    s_add_u32 s40, s36, 0
    s_add_u32 s41, s37, 24576
    s_add_u32 s42, s37, 73728
    s_and_b32 s58, s2, 7
    s_lshr_b32 s57, s2, 3
    s_lshl_b32 s58, s58, 5
    s_add_u32 s58, s58, s57
    s_lshr_b32 s56, s58, 2
    s_mul_i32 s56, s56, 196608
    s_mul_i32 s57, s58, 24576
    s_lshl1_add_u32 s56, s57, s56
    s_mov_b64 s[60:61], s[56:57]
    s_and_b32 s98, s2, 7
    s_cmp_lt_u32 s2, 48
    s_cselect_b32 s98, s98, 0
    s_mov_b32 s30, 18898944
    s_mov_b32 s31, 0x20000
    s_mov_b32 s26, 75743232
    s_mov_b32 s27, 0x20000
    s_mov_b32 s34, 16777216
    s_mov_b32 s35, 0x20000
    s_mov_b32 m0, s40
    s_and_b32 s56, s2, 7
    s_cmp_eq_u32 s56, 2
    s_cbranch_scc1 L_spec
    s_and_b32 s56, s2, 7
    s_cbranch_scc1 L_plain
L_spec:
    s_waitcnt lgkmcnt(0)
    s_add_u32 s28, s8, s61
    s_addc_u32 s29, s9, 0
    s_add_u32 s24, s6, s60
    s_addc_u32 s25, s7, 0
    s_mov_b64 s[32:33], s[22:23]
    s_lshr_b32 s43, s2, 3
    s_mul_i32 s57, s43, 2304
    v_min_u32 v1, 17, v0
    v_lshlrev_b32 v1, 7, v1
    s_mov_b32 s66, 73728
    s_mov_b32 s67, 0x20000
    s_mov_b32 s70, 73728
    s_mov_b32 s71, 0x20000
    s_mov_b32 s72, s4
    s_mov_b32 s73, s5
    s_mov_b32 s74, 6144
    s_mov_b32 s75, 0x20000
    s_bitcmp1_b32 s2, 1
    s_cselect_b64 s[64:65], s[16:17], s[10:11]
    s_cselect_b64 s[68:69], s[14:15], s[12:13]
    s_cmp_eq_u32 s3, 0
    s_cbranch_scc1 L_pf0
    s_cmp_eq_u32 s3, 1
    s_cbranch_scc0 L_pfdone
    s_lshl_b32 s58, s43, 8
    buffer_load_dword v234, v1, s[68:71], s57 offen
    v_min_u32 v2, 128, v1
    buffer_load_dword v235, v2, s[72:75], s58 offen
    s_branch L_pfdone
L_pf0:
    buffer_load_dword v234, v1, s[64:67], s57 offen
L_pfdone:
    s_cmp_ge_u32 s43, 3
    s_cbranch_scc1 L_nopf
    s_mov_b32 s0, 1
    s_bitcmp1_b32 s2, 1
    s_cbranch_scc0 L_prod
    s_branch L_vprod
L_plain:
    s_waitcnt lgkmcnt(0)
    s_cmp_eq_u32 s98, 1
    s_cbranch_scc0 L_nopf
    s_lshl2_add_u32 s20, s2, s3
    s_lshl4_add_u32 s20, s20, s44
    s_mul_i32 s20, s20, 0x9e3779b1
    s_lshr_b32 s20, s20, 11
    s_and_b32 s20, s20, 0x1fdf80
    s_bfe_u32 s56, s2, 0x10003
    s_lshl_b32 s56, s56, 13
    s_add_u32 s56, s56, 6291456
    s_add_u32 s56, s56, s20
    s_load_dword s38, s[22:23], s56
    s_memtime s[20:21]
L_nopf:
    s_add_u32 s28, s8, s61
    s_addc_u32 s29, s9, 0
    buffer_load_dwordx4 v16, s[28:31], s36 offen offset:0 nt lds
    s_add_u32 s24, s6, s60
    s_addc_u32 s25, s7, 0
    s_mov_b64 s[32:33], s[22:23]
    s_mov_b32 s0, 0
    buffer_load_dwordx4 v17, s[28:31], s36 offen offset:1024 nt lds
    buffer_load_dwordx4 v18, s[28:31], s36 offen offset:2048 nt lds
    buffer_load_dwordx4 v19, s[28:31], s36 offen offset:3072 nt lds
    s_add_u32 m0, s40, 4096
    s_nop 0
    buffer_load_dwordx4 v20, s[28:31], s36 offen offset:0 nt lds
    buffer_load_dwordx4 v21, s[28:31], s36 offen offset:1024 nt lds
    s_mov_b32 s43, -1
    s_sub_u32 s59, s2, 64
    s_lshr_b32 s59, s59, 4
    s_and_b32 s56, s2, 7
    s_lshl3_add_u32 s59, s59, s56
    s_cmp_ge_u32 s59, 64
    s_cbranch_scc1 L_nocs
    s_mov_b32 s64, s4
    s_mov_b32 s65, s5
    s_mov_b32 s66, 6144
    s_mov_b32 s67, 0x20000
    s_mov_b32 s68, s18
    s_mov_b32 s69, s19
    s_mov_b32 s70, 6144
    s_mov_b32 s71, 0x20000
    v_and_b32 v1, 1, v0
    v_bfe_u32 v2, v0, 1, 1
    s_bfe_u32 s57, s2, 0x10003
    s_lshr_b32 s56, s59, 4
    s_lshl2_add_u32 s56, s56, s57
    s_add_u32 s56, s56, s57
    v_add_u32 v2, s56, v2
    v_lshlrev_b32 v252, 2, v2
    v_lshrrev_b32 v3, 4, v0
    v_mad_u32_u24 v3, v1, 3, v3
    v_lshrrev_b32 v4, 1, v3
    v_and_b32 v3, 1, v3
    v_lshlrev_b32 v3, 2, v3
    v_lshl_add_u32 v3, v4, 5, v3
    v_bfe_u32 v4, v0, 3, 1
    v_lshl_add_u32 v3, v4, 1, v3
    v_mul_u32_u24 v2, 384, v2
    s_bfe_u32 s56, s59, 0x20002
    s_mul_i32 s56, s56, 96
    s_and_b32 s57, s59, 3
    s_lshl_b32 s57, s57, 3
    s_add_u32 s56, s56, s57
    v_add3_u32 v248, s56, v2, v3
    v_and_b32 v3, 4, v0
    v_cmp_eq_u32 vcc, 4, v3
    s_nop 1
    v_cndmask_b32 v3, 63, v0, vcc
    v_cmp_gt_u32 vcc, 48, v3
    v_mov_b32 v4, 0x10000
    s_lshl_b32 s56, s3, 2
    v_cndmask_b32 v248, v4, v248, vcc
    buffer_load_ushort v249, v248, s[64:67], 0 offen
    s_xor_b32 s59, s2, 64
    s_or_b32 s57, s59, s3
    s_cselect_b32 s70, 0, 6144
    v_lshlrev_b32 v4, 7, v0
    buffer_load_ushort v246, v4, s[68:71], 0 offen
    v_add_u32 v250, s56, v65
    v_and_b32 v251, 0x70, v65
L_nocs:
    s_cmp_eq_u32 s98, 1
    s_cbranch_scc0 L_noprobe
    s_waitcnt lgkmcnt(0)
    s_memtime s[54:55]
    s_waitcnt lgkmcnt(0)
    s_sub_u32 s20, s54, s20
    s_add_u32 s98, s3, 1
L_noprobe:
    s_load_dword s38, s[22:23], 0
    v_and_b32 v1, 15, v0
    v_lshrrev_b32 v6, 5, v0
    v_bfe_u32 v3, v0, 4, 1
    v_lshl_or_b32 v3, v3, 1, v6
    v_lshrrev_b32 v4, 2, v0
    v_bfe_u32 v5, v0, 1, 1
    v_lshrrev_b32 v6, 3, v1
    v_and_or_b32 v6, v1, 6, v6
    v_xor_b32 v6, v6, v3
    v_mul_u32_u24 v7, 384, v1
    v_lshl_add_u32 v6, v6, 4, v7
    v_add_u32 v34, s40, v6
    v_xor_b32 v35, 64, v34
    v_lshrrev_b32 v6, 3, v1
    v_and_b32 v7, 7, v1
    v_lshl_or_b32 v6, v7, 1, v6
    v_xor_b32 v6, v6, v3
    v_mul_u32_u24 v7, 768, v1
    v_lshl_add_u32 v6, v6, 4, v7
    v_add_u32 v40, s41, v6
    v_xor_b32 v41, 0x40, v40
    v_xor_b32 v42, 0x80, v40
    v_xor_b32 v43, 0xc0, v40
    v_and_b32 v2, 1, v0
    v_lshlrev_b32 v2, 3, v2
    s_mul_i32 s56, s3, 96
    v_lshrrev_b32 v6, 3, v4
    v_and_or_b32 v6, v4, 6, v6
    v_xor_b32 v6, v6, v5
    v_lshl_add_u32 v6, v6, 4, v2
    v_mul_u32_u24 v7, 384, v4
    s_add_u32 s57, s56, 0
    v_xad_u32 v36, v6, s57, v7
    s_add_u32 s57, s56, 32
    v_xad_u32 v37, v6, s57, v7
    s_add_u32 s57, s56, 64
    v_xad_u32 v38, v6, s57, v7
    v_lshrrev_b32 v6, 3, v4
    v_and_b32 v3, 7, v4
    v_lshl_or_b32 v6, v3, 1, v6
    v_xor_b32 v6, v6, v5
    v_lshl_add_u32 v6, v6, 4, v2
    v_lshlrev_b32 v7, 1, v7
    v_add_u32 v7, 24576, v7
    s_add_u32 s57, s56, 0
    v_xad_u32 v44, v6, s57, v7
    s_add_u32 s57, s56, 384
    v_xad_u32 v45, v6, s57, v7
    s_add_u32 s57, s56, 32
    v_xad_u32 v46, v6, s57, v7
    s_add_u32 s57, s56, 416
    v_xad_u32 v47, v6, s57, v7
    s_add_u32 s57, s56, 64
    v_xad_u32 v48, v6, s57, v7
    s_add_u32 s57, s56, 448
    v_xad_u32 v49, v6, s57, v7
    v_mov_b32 v52, 0x3f803f80
    v_mov_b32 v56, 0x3ebcbe62
    s_mov_b32 s44, 0x100001
    s_mov_b32 s45, 0x10000100
    v_mov_b32 v53, 0x3f803f80
    v_mov_b32 v57, 0x3ebcbe62
    s_mov_b32 s46, 0x200002
    s_mov_b32 s47, 0x20000200
    v_mov_b32 v54, 0x3f803f80
    v_mov_b32 v58, 0x3ebcbe62
    s_mov_b32 s48, 0x400004
    s_mov_b32 s49, 0x40000400
    v_mov_b32 v55, 0x3f803f80
    v_mov_b32 v59, 0x3ebcbe62
    s_mov_b32 s50, 0x800008
    s_mov_b32 s51, 0x80000800
    v_mov_b32 v60, 0x43400000
    v_lshrrev_b32 v1, 5, v0
    v_lshlrev_b32 v1, 8, v1
    v_and_b32 v2, 15, v0
    v_lshl_add_u32 v1, v2, 4, v1
    v_bfe_u32 v2, v0, 4, 1
    v_lshl_add_u32 v1, v2, 3, v1
    s_mul_i32 s56, s3, 1536
    s_add_u32 s56, s56, 147456
    v_add_u32 v236, s56, v1
    s_mul_i32 s56, s3, 3072
    s_add_u32 s56, s56, 24576
    v_add_u32 v237, s56, v65
    v_add_u32 v238, s41, v65
    s_lshl_b32 s56, s3, 10
    v_add_u32 v240, 159744, v65
    v_add_u32 v239, s56, v240
    v_add_u32 v241, 147456, v65
    v_bfe_u32 v1, v0, 2, 2
    v_lshrrev_b32 v2, 4, v0
    v_lshl_or_b32 v1, v1, 4, v2
    v_mul_u32_u24 v1, 65536, v1
    v_and_b32 v2, 3, v0
    v_lshl_or_b32 v242, v2, 5, v1
    v_xor_b32 v243, 0x70, v242
    s_mul_i32 s56, s3, 3
    v_min_u32 v1, 2, v0
    v_add_u32 v1, s56, v1
    v_min_u32 v2, 8, v0
    v_add_u32 v2, 9, v2
    v_cmp_gt_u32 vcc, 3, v0
    s_nop 1
    v_cndmask_b32 v1, v2, v1, vcc
    v_lshlrev_b32 v245, 7, v1
    v_lshlrev_b32 v1, 3, v0
    v_add_u32 v254, 126976, v1
    s_lshl_b32 s56, s3, 9
    v_add_u32 v238, s56, v254
    v_add_u32 v253, 122880, v65
    s_lshl_b32 s56, s3, 10
    v_add_u32 v237, s56, v253
    s_mov_b32 s52, 0x41c00000
    s_waitcnt vmcnt(5)
    s_add_u32 m0, s41, 0
    s_add_u32 s58, s37, 0
    buffer_load_dwordx4 v22, s[24:27], s58 offen offset:0 nt lds
    s_waitcnt vmcnt(5)
    buffer_load_dwordx4 v23, s[24:27], s58 offen offset:1024 nt lds
    s_waitcnt vmcnt(5)
    buffer_load_dwordx4 v24, s[24:27], s58 offen offset:2048 nt lds
    s_waitcnt vmcnt(5)
    buffer_load_dwordx4 v25, s[24:27], s58 offen offset:3072 nt lds
    s_waitcnt vmcnt(5)
    s_add_u32 m0, s41, 4096
    s_nop 0
    buffer_load_dwordx4 v26, s[24:27], s58 offen offset:0 nt lds
    s_waitcnt vmcnt(5)
    buffer_load_dwordx4 v27, s[24:27], s58 offen offset:1024 nt lds
    s_waitcnt vmcnt(5)
    buffer_load_dwordx4 v28, s[24:27], s58 offen offset:2048 nt lds
    s_waitcnt vmcnt(5)
    buffer_load_dwordx4 v29, s[24:27], s58 offen offset:3072 nt lds
    s_waitcnt vmcnt(5)
    s_add_u32 m0, s41, 8192
    s_nop 0
    buffer_load_dwordx4 v30, s[24:27], s58 offen offset:0 nt lds
    s_waitcnt vmcnt(9)
    s_waitcnt lgkmcnt(0)
    s_barrier
    ds_read_b128 a[48:51], v34 offset:0
    ds_read_b128 a[52:55], v35 offset:0
    ds_read_b128 a[56:59], v34 offset:128
    ds_read_b128 a[60:63], v35 offset:128
    ds_read_b128 a[64:67], v34 offset:256
    ds_read_b128 a[68:71], v35 offset:256
    s_waitcnt lgkmcnt(5)
    v_mfma_f32_16x16x32_bf16 v[84:87], a[48:51], a[48:51], 0
    s_waitcnt vmcnt(5)
    buffer_load_dwordx4 v31, s[24:27], s58 offen offset:1024 nt lds
    ds_read_b64_tr_b16 a[72:73], v36 offset:0
    ds_read_b64_tr_b16 a[74:75], v36 offset:6144
    v_mfma_f32_16x16x32_bf16 v[80:83], a[48:51], v[52:55], 0
    s_waitcnt vmcnt(5)
    buffer_load_dwordx4 v32, s[24:27], s58 offen offset:2048 nt lds
    ds_read_b64_tr_b16 a[76:77], v36 offset:12288
    ds_read_b64_tr_b16 a[78:79], v36 offset:18432
    s_waitcnt lgkmcnt(8)
    v_mfma_f32_16x16x32_bf16 v[84:87], a[52:55], a[52:55], v[84:87]
    s_waitcnt vmcnt(5)
    buffer_load_dwordx4 v33, s[24:27], s58 offen offset:3072 nt lds
    ds_read_b64_tr_b16 a[80:81], v37 offset:0
    ds_read_b64_tr_b16 a[82:83], v37 offset:6144
    v_mfma_f32_16x16x32_bf16 v[80:83], a[52:55], v[52:55], v[80:83]
    ds_read_b64_tr_b16 a[84:85], v37 offset:12288
    ds_read_b64_tr_b16 a[86:87], v37 offset:18432
    s_waitcnt lgkmcnt(11)
    v_mfma_f32_16x16x32_bf16 v[84:87], a[56:59], a[56:59], v[84:87]
    ds_read_b64_tr_b16 a[88:89], v38 offset:0
    ds_read_b64_tr_b16 a[90:91], v38 offset:6144
    v_mfma_f32_16x16x32_bf16 v[80:83], a[56:59], v[52:55], v[80:83]
    ds_read_b64_tr_b16 a[92:93], v38 offset:12288
    ds_read_b64_tr_b16 a[94:95], v38 offset:18432
    s_waitcnt lgkmcnt(14)
    v_mfma_f32_16x16x32_bf16 v[84:87], a[60:63], a[60:63], v[84:87]
    v_mfma_f32_16x16x32_bf16 v[80:83], a[60:63], v[52:55], v[80:83]
    s_waitcnt lgkmcnt(13)
    v_mfma_f32_16x16x32_bf16 v[84:87], a[64:67], a[64:67], v[84:87]
    v_mfma_f32_16x16x32_bf16 v[80:83], a[64:67], v[52:55], v[80:83]
    s_waitcnt lgkmcnt(12)
    v_mfma_f32_16x16x32_bf16 v[84:87], a[68:71], a[68:71], v[84:87]
    s_waitcnt vmcnt(5)
    s_add_u32 m0, s42, 0
    s_add_u32 s59, s37, 196608
    buffer_load_dwordx4 v22, s[24:27], s59 offen offset:0 nt lds
    v_mfma_f32_16x16x32_bf16 v[80:83], a[68:71], v[52:55], v[80:83]
    s_waitcnt lgkmcnt(0)
    s_mul_i32 s39, s38, 0x9e3779b1
    s_add_u32 s39, s39, 0x7f4a7c16
    s_or_b32 s39, s39, 1
    s_waitcnt vmcnt(5)
    buffer_load_dwordx4 v23, s[24:27], s59 offen offset:1024 nt lds
    s_waitcnt vmcnt(5)
    buffer_load_dwordx4 v24, s[24:27], s59 offen offset:2048 nt lds
    s_waitcnt vmcnt(5)
    buffer_load_dwordx4 v25, s[24:27], s59 offen offset:3072 nt lds
    s_waitcnt vmcnt(5)
    s_add_u32 m0, s42, 4096
    s_nop 0
    buffer_load_dwordx4 v26, s[24:27], s59 offen offset:0 nt lds
    s_waitcnt vmcnt(5)
    buffer_load_dwordx4 v27, s[24:27], s59 offen offset:1024 nt lds
    s_waitcnt vmcnt(5)
    buffer_load_dwordx4 v28, s[24:27], s59 offen offset:2048 nt lds
    s_waitcnt vmcnt(5)
    buffer_load_dwordx4 v29, s[24:27], s59 offen offset:3072 nt lds
    s_waitcnt vmcnt(5)
    s_add_u32 m0, s42, 8192
    s_nop 0
    buffer_load_dwordx4 v30, s[24:27], s59 offen offset:0 nt lds
    s_waitcnt vmcnt(5)
    buffer_load_dwordx4 v31, s[24:27], s59 offen offset:1024 nt lds
    s_waitcnt vmcnt(5)
    buffer_load_dwordx4 v32, s[24:27], s59 offen offset:2048 nt lds
    s_mul_i32 s56, s3, 3072
    s_add_u32 s56, s56, 16384
    buffer_load_dwordx4 v[136:139], v65, s[32:35], s56 offen offset:0 sc1
    buffer_load_dwordx4 v[140:143], v65, s[32:35], s56 offen offset:1024 sc1
    buffer_load_dwordx4 v[144:147], v65, s[32:35], s56 offen offset:2048 sc1
L_join:
    s_mul_i32 s60, s3, 18432
    s_mov_b32 s72, s22
    s_mov_b32 s73, s23
    s_mov_b32 s74, 16777216
    s_mov_b32 s75, 0x20000
    s_cmp_eq_u32 s0, 1
    s_cselect_b32 s74, 0, s74
    s_waitcnt vmcnt(14)
    s_barrier
    ds_read_b128 a[96:99], v40 offset:0
    ds_read_b128 a[100:103], v41 offset:0
    ds_read_b128 a[104:107], v42 offset:0
    ds_read_b128 a[108:111], v43 offset:0
    ds_read_b128 a[112:115], v40 offset:256
    ds_read_b128 a[116:119], v41 offset:256
    ds_read_b128 a[120:123], v42 offset:256
    ds_read_b128 a[124:127], v43 offset:256
    ds_read_b128 a[128:131], v40 offset:512
    ds_read_b128 a[132:135], v41 offset:512
    ds_read_b128 a[136:139], v42 offset:512
    ds_read_b128 a[140:143], v43 offset:512
    ds_read_b64_tr_b16 a[144:145], v44 offset:0
    ds_read_b64_tr_b16 a[146:147], v45 offset:0
    ds_read_b64_tr_b16 a[148:149], v44 offset:12288
    ds_read_b64_tr_b16 a[150:151], v45 offset:12288
    ds_read_b64_tr_b16 a[152:153], v44 offset:24576
    ds_read_b64_tr_b16 a[154:155], v45 offset:24576
    ds_read_b64_tr_b16 a[156:157], v44 offset:36864
    ds_read_b64_tr_b16 a[158:159], v45 offset:36864
    ds_read_b64_tr_b16 a[160:161], v46 offset:0
    ds_read_b64_tr_b16 a[162:163], v47 offset:0
    ds_read_b64_tr_b16 a[164:165], v46 offset:12288
    ds_read_b64_tr_b16 a[166:167], v47 offset:12288
    ds_read_b64_tr_b16 a[168:169], v46 offset:24576
    ds_read_b64_tr_b16 a[170:171], v47 offset:24576
    ds_read_b64_tr_b16 a[172:173], v46 offset:36864
    ds_read_b64_tr_b16 a[174:175], v47 offset:36864
    ds_read_b64_tr_b16 a[176:177], v48 offset:0
    ds_read_b64_tr_b16 a[178:179], v49 offset:0
    ds_read_b64_tr_b16 a[180:181], v48 offset:12288
    ds_read_b64_tr_b16 a[182:183], v49 offset:12288
    ds_read_b64_tr_b16 a[184:185], v48 offset:24576
    ds_read_b64_tr_b16 a[186:187], v49 offset:24576
    ds_read_b64_tr_b16 a[188:189], v48 offset:36864
    ds_read_b64_tr_b16 a[190:191], v49 offset:36864
    s_memrealtime s[14:15]
    s_waitcnt lgkmcnt(0)
    s_barrier
    s_cmp_ge_u32 s43, 3
    s_cbranch_scc1 L_v_nofl
    s_mul_i32 s56, s3, 3
    s_add_u32 s56, s56, s43
    s_lshl_b32 s56, s56, 7
    v_mov_b32 v1, s39
    v_mov_b32 v2, 0
    s_mov_b64 exec, 1
    s_waitcnt vmcnt(8)
    buffer_store_dword v1, v2, s[32:35], s56 offen offset:128 sc1
    s_mov_b64 exec, -1
L_v_nofl:
    s_cmp_eq_u32 s98, 1
    s_cbranch_scc0 L_nopub
    s_lshl_b32 s56, s2, 4
    v_mov_b32 v2, s39
    v_mov_b32 v3, s20
    v_mov_b32 v1, 0
    s_mov_b64 exec, 1
    buffer_store_dwordx2 v[2:3], v1, s[32:35], s56 offen offset:1648 sc1
    s_mov_b64 exec, -1
L_nopub:
    s_lshl2_add_u32 s15, s2, s3
    s_sub_u32 s15, s15, 240
    s_and_b32 s16, s15, 0xffffffe3
    s_cbranch_scc1 L_nolc
    s_add_u32 s15, s15, 32
    v_mov_b32 v244, s14
    s_mov_b64 exec, 1
    buffer_store_dword v244, off, s[32:35], s15 sc1
    s_mov_b64 exec, -1
L_nolc:
    v_mfma_f32_16x16x32_bf16 v[96:99], a[96:99], a[96:99], v[84:87]
    s_cmp_eq_u32 s0, 0
    s_cbranch_scc0 L_g24
    s_waitcnt vmcnt(9)
L_g24:
    s_add_u32 m0, s42, 8192
    s_add_u32 s59, s37, 196608
    buffer_load_dwordx4 v33, s[24:27], s59 offen offset:3072 nt lds
    v_add_u32 v44, 49152, v44
    v_add_u32 v45, 49152, v45
    v_mfma_f32_16x16x32_bf16 v[100:103], a[96:99], a[48:51], 0
    s_cmp_eq_u32 s0, 0
    s_cbranch_scc0 L_g25
    s_waitcnt vmcnt(9)
L_g25:
    s_add_u32 m0, s40, 0
    s_add_u32 s57, s36, 6291456
    buffer_load_dwordx4 v16, s[28:31], s57 offen offset:0 nt lds
    v_add_u32 v46, 49152, v46
    v_add_u32 v47, 49152, v47
    v_mfma_f32_16x16x32_bf16 v[96:99], a[100:103], a[100:103], v[96:99]
    v_add_u32 v48, 49152, v48
    v_add_u32 v49, 49152, v49
    v_mfma_f32_16x16x32_bf16 v[100:103], a[100:103], a[52:55], v[100:103]
    v_mfma_f32_16x16x32_bf16 v[96:99], a[104:107], a[104:107], v[96:99]
    v_mfma_f32_16x16x32_bf16 v[100:103], a[104:107], a[56:59], v[100:103]
    v_mfma_f32_16x16x32_bf16 v[96:99], a[108:111], a[108:111], v[96:99]
    v_mfma_f32_16x16x32_bf16 v[100:103], a[108:111], a[60:63], v[100:103]
    v_mfma_f32_16x16x32_bf16 v[96:99], a[112:115], a[112:115], v[96:99]
    v_mfma_f32_16x16x32_bf16 v[100:103], a[112:115], a[64:67], v[100:103]
    v_mfma_f32_16x16x32_bf16 v[96:99], a[116:119], a[116:119], v[96:99]
    v_mfma_f32_16x16x32_bf16 v[100:103], a[116:119], a[68:71], v[100:103]
    v_mfma_f32_16x16x32_bf16 v[92:95], a[96:99], v[52:55], v[80:83]
    v_mfma_f32_16x16x32_bf16 v[92:95], a[100:103], v[52:55], v[92:95]
    s_cmp_eq_u32 s0, 0
    s_cbranch_scc0 L_g26
    s_waitcnt vmcnt(9)
L_g26:
    buffer_load_dwordx4 v17, s[28:31], s57 offen offset:1024 nt lds
    v_mfma_f32_16x16x32_bf16 v[92:95], a[104:107], v[52:55], v[92:95]
    v_mfma_f32_16x16x32_bf16 v[92:95], a[108:111], v[52:55], v[92:95]
    v_fma_f32 v96, v100, 2.0, v96
    v_fma_f32 v97, v101, 2.0, v97
    v_mfma_f32_16x16x32_bf16 v[92:95], a[112:115], v[52:55], v[92:95]
    v_fma_f32 v98, v102, 2.0, v98
    v_fma_f32 v99, v103, 2.0, v99
    v_mfma_f32_16x16x32_bf16 v[92:95], a[116:119], v[52:55], v[92:95]
    v_cndmask_b32 v3, 0, v96, s[44:45]
    v_cndmask_b32 v3, v3, v97, s[46:47]
    v_mfma_f32_16x16x32_bf16 v[112:115], a[120:123], a[120:123], v[84:87]
    v_cndmask_b32 v3, v3, v98, s[48:49]
    v_cndmask_b32 v3, v3, v99, s[50:51]
    v_mfma_f32_16x16x32_bf16 v[116:119], a[120:123], a[48:51], 0
    s_nop 0
    s_nop 0
    v_mfma_f32_16x16x32_bf16 v[112:115], a[124:127], a[124:127], v[112:115]
    v_mfma_f32_16x16x4_f32 v[120:123], v3, v60, v[56:59]
    v_mfma_f32_16x16x32_bf16 v[116:119], a[124:127], a[52:55], v[116:119]
    v_mfma_f32_16x16x32_bf16 v[112:115], a[128:131], a[128:131], v[112:115]
    v_mfma_f32_16x16x32_bf16 v[116:119], a[128:131], a[56:59], v[116:119]
    v_mfma_f32_16x16x32_bf16 v[112:115], a[132:135], a[132:135], v[112:115]
    s_cmp_eq_u32 s0, 0
    s_cbranch_scc0 L_g27
    s_waitcnt vmcnt(9)
L_g27:
    buffer_load_dwordx4 v18, s[28:31], s57 offen offset:2048 nt lds
    s_nop 1
    v_fma_f32 v128, -v92, v92, v120
    v_fma_f32 v129, -v93, v93, v121
    v_mfma_f32_16x16x32_bf16 v[116:119], a[132:135], a[60:63], v[116:119]
    v_fma_f32 v130, -v94, v94, v122
    v_fma_f32 v131, -v95, v95, v123
    v_mfma_f32_16x16x32_bf16 v[112:115], a[136:139], a[136:139], v[112:115]
    v_max_f32 v128, v128, v56
    v_max_f32 v129, v129, v56
    v_mfma_f32_16x16x32_bf16 v[116:119], a[136:139], a[64:67], v[116:119]
    v_max_f32 v130, v130, v56
    v_max_f32 v131, v131, v56
    v_mfma_f32_16x16x32_bf16 v[112:115], a[140:143], a[140:143], v[112:115]
    v_rsq_f32 v128, v128
    v_mfma_f32_16x16x32_bf16 v[116:119], a[140:143], a[68:71], v[116:119]
    v_rsq_f32 v129, v129
    v_mfma_f32_16x16x32_bf16 v[108:111], a[120:123], v[52:55], v[80:83]
    v_rsq_f32 v130, v130
    v_mfma_f32_16x16x32_bf16 v[108:111], a[124:127], v[52:55], v[108:111]
    v_rsq_f32 v131, v131
    v_mfma_f32_16x16x32_bf16 v[108:111], a[128:131], v[52:55], v[108:111]
    v_mfma_f32_16x16x32_bf16 v[108:111], a[132:135], v[52:55], v[108:111]
    v_mfma_f32_16x16x32_bf16 v[108:111], a[136:139], v[52:55], v[108:111]
    v_fma_f32 v112, v116, 2.0, v112
    v_fma_f32 v113, v117, 2.0, v113
    v_mfma_f32_16x16x32_bf16 v[108:111], a[140:143], v[52:55], v[108:111]
    v_fma_f32 v114, v118, 2.0, v114
    v_fma_f32 v115, v119, 2.0, v115
    v_cndmask_b32 v4, 0, v112, s[44:45]
    v_cndmask_b32 v4, v4, v113, s[46:47]
    v_cndmask_b32 v4, v4, v114, s[48:49]
    v_cndmask_b32 v4, v4, v115, s[50:51]
    s_nop 0
    s_nop 0
    v_mfma_f32_16x16x4_f32 v[124:127], v4, v60, v[56:59]
    s_nop 9
    v_fma_f32 v132, -v108, v108, v124
    v_fma_f32 v133, -v109, v109, v125
    v_fma_f32 v134, -v110, v110, v126
    v_fma_f32 v135, -v111, v111, v127
    v_max_f32 v132, v132, v56
    v_max_f32 v133, v133, v56
    v_max_f32 v134, v134, v56
    v_max_f32 v135, v135, v56
    v_rsq_f32 v132, v132
    v_rsq_f32 v133, v133
    v_rsq_f32 v134, v134
    v_rsq_f32 v135, v135
    s_mul_i32 s56, s3, 1536
    v_lshlrev_b32 v5, 3, v0
    v_add_u32 v5, 153600, v5
    v_add_u32 v4, s56, v5
    s_cmp_eq_u32 s0, 0
    s_cbranch_scc0 L_g28
    s_waitcnt vmcnt(9)
L_g28:
    buffer_load_dwordx4 v19, s[28:31], s57 offen offset:3072 nt lds
    s_cmp_eq_u32 s0, 0
    s_cbranch_scc0 L_g29
    s_waitcnt vmcnt(9)
L_g29:
    s_add_u32 m0, s40, 4096
    s_nop 0
    buffer_load_dwordx4 v20, s[28:31], s57 offen offset:0 nt lds
    s_cmp_eq_u32 s0, 0
    s_cbranch_scc0 L_g30
    s_waitcnt vmcnt(5)
L_g30:
    buffer_load_dwordx4 v21, s[28:31], s57 offen offset:1024 nt lds
    s_cmp_eq_u32 s0, 0
    s_cbranch_scc0 L_g31
    s_waitcnt vmcnt(5)
L_g31:
    s_add_u32 m0, s41, 0
    s_add_u32 s58, s37, 25165824
    buffer_load_dwordx4 v22, s[24:27], s58 offen offset:0 nt lds
    s_cmp_eq_u32 s0, 0
    s_cbranch_scc0 L_g32
    s_waitcnt vmcnt(5)
L_g32:
    buffer_load_dwordx4 v23, s[24:27], s58 offen offset:1024 nt lds
    s_cmp_eq_u32 s0, 0
    s_cbranch_scc0 L_g33
    s_waitcnt vmcnt(5)
L_g33:
    buffer_load_dwordx4 v24, s[24:27], s58 offen offset:2048 nt lds
    s_cmp_eq_u32 s0, 0
    s_cbranch_scc0 L_g34
    s_waitcnt vmcnt(5)
L_g34:
    buffer_load_dwordx4 v25, s[24:27], s58 offen offset:3072 nt lds
    s_waitcnt vmcnt(11)
    v_xor_b32 v1, s39, v138
    v_xor_b32 v2, s39, v142
    v_xor_b32 v3, s39, v146
    v_or3_b32 v1, v1, v2, v3
    v_cmp_ne_u32 vcc, 0, v1
    s_cbranch_vccnz L_qk_retry
L_qk_ok:
    ds_write_b64 v4, v[136:137] offset:0
    ds_write_b64 v4, v[140:141] offset:512
    ds_write_b64 v4, v[144:145] offset:1024
    s_waitcnt lgkmcnt(0)
    s_barrier
    ds_read2st64_b64 v[136:139], v5 offset0:0 offset1:1
    ds_read2st64_b64 v[140:143], v5 offset0:2 offset1:3
    ds_read2st64_b64 v[144:147], v5 offset0:4 offset1:5
    ds_read2st64_b64 v[148:151], v5 offset0:6 offset1:7
    ds_read2st64_b64 v[152:155], v5 offset0:8 offset1:9
    ds_read2st64_b64 v[156:159], v5 offset0:10 offset1:11
    s_waitcnt lgkmcnt(5)
    v_mfma_f32_16x16x32_bf16 v[120:123], v[52:55], v[136:139], 0
    v_mfma_f32_16x16x32_bf16 v[76:79], a[48:51], v[136:139], 0
    s_waitcnt lgkmcnt(4)
    v_mfma_f32_16x16x32_bf16 v[120:123], v[52:55], v[140:143], v[120:123]
    v_mfma_f32_16x16x32_bf16 v[76:79], a[52:55], v[140:143], v[76:79]
    s_waitcnt lgkmcnt(3)
    v_mfma_f32_16x16x32_bf16 v[120:123], v[52:55], v[144:147], v[120:123]
    v_mfma_f32_16x16x32_bf16 v[76:79], a[56:59], v[144:147], v[76:79]
    s_waitcnt lgkmcnt(2)
    v_mfma_f32_16x16x32_bf16 v[120:123], v[52:55], v[148:151], v[120:123]
    v_mfma_f32_16x16x32_bf16 v[76:79], a[60:63], v[148:151], v[76:79]
    s_cmp_eq_u32 s0, 0
    s_cbranch_scc0 L_g35
    s_waitcnt vmcnt(5)
L_g35:
    s_add_u32 m0, s41, 4096
    s_nop 0
    buffer_load_dwordx4 v26, s[24:27], s58 offen offset:0 nt lds
    s_waitcnt lgkmcnt(1)
    v_mfma_f32_16x16x32_bf16 v[120:123], v[52:55], v[152:155], v[120:123]
    v_mfma_f32_16x16x32_bf16 v[76:79], a[64:67], v[152:155], v[76:79]
    s_waitcnt lgkmcnt(0)
    v_mfma_f32_16x16x32_bf16 v[120:123], v[52:55], v[156:159], v[120:123]
    v_mfma_f32_16x16x32_bf16 v[76:79], a[68:71], v[156:159], v[76:79]
    s_nop 6
    v_mul_f32 v61, 0x3baaaaab, v120
    v_mfma_f32_16x16x32_bf16 v[88:91], a[96:99], v[136:139], v[76:79]
    v_mov_b32 v9, 0
    v_mfma_f32_16x16x32_bf16 v[88:91], a[100:103], v[140:143], v[88:91]
    v_mfma_f32_16x16x32_bf16 v[88:91], a[104:107], v[144:147], v[88:91]
    v_mfma_f32_16x16x32_bf16 v[88:91], a[108:111], v[148:151], v[88:91]
    v_mfma_f32_16x16x32_bf16 v[88:91], a[112:115], v[152:155], v[88:91]
    v_mfma_f32_16x16x32_bf16 v[88:91], a[116:119], v[156:159], v[88:91]
    ds_write_b32 v254, v9 offset:4096
    ds_write_b32 v254, v9 offset:4100
    v_mfma_f32_16x16x32_bf16 v[104:107], a[120:123], v[136:139], v[76:79]
    v_mfma_f32_16x16x32_bf16 v[104:107], a[124:127], v[140:143], v[104:107]
    v_mfma_f32_16x16x32_bf16 v[104:107], a[128:131], v[144:147], v[104:107]
    v_and_b32 v244, 7, v0
    v_lshlrev_b32 v244, 2, v244
    v_or_b32 v244, 0x20, v244
    buffer_load_dword v244, v244, s[32:35], 0 offen sc1
    s_cmp_eq_u32 s0, 0
    s_cbranch_scc0 L_g36
    s_waitcnt vmcnt(6)
L_g36:
    buffer_load_dwordx4 v27, s[24:27], s58 offen offset:1024 nt lds
    v_mfma_f32_16x16x32_bf16 v[104:107], a[132:135], v[148:151], v[104:107]
    v_fma_f32 v88, -v92, v61, v88
    v_fma_f32 v89, -v93, v61, v89
    v_mfma_f32_16x16x32_bf16 v[104:107], a[136:139], v[152:155], v[104:107]
    v_fma_f32 v90, -v94, v61, v90
    v_fma_f32 v91, -v95, v61, v91
    v_mfma_f32_16x16x32_bf16 v[104:107], a[140:143], v[156:159], v[104:107]
    v_mul_f32 v88, v88, v128
    v_mul_f32 v89, v89, v129
    v_mul_f32 v90, v90, v130
    v_mul_f32 v91, v91, v131
    v_max3_f32 v1, v88, v89, v90
    v_max_f32 v1, v1, v91
    s_nop 1
    v_fma_f32 v104, -v108, v61, v104
    v_fma_f32 v105, -v109, v61, v105
    v_fma_f32 v106, -v110, v61, v106
    v_fma_f32 v107, -v111, v61, v107
    v_mul_f32 v104, v104, v132
    v_mul_f32 v105, v105, v133
    v_mul_f32 v106, v106, v134
    v_mul_f32 v107, v107, v135
    v_max3_f32 v1, v1, v104, v105
    v_max3_f32 v1, v1, v106, v107
    v_mov_b32 v2, v1
    s_nop 1
    v_permlane32_swap_b32 v1, v2
    v_max_f32 v1, v1, v2
    v_mov_b32 v2, v1
    s_nop 1
    v_permlane16_swap_b32 v1, v2
    v_max_f32 v1, v1, v2
    ds_write_b32 v239, v1
    s_waitcnt lgkmcnt(0)
    s_barrier
    ds_read_b32 v12, v240 offset:0
    ds_read_b32 v13, v240 offset:1024
    ds_read_b32 v14, v240 offset:2048
    ds_read_b32 v15, v240 offset:3072
    s_cmp_eq_u32 s0, 0
    s_cbranch_scc0 L_g37
    s_waitcnt vmcnt(6)
L_g37:
    buffer_load_dwordx4 v28, s[24:27], s58 offen offset:2048 nt lds
    s_waitcnt lgkmcnt(0)
    v_max3_f32 v1, v12, v13, v14
    v_max_f32 v1, v1, v15
    v_sub_f32 v88, v88, v1
    v_sub_f32 v89, v89, v1
    v_sub_f32 v90, v90, v1
    v_sub_f32 v91, v91, v1
    v_sub_f32 v104, v104, v1
    v_sub_f32 v105, v105, v1
    v_sub_f32 v106, v106, v1
    v_sub_f32 v107, v107, v1
    v_sub_f32 v62, 0, v1
    v_sub_f32 v255, 0, v1
    v_exp_f32 v96, v88
    v_exp_f32 v97, v89
    v_exp_f32 v98, v90
    v_exp_f32 v99, v91
    v_mul_f32 v88, v96, v128
    v_mul_f32 v89, v97, v129
    v_mul_f32 v90, v98, v130
    v_mul_f32 v91, v99, v131
    s_cmp_eq_u32 s0, 0
    s_cbranch_scc0 L_g38
    s_waitcnt vmcnt(6)
L_g38:
    buffer_load_dwordx4 v29, s[24:27], s58 offen offset:3072 nt lds
    v_exp_f32 v112, v104
    v_exp_f32 v113, v105
    v_exp_f32 v114, v106
    v_exp_f32 v115, v107
    v_cvt_pk_bf16_f32 v72, v88, v89
    v_cvt_pk_bf16_f32 v73, v90, v91
    v_mul_f32 v104, v112, v132
    v_mul_f32 v105, v113, v133
    v_mul_f32 v106, v114, v134
    v_mul_f32 v107, v115, v135
    v_cvt_pk_bf16_f32 v74, v104, v105
    v_cvt_pk_bf16_f32 v75, v106, v107
    ds_write_b128 v237, v[72:75] offset:0
    v_mov_b32 v63, v96
    v_mul_f32 v64, v88, v92
    v_add_f32 v63, v63, v97
    v_fmac_f32 v64, v89, v93
    v_add_f32 v63, v63, v98
    v_fmac_f32 v64, v90, v94
    v_add_f32 v63, v63, v99
    v_fmac_f32 v64, v91, v95
    v_mov_b32 v68, v88
    v_mov_b32 v69, v89
    v_mov_b32 v70, v90
    v_mov_b32 v71, v91
    s_waitcnt lgkmcnt(0)
    s_barrier
    ds_read_b128 v[92:95], v253 offset:0
    ds_read_b128 v[96:99], v253 offset:1024
    ds_read_b128 v[100:103], v253 offset:2048
    ds_read_b128 v[116:119], v253 offset:3072
    s_waitcnt lgkmcnt(3)
    v_mfma_f32_16x16x32_bf16 a[0:3], a[144:147], v[92:95], 0
    s_cmp_eq_u32 s0, 0
    s_cbranch_scc0 L_g39
    s_waitcnt vmcnt(6)
L_g39:
    s_add_u32 m0, s41, 8192
    s_nop 0
    buffer_load_dwordx4 v30, s[24:27], s58 offen offset:0 nt lds
    v_add_f32 v68, v68, v104
    v_add_f32 v69, v69, v105
    v_mfma_f32_16x16x32_bf16 a[4:7], a[160:163], v[92:95], 0
    v_add_f32 v70, v70, v106
    v_add_f32 v71, v71, v107
    v_mfma_f32_16x16x32_bf16 a[8:11], a[176:179], v[92:95], 0
    v_add_f32 v63, v63, v112
    v_fma_f32 v64, v104, v108, v64
    s_waitcnt lgkmcnt(2)
    v_mfma_f32_16x16x32_bf16 a[0:3], a[148:151], v[96:99], a[0:3]
    v_add_f32 v63, v63, v113
    v_fma_f32 v64, v105, v109, v64
    v_mfma_f32_16x16x32_bf16 a[4:7], a[164:167], v[96:99], a[4:7]
    v_add_f32 v63, v63, v114
    v_fma_f32 v64, v106, v110, v64
    v_mfma_f32_16x16x32_bf16 a[8:11], a[180:183], v[96:99], a[8:11]
    s_cmp_eq_u32 s0, 0
    s_cbranch_scc0 L_g40
    s_waitcnt vmcnt(6)
L_g40:
    buffer_load_dwordx4 v31, s[24:27], s58 offen offset:1024 nt lds
    v_add_f32 v63, v63, v115
    v_fma_f32 v64, v107, v111, v64
    s_waitcnt lgkmcnt(1)
    v_mfma_f32_16x16x32_bf16 a[0:3], a[152:155], v[100:103], a[0:3]
    v_mfma_f32_16x16x32_bf16 a[4:7], a[168:171], v[100:103], a[4:7]
    v_mfma_f32_16x16x32_bf16 a[8:11], a[184:187], v[100:103], a[8:11]
    s_waitcnt lgkmcnt(0)
    v_mfma_f32_16x16x32_bf16 a[0:3], a[156:159], v[116:119], a[0:3]
    v_mfma_f32_16x16x32_bf16 a[4:7], a[172:175], v[116:119], a[4:7]
    v_mfma_f32_16x16x32_bf16 a[8:11], a[188:191], v[116:119], a[8:11]
    s_waitcnt vmcnt(17)
    s_barrier
    s_memrealtime s[14:15]
    ds_read_b128 a[96:99], v40 offset:49152
    ds_read_b128 a[100:103], v41 offset:49152
    ds_read_b128 a[104:107], v42 offset:49152
    ds_read_b128 a[108:111], v43 offset:49152
    ds_read_b128 a[112:115], v40 offset:49408
    ds_read_b128 a[116:119], v41 offset:49408
    ds_read_b128 a[120:123], v42 offset:49408
    ds_read_b128 a[124:127], v43 offset:49408
    ds_read_b128 a[128:131], v40 offset:49664
    ds_read_b128 a[132:135], v41 offset:49664
    ds_read_b128 a[136:139], v42 offset:49664
    ds_read_b128 a[140:143], v43 offset:49664
    s_waitcnt lgkmcnt(0)
    v_mfma_f32_16x16x32_bf16 v[96:99], a[96:99], a[96:99], v[84:87]
    s_cmp_eq_u32 s0, 0
    s_cbranch_scc0 L_g41
    s_waitcnt vmcnt(6)
L_g41:
    buffer_load_dwordx4 v32, s[24:27], s58 offen offset:2048 nt lds
    ds_read_b64_tr_b16 a[144:145], v44 offset:0
    ds_read_b64_tr_b16 a[146:147], v45 offset:0
    v_mfma_f32_16x16x32_bf16 v[100:103], a[96:99], a[48:51], 0
    s_cmp_eq_u32 s0, 0
    s_cbranch_scc0 L_g42
    s_waitcnt vmcnt(5)
L_g42:
    buffer_load_dwordx4 v33, s[24:27], s58 offen offset:3072 nt lds
    ds_read_b64_tr_b16 a[148:149], v44 offset:12288
    ds_read_b64_tr_b16 a[150:151], v45 offset:12288
    v_mfma_f32_16x16x32_bf16 v[96:99], a[100:103], a[100:103], v[96:99]
    ds_read_b64_tr_b16 a[152:153], v44 offset:24576
    ds_read_b64_tr_b16 a[154:155], v45 offset:24576
    v_mfma_f32_16x16x32_bf16 v[100:103], a[100:103], a[52:55], v[100:103]
    ds_read_b64_tr_b16 a[156:157], v44 offset:36864
    ds_read_b64_tr_b16 a[158:159], v45 offset:36864
    v_mfma_f32_16x16x32_bf16 v[96:99], a[104:107], a[104:107], v[96:99]
    ds_read_b64_tr_b16 a[160:161], v46 offset:0
    ds_read_b64_tr_b16 a[162:163], v47 offset:0
    v_mfma_f32_16x16x32_bf16 v[100:103], a[104:107], a[56:59], v[100:103]
    ds_read_b64_tr_b16 a[164:165], v46 offset:12288
    ds_read_b64_tr_b16 a[166:167], v47 offset:12288
    v_mfma_f32_16x16x32_bf16 v[96:99], a[108:111], a[108:111], v[96:99]
    ds_read_b64_tr_b16 a[168:169], v46 offset:24576
    ds_read_b64_tr_b16 a[170:171], v47 offset:24576
    v_mfma_f32_16x16x32_bf16 v[100:103], a[108:111], a[60:63], v[100:103]
    ds_read_b64_tr_b16 a[172:173], v46 offset:36864
    ds_read_b64_tr_b16 a[174:175], v47 offset:36864
    v_mfma_f32_16x16x32_bf16 v[96:99], a[112:115], a[112:115], v[96:99]
    ds_read_b64_tr_b16 a[176:177], v48 offset:0
    ds_read_b64_tr_b16 a[178:179], v49 offset:0
    v_mfma_f32_16x16x32_bf16 v[100:103], a[112:115], a[64:67], v[100:103]
    ds_read_b64_tr_b16 a[180:181], v48 offset:12288
    ds_read_b64_tr_b16 a[182:183], v49 offset:12288
    v_mfma_f32_16x16x32_bf16 v[96:99], a[116:119], a[116:119], v[96:99]
    ds_read_b64_tr_b16 a[184:185], v48 offset:24576
    ds_read_b64_tr_b16 a[186:187], v49 offset:24576
    v_mfma_f32_16x16x32_bf16 v[100:103], a[116:119], a[68:71], v[100:103]
    ds_read_b64_tr_b16 a[188:189], v48 offset:36864
    ds_read_b64_tr_b16 a[190:191], v49 offset:36864
    v_mfma_f32_16x16x32_bf16 v[92:95], a[96:99], v[52:55], v[80:83]
    v_mfma_f32_16x16x32_bf16 v[92:95], a[100:103], v[52:55], v[92:95]
    v_mfma_f32_16x16x32_bf16 v[92:95], a[104:107], v[52:55], v[92:95]
    v_mfma_f32_16x16x32_bf16 v[92:95], a[108:111], v[52:55], v[92:95]
    s_nop 1
    v_fma_f32 v96, v100, 2.0, v96
    v_fma_f32 v97, v101, 2.0, v97
    v_mfma_f32_16x16x32_bf16 v[92:95], a[112:115], v[52:55], v[92:95]
    v_fma_f32 v98, v102, 2.0, v98
    v_fma_f32 v99, v103, 2.0, v99
    v_mfma_f32_16x16x32_bf16 v[92:95], a[116:119], v[52:55], v[92:95]
    v_cndmask_b32 v3, 0, v96, s[44:45]
    v_cndmask_b32 v3, v3, v97, s[46:47]
    v_mfma_f32_16x16x32_bf16 v[88:91], a[96:99], v[136:139], v[76:79]
    v_cndmask_b32 v3, v3, v98, s[48:49]
    v_cndmask_b32 v3, v3, v99, s[50:51]
    v_mfma_f32_16x16x32_bf16 v[88:91], a[100:103], v[140:143], v[88:91]
    s_nop 0
    s_nop 0
    v_mfma_f32_16x16x32_bf16 v[88:91], a[104:107], v[144:147], v[88:91]
    v_mfma_f32_16x16x4_f32 v[120:123], v3, v60, v[56:59]
    v_mfma_f32_16x16x32_bf16 v[88:91], a[108:111], v[148:151], v[88:91]
    v_mfma_f32_16x16x32_bf16 v[88:91], a[112:115], v[152:155], v[88:91]
    v_mfma_f32_16x16x32_bf16 v[88:91], a[116:119], v[156:159], v[88:91]
    s_waitcnt lgkmcnt(0)
    s_barrier
    v_mfma_f32_16x16x32_bf16 v[112:115], a[120:123], a[120:123], v[84:87]
    s_cmp_eq_u32 s0, 0
    s_cbranch_scc0 L_g43
    s_waitcnt vmcnt(5)
L_g43:
    s_add_u32 m0, s42, 0
    s_add_u32 s59, s37, 25362432
    buffer_load_dwordx4 v22, s[24:27], s59 offen offset:0 nt lds
    v_mfma_f32_16x16x32_bf16 v[116:119], a[120:123], a[48:51], 0
    s_waitcnt vmcnt(8)
    s_movk_i32 s15, 1024
    v_sub_u32 v244, s14, v244
    v_cmp_gt_u32 s[16:17], s15, v244
    v_subrev_u32 v244, 234, v244
    s_nop 0
    v_cndmask_b32 v244, 0, v244, s[16:17]
    s_nop 1
    v_add_u32_dpp v244, v244, v244 row_ror:4 row_mask:0xf bank_mask:0xf
    s_nop 1
    v_add_u32_dpp v244, v244, v244 row_ror:2 row_mask:0xf bank_mask:0xf
    s_nop 1
    v_add_u32_dpp v244, v244, v244 row_ror:1 row_mask:0xf bank_mask:0xf
    s_nop 0
    v_readfirstlane_b32 s14, v244
    s_cmp_gt_i32 s14, -40
    s_cselect_b32 s17, 2, s0
    s_cmp_eq_u32 s17, 0
    s_cbranch_scc0 L_g44
    s_waitcnt vmcnt(5)
L_g44:
    buffer_load_dwordx4 v23, s[24:27], s59 offen offset:1024 nt lds
    v_mfma_f32_16x16x32_bf16 v[112:115], a[124:127], a[124:127], v[112:115]
    v_mfma_f32_16x16x32_bf16 v[116:119], a[124:127], a[52:55], v[116:119]
    v_fma_f32 v128, -v92, v92, v120
    v_fma_f32 v129, -v93, v93, v121
    v_mfma_f32_16x16x32_bf16 v[112:115], a[128:131], a[128:131], v[112:115]
    v_fma_f32 v130, -v94, v94, v122
    v_fma_f32 v131, -v95, v95, v123
    v_mfma_f32_16x16x32_bf16 v[116:119], a[128:131], a[56:59], v[116:119]
    v_max_f32 v128, v128, v56
    v_max_f32 v129, v129, v56
    v_mfma_f32_16x16x32_bf16 v[112:115], a[132:135], a[132:135], v[112:115]
    v_max_f32 v130, v130, v56
    v_max_f32 v131, v131, v56
    v_mfma_f32_16x16x32_bf16 v[116:119], a[132:135], a[60:63], v[116:119]
    v_rsq_f32 v128, v128
    v_mfma_f32_16x16x32_bf16 v[112:115], a[136:139], a[136:139], v[112:115]
    v_rsq_f32 v129, v129
    v_mfma_f32_16x16x32_bf16 v[116:119], a[136:139], a[64:67], v[116:119]
    s_cmp_eq_u32 s17, 0
    s_cbranch_scc0 L_g45
    s_waitcnt vmcnt(5)
L_g45:
    buffer_load_dwordx4 v24, s[24:27], s59 offen offset:2048 nt lds
    v_rsq_f32 v130, v130
    v_mfma_f32_16x16x32_bf16 v[112:115], a[140:143], a[140:143], v[112:115]
    v_rsq_f32 v131, v131
    v_mfma_f32_16x16x32_bf16 v[116:119], a[140:143], a[68:71], v[116:119]
    v_fma_f32 v88, -v92, v61, v88
    v_fma_f32 v89, -v93, v61, v89
    v_mfma_f32_16x16x32_bf16 v[108:111], a[120:123], v[52:55], v[80:83]
    v_fma_f32 v90, -v94, v61, v90
    v_fma_f32 v91, -v95, v61, v91
    v_mfma_f32_16x16x32_bf16 v[108:111], a[124:127], v[52:55], v[108:111]
    v_fma_f32 v88, v88, v128, v62
    v_fma_f32 v89, v89, v129, v62
    v_mfma_f32_16x16x32_bf16 v[108:111], a[128:131], v[52:55], v[108:111]
    v_fma_f32 v90, v90, v130, v62
    v_fma_f32 v91, v91, v131, v62
    v_mfma_f32_16x16x32_bf16 v[108:111], a[132:135], v[52:55], v[108:111]
    v_max3_f32 v1, v88, v89, v90
    v_max_f32 v1, v1, v91
    v_mfma_f32_16x16x32_bf16 v[108:111], a[136:139], v[52:55], v[108:111]
    v_cmp_lt_f32 vcc, s52, v1
    s_cbranch_vccnz L_site0
L_back0:
    v_mfma_f32_16x16x32_bf16 v[108:111], a[140:143], v[52:55], v[108:111]
    v_exp_f32 v96, v88
    v_mfma_f32_16x16x32_bf16 v[104:107], a[120:123], v[136:139], v[76:79]
    v_exp_f32 v97, v89
    v_mfma_f32_16x16x32_bf16 v[104:107], a[124:127], v[140:143], v[104:107]
    v_exp_f32 v98, v90
    v_mfma_f32_16x16x32_bf16 v[104:107], a[128:131], v[144:147], v[104:107]
    v_exp_f32 v99, v91
    v_mfma_f32_16x16x32_bf16 v[104:107], a[132:135], v[148:151], v[104:107]
    s_cmp_eq_u32 s17, 0
    s_cbranch_scc0 L_g46
    s_waitcnt vmcnt(5)
L_g46:
    buffer_load_dwordx4 v25, s[24:27], s59 offen offset:3072 nt lds
    v_mul_f32 v88, v96, v128
    v_mul_f32 v89, v97, v129
    v_mfma_f32_16x16x32_bf16 v[104:107], a[136:139], v[152:155], v[104:107]
    v_mul_f32 v90, v98, v130
    v_mul_f32 v91, v99, v131
    v_mfma_f32_16x16x32_bf16 v[104:107], a[140:143], v[156:159], v[104:107]
    v_fma_f32 v112, v116, 2.0, v112
    v_fma_f32 v113, v117, 2.0, v113
    v_fma_f32 v114, v118, 2.0, v114
    v_fma_f32 v115, v119, 2.0, v115
    v_cndmask_b32 v4, 0, v112, s[44:45]
    v_cndmask_b32 v4, v4, v113, s[46:47]
    v_cndmask_b32 v4, v4, v114, s[48:49]
    v_cndmask_b32 v4, v4, v115, s[50:51]
    v_add_f32 v63, v63, v96
    v_fmac_f32 v64, v88, v92
    v_mfma_f32_16x16x4_f32 v[124:127], v4, v60, v[56:59]
    v_add_f32 v63, v63, v97
    v_fmac_f32 v64, v89, v93
    v_add_f32 v63, v63, v98
    v_fmac_f32 v64, v90, v94
    v_add_f32 v63, v63, v99
    v_fmac_f32 v64, v91, v95
    v_add_f32 v68, v68, v88
    v_add_f32 v69, v69, v89
    v_add_f32 v70, v70, v90
    v_add_f32 v71, v71, v91
    v_add_u32 v44, -49152, v44
    v_add_u32 v45, -49152, v45
    v_add_u32 v46, -49152, v46
    v_add_u32 v47, -49152, v47
    v_add_u32 v48, -49152, v48
    v_add_u32 v49, -49152, v49
    v_fma_f32 v132, -v108, v108, v124
    v_fma_f32 v133, -v109, v109, v125
    v_fma_f32 v134, -v110, v110, v126
    v_fma_f32 v135, -v111, v111, v127
    v_max_f32 v132, v132, v56
    v_max_f32 v133, v133, v56
    v_max_f32 v134, v134, v56
    v_max_f32 v135, v135, v56
    v_rsq_f32 v132, v132
    v_rsq_f32 v133, v133
    v_rsq_f32 v134, v134
    v_rsq_f32 v135, v135
    s_cmp_eq_u32 s17, 0
    s_cbranch_scc0 L_g47
    s_waitcnt vmcnt(5)
L_g47:
    s_add_u32 m0, s42, 4096
    s_nop 0
    buffer_load_dwordx4 v26, s[24:27], s59 offen offset:0 nt lds
    v_fma_f32 v104, -v108, v61, v104
    v_fma_f32 v105, -v109, v61, v105
    v_fma_f32 v106, -v110, v61, v106
    v_fma_f32 v107, -v111, v61, v107
    v_fma_f32 v104, v104, v132, v62
    v_fma_f32 v105, v105, v133, v62
    v_fma_f32 v106, v106, v134, v62
    v_fma_f32 v107, v107, v135, v62
    v_max3_f32 v1, v104, v105, v106
    v_max_f32 v1, v1, v107
    v_cmp_lt_f32 vcc, s52, v1
    s_cbranch_vccnz L_site1
L_back1:
    v_exp_f32 v112, v104
    v_exp_f32 v113, v105
    v_exp_f32 v114, v106
    v_exp_f32 v115, v107
    v_cvt_pk_bf16_f32 v72, v88, v89
    v_cvt_pk_bf16_f32 v73, v90, v91
    v_mul_f32 v104, v112, v132
    v_mul_f32 v105, v113, v133
    v_mul_f32 v106, v114, v134
    v_mul_f32 v107, v115, v135
    v_cvt_pk_bf16_f32 v74, v104, v105
    v_cvt_pk_bf16_f32 v75, v106, v107
    ds_write_b128 v237, v[72:75] offset:0
    v_add_f32 v68, v68, v104
    v_add_f32 v69, v69, v105
    v_add_f32 v70, v70, v106
    v_add_f32 v71, v71, v107
    v_cvt_pk_bf16_f32 v66, v68, v69
    v_cvt_pk_bf16_f32 v67, v70, v71
    ds_write_b64 v238, v[66:67]
    s_waitcnt lgkmcnt(0)
    s_barrier
L_post3:
    ds_read_b32 v9, v254 offset:4096
    ds_read_b64 v[120:121], v254 offset:0
    ds_read_b64 v[122:123], v254 offset:512
    ds_read_b64 v[124:125], v254 offset:1024
    ds_read_b64 v[126:127], v254 offset:1536
    ds_read_b128 v[92:95], v253 offset:0
    ds_read_b128 v[96:99], v253 offset:1024
    ds_read_b128 v[100:103], v253 offset:2048
    ds_read_b128 v[116:119], v253 offset:3072
    ds_read_b128 a[48:51], v34 offset:0
    ds_read_b128 a[52:55], v35 offset:0
    ds_read_b128 a[56:59], v34 offset:128
    ds_read_b128 a[60:63], v35 offset:128
    ds_read_b128 a[64:67], v34 offset:256
    ds_read_b128 a[68:71], v35 offset:256
    s_waitcnt lgkmcnt(14)
    v_cmp_ne_u32 vcc, 0, v9
    s_cbranch_vccnz L_xt3
    s_waitcnt lgkmcnt(12)
    v_mfma_f32_16x16x32_bf16 a[0:3], a[72:75], v[120:123], a[0:3]
    s_cmp_eq_u32 s17, 0
    s_cbranch_scc0 L_g48
    s_waitcnt vmcnt(5)
L_g48:
    buffer_load_dwordx4 v27, s[24:27], s59 offen offset:1024 nt lds
    v_add_f32 v63, v63, v112
    v_fma_f32 v64, v104, v108, v64
    v_mfma_f32_16x16x32_bf16 a[4:7], a[80:83], v[120:123], a[4:7]
    s_cmp_eq_u32 s17, 0
    s_cbranch_scc0 L_g49
    s_waitcnt vmcnt(5)
L_g49:
    buffer_load_dwordx4 v28, s[24:27], s59 offen offset:2048 nt lds
    v_add_f32 v63, v63, v113
    v_fma_f32 v64, v105, v109, v64
    v_mfma_f32_16x16x32_bf16 a[8:11], a[88:91], v[120:123], a[8:11]
    v_add_f32 v63, v63, v114
    v_fma_f32 v64, v106, v110, v64
    s_waitcnt lgkmcnt(10)
    v_mfma_f32_16x16x32_bf16 a[0:3], a[76:79], v[124:127], a[0:3]
    v_add_f32 v63, v63, v115
    v_fma_f32 v64, v107, v111, v64
    v_mfma_f32_16x16x32_bf16 a[4:7], a[84:87], v[124:127], a[4:7]
    v_mfma_f32_16x16x32_bf16 a[8:11], a[92:95], v[124:127], a[8:11]
    s_waitcnt lgkmcnt(9)
    v_mfma_f32_16x16x32_bf16 a[0:3], a[144:147], v[92:95], a[0:3]
    ds_read_b64_tr_b16 a[72:73], v36 offset:0
    ds_read_b64_tr_b16 a[74:75], v36 offset:6144
    v_mfma_f32_16x16x32_bf16 a[4:7], a[160:163], v[92:95], a[4:7]
    ds_read_b64_tr_b16 a[76:77], v36 offset:12288
    ds_read_b64_tr_b16 a[78:79], v36 offset:18432
    v_mfma_f32_16x16x32_bf16 a[8:11], a[176:179], v[92:95], a[8:11]
    ds_read_b64_tr_b16 a[80:81], v37 offset:0
    ds_read_b64_tr_b16 a[82:83], v37 offset:6144
    s_waitcnt lgkmcnt(14)
    v_mfma_f32_16x16x32_bf16 a[0:3], a[148:151], v[96:99], a[0:3]
    ds_read_b64_tr_b16 a[84:85], v37 offset:12288
    ds_read_b64_tr_b16 a[86:87], v37 offset:18432
    v_mfma_f32_16x16x32_bf16 a[4:7], a[164:167], v[96:99], a[4:7]
    s_cmp_eq_u32 s17, 0
    s_cbranch_scc0 L_g50
    s_waitcnt vmcnt(5)
L_g50:
    buffer_load_dwordx4 v29, s[24:27], s59 offen offset:3072 nt lds
    ds_read_b64_tr_b16 a[88:89], v38 offset:0
    ds_read_b64_tr_b16 a[90:91], v38 offset:6144
    v_mfma_f32_16x16x32_bf16 a[8:11], a[180:183], v[96:99], a[8:11]
    ds_read_b64_tr_b16 a[92:93], v38 offset:12288
    ds_read_b64_tr_b16 a[94:95], v38 offset:18432
    s_waitcnt lgkmcnt(15)
    v_mfma_f32_16x16x32_bf16 a[0:3], a[152:155], v[100:103], a[0:3]
    v_mfma_f32_16x16x32_bf16 a[4:7], a[168:171], v[100:103], a[4:7]
    v_mfma_f32_16x16x32_bf16 a[8:11], a[184:187], v[100:103], a[8:11]
    v_mfma_f32_16x16x32_bf16 a[0:3], a[156:159], v[116:119], a[0:3]
    v_mfma_f32_16x16x32_bf16 a[4:7], a[172:175], v[116:119], a[4:7]
    v_mfma_f32_16x16x32_bf16 a[8:11], a[188:191], v[116:119], a[8:11]
    v_mfma_f32_16x16x32_bf16 v[84:87], a[48:51], a[48:51], 0
    v_mfma_f32_16x16x32_bf16 v[80:83], a[48:51], v[52:55], 0
    v_mfma_f32_16x16x32_bf16 v[84:87], a[52:55], a[52:55], v[84:87]
    v_mfma_f32_16x16x32_bf16 v[80:83], a[52:55], v[52:55], v[80:83]
    v_mfma_f32_16x16x32_bf16 v[84:87], a[56:59], a[56:59], v[84:87]
    v_mfma_f32_16x16x32_bf16 v[80:83], a[56:59], v[52:55], v[80:83]
    s_cmp_eq_u32 s17, 0
    s_cbranch_scc0 L_g51
    s_waitcnt vmcnt(5)
L_g51:
    s_add_u32 m0, s42, 8192
    s_nop 0
    buffer_load_dwordx4 v30, s[24:27], s59 offen offset:0 nt lds
    s_waitcnt lgkmcnt(14)
    v_mfma_f32_16x16x32_bf16 v[84:87], a[60:63], a[60:63], v[84:87]
    v_mfma_f32_16x16x32_bf16 v[80:83], a[60:63], v[52:55], v[80:83]
    s_waitcnt lgkmcnt(13)
    v_mfma_f32_16x16x32_bf16 v[84:87], a[64:67], a[64:67], v[84:87]
    v_mfma_f32_16x16x32_bf16 v[80:83], a[64:67], v[52:55], v[80:83]
    s_waitcnt lgkmcnt(12)
    v_mfma_f32_16x16x32_bf16 v[84:87], a[68:71], a[68:71], v[84:87]
    v_mfma_f32_16x16x32_bf16 v[80:83], a[68:71], v[52:55], v[80:83]
    s_waitcnt lgkmcnt(0)
    v_mfma_f32_16x16x32_bf16 v[76:79], a[48:51], v[136:139], 0
    v_mfma_f32_16x16x32_bf16 v[76:79], a[52:55], v[140:143], v[76:79]
    v_mfma_f32_16x16x32_bf16 v[76:79], a[56:59], v[144:147], v[76:79]
    v_mfma_f32_16x16x32_bf16 v[76:79], a[60:63], v[148:151], v[76:79]
    v_mfma_f32_16x16x32_bf16 v[76:79], a[64:67], v[152:155], v[76:79]
    v_mfma_f32_16x16x32_bf16 v[76:79], a[68:71], v[156:159], v[76:79]
    v_lshrrev_b32 v1, 3, v0
    v_and_b32 v2, 6, v1
    v_xor_b32 v2, v0, v2
    v_and_b32 v2, 7, v2
    v_mul_u32_u24 v1, 768, v1
    v_lshl_add_u32 v224, v2, 4, v1
    v_xor_b32 v225, 16, v224
    v_add_u32 v225, 5120, v225
    s_cmp_eq_u32 s17, 0
    s_cbranch_scc0 L_g52
    s_waitcnt vmcnt(5)
L_g52:
    buffer_load_dwordx4 v31, s[24:27], s59 offen offset:1024 nt lds
    s_cmp_eq_u32 s17, 0
    s_cbranch_scc0 L_g53
    s_waitcnt vmcnt(5)
L_g53:
    buffer_load_dwordx4 v32, s[24:27], s59 offen offset:2048 nt lds
    s_waitcnt vmcnt(11)
    s_barrier
    ds_read_b128 a[96:99], v40 offset:0
    ds_read_b128 a[100:103], v41 offset:0
    ds_read_b128 a[104:107], v42 offset:0
    ds_read_b128 a[108:111], v43 offset:0
    ds_read_b128 a[112:115], v40 offset:256
    ds_read_b128 a[116:119], v41 offset:256
    ds_read_b128 a[120:123], v42 offset:256
    ds_read_b128 a[124:127], v43 offset:256
    ds_read_b128 a[128:131], v40 offset:512
    ds_read_b128 a[132:135], v41 offset:512
    ds_read_b128 a[136:139], v42 offset:512
    ds_read_b128 a[140:143], v43 offset:512
    s_waitcnt lgkmcnt(11)
    v_mfma_f32_16x16x32_bf16 v[96:99], a[96:99], a[96:99], v[84:87]
    ds_read_b64_tr_b16 a[144:145], v44 offset:0
    ds_read_b64_tr_b16 a[146:147], v45 offset:0
    v_mfma_f32_16x16x32_bf16 v[100:103], a[96:99], a[48:51], 0
    ds_read_b64_tr_b16 a[148:149], v44 offset:12288
    ds_read_b64_tr_b16 a[150:151], v45 offset:12288
    s_waitcnt lgkmcnt(14)
    v_mfma_f32_16x16x32_bf16 v[96:99], a[100:103], a[100:103], v[96:99]
    ds_read_b64_tr_b16 a[152:153], v44 offset:24576
    ds_read_b64_tr_b16 a[154:155], v45 offset:24576
    v_mfma_f32_16x16x32_bf16 v[100:103], a[100:103], a[52:55], v[100:103]
    ds_read_b64_tr_b16 a[156:157], v44 offset:36864
    ds_read_b64_tr_b16 a[158:159], v45 offset:36864
    s_waitcnt lgkmcnt(15)
    v_mfma_f32_16x16x32_bf16 v[96:99], a[104:107], a[104:107], v[96:99]
    ds_read_b64_tr_b16 a[160:161], v46 offset:0
    ds_read_b64_tr_b16 a[162:163], v47 offset:0
    v_mfma_f32_16x16x32_bf16 v[100:103], a[104:107], a[56:59], v[100:103]
    ds_read_b64_tr_b16 a[164:165], v46 offset:12288
    ds_read_b64_tr_b16 a[166:167], v47 offset:12288
    v_mfma_f32_16x16x32_bf16 v[96:99], a[108:111], a[108:111], v[96:99]
    s_cmp_eq_u32 s17, 0
    s_cbranch_scc0 L_g54
    s_waitcnt vmcnt(5)
L_g54:
    buffer_load_dwordx4 v33, s[24:27], s59 offen offset:3072 nt lds
    ds_read_b64_tr_b16 a[168:169], v46 offset:24576
    ds_read_b64_tr_b16 a[170:171], v47 offset:24576
    v_mfma_f32_16x16x32_bf16 v[100:103], a[108:111], a[60:63], v[100:103]
    ds_read_b64_tr_b16 a[172:173], v46 offset:36864
    ds_read_b64_tr_b16 a[174:175], v47 offset:36864
    v_mfma_f32_16x16x32_bf16 v[96:99], a[112:115], a[112:115], v[96:99]
    ds_read_b64_tr_b16 a[176:177], v48 offset:0
    ds_read_b64_tr_b16 a[178:179], v49 offset:0
    v_mfma_f32_16x16x32_bf16 v[100:103], a[112:115], a[64:67], v[100:103]
    ds_read_b64_tr_b16 a[180:181], v48 offset:12288
    ds_read_b64_tr_b16 a[182:183], v49 offset:12288
    s_waitcnt lgkmcnt(15)
    v_mfma_f32_16x16x32_bf16 v[96:99], a[116:119], a[116:119], v[96:99]
    ds_read_b64_tr_b16 a[184:185], v48 offset:24576
    ds_read_b64_tr_b16 a[186:187], v49 offset:24576
    v_mfma_f32_16x16x32_bf16 v[100:103], a[116:119], a[68:71], v[100:103]
    ds_read_b64_tr_b16 a[188:189], v48 offset:36864
    ds_read_b64_tr_b16 a[190:191], v49 offset:36864
    v_mfma_f32_16x16x32_bf16 v[92:95], a[96:99], v[52:55], v[80:83]
    v_mfma_f32_16x16x32_bf16 v[92:95], a[100:103], v[52:55], v[92:95]
    v_mfma_f32_16x16x32_bf16 v[92:95], a[104:107], v[52:55], v[92:95]
    v_mfma_f32_16x16x32_bf16 v[92:95], a[108:111], v[52:55], v[92:95]
    s_nop 1
    v_fma_f32 v96, v100, 2.0, v96
    v_fma_f32 v97, v101, 2.0, v97
    v_mfma_f32_16x16x32_bf16 v[92:95], a[112:115], v[52:55], v[92:95]
    v_fma_f32 v98, v102, 2.0, v98
    v_fma_f32 v99, v103, 2.0, v99
    v_mfma_f32_16x16x32_bf16 v[92:95], a[116:119], v[52:55], v[92:95]
    v_cndmask_b32 v3, 0, v96, s[44:45]
    v_cndmask_b32 v3, v3, v97, s[46:47]
    v_mfma_f32_16x16x32_bf16 v[88:91], a[96:99], v[136:139], v[76:79]
    s_cmp_eq_u32 s17, 0
    s_cbranch_scc0 L_g55
    s_waitcnt vmcnt(5)
L_g55:
    s_add_u32 m0, s40, 0
    s_add_u32 s57, s36, 12582912
    buffer_load_dwordx4 v16, s[28:31], s57 offen offset:0 nt lds
    v_cndmask_b32 v3, v3, v98, s[48:49]
    v_cndmask_b32 v3, v3, v99, s[50:51]
    v_mfma_f32_16x16x32_bf16 v[88:91], a[100:103], v[140:143], v[88:91]
    s_nop 0
    s_nop 0
    v_mfma_f32_16x16x32_bf16 v[88:91], a[104:107], v[144:147], v[88:91]
    v_mfma_f32_16x16x4_f32 v[120:123], v3, v60, v[56:59]
    v_mfma_f32_16x16x32_bf16 v[88:91], a[108:111], v[148:151], v[88:91]
    v_mfma_f32_16x16x32_bf16 v[88:91], a[112:115], v[152:155], v[88:91]
    v_mfma_f32_16x16x32_bf16 v[88:91], a[116:119], v[156:159], v[88:91]
    v_mfma_f32_16x16x32_bf16 v[112:115], a[120:123], a[120:123], v[84:87]
    v_mfma_f32_16x16x32_bf16 v[116:119], a[120:123], a[48:51], 0
    v_mfma_f32_16x16x32_bf16 v[112:115], a[124:127], a[124:127], v[112:115]
    v_mfma_f32_16x16x32_bf16 v[116:119], a[124:127], a[52:55], v[116:119]
    s_nop 2
    v_fma_f32 v128, -v92, v92, v120
    v_fma_f32 v129, -v93, v93, v121
    v_mfma_f32_16x16x32_bf16 v[112:115], a[128:131], a[128:131], v[112:115]
    v_fma_f32 v130, -v94, v94, v122
    v_fma_f32 v131, -v95, v95, v123
    v_mfma_f32_16x16x32_bf16 v[116:119], a[128:131], a[56:59], v[116:119]
    s_cmp_eq_u32 s17, 0
    s_cbranch_scc0 L_g56
    s_waitcnt vmcnt(5)
L_g56:
    buffer_load_dwordx4 v17, s[28:31], s57 offen offset:1024 nt lds
    v_max_f32 v128, v128, v56
    v_max_f32 v129, v129, v56
    v_mfma_f32_16x16x32_bf16 v[112:115], a[132:135], a[132:135], v[112:115]
    v_max_f32 v130, v130, v56
    v_max_f32 v131, v131, v56
    v_mfma_f32_16x16x32_bf16 v[116:119], a[132:135], a[60:63], v[116:119]
    v_rsq_f32 v128, v128
    v_mfma_f32_16x16x32_bf16 v[112:115], a[136:139], a[136:139], v[112:115]
    v_rsq_f32 v129, v129
    v_mfma_f32_16x16x32_bf16 v[116:119], a[136:139], a[64:67], v[116:119]
    v_rsq_f32 v130, v130
    v_mfma_f32_16x16x32_bf16 v[112:115], a[140:143], a[140:143], v[112:115]
    v_rsq_f32 v131, v131
    v_mfma_f32_16x16x32_bf16 v[116:119], a[140:143], a[68:71], v[116:119]
    v_fma_f32 v88, -v92, v61, v88
    v_fma_f32 v89, -v93, v61, v89
    v_mfma_f32_16x16x32_bf16 v[108:111], a[120:123], v[52:55], v[80:83]
    v_fma_f32 v90, -v94, v61, v90
    v_fma_f32 v91, -v95, v61, v91
    v_mfma_f32_16x16x32_bf16 v[108:111], a[124:127], v[52:55], v[108:111]
    v_fma_f32 v88, v88, v128, v62
    v_fma_f32 v89, v89, v129, v62
    v_mfma_f32_16x16x32_bf16 v[108:111], a[128:131], v[52:55], v[108:111]
    v_fma_f32 v90, v90, v130, v62
    v_fma_f32 v91, v91, v131, v62
    v_mfma_f32_16x16x32_bf16 v[108:111], a[132:135], v[52:55], v[108:111]
    v_max3_f32 v1, v88, v89, v90
    v_max_f32 v1, v1, v91
    v_mfma_f32_16x16x32_bf16 v[108:111], a[136:139], v[52:55], v[108:111]
    v_cmp_lt_f32 vcc, s52, v1
    s_cbranch_vccnz L_site2
L_back2:
    v_mfma_f32_16x16x32_bf16 v[108:111], a[140:143], v[52:55], v[108:111]
    s_cmp_eq_u32 s17, 0
    s_cbranch_scc0 L_g57
    s_waitcnt vmcnt(5)
L_g57:
    buffer_load_dwordx4 v18, s[28:31], s57 offen offset:2048 nt lds
    v_exp_f32 v96, v88
    v_mfma_f32_16x16x32_bf16 v[104:107], a[120:123], v[136:139], v[76:79]
    v_exp_f32 v97, v89
    v_mfma_f32_16x16x32_bf16 v[104:107], a[124:127], v[140:143], v[104:107]
    v_exp_f32 v98, v90
    v_mfma_f32_16x16x32_bf16 v[104:107], a[128:131], v[144:147], v[104:107]
    v_exp_f32 v99, v91
    v_mfma_f32_16x16x32_bf16 v[104:107], a[132:135], v[148:151], v[104:107]
    v_mul_f32 v88, v96, v128
    v_mul_f32 v89, v97, v129
    v_mfma_f32_16x16x32_bf16 v[104:107], a[136:139], v[152:155], v[104:107]
    v_mul_f32 v90, v98, v130
    v_mul_f32 v91, v99, v131
    v_mfma_f32_16x16x32_bf16 v[104:107], a[140:143], v[156:159], v[104:107]
    v_fma_f32 v112, v116, 2.0, v112
    v_fma_f32 v113, v117, 2.0, v113
    v_fma_f32 v114, v118, 2.0, v114
    v_fma_f32 v115, v119, 2.0, v115
    v_cndmask_b32 v4, 0, v112, s[44:45]
    v_cndmask_b32 v4, v4, v113, s[46:47]
    v_cndmask_b32 v4, v4, v114, s[48:49]
    v_cndmask_b32 v4, v4, v115, s[50:51]
    v_add_f32 v63, v63, v96
    v_fmac_f32 v64, v88, v92
    v_mfma_f32_16x16x4_f32 v[124:127], v4, v60, v[56:59]
    v_add_f32 v63, v63, v97
    v_fmac_f32 v64, v89, v93
    v_add_f32 v63, v63, v98
    v_fmac_f32 v64, v90, v94
    v_add_f32 v63, v63, v99
    v_fmac_f32 v64, v91, v95
    v_mov_b32 v68, v88
    v_mov_b32 v69, v89
    v_mov_b32 v70, v90
    v_mov_b32 v71, v91
    v_add_u32 v44, 49152, v44
    v_add_u32 v45, 49152, v45
    v_add_u32 v46, 49152, v46
    v_add_u32 v47, 49152, v47
    v_add_u32 v48, 49152, v48
    v_add_u32 v49, 49152, v49
    v_fma_f32 v132, -v108, v108, v124
    v_fma_f32 v133, -v109, v109, v125
    v_fma_f32 v134, -v110, v110, v126
    v_fma_f32 v135, -v111, v111, v127
    v_max_f32 v132, v132, v56
    v_max_f32 v133, v133, v56
    v_max_f32 v134, v134, v56
    v_max_f32 v135, v135, v56
    v_rsq_f32 v132, v132
    v_rsq_f32 v133, v133
    v_rsq_f32 v134, v134
    v_rsq_f32 v135, v135
    s_cmp_gt_i32 s14, 80
    s_cselect_b32 s17, 2, s0
    s_cmp_eq_u32 s17, 0
    s_cbranch_scc0 L_g58
    s_waitcnt vmcnt(5)
L_g58:
    buffer_load_dwordx4 v19, s[28:31], s57 offen offset:3072 nt lds
    v_fma_f32 v104, -v108, v61, v104
    v_fma_f32 v105, -v109, v61, v105
    v_fma_f32 v106, -v110, v61, v106
    v_fma_f32 v107, -v111, v61, v107
    v_fma_f32 v104, v104, v132, v62
    v_fma_f32 v105, v105, v133, v62
    v_fma_f32 v106, v106, v134, v62
    v_fma_f32 v107, v107, v135, v62
    v_max3_f32 v1, v104, v105, v106
    v_max_f32 v1, v1, v107
    v_cmp_lt_f32 vcc, s52, v1
    s_cbranch_vccnz L_site3
L_back3:
    v_exp_f32 v112, v104
    v_exp_f32 v113, v105
    v_exp_f32 v114, v106
    v_exp_f32 v115, v107
    v_cvt_pk_bf16_f32 v72, v88, v89
    v_cvt_pk_bf16_f32 v73, v90, v91
    v_mul_f32 v104, v112, v132
    v_mul_f32 v105, v113, v133
    v_mul_f32 v106, v114, v134
    v_mul_f32 v107, v115, v135
    v_cvt_pk_bf16_f32 v74, v104, v105
    v_cvt_pk_bf16_f32 v75, v106, v107
    ds_write_b128 v237, v[72:75] offset:0
    s_waitcnt lgkmcnt(0)
    s_barrier
L_post24:
    ds_read_b32 v9, v254 offset:4096
    ds_read_b128 v[92:95], v253 offset:0
    ds_read_b128 v[96:99], v253 offset:1024
    ds_read_b128 v[100:103], v253 offset:2048
    ds_read_b128 v[116:119], v253 offset:3072
    s_waitcnt lgkmcnt(4)
    v_cmp_ne_u32 vcc, 0, v9
    s_cbranch_vccnz L_xt24
    s_waitcnt lgkmcnt(3)
    v_mfma_f32_16x16x32_bf16 a[0:3], a[144:147], v[92:95], a[0:3]
    s_cmp_eq_u32 s17, 0
    s_cbranch_scc0 L_g59
    s_waitcnt vmcnt(5)
L_g59:
    s_add_u32 m0, s40, 4096
    s_nop 0
    buffer_load_dwordx4 v20, s[28:31], s57 offen offset:0 nt lds
    v_add_f32 v68, v68, v104
    v_add_f32 v69, v69, v105
    v_mfma_f32_16x16x32_bf16 a[4:7], a[160:163], v[92:95], a[4:7]
    s_cmp_eq_u32 s17, 0
    s_cbranch_scc0 L_g60
    s_waitcnt vmcnt(5)
L_g60:
    buffer_load_dwordx4 v21, s[28:31], s57 offen offset:1024 nt lds
    v_add_f32 v70, v70, v106
    v_add_f32 v71, v71, v107
    v_mfma_f32_16x16x32_bf16 a[8:11], a[176:179], v[92:95], a[8:11]
    v_add_f32 v63, v63, v112
    v_fma_f32 v64, v104, v108, v64
    s_waitcnt lgkmcnt(2)
    v_mfma_f32_16x16x32_bf16 a[0:3], a[148:151], v[96:99], a[0:3]
    v_add_f32 v63, v63, v113
    v_fma_f32 v64, v105, v109, v64
    v_mfma_f32_16x16x32_bf16 a[4:7], a[164:167], v[96:99], a[4:7]
    v_add_f32 v63, v63, v114
    v_fma_f32 v64, v106, v110, v64
    v_mfma_f32_16x16x32_bf16 a[8:11], a[180:183], v[96:99], a[8:11]
    v_add_f32 v63, v63, v115
    v_fma_f32 v64, v107, v111, v64
    s_waitcnt lgkmcnt(1)
    v_mfma_f32_16x16x32_bf16 a[0:3], a[152:155], v[100:103], a[0:3]
    v_mfma_f32_16x16x32_bf16 a[4:7], a[168:171], v[100:103], a[4:7]
    v_mfma_f32_16x16x32_bf16 a[8:11], a[184:187], v[100:103], a[8:11]
    s_waitcnt lgkmcnt(0)
    v_mfma_f32_16x16x32_bf16 a[0:3], a[156:159], v[116:119], a[0:3]
    buffer_load_dwordx2 v[234:235], v245, s[32:35], 0 offen offset:128 sc1
    v_mfma_f32_16x16x32_bf16 a[4:7], a[172:175], v[116:119], a[4:7]
    v_mfma_f32_16x16x32_bf16 a[8:11], a[188:191], v[116:119], a[8:11]
    s_cmp_eq_u32 s17, 0
    s_cbranch_scc0 L_g61
    s_waitcnt vmcnt(6)
L_g61:
    s_add_u32 m0, s41, 0
    s_add_u32 s58, s37, 50331648
    buffer_load_dwordx4 v22, s[24:27], s58 offen offset:0 nt lds
    s_cmp_eq_u32 s17, 0
    s_cbranch_scc0 L_g62
    s_waitcnt vmcnt(6)
L_g62:
    buffer_load_dwordx4 v23, s[24:27], s58 offen offset:1024 nt lds
    s_cmp_eq_u32 s17, 0
    s_cbranch_scc0 L_g63
    s_waitcnt vmcnt(6)
L_g63:
    buffer_load_dwordx4 v24, s[24:27], s58 offen offset:2048 nt lds
    s_cmp_eq_u32 s17, 0
    s_cbranch_scc0 L_g64
    s_waitcnt vmcnt(6)
L_g64:
    buffer_load_dwordx4 v25, s[24:27], s58 offen offset:3072 nt lds
    s_waitcnt vmcnt(11)
    s_barrier
    ds_read_b128 a[96:99], v40 offset:49152
    ds_read_b128 a[100:103], v41 offset:49152
    ds_read_b128 a[104:107], v42 offset:49152
    ds_read_b128 a[108:111], v43 offset:49152
    ds_read_b128 a[112:115], v40 offset:49408
    ds_read_b128 a[116:119], v41 offset:49408
    ds_read_b128 a[120:123], v42 offset:49408
    ds_read_b128 a[124:127], v43 offset:49408
    ds_read_b128 a[128:131], v40 offset:49664
    ds_read_b128 a[132:135], v41 offset:49664
    ds_read_b128 a[136:139], v42 offset:49664
    ds_read_b128 a[140:143], v43 offset:49664
    s_waitcnt lgkmcnt(11)
    v_mfma_f32_16x16x32_bf16 v[96:99], a[96:99], a[96:99], v[84:87]
    ds_read_b64_tr_b16 a[144:145], v44 offset:0
    ds_read_b64_tr_b16 a[146:147], v45 offset:0
    v_mfma_f32_16x16x32_bf16 v[100:103], a[96:99], a[48:51], 0
    ds_read_b64_tr_b16 a[148:149], v44 offset:12288
    ds_read_b64_tr_b16 a[150:151], v45 offset:12288
    s_waitcnt lgkmcnt(14)
    v_mfma_f32_16x16x32_bf16 v[96:99], a[100:103], a[100:103], v[96:99]
    ds_read_b64_tr_b16 a[152:153], v44 offset:24576
    ds_read_b64_tr_b16 a[154:155], v45 offset:24576
    v_mfma_f32_16x16x32_bf16 v[100:103], a[100:103], a[52:55], v[100:103]
    ds_read_b64_tr_b16 a[156:157], v44 offset:36864
    ds_read_b64_tr_b16 a[158:159], v45 offset:36864
    s_waitcnt lgkmcnt(15)
    v_mfma_f32_16x16x32_bf16 v[96:99], a[104:107], a[104:107], v[96:99]
    ds_read_b64_tr_b16 a[160:161], v46 offset:0
    ds_read_b64_tr_b16 a[162:163], v47 offset:0
    v_mfma_f32_16x16x32_bf16 v[100:103], a[104:107], a[56:59], v[100:103]
    ds_read_b64_tr_b16 a[164:165], v46 offset:12288
    ds_read_b64_tr_b16 a[166:167], v47 offset:12288
    v_mfma_f32_16x16x32_bf16 v[96:99], a[108:111], a[108:111], v[96:99]
    s_cmp_eq_u32 s17, 0
    s_cbranch_scc0 L_g65
    s_waitcnt vmcnt(6)
L_g65:
    s_add_u32 m0, s41, 4096
    s_nop 0
    buffer_load_dwordx4 v26, s[24:27], s58 offen offset:0 nt lds
    ds_read_b64_tr_b16 a[168:169], v46 offset:24576
    ds_read_b64_tr_b16 a[170:171], v47 offset:24576
    v_mfma_f32_16x16x32_bf16 v[100:103], a[108:111], a[60:63], v[100:103]
    ds_read_b64_tr_b16 a[172:173], v46 offset:36864
    ds_read_b64_tr_b16 a[174:175], v47 offset:36864
    v_mfma_f32_16x16x32_bf16 v[96:99], a[112:115], a[112:115], v[96:99]
    ds_read_b64_tr_b16 a[176:177], v48 offset:0
    ds_read_b64_tr_b16 a[178:179], v49 offset:0
    v_mfma_f32_16x16x32_bf16 v[100:103], a[112:115], a[64:67], v[100:103]
    ds_read_b64_tr_b16 a[180:181], v48 offset:12288
    ds_read_b64_tr_b16 a[182:183], v49 offset:12288
    s_waitcnt lgkmcnt(15)
    v_mfma_f32_16x16x32_bf16 v[96:99], a[116:119], a[116:119], v[96:99]
    ds_read_b64_tr_b16 a[184:185], v48 offset:24576
    ds_read_b64_tr_b16 a[186:187], v49 offset:24576
    v_mfma_f32_16x16x32_bf16 v[100:103], a[116:119], a[68:71], v[100:103]
    ds_read_b64_tr_b16 a[188:189], v48 offset:36864
    ds_read_b64_tr_b16 a[190:191], v49 offset:36864
    v_mfma_f32_16x16x32_bf16 v[92:95], a[96:99], v[52:55], v[80:83]
    v_mfma_f32_16x16x32_bf16 v[92:95], a[100:103], v[52:55], v[92:95]
    v_mfma_f32_16x16x32_bf16 v[92:95], a[104:107], v[52:55], v[92:95]
    v_mfma_f32_16x16x32_bf16 v[92:95], a[108:111], v[52:55], v[92:95]
    s_nop 1
    v_fma_f32 v96, v100, 2.0, v96
    v_fma_f32 v97, v101, 2.0, v97
    v_mfma_f32_16x16x32_bf16 v[92:95], a[112:115], v[52:55], v[92:95]
    v_fma_f32 v98, v102, 2.0, v98
    v_fma_f32 v99, v103, 2.0, v99
    v_mfma_f32_16x16x32_bf16 v[92:95], a[116:119], v[52:55], v[92:95]
    v_cndmask_b32 v3, 0, v96, s[44:45]
    v_cndmask_b32 v3, v3, v97, s[46:47]
    v_mfma_f32_16x16x32_bf16 v[88:91], a[96:99], v[136:139], v[76:79]
    s_cmp_eq_u32 s17, 0
    s_cbranch_scc0 L_g66
    s_waitcnt vmcnt(6)
L_g66:
    buffer_load_dwordx4 v27, s[24:27], s58 offen offset:1024 nt lds
    v_cndmask_b32 v3, v3, v98, s[48:49]
    v_cndmask_b32 v3, v3, v99, s[50:51]
    v_mfma_f32_16x16x32_bf16 v[88:91], a[100:103], v[140:143], v[88:91]
    s_nop 0
    s_nop 0
    v_mfma_f32_16x16x32_bf16 v[88:91], a[104:107], v[144:147], v[88:91]
    v_mfma_f32_16x16x4_f32 v[120:123], v3, v60, v[56:59]
    v_mfma_f32_16x16x32_bf16 v[88:91], a[108:111], v[148:151], v[88:91]
    v_mfma_f32_16x16x32_bf16 v[88:91], a[112:115], v[152:155], v[88:91]
    v_mfma_f32_16x16x32_bf16 v[88:91], a[116:119], v[156:159], v[88:91]
    v_mfma_f32_16x16x32_bf16 v[112:115], a[120:123], a[120:123], v[84:87]
    v_mfma_f32_16x16x32_bf16 v[116:119], a[120:123], a[48:51], 0
    v_mfma_f32_16x16x32_bf16 v[112:115], a[124:127], a[124:127], v[112:115]
    v_mfma_f32_16x16x32_bf16 v[116:119], a[124:127], a[52:55], v[116:119]
    s_nop 2
    v_fma_f32 v128, -v92, v92, v120
    v_fma_f32 v129, -v93, v93, v121
    v_mfma_f32_16x16x32_bf16 v[112:115], a[128:131], a[128:131], v[112:115]
    v_fma_f32 v130, -v94, v94, v122
    v_fma_f32 v131, -v95, v95, v123
    v_mfma_f32_16x16x32_bf16 v[116:119], a[128:131], a[56:59], v[116:119]
    s_cmp_eq_u32 s17, 0
    s_cbranch_scc0 L_g67
    s_waitcnt vmcnt(5)
L_g67:
    buffer_load_dwordx4 v28, s[24:27], s58 offen offset:2048 nt lds
    v_max_f32 v128, v128, v56
    v_max_f32 v129, v129, v56
    v_mfma_f32_16x16x32_bf16 v[112:115], a[132:135], a[132:135], v[112:115]
    v_max_f32 v130, v130, v56
    v_max_f32 v131, v131, v56
    v_mfma_f32_16x16x32_bf16 v[116:119], a[132:135], a[60:63], v[116:119]
    v_rsq_f32 v128, v128
    v_mfma_f32_16x16x32_bf16 v[112:115], a[136:139], a[136:139], v[112:115]
    v_rsq_f32 v129, v129
    v_mfma_f32_16x16x32_bf16 v[116:119], a[136:139], a[64:67], v[116:119]
    v_rsq_f32 v130, v130
    v_mfma_f32_16x16x32_bf16 v[112:115], a[140:143], a[140:143], v[112:115]
    v_rsq_f32 v131, v131
    v_mfma_f32_16x16x32_bf16 v[116:119], a[140:143], a[68:71], v[116:119]
    v_fma_f32 v88, -v92, v61, v88
    v_fma_f32 v89, -v93, v61, v89
    v_mfma_f32_16x16x32_bf16 v[108:111], a[120:123], v[52:55], v[80:83]
    v_fma_f32 v90, -v94, v61, v90
    v_fma_f32 v91, -v95, v61, v91
    v_mfma_f32_16x16x32_bf16 v[108:111], a[124:127], v[52:55], v[108:111]
    v_fma_f32 v88, v88, v128, v62
    v_fma_f32 v89, v89, v129, v62
    v_mfma_f32_16x16x32_bf16 v[108:111], a[128:131], v[52:55], v[108:111]
    v_fma_f32 v90, v90, v130, v62
    v_fma_f32 v91, v91, v131, v62
    v_mfma_f32_16x16x32_bf16 v[108:111], a[132:135], v[52:55], v[108:111]
    v_max3_f32 v1, v88, v89, v90
    v_max_f32 v1, v1, v91
    v_mfma_f32_16x16x32_bf16 v[108:111], a[136:139], v[52:55], v[108:111]
    v_cmp_lt_f32 vcc, s52, v1
    s_cbranch_vccnz L_site4
L_back4:
    v_mfma_f32_16x16x32_bf16 v[108:111], a[140:143], v[52:55], v[108:111]
    v_exp_f32 v96, v88
    v_mfma_f32_16x16x32_bf16 v[104:107], a[120:123], v[136:139], v[76:79]
    s_cmp_eq_u32 s17, 0
    s_cbranch_scc0 L_g68
    s_waitcnt vmcnt(5)
L_g68:
    buffer_load_dwordx4 v29, s[24:27], s58 offen offset:3072 nt lds
    v_exp_f32 v97, v89
    v_mfma_f32_16x16x32_bf16 v[104:107], a[124:127], v[140:143], v[104:107]
    v_exp_f32 v98, v90
    v_mfma_f32_16x16x32_bf16 v[104:107], a[128:131], v[144:147], v[104:107]
    v_exp_f32 v99, v91
    v_mfma_f32_16x16x32_bf16 v[104:107], a[132:135], v[148:151], v[104:107]
    v_mul_f32 v88, v96, v128
    v_mul_f32 v89, v97, v129
    v_mfma_f32_16x16x32_bf16 v[104:107], a[136:139], v[152:155], v[104:107]
    v_mul_f32 v90, v98, v130
    v_mul_f32 v91, v99, v131
    v_mfma_f32_16x16x32_bf16 v[104:107], a[140:143], v[156:159], v[104:107]
    v_fma_f32 v112, v116, 2.0, v112
    v_fma_f32 v113, v117, 2.0, v113
    v_fma_f32 v114, v118, 2.0, v114
    v_fma_f32 v115, v119, 2.0, v115
    v_cndmask_b32 v4, 0, v112, s[44:45]
    v_cndmask_b32 v4, v4, v113, s[46:47]
    v_cndmask_b32 v4, v4, v114, s[48:49]
    v_cndmask_b32 v4, v4, v115, s[50:51]
    v_add_f32 v63, v63, v96
    v_fmac_f32 v64, v88, v92
    v_mfma_f32_16x16x4_f32 v[124:127], v4, v60, v[56:59]
    v_add_f32 v63, v63, v97
    v_fmac_f32 v64, v89, v93
    v_add_f32 v63, v63, v98
    v_fmac_f32 v64, v90, v94
    v_add_f32 v63, v63, v99
    v_fmac_f32 v64, v91, v95
    v_add_f32 v68, v68, v88
    v_add_f32 v69, v69, v89
    v_add_f32 v70, v70, v90
    v_add_f32 v71, v71, v91
    v_add_u32 v44, -49152, v44
    v_add_u32 v45, -49152, v45
    v_add_u32 v46, -49152, v46
    v_add_u32 v47, -49152, v47
    v_add_u32 v48, -49152, v48
    v_add_u32 v49, -49152, v49
    v_fma_f32 v132, -v108, v108, v124
    v_fma_f32 v133, -v109, v109, v125
    v_fma_f32 v134, -v110, v110, v126
    v_fma_f32 v135, -v111, v111, v127
    v_max_f32 v132, v132, v56
    v_max_f32 v133, v133, v56
    v_max_f32 v134, v134, v56
    v_max_f32 v135, v135, v56
    v_rsq_f32 v132, v132
    v_rsq_f32 v133, v133
    v_rsq_f32 v134, v134
    v_rsq_f32 v135, v135
    s_cmp_eq_u32 s17, 0
    s_cbranch_scc0 L_g69
    s_waitcnt vmcnt(5)
L_g69:
    s_add_u32 m0, s41, 8192
    s_nop 0
    buffer_load_dwordx4 v30, s[24:27], s58 offen offset:0 nt lds
    v_fma_f32 v104, -v108, v61, v104
    v_fma_f32 v105, -v109, v61, v105
    v_fma_f32 v106, -v110, v61, v106
    v_fma_f32 v107, -v111, v61, v107
    v_fma_f32 v104, v104, v132, v62
    v_fma_f32 v105, v105, v133, v62
    v_fma_f32 v106, v106, v134, v62
    v_fma_f32 v107, v107, v135, v62
    v_max3_f32 v1, v104, v105, v106
    v_max_f32 v1, v1, v107
    v_cmp_lt_f32 vcc, s52, v1
    s_cbranch_vccnz L_site5
L_back5:
    v_exp_f32 v112, v104
    v_exp_f32 v113, v105
    v_exp_f32 v114, v106
    v_exp_f32 v115, v107
    v_cvt_pk_bf16_f32 v72, v88, v89
    v_cvt_pk_bf16_f32 v73, v90, v91
    v_mul_f32 v104, v112, v132
    v_mul_f32 v105, v113, v133
    v_mul_f32 v106, v114, v134
    v_mul_f32 v107, v115, v135
    v_cvt_pk_bf16_f32 v74, v104, v105
    v_cvt_pk_bf16_f32 v75, v106, v107
    ds_write_b128 v237, v[72:75] offset:0
    v_add_f32 v68, v68, v104
    v_add_f32 v69, v69, v105
    v_add_f32 v70, v70, v106
    v_add_f32 v71, v71, v107
    v_cvt_pk_bf16_f32 v66, v68, v69
    v_cvt_pk_bf16_f32 v67, v70, v71
    ds_write_b64 v238, v[66:67]
    s_cmp_eq_u32 s17, 0
    s_cbranch_scc0 L_g70
    s_waitcnt vmcnt(5)
L_g70:
    buffer_load_dwordx4 v31, s[24:27], s58 offen offset:1024 nt lds
    s_cmp_eq_u32 s17, 0
    s_cbranch_scc0 L_g71
    s_waitcnt vmcnt(5)
L_g71:
    buffer_load_dwordx4 v32, s[24:27], s58 offen offset:2048 nt lds
    s_waitcnt vmcnt(12)
    s_waitcnt vmcnt(11)
    v_cmp_ne_u32 vcc, s39, v234
    s_cbranch_vccnz L_fl_retry
L_fl_ok:
    v_readlane_b32 s20, v235, 3
    v_readlane_b32 s21, v235, 4
    s_sub_u32 s20, s20, s21
    v_readlane_b32 s21, v235, 5
    s_add_u32 s20, s20, s21
    v_readlane_b32 s21, v235, 6
    s_sub_u32 s20, s20, s21
    v_readlane_b32 s21, v235, 7
    s_add_u32 s20, s20, s21
    v_readlane_b32 s21, v235, 8
    s_sub_u32 s20, s20, s21
    s_lshr_b32 s1, s20, 31
    s_waitcnt lgkmcnt(0)
    s_barrier
L_post6:
    ds_read_b32 v9, v254 offset:4096
    ds_read_b64 v[120:121], v254 offset:0
    ds_read_b64 v[122:123], v254 offset:512
    ds_read_b64 v[124:125], v254 offset:1024
    ds_read_b64 v[126:127], v254 offset:1536
    ds_read_b128 v[92:95], v253 offset:0
    ds_read_b128 v[96:99], v253 offset:1024
    ds_read_b128 v[100:103], v253 offset:2048
    ds_read_b128 v[116:119], v253 offset:3072
    ds_read_b128 a[48:51], v34 offset:0
    ds_read_b128 a[52:55], v35 offset:0
    ds_read_b128 a[56:59], v34 offset:128
    ds_read_b128 a[60:63], v35 offset:128
    ds_read_b128 a[64:67], v34 offset:256
    ds_read_b128 a[68:71], v35 offset:256
    s_waitcnt lgkmcnt(14)
    v_cmp_ne_u32 vcc, 0, v9
    s_cbranch_vccnz L_xt6
    s_waitcnt lgkmcnt(12)
    v_mfma_f32_16x16x32_bf16 a[0:3], a[72:75], v[120:123], a[0:3]
    s_cmp_gt_i32 s14, 200
    s_cselect_b32 s17, 2, s0
    s_cmp_eq_u32 s17, 0
    s_cbranch_scc0 L_g72
    s_waitcnt vmcnt(5)
L_g72:
    buffer_load_dwordx4 v33, s[24:27], s58 offen offset:3072 nt lds
    v_add_f32 v63, v63, v112
    v_fma_f32 v64, v104, v108, v64
    v_mfma_f32_16x16x32_bf16 a[4:7], a[80:83], v[120:123], a[4:7]
    v_add_f32 v63, v63, v113
    v_fma_f32 v64, v105, v109, v64
    v_mfma_f32_16x16x32_bf16 a[8:11], a[88:91], v[120:123], a[8:11]
    v_add_f32 v63, v63, v114
    v_fma_f32 v64, v106, v110, v64
    s_waitcnt lgkmcnt(10)
    v_mfma_f32_16x16x32_bf16 a[0:3], a[76:79], v[124:127], a[0:3]
    v_add_f32 v63, v63, v115
    v_fma_f32 v64, v107, v111, v64
    v_mfma_f32_16x16x32_bf16 a[4:7], a[84:87], v[124:127], a[4:7]
    v_mfma_f32_16x16x32_bf16 a[8:11], a[92:95], v[124:127], a[8:11]
    s_waitcnt lgkmcnt(9)
    v_mfma_f32_16x16x32_bf16 a[0:3], a[144:147], v[92:95], a[0:3]
    ds_read_b64_tr_b16 a[72:73], v36 offset:0
    ds_read_b64_tr_b16 a[74:75], v36 offset:6144
    v_mfma_f32_16x16x32_bf16 a[4:7], a[160:163], v[92:95], a[4:7]
    s_cmp_eq_u32 s17, 0
    s_cbranch_scc0 L_g73
    s_waitcnt vmcnt(5)
L_g73:
    s_add_u32 m0, s42, 0
    s_add_u32 s59, s37, 50528256
    buffer_load_dwordx4 v22, s[24:27], s59 offen offset:0 nt lds
    ds_read_b64_tr_b16 a[76:77], v36 offset:12288
    ds_read_b64_tr_b16 a[78:79], v36 offset:18432
    v_mfma_f32_16x16x32_bf16 a[8:11], a[176:179], v[92:95], a[8:11]
    ds_read_b64_tr_b16 a[80:81], v37 offset:0
    ds_read_b64_tr_b16 a[82:83], v37 offset:6144
    s_waitcnt lgkmcnt(14)
    v_mfma_f32_16x16x32_bf16 a[0:3], a[148:151], v[96:99], a[0:3]
    ds_read_b64_tr_b16 a[84:85], v37 offset:12288
    ds_read_b64_tr_b16 a[86:87], v37 offset:18432
    v_mfma_f32_16x16x32_bf16 a[4:7], a[164:167], v[96:99], a[4:7]
    ds_read_b64_tr_b16 a[88:89], v38 offset:0
    ds_read_b64_tr_b16 a[90:91], v38 offset:6144
    v_mfma_f32_16x16x32_bf16 a[8:11], a[180:183], v[96:99], a[8:11]
    ds_read_b64_tr_b16 a[92:93], v38 offset:12288
    ds_read_b64_tr_b16 a[94:95], v38 offset:18432
    s_waitcnt lgkmcnt(15)
    v_mfma_f32_16x16x32_bf16 a[0:3], a[152:155], v[100:103], a[0:3]
    v_mfma_f32_16x16x32_bf16 a[4:7], a[168:171], v[100:103], a[4:7]
    v_mfma_f32_16x16x32_bf16 a[8:11], a[184:187], v[100:103], a[8:11]
    v_mfma_f32_16x16x32_bf16 a[0:3], a[156:159], v[116:119], a[0:3]
    v_mfma_f32_16x16x32_bf16 a[4:7], a[172:175], v[116:119], a[4:7]
    v_mfma_f32_16x16x32_bf16 a[8:11], a[188:191], v[116:119], a[8:11]
    v_mfma_f32_16x16x32_bf16 v[84:87], a[48:51], a[48:51], 0
    s_cmp_eq_u32 s17, 0
    s_cbranch_scc0 L_g74
    s_waitcnt vmcnt(5)
L_g74:
    buffer_load_dwordx4 v23, s[24:27], s59 offen offset:1024 nt lds
    v_mfma_f32_16x16x32_bf16 v[80:83], a[48:51], v[52:55], 0
    v_mfma_f32_16x16x32_bf16 v[84:87], a[52:55], a[52:55], v[84:87]
    v_mfma_f32_16x16x32_bf16 v[80:83], a[52:55], v[52:55], v[80:83]
    v_mfma_f32_16x16x32_bf16 v[84:87], a[56:59], a[56:59], v[84:87]
    v_mfma_f32_16x16x32_bf16 v[80:83], a[56:59], v[52:55], v[80:83]
    s_waitcnt lgkmcnt(14)
    v_mfma_f32_16x16x32_bf16 v[84:87], a[60:63], a[60:63], v[84:87]
    v_mfma_f32_16x16x32_bf16 v[80:83], a[60:63], v[52:55], v[80:83]
    s_waitcnt lgkmcnt(13)
    v_mfma_f32_16x16x32_bf16 v[84:87], a[64:67], a[64:67], v[84:87]
    v_mfma_f32_16x16x32_bf16 v[80:83], a[64:67], v[52:55], v[80:83]
    s_waitcnt lgkmcnt(12)
    v_mfma_f32_16x16x32_bf16 v[84:87], a[68:71], a[68:71], v[84:87]
    v_mfma_f32_16x16x32_bf16 v[80:83], a[68:71], v[52:55], v[80:83]
    s_waitcnt lgkmcnt(0)
    v_mfma_f32_16x16x32_bf16 v[76:79], a[48:51], v[136:139], 0
    v_mfma_f32_16x16x32_bf16 v[76:79], a[52:55], v[140:143], v[76:79]
    v_mfma_f32_16x16x32_bf16 v[76:79], a[56:59], v[144:147], v[76:79]
    s_add_u32 s61, s60, 3145728
    buffer_load_dwordx4 v[160:163], v65, s[72:75], s61 offen offset:0 sc1
    v_mfma_f32_16x16x32_bf16 v[76:79], a[60:63], v[148:151], v[76:79]
    v_mfma_f32_16x16x32_bf16 v[76:79], a[64:67], v[152:155], v[76:79]
    v_mfma_f32_16x16x32_bf16 v[76:79], a[68:71], v[156:159], v[76:79]
    s_cmp_eq_u32 s17, 0
    s_cbranch_scc0 L_g75
    s_waitcnt vmcnt(6)
L_g75:
    buffer_load_dwordx4 v24, s[24:27], s59 offen offset:2048 nt lds
    s_cmp_eq_u32 s17, 0
    s_cbranch_scc0 L_g76
    s_waitcnt vmcnt(6)
L_g76:
    buffer_load_dwordx4 v25, s[24:27], s59 offen offset:3072 nt lds
    buffer_load_dwordx4 v[164:167], v65, s[72:75], s61 offen offset:1024 sc1
    s_cmp_eq_u32 s17, 0
    s_cbranch_scc0 L_g77
    s_waitcnt vmcnt(7)
L_g77:
    s_add_u32 m0, s42, 4096
    s_nop 0
    buffer_load_dwordx4 v26, s[24:27], s59 offen offset:0 nt lds
    s_cmp_eq_u32 s17, 0
    s_cbranch_scc0 L_g78
    s_waitcnt vmcnt(7)
L_g78:
    buffer_load_dwordx4 v27, s[24:27], s59 offen offset:1024 nt lds
    s_cmp_eq_u32 s17, 0
    s_cbranch_scc0 L_g79
    s_waitcnt vmcnt(7)
L_g79:
    buffer_load_dwordx4 v28, s[24:27], s59 offen offset:2048 nt lds
    buffer_load_dwordx4 v[168:171], v65, s[72:75], s61 offen offset:2048 sc1
    s_cmp_eq_u32 s17, 0
    s_cbranch_scc0 L_g80
    s_waitcnt vmcnt(8)
L_g80:
    buffer_load_dwordx4 v29, s[24:27], s59 offen offset:3072 nt lds
    s_waitcnt vmcnt(11)
    s_barrier
    ds_read_b128 a[96:99], v40 offset:0
    ds_read_b128 a[100:103], v41 offset:0
    ds_read_b128 a[104:107], v42 offset:0
    ds_read_b128 a[108:111], v43 offset:0
    ds_read_b128 a[112:115], v40 offset:256
    ds_read_b128 a[116:119], v41 offset:256
    ds_read_b128 a[120:123], v42 offset:256
    ds_read_b128 a[124:127], v43 offset:256
    ds_read_b128 a[128:131], v40 offset:512
    ds_read_b128 a[132:135], v41 offset:512
    ds_read_b128 a[136:139], v42 offset:512
    ds_read_b128 a[140:143], v43 offset:512
    s_waitcnt lgkmcnt(11)
    v_mfma_f32_16x16x32_bf16 v[96:99], a[96:99], a[96:99], v[84:87]
    ds_read_b64_tr_b16 a[144:145], v44 offset:0
    ds_read_b64_tr_b16 a[146:147], v45 offset:0
    v_mfma_f32_16x16x32_bf16 v[100:103], a[96:99], a[48:51], 0
    ds_read_b64_tr_b16 a[148:149], v44 offset:12288
    ds_read_b64_tr_b16 a[150:151], v45 offset:12288
    s_waitcnt lgkmcnt(14)
    v_mfma_f32_16x16x32_bf16 v[96:99], a[100:103], a[100:103], v[96:99]
    ds_read_b64_tr_b16 a[152:153], v44 offset:24576
    ds_read_b64_tr_b16 a[154:155], v45 offset:24576
    v_mfma_f32_16x16x32_bf16 v[100:103], a[100:103], a[52:55], v[100:103]
    ds_read_b64_tr_b16 a[156:157], v44 offset:36864
    ds_read_b64_tr_b16 a[158:159], v45 offset:36864
    s_waitcnt lgkmcnt(15)
    v_mfma_f32_16x16x32_bf16 v[96:99], a[104:107], a[104:107], v[96:99]
    ds_read_b64_tr_b16 a[160:161], v46 offset:0
    ds_read_b64_tr_b16 a[162:163], v47 offset:0
    v_mfma_f32_16x16x32_bf16 v[100:103], a[104:107], a[56:59], v[100:103]
    ds_read_b64_tr_b16 a[164:165], v46 offset:12288
    ds_read_b64_tr_b16 a[166:167], v47 offset:12288
    v_mfma_f32_16x16x32_bf16 v[96:99], a[108:111], a[108:111], v[96:99]
    s_cmp_eq_u32 s17, 0
    s_cbranch_scc0 L_g81
    s_waitcnt vmcnt(7)
L_g81:
    s_add_u32 m0, s42, 8192
    s_nop 0
    buffer_load_dwordx4 v30, s[24:27], s59 offen offset:0 nt lds
    ds_read_b64_tr_b16 a[168:169], v46 offset:24576
    ds_read_b64_tr_b16 a[170:171], v47 offset:24576
    v_mfma_f32_16x16x32_bf16 v[100:103], a[108:111], a[60:63], v[100:103]
    ds_read_b64_tr_b16 a[172:173], v46 offset:36864
    ds_read_b64_tr_b16 a[174:175], v47 offset:36864
    v_mfma_f32_16x16x32_bf16 v[96:99], a[112:115], a[112:115], v[96:99]
    ds_read_b64_tr_b16 a[176:177], v48 offset:0
    ds_read_b64_tr_b16 a[178:179], v49 offset:0
    v_mfma_f32_16x16x32_bf16 v[100:103], a[112:115], a[64:67], v[100:103]
    ds_read_b64_tr_b16 a[180:181], v48 offset:12288
    ds_read_b64_tr_b16 a[182:183], v49 offset:12288
    s_waitcnt lgkmcnt(15)
    v_mfma_f32_16x16x32_bf16 v[96:99], a[116:119], a[116:119], v[96:99]
    ds_read_b64_tr_b16 a[184:185], v48 offset:24576
    ds_read_b64_tr_b16 a[186:187], v49 offset:24576
    v_mfma_f32_16x16x32_bf16 v[100:103], a[116:119], a[68:71], v[100:103]
    ds_read_b64_tr_b16 a[188:189], v48 offset:36864
    ds_read_b64_tr_b16 a[190:191], v49 offset:36864
    v_mfma_f32_16x16x32_bf16 v[92:95], a[96:99], v[52:55], v[80:83]
    v_mfma_f32_16x16x32_bf16 v[92:95], a[100:103], v[52:55], v[92:95]
    v_mfma_f32_16x16x32_bf16 v[92:95], a[104:107], v[52:55], v[92:95]
    v_mfma_f32_16x16x32_bf16 v[92:95], a[108:111], v[52:55], v[92:95]
    s_nop 1
    v_fma_f32 v96, v100, 2.0, v96
    v_fma_f32 v97, v101, 2.0, v97
    v_mfma_f32_16x16x32_bf16 v[92:95], a[112:115], v[52:55], v[92:95]
    v_fma_f32 v98, v102, 2.0, v98
    v_fma_f32 v99, v103, 2.0, v99
    v_mfma_f32_16x16x32_bf16 v[92:95], a[116:119], v[52:55], v[92:95]
    v_cndmask_b32 v3, 0, v96, s[44:45]
    v_cndmask_b32 v3, v3, v97, s[46:47]
    v_mfma_f32_16x16x32_bf16 v[88:91], a[96:99], v[136:139], v[76:79]
    buffer_load_dwordx4 v[172:175], v65, s[72:75], s61 offen offset:3072 sc1
    v_cndmask_b32 v3, v3, v98, s[48:49]
    v_cndmask_b32 v3, v3, v99, s[50:51]
    v_mfma_f32_16x16x32_bf16 v[88:91], a[100:103], v[140:143], v[88:91]
    s_cmp_eq_u32 s17, 0
    s_cbranch_scc0 L_g82
    s_waitcnt vmcnt(8)
L_g82:
    buffer_load_dwordx4 v31, s[24:27], s59 offen offset:1024 nt lds
    s_nop 0
    s_nop 0
    v_mfma_f32_16x16x32_bf16 v[88:91], a[104:107], v[144:147], v[88:91]
    v_mfma_f32_16x16x4_f32 v[120:123], v3, v60, v[56:59]
    v_mfma_f32_16x16x32_bf16 v[88:91], a[108:111], v[148:151], v[88:91]
    v_mfma_f32_16x16x32_bf16 v[88:91], a[112:115], v[152:155], v[88:91]
    v_mfma_f32_16x16x32_bf16 v[88:91], a[116:119], v[156:159], v[88:91]
    v_mfma_f32_16x16x32_bf16 v[112:115], a[120:123], a[120:123], v[84:87]
    v_mfma_f32_16x16x32_bf16 v[116:119], a[120:123], a[48:51], 0
    v_mfma_f32_16x16x32_bf16 v[112:115], a[124:127], a[124:127], v[112:115]
    v_mfma_f32_16x16x32_bf16 v[116:119], a[124:127], a[52:55], v[116:119]
    s_nop 2
    v_fma_f32 v128, -v92, v92, v120
    v_fma_f32 v129, -v93, v93, v121
    v_mfma_f32_16x16x32_bf16 v[112:115], a[128:131], a[128:131], v[112:115]
    s_cmp_eq_u32 s17, 0
    s_cbranch_scc0 L_g83
    s_waitcnt vmcnt(7)
L_g83:
    buffer_load_dwordx4 v32, s[24:27], s59 offen offset:2048 nt lds
    v_fma_f32 v130, -v94, v94, v122
    v_fma_f32 v131, -v95, v95, v123
    v_mfma_f32_16x16x32_bf16 v[116:119], a[128:131], a[56:59], v[116:119]
    v_max_f32 v128, v128, v56
    v_max_f32 v129, v129, v56
    v_mfma_f32_16x16x32_bf16 v[112:115], a[132:135], a[132:135], v[112:115]
    v_max_f32 v130, v130, v56
    v_max_f32 v131, v131, v56
    v_mfma_f32_16x16x32_bf16 v[116:119], a[132:135], a[60:63], v[116:119]
    v_rsq_f32 v128, v128
    v_mfma_f32_16x16x32_bf16 v[112:115], a[136:139], a[136:139], v[112:115]
    v_rsq_f32 v129, v129
    v_mfma_f32_16x16x32_bf16 v[116:119], a[136:139], a[64:67], v[116:119]
    v_rsq_f32 v130, v130
    v_mfma_f32_16x16x32_bf16 v[112:115], a[140:143], a[140:143], v[112:115]
    v_rsq_f32 v131, v131
    v_mfma_f32_16x16x32_bf16 v[116:119], a[140:143], a[68:71], v[116:119]
    v_fma_f32 v88, -v92, v61, v88
    v_fma_f32 v89, -v93, v61, v89
    v_mfma_f32_16x16x32_bf16 v[108:111], a[120:123], v[52:55], v[80:83]
    v_fma_f32 v90, -v94, v61, v90
    v_fma_f32 v91, -v95, v61, v91
    v_mfma_f32_16x16x32_bf16 v[108:111], a[124:127], v[52:55], v[108:111]
    v_fma_f32 v88, v88, v128, v62
    v_fma_f32 v89, v89, v129, v62
    v_mfma_f32_16x16x32_bf16 v[108:111], a[128:131], v[52:55], v[108:111]
    v_fma_f32 v90, v90, v130, v62
    v_fma_f32 v91, v91, v131, v62
    v_mfma_f32_16x16x32_bf16 v[108:111], a[132:135], v[52:55], v[108:111]
    v_max3_f32 v1, v88, v89, v90
    v_max_f32 v1, v1, v91
    v_mfma_f32_16x16x32_bf16 v[108:111], a[136:139], v[52:55], v[108:111]
    s_cmp_eq_u32 s17, 0
    s_cbranch_scc0 L_g84
    s_waitcnt vmcnt(7)
L_g84:
    buffer_load_dwordx4 v33, s[24:27], s59 offen offset:3072 nt lds
    v_cmp_lt_f32 vcc, s52, v1
    s_cbranch_vccnz L_site6
L_back6:
    v_mfma_f32_16x16x32_bf16 v[108:111], a[140:143], v[52:55], v[108:111]
    s_add_u32 s61, s60, 3149824
    buffer_load_dwordx4 v[176:179], v65, s[72:75], s61 offen offset:0 sc1
    v_exp_f32 v96, v88
    v_mfma_f32_16x16x32_bf16 v[104:107], a[120:123], v[136:139], v[76:79]
    v_exp_f32 v97, v89
    v_mfma_f32_16x16x32_bf16 v[104:107], a[124:127], v[140:143], v[104:107]
    v_exp_f32 v98, v90
    v_mfma_f32_16x16x32_bf16 v[104:107], a[128:131], v[144:147], v[104:107]
    v_exp_f32 v99, v91
    v_mfma_f32_16x16x32_bf16 v[104:107], a[132:135], v[148:151], v[104:107]
    v_mul_f32 v88, v96, v128
    v_mul_f32 v89, v97, v129
    v_mfma_f32_16x16x32_bf16 v[104:107], a[136:139], v[152:155], v[104:107]
    v_mul_f32 v90, v98, v130
    v_mul_f32 v91, v99, v131
    v_mfma_f32_16x16x32_bf16 v[104:107], a[140:143], v[156:159], v[104:107]
    v_fma_f32 v112, v116, 2.0, v112
    v_fma_f32 v113, v117, 2.0, v113
    v_fma_f32 v114, v118, 2.0, v114
    v_fma_f32 v115, v119, 2.0, v115
    v_cndmask_b32 v4, 0, v112, s[44:45]
    v_cndmask_b32 v4, v4, v113, s[46:47]
    v_cndmask_b32 v4, v4, v114, s[48:49]
    v_cndmask_b32 v4, v4, v115, s[50:51]
    v_add_f32 v63, v63, v96
    v_fmac_f32 v64, v88, v92
    v_mfma_f32_16x16x4_f32 v[124:127], v4, v60, v[56:59]
    v_add_f32 v63, v63, v97
    v_fmac_f32 v64, v89, v93
    v_add_f32 v63, v63, v98
    v_fmac_f32 v64, v90, v94
    v_add_f32 v63, v63, v99
    v_fmac_f32 v64, v91, v95
    v_mov_b32 v68, v88
    v_mov_b32 v69, v89
    v_mov_b32 v70, v90
    v_mov_b32 v71, v91
    v_add_u32 v44, 49152, v44
    v_add_u32 v45, 49152, v45
    v_add_u32 v46, 49152, v46
    v_add_u32 v47, 49152, v47
    v_add_u32 v48, 49152, v48
    v_add_u32 v49, 49152, v49
    v_fma_f32 v132, -v108, v108, v124
    v_fma_f32 v133, -v109, v109, v125
    v_fma_f32 v134, -v110, v110, v126
    v_fma_f32 v135, -v111, v111, v127
    v_max_f32 v132, v132, v56
    v_max_f32 v133, v133, v56
    v_max_f32 v134, v134, v56
    v_max_f32 v135, v135, v56
    v_rsq_f32 v132, v132
    v_rsq_f32 v133, v133
    v_rsq_f32 v134, v134
    v_rsq_f32 v135, v135
    s_cmp_eq_u32 s17, 0
    s_cbranch_scc0 L_g85
    s_waitcnt vmcnt(8)
L_g85:
    s_add_u32 m0, s40, 0
    s_add_u32 s57, s36, 18874368
    buffer_load_dwordx4 v16, s[28:31], s57 offen offset:0 nt lds
    v_fma_f32 v104, -v108, v61, v104
    v_fma_f32 v105, -v109, v61, v105
    v_fma_f32 v106, -v110, v61, v106
    v_fma_f32 v107, -v111, v61, v107
    v_fma_f32 v104, v104, v132, v62
    v_fma_f32 v105, v105, v133, v62
    v_fma_f32 v106, v106, v134, v62
    v_fma_f32 v107, v107, v135, v62
    v_max3_f32 v1, v104, v105, v106
    v_max_f32 v1, v1, v107
    v_cmp_lt_f32 vcc, s52, v1
    s_cbranch_vccnz L_site7
L_back7:
    v_exp_f32 v112, v104
    v_exp_f32 v113, v105
    v_exp_f32 v114, v106
    v_exp_f32 v115, v107
    v_cvt_pk_bf16_f32 v72, v88, v89
    v_cvt_pk_bf16_f32 v73, v90, v91
    v_mul_f32 v104, v112, v132
    v_mul_f32 v105, v113, v133
    v_mul_f32 v106, v114, v134
    v_mul_f32 v107, v115, v135
    v_cvt_pk_bf16_f32 v74, v104, v105
    v_cvt_pk_bf16_f32 v75, v106, v107
    ds_write_b128 v237, v[72:75] offset:0
    s_waitcnt lgkmcnt(0)
    s_barrier
L_post27:
    ds_read_b32 v9, v254 offset:4096
    ds_read_b128 v[92:95], v253 offset:0
    ds_read_b128 v[96:99], v253 offset:1024
    ds_read_b128 v[100:103], v253 offset:2048
    ds_read_b128 v[116:119], v253 offset:3072
    s_waitcnt lgkmcnt(4)
    v_cmp_ne_u32 vcc, 0, v9
    s_cbranch_vccnz L_xt27
    s_waitcnt lgkmcnt(3)
    v_mfma_f32_16x16x32_bf16 a[0:3], a[144:147], v[92:95], a[0:3]
    buffer_load_dwordx4 v17, s[28:31], s57 offen offset:1024 nt lds
    v_add_f32 v68, v68, v104
    v_add_f32 v69, v69, v105
    v_mfma_f32_16x16x32_bf16 a[4:7], a[160:163], v[92:95], a[4:7]
    buffer_load_dwordx4 v[180:183], v65, s[72:75], s61 offen offset:1024 sc1
    v_add_f32 v70, v70, v106
    v_add_f32 v71, v71, v107
    v_mfma_f32_16x16x32_bf16 a[8:11], a[176:179], v[92:95], a[8:11]
    buffer_load_dwordx4 v18, s[28:31], s57 offen offset:2048 nt lds
    v_add_f32 v63, v63, v112
    v_fma_f32 v64, v104, v108, v64
    s_waitcnt lgkmcnt(2)
    v_mfma_f32_16x16x32_bf16 a[0:3], a[148:151], v[96:99], a[0:3]
    v_add_f32 v63, v63, v113
    v_fma_f32 v64, v105, v109, v64
    v_mfma_f32_16x16x32_bf16 a[4:7], a[164:167], v[96:99], a[4:7]
    v_add_f32 v63, v63, v114
    v_fma_f32 v64, v106, v110, v64
    v_mfma_f32_16x16x32_bf16 a[8:11], a[180:183], v[96:99], a[8:11]
    buffer_load_dwordx4 v19, s[28:31], s57 offen offset:3072 nt lds
    v_add_f32 v63, v63, v115
    v_fma_f32 v64, v107, v111, v64
    s_waitcnt lgkmcnt(1)
    v_mfma_f32_16x16x32_bf16 a[0:3], a[152:155], v[100:103], a[0:3]
    v_mfma_f32_16x16x32_bf16 a[4:7], a[168:171], v[100:103], a[4:7]
    v_mfma_f32_16x16x32_bf16 a[8:11], a[184:187], v[100:103], a[8:11]
    s_waitcnt lgkmcnt(0)
    v_mfma_f32_16x16x32_bf16 a[0:3], a[156:159], v[116:119], a[0:3]
    v_mfma_f32_16x16x32_bf16 a[4:7], a[172:175], v[116:119], a[4:7]
    v_mfma_f32_16x16x32_bf16 a[8:11], a[188:191], v[116:119], a[8:11]
    s_add_u32 m0, s40, 4096
    s_nop 0
    buffer_load_dwordx4 v20, s[28:31], s57 offen offset:0 nt lds
    buffer_load_dwordx4 v[184:187], v65, s[72:75], s61 offen offset:2048 sc1
    buffer_load_dwordx4 v21, s[28:31], s57 offen offset:1024 nt lds
    s_add_u32 m0, s41, 0
    s_add_u32 s58, s37, 75497472
    buffer_load_dwordx4 v224, s[24:27], s58 offen offset:0 nt lds
    buffer_load_dwordx4 v[188:191], v65, s[72:75], s61 offen offset:3072 sc1
    s_waitcnt vmcnt(11)
    s_barrier
    ds_read_b128 a[96:99], v40 offset:49152
    ds_read_b128 a[100:103], v41 offset:49152
    ds_read_b128 a[104:107], v42 offset:49152
    ds_read_b128 a[108:111], v43 offset:49152
    ds_read_b128 a[112:115], v40 offset:49408
    ds_read_b128 a[116:119], v41 offset:49408
    ds_read_b128 a[120:123], v42 offset:49408
    ds_read_b128 a[124:127], v43 offset:49408
    ds_read_b128 a[128:131], v40 offset:49664
    ds_read_b128 a[132:135], v41 offset:49664
    ds_read_b128 a[136:139], v42 offset:49664
    ds_read_b128 a[140:143], v43 offset:49664
    s_waitcnt lgkmcnt(11)
    v_mfma_f32_16x16x32_bf16 v[96:99], a[96:99], a[96:99], v[84:87]
    buffer_load_dwordx4 v225, s[24:27], s58 offen offset:1024 nt lds
    ds_read_b64_tr_b16 a[144:145], v44 offset:0
    ds_read_b64_tr_b16 a[146:147], v45 offset:0
    v_mfma_f32_16x16x32_bf16 v[100:103], a[96:99], a[48:51], 0
    ds_read_b64_tr_b16 a[148:149], v44 offset:12288
    ds_read_b64_tr_b16 a[150:151], v45 offset:12288
    s_waitcnt lgkmcnt(14)
    v_mfma_f32_16x16x32_bf16 v[96:99], a[100:103], a[100:103], v[96:99]
    ds_read_b64_tr_b16 a[152:153], v44 offset:24576
    ds_read_b64_tr_b16 a[154:155], v45 offset:24576
    v_mfma_f32_16x16x32_bf16 v[100:103], a[100:103], a[52:55], v[100:103]
    ds_read_b64_tr_b16 a[156:157], v44 offset:36864
    ds_read_b64_tr_b16 a[158:159], v45 offset:36864
    s_waitcnt lgkmcnt(15)
    v_mfma_f32_16x16x32_bf16 v[96:99], a[104:107], a[104:107], v[96:99]
    ds_read_b64_tr_b16 a[160:161], v46 offset:0
    ds_read_b64_tr_b16 a[162:163], v47 offset:0
    v_mfma_f32_16x16x32_bf16 v[100:103], a[104:107], a[56:59], v[100:103]
    s_add_u32 m0, s41, 2048
    s_add_u32 s58, s37, 75497600
    buffer_load_dwordx4 v224, s[24:27], s58 offen offset:0 nt lds
    ds_read_b64_tr_b16 a[164:165], v46 offset:12288
    ds_read_b64_tr_b16 a[166:167], v47 offset:12288
    v_mfma_f32_16x16x32_bf16 v[96:99], a[108:111], a[108:111], v[96:99]
    ds_read_b64_tr_b16 a[168:169], v46 offset:24576
    ds_read_b64_tr_b16 a[170:171], v47 offset:24576
    v_mfma_f32_16x16x32_bf16 v[100:103], a[108:111], a[60:63], v[100:103]
    ds_read_b64_tr_b16 a[172:173], v46 offset:36864
    ds_read_b64_tr_b16 a[174:175], v47 offset:36864
    v_mfma_f32_16x16x32_bf16 v[96:99], a[112:115], a[112:115], v[96:99]
    ds_read_b64_tr_b16 a[176:177], v48 offset:0
    ds_read_b64_tr_b16 a[178:179], v49 offset:0
    v_mfma_f32_16x16x32_bf16 v[100:103], a[112:115], a[64:67], v[100:103]
    ds_read_b64_tr_b16 a[180:181], v48 offset:12288
    ds_read_b64_tr_b16 a[182:183], v49 offset:12288
    s_waitcnt lgkmcnt(15)
    v_mfma_f32_16x16x32_bf16 v[96:99], a[116:119], a[116:119], v[96:99]
    ds_read_b64_tr_b16 a[184:185], v48 offset:24576
    ds_read_b64_tr_b16 a[186:187], v49 offset:24576
    v_mfma_f32_16x16x32_bf16 v[100:103], a[116:119], a[68:71], v[100:103]
    ds_read_b64_tr_b16 a[188:189], v48 offset:36864
    ds_read_b64_tr_b16 a[190:191], v49 offset:36864
    v_mfma_f32_16x16x32_bf16 v[92:95], a[96:99], v[52:55], v[80:83]
    v_mfma_f32_16x16x32_bf16 v[92:95], a[100:103], v[52:55], v[92:95]
    v_mfma_f32_16x16x32_bf16 v[92:95], a[104:107], v[52:55], v[92:95]
    v_mfma_f32_16x16x32_bf16 v[92:95], a[108:111], v[52:55], v[92:95]
    s_nop 1
    v_fma_f32 v96, v100, 2.0, v96
    v_fma_f32 v97, v101, 2.0, v97
    v_mfma_f32_16x16x32_bf16 v[92:95], a[112:115], v[52:55], v[92:95]
    buffer_load_dwordx4 v225, s[24:27], s58 offen offset:1024 nt lds
    v_fma_f32 v98, v102, 2.0, v98
    v_fma_f32 v99, v103, 2.0, v99
    v_mfma_f32_16x16x32_bf16 v[92:95], a[116:119], v[52:55], v[92:95]
    s_add_u32 s61, s60, 3153920
    buffer_load_dwordx4 v[192:195], v65, s[72:75], s61 offen offset:0 sc1
    v_cndmask_b32 v3, 0, v96, s[44:45]
    v_cndmask_b32 v3, v3, v97, s[46:47]
    v_mfma_f32_16x16x32_bf16 v[88:91], a[96:99], v[136:139], v[76:79]
    v_cndmask_b32 v3, v3, v98, s[48:49]
    v_cndmask_b32 v3, v3, v99, s[50:51]
    v_mfma_f32_16x16x32_bf16 v[88:91], a[100:103], v[140:143], v[88:91]
    s_nop 0
    s_nop 0
    v_mfma_f32_16x16x32_bf16 v[88:91], a[104:107], v[144:147], v[88:91]
    v_mfma_f32_16x16x4_f32 v[120:123], v3, v60, v[56:59]
    v_mfma_f32_16x16x32_bf16 v[88:91], a[108:111], v[148:151], v[88:91]
    v_mfma_f32_16x16x32_bf16 v[88:91], a[112:115], v[152:155], v[88:91]
    v_mfma_f32_16x16x32_bf16 v[88:91], a[116:119], v[156:159], v[88:91]
    v_mfma_f32_16x16x32_bf16 v[112:115], a[120:123], a[120:123], v[84:87]
    v_mfma_f32_16x16x32_bf16 v[116:119], a[120:123], a[48:51], 0
    v_mfma_f32_16x16x32_bf16 v[112:115], a[124:127], a[124:127], v[112:115]
    s_add_u32 m0, s41, 4096
    s_add_u32 s58, s37, 75497728
    buffer_load_dwordx4 v224, s[24:27], s58 offen offset:0 nt lds
    v_mfma_f32_16x16x32_bf16 v[116:119], a[124:127], a[52:55], v[116:119]
    v_fma_f32 v128, -v92, v92, v120
    v_fma_f32 v129, -v93, v93, v121
    v_mfma_f32_16x16x32_bf16 v[112:115], a[128:131], a[128:131], v[112:115]
    v_fma_f32 v130, -v94, v94, v122
    v_fma_f32 v131, -v95, v95, v123
    v_mfma_f32_16x16x32_bf16 v[116:119], a[128:131], a[56:59], v[116:119]
    v_max_f32 v128, v128, v56
    v_max_f32 v129, v129, v56
    v_mfma_f32_16x16x32_bf16 v[112:115], a[132:135], a[132:135], v[112:115]
    v_max_f32 v130, v130, v56
    v_max_f32 v131, v131, v56
    v_mfma_f32_16x16x32_bf16 v[116:119], a[132:135], a[60:63], v[116:119]
    v_rsq_f32 v128, v128
    v_mfma_f32_16x16x32_bf16 v[112:115], a[136:139], a[136:139], v[112:115]
    v_rsq_f32 v129, v129
    v_mfma_f32_16x16x32_bf16 v[116:119], a[136:139], a[64:67], v[116:119]
    v_rsq_f32 v130, v130
    v_mfma_f32_16x16x32_bf16 v[112:115], a[140:143], a[140:143], v[112:115]
    v_rsq_f32 v131, v131
    v_mfma_f32_16x16x32_bf16 v[116:119], a[140:143], a[68:71], v[116:119]
    v_fma_f32 v88, -v92, v61, v88
    v_fma_f32 v89, -v93, v61, v89
    v_mfma_f32_16x16x32_bf16 v[108:111], a[120:123], v[52:55], v[80:83]
    v_fma_f32 v90, -v94, v61, v90
    v_fma_f32 v91, -v95, v61, v91
    v_mfma_f32_16x16x32_bf16 v[108:111], a[124:127], v[52:55], v[108:111]
    v_fma_f32 v88, v88, v128, v62
    v_fma_f32 v89, v89, v129, v62
    v_mfma_f32_16x16x32_bf16 v[108:111], a[128:131], v[52:55], v[108:111]
    v_fma_f32 v90, v90, v130, v62
    v_fma_f32 v91, v91, v131, v62
    v_mfma_f32_16x16x32_bf16 v[108:111], a[132:135], v[52:55], v[108:111]
    buffer_load_dwordx4 v225, s[24:27], s58 offen offset:1024 nt lds
    v_max3_f32 v1, v88, v89, v90
    v_max_f32 v1, v1, v91
    v_mfma_f32_16x16x32_bf16 v[108:111], a[136:139], v[52:55], v[108:111]
    v_cmp_lt_f32 vcc, s52, v1
    s_cbranch_vccnz L_site8
L_back8:
    v_mfma_f32_16x16x32_bf16 v[108:111], a[140:143], v[52:55], v[108:111]
    v_exp_f32 v96, v88
    v_mfma_f32_16x16x32_bf16 v[104:107], a[120:123], v[136:139], v[76:79]
    v_exp_f32 v97, v89
    v_mfma_f32_16x16x32_bf16 v[104:107], a[124:127], v[140:143], v[104:107]
    v_exp_f32 v98, v90
    v_mfma_f32_16x16x32_bf16 v[104:107], a[128:131], v[144:147], v[104:107]
    v_exp_f32 v99, v91
    v_mfma_f32_16x16x32_bf16 v[104:107], a[132:135], v[148:151], v[104:107]
    v_mul_f32 v88, v96, v128
    v_mul_f32 v89, v97, v129
    v_mfma_f32_16x16x32_bf16 v[104:107], a[136:139], v[152:155], v[104:107]
    v_mul_f32 v90, v98, v130
    v_mul_f32 v91, v99, v131
    v_mfma_f32_16x16x32_bf16 v[104:107], a[140:143], v[156:159], v[104:107]
    v_fma_f32 v112, v116, 2.0, v112
    v_fma_f32 v113, v117, 2.0, v113
    v_fma_f32 v114, v118, 2.0, v114
    v_fma_f32 v115, v119, 2.0, v115
    v_cndmask_b32 v4, 0, v112, s[44:45]
    v_cndmask_b32 v4, v4, v113, s[46:47]
    v_cndmask_b32 v4, v4, v114, s[48:49]
    v_cndmask_b32 v4, v4, v115, s[50:51]
    v_add_f32 v63, v63, v96
    v_fmac_f32 v64, v88, v92
    v_mfma_f32_16x16x4_f32 v[124:127], v4, v60, v[56:59]
    v_add_f32 v63, v63, v97
    v_fmac_f32 v64, v89, v93
    v_add_f32 v63, v63, v98
    v_fmac_f32 v64, v90, v94
    v_add_f32 v63, v63, v99
    v_fmac_f32 v64, v91, v95
    v_add_f32 v68, v68, v88
    v_add_f32 v69, v69, v89
    v_add_f32 v70, v70, v90
    v_add_f32 v71, v71, v91
    v_add_u32 v44, -49152, v44
    v_add_u32 v45, -49152, v45
    v_add_u32 v46, -49152, v46
    v_add_u32 v47, -49152, v47
    v_add_u32 v48, -49152, v48
    v_add_u32 v49, -49152, v49
    v_fma_f32 v132, -v108, v108, v124
    v_fma_f32 v133, -v109, v109, v125
    v_fma_f32 v134, -v110, v110, v126
    v_fma_f32 v135, -v111, v111, v127
    v_max_f32 v132, v132, v56
    v_max_f32 v133, v133, v56
    v_max_f32 v134, v134, v56
    v_max_f32 v135, v135, v56
    v_rsq_f32 v132, v132
    v_rsq_f32 v133, v133
    v_rsq_f32 v134, v134
    v_rsq_f32 v135, v135
    buffer_load_dwordx4 v[196:199], v65, s[72:75], s61 offen offset:1024 sc1
    v_fma_f32 v104, -v108, v61, v104
    v_fma_f32 v105, -v109, v61, v105
    v_fma_f32 v106, -v110, v61, v106
    v_fma_f32 v107, -v111, v61, v107
    v_fma_f32 v104, v104, v132, v62
    v_fma_f32 v105, v105, v133, v62
    v_fma_f32 v106, v106, v134, v62
    v_fma_f32 v107, v107, v135, v62
    v_max3_f32 v1, v104, v105, v106
    v_max_f32 v1, v1, v107
    v_cmp_lt_f32 vcc, s52, v1
    s_cbranch_vccnz L_site9
L_back9:
    s_add_u32 m0, s41, 6144
    s_add_u32 s58, s37, 75497856
    buffer_load_dwordx4 v224, s[24:27], s58 offen offset:0 nt lds
    v_exp_f32 v112, v104
    v_exp_f32 v113, v105
    v_exp_f32 v114, v106
    v_exp_f32 v115, v107
    v_cvt_pk_bf16_f32 v72, v88, v89
    v_cvt_pk_bf16_f32 v73, v90, v91
    v_mul_f32 v104, v112, v132
    v_mul_f32 v105, v113, v133
    v_mul_f32 v106, v114, v134
    v_mul_f32 v107, v115, v135
    v_cvt_pk_bf16_f32 v74, v104, v105
    v_cvt_pk_bf16_f32 v75, v106, v107
    ds_write_b128 v237, v[72:75] offset:0
    v_add_f32 v68, v68, v104
    v_add_f32 v69, v69, v105
    v_add_f32 v70, v70, v106
    v_add_f32 v71, v71, v107
    v_cvt_pk_bf16_f32 v66, v68, v69
    v_cvt_pk_bf16_f32 v67, v70, v71
    ds_write_b64 v238, v[66:67]
    s_lshl_b32 s56, s3, 13
    v_lshl_add_u32 v233, v0, 7, s56
    v_min_u32 v233, L_hot - L_tail, v233
    v_add_u32 v233, L_tail - L_pc_main, v233
    global_load_dword v234, v233, s[100:101]
    s_waitcnt vmcnt(11)
    s_waitcnt lgkmcnt(0)
    s_barrier
L_post9:
    ds_read_b32 v9, v254 offset:4096
    ds_read_b64 v[120:121], v254 offset:0
    ds_read_b64 v[122:123], v254 offset:512
    ds_read_b64 v[124:125], v254 offset:1024
    ds_read_b64 v[126:127], v254 offset:1536
    ds_read_b128 v[92:95], v253 offset:0
    ds_read_b128 v[96:99], v253 offset:1024
    ds_read_b128 v[100:103], v253 offset:2048
    ds_read_b128 v[116:119], v253 offset:3072
    ds_read_b128 a[48:51], v34 offset:0
    ds_read_b128 a[52:55], v35 offset:0
    ds_read_b128 a[56:59], v34 offset:128
    ds_read_b128 a[60:63], v35 offset:128
    ds_read_b128 a[64:67], v34 offset:256
    ds_read_b128 a[68:71], v35 offset:256
    s_waitcnt lgkmcnt(14)
    v_cmp_ne_u32 vcc, 0, v9
    s_cbranch_vccnz L_xt9
    s_waitcnt lgkmcnt(12)
    v_mfma_f32_16x16x32_bf16 a[0:3], a[72:75], v[120:123], a[0:3]
    buffer_load_dwordx4 v225, s[24:27], s58 offen offset:1024 nt lds
    v_add_f32 v63, v63, v112
    v_fma_f32 v64, v104, v108, v64
    v_mfma_f32_16x16x32_bf16 a[4:7], a[80:83], v[120:123], a[4:7]
    s_add_u32 m0, s41, 8192
    s_add_u32 s58, s37, 75497984
    buffer_load_dwordx4 v224, s[24:27], s58 offen offset:0 nt lds
    v_add_f32 v63, v63, v113
    v_fma_f32 v64, v105, v109, v64
    v_mfma_f32_16x16x32_bf16 a[8:11], a[88:91], v[120:123], a[8:11]
    v_add_f32 v63, v63, v114
    v_fma_f32 v64, v106, v110, v64
    s_waitcnt lgkmcnt(10)
    v_mfma_f32_16x16x32_bf16 a[0:3], a[76:79], v[124:127], a[0:3]
    v_add_f32 v63, v63, v115
    v_fma_f32 v64, v107, v111, v64
    v_mfma_f32_16x16x32_bf16 a[4:7], a[84:87], v[124:127], a[4:7]
    v_mfma_f32_16x16x32_bf16 a[8:11], a[92:95], v[124:127], a[8:11]
    buffer_load_dwordx4 v[200:203], v65, s[72:75], s61 offen offset:2048 sc1
    s_waitcnt lgkmcnt(9)
    v_mfma_f32_16x16x32_bf16 a[0:3], a[144:147], v[92:95], a[0:3]
    ds_read_b64_tr_b16 a[72:73], v36 offset:0
    ds_read_b64_tr_b16 a[74:75], v36 offset:6144
    v_mfma_f32_16x16x32_bf16 a[4:7], a[160:163], v[92:95], a[4:7]
    ds_read_b64_tr_b16 a[76:77], v36 offset:12288
    ds_read_b64_tr_b16 a[78:79], v36 offset:18432
    v_mfma_f32_16x16x32_bf16 a[8:11], a[176:179], v[92:95], a[8:11]
    ds_read_b64_tr_b16 a[80:81], v37 offset:0
    ds_read_b64_tr_b16 a[82:83], v37 offset:6144
    s_waitcnt lgkmcnt(14)
    v_mfma_f32_16x16x32_bf16 a[0:3], a[148:151], v[96:99], a[0:3]
    ds_read_b64_tr_b16 a[84:85], v37 offset:12288
    ds_read_b64_tr_b16 a[86:87], v37 offset:18432
    v_mfma_f32_16x16x32_bf16 a[4:7], a[164:167], v[96:99], a[4:7]
    ds_read_b64_tr_b16 a[88:89], v38 offset:0
    ds_read_b64_tr_b16 a[90:91], v38 offset:6144
    v_mfma_f32_16x16x32_bf16 a[8:11], a[180:183], v[96:99], a[8:11]
    ds_read_b64_tr_b16 a[92:93], v38 offset:12288
    ds_read_b64_tr_b16 a[94:95], v38 offset:18432
    s_waitcnt lgkmcnt(15)
    v_mfma_f32_16x16x32_bf16 a[0:3], a[152:155], v[100:103], a[0:3]
    v_mfma_f32_16x16x32_bf16 a[4:7], a[168:171], v[100:103], a[4:7]
    v_mfma_f32_16x16x32_bf16 a[8:11], a[184:187], v[100:103], a[8:11]
    v_mfma_f32_16x16x32_bf16 a[0:3], a[156:159], v[116:119], a[0:3]
    v_mfma_f32_16x16x32_bf16 a[4:7], a[172:175], v[116:119], a[4:7]
    v_mfma_f32_16x16x32_bf16 a[8:11], a[188:191], v[116:119], a[8:11]
    buffer_load_dwordx4 v225, s[24:27], s58 offen offset:1024 nt lds
    v_mfma_f32_16x16x32_bf16 v[84:87], a[48:51], a[48:51], 0
    v_mfma_f32_16x16x32_bf16 v[80:83], a[48:51], v[52:55], 0
    v_mfma_f32_16x16x32_bf16 v[84:87], a[52:55], a[52:55], v[84:87]
    v_mfma_f32_16x16x32_bf16 v[80:83], a[52:55], v[52:55], v[80:83]
    v_mfma_f32_16x16x32_bf16 v[84:87], a[56:59], a[56:59], v[84:87]
    v_mfma_f32_16x16x32_bf16 v[80:83], a[56:59], v[52:55], v[80:83]
    s_waitcnt lgkmcnt(14)
    v_mfma_f32_16x16x32_bf16 v[84:87], a[60:63], a[60:63], v[84:87]
    v_mfma_f32_16x16x32_bf16 v[80:83], a[60:63], v[52:55], v[80:83]
    s_waitcnt lgkmcnt(13)
    v_mfma_f32_16x16x32_bf16 v[84:87], a[64:67], a[64:67], v[84:87]
    v_mfma_f32_16x16x32_bf16 v[80:83], a[64:67], v[52:55], v[80:83]
    s_waitcnt lgkmcnt(12)
    v_mfma_f32_16x16x32_bf16 v[84:87], a[68:71], a[68:71], v[84:87]
    v_mfma_f32_16x16x32_bf16 v[80:83], a[68:71], v[52:55], v[80:83]
    s_waitcnt lgkmcnt(0)
    v_mfma_f32_16x16x32_bf16 v[76:79], a[48:51], v[136:139], 0
    v_mfma_f32_16x16x32_bf16 v[76:79], a[52:55], v[140:143], v[76:79]
    s_add_u32 m0, s41, 10240
    s_add_u32 s58, s37, 75498112
    buffer_load_dwordx4 v224, s[24:27], s58 offen offset:0 nt lds
    v_mfma_f32_16x16x32_bf16 v[76:79], a[56:59], v[144:147], v[76:79]
    buffer_load_dwordx4 v[204:207], v65, s[72:75], s61 offen offset:3072 sc1
    v_mfma_f32_16x16x32_bf16 v[76:79], a[60:63], v[148:151], v[76:79]
    v_mfma_f32_16x16x32_bf16 v[76:79], a[64:67], v[152:155], v[76:79]
    v_mfma_f32_16x16x32_bf16 v[76:79], a[68:71], v[156:159], v[76:79]
    s_mul_i32 s28, s3, 262144
    s_and_b32 s56, s2, 7
    s_lshl_b32 s56, s56, 10
    s_add_u32 s28, s28, s56
    s_bfe_u32 s56, s2, 0x30003
    s_lshl_b32 s56, s56, 7
    s_add_u32 s28, s28, s56
    s_lshr_b32 s56, s2, 6
    s_lshl_b32 s56, s56, 14
    s_add_u32 s28, s28, s56
    s_add_u32 s28, s28, 8388608
    v_lshrrev_b32 v1, 3, v0
    s_xor_b32 s56, s1, s3
    v_xor_b32 v1, s56, v1
    v_and_b32 v1, 1, v1
    v_lshl_or_b32 v242, v1, 13, v242
    s_sub_u32 s29, s2, 64
    s_lshr_b32 s29, s29, 4
    s_and_b32 s56, s2, 7
    s_lshl3_add_u32 s29, s29, s56
    s_mul_i32 s30, s29, 65536
    s_lshl_b32 s56, s3, 14
    s_add_u32 s30, s30, s56
    s_add_u32 s30, s30, 8388608
    s_lshr_b32 s56, s29, 5
    s_xor_b32 s56, s56, s1
    s_lshr_b32 s57, s29, 2
    s_xor_b32 s56, s56, s57
    s_and_b32 s56, s56, 1
    s_lshl_b32 s56, s56, 13
    s_add_u32 s30, s30, s56
    s_add_u32 s31, s30, 4096
    v_mov_b32 v28, v242
    v_bfe_u32 v1, v0, 4, 1
    v_mul_u32_u24 v2, 65536, v1
    v_mul_u32_u24 v1, 0x10, v1
    v_xor_b32 v242, v242, v1
    v_sub_u32 v242, v242, v2
    v_add_u32 v243, 65536, v242
    s_bfe_u32 s56, s2, 0x10003
    s_lshl_b32 s56, s56, 6
    v_lshrrev_b32 v1, 2, v0
    v_and_b32 v2, 48, v65
    v_lshl_add_u32 v1, v1, 7, v2
    v_add_u32 v29, s56, v1
    v_mov_b32 v232, 0x53800000
    s_mov_b32 s43, 1
    s_mov_b32 s68, s18
    s_mov_b32 s69, s19
    s_mov_b32 s70, 6144
    s_mov_b32 s71, 0x20000
L_tail:
    v_and_b32 v1, 15, v0
    v_lshlrev_b32 v1, 8, v1
    v_sub_u32 v1, v34, v1
    v_lshrrev_b32 v2, 2, v0
    v_lshlrev_b32 v2, 8, v2
    s_sub_u32 s56, s41, s40
    v_add_u32 v40, s56, v1
    v_xor_b32 v41, 64, v40
    s_sub_u32 s56, s42, s40
    v_add_u32 v42, s56, v1
    v_xor_b32 v43, 64, v42
    s_mul_i32 s56, s3, 3
    s_add_u32 s57, s56, 0
    s_lshr_b32 s57, s57, 2
    s_mul_i32 s57, s57, 1920
    s_add_u32 s57, s57, 24576
    v_sub_u32 v44, v36, v2
    v_add_u32 v44, s57, v44
    v_add_u32 v47, 49152, v44
    s_add_u32 s57, s56, 1
    s_lshr_b32 s57, s57, 2
    s_mul_i32 s57, s57, 1920
    s_add_u32 s57, s57, 24576
    v_sub_u32 v45, v37, v2
    v_add_u32 v45, s57, v45
    v_add_u32 v48, 49152, v45
    s_add_u32 s57, s56, 2
    s_lshr_b32 s57, s57, 2
    s_mul_i32 s57, s57, 1920
    s_add_u32 s57, s57, 24576
    v_sub_u32 v46, v38, v2
    v_add_u32 v46, s57, v46
    v_add_u32 v49, 49152, v46
    v_accvgpr_read_b32 v16, a0
    v_accvgpr_read_b32 v17, a1
    v_accvgpr_read_b32 v18, a2
    v_accvgpr_read_b32 v19, a3
    v_accvgpr_read_b32 v20, a4
    v_accvgpr_read_b32 v21, a5
    v_accvgpr_read_b32 v22, a6
    v_accvgpr_read_b32 v23, a7
    v_accvgpr_read_b32 v24, a8
    v_accvgpr_read_b32 v25, a9
    v_accvgpr_read_b32 v26, a10
    v_accvgpr_read_b32 v27, a11
    buffer_load_dwordx4 v225, s[24:27], s58 offen offset:1024 nt lds
    s_add_u32 m0, s42, 0
    s_add_u32 s59, s37, 75694080
    buffer_load_dwordx4 v224, s[24:27], s59 offen offset:0 nt lds
    buffer_load_dwordx4 v225, s[24:27], s59 offen offset:1024 nt lds
    s_waitcnt vmcnt(12)
    s_barrier
    ds_read_b128 a[96:99], v40 offset:0
    ds_read_b128 a[100:103], v41 offset:0
    ds_read_b128 a[104:107], v40 offset:2048
    ds_read_b128 a[108:111], v41 offset:2048
    ds_read_b128 a[112:115], v40 offset:4096
    ds_read_b128 a[116:119], v41 offset:4096
    s_waitcnt lgkmcnt(5)
    v_mfma_f32_16x16x32_bf16 v[96:99], a[96:99], a[96:99], v[84:87]
    s_add_u32 m0, s42, 2048
    s_add_u32 s59, s37, 75694208
    buffer_load_dwordx4 v224, s[24:27], s59 offen offset:0 nt lds
    ds_read_b64_tr_b16 a[144:145], v44 offset:0
    ds_read_b64_tr_b16 a[148:149], v44 offset:12288
    v_mfma_f32_16x16x32_bf16 v[100:103], a[96:99], a[48:51], 0
    buffer_load_dwordx4 v225, s[24:27], s59 offen offset:1024 nt lds
    ds_read_b64_tr_b16 a[152:153], v44 offset:24576
    ds_read_b64_tr_b16 a[156:157], v44 offset:36864
    s_waitcnt lgkmcnt(8)
    v_mfma_f32_16x16x32_bf16 v[96:99], a[100:103], a[100:103], v[96:99]
    ds_read_b64_tr_b16 a[160:161], v45 offset:0
    ds_read_b64_tr_b16 a[164:165], v45 offset:12288
    v_mfma_f32_16x16x32_bf16 v[100:103], a[100:103], a[52:55], v[100:103]
    ds_read_b64_tr_b16 a[168:169], v45 offset:24576
    ds_read_b64_tr_b16 a[172:173], v45 offset:36864
    s_waitcnt lgkmcnt(11)
    v_mfma_f32_16x16x32_bf16 v[96:99], a[104:107], a[104:107], v[96:99]
    ds_read_b64_tr_b16 a[176:177], v46 offset:0
    ds_read_b64_tr_b16 a[180:181], v46 offset:12288
    v_mfma_f32_16x16x32_bf16 v[100:103], a[104:107], a[56:59], v[100:103]
    ds_read_b64_tr_b16 a[184:185], v46 offset:24576
    ds_read_b64_tr_b16 a[188:189], v46 offset:36864
    s_waitcnt lgkmcnt(14)
    v_mfma_f32_16x16x32_bf16 v[96:99], a[108:111], a[108:111], v[96:99]
    s_add_u32 m0, s42, 4096
    s_add_u32 s59, s37, 75694336
    buffer_load_dwordx4 v224, s[24:27], s59 offen offset:0 nt lds
    v_mfma_f32_16x16x32_bf16 v[100:103], a[108:111], a[60:63], v[100:103]
    s_waitcnt lgkmcnt(13)
    v_mfma_f32_16x16x32_bf16 v[96:99], a[112:115], a[112:115], v[96:99]
    v_mfma_f32_16x16x32_bf16 v[100:103], a[112:115], a[64:67], v[100:103]
    s_waitcnt lgkmcnt(12)
    v_mfma_f32_16x16x32_bf16 v[96:99], a[116:119], a[116:119], v[96:99]
    v_mfma_f32_16x16x32_bf16 v[100:103], a[116:119], a[68:71], v[100:103]
    v_mfma_f32_16x16x32_bf16 v[92:95], a[96:99], v[52:55], v[80:83]
    v_mfma_f32_16x16x32_bf16 v[92:95], a[100:103], v[52:55], v[92:95]
    v_mfma_f32_16x16x32_bf16 v[92:95], a[104:107], v[52:55], v[92:95]
    v_mfma_f32_16x16x32_bf16 v[92:95], a[108:111], v[52:55], v[92:95]
    s_nop 3
    v_fma_f32 v96, v100, 2.0, v96
    v_fma_f32 v97, v101, 2.0, v97
    v_mfma_f32_16x16x32_bf16 v[92:95], a[112:115], v[52:55], v[92:95]
    v_fma_f32 v98, v102, 2.0, v98
    v_fma_f32 v99, v103, 2.0, v99
    v_mfma_f32_16x16x32_bf16 v[92:95], a[116:119], v[52:55], v[92:95]
    v_cndmask_b32 v3, 0, v96, s[44:45]
    v_cndmask_b32 v3, v3, v97, s[46:47]
    v_mfma_f32_16x16x32_bf16 v[88:91], a[96:99], v[136:139], v[76:79]
    v_cndmask_b32 v3, v3, v98, s[48:49]
    v_cndmask_b32 v3, v3, v99, s[50:51]
    v_mfma_f32_16x16x32_bf16 v[88:91], a[100:103], v[140:143], v[88:91]
    buffer_load_dwordx4 v225, s[24:27], s59 offen offset:1024 nt lds
    s_nop 0
    s_nop 0
    v_mfma_f32_16x16x32_bf16 v[88:91], a[104:107], v[144:147], v[88:91]
    s_add_u32 m0, s42, 6144
    s_add_u32 s59, s37, 75694464
    buffer_load_dwordx4 v224, s[24:27], s59 offen offset:0 nt lds
    v_mfma_f32_16x16x4_f32 v[120:123], v3, v60, v[56:59]
    v_mfma_f32_16x16x32_bf16 v[88:91], a[108:111], v[148:151], v[88:91]
    v_mfma_f32_16x16x32_bf16 v[88:91], a[112:115], v[152:155], v[88:91]
    v_mfma_f32_16x16x32_bf16 v[88:91], a[116:119], v[156:159], v[88:91]
    s_nop 6
    v_fma_f32 v128, -v92, v92, v120
    v_fma_f32 v129, -v93, v93, v121
    v_fma_f32 v130, -v94, v94, v122
    v_fma_f32 v131, -v95, v95, v123
    v_max_f32 v128, v128, v56
    v_max_f32 v129, v129, v56
    v_max_f32 v130, v130, v56
    v_max_f32 v131, v131, v56
    v_rsq_f32 v128, v128
    v_rsq_f32 v129, v129
    v_rsq_f32 v130, v130
    v_rsq_f32 v131, v131
    v_fma_f32 v88, -v92, v61, v88
    v_fma_f32 v89, -v93, v61, v89
    v_fma_f32 v90, -v94, v61, v90
    v_fma_f32 v91, -v95, v61, v91
    v_fma_f32 v88, v88, v128, v62
    v_fma_f32 v89, v89, v129, v62
    buffer_load_dwordx4 v225, s[24:27], s59 offen offset:1024 nt lds
    v_fma_f32 v90, v90, v130, v62
    v_fma_f32 v91, v91, v131, v62
    v_max3_f32 v1, v88, v89, v90
    v_max_f32 v1, v1, v91
    v_cmp_lt_f32 vcc, s52, v1
    s_cbranch_vccnz L_site10
L_back10:
    v_exp_f32 v96, v88
    v_exp_f32 v97, v89
    v_exp_f32 v98, v90
    v_exp_f32 v99, v91
    v_mul_f32 v88, v96, v128
    v_mul_f32 v89, v97, v129
    v_mul_f32 v90, v98, v130
    v_mul_f32 v91, v99, v131
    v_add_f32 v63, v63, v96
    v_fmac_f32 v64, v88, v92
    v_add_f32 v63, v63, v97
    v_fmac_f32 v64, v89, v93
    v_add_f32 v63, v63, v98
    v_fmac_f32 v64, v90, v94
    v_add_f32 v63, v63, v99
    v_fmac_f32 v64, v91, v95
    v_mov_b32 v68, v88
    v_mov_b32 v69, v89
    v_mov_b32 v70, v90
    v_mov_b32 v71, v91
    s_waitcnt vmcnt(14)
    ds_read_b128 a[120:123], v40 offset:6144
    ds_read_b128 a[124:127], v41 offset:6144
    s_waitcnt lgkmcnt(1)
    v_mfma_f32_16x16x32_bf16 v[112:115], a[120:123], a[120:123], v[84:87]
    s_add_u32 m0, s42, 8192
    s_add_u32 s59, s37, 75694592
    buffer_load_dwordx4 v224, s[24:27], s59 offen offset:0 nt lds
    v_mfma_f32_16x16x32_bf16 v[116:119], a[120:123], a[48:51], 0
    buffer_load_dwordx4 v225, s[24:27], s59 offen offset:1024 nt lds
    s_waitcnt lgkmcnt(0)
    v_mfma_f32_16x16x32_bf16 v[112:115], a[124:127], a[124:127], v[112:115]
    v_mfma_f32_16x16x32_bf16 v[116:119], a[124:127], a[52:55], v[116:119]
    v_mfma_f32_16x16x32_bf16 v[108:111], a[120:123], v[52:55], v[80:83]
    v_mfma_f32_16x16x32_bf16 v[104:107], a[120:123], v[136:139], v[76:79]
    s_waitcnt vmcnt(13)
    ds_read_b128 a[128:131], v40 offset:8192
    ds_read_b128 a[132:135], v41 offset:8192
    v_mfma_f32_16x16x32_bf16 v[108:111], a[124:127], v[52:55], v[108:111]
    v_mfma_f32_16x16x32_bf16 v[104:107], a[124:127], v[140:143], v[104:107]
    s_waitcnt lgkmcnt(1)
    v_mfma_f32_16x16x32_bf16 v[112:115], a[128:131], a[128:131], v[112:115]
    v_mfma_f32_16x16x32_bf16 v[116:119], a[128:131], a[56:59], v[116:119]
    s_waitcnt lgkmcnt(0)
    v_mfma_f32_16x16x32_bf16 v[112:115], a[132:135], a[132:135], v[112:115]
    v_mfma_f32_16x16x32_bf16 v[116:119], a[132:135], a[60:63], v[116:119]
    v_mfma_f32_16x16x32_bf16 v[108:111], a[128:131], v[52:55], v[108:111]
    s_add_u32 m0, s42, 10240
    s_add_u32 s59, s37, 75694720
    buffer_load_dwordx4 v224, s[24:27], s59 offen offset:0 nt lds
    v_mfma_f32_16x16x32_bf16 v[104:107], a[128:131], v[144:147], v[104:107]
    buffer_load_dwordx4 v225, s[24:27], s59 offen offset:1024 nt lds
    s_waitcnt vmcnt(12)
    ds_read_b128 a[136:139], v40 offset:10240
    ds_read_b128 a[140:143], v41 offset:10240
    s_barrier
    s_add_u32 s61, s60, 3158016
    buffer_load_dwordx4 v[208:211], v65, s[32:35], s61 offen offset:0 sc1
    v_mfma_f32_16x16x32_bf16 v[108:111], a[132:135], v[52:55], v[108:111]
    ds_read_b64_tr_b16 a[146:147], v44 offset:6144
    v_mfma_f32_16x16x32_bf16 v[104:107], a[132:135], v[148:151], v[104:107]
    ds_read_b64_tr_b16 a[150:151], v44 offset:18432
    s_waitcnt lgkmcnt(3)
    v_mfma_f32_16x16x32_bf16 v[112:115], a[136:139], a[136:139], v[112:115]
    ds_read_b64_tr_b16 a[154:155], v44 offset:30720
    v_mfma_f32_16x16x32_bf16 v[116:119], a[136:139], a[64:67], v[116:119]
    ds_read_b64_tr_b16 a[158:159], v44 offset:43008
    s_waitcnt lgkmcnt(4)
    v_mfma_f32_16x16x32_bf16 v[112:115], a[140:143], a[140:143], v[112:115]
    ds_read_b64_tr_b16 a[162:163], v45 offset:6144
    v_mfma_f32_16x16x32_bf16 v[116:119], a[140:143], a[68:71], v[116:119]
    ds_read_b64_tr_b16 a[166:167], v45 offset:18432
    v_mfma_f32_16x16x32_bf16 v[108:111], a[136:139], v[52:55], v[108:111]
    ds_read_b64_tr_b16 a[170:171], v45 offset:30720
    v_mfma_f32_16x16x32_bf16 v[108:111], a[140:143], v[52:55], v[108:111]
    ds_read_b64_tr_b16 a[174:175], v45 offset:43008
    s_nop 2
    v_fma_f32 v112, v116, 2.0, v112
    v_fma_f32 v113, v117, 2.0, v113
    v_fma_f32 v114, v118, 2.0, v114
    v_fma_f32 v115, v119, 2.0, v115
    v_cndmask_b32 v4, 0, v112, s[44:45]
    v_cndmask_b32 v4, v4, v113, s[46:47]
    v_cndmask_b32 v4, v4, v114, s[48:49]
    v_cndmask_b32 v4, v4, v115, s[50:51]
    ds_read_b64_tr_b16 a[178:179], v46 offset:6144
    ds_read_b64_tr_b16 a[182:183], v46 offset:18432
    v_mfma_f32_16x16x4_f32 v[124:127], v4, v60, v[56:59]
    ds_read_b64_tr_b16 a[186:187], v46 offset:30720
    ds_read_b64_tr_b16 a[190:191], v46 offset:43008
    buffer_load_dwordx4 v[212:215], v65, s[32:35], s61 offen offset:1024 sc1
    s_nop 5
    v_mfma_f32_16x16x32_bf16 v[104:107], a[136:139], v[152:155], v[104:107]
    v_fma_f32 v132, -v108, v108, v124
    v_fma_f32 v133, -v109, v109, v125
    v_mfma_f32_16x16x32_bf16 v[104:107], a[140:143], v[156:159], v[104:107]
    v_fma_f32 v134, -v110, v110, v126
    v_fma_f32 v135, -v111, v111, v127
    v_max_f32 v132, v132, v56
    v_max_f32 v133, v133, v56
    v_max_f32 v134, v134, v56
    v_max_f32 v135, v135, v56
    v_rsq_f32 v132, v132
    v_rsq_f32 v133, v133
    v_rsq_f32 v134, v134
    v_rsq_f32 v135, v135
    v_pk_fma_f32 v[104:105], v[108:109], v[60:61], v[104:105] op_sel:[0,1,0] neg_lo:[1,0,0] neg_hi:[1,0,0]
    v_pk_fma_f32 v[106:107], v[110:111], v[60:61], v[106:107] op_sel:[0,1,0] neg_lo:[1,0,0] neg_hi:[1,0,0]
    v_pk_fma_f32 v[104:105], v[104:105], v[132:133], v[62:63] op_sel_hi:[1,1,0]
    v_pk_fma_f32 v[106:107], v[106:107], v[134:135], v[62:63] op_sel_hi:[1,1,0]
L_back11:
    v_max3_f32 v1, v104, v105, v106
    v_max_f32 v1, v1, v107
    v_cmp_lt_f32 vcc, s52, v1
    v_exp_f32 v112, v104
    v_exp_f32 v113, v105
    v_exp_f32 v114, v106
    v_exp_f32 v115, v107
    s_cbranch_vccnz L_site11
    v_cvt_pk_bf16_f32 v72, v88, v89
    v_cvt_pk_bf16_f32 v73, v90, v91
    v_pk_mul_f32 v[104:105], v[112:113], v[132:133]
    v_pk_mul_f32 v[106:107], v[114:115], v[134:135]
    v_cvt_pk_bf16_f32 v74, v104, v105
    v_cvt_pk_bf16_f32 v75, v106, v107
    ds_write_b128 v237, v[72:75] offset:12288
    s_waitcnt lgkmcnt(0)
    s_barrier
    ds_read_b32 v9, v254 offset:4100
    ds_read_b128 a[192:195], v253 offset:12288
    ds_read_b128 a[196:199], v253 offset:13312
    ds_read_b128 a[200:203], v253 offset:14336
    ds_read_b128 a[204:207], v253 offset:15360
    buffer_load_dwordx4 v[216:219], v65, s[32:35], s61 offen offset:2048 sc1
    s_waitcnt lgkmcnt(4)
    v_cmp_ne_u32 vcc, 0, v9
    s_cbranch_vccnz L_xt11
L_post11:
    s_waitcnt lgkmcnt(3)
    v_mfma_f32_16x16x32_bf16 v[16:19], a[144:147], a[192:195], v[16:19]
    v_add_f32 v68, v68, v104
    v_add_f32 v69, v69, v105
    v_mfma_f32_16x16x32_bf16 v[20:23], a[160:163], a[192:195], v[20:23]
    v_add_f32 v70, v70, v106
    v_add_f32 v71, v71, v107
    v_mfma_f32_16x16x32_bf16 v[24:27], a[176:179], a[192:195], v[24:27]
    v_add_f32 v63, v63, v112
    v_fma_f32 v64, v104, v108, v64
    s_waitcnt lgkmcnt(2)
    v_mfma_f32_16x16x32_bf16 v[16:19], a[148:151], a[196:199], v[16:19]
    s_waitcnt vmcnt(13)
    ds_read_b128 a[96:99], v42 offset:0
    ds_read_b128 a[100:103], v43 offset:0
    v_mfma_f32_16x16x32_bf16 v[20:23], a[164:167], a[196:199], v[20:23]
    v_add_f32 v63, v63, v113
    v_fma_f32 v64, v105, v109, v64
    v_mfma_f32_16x16x32_bf16 v[24:27], a[180:183], a[196:199], v[24:27]
    v_add_f32 v63, v63, v114
    v_fma_f32 v64, v106, v110, v64
    s_waitcnt lgkmcnt(3)
    v_mfma_f32_16x16x32_bf16 v[16:19], a[152:155], a[200:203], v[16:19]
    v_add_f32 v63, v63, v115
    v_fma_f32 v64, v107, v111, v64
    v_mfma_f32_16x16x32_bf16 v[20:23], a[168:171], a[200:203], v[20:23]
    s_waitcnt vmcnt(11)
    ds_read_b128 a[104:107], v42 offset:2048
    ds_read_b128 a[108:111], v43 offset:2048
    v_mfma_f32_16x16x32_bf16 v[24:27], a[184:187], a[200:203], v[24:27]
    s_waitcnt lgkmcnt(4)
    v_mfma_f32_16x16x32_bf16 v[16:19], a[156:159], a[204:207], v[16:19]
    v_mfma_f32_16x16x32_bf16 v[20:23], a[172:175], a[204:207], v[20:23]
    v_mfma_f32_16x16x32_bf16 v[24:27], a[188:191], a[204:207], v[24:27]
    s_waitcnt lgkmcnt(3)
    v_mfma_f32_16x16x32_bf16 v[96:99], a[96:99], a[96:99], v[84:87]
    v_mfma_f32_16x16x32_bf16 v[100:103], a[96:99], a[48:51], 0
    s_waitcnt lgkmcnt(2)
    v_mfma_f32_16x16x32_bf16 v[96:99], a[100:103], a[100:103], v[96:99]
    v_mfma_f32_16x16x32_bf16 v[100:103], a[100:103], a[52:55], v[100:103]
    s_waitcnt vmcnt(9)
    ds_read_b128 a[112:115], v42 offset:4096
    ds_read_b128 a[116:119], v43 offset:4096
    s_barrier
    v_mfma_f32_16x16x32_bf16 v[92:95], a[96:99], v[52:55], v[80:83]
    buffer_load_dwordx4 v[220:223], v65, s[32:35], s61 offen offset:3072 sc1
    ds_read_b64_tr_b16 a[0:1], v47 offset:0
    v_mfma_f32_16x16x32_bf16 v[88:91], a[96:99], v[136:139], v[76:79]
    ds_read_b64_tr_b16 a[4:5], v47 offset:12288
    v_mfma_f32_16x16x32_bf16 v[92:95], a[100:103], v[52:55], v[92:95]
    ds_read_b64_tr_b16 a[8:9], v47 offset:24576
    v_mfma_f32_16x16x32_bf16 v[88:91], a[100:103], v[140:143], v[88:91]
    ds_read_b64_tr_b16 a[12:13], v47 offset:36864
    s_waitcnt lgkmcnt(7)
    v_mfma_f32_16x16x32_bf16 v[96:99], a[104:107], a[104:107], v[96:99]
    ds_read_b64_tr_b16 a[16:17], v48 offset:0
    v_mfma_f32_16x16x32_bf16 v[100:103], a[104:107], a[56:59], v[100:103]
    ds_read_b64_tr_b16 a[20:21], v48 offset:12288
    s_waitcnt lgkmcnt(8)
    v_mfma_f32_16x16x32_bf16 v[96:99], a[108:111], a[108:111], v[96:99]
    ds_read_b64_tr_b16 a[24:25], v48 offset:24576
    v_mfma_f32_16x16x32_bf16 v[100:103], a[108:111], a[60:63], v[100:103]
    ds_read_b64_tr_b16 a[28:29], v48 offset:36864
    v_mfma_f32_16x16x32_bf16 v[92:95], a[104:107], v[52:55], v[92:95]
    ds_read_b64_tr_b16 a[32:33], v49 offset:0
    v_mfma_f32_16x16x32_bf16 v[88:91], a[104:107], v[144:147], v[88:91]
    ds_read_b64_tr_b16 a[36:37], v49 offset:12288
    v_mfma_f32_16x16x32_bf16 v[92:95], a[108:111], v[52:55], v[92:95]
    ds_read_b64_tr_b16 a[40:41], v49 offset:24576
    v_mfma_f32_16x16x32_bf16 v[88:91], a[108:111], v[148:151], v[88:91]
    ds_read_b64_tr_b16 a[44:45], v49 offset:36864
    s_waitcnt lgkmcnt(13)
    v_mfma_f32_16x16x32_bf16 v[96:99], a[112:115], a[112:115], v[96:99]
    v_mfma_f32_16x16x32_bf16 v[100:103], a[112:115], a[64:67], v[100:103]
    s_waitcnt lgkmcnt(12)
    v_mfma_f32_16x16x32_bf16 v[96:99], a[116:119], a[116:119], v[96:99]
    v_mfma_f32_16x16x32_bf16 v[100:103], a[116:119], a[68:71], v[100:103]
    s_waitcnt vmcnt(8)
    ds_read_b128 a[120:123], v42 offset:6144
    ds_read_b128 a[124:127], v43 offset:6144
    v_mfma_f32_16x16x32_bf16 v[92:95], a[112:115], v[52:55], v[92:95]
    v_mfma_f32_16x16x32_bf16 v[92:95], a[116:119], v[52:55], v[92:95]
    s_nop 2
    v_fma_f32 v96, v100, 2.0, v96
    v_fma_f32 v97, v101, 2.0, v97
    v_mfma_f32_16x16x32_bf16 v[88:91], a[112:115], v[152:155], v[88:91]
    v_fma_f32 v98, v102, 2.0, v98
    v_fma_f32 v99, v103, 2.0, v99
    v_mfma_f32_16x16x32_bf16 v[88:91], a[116:119], v[156:159], v[88:91]
    v_cndmask_b32 v3, 0, v96, s[44:45]
    v_cndmask_b32 v3, v3, v97, s[46:47]
    v_cndmask_b32 v3, v3, v98, s[48:49]
    v_cndmask_b32 v3, v3, v99, s[50:51]
    s_nop 0
    s_nop 0
    v_mfma_f32_16x16x4_f32 v[120:123], v3, v60, v[56:59]
    s_waitcnt lgkmcnt(1)
    v_mfma_f32_16x16x32_bf16 v[112:115], a[120:123], a[120:123], v[84:87]
    v_mfma_f32_16x16x32_bf16 v[116:119], a[120:123], a[48:51], 0
    s_waitcnt vmcnt(6)
    ds_read_b128 a[128:131], v42 offset:8192
    ds_read_b128 a[132:135], v43 offset:8192
    s_add_u32 s61, s60, 3162112
    buffer_load_dwordx4 v[224:227], v65, s[32:35], s61 offen offset:0 sc1
    s_waitcnt lgkmcnt(2)
    v_mfma_f32_16x16x32_bf16 v[112:115], a[124:127], a[124:127], v[112:115]
    v_fma_f32 v128, -v92, v92, v120
    v_fma_f32 v129, -v93, v93, v121
    v_fma_f32 v130, -v94, v94, v122
    v_mfma_f32_16x16x32_bf16 v[116:119], a[124:127], a[52:55], v[116:119]
    v_fma_f32 v131, -v95, v95, v123
    v_max_f32 v128, v128, v56
    v_max_f32 v129, v129, v56
    v_mfma_f32_16x16x32_bf16 v[108:111], a[120:123], v[52:55], v[80:83]
    v_max_f32 v130, v130, v56
    v_max_f32 v131, v131, v56
    v_mfma_f32_16x16x32_bf16 v[104:107], a[120:123], v[136:139], v[76:79]
    v_rsq_f32 v128, v128
    v_mfma_f32_16x16x32_bf16 v[108:111], a[124:127], v[52:55], v[108:111]
    v_rsq_f32 v129, v129
    v_mfma_f32_16x16x32_bf16 v[104:107], a[124:127], v[140:143], v[104:107]
    v_rsq_f32 v130, v130
    s_waitcnt lgkmcnt(1)
    v_mfma_f32_16x16x32_bf16 v[112:115], a[128:131], a[128:131], v[112:115]
    v_rsq_f32 v131, v131
    v_fma_f32 v88, -v92, v61, v88
    v_mfma_f32_16x16x32_bf16 v[116:119], a[128:131], a[56:59], v[116:119]
    v_fma_f32 v89, -v93, v61, v89
    v_fma_f32 v90, -v94, v61, v90
    v_fma_f32 v91, -v95, v61, v91
    s_waitcnt lgkmcnt(0)
    v_mfma_f32_16x16x32_bf16 v[112:115], a[132:135], a[132:135], v[112:115]
    v_fma_f32 v88, v88, v128, v62
    v_fma_f32 v89, v89, v129, v62
    v_fma_f32 v90, v90, v130, v62
    v_mfma_f32_16x16x32_bf16 v[116:119], a[132:135], a[60:63], v[116:119]
    v_fma_f32 v91, v91, v131, v62
    v_max3_f32 v1, v88, v89, v90
    v_max_f32 v1, v1, v91
    v_mfma_f32_16x16x32_bf16 v[108:111], a[128:131], v[52:55], v[108:111]
    v_cmp_lt_f32 vcc, s52, v1
    s_cbranch_vccnz L_site12
L_back12:
    v_mfma_f32_16x16x32_bf16 v[104:107], a[128:131], v[144:147], v[104:107]
    s_waitcnt vmcnt(5)
    ds_read_b128 a[136:139], v42 offset:10240
    ds_read_b128 a[140:143], v43 offset:10240
    s_barrier
    buffer_load_dwordx4 v[228:231], v65, s[32:35], s61 offen offset:1024 sc1
    s_cmp_eq_u32 s0, 1
    s_cbranch_scc0 L_nolate
    s_add_u32 s56, s60, 3145728
    buffer_load_dwordx4 v[160:163], v65, s[32:35], s56 offen offset:0 sc1
    buffer_load_dwordx4 v[164:167], v65, s[32:35], s56 offen offset:1024 sc1
    buffer_load_dwordx4 v[168:171], v65, s[32:35], s56 offen offset:2048 sc1
    buffer_load_dwordx4 v[172:175], v65, s[32:35], s56 offen offset:3072 sc1
    s_add_u32 s56, s60, 3149824
    buffer_load_dwordx4 v[176:179], v65, s[32:35], s56 offen offset:0 sc1
    buffer_load_dwordx4 v[180:183], v65, s[32:35], s56 offen offset:1024 sc1
    buffer_load_dwordx4 v[184:187], v65, s[32:35], s56 offen offset:2048 sc1
    buffer_load_dwordx4 v[188:191], v65, s[32:35], s56 offen offset:3072 sc1
    s_add_u32 s56, s60, 3153920
    buffer_load_dwordx4 v[192:195], v65, s[32:35], s56 offen offset:0 sc1
    buffer_load_dwordx4 v[196:199], v65, s[32:35], s56 offen offset:1024 sc1
    buffer_load_dwordx4 v[200:203], v65, s[32:35], s56 offen offset:2048 sc1
    buffer_load_dwordx4 v[204:207], v65, s[32:35], s56 offen offset:3072 sc1
L_nolate:
    buffer_load_dword v244, v28, s[32:35], s28 offen
    v_mfma_f32_16x16x32_bf16 v[108:111], a[132:135], v[52:55], v[108:111]
    ds_read_b64_tr_b16 a[2:3], v47 offset:6144
    v_exp_f32 v96, v88
    v_mfma_f32_16x16x32_bf16 v[104:107], a[132:135], v[148:151], v[104:107]
    ds_read_b64_tr_b16 a[6:7], v47 offset:18432
    v_exp_f32 v97, v89
    s_waitcnt lgkmcnt(3)
    v_mfma_f32_16x16x32_bf16 v[112:115], a[136:139], a[136:139], v[112:115]
    ds_read_b64_tr_b16 a[10:11], v47 offset:30720
    v_exp_f32 v98, v90
    v_mfma_f32_16x16x32_bf16 v[116:119], a[136:139], a[64:67], v[116:119]
    ds_read_b64_tr_b16 a[14:15], v47 offset:43008
    v_exp_f32 v99, v91
    s_waitcnt lgkmcnt(4)
    v_mfma_f32_16x16x32_bf16 v[112:115], a[140:143], a[140:143], v[112:115]
    ds_read_b64_tr_b16 a[18:19], v48 offset:6144
    v_mul_f32 v88, v96, v128
    v_mul_f32 v89, v97, v129
    v_mfma_f32_16x16x32_bf16 v[116:119], a[140:143], a[68:71], v[116:119]
    ds_read_b64_tr_b16 a[22:23], v48 offset:18432
    v_mul_f32 v90, v98, v130
    v_mul_f32 v91, v99, v131
    v_mfma_f32_16x16x32_bf16 v[108:111], a[136:139], v[52:55], v[108:111]
    ds_read_b64_tr_b16 a[26:27], v48 offset:30720
    v_add_f32 v63, v63, v96
    v_fmac_f32 v64, v88, v92
    v_mfma_f32_16x16x32_bf16 v[108:111], a[140:143], v[52:55], v[108:111]
    ds_read_b64_tr_b16 a[30:31], v48 offset:43008
    v_add_f32 v63, v63, v97
    v_fmac_f32 v64, v89, v93
    v_add_f32 v63, v63, v98
    v_fma_f32 v112, v116, 2.0, v112
    v_fma_f32 v113, v117, 2.0, v113
    v_fma_f32 v114, v118, 2.0, v114
    v_fma_f32 v115, v119, 2.0, v115
    v_cndmask_b32 v4, 0, v112, s[44:45]
    v_cndmask_b32 v4, v4, v113, s[46:47]
    v_cndmask_b32 v4, v4, v114, s[48:49]
    v_cndmask_b32 v4, v4, v115, s[50:51]
    ds_read_b64_tr_b16 a[34:35], v49 offset:6144
    ds_read_b64_tr_b16 a[38:39], v49 offset:18432
    v_mfma_f32_16x16x4_f32 v[124:127], v4, v60, v[56:59]
    ds_read_b64_tr_b16 a[42:43], v49 offset:30720
    ds_read_b64_tr_b16 a[46:47], v49 offset:43008
    v_fmac_f32 v64, v90, v94
    v_add_f32 v63, v63, v99
    v_fmac_f32 v64, v91, v95
    v_add_f32 v68, v68, v88
    v_add_f32 v69, v69, v89
    v_add_f32 v70, v70, v90
    v_add_f32 v71, v71, v91
    v_mfma_f32_16x16x32_bf16 v[104:107], a[136:139], v[152:155], v[104:107]
    v_cvt_pk_bf16_f32 v72, v88, v89
    v_cvt_pk_bf16_f32 v73, v90, v91
    v_mfma_f32_16x16x32_bf16 v[104:107], a[140:143], v[156:159], v[104:107]
    v_fma_f32 v132, -v108, v108, v124
    v_fma_f32 v133, -v109, v109, v125
    v_fma_f32 v134, -v110, v110, v126
    v_fma_f32 v135, -v111, v111, v127
    v_max_f32 v132, v132, v56
    v_max_f32 v133, v133, v56
    v_max_f32 v134, v134, v56
    v_max_f32 v135, v135, v56
    v_rsq_f32 v132, v132
    v_rsq_f32 v133, v133
    v_rsq_f32 v134, v134
    v_rsq_f32 v135, v135
    v_pk_fma_f32 v[104:105], v[108:109], v[60:61], v[104:105] op_sel:[0,1,0] neg_lo:[1,0,0] neg_hi:[1,0,0]
    v_pk_fma_f32 v[106:107], v[110:111], v[60:61], v[106:107] op_sel:[0,1,0] neg_lo:[1,0,0] neg_hi:[1,0,0]
    v_pk_fma_f32 v[104:105], v[104:105], v[132:133], v[62:63] op_sel_hi:[1,1,0]
    v_pk_fma_f32 v[106:107], v[106:107], v[134:135], v[62:63] op_sel_hi:[1,1,0]
L_back13:
    v_max3_f32 v1, v104, v105, v106
    v_max_f32 v1, v1, v107
    v_cmp_lt_f32 vcc, s52, v1
    v_exp_f32 v112, v104
    v_exp_f32 v113, v105
    v_exp_f32 v114, v106
    v_exp_f32 v115, v107
    s_cbranch_vccnz L_site13
    v_pk_mul_f32 v[104:105], v[112:113], v[132:133]
    v_pk_mul_f32 v[106:107], v[114:115], v[134:135]
    v_cvt_pk_bf16_f32 v74, v104, v105
    v_cvt_pk_bf16_f32 v75, v106, v107
    ds_write_b128 v237, v[72:75] offset:0
    v_pk_add_f32 v[68:69], v[68:69], v[104:105]
    v_pk_add_f32 v[70:71], v[70:71], v[106:107]
    v_pk_add_f32 v[112:113], v[112:113], v[114:115]
    v_cvt_pk_bf16_f32 v66, v68, v69
    v_cvt_pk_bf16_f32 v67, v70, v71
    ds_write_b64 v238, v[66:67]
    v_pk_mul_f32 v[114:115], v[104:105], v[108:109]
    v_add_f32 v63, v63, v112
    v_pk_fma_f32 v[114:115], v[106:107], v[110:111], v[114:115]
    v_add_f32 v10, v63, v113
    v_add_f32 v64, v64, v114
    v_add_f32 v11, v64, v115
    ds_write_b64 v238, v[10:11] offset:2048
L_merge:
    s_waitcnt lgkmcnt(0)
    s_barrier
L_postx:
    ds_read_b32 v9, v254 offset:4096
    ds_read_b128 v[92:95], v253 offset:0
    ds_read_b128 v[96:99], v253 offset:1024
    ds_read_b128 v[100:103], v253 offset:2048
    ds_read_b64 v[136:137], v254 offset:2048
    ds_read_b64 v[138:139], v254 offset:2560
    ds_read_b64 v[140:141], v254 offset:3072
    ds_read_b64 v[142:143], v254 offset:3584
    ds_read_b128 v[116:119], v253 offset:3072
    ds_read_b64 v[120:121], v254 offset:0
    ds_read_b64 v[122:123], v254 offset:512
    s_waitcnt lgkmcnt(10)
    v_cmp_ne_u32 vcc, 0, v9
    s_cbranch_vccnz L_xlast
    s_waitcnt lgkmcnt(9)
    v_mfma_f32_16x16x32_bf16 v[16:19], a[0:3], v[92:95], v[16:19]
    ds_read_b64 v[124:125], v254 offset:1024
    v_mfma_f32_16x16x32_bf16 v[20:23], a[16:19], v[92:95], v[20:23]
    ds_read_b64 v[126:127], v254 offset:1536
    v_mfma_f32_16x16x32_bf16 v[24:27], a[32:35], v[92:95], v[24:27]
    s_waitcnt lgkmcnt(10)
    v_mfma_f32_16x16x32_bf16 v[16:19], a[4:7], v[96:99], v[16:19]
    v_mfma_f32_16x16x32_bf16 v[20:23], a[20:23], v[96:99], v[20:23]
    v_mfma_f32_16x16x32_bf16 v[24:27], a[36:39], v[96:99], v[24:27]
    s_waitcnt lgkmcnt(9)
    v_mfma_f32_16x16x32_bf16 v[16:19], a[8:11], v[100:103], v[16:19]
    s_waitcnt lgkmcnt(5)
    v_add_f32 v1, v136, v138
    v_add_f32 v2, v137, v139
    v_add_f32 v140, v140, v142
    v_mfma_f32_16x16x32_bf16 v[20:23], a[24:27], v[100:103], v[20:23]
    v_add_f32 v141, v141, v143
    v_add_f32 v1, v1, v140
    v_add_f32 v2, v2, v141
    v_mfma_f32_16x16x32_bf16 v[24:27], a[40:43], v[100:103], v[24:27]
    s_nop 0
    v_permlane32_swap_b32 v1, v2
    v_add_f32 v1, v1, v2
    v_mov_b32 v2, v1
    s_waitcnt lgkmcnt(4)
    v_mfma_f32_16x16x32_bf16 v[16:19], a[12:15], v[116:119], v[16:19]
    v_permlane16_swap_b32 v1, v2
    v_add_f32 v1, v1, v2
    v_mov_b32 v2, v1
    s_waitcnt lgkmcnt(2)
    v_mfma_f32_16x16x32_bf16 v[16:19], a[72:75], v[120:123], v[16:19]
    v_permlane32_swap_b32 v1, v2
    v_rcp_f32 v3, v1
    s_waitcnt lgkmcnt(0)
    v_mfma_f32_16x16x32_bf16 v[16:19], a[76:79], v[124:127], v[16:19]
    v_log_f32 v4, v1
    v_mul_f32 v5, v60, v3
    v_mfma_f32_16x16x32_bf16 v[20:23], a[28:31], v[116:119], v[20:23]
    v_mul_f32 v6, v2, v3
    v_sub_f32 v4, v4, v255
    v_mfma_f32_16x16x32_bf16 v[20:23], a[80:83], v[120:123], v[20:23]
    v_mfma_f32_16x16x32_bf16 v[20:23], a[84:87], v[124:127], v[20:23]
    v_mfma_f32_16x16x32_bf16 v[24:27], a[44:47], v[116:119], v[24:27]
    v_fma_f32 v16, v16, v5, -v6
    v_fma_f32 v17, v17, v5, -v6
    v_mfma_f32_16x16x32_bf16 v[24:27], a[88:91], v[120:123], v[24:27]
    v_fma_f32 v18, v18, v5, -v6
    v_fma_f32 v19, v19, v5, -v6
    v_mfma_f32_16x16x32_bf16 v[24:27], a[92:95], v[124:127], v[24:27]
    v_cvt_pk_bf16_f32 v66, v16, v17
    v_cvt_pk_bf16_f32 v67, v18, v19
    ds_write_b64 v236, v[66:67] offset:0
    v_pk_fma_f32 v[20:21], v[20:21], v[4:5], v[6:7] op_sel:[0,1,0] op_sel_hi:[1,1,0] neg_lo:[0,0,1] neg_hi:[0,0,1]
    v_pk_fma_f32 v[22:23], v[22:23], v[4:5], v[6:7] op_sel:[0,1,0] op_sel_hi:[1,1,0] neg_lo:[0,0,1] neg_hi:[0,0,1]
    v_cvt_pk_bf16_f32 v68, v20, v21
    v_cvt_pk_bf16_f32 v69, v22, v23
    ds_write_b64 v236, v[68:69] offset:512
    v_pk_fma_f32 v[24:25], v[24:25], v[4:5], v[6:7] op_sel:[0,1,0] op_sel_hi:[1,1,0] neg_lo:[0,0,1] neg_hi:[0,0,1]
    v_pk_fma_f32 v[26:27], v[26:27], v[4:5], v[6:7] op_sel:[0,1,0] op_sel_hi:[1,1,0] neg_lo:[0,0,1] neg_hi:[0,0,1]
    v_cvt_pk_bf16_f32 v70, v24, v25
    v_cvt_pk_bf16_f32 v71, v26, v27
    ds_write_b64 v236, v[70:71] offset:1024
    s_waitcnt lgkmcnt(0)
    s_barrier
    ds_read_b128 v[136:139], v241 offset:0
    ds_read_b128 v[140:143], v241 offset:1024
    ds_read_b128 v[144:147], v241 offset:2048
    ds_read_b128 v[148:151], v241 offset:3072
    ds_read_b128 v[152:155], v241 offset:4096
    ds_read_b128 v[156:159], v241 offset:5120
    s_waitcnt vmcnt(1)
    v_subrev_u32 v35, s39, v4
    v_add_u32 v39, s39, v4
    s_waitcnt lgkmcnt(5)
    v_mfma_f32_16x16x32_bf16 v[16:19], v[160:163], v[136:139], 0
    v_mfma_f32_16x16x32_bf16 v[20:23], v[184:187], v[136:139], 0
    v_mfma_f32_16x16x32_bf16 v[24:27], v[208:211], v[136:139], 0
    s_waitcnt lgkmcnt(4)
    v_mfma_f32_16x16x32_bf16 v[16:19], v[164:167], v[140:143], v[16:19]
    v_mfma_f32_16x16x32_bf16 v[20:23], v[188:191], v[140:143], v[20:23]
    v_mfma_f32_16x16x32_bf16 v[24:27], v[212:215], v[140:143], v[24:27]
    s_waitcnt lgkmcnt(3)
    v_mfma_f32_16x16x32_bf16 v[16:19], v[168:171], v[144:147], v[16:19]
    v_mfma_f32_16x16x32_bf16 v[20:23], v[192:195], v[144:147], v[20:23]
    v_mfma_f32_16x16x32_bf16 v[24:27], v[216:219], v[144:147], v[24:27]
    s_waitcnt lgkmcnt(2)
    v_mfma_f32_16x16x32_bf16 v[16:19], v[172:175], v[148:151], v[16:19]
    s_waitcnt lgkmcnt(1)
    v_mfma_f32_16x16x32_bf16 v[16:19], v[176:179], v[152:155], v[16:19]
    s_waitcnt lgkmcnt(0)
    v_mfma_f32_16x16x32_bf16 v[16:19], v[180:183], v[156:159], v[16:19]
    v_mfma_f32_16x16x32_bf16 v[20:23], v[196:199], v[148:151], v[20:23]
    v_mfma_f32_16x16x32_bf16 v[20:23], v[200:203], v[152:155], v[20:23]
    v_mfma_f32_16x16x32_bf16 v[20:23], v[204:207], v[156:159], v[20:23]
    v_mfma_f32_16x16x32_bf16 v[24:27], v[220:223], v[148:151], v[24:27]
    v_mfma_f32_16x16x32_bf16 v[24:27], v[224:227], v[152:155], v[24:27]
    s_nop 2
    v_cvt_pk_bf16_f32 v32, v16, v17
    v_mfma_f32_16x16x32_bf16 v[24:27], v[228:231], v[156:159], v[24:27]
    v_cvt_pk_bf16_f32 v33, v18, v19
    v_cvt_pk_bf16_f32 v34, v20, v21
    v_cvt_pk_bf16_f32 v36, v22, v23
    v_permlane16_swap_b32 v35, v39
    s_nop 0
    v_permlane16_swap_b32 v32, v36
    s_nop 1
    v_cvt_pk_bf16_f32 v37, v24, v25
    v_cvt_pk_bf16_f32 v38, v26, v27
    s_nop 0
    v_permlane16_swap_b32 v33, v37
    v_permlane16_swap_b32 v34, v38
    buffer_store_dwordx4 v[32:35], v242, s[32:35], s28 offen sc1
    buffer_store_dwordx4 v[36:39], v243, s[32:35], s28 offen sc1
    s_cmp_lt_u32 s29, 64
    s_cbranch_scc0 L_fin
    buffer_load_dwordx4 v[76:79], v29, s[32:35], s30 offen offset:0 sc1
    buffer_load_dwordx4 v[80:83], v29, s[32:35], s30 offen offset:2048 sc1
    buffer_load_dwordx4 v[84:87], v29, s[32:35], s31 offen offset:0 sc1
    buffer_load_dwordx4 v[108:111], v29, s[32:35], s31 offen offset:2048 sc1
    ds_bpermute_b32 v42, v252, v4
    v_bfe_u32 v48, v0, 0, 1
    v_cmp_eq_u32 vcc, 1, v48
    v_mov_b32 v246, s39
    s_movk_i32 s26, 0x11
    v_sub_u32 v247, 0, v246
    v_cndmask_b32 v247, v247, v246, vcc
    v_mul_lo_u32 v246, v247, -2
    v_mov_b32 v16, 0
    v_mov_b32 v17, 0
    v_mov_b32 v18, 0
    v_mov_b32 v19, 0
    v_mov_b32 v20, 0
    v_mov_b32 v21, 0
    v_mov_b32 v22, 0
    v_mov_b32 v97, 0
    s_mov_b32 s53, 0
    v_mov_b32 v160, 0x11
    v_mov_b32 v161, 0x22
    v_mov_b32 v162, 0x44
    v_mov_b32 v163, 0x88
    s_waitcnt vmcnt(0)
    v_sub_u32_dpp v136, v79, v79 quad_perm:[1,0,3,2] row_mask:0xf bank_mask:0xf
    v_sub_u32_dpp v137, v83, v83 quad_perm:[1,0,3,2] row_mask:0xf bank_mask:0xf
    v_sub_u32_dpp v138, v87, v87 quad_perm:[1,0,3,2] row_mask:0xf bank_mask:0xf
    v_sub_u32_dpp v139, v111, v111 quad_perm:[1,0,3,2] row_mask:0xf bank_mask:0xf
    v_cmp_eq_u32 s[6:7], v136, v246
    v_cmp_eq_u32 s[8:9], v137, v246
    v_cmp_eq_u32 s[10:11], v138, v246
    v_cmp_eq_u32 s[12:13], v139, v246
    v_cndmask_b32 v136, v160, 0, s[6:7]
    v_cndmask_b32 v137, v161, 0, s[8:9]
    v_cndmask_b32 v138, v162, 0, s[10:11]
    v_cndmask_b32 v139, v163, 0, s[12:13]
    v_or3_b32 v96, v136, v137, v138
    v_or_b32 v96, v96, v139
    v_cmp_ne_u32 vcc, 0, v96
    v_sub_u32 v168, v79, v247
    v_sub_u32 v169, v83, v247
    s_cbranch_vccz L_c_all
    v_lshrrev_b32 v48, v97, v96
    v_ffbl_b32 v48, v48
    v_add_u32 v48, v48, v97
    v_and_b32 v48, 3, v48
    v_lshl_add_u32 v51, v48, 11, v29
    v_lshlrev_b32 v88, v48, s26
    v_add_u32 v97, 1, v48
    s_mov_b64 exec, vcc
    buffer_load_dwordx4 v[136:139], v51, s[32:35], s30 offen sc1
    s_mov_b64 exec, -1
    v_lshrrev_b32 v48, v97, v96
    v_ffbl_b32 v48, v48
    v_add_u32 v48, v48, v97
    v_and_b32 v48, 3, v48
    v_lshl_add_u32 v51, v48, 11, v29
    v_lshlrev_b32 v89, v48, s26
    v_add_u32 v97, 1, v48
    s_mov_b64 exec, vcc
    buffer_load_dwordx4 v[140:143], v51, s[32:35], s30 offen sc1
    s_mov_b64 exec, -1
L_c_all:
    v_sub_u32 v170, v87, v247
    v_sub_u32 v171, v111, v247
    s_waitcnt lgkmcnt(0)
    v_sub_f32 v168, v168, v42
    v_sub_f32 v169, v169, v42
    v_sub_f32 v170, v170, v42
    v_sub_f32 v171, v171, v42
    v_exp_f32 v168, v168
    v_exp_f32 v169, v169
    v_exp_f32 v170, v170
    v_exp_f32 v171, v171
    v_cvt_pk_bf16_f32 v168, v168, 0
    v_cvt_pk_bf16_f32 v169, v169, 0
    v_cvt_pk_bf16_f32 v170, v170, 0
    v_cvt_pk_bf16_f32 v171, v171, 0
    v_lshlrev_b32 v176, 16, v168
    v_lshlrev_b32 v177, 16, v169
    v_lshlrev_b32 v178, 16, v170
    v_lshlrev_b32 v179, 16, v171
    s_mov_b64 exec, s[6:7]
    v_dot2c_f32_bf16 v16, v76, v168
    v_dot2c_f32_bf16 v18, v77, v168
    v_dot2c_f32_bf16 v20, v78, v168
    v_add_f32 v22, v22, v176
    v_dot2c_f32_bf16 v17, v76, v176
    v_dot2c_f32_bf16 v19, v77, v176
    v_dot2c_f32_bf16 v21, v78, v176
    s_mov_b64 exec, s[8:9]
    v_dot2c_f32_bf16 v16, v80, v169
    v_dot2c_f32_bf16 v18, v81, v169
    v_dot2c_f32_bf16 v20, v82, v169
    v_add_f32 v22, v22, v177
    v_dot2c_f32_bf16 v17, v80, v177
    v_dot2c_f32_bf16 v19, v81, v177
    v_dot2c_f32_bf16 v21, v82, v177
    s_mov_b64 exec, s[10:11]
    v_dot2c_f32_bf16 v16, v84, v170
    v_dot2c_f32_bf16 v18, v85, v170
    v_dot2c_f32_bf16 v20, v86, v170
    v_add_f32 v22, v22, v178
    v_dot2c_f32_bf16 v17, v84, v178
    v_dot2c_f32_bf16 v19, v85, v178
    v_dot2c_f32_bf16 v21, v86, v178
    s_mov_b64 exec, s[12:13]
    v_dot2c_f32_bf16 v16, v108, v171
    v_dot2c_f32_bf16 v18, v109, v171
    v_dot2c_f32_bf16 v20, v110, v171
    v_add_f32 v22, v22, v179
    v_dot2c_f32_bf16 v17, v108, v179
    v_dot2c_f32_bf16 v19, v109, v179
    v_dot2c_f32_bf16 v21, v110, v179
    s_mov_b64 exec, -1
    s_cbranch_vccz L_c_red
L_c_loop:
    s_waitcnt vmcnt(1)
    v_sub_u32_dpp v48, v139, v139 quad_perm:[1,0,3,2] row_mask:0xf bank_mask:0xf
    v_and_b32 v49, v88, v96
    v_cmpx_eq_u32 vcc, v48, v246
    v_cmpx_ne_u32 vcc, 0, v49
    v_xor_b32 v96, v96, v88
    v_sub_u32 v49, v139, v247
    v_sub_f32 v49, v49, v42
    v_exp_f32 v49, v49
    s_cbranch_execz L_c_s0
    v_cvt_pk_bf16_f32 v49, v49, 0
    v_lshlrev_b32 v50, 16, v49
    v_dot2c_f32_bf16 v16, v136, v49
    v_dot2c_f32_bf16 v18, v137, v49
    v_dot2c_f32_bf16 v20, v138, v49
    v_add_f32 v22, v22, v50
    v_dot2c_f32_bf16 v17, v136, v50
    v_dot2c_f32_bf16 v19, v137, v50
    v_dot2c_f32_bf16 v21, v138, v50
L_c_s0:
    s_mov_b64 exec, -1
    v_cmp_ne_u32 vcc, 0, v96
    v_lshrrev_b32 v48, v97, v96
    v_ffbl_b32 v48, v48
    s_cbranch_vccz L_c_red
    v_add_u32 v48, v48, v97
    v_and_b32 v48, 3, v48
    v_lshl_add_u32 v51, v48, 11, v29
    v_lshlrev_b32 v88, v48, s26
    v_add_u32 v97, 1, v48
    s_mov_b64 exec, vcc
    buffer_load_dwordx4 v[136:139], v51, s[32:35], s30 offen sc1
    s_mov_b64 exec, -1
    s_waitcnt vmcnt(1)
    v_sub_u32_dpp v48, v143, v143 quad_perm:[1,0,3,2] row_mask:0xf bank_mask:0xf
    v_and_b32 v49, v89, v96
    v_cmpx_eq_u32 vcc, v48, v246
    v_cmpx_ne_u32 vcc, 0, v49
    v_xor_b32 v96, v96, v89
    v_sub_u32 v49, v143, v247
    v_sub_f32 v49, v49, v42
    v_exp_f32 v49, v49
    s_cbranch_execz L_c_s1
    v_cvt_pk_bf16_f32 v49, v49, 0
    v_lshlrev_b32 v50, 16, v49
    v_dot2c_f32_bf16 v16, v140, v49
    v_dot2c_f32_bf16 v18, v141, v49
    v_dot2c_f32_bf16 v20, v142, v49
    v_add_f32 v22, v22, v50
    v_dot2c_f32_bf16 v17, v140, v50
    v_dot2c_f32_bf16 v19, v141, v50
    v_dot2c_f32_bf16 v21, v142, v50
L_c_s1:
    s_mov_b64 exec, -1
    v_cmp_ne_u32 vcc, 0, v96
    v_lshrrev_b32 v48, v97, v96
    v_ffbl_b32 v48, v48
    s_cbranch_vccz L_c_red
    v_add_u32 v48, v48, v97
    v_and_b32 v48, 3, v48
    v_lshl_add_u32 v51, v48, 11, v29
    v_lshlrev_b32 v89, v48, s26
    v_add_u32 v97, 1, v48
    s_mov_b64 exec, vcc
    buffer_load_dwordx4 v[140:143], v51, s[32:35], s30 offen sc1
    s_mov_b64 exec, -1
    s_add_u32 s53, s53, 1
    s_cmp_lt_u32 s53, 65536
    s_cbranch_scc1 L_c_loop
L_c_red:
    v_mov_b32 v23, v22
    v_permlane32_swap_b32 v16, v20
    v_permlane32_swap_b32 v17, v21
    v_permlane32_swap_b32 v18, v22
    v_permlane32_swap_b32 v19, v23
    v_add_f32 v16, v16, v20
    v_add_f32 v17, v17, v21
    v_add_f32 v18, v18, v22
    v_add_f32 v19, v19, v23
    s_nop 0
    v_permlane16_swap_b32 v16, v18
    v_permlane16_swap_b32 v17, v19
    v_add_f32 v16, v16, v18
    v_add_f32 v17, v17, v19
    s_nop 0
    v_add_f32_dpp v48, v16, v16 row_ror:8 row_mask:0xf bank_mask:0x3
    s_nop 1
    v_add_f32_dpp v48, v17, v17 row_ror:8 row_mask:0xf bank_mask:0xc
    s_nop 1
    v_add_f32_dpp v48, v48, v48 row_shr:4 row_mask:0xf bank_mask:0xa
    ds_write_b32 v250, v48
    s_waitcnt lgkmcnt(0)
    s_barrier
    ds_read_b128 v[48:51], v251 offset:768
    ds_read_b128 v[52:55], v65
    v_lshlrev_b32 v18, 16, v249
    s_waitcnt lgkmcnt(1)
    v_add_f32 v48, v48, v49
    v_add_f32 v50, v50, v51
    v_add_f32 v48, v48, v50
    v_cmp_nlt_f32 vcc, v48, v232
    v_rcp_f32 v48, v48
    s_waitcnt lgkmcnt(0)
    s_cbranch_vccnz L_c_slow
L_c_out:
    s_cmp_lg_u32 s3, 0
    s_cbranch_scc1 L_fin
    v_add_f32 v52, v52, v53
    v_add_f32 v54, v54, v55
    v_add_f32 v52, v52, v54
    v_fmac_f32 v18, v52, v48
    v_cvt_pk_bf16_f32 v18, v18, v18
    buffer_store_short v18, v248, s[68:71], 0 offen sc1
    s_cmp_lg_u32 s2, 64
    s_cbranch_scc1 L_fin
    v_mov_b32 v48, s39
    v_mov_b32 v49, 0
    s_mov_b64 exec, 1
    buffer_store_dword v48, v49, s[32:35], 0 offen offset:0 sc1
    s_mov_b64 exec, -1
L_fin:
L_end:
    s_endpgm
L_hot:
L_prod:
    s_cmp_lg_u32 s3, 0
    s_cbranch_scc1 L_p_noq
    s_mov_b32 m0, 147456
    s_nop 0
    buffer_load_dwordx4 v16, s[72:75], 0 offen offset:0  lds
    buffer_load_dwordx4 v17, s[72:75], 0 offen offset:1024  lds
    buffer_load_dwordx4 v18, s[72:75], 0 offen offset:2048  lds
    buffer_load_dwordx4 v19, s[72:75], 0 offen offset:3072  lds
    s_mov_b32 m0, 151552
    s_nop 0
    buffer_load_dwordx4 v20, s[72:75], 0 offen offset:0  lds
    buffer_load_dwordx4 v21, s[72:75], 0 offen offset:1024  lds
L_p_noq:
    s_mul_i32 s60, s3, 18432
    s_add_u32 m0, s60, 73728
    s_nop 0
    buffer_load_dwordx4 v16, s[64:67], s60 offen offset:0  lds
    buffer_load_dwordx4 v17, s[64:67], s60 offen offset:1024  lds
    buffer_load_dwordx4 v18, s[64:67], s60 offen offset:2048  lds
    buffer_load_dwordx4 v19, s[64:67], s60 offen offset:3072  lds
    s_add_u32 m0, s60, 77824
    s_nop 0
    buffer_load_dwordx4 v20, s[64:67], s60 offen offset:0  lds
    buffer_load_dwordx4 v21, s[64:67], s60 offen offset:1024  lds
    s_add_u32 s60, s60, 6144
    s_add_u32 m0, s60, 73728
    s_nop 0
    buffer_load_dwordx4 v16, s[64:67], s60 offen offset:0  lds
    buffer_load_dwordx4 v17, s[64:67], s60 offen offset:1024  lds
    buffer_load_dwordx4 v18, s[64:67], s60 offen offset:2048  lds
    buffer_load_dwordx4 v19, s[64:67], s60 offen offset:3072  lds
    s_add_u32 m0, s60, 77824
    s_nop 0
    buffer_load_dwordx4 v20, s[64:67], s60 offen offset:0  lds
    buffer_load_dwordx4 v21, s[64:67], s60 offen offset:1024  lds
    s_add_u32 s60, s60, 6144
    s_add_u32 m0, s60, 73728
    s_nop 0
    buffer_load_dwordx4 v16, s[64:67], s60 offen offset:0  lds
    v_mov_b32 v52, 0x3f803f80
    v_mov_b32 v56, 0x3ebcbe62
    s_mov_b32 s44, 0x100001
    s_mov_b32 s45, 0x10000100
    v_mov_b32 v53, 0x3f803f80
    v_mov_b32 v57, 0x3ebcbe62
    s_mov_b32 s46, 0x200002
    buffer_load_dwordx4 v17, s[64:67], s60 offen offset:1024  lds
    s_mov_b32 s47, 0x20000200
    v_mov_b32 v54, 0x3f803f80
    v_mov_b32 v58, 0x3ebcbe62
    s_mov_b32 s48, 0x400004
    s_mov_b32 s49, 0x40000400
    v_mov_b32 v55, 0x3f803f80
    v_mov_b32 v59, 0x3ebcbe62
    buffer_load_dwordx4 v18, s[64:67], s60 offen offset:2048  lds
    s_mov_b32 s50, 0x800008
    s_mov_b32 s51, 0x80000800
    v_mov_b32 v60, 0x43400000
    v_lshrrev_b32 v1, 5, v0
    v_lshlrev_b32 v1, 8, v1
    v_and_b32 v2, 15, v0
    v_lshl_add_u32 v1, v2, 4, v1
    buffer_load_dwordx4 v19, s[64:67], s60 offen offset:3072  lds
    v_bfe_u32 v2, v0, 4, 1
    v_lshl_add_u32 v1, v2, 3, v1
    s_mul_i32 s56, s3, 1536
    s_add_u32 s56, s56, 153600
    v_add_u32 v134, s56, v1
    v_bfe_u32 v1, v0, 4, 1
    v_lshrrev_b32 v5, 5, v0
    s_add_u32 m0, s60, 77824
    s_nop 0
    buffer_load_dwordx4 v20, s[64:67], s60 offen offset:0  lds
    v_lshl_or_b32 v1, v1, 1, v5
    v_bfe_u32 v2, v0, 2, 2
    v_lshl_add_u32 v3, v1, 3, v2
    v_mul_u32_u24 v3, 384, v3
    v_and_b32 v4, 1, v0
    v_lshl_add_u32 v3, v4, 3, v3
    v_add_u32 v3, 73728, v3
    buffer_load_dwordx4 v21, s[64:67], s60 offen offset:1024  lds
    v_and_or_b32 v2, v2, 2, v5
    v_bfe_u32 v4, v0, 1, 1
    v_xor_b32 v2, v2, v4
    s_mul_i32 s56, s3, 6
    s_add_u32 s57, s56, 0
    v_xor_b32 v4, s57, v2
    v_lshl_add_u32 v124, v4, 4, v3
    s_lshl_b32 s61, s43, 2
    s_add_u32 s61, s61, s3
    s_mul_i32 s60, s61, 6144
    s_add_u32 m0, s41, 6144
    s_nop 0
    buffer_load_dwordx4 v16, s[68:71], s60 offen offset:0  lds
    v_xor_b32 v125, 64, v124
    s_add_u32 s57, s56, 2
    v_xor_b32 v4, s57, v2
    v_lshl_add_u32 v126, v4, 4, v3
    v_xor_b32 v127, 64, v126
    s_add_u32 s57, s56, 4
    v_xor_b32 v4, s57, v2
    buffer_load_dwordx4 v17, s[68:71], s60 offen offset:1024  lds
    v_lshl_add_u32 v128, v4, 4, v3
    v_xor_b32 v129, 64, v128
    v_and_b32 v2, 15, v0
    v_bfe_u32 v3, v0, 3, 1
    v_and_or_b32 v4, v0, 6, v3
    v_xor_b32 v4, v4, v1
    v_mul_u32_u24 v2, 384, v2
    buffer_load_dwordx4 v18, s[68:71], s60 offen offset:2048  lds
    v_lshl_add_u32 v2, v4, 4, v2
    v_add_u32 v132, 147456, v2
    v_xor_b32 v133, 64, v132
    s_and_b32 s56, s3, 1
    s_lshl_b32 s56, s56, 2
    s_lshr_b32 s57, s3, 1
    s_mul_i32 s57, s57, 24576
    buffer_load_dwordx4 v19, s[68:71], s60 offen offset:3072  lds
    s_add_u32 s57, s57, 30720
    v_and_b32 v1, 11, v0
    v_or_b32 v1, s56, v1
    v_and_or_b32 v2, v1, 6, v3
    v_lshrrev_b32 v3, 4, v0
    v_xor_b32 v2, v2, v3
    v_mul_u32_u24 v1, 384, v1
    s_add_u32 m0, s41, 10240
    s_nop 0
    buffer_load_dwordx4 v20, s[68:71], s60 offen offset:0  lds
    v_lshl_add_u32 v1, v2, 4, v1
    v_bfe_u32 v2, v0, 2, 1
    v_mul_u32_u24 v2, 12288, v2
    v_add3_u32 v130, s57, v1, v2
    v_xor_b32 v131, 64, v130
    v_add_u32 v135, 153600, v65
    buffer_load_dwordx4 v21, s[68:71], s60 offen offset:1024  lds
    s_waitcnt vmcnt(24)
    s_barrier
    s_load_dword s38, s[22:23], 0
    ds_read_b128 v[136:139], v132 offset:0
    ds_read_b128 v[140:143], v133 offset:0
    ds_read_b128 v[144:147], v132 offset:128
    ds_read_b128 v[148:151], v133 offset:128
    ds_read_b128 v[152:155], v132 offset:256
    ds_read_b128 v[156:159], v133 offset:256
    s_add_u32 m0, s40, 0
    s_add_u32 s57, s36, 0
    buffer_load_dwordx4 v16, s[28:31], s57 offen offset:0 nt lds
    buffer_load_dwordx4 v17, s[28:31], s57 offen offset:1024 nt lds
    buffer_load_dwordx4 v18, s[28:31], s57 offen offset:2048 nt lds
    buffer_load_dwordx4 v19, s[28:31], s57 offen offset:3072 nt lds
    s_add_u32 m0, s40, 4096
    s_nop 0
    buffer_load_dwordx4 v20, s[28:31], s57 offen offset:0 nt lds
    buffer_load_dwordx4 v21, s[28:31], s57 offen offset:1024 nt lds
    s_waitcnt lgkmcnt(0)
    v_mfma_f32_16x16x32_bf16 v[112:115], v[136:139], v[136:139], 0
    v_mfma_f32_16x16x32_bf16 v[116:119], v[52:55], v[136:139], 0
    s_add_u32 m0, s41, 0
    s_add_u32 s58, s37, 0
    buffer_load_dwordx4 v22, s[24:27], s58 offen offset:0 nt lds
    v_mfma_f32_16x16x32_bf16 v[112:115], v[140:143], v[140:143], v[112:115]
    v_mfma_f32_16x16x32_bf16 v[116:119], v[52:55], v[140:143], v[116:119]
    buffer_load_dwordx4 v23, s[24:27], s58 offen offset:1024 nt lds
    v_mfma_f32_16x16x32_bf16 v[112:115], v[144:147], v[144:147], v[112:115]
    v_mfma_f32_16x16x32_bf16 v[116:119], v[52:55], v[144:147], v[116:119]
    buffer_load_dwordx4 v24, s[24:27], s58 offen offset:2048 nt lds
    v_mfma_f32_16x16x32_bf16 v[112:115], v[148:151], v[148:151], v[112:115]
    v_mfma_f32_16x16x32_bf16 v[116:119], v[52:55], v[148:151], v[116:119]
    v_mfma_f32_16x16x32_bf16 v[112:115], v[152:155], v[152:155], v[112:115]
    v_mfma_f32_16x16x32_bf16 v[116:119], v[52:55], v[152:155], v[116:119]
    v_mfma_f32_16x16x32_bf16 v[112:115], v[156:159], v[156:159], v[112:115]
    v_mfma_f32_16x16x32_bf16 v[116:119], v[52:55], v[156:159], v[116:119]
    s_mul_i32 s39, s38, 0x9e3779b1
    s_add_u32 s39, s39, 0x7f4a7c16
    s_or_b32 s39, s39, 1
    s_lshl_b32 s61, s61, 10
    s_add_u32 s61, s61, 16384
    s_waitcnt vmcnt(15)
    s_barrier
    ds_read_b64_tr_b16 v[160:161], v124 offset:0
    ds_read_b64_tr_b16 v[162:163], v125 offset:1536
    ds_read_b64_tr_b16 v[184:185], v126 offset:0
    ds_read_b64_tr_b16 v[186:187], v127 offset:1536
    ds_read_b64_tr_b16 v[208:209], v128 offset:0
    ds_read_b64_tr_b16 v[210:211], v129 offset:1536
    ds_read_b64_tr_b16 v[164:165], v124 offset:12288
    ds_read_b64_tr_b16 v[166:167], v125 offset:13824
    ds_read_b64_tr_b16 v[188:189], v126 offset:12288
    ds_read_b64_tr_b16 v[190:191], v127 offset:13824
    ds_read_b64_tr_b16 v[212:213], v128 offset:12288
    ds_read_b64_tr_b16 v[214:215], v129 offset:13824
    v_cndmask_b32 v3, 0, v112, s[44:45]
    v_cndmask_b32 v3, v3, v113, s[46:47]
    v_cndmask_b32 v3, v3, v114, s[48:49]
    v_cndmask_b32 v3, v3, v115, s[50:51]
    v_mul_f32 v6, 0x3baaaaab, v116
    ds_read_b64_tr_b16 v[168:169], v124 offset:24576
    ds_read_b64_tr_b16 v[170:171], v125 offset:26112
    v_mfma_f32_16x16x4_f32 v[120:123], v60, v3, v[56:59]
    s_waitcnt lgkmcnt(12)
    v_mfma_f32_16x16x32_bf16 v[88:91], v[160:163], v[136:139], 0
    ds_read_b64_tr_b16 v[192:193], v126 offset:24576
    v_mfma_f32_16x16x32_bf16 v[100:103], v[160:163], v[52:55], 0
    ds_read_b64_tr_b16 v[194:195], v127 offset:26112
    s_waitcnt lgkmcnt(12)
    v_mfma_f32_16x16x32_bf16 v[92:95], v[184:187], v[136:139], 0
    ds_read_b64_tr_b16 v[216:217], v128 offset:24576
    v_mfma_f32_16x16x32_bf16 v[104:107], v[184:187], v[52:55], 0
    ds_read_b64_tr_b16 v[218:219], v129 offset:26112
    s_waitcnt lgkmcnt(12)
    v_mfma_f32_16x16x32_bf16 v[96:99], v[208:211], v[136:139], 0
    ds_read_b64_tr_b16 v[172:173], v124 offset:36864
    v_mfma_f32_16x16x32_bf16 v[108:111], v[208:211], v[52:55], 0
    ds_read_b64_tr_b16 v[174:175], v125 offset:38400
    s_waitcnt lgkmcnt(12)
    v_mfma_f32_16x16x32_bf16 v[88:91], v[164:167], v[140:143], v[88:91]
    ds_read_b64_tr_b16 v[196:197], v126 offset:36864
    v_mfma_f32_16x16x32_bf16 v[100:103], v[164:167], v[52:55], v[100:103]
    ds_read_b64_tr_b16 v[198:199], v127 offset:38400
    s_waitcnt lgkmcnt(12)
    v_mfma_f32_16x16x32_bf16 v[92:95], v[188:191], v[140:143], v[92:95]
    ds_read_b64_tr_b16 v[220:221], v128 offset:36864
    v_mfma_f32_16x16x32_bf16 v[104:107], v[188:191], v[52:55], v[104:107]
    ds_read_b64_tr_b16 v[222:223], v129 offset:38400
    s_waitcnt lgkmcnt(12)
    v_mfma_f32_16x16x32_bf16 v[96:99], v[212:215], v[140:143], v[96:99]
    ds_read_b64_tr_b16 v[176:177], v124 offset:49152
    v_mfma_f32_16x16x32_bf16 v[108:111], v[212:215], v[52:55], v[108:111]
    ds_read_b64_tr_b16 v[178:179], v125 offset:50688
    s_waitcnt lgkmcnt(12)
    v_mfma_f32_16x16x32_bf16 v[88:91], v[168:171], v[144:147], v[88:91]
    ds_read_b64_tr_b16 v[200:201], v126 offset:49152
    v_mfma_f32_16x16x32_bf16 v[100:103], v[168:171], v[52:55], v[100:103]
    ds_read_b64_tr_b16 v[202:203], v127 offset:50688
    s_waitcnt lgkmcnt(12)
    v_mfma_f32_16x16x32_bf16 v[92:95], v[192:195], v[144:147], v[92:95]
    ds_read_b64_tr_b16 v[224:225], v128 offset:49152
    v_mfma_f32_16x16x32_bf16 v[104:107], v[192:195], v[52:55], v[104:107]
    ds_read_b64_tr_b16 v[226:227], v129 offset:50688
    s_waitcnt lgkmcnt(12)
    v_mfma_f32_16x16x32_bf16 v[96:99], v[216:219], v[144:147], v[96:99]
    ds_read_b64_tr_b16 v[180:181], v124 offset:61440
    v_mfma_f32_16x16x32_bf16 v[108:111], v[216:219], v[52:55], v[108:111]
    ds_read_b64_tr_b16 v[182:183], v125 offset:62976
    s_waitcnt lgkmcnt(12)
    v_mfma_f32_16x16x32_bf16 v[88:91], v[172:175], v[148:151], v[88:91]
    ds_read_b64_tr_b16 v[204:205], v126 offset:61440
    v_mfma_f32_16x16x32_bf16 v[100:103], v[172:175], v[52:55], v[100:103]
    ds_read_b64_tr_b16 v[206:207], v127 offset:62976
    s_waitcnt lgkmcnt(12)
    v_mfma_f32_16x16x32_bf16 v[92:95], v[196:199], v[148:151], v[92:95]
    ds_read_b64_tr_b16 v[228:229], v128 offset:61440
    v_mfma_f32_16x16x32_bf16 v[104:107], v[196:199], v[52:55], v[104:107]
    ds_read_b64_tr_b16 v[230:231], v129 offset:62976
    s_waitcnt lgkmcnt(12)
    v_mfma_f32_16x16x32_bf16 v[96:99], v[220:223], v[148:151], v[96:99]
    v_fma_f32 v5, -v116, v116, v120
    v_mfma_f32_16x16x32_bf16 v[108:111], v[220:223], v[52:55], v[108:111]
    v_max_f32 v5, v5, v56
    s_waitcnt lgkmcnt(10)
    v_mfma_f32_16x16x32_bf16 v[88:91], v[176:179], v[152:155], v[88:91]
    v_rsq_f32 v5, v5
    v_mfma_f32_16x16x32_bf16 v[100:103], v[176:179], v[52:55], v[100:103]
    v_mov_b32 v122, s39
    s_waitcnt lgkmcnt(8)
    v_mfma_f32_16x16x32_bf16 v[92:95], v[200:203], v[152:155], v[92:95]
    v_mul_f32 v5, v60, v5
    v_mfma_f32_16x16x32_bf16 v[104:107], v[200:203], v[52:55], v[104:107]
    v_mov_b32 v123, s39
    s_waitcnt lgkmcnt(6)
    v_mfma_f32_16x16x32_bf16 v[96:99], v[224:227], v[152:155], v[96:99]
    v_mfma_f32_16x16x32_bf16 v[108:111], v[224:227], v[52:55], v[108:111]
    s_waitcnt lgkmcnt(4)
    v_mfma_f32_16x16x32_bf16 v[88:91], v[180:183], v[156:159], v[88:91]
    v_mfma_f32_16x16x32_bf16 v[100:103], v[180:183], v[52:55], v[100:103]
    s_waitcnt lgkmcnt(2)
    v_mfma_f32_16x16x32_bf16 v[92:95], v[204:207], v[156:159], v[92:95]
    v_mfma_f32_16x16x32_bf16 v[104:107], v[204:207], v[52:55], v[104:107]
    s_waitcnt lgkmcnt(0)
    v_mfma_f32_16x16x32_bf16 v[96:99], v[228:231], v[156:159], v[96:99]
    v_mfma_f32_16x16x32_bf16 v[108:111], v[228:231], v[52:55], v[108:111]
    s_nop 1
    v_fma_f32 v88, -v6, v100, v88
    v_fma_f32 v89, -v6, v101, v89
    v_fma_f32 v90, -v6, v102, v90
    v_fma_f32 v91, -v6, v103, v91
    v_mul_f32 v88, v88, v5
    v_mul_f32 v89, v89, v5
    v_mul_f32 v90, v90, v5
    v_mul_f32 v91, v91, v5
    v_cvt_pk_bf16_f32 v112, v88, v89
    v_cvt_pk_bf16_f32 v113, v90, v91
    ds_write_b64 v134, v[112:113] offset:0
    v_fma_f32 v92, -v6, v104, v92
    v_fma_f32 v93, -v6, v105, v93
    v_fma_f32 v94, -v6, v106, v94
    v_fma_f32 v95, -v6, v107, v95
    v_mul_f32 v92, v92, v5
    v_mul_f32 v93, v93, v5
    v_mul_f32 v94, v94, v5
    v_mul_f32 v95, v95, v5
    v_cvt_pk_bf16_f32 v114, v92, v93
    v_cvt_pk_bf16_f32 v115, v94, v95
    ds_write_b64 v134, v[114:115] offset:512
    v_fma_f32 v96, -v6, v108, v96
    v_fma_f32 v97, -v6, v109, v97
    v_fma_f32 v98, -v6, v110, v98
    v_fma_f32 v99, -v6, v111, v99
    v_mul_f32 v96, v96, v5
    v_mul_f32 v97, v97, v5
    v_mul_f32 v98, v98, v5
    v_mul_f32 v99, v99, v5
    v_cvt_pk_bf16_f32 v116, v96, v97
    v_cvt_pk_bf16_f32 v117, v98, v99
    ds_write_b64 v134, v[116:117] offset:1024
    s_waitcnt vmcnt(9)
    s_waitcnt lgkmcnt(0)
    s_barrier
    ds_read_b128 v[136:139], v135 offset:0
    ds_read_b128 a[96:99], v130 offset:0
    ds_read_b128 v[140:143], v135 offset:1024
    ds_read_b128 a[100:103], v131 offset:0
    ds_read_b128 v[144:147], v135 offset:2048
    ds_read_b128 a[104:107], v130 offset:128
    ds_read_b128 v[148:151], v135 offset:3072
    ds_read_b128 a[108:111], v131 offset:128
    ds_read_b128 v[152:155], v135 offset:4096
    ds_read_b128 a[112:115], v130 offset:256
    ds_read_b128 v[156:159], v135 offset:5120
    ds_read_b128 a[116:119], v131 offset:256
    s_waitcnt lgkmcnt(10)
    v_mfma_f32_16x16x32_bf16 v[88:91], a[96:99], v[136:139], 0
    s_waitcnt lgkmcnt(8)
    v_mfma_f32_16x16x32_bf16 v[92:95], a[100:103], v[140:143], 0
    s_waitcnt lgkmcnt(6)
    v_mfma_f32_16x16x32_bf16 v[88:91], a[104:107], v[144:147], v[88:91]
    s_waitcnt lgkmcnt(4)
    v_mfma_f32_16x16x32_bf16 v[92:95], a[108:111], v[148:151], v[92:95]
    s_waitcnt lgkmcnt(2)
    v_mfma_f32_16x16x32_bf16 v[88:91], a[112:115], v[152:155], v[88:91]
    s_waitcnt lgkmcnt(0)
    v_mfma_f32_16x16x32_bf16 v[92:95], a[116:119], v[156:159], v[92:95]
    s_nop 7
    v_add_f32 v88, v88, v92
    v_add_f32 v89, v89, v93
    v_add_f32 v90, v90, v94
    v_add_f32 v91, v91, v95
    v_mul_f32 v88, 0x419fecaf, v88
    v_mul_f32 v89, 0x419fecaf, v89
    v_mul_f32 v90, 0x419fecaf, v90
    v_mul_f32 v91, 0x419fecaf, v91
    v_cvt_pk_bf16_f32 v120, v88, v89
    v_cvt_pk_bf16_f32 v121, v90, v91
    buffer_store_dwordx4 v[120:123], v65, s[32:35], s61 offen sc1
    buffer_load_dwordx4 v25, s[24:27], s58 offen offset:3072 nt lds
    s_add_u32 m0, s41, 4096
    s_nop 0
    buffer_load_dwordx4 v26, s[24:27], s58 offen offset:0 nt lds
    buffer_load_dwordx4 v27, s[24:27], s58 offen offset:1024 nt lds
    s_barrier
    buffer_load_dwordx4 v28, s[24:27], s58 offen offset:2048 nt lds
    buffer_load_dwordx4 v29, s[24:27], s58 offen offset:3072 nt lds
    s_add_u32 m0, s41, 8192
    s_nop 0
    buffer_load_dwordx4 v30, s[24:27], s58 offen offset:0 nt lds
    buffer_load_dwordx4 v31, s[24:27], s58 offen offset:1024 nt lds
    buffer_load_dwordx4 v32, s[24:27], s58 offen offset:2048 nt lds
    buffer_load_dwordx4 v33, s[24:27], s58 offen offset:3072 nt lds
    v_and_b32 v1, 15, v0
    v_lshrrev_b32 v6, 5, v0
    v_bfe_u32 v3, v0, 4, 1
    v_lshl_or_b32 v3, v3, 1, v6
    v_lshrrev_b32 v4, 2, v0
    v_bfe_u32 v5, v0, 1, 1
    v_lshrrev_b32 v6, 3, v1
    v_and_or_b32 v6, v1, 6, v6
    v_xor_b32 v6, v6, v3
    v_mul_u32_u24 v7, 384, v1
    v_lshl_add_u32 v6, v6, 4, v7
    v_add_u32 v34, s40, v6
    v_xor_b32 v35, 64, v34
    v_lshrrev_b32 v6, 3, v1
    v_and_b32 v7, 7, v1
    v_lshl_or_b32 v6, v7, 1, v6
    v_xor_b32 v6, v6, v3
    v_mul_u32_u24 v7, 768, v1
    v_lshl_add_u32 v6, v6, 4, v7
    v_add_u32 v40, s41, v6
    v_xor_b32 v41, 0x40, v40
    v_xor_b32 v42, 0x80, v40
    v_xor_b32 v43, 0xc0, v40
    v_and_b32 v2, 1, v0
    v_lshlrev_b32 v2, 3, v2
    s_mul_i32 s56, s3, 96
    v_lshrrev_b32 v6, 3, v4
    v_and_or_b32 v6, v4, 6, v6
    v_xor_b32 v6, v6, v5
    v_lshl_add_u32 v6, v6, 4, v2
    v_mul_u32_u24 v7, 384, v4
    s_add_u32 s57, s56, 0
    v_xad_u32 v36, v6, s57, v7
    s_add_u32 s57, s56, 32
    v_xad_u32 v37, v6, s57, v7
    s_add_u32 s57, s56, 64
    v_xad_u32 v38, v6, s57, v7
    v_lshrrev_b32 v6, 3, v4
    v_and_b32 v3, 7, v4
    v_lshl_or_b32 v6, v3, 1, v6
    v_xor_b32 v6, v6, v5
    v_lshl_add_u32 v6, v6, 4, v2
    v_lshlrev_b32 v7, 1, v7
    v_add_u32 v7, 24576, v7
    s_add_u32 s57, s56, 0
    v_xad_u32 v44, v6, s57, v7
    s_add_u32 s57, s56, 384
    v_xad_u32 v45, v6, s57, v7
    s_add_u32 s57, s56, 32
    v_xad_u32 v46, v6, s57, v7
    s_add_u32 s57, s56, 416
    v_xad_u32 v47, v6, s57, v7
    s_add_u32 s57, s56, 64
    v_xad_u32 v48, v6, s57, v7
    s_add_u32 s57, s56, 448
    v_xad_u32 v49, v6, s57, v7
    v_lshrrev_b32 v1, 5, v0
    v_lshlrev_b32 v1, 8, v1
    v_and_b32 v2, 15, v0
    v_lshl_add_u32 v1, v2, 4, v1
    v_bfe_u32 v2, v0, 4, 1
    v_lshl_add_u32 v1, v2, 3, v1
    s_mul_i32 s56, s3, 1536
    s_add_u32 s56, s56, 147456
    v_add_u32 v236, s56, v1
    s_mul_i32 s56, s3, 3072
    s_add_u32 s56, s56, 24576
    v_add_u32 v237, s56, v65
    v_add_u32 v238, s41, v65
    s_lshl_b32 s56, s3, 10
    v_add_u32 v240, 159744, v65
    v_add_u32 v239, s56, v240
    v_add_u32 v241, 147456, v65
    v_bfe_u32 v1, v0, 2, 2
    v_lshrrev_b32 v2, 4, v0
    v_lshl_or_b32 v1, v1, 4, v2
    v_mul_u32_u24 v1, 65536, v1
    v_and_b32 v2, 3, v0
    v_lshl_or_b32 v242, v2, 5, v1
    v_xor_b32 v243, 0x70, v242
    s_mul_i32 s56, s3, 3
    v_min_u32 v1, 2, v0
    v_add_u32 v1, s56, v1
    v_min_u32 v2, 8, v0
    v_add_u32 v2, 9, v2
    v_cmp_gt_u32 vcc, 3, v0
    s_nop 1
    v_cndmask_b32 v1, v2, v1, vcc
    v_lshlrev_b32 v245, 7, v1
    v_lshlrev_b32 v1, 3, v0
    v_add_u32 v254, 126976, v1
    s_lshl_b32 s56, s3, 9
    v_add_u32 v238, s56, v254
    v_add_u32 v253, 122880, v65
    s_lshl_b32 s56, s3, 10
    v_add_u32 v237, s56, v253
    s_mov_b32 s52, 0x41c00000
    s_add_u32 m0, s42, 0
    s_add_u32 s59, s37, 196608
    buffer_load_dwordx4 v22, s[24:27], s59 offen offset:0 nt lds
    s_waitcnt vmcnt(14)
    s_barrier
    ds_read_b128 a[48:51], v34 offset:0
    ds_read_b128 a[52:55], v35 offset:0
    ds_read_b128 a[56:59], v34 offset:128
    ds_read_b128 a[60:63], v35 offset:128
    ds_read_b128 a[64:67], v34 offset:256
    ds_read_b128 a[68:71], v35 offset:256
    s_waitcnt lgkmcnt(5)
    v_mfma_f32_16x16x32_bf16 v[84:87], a[48:51], a[48:51], 0
    buffer_load_dwordx4 v23, s[24:27], s59 offen offset:1024 nt lds
    ds_read_b64_tr_b16 a[72:73], v36 offset:0
    ds_read_b64_tr_b16 a[74:75], v36 offset:6144
    v_mfma_f32_16x16x32_bf16 v[80:83], a[48:51], v[52:55], 0
    ds_read_b64_tr_b16 a[76:77], v36 offset:12288
    ds_read_b64_tr_b16 a[78:79], v36 offset:18432
    s_waitcnt lgkmcnt(8)
    v_mfma_f32_16x16x32_bf16 v[84:87], a[52:55], a[52:55], v[84:87]
    ds_read_b64_tr_b16 a[80:81], v37 offset:0
    ds_read_b64_tr_b16 a[82:83], v37 offset:6144
    v_mfma_f32_16x16x32_bf16 v[80:83], a[52:55], v[52:55], v[80:83]
    ds_read_b64_tr_b16 a[84:85], v37 offset:12288
    ds_read_b64_tr_b16 a[86:87], v37 offset:18432
    s_waitcnt lgkmcnt(11)
    v_mfma_f32_16x16x32_bf16 v[84:87], a[56:59], a[56:59], v[84:87]
    ds_read_b64_tr_b16 a[88:89], v38 offset:0
    ds_read_b64_tr_b16 a[90:91], v38 offset:6144
    v_mfma_f32_16x16x32_bf16 v[80:83], a[56:59], v[52:55], v[80:83]
    ds_read_b64_tr_b16 a[92:93], v38 offset:12288
    ds_read_b64_tr_b16 a[94:95], v38 offset:18432
    s_waitcnt lgkmcnt(14)
    v_mfma_f32_16x16x32_bf16 v[84:87], a[60:63], a[60:63], v[84:87]
    buffer_load_dwordx4 v24, s[24:27], s59 offen offset:2048 nt lds
    v_mfma_f32_16x16x32_bf16 v[80:83], a[60:63], v[52:55], v[80:83]
    buffer_load_dwordx4 v25, s[24:27], s59 offen offset:3072 nt lds
    s_waitcnt lgkmcnt(13)
    v_mfma_f32_16x16x32_bf16 v[84:87], a[64:67], a[64:67], v[84:87]
    v_mfma_f32_16x16x32_bf16 v[80:83], a[64:67], v[52:55], v[80:83]
    s_waitcnt lgkmcnt(12)
    v_mfma_f32_16x16x32_bf16 v[84:87], a[68:71], a[68:71], v[84:87]
    v_mfma_f32_16x16x32_bf16 v[80:83], a[68:71], v[52:55], v[80:83]
    s_waitcnt lgkmcnt(0)
    s_mul_i32 s39, s38, 0x9e3779b1
    s_add_u32 s39, s39, 0x7f4a7c16
    s_or_b32 s39, s39, 1
    s_add_u32 m0, s42, 4096
    s_nop 0
    buffer_load_dwordx4 v26, s[24:27], s59 offen offset:0 nt lds
    buffer_load_dwordx4 v27, s[24:27], s59 offen offset:1024 nt lds
    buffer_load_dwordx4 v28, s[24:27], s59 offen offset:2048 nt lds
    buffer_load_dwordx4 v29, s[24:27], s59 offen offset:3072 nt lds
    s_add_u32 m0, s42, 8192
    s_nop 0
    buffer_load_dwordx4 v30, s[24:27], s59 offen offset:0 nt lds
    buffer_load_dwordx4 v31, s[24:27], s59 offen offset:1024 nt lds
    buffer_load_dwordx4 v32, s[24:27], s59 offen offset:2048 nt lds
    s_mul_i32 s56, s3, 3072
    s_add_u32 s56, s56, 16384
    buffer_load_dwordx4 v[136:139], v65, s[32:35], s56 offen offset:0 sc1
    buffer_load_dwordx4 v[140:143], v65, s[32:35], s56 offen offset:1024 sc1
    buffer_load_dwordx4 v[144:147], v65, s[32:35], s56 offen offset:2048 sc1
    s_mov_b32 s43, -1
    s_branch L_join
L_vprod:
    s_mul_i32 s60, s3, 18432
    s_add_u32 m0, s60, 73728
    s_nop 0
    buffer_load_dwordx4 v16, s[64:67], s60 offen offset:0  lds
    buffer_load_dwordx4 v17, s[64:67], s60 offen offset:1024  lds
    buffer_load_dwordx4 v18, s[64:67], s60 offen offset:2048  lds
    buffer_load_dwordx4 v19, s[64:67], s60 offen offset:3072  lds
    s_add_u32 m0, s60, 77824
    s_nop 0
    buffer_load_dwordx4 v20, s[64:67], s60 offen offset:0  lds
    buffer_load_dwordx4 v21, s[64:67], s60 offen offset:1024  lds
    s_add_u32 s60, s60, 6144
    s_add_u32 m0, s60, 73728
    s_nop 0
    buffer_load_dwordx4 v16, s[64:67], s60 offen offset:0  lds
    buffer_load_dwordx4 v17, s[64:67], s60 offen offset:1024  lds
    buffer_load_dwordx4 v18, s[64:67], s60 offen offset:2048  lds
    buffer_load_dwordx4 v19, s[64:67], s60 offen offset:3072  lds
    s_add_u32 m0, s60, 77824
    s_nop 0
    buffer_load_dwordx4 v20, s[64:67], s60 offen offset:0  lds
    buffer_load_dwordx4 v21, s[64:67], s60 offen offset:1024  lds
    s_add_u32 s60, s60, 6144
    s_add_u32 m0, s60, 73728
    s_nop 0
    buffer_load_dwordx4 v16, s[64:67], s60 offen offset:0  lds
    v_lshrrev_b32 v1, 4, v0
    v_and_b32 v5, 1, v1
    v_bfe_u32 v2, v0, 2, 2
    v_lshl_add_u32 v3, v1, 3, v2
    buffer_load_dwordx4 v17, s[64:67], s60 offen offset:1024  lds
    v_mul_u32_u24 v3, 384, v3
    v_and_b32 v4, 1, v0
    v_lshl_add_u32 v3, v4, 3, v3
    v_add_u32 v3, 73728, v3
    buffer_load_dwordx4 v18, s[64:67], s60 offen offset:2048  lds
    v_and_or_b32 v2, v2, 2, v5
    v_bfe_u32 v4, v0, 1, 1
    v_xor_b32 v2, v2, v4
    s_mul_i32 s56, s3, 6
    buffer_load_dwordx4 v19, s[64:67], s60 offen offset:3072  lds
    s_add_u32 s57, s56, 0
    v_xor_b32 v4, s57, v2
    v_lshl_add_u32 v136, v4, 4, v3
    v_xor_b32 v137, 64, v136
    s_add_u32 m0, s60, 77824
    s_nop 0
    buffer_load_dwordx4 v20, s[64:67], s60 offen offset:0  lds
    s_add_u32 s57, s56, 2
    v_xor_b32 v4, s57, v2
    v_lshl_add_u32 v138, v4, 4, v3
    v_xor_b32 v139, 64, v138
    buffer_load_dwordx4 v21, s[64:67], s60 offen offset:1024  lds
    s_add_u32 s57, s56, 4
    v_xor_b32 v4, s57, v2
    v_lshl_add_u32 v140, v4, 4, v3
    v_xor_b32 v141, 64, v140
    s_lshl_b32 s61, s43, 2
    s_add_u32 s61, s61, s3
    s_mul_i32 s60, s61, 6144
    s_add_u32 m0, s41, 6144
    s_nop 0
    buffer_load_dwordx4 v16, s[68:71], s60 offen offset:0  lds
    v_bfe_u32 v1, v0, 2, 1
    v_and_b32 v2, 3, v0
    v_lshl_or_b32 v2, v1, 3, v2
    v_and_or_b32 v1, v0, 2, v1
    buffer_load_dwordx4 v17, s[68:71], s60 offen offset:1024  lds
    v_lshrrev_b32 v3, 4, v0
    v_xor_b32 v1, v1, v3
    v_mul_u32_u24 v2, 384, v2
    v_lshl_add_u32 v1, v1, 4, v2
    buffer_load_dwordx4 v18, s[68:71], s60 offen offset:2048  lds
    v_bfe_u32 v2, v0, 3, 1
    v_mul_u32_u24 v2, 12288, v2
    s_mov_b32 s56, 30720
    v_add3_u32 v142, s56, v1, v2
    buffer_load_dwordx4 v19, s[68:71], s60 offen offset:3072  lds
    v_xor_b32 v143, 64, v142
    s_add_u32 m0, s41, 10240
    s_nop 0
    buffer_load_dwordx4 v20, s[68:71], s60 offen offset:0  lds
    buffer_load_dwordx4 v21, s[68:71], s60 offen offset:1024  lds
    s_load_dword s38, s[22:23], 0
    s_barrier
    s_add_u32 m0, s40, 0
    s_add_u32 s57, s36, 0
    buffer_load_dwordx4 v16, s[28:31], s57 offen offset:0 nt lds
    buffer_load_dwordx4 v17, s[28:31], s57 offen offset:1024 nt lds
    buffer_load_dwordx4 v18, s[28:31], s57 offen offset:2048 nt lds
    buffer_load_dwordx4 v19, s[28:31], s57 offen offset:3072 nt lds
    s_add_u32 m0, s40, 4096
    s_nop 0
    buffer_load_dwordx4 v20, s[28:31], s57 offen offset:0 nt lds
    buffer_load_dwordx4 v21, s[28:31], s57 offen offset:1024 nt lds
    s_add_u32 m0, s41, 0
    s_add_u32 s58, s37, 0
    buffer_load_dwordx4 v22, s[24:27], s58 offen offset:0 nt lds
    buffer_load_dwordx4 v23, s[24:27], s58 offen offset:1024 nt lds
    buffer_load_dwordx4 v24, s[24:27], s58 offen offset:2048 nt lds
    s_waitcnt vmcnt(9)
    s_barrier
    ds_read_b128 a[96:99], v142 offset:0
    ds_read_b128 a[100:103], v143 offset:0
    ds_read_b128 a[104:107], v142 offset:128
    ds_read_b128 a[108:111], v143 offset:128
    ds_read_b128 a[112:115], v142 offset:256
    ds_read_b128 a[116:119], v143 offset:256
    ds_read_b128 a[120:123], v143 offset:1536
    ds_read_b128 a[124:127], v142 offset:1536
    ds_read_b128 a[128:131], v143 offset:1664
    ds_read_b128 a[132:135], v142 offset:1664
    ds_read_b128 a[136:139], v143 offset:1792
    ds_read_b128 a[140:143], v142 offset:1792
    ds_read_b128 a[144:147], v142 offset:24576
    ds_read_b128 a[148:151], v143 offset:24576
    ds_read_b128 a[152:155], v142 offset:24704
    ds_read_b128 a[156:159], v143 offset:24704
    ds_read_b128 a[160:163], v142 offset:24832
    ds_read_b128 a[164:167], v143 offset:24832
    ds_read_b128 a[168:171], v143 offset:26112
    ds_read_b128 a[172:175], v142 offset:26112
    ds_read_b128 a[176:179], v143 offset:26240
    ds_read_b128 a[180:183], v142 offset:26240
    ds_read_b128 a[184:187], v143 offset:26368
    ds_read_b128 a[188:191], v142 offset:26368
    ds_read_b64_tr_b16 v[160:161], v136 offset:0
    ds_read_b64_tr_b16 v[162:163], v137 offset:1536
    ds_read_b64_tr_b16 v[164:165], v136 offset:12288
    ds_read_b64_tr_b16 v[166:167], v137 offset:13824
    ds_read_b64_tr_b16 v[168:169], v136 offset:24576
    ds_read_b64_tr_b16 v[170:171], v137 offset:26112
    ds_read_b64_tr_b16 v[172:173], v136 offset:36864
    ds_read_b64_tr_b16 v[174:175], v137 offset:38400
    ds_read_b64_tr_b16 v[176:177], v136 offset:49152
    ds_read_b64_tr_b16 v[178:179], v137 offset:50688
    ds_read_b64_tr_b16 v[180:181], v136 offset:61440
    ds_read_b64_tr_b16 v[182:183], v137 offset:62976
    ds_read_b64_tr_b16 v[184:185], v138 offset:0
    ds_read_b64_tr_b16 v[186:187], v139 offset:1536
    ds_read_b64_tr_b16 v[188:189], v138 offset:12288
    ds_read_b64_tr_b16 v[190:191], v139 offset:13824
    ds_read_b64_tr_b16 v[192:193], v138 offset:24576
    ds_read_b64_tr_b16 v[194:195], v139 offset:26112
    ds_read_b64_tr_b16 v[196:197], v138 offset:36864
    ds_read_b64_tr_b16 v[198:199], v139 offset:38400
    ds_read_b64_tr_b16 v[200:201], v138 offset:49152
    ds_read_b64_tr_b16 v[202:203], v139 offset:50688
    ds_read_b64_tr_b16 v[204:205], v138 offset:61440
    ds_read_b64_tr_b16 v[206:207], v139 offset:62976
    ds_read_b64_tr_b16 v[208:209], v140 offset:0
    ds_read_b64_tr_b16 v[210:211], v141 offset:1536
    ds_read_b64_tr_b16 v[212:213], v140 offset:12288
    ds_read_b64_tr_b16 v[214:215], v141 offset:13824
    ds_read_b64_tr_b16 v[216:217], v140 offset:24576
    ds_read_b64_tr_b16 v[218:219], v141 offset:26112
    ds_read_b64_tr_b16 v[220:221], v140 offset:36864
    ds_read_b64_tr_b16 v[222:223], v141 offset:38400
    ds_read_b64_tr_b16 v[224:225], v140 offset:49152
    ds_read_b64_tr_b16 v[226:227], v141 offset:50688
    ds_read_b64_tr_b16 v[228:229], v140 offset:61440
    ds_read_b64_tr_b16 v[230:231], v141 offset:62976
    s_waitcnt lgkmcnt(0)
    s_barrier
    s_mul_i32 s60, s3, 18432
    s_lshl_b32 s61, s43, 11
    s_add_u32 s60, s60, s61
    s_add_u32 s60, s60, 3145728
    v_mfma_f32_16x16x32_bf16 v[88:91], a[96:99], v[160:163], 0
    v_mfma_f32_16x16x32_bf16 v[92:95], a[120:123], v[160:163], 0
    v_mfma_f32_16x16x32_bf16 v[96:99], a[144:147], v[160:163], 0
    v_mfma_f32_16x16x32_bf16 v[100:103], a[168:171], v[160:163], 0
    buffer_load_dwordx4 v25, s[24:27], s58 offen offset:3072 nt lds
    v_mfma_f32_16x16x32_bf16 v[88:91], a[100:103], v[164:167], v[88:91]
    v_mfma_f32_16x16x32_bf16 v[92:95], a[124:127], v[164:167], v[92:95]
    v_mfma_f32_16x16x32_bf16 v[96:99], a[148:151], v[164:167], v[96:99]
    v_mfma_f32_16x16x32_bf16 v[100:103], a[172:175], v[164:167], v[100:103]
    s_add_u32 m0, s41, 4096
    s_nop 0
    buffer_load_dwordx4 v26, s[24:27], s58 offen offset:0 nt lds
    v_mfma_f32_16x16x32_bf16 v[88:91], a[104:107], v[168:171], v[88:91]
    v_mfma_f32_16x16x32_bf16 v[92:95], a[128:131], v[168:171], v[92:95]
    v_mfma_f32_16x16x32_bf16 v[96:99], a[152:155], v[168:171], v[96:99]
    v_mfma_f32_16x16x32_bf16 v[100:103], a[176:179], v[168:171], v[100:103]
    buffer_load_dwordx4 v27, s[24:27], s58 offen offset:1024 nt lds
    v_mfma_f32_16x16x32_bf16 v[88:91], a[108:111], v[172:175], v[88:91]
    v_mfma_f32_16x16x32_bf16 v[92:95], a[132:135], v[172:175], v[92:95]
    v_mfma_f32_16x16x32_bf16 v[96:99], a[156:159], v[172:175], v[96:99]
    v_mfma_f32_16x16x32_bf16 v[100:103], a[180:183], v[172:175], v[100:103]
    buffer_load_dwordx4 v28, s[24:27], s58 offen offset:2048 nt lds
    v_mfma_f32_16x16x32_bf16 v[88:91], a[112:115], v[176:179], v[88:91]
    v_mfma_f32_16x16x32_bf16 v[92:95], a[136:139], v[176:179], v[92:95]
    v_mfma_f32_16x16x32_bf16 v[96:99], a[160:163], v[176:179], v[96:99]
    v_mfma_f32_16x16x32_bf16 v[100:103], a[184:187], v[176:179], v[100:103]
    buffer_load_dwordx4 v29, s[24:27], s58 offen offset:3072 nt lds
    v_mfma_f32_16x16x32_bf16 v[88:91], a[116:119], v[180:183], v[88:91]
    v_mfma_f32_16x16x32_bf16 v[92:95], a[140:143], v[180:183], v[92:95]
    v_mfma_f32_16x16x32_bf16 v[96:99], a[164:167], v[180:183], v[96:99]
    v_mfma_f32_16x16x32_bf16 v[100:103], a[188:191], v[180:183], v[100:103]
    v_mfma_f32_16x16x32_bf16 v[104:107], a[96:99], v[184:187], 0
    v_mfma_f32_16x16x32_bf16 v[108:111], a[120:123], v[184:187], 0
    v_mfma_f32_16x16x32_bf16 v[112:115], a[144:147], v[184:187], 0
    v_mfma_f32_16x16x32_bf16 v[116:119], a[168:171], v[184:187], 0
    s_add_u32 m0, s41, 8192
    s_nop 0
    buffer_load_dwordx4 v30, s[24:27], s58 offen offset:0 nt lds
    v_mfma_f32_16x16x32_bf16 v[104:107], a[100:103], v[188:191], v[104:107]
    v_mfma_f32_16x16x32_bf16 v[108:111], a[124:127], v[188:191], v[108:111]
    v_mfma_f32_16x16x32_bf16 v[112:115], a[148:151], v[188:191], v[112:115]
    v_mfma_f32_16x16x32_bf16 v[116:119], a[172:175], v[188:191], v[116:119]
    buffer_load_dwordx4 v31, s[24:27], s58 offen offset:1024 nt lds
    v_mfma_f32_16x16x32_bf16 v[104:107], a[104:107], v[192:195], v[104:107]
    v_mfma_f32_16x16x32_bf16 v[108:111], a[128:131], v[192:195], v[108:111]
    v_mfma_f32_16x16x32_bf16 v[112:115], a[152:155], v[192:195], v[112:115]
    v_mfma_f32_16x16x32_bf16 v[116:119], a[176:179], v[192:195], v[116:119]
    buffer_load_dwordx4 v32, s[24:27], s58 offen offset:2048 nt lds
    v_cvt_pk_bf16_f32 v144, v88, v89
    v_cvt_pk_bf16_f32 v145, v90, v91
    v_cvt_pk_bf16_f32 v146, v92, v93
    v_cvt_pk_bf16_f32 v147, v94, v95
    buffer_store_dwordx4 v[144:147], v65, s[32:35], s60 offen offset:0 sc1
    v_cvt_pk_bf16_f32 v148, v96, v97
    v_cvt_pk_bf16_f32 v149, v98, v99
    v_cvt_pk_bf16_f32 v150, v100, v101
    v_cvt_pk_bf16_f32 v151, v102, v103
    buffer_store_dwordx4 v[148:151], v65, s[32:35], s60 offen offset:1024 sc1
    s_add_u32 s60, s60, 6144
    v_mfma_f32_16x16x32_bf16 v[104:107], a[108:111], v[196:199], v[104:107]
    v_mfma_f32_16x16x32_bf16 v[108:111], a[132:135], v[196:199], v[108:111]
    v_mfma_f32_16x16x32_bf16 v[112:115], a[156:159], v[196:199], v[112:115]
    v_mfma_f32_16x16x32_bf16 v[116:119], a[180:183], v[196:199], v[116:119]
    buffer_load_dwordx4 v33, s[24:27], s58 offen offset:3072 nt lds
    v_mfma_f32_16x16x32_bf16 v[104:107], a[112:115], v[200:203], v[104:107]
    v_mfma_f32_16x16x32_bf16 v[108:111], a[136:139], v[200:203], v[108:111]
    v_mfma_f32_16x16x32_bf16 v[112:115], a[160:163], v[200:203], v[112:115]
    v_mfma_f32_16x16x32_bf16 v[116:119], a[184:187], v[200:203], v[116:119]
    s_add_u32 m0, s42, 0
    s_add_u32 s59, s37, 196608
    buffer_load_dwordx4 v22, s[24:27], s59 offen offset:0 nt lds
    v_mfma_f32_16x16x32_bf16 v[104:107], a[116:119], v[204:207], v[104:107]
    v_mfma_f32_16x16x32_bf16 v[108:111], a[140:143], v[204:207], v[108:111]
    v_mfma_f32_16x16x32_bf16 v[112:115], a[164:167], v[204:207], v[112:115]
    v_mfma_f32_16x16x32_bf16 v[116:119], a[188:191], v[204:207], v[116:119]
    v_mfma_f32_16x16x32_bf16 v[120:123], a[96:99], v[208:211], 0
    v_mfma_f32_16x16x32_bf16 v[124:127], a[120:123], v[208:211], 0
    v_mfma_f32_16x16x32_bf16 v[128:131], a[144:147], v[208:211], 0
    v_mfma_f32_16x16x32_bf16 v[132:135], a[168:171], v[208:211], 0
    buffer_load_dwordx4 v23, s[24:27], s59 offen offset:1024 nt lds
    v_mfma_f32_16x16x32_bf16 v[120:123], a[100:103], v[212:215], v[120:123]
    v_mfma_f32_16x16x32_bf16 v[124:127], a[124:127], v[212:215], v[124:127]
    v_mfma_f32_16x16x32_bf16 v[128:131], a[148:151], v[212:215], v[128:131]
    v_mfma_f32_16x16x32_bf16 v[132:135], a[172:175], v[212:215], v[132:135]
    buffer_load_dwordx4 v24, s[24:27], s59 offen offset:2048 nt lds
    v_mfma_f32_16x16x32_bf16 v[120:123], a[104:107], v[216:219], v[120:123]
    v_mfma_f32_16x16x32_bf16 v[124:127], a[128:131], v[216:219], v[124:127]
    v_mfma_f32_16x16x32_bf16 v[128:131], a[152:155], v[216:219], v[128:131]
    v_mfma_f32_16x16x32_bf16 v[132:135], a[176:179], v[216:219], v[132:135]
    buffer_load_dwordx4 v25, s[24:27], s59 offen offset:3072 nt lds
    v_cvt_pk_bf16_f32 v152, v104, v105
    v_cvt_pk_bf16_f32 v153, v106, v107
    v_cvt_pk_bf16_f32 v154, v108, v109
    v_cvt_pk_bf16_f32 v155, v110, v111
    buffer_store_dwordx4 v[152:155], v65, s[32:35], s60 offen offset:0 sc1
    v_cvt_pk_bf16_f32 v156, v112, v113
    v_cvt_pk_bf16_f32 v157, v114, v115
    v_cvt_pk_bf16_f32 v158, v116, v117
    v_cvt_pk_bf16_f32 v159, v118, v119
    buffer_store_dwordx4 v[156:159], v65, s[32:35], s60 offen offset:1024 sc1
    s_add_u32 s60, s60, 6144
    v_mfma_f32_16x16x32_bf16 v[120:123], a[108:111], v[220:223], v[120:123]
    v_mfma_f32_16x16x32_bf16 v[124:127], a[132:135], v[220:223], v[124:127]
    v_mfma_f32_16x16x32_bf16 v[128:131], a[156:159], v[220:223], v[128:131]
    v_mfma_f32_16x16x32_bf16 v[132:135], a[180:183], v[220:223], v[132:135]
    s_add_u32 m0, s42, 4096
    s_nop 0
    buffer_load_dwordx4 v26, s[24:27], s59 offen offset:0 nt lds
    v_mfma_f32_16x16x32_bf16 v[120:123], a[112:115], v[224:227], v[120:123]
    v_mfma_f32_16x16x32_bf16 v[124:127], a[136:139], v[224:227], v[124:127]
    v_mfma_f32_16x16x32_bf16 v[128:131], a[160:163], v[224:227], v[128:131]
    v_mfma_f32_16x16x32_bf16 v[132:135], a[184:187], v[224:227], v[132:135]
    buffer_load_dwordx4 v27, s[24:27], s59 offen offset:1024 nt lds
    v_mfma_f32_16x16x32_bf16 v[120:123], a[116:119], v[228:231], v[120:123]
    v_mfma_f32_16x16x32_bf16 v[124:127], a[140:143], v[228:231], v[124:127]
    v_mfma_f32_16x16x32_bf16 v[128:131], a[164:167], v[228:231], v[128:131]
    v_mfma_f32_16x16x32_bf16 v[132:135], a[188:191], v[228:231], v[132:135]
    s_nop 4
    v_cvt_pk_bf16_f32 v144, v120, v121
    v_cvt_pk_bf16_f32 v145, v122, v123
    v_cvt_pk_bf16_f32 v146, v124, v125
    v_cvt_pk_bf16_f32 v147, v126, v127
    buffer_store_dwordx4 v[144:147], v65, s[32:35], s60 offen offset:0 sc1
    v_cvt_pk_bf16_f32 v148, v128, v129
    v_cvt_pk_bf16_f32 v149, v130, v131
    v_cvt_pk_bf16_f32 v150, v132, v133
    v_cvt_pk_bf16_f32 v151, v134, v135
    buffer_store_dwordx4 v[148:151], v65, s[32:35], s60 offen offset:1024 sc1
    v_and_b32 v1, 15, v0
    v_lshrrev_b32 v6, 5, v0
    v_bfe_u32 v3, v0, 4, 1
    v_lshl_or_b32 v3, v3, 1, v6
    v_lshrrev_b32 v4, 2, v0
    v_bfe_u32 v5, v0, 1, 1
    v_lshrrev_b32 v6, 3, v1
    v_and_or_b32 v6, v1, 6, v6
    v_xor_b32 v6, v6, v3
    v_mul_u32_u24 v7, 384, v1
    v_lshl_add_u32 v6, v6, 4, v7
    v_add_u32 v34, s40, v6
    v_xor_b32 v35, 64, v34
    v_lshrrev_b32 v6, 3, v1
    v_and_b32 v7, 7, v1
    v_lshl_or_b32 v6, v7, 1, v6
    v_xor_b32 v6, v6, v3
    v_mul_u32_u24 v7, 768, v1
    v_lshl_add_u32 v6, v6, 4, v7
    v_add_u32 v40, s41, v6
    v_xor_b32 v41, 0x40, v40
    v_xor_b32 v42, 0x80, v40
    v_xor_b32 v43, 0xc0, v40
    v_and_b32 v2, 1, v0
    v_lshlrev_b32 v2, 3, v2
    s_mul_i32 s56, s3, 96
    v_lshrrev_b32 v6, 3, v4
    v_and_or_b32 v6, v4, 6, v6
    v_xor_b32 v6, v6, v5
    v_lshl_add_u32 v6, v6, 4, v2
    v_mul_u32_u24 v7, 384, v4
    s_add_u32 s57, s56, 0
    v_xad_u32 v36, v6, s57, v7
    s_add_u32 s57, s56, 32
    v_xad_u32 v37, v6, s57, v7
    s_add_u32 s57, s56, 64
    v_xad_u32 v38, v6, s57, v7
    v_lshrrev_b32 v6, 3, v4
    v_and_b32 v3, 7, v4
    v_lshl_or_b32 v6, v3, 1, v6
    v_xor_b32 v6, v6, v5
    v_lshl_add_u32 v6, v6, 4, v2
    v_lshlrev_b32 v7, 1, v7
    v_add_u32 v7, 24576, v7
    s_add_u32 s57, s56, 0
    v_xad_u32 v44, v6, s57, v7
    s_add_u32 s57, s56, 384
    v_xad_u32 v45, v6, s57, v7
    s_add_u32 s57, s56, 32
    v_xad_u32 v46, v6, s57, v7
    s_add_u32 s57, s56, 416
    v_xad_u32 v47, v6, s57, v7
    s_add_u32 s57, s56, 64
    v_xad_u32 v48, v6, s57, v7
    s_add_u32 s57, s56, 448
    v_xad_u32 v49, v6, s57, v7
    v_mov_b32 v52, 0x3f803f80
    v_mov_b32 v56, 0x3ebcbe62
    s_mov_b32 s44, 0x100001
    s_mov_b32 s45, 0x10000100
    v_mov_b32 v53, 0x3f803f80
    v_mov_b32 v57, 0x3ebcbe62
    s_mov_b32 s46, 0x200002
    s_mov_b32 s47, 0x20000200
    v_mov_b32 v54, 0x3f803f80
    v_mov_b32 v58, 0x3ebcbe62
    s_mov_b32 s48, 0x400004
    s_mov_b32 s49, 0x40000400
    v_mov_b32 v55, 0x3f803f80
    v_mov_b32 v59, 0x3ebcbe62
    s_mov_b32 s50, 0x800008
    s_mov_b32 s51, 0x80000800
    v_mov_b32 v60, 0x43400000
    v_lshrrev_b32 v1, 5, v0
    v_lshlrev_b32 v1, 8, v1
    v_and_b32 v2, 15, v0
    v_lshl_add_u32 v1, v2, 4, v1
    v_bfe_u32 v2, v0, 4, 1
    v_lshl_add_u32 v1, v2, 3, v1
    s_mul_i32 s56, s3, 1536
    s_add_u32 s56, s56, 147456
    v_add_u32 v236, s56, v1
    s_mul_i32 s56, s3, 3072
    s_add_u32 s56, s56, 24576
    v_add_u32 v237, s56, v65
    v_add_u32 v238, s41, v65
    s_lshl_b32 s56, s3, 10
    v_add_u32 v240, 159744, v65
    v_add_u32 v239, s56, v240
    v_add_u32 v241, 147456, v65
    v_bfe_u32 v1, v0, 2, 2
    v_lshrrev_b32 v2, 4, v0
    v_lshl_or_b32 v1, v1, 4, v2
    v_mul_u32_u24 v1, 65536, v1
    v_and_b32 v2, 3, v0
    v_lshl_or_b32 v242, v2, 5, v1
    v_xor_b32 v243, 0x70, v242
    s_mul_i32 s56, s3, 3
    v_min_u32 v1, 2, v0
    v_add_u32 v1, s56, v1
    v_min_u32 v2, 8, v0
    v_add_u32 v2, 9, v2
    v_cmp_gt_u32 vcc, 3, v0
    s_nop 1
    v_cndmask_b32 v1, v2, v1, vcc
    v_lshlrev_b32 v245, 7, v1
    v_lshlrev_b32 v1, 3, v0
    v_add_u32 v254, 126976, v1
    s_lshl_b32 s56, s3, 9
    v_add_u32 v238, s56, v254
    v_add_u32 v253, 122880, v65
    s_lshl_b32 s56, s3, 10
    v_add_u32 v237, s56, v253
    s_mov_b32 s52, 0x41c00000
    buffer_load_dwordx4 v28, s[24:27], s59 offen offset:2048 nt lds
    buffer_load_dwordx4 v29, s[24:27], s59 offen offset:3072 nt lds
    s_add_u32 m0, s42, 8192
    s_nop 0
    buffer_load_dwordx4 v30, s[24:27], s59 offen offset:0 nt lds
    buffer_load_dwordx4 v31, s[24:27], s59 offen offset:1024 nt lds
    s_waitcnt vmcnt(28)
    s_barrier
    ds_read_b128 a[48:51], v34 offset:0
    ds_read_b128 a[52:55], v35 offset:0
    ds_read_b128 a[56:59], v34 offset:128
    ds_read_b128 a[60:63], v35 offset:128
    ds_read_b128 a[64:67], v34 offset:256
    ds_read_b128 a[68:71], v35 offset:256
    s_waitcnt lgkmcnt(5)
    v_mfma_f32_16x16x32_bf16 v[84:87], a[48:51], a[48:51], 0
    ds_read_b64_tr_b16 a[72:73], v36 offset:0
    ds_read_b64_tr_b16 a[74:75], v36 offset:6144
    v_mfma_f32_16x16x32_bf16 v[80:83], a[48:51], v[52:55], 0
    buffer_load_dwordx4 v32, s[24:27], s59 offen offset:2048 nt lds
    ds_read_b64_tr_b16 a[76:77], v36 offset:12288
    ds_read_b64_tr_b16 a[78:79], v36 offset:18432
    s_waitcnt lgkmcnt(8)
    v_mfma_f32_16x16x32_bf16 v[84:87], a[52:55], a[52:55], v[84:87]
    ds_read_b64_tr_b16 a[80:81], v37 offset:0
    ds_read_b64_tr_b16 a[82:83], v37 offset:6144
    v_mfma_f32_16x16x32_bf16 v[80:83], a[52:55], v[52:55], v[80:83]
    ds_read_b64_tr_b16 a[84:85], v37 offset:12288
    ds_read_b64_tr_b16 a[86:87], v37 offset:18432
    s_waitcnt lgkmcnt(11)
    v_mfma_f32_16x16x32_bf16 v[84:87], a[56:59], a[56:59], v[84:87]
    ds_read_b64_tr_b16 a[88:89], v38 offset:0
    ds_read_b64_tr_b16 a[90:91], v38 offset:6144
    v_mfma_f32_16x16x32_bf16 v[80:83], a[56:59], v[52:55], v[80:83]
    ds_read_b64_tr_b16 a[92:93], v38 offset:12288
    ds_read_b64_tr_b16 a[94:95], v38 offset:18432
    s_waitcnt lgkmcnt(14)
    v_mfma_f32_16x16x32_bf16 v[84:87], a[60:63], a[60:63], v[84:87]
    v_mfma_f32_16x16x32_bf16 v[80:83], a[60:63], v[52:55], v[80:83]
    s_waitcnt lgkmcnt(13)
    v_mfma_f32_16x16x32_bf16 v[84:87], a[64:67], a[64:67], v[84:87]
    v_mfma_f32_16x16x32_bf16 v[80:83], a[64:67], v[52:55], v[80:83]
    s_waitcnt lgkmcnt(12)
    v_mfma_f32_16x16x32_bf16 v[84:87], a[68:71], a[68:71], v[84:87]
    v_mfma_f32_16x16x32_bf16 v[80:83], a[68:71], v[52:55], v[80:83]
    s_waitcnt lgkmcnt(0)
    s_mul_i32 s39, s38, 0x9e3779b1
    s_add_u32 s39, s39, 0x7f4a7c16
    s_or_b32 s39, s39, 1
    s_mul_i32 s56, s3, 3072
    s_add_u32 s56, s56, 16384
    buffer_load_dwordx4 v[136:139], v65, s[32:35], s56 offen offset:0 sc1
    buffer_load_dwordx4 v[140:143], v65, s[32:35], s56 offen offset:1024 sc1
    buffer_load_dwordx4 v[144:147], v65, s[32:35], s56 offen offset:2048 sc1
    s_branch L_join
L_xt3:
    s_call_b64 s[54:55], L_xslow
    s_branch L_post3
L_xt24:
    s_call_b64 s[54:55], L_xslow
    s_branch L_post24
L_xt6:
    s_call_b64 s[54:55], L_xslow
    s_branch L_post6
L_xt27:
    s_call_b64 s[54:55], L_xslow
    s_branch L_post27
L_xt9:
    s_call_b64 s[54:55], L_xslow
    s_branch L_post9
L_xt11:
    s_call_b64 s[54:55], L_xalt
    ds_read_b128 a[192:195], v253 offset:12288
    ds_read_b128 a[196:199], v253 offset:13312
    ds_read_b128 a[200:203], v253 offset:14336
    ds_read_b128 a[204:207], v253 offset:15360
    s_waitcnt lgkmcnt(0)
    s_branch L_post11
L_xslow:
    s_waitcnt lgkmcnt(0)
    ds_write_b32 v239, v62
    s_waitcnt lgkmcnt(0)
    s_barrier
    ds_read_b32 v12, v240 offset:0
    ds_read_b32 v13, v240 offset:1024
    ds_read_b32 v14, v240 offset:2048
    ds_read_b32 v15, v240 offset:3072
    v_mov_b32 v9, 0
    ds_write_b32 v254, v9 offset:4096
    s_waitcnt lgkmcnt(0)
    v_min3_f32 v1, v12, v13, v14
    v_min_f32 v1, v1, v15
    v_sub_f32 v2, v1, v255
    v_sub_f32 v12, v1, v62
    v_exp_f32 v2, v2
    v_exp_f32 v12, v12
    v_mov_b32 v62, v1
    v_mov_b32 v255, v1
    v_mul_f32 v88, v88, v12
    v_mul_f32 v89, v89, v12
    v_mul_f32 v90, v90, v12
    v_mul_f32 v91, v91, v12
    v_mul_f32 v104, v104, v12
    v_mul_f32 v105, v105, v12
    v_mul_f32 v106, v106, v12
    v_mul_f32 v107, v107, v12
    v_mul_f32 v68, v68, v12
    v_mul_f32 v69, v69, v12
    v_mul_f32 v70, v70, v12
    v_mul_f32 v71, v71, v12
    v_mul_f32 v112, v112, v12
    v_mul_f32 v113, v113, v12
    v_mul_f32 v114, v114, v12
    v_mul_f32 v115, v115, v12
    v_mul_f32 v63, v63, v12
    v_mul_f32 v64, v64, v12
    v_accvgpr_read_b32 v1, a0
    v_mul_f32 v1, v1, v2
    v_accvgpr_write_b32 a0, v1
    v_accvgpr_read_b32 v1, a1
    v_mul_f32 v1, v1, v2
    v_accvgpr_write_b32 a1, v1
    v_accvgpr_read_b32 v1, a2
    v_mul_f32 v1, v1, v2
    v_accvgpr_write_b32 a2, v1
    v_accvgpr_read_b32 v1, a3
    v_mul_f32 v1, v1, v2
    v_accvgpr_write_b32 a3, v1
    v_accvgpr_read_b32 v1, a4
    v_mul_f32 v1, v1, v2
    v_accvgpr_write_b32 a4, v1
    v_accvgpr_read_b32 v1, a5
    v_mul_f32 v1, v1, v2
    v_accvgpr_write_b32 a5, v1
    v_accvgpr_read_b32 v1, a6
    v_mul_f32 v1, v1, v2
    v_accvgpr_write_b32 a6, v1
    v_accvgpr_read_b32 v1, a7
    v_mul_f32 v1, v1, v2
    v_accvgpr_write_b32 a7, v1
    v_accvgpr_read_b32 v1, a8
    v_mul_f32 v1, v1, v2
    v_accvgpr_write_b32 a8, v1
    v_accvgpr_read_b32 v1, a9
    v_mul_f32 v1, v1, v2
    v_accvgpr_write_b32 a9, v1
    v_accvgpr_read_b32 v1, a10
    v_mul_f32 v1, v1, v2
    v_accvgpr_write_b32 a10, v1
    v_accvgpr_read_b32 v1, a11
    v_mul_f32 v1, v1, v2
    v_accvgpr_write_b32 a11, v1
    v_cvt_pk_bf16_f32 v72, v88, v89
    v_cvt_pk_bf16_f32 v73, v90, v91
    v_cvt_pk_bf16_f32 v74, v104, v105
    v_cvt_pk_bf16_f32 v75, v106, v107
    ds_write_b128 v237, v[72:75] offset:0
    v_cvt_pk_bf16_f32 v66, v68, v69
    v_cvt_pk_bf16_f32 v67, v70, v71
    ds_write_b64 v238, v[66:67]
    s_waitcnt lgkmcnt(0)
    s_barrier
    s_setpc_b64 s[54:55]
L_xlast:
    s_waitcnt lgkmcnt(0)
    ds_write_b32 v239, v62
    s_waitcnt lgkmcnt(0)
    s_barrier
    ds_read_b32 v12, v240 offset:0
    ds_read_b32 v13, v240 offset:1024
    ds_read_b32 v14, v240 offset:2048
    ds_read_b32 v15, v240 offset:3072
    v_mov_b32 v9, 0
    ds_write_b32 v254, v9 offset:4096
    s_waitcnt lgkmcnt(0)
    v_min3_f32 v1, v12, v13, v14
    v_min_f32 v1, v1, v15
    v_sub_f32 v2, v1, v255
    v_sub_f32 v12, v1, v62
    v_exp_f32 v2, v2
    v_exp_f32 v12, v12
    v_mov_b32 v62, v1
    v_mov_b32 v255, v1
    v_mul_f32 v88, v88, v12
    v_mul_f32 v89, v89, v12
    v_mul_f32 v90, v90, v12
    v_mul_f32 v91, v91, v12
    v_mul_f32 v104, v104, v12
    v_mul_f32 v105, v105, v12
    v_mul_f32 v106, v106, v12
    v_mul_f32 v107, v107, v12
    v_mul_f32 v68, v68, v12
    v_mul_f32 v69, v69, v12
    v_mul_f32 v70, v70, v12
    v_mul_f32 v71, v71, v12
    v_mul_f32 v10, v10, v12
    v_mul_f32 v11, v11, v12
    v_mul_f32 v16, v16, v2
    v_mul_f32 v17, v17, v2
    v_mul_f32 v18, v18, v2
    v_mul_f32 v19, v19, v2
    v_mul_f32 v20, v20, v2
    v_mul_f32 v21, v21, v2
    v_mul_f32 v22, v22, v2
    v_mul_f32 v23, v23, v2
    v_mul_f32 v24, v24, v2
    v_mul_f32 v25, v25, v2
    v_mul_f32 v26, v26, v2
    v_mul_f32 v27, v27, v2
    v_cvt_pk_bf16_f32 v72, v88, v89
    v_cvt_pk_bf16_f32 v73, v90, v91
    v_cvt_pk_bf16_f32 v74, v104, v105
    v_cvt_pk_bf16_f32 v75, v106, v107
    ds_write_b128 v237, v[72:75] offset:0
    v_cvt_pk_bf16_f32 v66, v68, v69
    v_cvt_pk_bf16_f32 v67, v70, v71
    ds_write_b64 v238, v[66:67]
    ds_write_b64 v238, v[10:11] offset:2048
    s_waitcnt lgkmcnt(0)
    s_barrier
    s_branch L_postx
L_xalt:
    s_waitcnt lgkmcnt(0)
    ds_write_b32 v239, v62
    s_waitcnt lgkmcnt(0)
    s_barrier
    ds_read_b32 v12, v240 offset:0
    ds_read_b32 v13, v240 offset:1024
    ds_read_b32 v14, v240 offset:2048
    ds_read_b32 v15, v240 offset:3072
    v_mov_b32 v9, 0
    ds_write_b32 v254, v9 offset:4100
    s_waitcnt lgkmcnt(0)
    v_min3_f32 v1, v12, v13, v14
    v_min_f32 v1, v1, v15
    v_sub_f32 v2, v1, v255
    v_sub_f32 v12, v1, v62
    v_exp_f32 v2, v2
    v_exp_f32 v12, v12
    v_mov_b32 v62, v1
    v_mov_b32 v255, v1
    v_mul_f32 v88, v88, v12
    v_mul_f32 v89, v89, v12
    v_mul_f32 v90, v90, v12
    v_mul_f32 v91, v91, v12
    v_mul_f32 v104, v104, v12
    v_mul_f32 v105, v105, v12
    v_mul_f32 v106, v106, v12
    v_mul_f32 v107, v107, v12
    v_mul_f32 v68, v68, v12
    v_mul_f32 v69, v69, v12
    v_mul_f32 v70, v70, v12
    v_mul_f32 v71, v71, v12
    v_mul_f32 v112, v112, v12
    v_mul_f32 v113, v113, v12
    v_mul_f32 v114, v114, v12
    v_mul_f32 v115, v115, v12
    v_mul_f32 v63, v63, v12
    v_mul_f32 v64, v64, v12
    v_mul_f32 v16, v16, v2
    v_mul_f32 v17, v17, v2
    v_mul_f32 v18, v18, v2
    v_mul_f32 v19, v19, v2
    v_mul_f32 v20, v20, v2
    v_mul_f32 v21, v21, v2
    v_mul_f32 v22, v22, v2
    v_mul_f32 v23, v23, v2
    v_mul_f32 v24, v24, v2
    v_mul_f32 v25, v25, v2
    v_mul_f32 v26, v26, v2
    v_mul_f32 v27, v27, v2
    v_cvt_pk_bf16_f32 v72, v88, v89
    v_cvt_pk_bf16_f32 v73, v90, v91
    v_cvt_pk_bf16_f32 v74, v104, v105
    v_cvt_pk_bf16_f32 v75, v106, v107
    ds_write_b128 v237, v[72:75] offset:12288
    s_waitcnt lgkmcnt(0)
    s_barrier
    s_setpc_b64 s[54:55]
L_c_slow:
    s_cmp_eq_u32 s43, 0
    s_cbranch_scc1 L_c_out
    s_mov_b32 s43, 0
    buffer_load_dwordx4 v[76:79], v29, s[32:35], s30 offen offset:0 sc1
    buffer_load_dwordx4 v[80:83], v29, s[32:35], s30 offen offset:2048 sc1
    buffer_load_dwordx4 v[84:87], v29, s[32:35], s31 offen offset:0 sc1
    buffer_load_dwordx4 v[108:111], v29, s[32:35], s31 offen offset:2048 sc1
    s_waitcnt vmcnt(0)
    v_sub_u32 v49, v79, v247
    v_max_f32 v42, v42, v49
    v_sub_u32 v49, v83, v247
    v_max_f32 v42, v42, v49
    v_sub_u32 v49, v87, v247
    v_max_f32 v42, v42, v49
    v_sub_u32 v49, v111, v247
    v_max_f32 v42, v42, v49
    s_nop 1
    v_max_f32_dpp v42, v42, v42 row_ror:8 row_mask:0xf bank_mask:0xf
    v_mov_b32 v48, v42
    s_nop 1
    v_max_f32_dpp v42, v48, v48 row_shr:4 row_mask:0xf bank_mask:0xa
    s_nop 1
    v_max_f32_dpp v42, v48, v48 row_shl:4 row_mask:0xf bank_mask:0x5
    v_mov_b32 v48, v42
    s_nop 1
    v_permlane32_swap_b32 v42, v48
    v_max_f32 v42, v42, v48
    v_mov_b32 v48, v42
    s_nop 1
    v_permlane16_swap_b32 v42, v48
    v_max_f32 v42, v42, v48
    s_lshl_b32 s56, s3, 2
    v_add_u32 v48, s56, v251
    ds_write_b32 v48, v42 offset:1024
    s_waitcnt lgkmcnt(0)
    s_barrier
    ds_read_b128 v[48:51], v251 offset:1024
    v_mov_b32 v16, 0
    v_mov_b32 v17, 0
    v_mov_b32 v18, 0
    v_mov_b32 v19, 0
    v_mov_b32 v20, 0
    v_mov_b32 v21, 0
    v_mov_b32 v22, 0
    s_waitcnt lgkmcnt(0)
    v_max3_f32 v42, v48, v49, v50
    v_max_f32 v42, v42, v51
    v_sub_u32 v49, v79, v247
    v_sub_f32 v49, v49, v42
    v_exp_f32 v49, v49
    s_nop 0
    v_cvt_pk_bf16_f32 v49, v49, 0
    v_lshlrev_b32 v50, 16, v49
    v_dot2_f32_bf16 v16, v76, v49, v16
    v_dot2_f32_bf16 v18, v77, v49, v18
    v_dot2_f32_bf16 v20, v78, v49, v20
    v_add_f32 v22, v22, v50
    v_dot2_f32_bf16 v17, v76, v50, v17
    v_dot2_f32_bf16 v19, v77, v50, v19
    v_dot2_f32_bf16 v21, v78, v50, v21
    v_sub_u32 v49, v83, v247
    v_sub_f32 v49, v49, v42
    v_exp_f32 v49, v49
    s_nop 0
    v_cvt_pk_bf16_f32 v49, v49, 0
    v_lshlrev_b32 v50, 16, v49
    v_dot2_f32_bf16 v16, v80, v49, v16
    v_dot2_f32_bf16 v18, v81, v49, v18
    v_dot2_f32_bf16 v20, v82, v49, v20
    v_add_f32 v22, v22, v50
    v_dot2_f32_bf16 v17, v80, v50, v17
    v_dot2_f32_bf16 v19, v81, v50, v19
    v_dot2_f32_bf16 v21, v82, v50, v21
    v_sub_u32 v49, v87, v247
    v_sub_f32 v49, v49, v42
    v_exp_f32 v49, v49
    s_nop 0
    v_cvt_pk_bf16_f32 v49, v49, 0
    v_lshlrev_b32 v50, 16, v49
    v_dot2_f32_bf16 v16, v84, v49, v16
    v_dot2_f32_bf16 v18, v85, v49, v18
    v_dot2_f32_bf16 v20, v86, v49, v20
    v_add_f32 v22, v22, v50
    v_dot2_f32_bf16 v17, v84, v50, v17
    v_dot2_f32_bf16 v19, v85, v50, v19
    v_dot2_f32_bf16 v21, v86, v50, v21
    v_sub_u32 v49, v111, v247
    v_sub_f32 v49, v49, v42
    v_exp_f32 v49, v49
    s_nop 0
    v_cvt_pk_bf16_f32 v49, v49, 0
    v_lshlrev_b32 v50, 16, v49
    v_dot2_f32_bf16 v16, v108, v49, v16
    v_dot2_f32_bf16 v18, v109, v49, v18
    v_dot2_f32_bf16 v20, v110, v49, v20
    v_add_f32 v22, v22, v50
    v_dot2_f32_bf16 v17, v108, v50, v17
    v_dot2_f32_bf16 v19, v109, v50, v19
    v_dot2_f32_bf16 v21, v110, v50, v21
    s_nop 2
    s_branch L_c_red
L_qk_retry:
    s_mov_b32 s53, 0
L_qk_again:
    s_mul_i32 s56, s3, 3072
    s_add_u32 s56, s56, 16384
    buffer_load_dwordx4 v[136:139], v65, s[32:35], s56 offen offset:0 sc1
    buffer_load_dwordx4 v[140:143], v65, s[32:35], s56 offen offset:1024 sc1
    buffer_load_dwordx4 v[144:147], v65, s[32:35], s56 offen offset:2048 sc1
    s_add_u32 s53, s53, 1
    s_waitcnt vmcnt(0)
    v_xor_b32 v1, s39, v138
    v_xor_b32 v2, s39, v142
    v_xor_b32 v3, s39, v146
    v_or3_b32 v1, v1, v2, v3
    v_cmp_ne_u32 vcc, 0, v1
    s_cbranch_vccz L_qk_ok
    s_cmp_lt_u32 s53, 65536
    s_cbranch_scc1 L_qk_again
    s_branch L_qk_ok
L_fl_retry:
    s_mov_b32 s53, 0
L_fl_again:
    buffer_load_dwordx2 v[234:235], v245, s[32:35], 0 offen offset:128 sc1
    s_add_u32 s53, s53, 1
    s_waitcnt vmcnt(0)
    v_cmp_ne_u32 vcc, s39, v234
    s_cbranch_vccz L_fl_ok
    s_cmp_lt_u32 s53, 65536
    s_cbranch_scc1 L_fl_again
    s_branch L_fl_ok
L_site0:
    s_call_b64 s[54:55], L_rare2
    s_branch L_back0
L_site1:
    s_call_b64 s[54:55], L_rare3
    s_branch L_back1
L_site2:
    s_call_b64 s[54:55], L_rare2
    s_branch L_back2
L_site3:
    s_call_b64 s[54:55], L_rare3
    s_branch L_back3
L_site4:
    s_call_b64 s[54:55], L_rare2
    s_branch L_back4
L_site5:
    s_call_b64 s[54:55], L_rare3
    s_branch L_back5
L_site6:
    s_call_b64 s[54:55], L_rare2
    s_branch L_back6
L_site7:
    s_call_b64 s[54:55], L_rare3
    s_branch L_back7
L_site8:
    s_call_b64 s[54:55], L_rare2
    s_branch L_back8
L_site9:
    s_call_b64 s[54:55], L_rare3
    s_branch L_back9
L_site10:
    s_call_b64 s[54:55], L_rare6
    s_branch L_back10
L_site11:
    s_call_b64 s[54:55], L_rare7
    s_branch L_back11
L_site12:
    s_call_b64 s[54:55], L_rare2
    s_branch L_back12
L_site13:
    s_call_b64 s[54:55], L_rare5
    s_branch L_back13
L_rare2:
    s_nop 7
    s_nop 7
    v_mov_b32 v2, v1
    s_nop 1
    v_permlane32_swap_b32 v1, v2
    v_max_f32 v1, v1, v2
    v_mov_b32 v2, v1
    s_nop 1
    v_permlane16_swap_b32 v1, v2
    v_max_f32 v1, v1, v2
    v_max_f32 v1, 0, v1
    v_sub_f32 v62, v62, v1
    v_sub_f32 v88, v88, v1
    v_sub_f32 v89, v89, v1
    v_sub_f32 v90, v90, v1
    v_sub_f32 v91, v91, v1
    v_sub_f32 v1, 0, v1
    v_exp_f32 v1, v1
    s_nop 0
    v_mul_f32 v63, v63, v1
    v_mul_f32 v64, v64, v1
    v_mul_f32 v68, v68, v1
    v_mul_f32 v69, v69, v1
    v_mul_f32 v70, v70, v1
    v_mul_f32 v71, v71, v1
    v_mov_b32 v2, 1
    ds_write_b32 v254, v2 offset:4096
    s_waitcnt lgkmcnt(0)
    s_nop 3
    s_setpc_b64 s[54:55]
L_rare3:
    s_nop 7
    s_nop 7
    v_mov_b32 v2, v1
    s_nop 1
    v_permlane32_swap_b32 v1, v2
    v_max_f32 v1, v1, v2
    v_mov_b32 v2, v1
    s_nop 1
    v_permlane16_swap_b32 v1, v2
    v_max_f32 v1, v1, v2
    v_max_f32 v1, 0, v1
    v_sub_f32 v62, v62, v1
    v_sub_f32 v104, v104, v1
    v_sub_f32 v105, v105, v1
    v_sub_f32 v106, v106, v1
    v_sub_f32 v107, v107, v1
    v_sub_f32 v1, 0, v1
    v_exp_f32 v1, v1
    s_nop 0
    v_mul_f32 v63, v63, v1
    v_mul_f32 v64, v64, v1
    v_mul_f32 v68, v68, v1
    v_mul_f32 v69, v69, v1
    v_mul_f32 v70, v70, v1
    v_mul_f32 v71, v71, v1
    v_mul_f32 v88, v88, v1
    v_mul_f32 v89, v89, v1
    v_mul_f32 v90, v90, v1
    v_mul_f32 v91, v91, v1
    v_mov_b32 v2, 1
    ds_write_b32 v254, v2 offset:4096
    s_waitcnt lgkmcnt(0)
    s_nop 3
    s_setpc_b64 s[54:55]
L_rare5:
    s_nop 7
    s_nop 7
    v_mov_b32 v2, v1
    s_nop 1
    v_permlane32_swap_b32 v1, v2
    v_max_f32 v1, v1, v2
    v_mov_b32 v2, v1
    s_nop 1
    v_permlane16_swap_b32 v1, v2
    v_max_f32 v1, v1, v2
    v_max_f32 v1, 0, v1
    v_sub_f32 v62, v62, v1
    v_sub_f32 v104, v104, v1
    v_sub_f32 v105, v105, v1
    v_sub_f32 v106, v106, v1
    v_sub_f32 v107, v107, v1
    v_sub_f32 v1, 0, v1
    v_exp_f32 v1, v1
    s_nop 0
    v_mul_f32 v63, v63, v1
    v_mul_f32 v64, v64, v1
    v_mul_f32 v68, v68, v1
    v_mul_f32 v69, v69, v1
    v_mul_f32 v70, v70, v1
    v_mul_f32 v71, v71, v1
    v_mul_f32 v88, v88, v1
    v_mul_f32 v89, v89, v1
    v_mul_f32 v90, v90, v1
    v_mul_f32 v91, v91, v1
    v_cvt_pk_bf16_f32 v72, v88, v89
    v_cvt_pk_bf16_f32 v73, v90, v91
    v_mov_b32 v2, 1
    ds_write_b32 v254, v2 offset:4096
    s_waitcnt lgkmcnt(0)
    s_nop 3
    s_setpc_b64 s[54:55]
L_rare6:
    s_nop 7
    s_nop 7
    v_mov_b32 v2, v1
    s_nop 1
    v_permlane32_swap_b32 v1, v2
    v_max_f32 v1, v1, v2
    v_mov_b32 v2, v1
    s_nop 1
    v_permlane16_swap_b32 v1, v2
    v_max_f32 v1, v1, v2
    v_max_f32 v1, 0, v1
    v_sub_f32 v62, v62, v1
    v_sub_f32 v88, v88, v1
    v_sub_f32 v89, v89, v1
    v_sub_f32 v90, v90, v1
    v_sub_f32 v91, v91, v1
    v_sub_f32 v1, 0, v1
    v_exp_f32 v1, v1
    s_nop 0
    v_mul_f32 v63, v63, v1
    v_mul_f32 v64, v64, v1
    v_mul_f32 v68, v68, v1
    v_mul_f32 v69, v69, v1
    v_mul_f32 v70, v70, v1
    v_mul_f32 v71, v71, v1
    v_mov_b32 v2, 1
    ds_write_b32 v254, v2 offset:4100
    s_waitcnt lgkmcnt(0)
    s_nop 3
    s_setpc_b64 s[54:55]
L_rare7:
    s_nop 7
    s_nop 7
    v_mov_b32 v2, v1
    s_nop 1
    v_permlane32_swap_b32 v1, v2
    v_max_f32 v1, v1, v2
    v_mov_b32 v2, v1
    s_nop 1
    v_permlane16_swap_b32 v1, v2
    v_max_f32 v1, v1, v2
    v_max_f32 v1, 0, v1
    v_sub_f32 v62, v62, v1
    v_sub_f32 v104, v104, v1
    v_sub_f32 v105, v105, v1
    v_sub_f32 v106, v106, v1
    v_sub_f32 v107, v107, v1
    v_sub_f32 v1, 0, v1
    v_exp_f32 v1, v1
    s_nop 0
    v_mul_f32 v63, v63, v1
    v_mul_f32 v64, v64, v1
    v_mul_f32 v68, v68, v1
    v_mul_f32 v69, v69, v1
    v_mul_f32 v70, v70, v1
    v_mul_f32 v71, v71, v1
    v_mul_f32 v88, v88, v1
    v_mul_f32 v89, v89, v1
    v_mul_f32 v90, v90, v1
    v_mul_f32 v91, v91, v1
    v_mov_b32 v2, 1
    ds_write_b32 v254, v2 offset:4100
    s_waitcnt lgkmcnt(0)
    s_nop 3
    s_setpc_b64 s[54:55]
L_codeend:
.section .rodata,"a"
.p2align 6
.amdhsa_kernel standalone__detection_seg_dino__vision_kernel
  .amdhsa_next_free_vgpr 464
  .amdhsa_next_free_sgpr 102
  .amdhsa_accum_offset 256
  .amdhsa_group_segment_fixed_size 0
  .amdhsa_kernarg_size 80
  .amdhsa_user_sgpr_count 2
  .amdhsa_user_sgpr_kernarg_segment_ptr 1
  .amdhsa_system_sgpr_workgroup_id_x 1
  .amdhsa_float_denorm_mode_32 3
.end_amdhsa_kernel
```

```asm
; @launch grid=(256,1,1) block=(256,1,1) lds=163840
.amdgcn_target "amdgcn-amd-amdhsa--gfx950"
.text
.globl standalone__detection_seg_dino__vision_kernel
.p2align 8
.type standalone__detection_seg_dino__vision_kernel,@function
standalone__detection_seg_dino__vision_kernel:
    s_cmp_ge_u32 s2, 256
    s_cbranch_scc1 L_end
    s_load_dwordx16 s[4:19], s[0:1], 0
    s_load_dwordx4 s[20:23], s[0:1], 64
    s_memrealtime s[44:45]
    s_getpc_b64 s[54:55]
L_pc_main:
    v_lshlrev_b32 v233, 7, v0
    v_min_u32 v233, L_codeend - L_pc_main - 4, v233
    global_load_dword v232, v233, s[54:55]
    s_mov_b64 s[100:101], s[54:55]
    v_lshrrev_b32 v1, 6, v0
    v_and_b32 v0, 63, v0
    v_readfirstlane_b32 s3, v1
    v_lshlrev_b32 v65, 4, v0
    v_lshrrev_b32 v1, 2, v0
    v_and_b32 v1, 14, v1
    s_mov_b32 s56, 0x5000
    v_bfe_u32 v2, s56, v1, 2
    v_lshlrev_b32 v2, 5, v2
    v_xor_b32 v16, v65, v2
    s_mov_b32 s56, 0xaa55
    v_bfe_u32 v2, s56, v1, 2
    v_lshlrev_b32 v2, 5, v2
    v_xor_b32 v17, v65, v2
    s_mov_b32 s56, 0xfffa
    v_bfe_u32 v2, s56, v1, 2
    v_lshlrev_b32 v2, 5, v2
    v_xor_b32 v18, v65, v2
    v_xor_b32 v19, 16, v16
    v_xor_b32 v20, 0x1010, v17
    v_xor_b32 v21, 0x1010, v18
    v_lshrrev_b32 v1, 3, v0
    v_and_b32 v1, 6, v1
    s_mov_b32 s56, 0x40
    v_bfe_u32 v2, s56, v1, 2
    v_lshlrev_b32 v2, 5, v2
    v_xor_b32 v22, v65, v2
    s_mov_b32 s56, 0xa5
    v_bfe_u32 v2, s56, v1, 2
    v_lshlrev_b32 v2, 5, v2
    v_xor_b32 v23, v65, v2
    s_mov_b32 s56, 0xfe
    v_bfe_u32 v2, s56, v1, 2
    v_lshlrev_b32 v2, 5, v2
    v_xor_b32 v24, v65, v2
    v_xor_b32 v25, 0x80, v22
    v_xor_b32 v26, 0x1080, v23
    v_xor_b32 v27, 0x1080, v24
    v_xor_b32 v28, 0x1010, v22
    v_xor_b32 v29, 0x1010, v23
    v_xor_b32 v30, 0x2010, v24
    v_xor_b32 v31, 0x2090, v22
    v_xor_b32 v32, 0x2090, v23
    v_xor_b32 v33, 0x2090, v24
    v_mov_b32 v248, 0x10000
    s_mul_i32 s36, s3, 6144
    s_mul_i32 s37, s3, 12288
    s_add_u32 s40, s36, 0
    s_add_u32 s41, s37, 24576
    s_add_u32 s42, s37, 73728
    s_and_b32 s58, s2, 7
    s_lshr_b32 s57, s2, 3
    s_lshl_b32 s58, s58, 5
    s_add_u32 s58, s58, s57
    s_lshr_b32 s56, s58, 2
    s_mul_i32 s56, s56, 196608
    s_mul_i32 s57, s58, 24576
    s_lshl1_add_u32 s56, s57, s56
    s_mov_b64 s[60:61], s[56:57]
    s_and_b32 s98, s2, 7
    s_cmp_lt_u32 s2, 48
    s_cselect_b32 s98, s98, 0
    s_mov_b32 s30, 18898944
    s_mov_b32 s31, 0x20000
    s_mov_b32 s26, 75743232
    s_mov_b32 s27, 0x20000
    s_mov_b32 s34, 16777216
    s_mov_b32 s35, 0x20000
    s_mov_b32 m0, s40
    s_and_b32 s56, s2, 7
    s_cmp_eq_u32 s56, 2
    s_cbranch_scc1 L_spec
    s_and_b32 s56, s2, 7
    s_cbranch_scc1 L_plain
L_spec:
    s_waitcnt lgkmcnt(0)
    s_add_u32 s28, s8, s61
    s_addc_u32 s29, s9, 0
    s_add_u32 s24, s6, s60
    s_addc_u32 s25, s7, 0
    s_mov_b64 s[32:33], s[22:23]
    s_lshr_b32 s43, s2, 3
    s_mul_i32 s57, s43, 2304
    v_min_u32 v1, 17, v0
    v_lshlrev_b32 v1, 7, v1
    s_mov_b32 s66, 73728
    s_mov_b32 s67, 0x20000
    s_mov_b32 s70, 73728
    s_mov_b32 s71, 0x20000
    s_mov_b32 s72, s4
    s_mov_b32 s73, s5
    s_mov_b32 s74, 6144
    s_mov_b32 s75, 0x20000
    s_bitcmp1_b32 s2, 1
    s_cselect_b64 s[64:65], s[16:17], s[10:11]
    s_cselect_b64 s[68:69], s[14:15], s[12:13]
    s_cmp_eq_u32 s3, 0
    s_cbranch_scc1 L_pf0
    s_cmp_eq_u32 s3, 1
    s_cbranch_scc0 L_pfdone
    s_lshl_b32 s58, s43, 8
    buffer_load_dword v234, v1, s[68:71], s57 offen
    v_min_u32 v2, 128, v1
    buffer_load_dword v235, v2, s[72:75], s58 offen
    s_branch L_pfdone
L_pf0:
    buffer_load_dword v234, v1, s[64:67], s57 offen
L_pfdone:
    s_cmp_ge_u32 s43, 3
    s_cbranch_scc1 L_nopf
    s_mov_b32 s0, 1
    s_bitcmp1_b32 s2, 1
    s_cbranch_scc0 L_prod
    s_branch L_vprod
L_plain:
    s_waitcnt lgkmcnt(0)
    s_cmp_eq_u32 s98, 1
    s_cbranch_scc0 L_nopf
    s_lshl2_add_u32 s20, s2, s3
    s_lshl4_add_u32 s20, s20, s44
    s_mul_i32 s20, s20, 0x9e3779b1
    s_lshr_b32 s20, s20, 11
    s_and_b32 s20, s20, 0x1fdf80
    s_bfe_u32 s56, s2, 0x10003
    s_lshl_b32 s56, s56, 13
    s_add_u32 s56, s56, 6291456
    s_add_u32 s56, s56, s20
    s_load_dword s38, s[22:23], s56
    s_memtime s[20:21]
L_nopf:
    s_add_u32 s28, s8, s61
    s_addc_u32 s29, s9, 0
    buffer_load_dwordx4 v16, s[28:31], s36 offen offset:0 nt lds
    s_add_u32 s24, s6, s60
    s_addc_u32 s25, s7, 0
    s_mov_b64 s[32:33], s[22:23]
    s_mov_b32 s0, 0
    buffer_load_dwordx4 v17, s[28:31], s36 offen offset:1024 nt lds
    buffer_load_dwordx4 v18, s[28:31], s36 offen offset:2048 nt lds
    buffer_load_dwordx4 v19, s[28:31], s36 offen offset:3072 nt lds
    s_add_u32 m0, s40, 4096
    s_nop 0
    buffer_load_dwordx4 v20, s[28:31], s36 offen offset:0 nt lds
    buffer_load_dwordx4 v21, s[28:31], s36 offen offset:1024 nt lds
    s_mov_b32 s43, -1
    s_cmp_eq_u32 s98, 1
    s_cbranch_scc0 L_noprobe
    s_waitcnt lgkmcnt(0)
    s_memtime s[54:55]
    s_waitcnt lgkmcnt(0)
    s_sub_u32 s20, s54, s20
    s_add_u32 s98, s3, 1
L_noprobe:
    s_load_dword s38, s[22:23], 0
    v_and_b32 v1, 15, v0
    v_lshrrev_b32 v6, 5, v0
    v_bfe_u32 v3, v0, 4, 1
    v_lshl_or_b32 v3, v3, 1, v6
    v_lshrrev_b32 v4, 2, v0
    v_bfe_u32 v5, v0, 1, 1
    v_lshrrev_b32 v6, 3, v1
    v_and_or_b32 v6, v1, 6, v6
    v_xor_b32 v6, v6, v3
    v_mul_u32_u24 v7, 384, v1
    v_lshl_add_u32 v6, v6, 4, v7
    v_add_u32 v34, s40, v6
    v_xor_b32 v35, 64, v34
    v_lshrrev_b32 v6, 3, v1
    v_and_b32 v7, 7, v1
    v_lshl_or_b32 v6, v7, 1, v6
    v_xor_b32 v6, v6, v3
    v_mul_u32_u24 v7, 768, v1
    v_lshl_add_u32 v6, v6, 4, v7
    v_add_u32 v40, s41, v6
    v_xor_b32 v41, 0x40, v40
    v_xor_b32 v42, 0x80, v40
    v_xor_b32 v43, 0xc0, v40
    v_and_b32 v2, 1, v0
    v_lshlrev_b32 v2, 3, v2
    s_mul_i32 s56, s3, 96
    v_lshrrev_b32 v6, 3, v4
    v_and_or_b32 v6, v4, 6, v6
    v_xor_b32 v6, v6, v5
    v_lshl_add_u32 v6, v6, 4, v2
    v_mul_u32_u24 v7, 384, v4
    s_add_u32 s57, s56, 0
    v_xad_u32 v36, v6, s57, v7
    s_add_u32 s57, s56, 32
    v_xad_u32 v37, v6, s57, v7
    s_add_u32 s57, s56, 64
    v_xad_u32 v38, v6, s57, v7
    v_lshrrev_b32 v6, 3, v4
    v_and_b32 v3, 7, v4
    v_lshl_or_b32 v6, v3, 1, v6
    v_xor_b32 v6, v6, v5
    v_lshl_add_u32 v6, v6, 4, v2
    v_lshlrev_b32 v7, 1, v7
    v_add_u32 v7, 24576, v7
    s_add_u32 s57, s56, 0
    v_xad_u32 v44, v6, s57, v7
    s_add_u32 s57, s56, 384
    v_xad_u32 v45, v6, s57, v7
    s_add_u32 s57, s56, 32
    v_xad_u32 v46, v6, s57, v7
    s_add_u32 s57, s56, 416
    v_xad_u32 v47, v6, s57, v7
    s_add_u32 s57, s56, 64
    v_xad_u32 v48, v6, s57, v7
    s_add_u32 s57, s56, 448
    v_xad_u32 v49, v6, s57, v7
    v_mov_b32 v52, 0x3f803f80
    v_mov_b32 v56, 0x3ebcbe62
    s_mov_b32 s44, 0x100001
    s_mov_b32 s45, 0x10000100
    v_mov_b32 v53, 0x3f803f80
    v_mov_b32 v57, 0x3ebcbe62
    s_mov_b32 s46, 0x200002
    s_mov_b32 s47, 0x20000200
    v_mov_b32 v54, 0x3f803f80
    v_mov_b32 v58, 0x3ebcbe62
    s_mov_b32 s48, 0x400004
    s_mov_b32 s49, 0x40000400
    v_mov_b32 v55, 0x3f803f80
    v_mov_b32 v59, 0x3ebcbe62
    s_mov_b32 s50, 0x800008
    s_mov_b32 s51, 0x80000800
    v_mov_b32 v60, 0x43400000
    v_lshrrev_b32 v1, 5, v0
    v_lshlrev_b32 v1, 8, v1
    v_and_b32 v2, 15, v0
    v_lshl_add_u32 v1, v2, 4, v1
    v_bfe_u32 v2, v0, 4, 1
    v_lshl_add_u32 v1, v2, 3, v1
    s_mul_i32 s56, s3, 1536
    s_add_u32 s56, s56, 147456
    v_add_u32 v236, s56, v1
    s_mul_i32 s56, s3, 3072
    s_add_u32 s56, s56, 24576
    v_add_u32 v237, s56, v65
    v_add_u32 v238, s41, v65
    s_lshl_b32 s56, s3, 10
    v_add_u32 v240, 159744, v65
    v_add_u32 v239, s56, v240
    v_add_u32 v241, 147456, v65
    v_bfe_u32 v1, v0, 2, 2
    v_lshrrev_b32 v2, 4, v0
    v_lshl_or_b32 v1, v1, 4, v2
    v_mul_u32_u24 v1, 65536, v1
    v_and_b32 v2, 3, v0
    v_lshl_or_b32 v242, v2, 5, v1
    v_xor_b32 v243, 0x70, v242
    s_mul_i32 s56, s3, 3
    v_min_u32 v1, 2, v0
    v_add_u32 v1, s56, v1
    v_min_u32 v2, 8, v0
    v_add_u32 v2, 9, v2
    v_cmp_gt_u32 vcc, 3, v0
    s_nop 1
    v_cndmask_b32 v1, v2, v1, vcc
    v_lshlrev_b32 v245, 7, v1
    v_lshlrev_b32 v1, 3, v0
    v_add_u32 v254, 126976, v1
    s_lshl_b32 s56, s3, 9
    v_add_u32 v238, s56, v254
    v_add_u32 v253, 122880, v65
    s_lshl_b32 s56, s3, 10
    v_add_u32 v237, s56, v253
    s_mov_b32 s52, 0x41c00000
    s_waitcnt vmcnt(5)
    s_add_u32 m0, s41, 0
    s_add_u32 s58, s37, 0
    buffer_load_dwordx4 v22, s[24:27], s58 offen offset:0 nt lds
    s_waitcnt vmcnt(5)
    buffer_load_dwordx4 v23, s[24:27], s58 offen offset:1024 nt lds
    s_sub_u32 s59, s2, 64
    s_lshr_b32 s59, s59, 4
    s_and_b32 s56, s2, 7
    s_lshl3_add_u32 s59, s59, s56
    s_cmp_ge_u32 s59, 64
    s_cbranch_scc1 L_nocs
    s_mov_b32 s64, s4
    s_mov_b32 s65, s5
    s_mov_b32 s66, 6144
    s_mov_b32 s67, 0x20000
    s_mov_b32 s68, s18
    s_mov_b32 s69, s19
    s_mov_b32 s70, 6144
    s_mov_b32 s71, 0x20000
    v_and_b32 v1, 1, v0
    v_bfe_u32 v2, v0, 1, 1
    s_bfe_u32 s57, s2, 0x10003
    s_lshr_b32 s56, s59, 4
    s_lshl2_add_u32 s56, s56, s57
    s_add_u32 s56, s56, s57
    v_add_u32 v2, s56, v2
    v_lshlrev_b32 v252, 2, v2
    v_lshrrev_b32 v3, 4, v0
    v_mad_u32_u24 v3, v1, 3, v3
    v_lshrrev_b32 v4, 1, v3
    v_and_b32 v3, 1, v3
    v_lshlrev_b32 v3, 2, v3
    v_lshl_add_u32 v3, v4, 5, v3
    v_bfe_u32 v4, v0, 3, 1
    v_lshl_add_u32 v3, v4, 1, v3
    v_mul_u32_u24 v2, 384, v2
    s_bfe_u32 s56, s59, 0x20002
    s_mul_i32 s56, s56, 96
    s_and_b32 s57, s59, 3
    s_lshl_b32 s57, s57, 3
    s_add_u32 s56, s56, s57
    v_add3_u32 v248, s56, v2, v3
    v_and_b32 v3, 4, v0
    v_cmp_eq_u32 vcc, 4, v3
    s_nop 1
    v_cndmask_b32 v3, 63, v0, vcc
    v_cmp_gt_u32 vcc, 48, v3
    v_mov_b32 v4, 0x10000
    s_lshl_b32 s56, s3, 2
    v_cndmask_b32 v248, v4, v248, vcc
    buffer_load_ushort v249, v248, s[64:67], 0 offen
    s_xor_b32 s59, s2, 64
    s_or_b32 s57, s59, s3
    s_cselect_b32 s70, 0, 6144
    v_lshlrev_b32 v4, 7, v0
    buffer_load_ushort v246, v4, s[68:71], 0 offen
    v_add_u32 v250, s56, v65
    v_and_b32 v251, 0x70, v65
L_nocs:
    s_waitcnt vmcnt(5)
    buffer_load_dwordx4 v24, s[24:27], s58 offen offset:2048 nt lds
    s_waitcnt vmcnt(5)
    buffer_load_dwordx4 v25, s[24:27], s58 offen offset:3072 nt lds
    s_waitcnt vmcnt(5)
    s_add_u32 m0, s41, 4096
    s_nop 0
    buffer_load_dwordx4 v26, s[24:27], s58 offen offset:0 nt lds
    s_waitcnt vmcnt(5)
    buffer_load_dwordx4 v27, s[24:27], s58 offen offset:1024 nt lds
    s_waitcnt vmcnt(5)
    buffer_load_dwordx4 v28, s[24:27], s58 offen offset:2048 nt lds
    s_waitcnt vmcnt(5)
    buffer_load_dwordx4 v29, s[24:27], s58 offen offset:3072 nt lds
    s_waitcnt vmcnt(5)
    s_add_u32 m0, s41, 8192
    s_nop 0
    buffer_load_dwordx4 v30, s[24:27], s58 offen offset:0 nt lds
    s_waitcnt vmcnt(5)
    buffer_load_dwordx4 v31, s[24:27], s58 offen offset:1024 nt lds
    s_waitcnt vmcnt(5)
    buffer_load_dwordx4 v32, s[24:27], s58 offen offset:2048 nt lds
    s_waitcnt vmcnt(11)
    s_waitcnt lgkmcnt(0)
    s_barrier
    ds_read_b128 a[48:51], v34 offset:0
    ds_read_b128 a[52:55], v35 offset:0
    ds_read_b128 a[56:59], v34 offset:128
    ds_read_b128 a[60:63], v35 offset:128
    ds_read_b128 a[64:67], v34 offset:256
    ds_read_b128 a[68:71], v35 offset:256
    s_waitcnt lgkmcnt(5)
    v_mfma_f32_16x16x32_bf16 v[84:87], a[48:51], a[48:51], 0
    s_waitcnt vmcnt(5)
    buffer_load_dwordx4 v33, s[24:27], s58 offen offset:3072 nt lds
    ds_read_b64_tr_b16 a[72:73], v36 offset:0
    ds_read_b64_tr_b16 a[74:75], v36 offset:6144
    v_mfma_f32_16x16x32_bf16 v[80:83], a[48:51], v[52:55], 0
    s_waitcnt vmcnt(5)
    s_add_u32 m0, s42, 0
    s_add_u32 s59, s37, 196608
    buffer_load_dwordx4 v22, s[24:27], s59 offen offset:0 nt lds
    ds_read_b64_tr_b16 a[76:77], v36 offset:12288
    ds_read_b64_tr_b16 a[78:79], v36 offset:18432
    s_waitcnt lgkmcnt(8)
    v_mfma_f32_16x16x32_bf16 v[84:87], a[52:55], a[52:55], v[84:87]
    s_waitcnt vmcnt(5)
    buffer_load_dwordx4 v23, s[24:27], s59 offen offset:1024 nt lds
    ds_read_b64_tr_b16 a[80:81], v37 offset:0
    ds_read_b64_tr_b16 a[82:83], v37 offset:6144
    v_mfma_f32_16x16x32_bf16 v[80:83], a[52:55], v[52:55], v[80:83]
    ds_read_b64_tr_b16 a[84:85], v37 offset:12288
    ds_read_b64_tr_b16 a[86:87], v37 offset:18432
    s_waitcnt lgkmcnt(11)
    v_mfma_f32_16x16x32_bf16 v[84:87], a[56:59], a[56:59], v[84:87]
    ds_read_b64_tr_b16 a[88:89], v38 offset:0
    ds_read_b64_tr_b16 a[90:91], v38 offset:6144
    v_mfma_f32_16x16x32_bf16 v[80:83], a[56:59], v[52:55], v[80:83]
    ds_read_b64_tr_b16 a[92:93], v38 offset:12288
    ds_read_b64_tr_b16 a[94:95], v38 offset:18432
    s_waitcnt lgkmcnt(14)
    v_mfma_f32_16x16x32_bf16 v[84:87], a[60:63], a[60:63], v[84:87]
    v_mfma_f32_16x16x32_bf16 v[80:83], a[60:63], v[52:55], v[80:83]
    s_waitcnt lgkmcnt(13)
    v_mfma_f32_16x16x32_bf16 v[84:87], a[64:67], a[64:67], v[84:87]
    v_mfma_f32_16x16x32_bf16 v[80:83], a[64:67], v[52:55], v[80:83]
    s_waitcnt vmcnt(5)
    buffer_load_dwordx4 v24, s[24:27], s59 offen offset:2048 nt lds
    s_waitcnt lgkmcnt(12)
    v_mfma_f32_16x16x32_bf16 v[84:87], a[68:71], a[68:71], v[84:87]
    v_mfma_f32_16x16x32_bf16 v[80:83], a[68:71], v[52:55], v[80:83]
    s_waitcnt lgkmcnt(0)
    s_mul_i32 s39, s38, 0x9e3779b1
    s_add_u32 s39, s39, 0x7f4a7c16
    s_or_b32 s39, s39, 1
    s_waitcnt vmcnt(5)
    buffer_load_dwordx4 v25, s[24:27], s59 offen offset:3072 nt lds
    s_waitcnt vmcnt(5)
    s_add_u32 m0, s42, 4096
    s_nop 0
    buffer_load_dwordx4 v26, s[24:27], s59 offen offset:0 nt lds
    s_waitcnt vmcnt(5)
    buffer_load_dwordx4 v27, s[24:27], s59 offen offset:1024 nt lds
    s_waitcnt vmcnt(5)
    buffer_load_dwordx4 v28, s[24:27], s59 offen offset:2048 nt lds
    s_waitcnt vmcnt(5)
    buffer_load_dwordx4 v29, s[24:27], s59 offen offset:3072 nt lds
    s_waitcnt vmcnt(5)
    s_add_u32 m0, s42, 8192
    s_nop 0
    buffer_load_dwordx4 v30, s[24:27], s59 offen offset:0 nt lds
    s_waitcnt vmcnt(5)
    buffer_load_dwordx4 v31, s[24:27], s59 offen offset:1024 nt lds
    s_waitcnt vmcnt(5)
    buffer_load_dwordx4 v32, s[24:27], s59 offen offset:2048 nt lds
    s_mul_i32 s56, s3, 3072
    s_add_u32 s56, s56, 16384
    buffer_load_dwordx4 v[136:139], v65, s[32:35], s56 offen offset:0 sc1
    buffer_load_dwordx4 v[140:143], v65, s[32:35], s56 offen offset:1024 sc1
    buffer_load_dwordx4 v[144:147], v65, s[32:35], s56 offen offset:2048 sc1
L_join:
    s_mul_i32 s60, s3, 18432
    s_mov_b32 s72, s22
    s_mov_b32 s73, s23
    s_mov_b32 s74, 16777216
    s_mov_b32 s75, 0x20000
    s_cmp_eq_u32 s0, 1
    s_cselect_b32 s74, 0, s74
    s_waitcnt vmcnt(14)
    s_barrier
    ds_read_b128 a[96:99], v40 offset:0
    ds_read_b128 a[100:103], v41 offset:0
    ds_read_b128 a[104:107], v42 offset:0
    ds_read_b128 a[108:111], v43 offset:0
    ds_read_b128 a[112:115], v40 offset:256
    ds_read_b128 a[116:119], v41 offset:256
    ds_read_b128 a[120:123], v42 offset:256
    ds_read_b128 a[124:127], v43 offset:256
    ds_read_b128 a[128:131], v40 offset:512
    ds_read_b128 a[132:135], v41 offset:512
    ds_read_b128 a[136:139], v42 offset:512
    ds_read_b128 a[140:143], v43 offset:512
    ds_read_b64_tr_b16 a[144:145], v44 offset:0
    ds_read_b64_tr_b16 a[146:147], v45 offset:0
    ds_read_b64_tr_b16 a[148:149], v44 offset:12288
    ds_read_b64_tr_b16 a[150:151], v45 offset:12288
    ds_read_b64_tr_b16 a[152:153], v44 offset:24576
    ds_read_b64_tr_b16 a[154:155], v45 offset:24576
    ds_read_b64_tr_b16 a[156:157], v44 offset:36864
    ds_read_b64_tr_b16 a[158:159], v45 offset:36864
    ds_read_b64_tr_b16 a[160:161], v46 offset:0
    ds_read_b64_tr_b16 a[162:163], v47 offset:0
    ds_read_b64_tr_b16 a[164:165], v46 offset:12288
    ds_read_b64_tr_b16 a[166:167], v47 offset:12288
    ds_read_b64_tr_b16 a[168:169], v46 offset:24576
    ds_read_b64_tr_b16 a[170:171], v47 offset:24576
    ds_read_b64_tr_b16 a[172:173], v46 offset:36864
    ds_read_b64_tr_b16 a[174:175], v47 offset:36864
    ds_read_b64_tr_b16 a[176:177], v48 offset:0
    ds_read_b64_tr_b16 a[178:179], v49 offset:0
    ds_read_b64_tr_b16 a[180:181], v48 offset:12288
    ds_read_b64_tr_b16 a[182:183], v49 offset:12288
    ds_read_b64_tr_b16 a[184:185], v48 offset:24576
    ds_read_b64_tr_b16 a[186:187], v49 offset:24576
    ds_read_b64_tr_b16 a[188:189], v48 offset:36864
    ds_read_b64_tr_b16 a[190:191], v49 offset:36864
    s_memrealtime s[14:15]
    s_waitcnt lgkmcnt(0)
    s_barrier
    s_cmp_ge_u32 s43, 3
    s_cbranch_scc1 L_v_nofl
    s_mul_i32 s56, s3, 3
    s_add_u32 s56, s56, s43
    s_lshl_b32 s56, s56, 7
    v_mov_b32 v1, s39
    v_mov_b32 v2, 0
    s_mov_b64 exec, 1
    s_waitcnt vmcnt(8)
    buffer_store_dword v1, v2, s[32:35], s56 offen offset:128 sc1
    s_mov_b64 exec, -1
L_v_nofl:
    s_cmp_eq_u32 s98, 1
    s_cbranch_scc0 L_nopub
    s_lshl_b32 s56, s2, 4
    v_mov_b32 v2, s39
    v_mov_b32 v3, s20
    v_mov_b32 v1, 0
    s_mov_b64 exec, 1
    buffer_store_dwordx2 v[2:3], v1, s[32:35], s56 offen offset:1648 sc1
    s_mov_b64 exec, -1
L_nopub:
    s_lshl2_add_u32 s15, s2, s3
    s_sub_u32 s15, s15, 240
    s_and_b32 s16, s15, 0xffffffe3
    s_cbranch_scc1 L_nolc
    s_add_u32 s15, s15, 32
    v_mov_b32 v244, s14
    s_mov_b64 exec, 1
    buffer_store_dword v244, off, s[32:35], s15 sc1
    s_mov_b64 exec, -1
L_nolc:
    v_mfma_f32_16x16x32_bf16 v[96:99], a[96:99], a[96:99], v[84:87]
    s_cmp_eq_u32 s0, 0
    s_cbranch_scc0 L_g24
    s_waitcnt vmcnt(9)
L_g24:
    s_add_u32 m0, s42, 8192
    s_add_u32 s59, s37, 196608
    buffer_load_dwordx4 v33, s[24:27], s59 offen offset:3072 nt lds
    v_add_u32 v44, 49152, v44
    v_add_u32 v45, 49152, v45
    v_mfma_f32_16x16x32_bf16 v[100:103], a[96:99], a[48:51], 0
    s_cmp_eq_u32 s0, 0
    s_cbranch_scc0 L_g25
    s_waitcnt vmcnt(9)
L_g25:
    s_add_u32 m0, s40, 0
    s_add_u32 s57, s36, 6291456
    buffer_load_dwordx4 v16, s[28:31], s57 offen offset:0 nt lds
    v_add_u32 v46, 49152, v46
    v_add_u32 v47, 49152, v47
    v_mfma_f32_16x16x32_bf16 v[96:99], a[100:103], a[100:103], v[96:99]
    v_add_u32 v48, 49152, v48
    v_add_u32 v49, 49152, v49
    v_mfma_f32_16x16x32_bf16 v[100:103], a[100:103], a[52:55], v[100:103]
    v_mfma_f32_16x16x32_bf16 v[96:99], a[104:107], a[104:107], v[96:99]
    v_mfma_f32_16x16x32_bf16 v[100:103], a[104:107], a[56:59], v[100:103]
    v_mfma_f32_16x16x32_bf16 v[96:99], a[108:111], a[108:111], v[96:99]
    v_mfma_f32_16x16x32_bf16 v[100:103], a[108:111], a[60:63], v[100:103]
    v_mfma_f32_16x16x32_bf16 v[96:99], a[112:115], a[112:115], v[96:99]
    v_mfma_f32_16x16x32_bf16 v[100:103], a[112:115], a[64:67], v[100:103]
    v_mfma_f32_16x16x32_bf16 v[96:99], a[116:119], a[116:119], v[96:99]
    v_mfma_f32_16x16x32_bf16 v[100:103], a[116:119], a[68:71], v[100:103]
    v_mfma_f32_16x16x32_bf16 v[92:95], a[96:99], v[52:55], v[80:83]
    s_cmp_eq_u32 s0, 0
    s_cbranch_scc0 L_g26
    s_waitcnt vmcnt(9)
L_g26:
    buffer_load_dwordx4 v17, s[28:31], s57 offen offset:1024 nt lds
    v_mfma_f32_16x16x32_bf16 v[92:95], a[100:103], v[52:55], v[92:95]
    v_mfma_f32_16x16x32_bf16 v[92:95], a[104:107], v[52:55], v[92:95]
    v_mfma_f32_16x16x32_bf16 v[92:95], a[108:111], v[52:55], v[92:95]
    v_fma_f32 v96, v100, 2.0, v96
    v_fma_f32 v97, v101, 2.0, v97
    v_mfma_f32_16x16x32_bf16 v[92:95], a[112:115], v[52:55], v[92:95]
    v_fma_f32 v98, v102, 2.0, v98
    v_fma_f32 v99, v103, 2.0, v99
    v_mfma_f32_16x16x32_bf16 v[92:95], a[116:119], v[52:55], v[92:95]
    v_cndmask_b32 v3, 0, v96, s[44:45]
    v_cndmask_b32 v3, v3, v97, s[46:47]
    v_mfma_f32_16x16x32_bf16 v[112:115], a[120:123], a[120:123], v[84:87]
    v_cndmask_b32 v3, v3, v98, s[48:49]
    v_cndmask_b32 v3, v3, v99, s[50:51]
    v_mfma_f32_16x16x32_bf16 v[116:119], a[120:123], a[48:51], 0
    s_nop 0
    s_nop 0
    v_mfma_f32_16x16x32_bf16 v[112:115], a[124:127], a[124:127], v[112:115]
    v_mfma_f32_16x16x4_f32 v[120:123], v3, v60, v[56:59]
    v_mfma_f32_16x16x32_bf16 v[116:119], a[124:127], a[52:55], v[116:119]
    v_mfma_f32_16x16x32_bf16 v[112:115], a[128:131], a[128:131], v[112:115]
    v_mfma_f32_16x16x32_bf16 v[116:119], a[128:131], a[56:59], v[116:119]
    s_cmp_eq_u32 s0, 0
    s_cbranch_scc0 L_g27
    s_waitcnt vmcnt(9)
L_g27:
    buffer_load_dwordx4 v18, s[28:31], s57 offen offset:2048 nt lds
    v_mfma_f32_16x16x32_bf16 v[112:115], a[132:135], a[132:135], v[112:115]
    s_nop 1
    v_fma_f32 v128, -v92, v92, v120
    v_fma_f32 v129, -v93, v93, v121
    v_mfma_f32_16x16x32_bf16 v[116:119], a[132:135], a[60:63], v[116:119]
    v_fma_f32 v130, -v94, v94, v122
    v_fma_f32 v131, -v95, v95, v123
    v_mfma_f32_16x16x32_bf16 v[112:115], a[136:139], a[136:139], v[112:115]
    v_max_f32 v128, v128, v56
    v_max_f32 v129, v129, v56
    v_mfma_f32_16x16x32_bf16 v[116:119], a[136:139], a[64:67], v[116:119]
    v_max_f32 v130, v130, v56
    v_max_f32 v131, v131, v56
    v_mfma_f32_16x16x32_bf16 v[112:115], a[140:143], a[140:143], v[112:115]
    v_rsq_f32 v128, v128
    v_mfma_f32_16x16x32_bf16 v[116:119], a[140:143], a[68:71], v[116:119]
    v_rsq_f32 v129, v129
    v_mfma_f32_16x16x32_bf16 v[108:111], a[120:123], v[52:55], v[80:83]
    v_rsq_f32 v130, v130
    v_mfma_f32_16x16x32_bf16 v[108:111], a[124:127], v[52:55], v[108:111]
    v_rsq_f32 v131, v131
    v_mfma_f32_16x16x32_bf16 v[108:111], a[128:131], v[52:55], v[108:111]
    v_mfma_f32_16x16x32_bf16 v[108:111], a[132:135], v[52:55], v[108:111]
    v_mfma_f32_16x16x32_bf16 v[108:111], a[136:139], v[52:55], v[108:111]
    v_fma_f32 v112, v116, 2.0, v112
    v_fma_f32 v113, v117, 2.0, v113
    v_mfma_f32_16x16x32_bf16 v[108:111], a[140:143], v[52:55], v[108:111]
    s_cmp_eq_u32 s0, 0
    s_cbranch_scc0 L_g28
    s_waitcnt vmcnt(9)
L_g28:
    buffer_load_dwordx4 v19, s[28:31], s57 offen offset:3072 nt lds
    v_fma_f32 v114, v118, 2.0, v114
    v_fma_f32 v115, v119, 2.0, v115
    v_cndmask_b32 v4, 0, v112, s[44:45]
    v_cndmask_b32 v4, v4, v113, s[46:47]
    v_cndmask_b32 v4, v4, v114, s[48:49]
    v_cndmask_b32 v4, v4, v115, s[50:51]
    s_nop 0
    s_nop 0
    v_mfma_f32_16x16x4_f32 v[124:127], v4, v60, v[56:59]
    s_nop 9
    v_fma_f32 v132, -v108, v108, v124
    v_fma_f32 v133, -v109, v109, v125
    v_fma_f32 v134, -v110, v110, v126
    v_fma_f32 v135, -v111, v111, v127
    v_max_f32 v132, v132, v56
    v_max_f32 v133, v133, v56
    v_max_f32 v134, v134, v56
    v_max_f32 v135, v135, v56
    v_rsq_f32 v132, v132
    v_rsq_f32 v133, v133
    v_rsq_f32 v134, v134
    v_rsq_f32 v135, v135
    s_mul_i32 s56, s3, 1536
    v_lshlrev_b32 v5, 3, v0
    v_add_u32 v5, 153600, v5
    v_add_u32 v4, s56, v5
    s_cmp_eq_u32 s0, 0
    s_cbranch_scc0 L_g29
    s_waitcnt vmcnt(9)
L_g29:
    s_add_u32 m0, s40, 4096
    s_nop 0
    buffer_load_dwordx4 v20, s[28:31], s57 offen offset:0 nt lds
    s_cmp_eq_u32 s0, 0
    s_cbranch_scc0 L_g30
    s_waitcnt vmcnt(5)
L_g30:
    buffer_load_dwordx4 v21, s[28:31], s57 offen offset:1024 nt lds
    s_cmp_eq_u32 s0, 0
    s_cbranch_scc0 L_g31
    s_waitcnt vmcnt(5)
L_g31:
    s_add_u32 m0, s41, 0
    s_add_u32 s58, s37, 25165824
    buffer_load_dwordx4 v22, s[24:27], s58 offen offset:0 nt lds
    s_cmp_eq_u32 s0, 0
    s_cbranch_scc0 L_g32
    s_waitcnt vmcnt(5)
L_g32:
    buffer_load_dwordx4 v23, s[24:27], s58 offen offset:1024 nt lds
    s_cmp_eq_u32 s0, 0
    s_cbranch_scc0 L_g33
    s_waitcnt vmcnt(5)
L_g33:
    buffer_load_dwordx4 v24, s[24:27], s58 offen offset:2048 nt lds
    s_cmp_eq_u32 s0, 0
    s_cbranch_scc0 L_g34
    s_waitcnt vmcnt(5)
L_g34:
    buffer_load_dwordx4 v25, s[24:27], s58 offen offset:3072 nt lds
    s_waitcnt vmcnt(11)
    v_xor_b32 v1, s39, v138
    v_xor_b32 v2, s39, v142
    v_xor_b32 v3, s39, v146
    v_or3_b32 v1, v1, v2, v3
    v_cmp_ne_u32 vcc, 0, v1
    s_cbranch_vccnz L_qk_retry
L_qk_ok:
    ds_write_b64 v4, v[136:137] offset:0
    ds_write_b64 v4, v[140:141] offset:512
    ds_write_b64 v4, v[144:145] offset:1024
    s_waitcnt lgkmcnt(0)
    s_barrier
    ds_read2st64_b64 v[136:139], v5 offset0:0 offset1:1
    ds_read2st64_b64 v[140:143], v5 offset0:2 offset1:3
    ds_read2st64_b64 v[144:147], v5 offset0:4 offset1:5
    ds_read2st64_b64 v[148:151], v5 offset0:6 offset1:7
    ds_read2st64_b64 v[152:155], v5 offset0:8 offset1:9
    ds_read2st64_b64 v[156:159], v5 offset0:10 offset1:11
    s_waitcnt lgkmcnt(5)
    v_mfma_f32_16x16x32_bf16 v[120:123], v[52:55], v[136:139], 0
    v_mfma_f32_16x16x32_bf16 v[76:79], a[48:51], v[136:139], 0
    s_waitcnt lgkmcnt(4)
    v_mfma_f32_16x16x32_bf16 v[120:123], v[52:55], v[140:143], v[120:123]
    v_mfma_f32_16x16x32_bf16 v[76:79], a[52:55], v[140:143], v[76:79]
    s_waitcnt lgkmcnt(3)
    v_mfma_f32_16x16x32_bf16 v[120:123], v[52:55], v[144:147], v[120:123]
    v_mfma_f32_16x16x32_bf16 v[76:79], a[56:59], v[144:147], v[76:79]
    s_waitcnt lgkmcnt(2)
    v_mfma_f32_16x16x32_bf16 v[120:123], v[52:55], v[148:151], v[120:123]
    v_mfma_f32_16x16x32_bf16 v[76:79], a[60:63], v[148:151], v[76:79]
    s_waitcnt lgkmcnt(1)
    v_mfma_f32_16x16x32_bf16 v[120:123], v[52:55], v[152:155], v[120:123]
    v_mfma_f32_16x16x32_bf16 v[76:79], a[64:67], v[152:155], v[76:79]
    s_waitcnt lgkmcnt(0)
    v_mfma_f32_16x16x32_bf16 v[120:123], v[52:55], v[156:159], v[120:123]
    s_cmp_eq_u32 s0, 0
    s_cbranch_scc0 L_g35
    s_waitcnt vmcnt(5)
L_g35:
    s_add_u32 m0, s41, 4096
    s_nop 0
    buffer_load_dwordx4 v26, s[24:27], s58 offen offset:0 nt lds
    v_mfma_f32_16x16x32_bf16 v[76:79], a[68:71], v[156:159], v[76:79]
    s_nop 0
    v_mul_f32 v61, 0x3baaaaab, v120
    v_mfma_f32_16x16x32_bf16 v[88:91], a[96:99], v[136:139], v[76:79]
    v_mov_b32 v9, 0
    v_mfma_f32_16x16x32_bf16 v[88:91], a[100:103], v[140:143], v[88:91]
    v_mfma_f32_16x16x32_bf16 v[88:91], a[104:107], v[144:147], v[88:91]
    v_mfma_f32_16x16x32_bf16 v[88:91], a[108:111], v[148:151], v[88:91]
    v_mfma_f32_16x16x32_bf16 v[88:91], a[112:115], v[152:155], v[88:91]
    v_mfma_f32_16x16x32_bf16 v[88:91], a[116:119], v[156:159], v[88:91]
    ds_write_b32 v254, v9 offset:4096
    ds_write_b32 v254, v9 offset:4100
    v_mfma_f32_16x16x32_bf16 v[104:107], a[120:123], v[136:139], v[76:79]
    v_mfma_f32_16x16x32_bf16 v[104:107], a[124:127], v[140:143], v[104:107]
    v_mfma_f32_16x16x32_bf16 v[104:107], a[128:131], v[144:147], v[104:107]
    v_mfma_f32_16x16x32_bf16 v[104:107], a[132:135], v[148:151], v[104:107]
    s_nop 1
    v_fma_f32 v88, -v92, v61, v88
    v_fma_f32 v89, -v93, v61, v89
    v_mfma_f32_16x16x32_bf16 v[104:107], a[136:139], v[152:155], v[104:107]
    v_fma_f32 v90, -v94, v61, v90
    v_fma_f32 v91, -v95, v61, v91
    v_mfma_f32_16x16x32_bf16 v[104:107], a[140:143], v[156:159], v[104:107]
    v_and_b32 v244, 7, v0
    v_lshlrev_b32 v244, 2, v244
    v_or_b32 v244, 0x20, v244
    buffer_load_dword v244, v244, s[32:35], 0 offen sc1
    s_cmp_eq_u32 s0, 0
    s_cbranch_scc0 L_g36
    s_waitcnt vmcnt(6)
L_g36:
    buffer_load_dwordx4 v27, s[24:27], s58 offen offset:1024 nt lds
    v_mul_f32 v88, v88, v128
    v_mul_f32 v89, v89, v129
    v_mul_f32 v90, v90, v130
    v_mul_f32 v91, v91, v131
    v_max3_f32 v1, v88, v89, v90
    v_max_f32 v1, v1, v91
    v_fma_f32 v104, -v108, v61, v104
    v_fma_f32 v105, -v109, v61, v105
    v_fma_f32 v106, -v110, v61, v106
    v_fma_f32 v107, -v111, v61, v107
    v_mul_f32 v104, v104, v132
    v_mul_f32 v105, v105, v133
    v_mul_f32 v106, v106, v134
    v_mul_f32 v107, v107, v135
    v_max3_f32 v1, v1, v104, v105
    v_max3_f32 v1, v1, v106, v107
    v_mov_b32 v2, v1
    s_nop 1
    v_permlane32_swap_b32 v1, v2
    v_max_f32 v1, v1, v2
    v_mov_b32 v2, v1
    s_nop 1
    v_permlane16_swap_b32 v1, v2
    v_max_f32 v1, v1, v2
    ds_write_b32 v239, v1
    s_waitcnt lgkmcnt(0)
    s_barrier
    ds_read_b32 v12, v240 offset:0
    ds_read_b32 v13, v240 offset:1024
    ds_read_b32 v14, v240 offset:2048
    ds_read_b32 v15, v240 offset:3072
    s_cmp_eq_u32 s0, 0
    s_cbranch_scc0 L_g37
    s_waitcnt vmcnt(6)
L_g37:
    buffer_load_dwordx4 v28, s[24:27], s58 offen offset:2048 nt lds
    s_waitcnt lgkmcnt(0)
    v_max3_f32 v1, v12, v13, v14
    v_max_f32 v1, v1, v15
    v_sub_f32 v88, v88, v1
    v_sub_f32 v89, v89, v1
    v_sub_f32 v90, v90, v1
    v_sub_f32 v91, v91, v1
    v_sub_f32 v104, v104, v1
    v_sub_f32 v105, v105, v1
    v_sub_f32 v106, v106, v1
    v_sub_f32 v107, v107, v1
    v_sub_f32 v62, 0, v1
    v_sub_f32 v255, 0, v1
    v_exp_f32 v96, v88
    v_exp_f32 v97, v89
    v_exp_f32 v98, v90
    v_exp_f32 v99, v91
    v_mul_f32 v88, v96, v128
    v_mul_f32 v89, v97, v129
    v_mul_f32 v90, v98, v130
    v_mul_f32 v91, v99, v131
    v_exp_f32 v112, v104
    v_exp_f32 v113, v105
    v_exp_f32 v114, v106
    v_exp_f32 v115, v107
    v_cvt_pk_bf16_f32 v72, v88, v89
    v_cvt_pk_bf16_f32 v73, v90, v91
    v_mul_f32 v104, v112, v132
    v_mul_f32 v105, v113, v133
    v_mul_f32 v106, v114, v134
    v_mul_f32 v107, v115, v135
    v_cvt_pk_bf16_f32 v74, v104, v105
    v_cvt_pk_bf16_f32 v75, v106, v107
    ds_write_b128 v237, v[72:75] offset:0
    v_mov_b32 v63, v96
    v_mul_f32 v64, v88, v92
    v_add_f32 v63, v63, v97
    v_fmac_f32 v64, v89, v93
    v_add_f32 v63, v63, v98
    v_fmac_f32 v64, v90, v94
    v_add_f32 v63, v63, v99
    v_fmac_f32 v64, v91, v95
    v_mov_b32 v68, v88
    v_mov_b32 v69, v89
    v_mov_b32 v70, v90
    v_mov_b32 v71, v91
    s_waitcnt lgkmcnt(0)
    s_barrier
    ds_read_b128 v[92:95], v253 offset:0
    ds_read_b128 v[96:99], v253 offset:1024
    ds_read_b128 v[100:103], v253 offset:2048
    ds_read_b128 v[116:119], v253 offset:3072
    s_waitcnt lgkmcnt(3)
    v_mfma_f32_16x16x32_bf16 a[0:3], a[144:147], v[92:95], 0
    s_cmp_eq_u32 s0, 0
    s_cbranch_scc0 L_g38
    s_waitcnt vmcnt(6)
L_g38:
    buffer_load_dwordx4 v29, s[24:27], s58 offen offset:3072 nt lds
    v_add_f32 v68, v68, v104
    v_add_f32 v69, v69, v105
    v_mfma_f32_16x16x32_bf16 a[4:7], a[160:163], v[92:95], 0
    s_cmp_eq_u32 s0, 0
    s_cbranch_scc0 L_g39
    s_waitcnt vmcnt(6)
L_g39:
    s_add_u32 m0, s41, 8192
    s_nop 0
    buffer_load_dwordx4 v30, s[24:27], s58 offen offset:0 nt lds
    v_add_f32 v70, v70, v106
    v_add_f32 v71, v71, v107
    v_mfma_f32_16x16x32_bf16 a[8:11], a[176:179], v[92:95], 0
    v_add_f32 v63, v63, v112
    v_fma_f32 v64, v104, v108, v64
    s_waitcnt lgkmcnt(2)
    v_mfma_f32_16x16x32_bf16 a[0:3], a[148:151], v[96:99], a[0:3]
    v_add_f32 v63, v63, v113
    v_fma_f32 v64, v105, v109, v64
    v_mfma_f32_16x16x32_bf16 a[4:7], a[164:167], v[96:99], a[4:7]
    v_add_f32 v63, v63, v114
    v_fma_f32 v64, v106, v110, v64
    v_mfma_f32_16x16x32_bf16 a[8:11], a[180:183], v[96:99], a[8:11]
    s_cmp_eq_u32 s0, 0
    s_cbranch_scc0 L_g40
    s_waitcnt vmcnt(6)
L_g40:
    buffer_load_dwordx4 v31, s[24:27], s58 offen offset:1024 nt lds
    v_add_f32 v63, v63, v115
    v_fma_f32 v64, v107, v111, v64
    s_waitcnt lgkmcnt(1)
    v_mfma_f32_16x16x32_bf16 a[0:3], a[152:155], v[100:103], a[0:3]
    v_mfma_f32_16x16x32_bf16 a[4:7], a[168:171], v[100:103], a[4:7]
    v_mfma_f32_16x16x32_bf16 a[8:11], a[184:187], v[100:103], a[8:11]
    s_waitcnt lgkmcnt(0)
    v_mfma_f32_16x16x32_bf16 a[0:3], a[156:159], v[116:119], a[0:3]
    v_mfma_f32_16x16x32_bf16 a[4:7], a[172:175], v[116:119], a[4:7]
    v_mfma_f32_16x16x32_bf16 a[8:11], a[188:191], v[116:119], a[8:11]
    s_waitcnt vmcnt(17)
    s_barrier
    s_memrealtime s[14:15]
    ds_read_b128 a[96:99], v40 offset:49152
    ds_read_b128 a[100:103], v41 offset:49152
    ds_read_b128 a[104:107], v42 offset:49152
    ds_read_b128 a[108:111], v43 offset:49152
    ds_read_b128 a[112:115], v40 offset:49408
    ds_read_b128 a[116:119], v41 offset:49408
    ds_read_b128 a[120:123], v42 offset:49408
    ds_read_b128 a[124:127], v43 offset:49408
    ds_read_b128 a[128:131], v40 offset:49664
    ds_read_b128 a[132:135], v41 offset:49664
    ds_read_b128 a[136:139], v42 offset:49664
    ds_read_b128 a[140:143], v43 offset:49664
    s_waitcnt lgkmcnt(0)
    v_mfma_f32_16x16x32_bf16 v[96:99], a[96:99], a[96:99], v[84:87]
    s_cmp_eq_u32 s0, 0
    s_cbranch_scc0 L_g41
    s_waitcnt vmcnt(6)
L_g41:
    buffer_load_dwordx4 v32, s[24:27], s58 offen offset:2048 nt lds
    ds_read_b64_tr_b16 a[144:145], v44 offset:0
    ds_read_b64_tr_b16 a[146:147], v45 offset:0
    v_mfma_f32_16x16x32_bf16 v[100:103], a[96:99], a[48:51], 0
    s_cmp_eq_u32 s0, 0
    s_cbranch_scc0 L_g42
    s_waitcnt vmcnt(5)
L_g42:
    buffer_load_dwordx4 v33, s[24:27], s58 offen offset:3072 nt lds
    ds_read_b64_tr_b16 a[148:149], v44 offset:12288
    ds_read_b64_tr_b16 a[150:151], v45 offset:12288
    v_mfma_f32_16x16x32_bf16 v[96:99], a[100:103], a[100:103], v[96:99]
    ds_read_b64_tr_b16 a[152:153], v44 offset:24576
    ds_read_b64_tr_b16 a[154:155], v45 offset:24576
    v_mfma_f32_16x16x32_bf16 v[100:103], a[100:103], a[52:55], v[100:103]
    ds_read_b64_tr_b16 a[156:157], v44 offset:36864
    ds_read_b64_tr_b16 a[158:159], v45 offset:36864
    v_mfma_f32_16x16x32_bf16 v[96:99], a[104:107], a[104:107], v[96:99]
    ds_read_b64_tr_b16 a[160:161], v46 offset:0
    ds_read_b64_tr_b16 a[162:163], v47 offset:0
    v_mfma_f32_16x16x32_bf16 v[100:103], a[104:107], a[56:59], v[100:103]
    ds_read_b64_tr_b16 a[164:165], v46 offset:12288
    ds_read_b64_tr_b16 a[166:167], v47 offset:12288
    v_mfma_f32_16x16x32_bf16 v[96:99], a[108:111], a[108:111], v[96:99]
    ds_read_b64_tr_b16 a[168:169], v46 offset:24576
    ds_read_b64_tr_b16 a[170:171], v47 offset:24576
    v_mfma_f32_16x16x32_bf16 v[100:103], a[108:111], a[60:63], v[100:103]
    ds_read_b64_tr_b16 a[172:173], v46 offset:36864
    ds_read_b64_tr_b16 a[174:175], v47 offset:36864
    v_mfma_f32_16x16x32_bf16 v[96:99], a[112:115], a[112:115], v[96:99]
    ds_read_b64_tr_b16 a[176:177], v48 offset:0
    ds_read_b64_tr_b16 a[178:179], v49 offset:0
    v_mfma_f32_16x16x32_bf16 v[100:103], a[112:115], a[64:67], v[100:103]
    ds_read_b64_tr_b16 a[180:181], v48 offset:12288
    ds_read_b64_tr_b16 a[182:183], v49 offset:12288
    v_mfma_f32_16x16x32_bf16 v[96:99], a[116:119], a[116:119], v[96:99]
    ds_read_b64_tr_b16 a[184:185], v48 offset:24576
    ds_read_b64_tr_b16 a[186:187], v49 offset:24576
    v_mfma_f32_16x16x32_bf16 v[100:103], a[116:119], a[68:71], v[100:103]
    ds_read_b64_tr_b16 a[188:189], v48 offset:36864
    ds_read_b64_tr_b16 a[190:191], v49 offset:36864
    v_mfma_f32_16x16x32_bf16 v[92:95], a[96:99], v[52:55], v[80:83]
    v_mfma_f32_16x16x32_bf16 v[92:95], a[100:103], v[52:55], v[92:95]
    v_mfma_f32_16x16x32_bf16 v[92:95], a[104:107], v[52:55], v[92:95]
    v_mfma_f32_16x16x32_bf16 v[92:95], a[108:111], v[52:55], v[92:95]
    s_nop 1
    v_fma_f32 v96, v100, 2.0, v96
    v_fma_f32 v97, v101, 2.0, v97
    v_mfma_f32_16x16x32_bf16 v[92:95], a[112:115], v[52:55], v[92:95]
    v_fma_f32 v98, v102, 2.0, v98
    v_fma_f32 v99, v103, 2.0, v99
    v_mfma_f32_16x16x32_bf16 v[92:95], a[116:119], v[52:55], v[92:95]
    v_cndmask_b32 v3, 0, v96, s[44:45]
    v_cndmask_b32 v3, v3, v97, s[46:47]
    v_mfma_f32_16x16x32_bf16 v[88:91], a[96:99], v[136:139], v[76:79]
    v_cndmask_b32 v3, v3, v98, s[48:49]
    v_cndmask_b32 v3, v3, v99, s[50:51]
    v_mfma_f32_16x16x32_bf16 v[88:91], a[100:103], v[140:143], v[88:91]
    s_nop 0
    s_nop 0
    v_mfma_f32_16x16x32_bf16 v[88:91], a[104:107], v[144:147], v[88:91]
    v_mfma_f32_16x16x4_f32 v[120:123], v3, v60, v[56:59]
    v_mfma_f32_16x16x32_bf16 v[88:91], a[108:111], v[148:151], v[88:91]
    v_mfma_f32_16x16x32_bf16 v[88:91], a[112:115], v[152:155], v[88:91]
    v_mfma_f32_16x16x32_bf16 v[88:91], a[116:119], v[156:159], v[88:91]
    s_waitcnt lgkmcnt(0)
    s_barrier
    v_mfma_f32_16x16x32_bf16 v[112:115], a[120:123], a[120:123], v[84:87]
    s_cmp_eq_u32 s0, 0
    s_cbranch_scc0 L_g43
    s_waitcnt vmcnt(5)
L_g43:
    s_add_u32 m0, s42, 0
    s_add_u32 s59, s37, 25362432
    buffer_load_dwordx4 v22, s[24:27], s59 offen offset:0 nt lds
    v_mfma_f32_16x16x32_bf16 v[116:119], a[120:123], a[48:51], 0
    s_waitcnt vmcnt(8)
    s_movk_i32 s15, 1024
    v_sub_u32 v244, s14, v244
    v_cmp_gt_u32 s[16:17], s15, v244
    v_subrev_u32 v244, 234, v244
    s_nop 0
    v_cndmask_b32 v244, 0, v244, s[16:17]
    s_nop 1
    v_add_u32_dpp v244, v244, v244 row_ror:4 row_mask:0xf bank_mask:0xf
    s_nop 1
    v_add_u32_dpp v244, v244, v244 row_ror:2 row_mask:0xf bank_mask:0xf
    s_nop 1
    v_add_u32_dpp v244, v244, v244 row_ror:1 row_mask:0xf bank_mask:0xf
    s_nop 0
    v_readfirstlane_b32 s14, v244
    s_cmp_gt_i32 s14, -40
    s_cselect_b32 s17, 2, s0
    s_cmp_eq_u32 s17, 0
    s_cbranch_scc0 L_g44
    s_waitcnt vmcnt(5)
L_g44:
    buffer_load_dwordx4 v23, s[24:27], s59 offen offset:1024 nt lds
    v_mfma_f32_16x16x32_bf16 v[112:115], a[124:127], a[124:127], v[112:115]
    v_mfma_f32_16x16x32_bf16 v[116:119], a[124:127], a[52:55], v[116:119]
    v_fma_f32 v128, -v92, v92, v120
    v_fma_f32 v129, -v93, v93, v121
    v_mfma_f32_16x16x32_bf16 v[112:115], a[128:131], a[128:131], v[112:115]
    v_fma_f32 v130, -v94, v94, v122
    v_fma_f32 v131, -v95, v95, v123
    v_mfma_f32_16x16x32_bf16 v[116:119], a[128:131], a[56:59], v[116:119]
    s_cmp_eq_u32 s17, 0
    s_cbranch_scc0 L_g45
    s_waitcnt vmcnt(5)
L_g45:
    buffer_load_dwordx4 v24, s[24:27], s59 offen offset:2048 nt lds
    v_max_f32 v128, v128, v56
    v_max_f32 v129, v129, v56
    v_mfma_f32_16x16x32_bf16 v[112:115], a[132:135], a[132:135], v[112:115]
    v_max_f32 v130, v130, v56
    v_max_f32 v131, v131, v56
    v_mfma_f32_16x16x32_bf16 v[116:119], a[132:135], a[60:63], v[116:119]
    v_rsq_f32 v128, v128
    v_mfma_f32_16x16x32_bf16 v[112:115], a[136:139], a[136:139], v[112:115]
    v_rsq_f32 v129, v129
    v_mfma_f32_16x16x32_bf16 v[116:119], a[136:139], a[64:67], v[116:119]
    v_rsq_f32 v130, v130
    v_mfma_f32_16x16x32_bf16 v[112:115], a[140:143], a[140:143], v[112:115]
    v_rsq_f32 v131, v131
    v_mfma_f32_16x16x32_bf16 v[116:119], a[140:143], a[68:71], v[116:119]
    v_fma_f32 v88, -v92, v61, v88
    v_fma_f32 v89, -v93, v61, v89
    v_mfma_f32_16x16x32_bf16 v[108:111], a[120:123], v[52:55], v[80:83]
    v_fma_f32 v90, -v94, v61, v90
    v_fma_f32 v91, -v95, v61, v91
    v_mfma_f32_16x16x32_bf16 v[108:111], a[124:127], v[52:55], v[108:111]
    v_fma_f32 v88, v88, v128, v62
    v_fma_f32 v89, v89, v129, v62
    v_mfma_f32_16x16x32_bf16 v[108:111], a[128:131], v[52:55], v[108:111]
    v_fma_f32 v90, v90, v130, v62
    v_fma_f32 v91, v91, v131, v62
    v_mfma_f32_16x16x32_bf16 v[108:111], a[132:135], v[52:55], v[108:111]
    v_max3_f32 v1, v88, v89, v90
    v_max_f32 v1, v1, v91
    v_mfma_f32_16x16x32_bf16 v[108:111], a[136:139], v[52:55], v[108:111]
    v_cmp_lt_f32 vcc, s52, v1
    s_cbranch_vccnz L_site0
L_back0:
    v_mfma_f32_16x16x32_bf16 v[108:111], a[140:143], v[52:55], v[108:111]
    s_cmp_eq_u32 s17, 0
    s_cbranch_scc0 L_g46
    s_waitcnt vmcnt(5)
L_g46:
    buffer_load_dwordx4 v25, s[24:27], s59 offen offset:3072 nt lds
    v_exp_f32 v96, v88
    v_mfma_f32_16x16x32_bf16 v[104:107], a[120:123], v[136:139], v[76:79]
    v_exp_f32 v97, v89
    v_mfma_f32_16x16x32_bf16 v[104:107], a[124:127], v[140:143], v[104:107]
    v_exp_f32 v98, v90
    v_mfma_f32_16x16x32_bf16 v[104:107], a[128:131], v[144:147], v[104:107]
    v_exp_f32 v99, v91
    v_mfma_f32_16x16x32_bf16 v[104:107], a[132:135], v[148:151], v[104:107]
    v_mul_f32 v88, v96, v128
    v_mul_f32 v89, v97, v129
    v_mfma_f32_16x16x32_bf16 v[104:107], a[136:139], v[152:155], v[104:107]
    v_mul_f32 v90, v98, v130
    v_mul_f32 v91, v99, v131
    v_mfma_f32_16x16x32_bf16 v[104:107], a[140:143], v[156:159], v[104:107]
    v_fma_f32 v112, v116, 2.0, v112
    v_fma_f32 v113, v117, 2.0, v113
    v_fma_f32 v114, v118, 2.0, v114
    v_fma_f32 v115, v119, 2.0, v115
    v_cndmask_b32 v4, 0, v112, s[44:45]
    v_cndmask_b32 v4, v4, v113, s[46:47]
    v_cndmask_b32 v4, v4, v114, s[48:49]
    v_cndmask_b32 v4, v4, v115, s[50:51]
    v_add_f32 v63, v63, v96
    v_fmac_f32 v64, v88, v92
    v_mfma_f32_16x16x4_f32 v[124:127], v4, v60, v[56:59]
    v_add_f32 v63, v63, v97
    v_fmac_f32 v64, v89, v93
    v_add_f32 v63, v63, v98
    v_fmac_f32 v64, v90, v94
    v_add_f32 v63, v63, v99
    v_fmac_f32 v64, v91, v95
    v_add_f32 v68, v68, v88
    v_add_f32 v69, v69, v89
    v_add_f32 v70, v70, v90
    v_add_f32 v71, v71, v91
    v_add_u32 v44, -49152, v44
    v_add_u32 v45, -49152, v45
    v_add_u32 v46, -49152, v46
    v_add_u32 v47, -49152, v47
    v_add_u32 v48, -49152, v48
    v_add_u32 v49, -49152, v49
    v_fma_f32 v132, -v108, v108, v124
    v_fma_f32 v133, -v109, v109, v125
    v_fma_f32 v134, -v110, v110, v126
    v_fma_f32 v135, -v111, v111, v127
    v_max_f32 v132, v132, v56
    v_max_f32 v133, v133, v56
    v_max_f32 v134, v134, v56
    v_max_f32 v135, v135, v56
    v_rsq_f32 v132, v132
    v_rsq_f32 v133, v133
    v_rsq_f32 v134, v134
    v_rsq_f32 v135, v135
    s_cmp_eq_u32 s17, 0
    s_cbranch_scc0 L_g47
    s_waitcnt vmcnt(5)
L_g47:
    s_add_u32 m0, s42, 4096
    s_nop 0
    buffer_load_dwordx4 v26, s[24:27], s59 offen offset:0 nt lds
    v_fma_f32 v104, -v108, v61, v104
    v_fma_f32 v105, -v109, v61, v105
    v_fma_f32 v106, -v110, v61, v106
    v_fma_f32 v107, -v111, v61, v107
    v_fma_f32 v104, v104, v132, v62
    v_fma_f32 v105, v105, v133, v62
    v_fma_f32 v106, v106, v134, v62
    v_fma_f32 v107, v107, v135, v62
    v_max3_f32 v1, v104, v105, v106
    v_max_f32 v1, v1, v107
    v_cmp_lt_f32 vcc, s52, v1
    s_cbranch_vccnz L_site1
L_back1:
    v_exp_f32 v112, v104
    v_exp_f32 v113, v105
    v_exp_f32 v114, v106
    v_exp_f32 v115, v107
    v_cvt_pk_bf16_f32 v72, v88, v89
    v_cvt_pk_bf16_f32 v73, v90, v91
    v_mul_f32 v104, v112, v132
    v_mul_f32 v105, v113, v133
    v_mul_f32 v106, v114, v134
    v_mul_f32 v107, v115, v135
    v_cvt_pk_bf16_f32 v74, v104, v105
    v_cvt_pk_bf16_f32 v75, v106, v107
    ds_write_b128 v237, v[72:75] offset:0
    v_add_f32 v68, v68, v104
    v_add_f32 v69, v69, v105
    v_add_f32 v70, v70, v106
    v_add_f32 v71, v71, v107
    v_cvt_pk_bf16_f32 v66, v68, v69
    v_cvt_pk_bf16_f32 v67, v70, v71
    ds_write_b64 v238, v[66:67]
    s_cmp_eq_u32 s17, 0
    s_cbranch_scc0 L_g48
    s_waitcnt vmcnt(5)
L_g48:
    buffer_load_dwordx4 v27, s[24:27], s59 offen offset:1024 nt lds
    s_waitcnt lgkmcnt(0)
    s_barrier
L_post3:
    ds_read_b32 v9, v254 offset:4096
    ds_read_b64 v[120:121], v254 offset:0
    ds_read_b64 v[122:123], v254 offset:512
    ds_read_b64 v[124:125], v254 offset:1024
    ds_read_b64 v[126:127], v254 offset:1536
    ds_read_b128 v[92:95], v253 offset:0
    ds_read_b128 v[96:99], v253 offset:1024
    ds_read_b128 v[100:103], v253 offset:2048
    ds_read_b128 v[116:119], v253 offset:3072
    ds_read_b128 a[48:51], v34 offset:0
    ds_read_b128 a[52:55], v35 offset:0
    ds_read_b128 a[56:59], v34 offset:128
    ds_read_b128 a[60:63], v35 offset:128
    ds_read_b128 a[64:67], v34 offset:256
    ds_read_b128 a[68:71], v35 offset:256
    s_waitcnt lgkmcnt(14)
    v_cmp_ne_u32 vcc, 0, v9
    s_cbranch_vccnz L_xt3
    s_waitcnt lgkmcnt(12)
    v_mfma_f32_16x16x32_bf16 a[0:3], a[72:75], v[120:123], a[0:3]
    s_cmp_eq_u32 s17, 0
    s_cbranch_scc0 L_g49
    s_waitcnt vmcnt(5)
L_g49:
    buffer_load_dwordx4 v28, s[24:27], s59 offen offset:2048 nt lds
    v_add_f32 v63, v63, v112
    v_fma_f32 v64, v104, v108, v64
    v_mfma_f32_16x16x32_bf16 a[4:7], a[80:83], v[120:123], a[4:7]
    v_add_f32 v63, v63, v113
    v_fma_f32 v64, v105, v109, v64
    v_mfma_f32_16x16x32_bf16 a[8:11], a[88:91], v[120:123], a[8:11]
    v_add_f32 v63, v63, v114
    v_fma_f32 v64, v106, v110, v64
    s_waitcnt lgkmcnt(10)
    v_mfma_f32_16x16x32_bf16 a[0:3], a[76:79], v[124:127], a[0:3]
    v_add_f32 v63, v63, v115
    v_fma_f32 v64, v107, v111, v64
    v_mfma_f32_16x16x32_bf16 a[4:7], a[84:87], v[124:127], a[4:7]
    v_mfma_f32_16x16x32_bf16 a[8:11], a[92:95], v[124:127], a[8:11]
    s_waitcnt lgkmcnt(9)
    v_mfma_f32_16x16x32_bf16 a[0:3], a[144:147], v[92:95], a[0:3]
    ds_read_b64_tr_b16 a[72:73], v36 offset:0
    ds_read_b64_tr_b16 a[74:75], v36 offset:6144
    v_mfma_f32_16x16x32_bf16 a[4:7], a[160:163], v[92:95], a[4:7]
    ds_read_b64_tr_b16 a[76:77], v36 offset:12288
    ds_read_b64_tr_b16 a[78:79], v36 offset:18432
    v_mfma_f32_16x16x32_bf16 a[8:11], a[176:179], v[92:95], a[8:11]
    ds_read_b64_tr_b16 a[80:81], v37 offset:0
    ds_read_b64_tr_b16 a[82:83], v37 offset:6144
    s_waitcnt lgkmcnt(14)
    v_mfma_f32_16x16x32_bf16 a[0:3], a[148:151], v[96:99], a[0:3]
    s_cmp_eq_u32 s17, 0
    s_cbranch_scc0 L_g50
    s_waitcnt vmcnt(5)
L_g50:
    buffer_load_dwordx4 v29, s[24:27], s59 offen offset:3072 nt lds
    ds_read_b64_tr_b16 a[84:85], v37 offset:12288
    ds_read_b64_tr_b16 a[86:87], v37 offset:18432
    v_mfma_f32_16x16x32_bf16 a[4:7], a[164:167], v[96:99], a[4:7]
    ds_read_b64_tr_b16 a[88:89], v38 offset:0
    ds_read_b64_tr_b16 a[90:91], v38 offset:6144
    v_mfma_f32_16x16x32_bf16 a[8:11], a[180:183], v[96:99], a[8:11]
    ds_read_b64_tr_b16 a[92:93], v38 offset:12288
    ds_read_b64_tr_b16 a[94:95], v38 offset:18432
    s_waitcnt lgkmcnt(15)
    v_mfma_f32_16x16x32_bf16 a[0:3], a[152:155], v[100:103], a[0:3]
    v_mfma_f32_16x16x32_bf16 a[4:7], a[168:171], v[100:103], a[4:7]
    v_mfma_f32_16x16x32_bf16 a[8:11], a[184:187], v[100:103], a[8:11]
    v_mfma_f32_16x16x32_bf16 a[0:3], a[156:159], v[116:119], a[0:3]
    v_mfma_f32_16x16x32_bf16 a[4:7], a[172:175], v[116:119], a[4:7]
    v_mfma_f32_16x16x32_bf16 a[8:11], a[188:191], v[116:119], a[8:11]
    v_mfma_f32_16x16x32_bf16 v[84:87], a[48:51], a[48:51], 0
    v_mfma_f32_16x16x32_bf16 v[80:83], a[48:51], v[52:55], 0
    v_mfma_f32_16x16x32_bf16 v[84:87], a[52:55], a[52:55], v[84:87]
    s_cmp_eq_u32 s17, 0
    s_cbranch_scc0 L_g51
    s_waitcnt vmcnt(5)
L_g51:
    s_add_u32 m0, s42, 8192
    s_nop 0
    buffer_load_dwordx4 v30, s[24:27], s59 offen offset:0 nt lds
    v_mfma_f32_16x16x32_bf16 v[80:83], a[52:55], v[52:55], v[80:83]
    v_mfma_f32_16x16x32_bf16 v[84:87], a[56:59], a[56:59], v[84:87]
    v_mfma_f32_16x16x32_bf16 v[80:83], a[56:59], v[52:55], v[80:83]
    s_waitcnt lgkmcnt(14)
    v_mfma_f32_16x16x32_bf16 v[84:87], a[60:63], a[60:63], v[84:87]
    v_mfma_f32_16x16x32_bf16 v[80:83], a[60:63], v[52:55], v[80:83]
    s_waitcnt lgkmcnt(13)
    v_mfma_f32_16x16x32_bf16 v[84:87], a[64:67], a[64:67], v[84:87]
    v_mfma_f32_16x16x32_bf16 v[80:83], a[64:67], v[52:55], v[80:83]
    s_waitcnt lgkmcnt(12)
    v_mfma_f32_16x16x32_bf16 v[84:87], a[68:71], a[68:71], v[84:87]
    v_mfma_f32_16x16x32_bf16 v[80:83], a[68:71], v[52:55], v[80:83]
    s_waitcnt lgkmcnt(0)
    v_mfma_f32_16x16x32_bf16 v[76:79], a[48:51], v[136:139], 0
    v_mfma_f32_16x16x32_bf16 v[76:79], a[52:55], v[140:143], v[76:79]
    v_mfma_f32_16x16x32_bf16 v[76:79], a[56:59], v[144:147], v[76:79]
    v_mfma_f32_16x16x32_bf16 v[76:79], a[60:63], v[148:151], v[76:79]
    s_cmp_eq_u32 s17, 0
    s_cbranch_scc0 L_g52
    s_waitcnt vmcnt(5)
L_g52:
    buffer_load_dwordx4 v31, s[24:27], s59 offen offset:1024 nt lds
    v_mfma_f32_16x16x32_bf16 v[76:79], a[64:67], v[152:155], v[76:79]
    v_mfma_f32_16x16x32_bf16 v[76:79], a[68:71], v[156:159], v[76:79]
    v_lshrrev_b32 v1, 3, v0
    v_and_b32 v2, 6, v1
    v_xor_b32 v2, v0, v2
    v_and_b32 v2, 7, v2
    v_mul_u32_u24 v1, 768, v1
    v_lshl_add_u32 v224, v2, 4, v1
    v_xor_b32 v225, 16, v224
    v_add_u32 v225, 5120, v225
    s_cmp_eq_u32 s17, 0
    s_cbranch_scc0 L_g53
    s_waitcnt vmcnt(5)
L_g53:
    buffer_load_dwordx4 v32, s[24:27], s59 offen offset:2048 nt lds
    s_waitcnt vmcnt(11)
    s_barrier
    ds_read_b128 a[96:99], v40 offset:0
    ds_read_b128 a[100:103], v41 offset:0
    ds_read_b128 a[104:107], v42 offset:0
    ds_read_b128 a[108:111], v43 offset:0
    ds_read_b128 a[112:115], v40 offset:256
    ds_read_b128 a[116:119], v41 offset:256
    ds_read_b128 a[120:123], v42 offset:256
    ds_read_b128 a[124:127], v43 offset:256
    ds_read_b128 a[128:131], v40 offset:512
    ds_read_b128 a[132:135], v41 offset:512
    ds_read_b128 a[136:139], v42 offset:512
    ds_read_b128 a[140:143], v43 offset:512
    s_waitcnt lgkmcnt(11)
    v_mfma_f32_16x16x32_bf16 v[96:99], a[96:99], a[96:99], v[84:87]
    ds_read_b64_tr_b16 a[144:145], v44 offset:0
    ds_read_b64_tr_b16 a[146:147], v45 offset:0
    v_mfma_f32_16x16x32_bf16 v[100:103], a[96:99], a[48:51], 0
    ds_read_b64_tr_b16 a[148:149], v44 offset:12288
    ds_read_b64_tr_b16 a[150:151], v45 offset:12288
    s_waitcnt lgkmcnt(14)
    v_mfma_f32_16x16x32_bf16 v[96:99], a[100:103], a[100:103], v[96:99]
    ds_read_b64_tr_b16 a[152:153], v44 offset:24576
    ds_read_b64_tr_b16 a[154:155], v45 offset:24576
    v_mfma_f32_16x16x32_bf16 v[100:103], a[100:103], a[52:55], v[100:103]
    ds_read_b64_tr_b16 a[156:157], v44 offset:36864
    ds_read_b64_tr_b16 a[158:159], v45 offset:36864
    s_waitcnt lgkmcnt(15)
    v_mfma_f32_16x16x32_bf16 v[96:99], a[104:107], a[104:107], v[96:99]
    ds_read_b64_tr_b16 a[160:161], v46 offset:0
    ds_read_b64_tr_b16 a[162:163], v47 offset:0
    v_mfma_f32_16x16x32_bf16 v[100:103], a[104:107], a[56:59], v[100:103]
    ds_read_b64_tr_b16 a[164:165], v46 offset:12288
    ds_read_b64_tr_b16 a[166:167], v47 offset:12288
    v_mfma_f32_16x16x32_bf16 v[96:99], a[108:111], a[108:111], v[96:99]
    s_cmp_eq_u32 s17, 0
    s_cbranch_scc0 L_g54
    s_waitcnt vmcnt(5)
L_g54:
    buffer_load_dwordx4 v33, s[24:27], s59 offen offset:3072 nt lds
    ds_read_b64_tr_b16 a[168:169], v46 offset:24576
    ds_read_b64_tr_b16 a[170:171], v47 offset:24576
    v_mfma_f32_16x16x32_bf16 v[100:103], a[108:111], a[60:63], v[100:103]
    ds_read_b64_tr_b16 a[172:173], v46 offset:36864
    ds_read_b64_tr_b16 a[174:175], v47 offset:36864
    v_mfma_f32_16x16x32_bf16 v[96:99], a[112:115], a[112:115], v[96:99]
    ds_read_b64_tr_b16 a[176:177], v48 offset:0
    ds_read_b64_tr_b16 a[178:179], v49 offset:0
    v_mfma_f32_16x16x32_bf16 v[100:103], a[112:115], a[64:67], v[100:103]
    ds_read_b64_tr_b16 a[180:181], v48 offset:12288
    ds_read_b64_tr_b16 a[182:183], v49 offset:12288
    s_waitcnt lgkmcnt(15)
    v_mfma_f32_16x16x32_bf16 v[96:99], a[116:119], a[116:119], v[96:99]
    ds_read_b64_tr_b16 a[184:185], v48 offset:24576
    ds_read_b64_tr_b16 a[186:187], v49 offset:24576
    v_mfma_f32_16x16x32_bf16 v[100:103], a[116:119], a[68:71], v[100:103]
    ds_read_b64_tr_b16 a[188:189], v48 offset:36864
    ds_read_b64_tr_b16 a[190:191], v49 offset:36864
    v_mfma_f32_16x16x32_bf16 v[92:95], a[96:99], v[52:55], v[80:83]
    v_mfma_f32_16x16x32_bf16 v[92:95], a[100:103], v[52:55], v[92:95]
    v_mfma_f32_16x16x32_bf16 v[92:95], a[104:107], v[52:55], v[92:95]
    v_mfma_f32_16x16x32_bf16 v[92:95], a[108:111], v[52:55], v[92:95]
    s_nop 1
    v_fma_f32 v96, v100, 2.0, v96
    v_fma_f32 v97, v101, 2.0, v97
    v_mfma_f32_16x16x32_bf16 v[92:95], a[112:115], v[52:55], v[92:95]
    v_fma_f32 v98, v102, 2.0, v98
    v_fma_f32 v99, v103, 2.0, v99
    v_mfma_f32_16x16x32_bf16 v[92:95], a[116:119], v[52:55], v[92:95]
    s_cmp_eq_u32 s17, 0
    s_cbranch_scc0 L_g55
    s_waitcnt vmcnt(5)
L_g55:
    s_add_u32 m0, s40, 0
    s_add_u32 s57, s36, 12582912
    buffer_load_dwordx4 v16, s[28:31], s57 offen offset:0 nt lds
    v_cndmask_b32 v3, 0, v96, s[44:45]
    v_cndmask_b32 v3, v3, v97, s[46:47]
    v_mfma_f32_16x16x32_bf16 v[88:91], a[96:99], v[136:139], v[76:79]
    v_cndmask_b32 v3, v3, v98, s[48:49]
    v_cndmask_b32 v3, v3, v99, s[50:51]
    v_mfma_f32_16x16x32_bf16 v[88:91], a[100:103], v[140:143], v[88:91]
    s_nop 0
    s_nop 0
    v_mfma_f32_16x16x32_bf16 v[88:91], a[104:107], v[144:147], v[88:91]
    v_mfma_f32_16x16x4_f32 v[120:123], v3, v60, v[56:59]
    v_mfma_f32_16x16x32_bf16 v[88:91], a[108:111], v[148:151], v[88:91]
    v_mfma_f32_16x16x32_bf16 v[88:91], a[112:115], v[152:155], v[88:91]
    v_mfma_f32_16x16x32_bf16 v[88:91], a[116:119], v[156:159], v[88:91]
    v_mfma_f32_16x16x32_bf16 v[112:115], a[120:123], a[120:123], v[84:87]
    v_mfma_f32_16x16x32_bf16 v[116:119], a[120:123], a[48:51], 0
    v_mfma_f32_16x16x32_bf16 v[112:115], a[124:127], a[124:127], v[112:115]
    v_mfma_f32_16x16x32_bf16 v[116:119], a[124:127], a[52:55], v[116:119]
    s_cmp_gt_i32 s14, 80
    s_cselect_b32 s17, 2, s0
    s_cmp_eq_u32 s17, 0
    s_cbranch_scc0 L_g56
    s_waitcnt vmcnt(5)
L_g56:
    buffer_load_dwordx4 v17, s[28:31], s57 offen offset:1024 nt lds
    v_fma_f32 v128, -v92, v92, v120
    v_fma_f32 v129, -v93, v93, v121
    v_mfma_f32_16x16x32_bf16 v[112:115], a[128:131], a[128:131], v[112:115]
    v_fma_f32 v130, -v94, v94, v122
    v_fma_f32 v131, -v95, v95, v123
    v_mfma_f32_16x16x32_bf16 v[116:119], a[128:131], a[56:59], v[116:119]
    v_max_f32 v128, v128, v56
    v_max_f32 v129, v129, v56
    v_mfma_f32_16x16x32_bf16 v[112:115], a[132:135], a[132:135], v[112:115]
    v_max_f32 v130, v130, v56
    v_max_f32 v131, v131, v56
    v_mfma_f32_16x16x32_bf16 v[116:119], a[132:135], a[60:63], v[116:119]
    v_rsq_f32 v128, v128
    v_mfma_f32_16x16x32_bf16 v[112:115], a[136:139], a[136:139], v[112:115]
    v_rsq_f32 v129, v129
    v_mfma_f32_16x16x32_bf16 v[116:119], a[136:139], a[64:67], v[116:119]
    v_rsq_f32 v130, v130
    v_mfma_f32_16x16x32_bf16 v[112:115], a[140:143], a[140:143], v[112:115]
    v_rsq_f32 v131, v131
    v_mfma_f32_16x16x32_bf16 v[116:119], a[140:143], a[68:71], v[116:119]
    v_fma_f32 v88, -v92, v61, v88
    v_fma_f32 v89, -v93, v61, v89
    v_mfma_f32_16x16x32_bf16 v[108:111], a[120:123], v[52:55], v[80:83]
    v_fma_f32 v90, -v94, v61, v90
    v_fma_f32 v91, -v95, v61, v91
    v_mfma_f32_16x16x32_bf16 v[108:111], a[124:127], v[52:55], v[108:111]
    v_fma_f32 v88, v88, v128, v62
    v_fma_f32 v89, v89, v129, v62
    v_mfma_f32_16x16x32_bf16 v[108:111], a[128:131], v[52:55], v[108:111]
    v_fma_f32 v90, v90, v130, v62
    v_fma_f32 v91, v91, v131, v62
    v_mfma_f32_16x16x32_bf16 v[108:111], a[132:135], v[52:55], v[108:111]
    s_cmp_eq_u32 s17, 0
    s_cbranch_scc0 L_g57
    s_waitcnt vmcnt(5)
L_g57:
    buffer_load_dwordx4 v18, s[28:31], s57 offen offset:2048 nt lds
    v_max3_f32 v1, v88, v89, v90
    v_max_f32 v1, v1, v91
    v_mfma_f32_16x16x32_bf16 v[108:111], a[136:139], v[52:55], v[108:111]
    v_cmp_lt_f32 vcc, s52, v1
    s_cbranch_vccnz L_site2
L_back2:
    v_mfma_f32_16x16x32_bf16 v[108:111], a[140:143], v[52:55], v[108:111]
    v_exp_f32 v96, v88
    v_mfma_f32_16x16x32_bf16 v[104:107], a[120:123], v[136:139], v[76:79]
    v_exp_f32 v97, v89
    v_mfma_f32_16x16x32_bf16 v[104:107], a[124:127], v[140:143], v[104:107]
    v_exp_f32 v98, v90
    v_mfma_f32_16x16x32_bf16 v[104:107], a[128:131], v[144:147], v[104:107]
    v_exp_f32 v99, v91
    v_mfma_f32_16x16x32_bf16 v[104:107], a[132:135], v[148:151], v[104:107]
    v_mul_f32 v88, v96, v128
    v_mul_f32 v89, v97, v129
    v_mfma_f32_16x16x32_bf16 v[104:107], a[136:139], v[152:155], v[104:107]
    v_mul_f32 v90, v98, v130
    v_mul_f32 v91, v99, v131
    v_mfma_f32_16x16x32_bf16 v[104:107], a[140:143], v[156:159], v[104:107]
    v_fma_f32 v112, v116, 2.0, v112
    v_fma_f32 v113, v117, 2.0, v113
    v_fma_f32 v114, v118, 2.0, v114
    v_fma_f32 v115, v119, 2.0, v115
    v_cndmask_b32 v4, 0, v112, s[44:45]
    v_cndmask_b32 v4, v4, v113, s[46:47]
    v_cndmask_b32 v4, v4, v114, s[48:49]
    v_cndmask_b32 v4, v4, v115, s[50:51]
    v_add_f32 v63, v63, v96
    v_fmac_f32 v64, v88, v92
    v_mfma_f32_16x16x4_f32 v[124:127], v4, v60, v[56:59]
    v_add_f32 v63, v63, v97
    v_fmac_f32 v64, v89, v93
    v_add_f32 v63, v63, v98
    v_fmac_f32 v64, v90, v94
    v_add_f32 v63, v63, v99
    v_fmac_f32 v64, v91, v95
    v_mov_b32 v68, v88
    v_mov_b32 v69, v89
    v_mov_b32 v70, v90
    v_mov_b32 v71, v91
    v_add_u32 v44, 49152, v44
    v_add_u32 v45, 49152, v45
    v_add_u32 v46, 49152, v46
    v_add_u32 v47, 49152, v47
    v_add_u32 v48, 49152, v48
    v_add_u32 v49, 49152, v49
    v_fma_f32 v132, -v108, v108, v124
    v_fma_f32 v133, -v109, v109, v125
    v_fma_f32 v134, -v110, v110, v126
    v_fma_f32 v135, -v111, v111, v127
    v_max_f32 v132, v132, v56
    v_max_f32 v133, v133, v56
    v_max_f32 v134, v134, v56
    v_max_f32 v135, v135, v56
    v_rsq_f32 v132, v132
    v_rsq_f32 v133, v133
    v_rsq_f32 v134, v134
    v_rsq_f32 v135, v135
    s_cmp_eq_u32 s17, 0
    s_cbranch_scc0 L_g58
    s_waitcnt vmcnt(5)
L_g58:
    buffer_load_dwordx4 v19, s[28:31], s57 offen offset:3072 nt lds
    v_fma_f32 v104, -v108, v61, v104
    v_fma_f32 v105, -v109, v61, v105
    v_fma_f32 v106, -v110, v61, v106
    v_fma_f32 v107, -v111, v61, v107
    v_fma_f32 v104, v104, v132, v62
    v_fma_f32 v105, v105, v133, v62
    v_fma_f32 v106, v106, v134, v62
    v_fma_f32 v107, v107, v135, v62
    v_max3_f32 v1, v104, v105, v106
    v_max_f32 v1, v1, v107
    v_cmp_lt_f32 vcc, s52, v1
    s_cbranch_vccnz L_site3
L_back3:
    v_exp_f32 v112, v104
    v_exp_f32 v113, v105
    v_exp_f32 v114, v106
    v_exp_f32 v115, v107
    v_cvt_pk_bf16_f32 v72, v88, v89
    v_cvt_pk_bf16_f32 v73, v90, v91
    v_mul_f32 v104, v112, v132
    v_mul_f32 v105, v113, v133
    v_mul_f32 v106, v114, v134
    v_mul_f32 v107, v115, v135
    v_cvt_pk_bf16_f32 v74, v104, v105
    v_cvt_pk_bf16_f32 v75, v106, v107
    ds_write_b128 v237, v[72:75] offset:0
    s_waitcnt lgkmcnt(0)
    s_barrier
L_post24:
    ds_read_b32 v9, v254 offset:4096
    ds_read_b128 v[92:95], v253 offset:0
    ds_read_b128 v[96:99], v253 offset:1024
    ds_read_b128 v[100:103], v253 offset:2048
    ds_read_b128 v[116:119], v253 offset:3072
    s_waitcnt lgkmcnt(4)
    v_cmp_ne_u32 vcc, 0, v9
    s_cbranch_vccnz L_xt24
    s_waitcnt lgkmcnt(3)
    v_mfma_f32_16x16x32_bf16 a[0:3], a[144:147], v[92:95], a[0:3]
    s_cmp_eq_u32 s17, 0
    s_cbranch_scc0 L_g59
    s_waitcnt vmcnt(5)
L_g59:
    s_add_u32 m0, s40, 4096
    s_nop 0
    buffer_load_dwordx4 v20, s[28:31], s57 offen offset:0 nt lds
    v_add_f32 v68, v68, v104
    v_add_f32 v69, v69, v105
    v_mfma_f32_16x16x32_bf16 a[4:7], a[160:163], v[92:95], a[4:7]
    s_cmp_eq_u32 s17, 0
    s_cbranch_scc0 L_g60
    s_waitcnt vmcnt(5)
L_g60:
    buffer_load_dwordx4 v21, s[28:31], s57 offen offset:1024 nt lds
    v_add_f32 v70, v70, v106
    v_add_f32 v71, v71, v107
    v_mfma_f32_16x16x32_bf16 a[8:11], a[176:179], v[92:95], a[8:11]
    v_add_f32 v63, v63, v112
    v_fma_f32 v64, v104, v108, v64
    s_waitcnt lgkmcnt(2)
    v_mfma_f32_16x16x32_bf16 a[0:3], a[148:151], v[96:99], a[0:3]
    v_add_f32 v63, v63, v113
    v_fma_f32 v64, v105, v109, v64
    v_mfma_f32_16x16x32_bf16 a[4:7], a[164:167], v[96:99], a[4:7]
    buffer_load_dwordx2 v[234:235], v245, s[32:35], 0 offen offset:128 sc1
    v_add_f32 v63, v63, v114
    v_fma_f32 v64, v106, v110, v64
    v_mfma_f32_16x16x32_bf16 a[8:11], a[180:183], v[96:99], a[8:11]
    v_add_f32 v63, v63, v115
    v_fma_f32 v64, v107, v111, v64
    s_waitcnt lgkmcnt(1)
    v_mfma_f32_16x16x32_bf16 a[0:3], a[152:155], v[100:103], a[0:3]
    v_mfma_f32_16x16x32_bf16 a[4:7], a[168:171], v[100:103], a[4:7]
    v_mfma_f32_16x16x32_bf16 a[8:11], a[184:187], v[100:103], a[8:11]
    s_waitcnt lgkmcnt(0)
    v_mfma_f32_16x16x32_bf16 a[0:3], a[156:159], v[116:119], a[0:3]
    v_mfma_f32_16x16x32_bf16 a[4:7], a[172:175], v[116:119], a[4:7]
    v_mfma_f32_16x16x32_bf16 a[8:11], a[188:191], v[116:119], a[8:11]
    s_cmp_eq_u32 s17, 0
    s_cbranch_scc0 L_g61
    s_waitcnt vmcnt(6)
L_g61:
    s_add_u32 m0, s41, 0
    s_add_u32 s58, s37, 50331648
    buffer_load_dwordx4 v22, s[24:27], s58 offen offset:0 nt lds
    s_cmp_eq_u32 s17, 0
    s_cbranch_scc0 L_g62
    s_waitcnt vmcnt(6)
L_g62:
    buffer_load_dwordx4 v23, s[24:27], s58 offen offset:1024 nt lds
    s_cmp_eq_u32 s17, 0
    s_cbranch_scc0 L_g63
    s_waitcnt vmcnt(6)
L_g63:
    buffer_load_dwordx4 v24, s[24:27], s58 offen offset:2048 nt lds
    s_cmp_eq_u32 s17, 0
    s_cbranch_scc0 L_g64
    s_waitcnt vmcnt(6)
L_g64:
    buffer_load_dwordx4 v25, s[24:27], s58 offen offset:3072 nt lds
    s_waitcnt vmcnt(11)
    s_barrier
    ds_read_b128 a[96:99], v40 offset:49152
    ds_read_b128 a[100:103], v41 offset:49152
    ds_read_b128 a[104:107], v42 offset:49152
    ds_read_b128 a[108:111], v43 offset:49152
    ds_read_b128 a[112:115], v40 offset:49408
    ds_read_b128 a[116:119], v41 offset:49408
    ds_read_b128 a[120:123], v42 offset:49408
    ds_read_b128 a[124:127], v43 offset:49408
    ds_read_b128 a[128:131], v40 offset:49664
    ds_read_b128 a[132:135], v41 offset:49664
    ds_read_b128 a[136:139], v42 offset:49664
    ds_read_b128 a[140:143], v43 offset:49664
    s_waitcnt lgkmcnt(11)
    v_mfma_f32_16x16x32_bf16 v[96:99], a[96:99], a[96:99], v[84:87]
    ds_read_b64_tr_b16 a[144:145], v44 offset:0
    ds_read_b64_tr_b16 a[146:147], v45 offset:0
    v_mfma_f32_16x16x32_bf16 v[100:103], a[96:99], a[48:51], 0
    ds_read_b64_tr_b16 a[148:149], v44 offset:12288
    ds_read_b64_tr_b16 a[150:151], v45 offset:12288
    s_waitcnt lgkmcnt(14)
    v_mfma_f32_16x16x32_bf16 v[96:99], a[100:103], a[100:103], v[96:99]
    ds_read_b64_tr_b16 a[152:153], v44 offset:24576
    ds_read_b64_tr_b16 a[154:155], v45 offset:24576
    v_mfma_f32_16x16x32_bf16 v[100:103], a[100:103], a[52:55], v[100:103]
    ds_read_b64_tr_b16 a[156:157], v44 offset:36864
    ds_read_b64_tr_b16 a[158:159], v45 offset:36864
    s_waitcnt lgkmcnt(15)
    v_mfma_f32_16x16x32_bf16 v[96:99], a[104:107], a[104:107], v[96:99]
    ds_read_b64_tr_b16 a[160:161], v46 offset:0
    ds_read_b64_tr_b16 a[162:163], v47 offset:0
    v_mfma_f32_16x16x32_bf16 v[100:103], a[104:107], a[56:59], v[100:103]
    ds_read_b64_tr_b16 a[164:165], v46 offset:12288
    ds_read_b64_tr_b16 a[166:167], v47 offset:12288
    v_mfma_f32_16x16x32_bf16 v[96:99], a[108:111], a[108:111], v[96:99]
    s_cmp_eq_u32 s17, 0
    s_cbranch_scc0 L_g65
    s_waitcnt vmcnt(6)
L_g65:
    s_add_u32 m0, s41, 4096
    s_nop 0
    buffer_load_dwordx4 v26, s[24:27], s58 offen offset:0 nt lds
    ds_read_b64_tr_b16 a[168:169], v46 offset:24576
    ds_read_b64_tr_b16 a[170:171], v47 offset:24576
    v_mfma_f32_16x16x32_bf16 v[100:103], a[108:111], a[60:63], v[100:103]
    ds_read_b64_tr_b16 a[172:173], v46 offset:36864
    ds_read_b64_tr_b16 a[174:175], v47 offset:36864
    v_mfma_f32_16x16x32_bf16 v[96:99], a[112:115], a[112:115], v[96:99]
    ds_read_b64_tr_b16 a[176:177], v48 offset:0
    ds_read_b64_tr_b16 a[178:179], v49 offset:0
    v_mfma_f32_16x16x32_bf16 v[100:103], a[112:115], a[64:67], v[100:103]
    ds_read_b64_tr_b16 a[180:181], v48 offset:12288
    ds_read_b64_tr_b16 a[182:183], v49 offset:12288
    s_waitcnt lgkmcnt(15)
    v_mfma_f32_16x16x32_bf16 v[96:99], a[116:119], a[116:119], v[96:99]
    ds_read_b64_tr_b16 a[184:185], v48 offset:24576
    ds_read_b64_tr_b16 a[186:187], v49 offset:24576
    v_mfma_f32_16x16x32_bf16 v[100:103], a[116:119], a[68:71], v[100:103]
    ds_read_b64_tr_b16 a[188:189], v48 offset:36864
    ds_read_b64_tr_b16 a[190:191], v49 offset:36864
    v_mfma_f32_16x16x32_bf16 v[92:95], a[96:99], v[52:55], v[80:83]
    v_mfma_f32_16x16x32_bf16 v[92:95], a[100:103], v[52:55], v[92:95]
    v_mfma_f32_16x16x32_bf16 v[92:95], a[104:107], v[52:55], v[92:95]
    v_mfma_f32_16x16x32_bf16 v[92:95], a[108:111], v[52:55], v[92:95]
    s_nop 1
    v_fma_f32 v96, v100, 2.0, v96
    v_fma_f32 v97, v101, 2.0, v97
    v_mfma_f32_16x16x32_bf16 v[92:95], a[112:115], v[52:55], v[92:95]
    v_fma_f32 v98, v102, 2.0, v98
    v_fma_f32 v99, v103, 2.0, v99
    v_mfma_f32_16x16x32_bf16 v[92:95], a[116:119], v[52:55], v[92:95]
    s_cmp_eq_u32 s17, 0
    s_cbranch_scc0 L_g66
    s_waitcnt vmcnt(6)
L_g66:
    buffer_load_dwordx4 v27, s[24:27], s58 offen offset:1024 nt lds
    v_cndmask_b32 v3, 0, v96, s[44:45]
    v_cndmask_b32 v3, v3, v97, s[46:47]
    v_mfma_f32_16x16x32_bf16 v[88:91], a[96:99], v[136:139], v[76:79]
    v_cndmask_b32 v3, v3, v98, s[48:49]
    v_cndmask_b32 v3, v3, v99, s[50:51]
    v_mfma_f32_16x16x32_bf16 v[88:91], a[100:103], v[140:143], v[88:91]
    s_nop 0
    s_nop 0
    v_mfma_f32_16x16x32_bf16 v[88:91], a[104:107], v[144:147], v[88:91]
    v_mfma_f32_16x16x4_f32 v[120:123], v3, v60, v[56:59]
    v_mfma_f32_16x16x32_bf16 v[88:91], a[108:111], v[148:151], v[88:91]
    v_mfma_f32_16x16x32_bf16 v[88:91], a[112:115], v[152:155], v[88:91]
    v_mfma_f32_16x16x32_bf16 v[88:91], a[116:119], v[156:159], v[88:91]
    v_mfma_f32_16x16x32_bf16 v[112:115], a[120:123], a[120:123], v[84:87]
    v_mfma_f32_16x16x32_bf16 v[116:119], a[120:123], a[48:51], 0
    v_mfma_f32_16x16x32_bf16 v[112:115], a[124:127], a[124:127], v[112:115]
    v_mfma_f32_16x16x32_bf16 v[116:119], a[124:127], a[52:55], v[116:119]
    s_cmp_eq_u32 s17, 0
    s_cbranch_scc0 L_g67
    s_waitcnt vmcnt(5)
L_g67:
    buffer_load_dwordx4 v28, s[24:27], s58 offen offset:2048 nt lds
    v_fma_f32 v128, -v92, v92, v120
    v_fma_f32 v129, -v93, v93, v121
    v_mfma_f32_16x16x32_bf16 v[112:115], a[128:131], a[128:131], v[112:115]
    v_fma_f32 v130, -v94, v94, v122
    v_fma_f32 v131, -v95, v95, v123
    v_mfma_f32_16x16x32_bf16 v[116:119], a[128:131], a[56:59], v[116:119]
    v_max_f32 v128, v128, v56
    v_max_f32 v129, v129, v56
    v_mfma_f32_16x16x32_bf16 v[112:115], a[132:135], a[132:135], v[112:115]
    v_max_f32 v130, v130, v56
    v_max_f32 v131, v131, v56
    v_mfma_f32_16x16x32_bf16 v[116:119], a[132:135], a[60:63], v[116:119]
    v_rsq_f32 v128, v128
    v_mfma_f32_16x16x32_bf16 v[112:115], a[136:139], a[136:139], v[112:115]
    v_rsq_f32 v129, v129
    v_mfma_f32_16x16x32_bf16 v[116:119], a[136:139], a[64:67], v[116:119]
    v_rsq_f32 v130, v130
    v_mfma_f32_16x16x32_bf16 v[112:115], a[140:143], a[140:143], v[112:115]
    v_rsq_f32 v131, v131
    v_mfma_f32_16x16x32_bf16 v[116:119], a[140:143], a[68:71], v[116:119]
    v_fma_f32 v88, -v92, v61, v88
    v_fma_f32 v89, -v93, v61, v89
    v_mfma_f32_16x16x32_bf16 v[108:111], a[120:123], v[52:55], v[80:83]
    v_fma_f32 v90, -v94, v61, v90
    v_fma_f32 v91, -v95, v61, v91
    v_mfma_f32_16x16x32_bf16 v[108:111], a[124:127], v[52:55], v[108:111]
    v_fma_f32 v88, v88, v128, v62
    v_fma_f32 v89, v89, v129, v62
    v_mfma_f32_16x16x32_bf16 v[108:111], a[128:131], v[52:55], v[108:111]
    v_fma_f32 v90, v90, v130, v62
    v_fma_f32 v91, v91, v131, v62
    v_mfma_f32_16x16x32_bf16 v[108:111], a[132:135], v[52:55], v[108:111]
    s_cmp_gt_i32 s14, 200
    s_cselect_b32 s17, 2, s0
    s_cmp_eq_u32 s17, 0
    s_cbranch_scc0 L_g68
    s_waitcnt vmcnt(5)
L_g68:
    buffer_load_dwordx4 v29, s[24:27], s58 offen offset:3072 nt lds
    v_max3_f32 v1, v88, v89, v90
    v_max_f32 v1, v1, v91
    v_mfma_f32_16x16x32_bf16 v[108:111], a[136:139], v[52:55], v[108:111]
    v_cmp_lt_f32 vcc, s52, v1
    s_cbranch_vccnz L_site4
L_back4:
    v_mfma_f32_16x16x32_bf16 v[108:111], a[140:143], v[52:55], v[108:111]
    v_exp_f32 v96, v88
    v_mfma_f32_16x16x32_bf16 v[104:107], a[120:123], v[136:139], v[76:79]
    v_exp_f32 v97, v89
    v_mfma_f32_16x16x32_bf16 v[104:107], a[124:127], v[140:143], v[104:107]
    v_exp_f32 v98, v90
    v_mfma_f32_16x16x32_bf16 v[104:107], a[128:131], v[144:147], v[104:107]
    v_exp_f32 v99, v91
    v_mfma_f32_16x16x32_bf16 v[104:107], a[132:135], v[148:151], v[104:107]
    v_mul_f32 v88, v96, v128
    v_mul_f32 v89, v97, v129
    v_mfma_f32_16x16x32_bf16 v[104:107], a[136:139], v[152:155], v[104:107]
    v_mul_f32 v90, v98, v130
    v_mul_f32 v91, v99, v131
    v_mfma_f32_16x16x32_bf16 v[104:107], a[140:143], v[156:159], v[104:107]
    v_fma_f32 v112, v116, 2.0, v112
    v_fma_f32 v113, v117, 2.0, v113
    v_fma_f32 v114, v118, 2.0, v114
    v_fma_f32 v115, v119, 2.0, v115
    v_cndmask_b32 v4, 0, v112, s[44:45]
    v_cndmask_b32 v4, v4, v113, s[46:47]
    v_cndmask_b32 v4, v4, v114, s[48:49]
    v_cndmask_b32 v4, v4, v115, s[50:51]
    v_add_f32 v63, v63, v96
    v_fmac_f32 v64, v88, v92
    v_mfma_f32_16x16x4_f32 v[124:127], v4, v60, v[56:59]
    v_add_f32 v63, v63, v97
    v_fmac_f32 v64, v89, v93
    v_add_f32 v63, v63, v98
    v_fmac_f32 v64, v90, v94
    v_add_f32 v63, v63, v99
    v_fmac_f32 v64, v91, v95
    v_add_f32 v68, v68, v88
    v_add_f32 v69, v69, v89
    v_add_f32 v70, v70, v90
    v_add_f32 v71, v71, v91
    v_add_u32 v44, -49152, v44
    v_add_u32 v45, -49152, v45
    v_add_u32 v46, -49152, v46
    v_add_u32 v47, -49152, v47
    v_add_u32 v48, -49152, v48
    v_add_u32 v49, -49152, v49
    v_fma_f32 v132, -v108, v108, v124
    v_fma_f32 v133, -v109, v109, v125
    v_fma_f32 v134, -v110, v110, v126
    v_fma_f32 v135, -v111, v111, v127
    v_max_f32 v132, v132, v56
    v_max_f32 v133, v133, v56
    v_max_f32 v134, v134, v56
    v_max_f32 v135, v135, v56
    v_rsq_f32 v132, v132
    v_rsq_f32 v133, v133
    v_rsq_f32 v134, v134
    v_rsq_f32 v135, v135
    s_cmp_eq_u32 s17, 0
    s_cbranch_scc0 L_g69
    s_waitcnt vmcnt(5)
L_g69:
    s_add_u32 m0, s41, 8192
    s_nop 0
    buffer_load_dwordx4 v30, s[24:27], s58 offen offset:0 nt lds
    v_fma_f32 v104, -v108, v61, v104
    v_fma_f32 v105, -v109, v61, v105
    v_fma_f32 v106, -v110, v61, v106
    v_fma_f32 v107, -v111, v61, v107
    v_fma_f32 v104, v104, v132, v62
    v_fma_f32 v105, v105, v133, v62
    v_fma_f32 v106, v106, v134, v62
    v_fma_f32 v107, v107, v135, v62
    v_max3_f32 v1, v104, v105, v106
    v_max_f32 v1, v1, v107
    v_cmp_lt_f32 vcc, s52, v1
    s_cbranch_vccnz L_site5
L_back5:
    v_exp_f32 v112, v104
    v_exp_f32 v113, v105
    v_exp_f32 v114, v106
    v_exp_f32 v115, v107
    v_cvt_pk_bf16_f32 v72, v88, v89
    v_cvt_pk_bf16_f32 v73, v90, v91
    v_mul_f32 v104, v112, v132
    v_mul_f32 v105, v113, v133
    v_mul_f32 v106, v114, v134
    v_mul_f32 v107, v115, v135
    v_cvt_pk_bf16_f32 v74, v104, v105
    v_cvt_pk_bf16_f32 v75, v106, v107
    ds_write_b128 v237, v[72:75] offset:0
    v_add_f32 v68, v68, v104
    v_add_f32 v69, v69, v105
    v_add_f32 v70, v70, v106
    v_add_f32 v71, v71, v107
    v_cvt_pk_bf16_f32 v66, v68, v69
    v_cvt_pk_bf16_f32 v67, v70, v71
    ds_write_b64 v238, v[66:67]
    s_cmp_eq_u32 s17, 0
    s_cbranch_scc0 L_g70
    s_waitcnt vmcnt(5)
L_g70:
    buffer_load_dwordx4 v31, s[24:27], s58 offen offset:1024 nt lds
    s_cmp_eq_u32 s17, 0
    s_cbranch_scc0 L_g71
    s_waitcnt vmcnt(5)
L_g71:
    buffer_load_dwordx4 v32, s[24:27], s58 offen offset:2048 nt lds
    s_waitcnt vmcnt(12)
    s_waitcnt vmcnt(11)
    v_cmp_ne_u32 vcc, s39, v234
    s_cbranch_vccnz L_fl_retry
L_fl_ok:
    v_readlane_b32 s20, v235, 3
    v_readlane_b32 s21, v235, 4
    s_sub_u32 s20, s20, s21
    v_readlane_b32 s21, v235, 5
    s_add_u32 s20, s20, s21
    v_readlane_b32 s21, v235, 6
    s_sub_u32 s20, s20, s21
    v_readlane_b32 s21, v235, 7
    s_add_u32 s20, s20, s21
    v_readlane_b32 s21, v235, 8
    s_sub_u32 s20, s20, s21
    s_lshr_b32 s1, s20, 31
    s_waitcnt lgkmcnt(0)
    s_barrier
L_post6:
    ds_read_b32 v9, v254 offset:4096
    ds_read_b64 v[120:121], v254 offset:0
    ds_read_b64 v[122:123], v254 offset:512
    ds_read_b64 v[124:125], v254 offset:1024
    ds_read_b64 v[126:127], v254 offset:1536
    ds_read_b128 v[92:95], v253 offset:0
    ds_read_b128 v[96:99], v253 offset:1024
    ds_read_b128 v[100:103], v253 offset:2048
    ds_read_b128 v[116:119], v253 offset:3072
    ds_read_b128 a[48:51], v34 offset:0
    ds_read_b128 a[52:55], v35 offset:0
    ds_read_b128 a[56:59], v34 offset:128
    ds_read_b128 a[60:63], v35 offset:128
    ds_read_b128 a[64:67], v34 offset:256
    ds_read_b128 a[68:71], v35 offset:256
    s_waitcnt lgkmcnt(14)
    v_cmp_ne_u32 vcc, 0, v9
    s_cbranch_vccnz L_xt6
    s_waitcnt lgkmcnt(12)
    v_mfma_f32_16x16x32_bf16 a[0:3], a[72:75], v[120:123], a[0:3]
    s_cmp_eq_u32 s17, 0
    s_cbranch_scc0 L_g72
    s_waitcnt vmcnt(5)
L_g72:
    buffer_load_dwordx4 v33, s[24:27], s58 offen offset:3072 nt lds
    v_add_f32 v63, v63, v112
    v_fma_f32 v64, v104, v108, v64
    v_mfma_f32_16x16x32_bf16 a[4:7], a[80:83], v[120:123], a[4:7]
    v_add_f32 v63, v63, v113
    v_fma_f32 v64, v105, v109, v64
    v_mfma_f32_16x16x32_bf16 a[8:11], a[88:91], v[120:123], a[8:11]
    s_cmp_eq_u32 s17, 0
    s_cbranch_scc0 L_g73
    s_waitcnt vmcnt(5)
L_g73:
    s_add_u32 m0, s42, 0
    s_add_u32 s59, s37, 50528256
    buffer_load_dwordx4 v22, s[24:27], s59 offen offset:0 nt lds
    v_add_f32 v63, v63, v114
    v_fma_f32 v64, v106, v110, v64
    s_waitcnt lgkmcnt(10)
    v_mfma_f32_16x16x32_bf16 a[0:3], a[76:79], v[124:127], a[0:3]
    v_add_f32 v63, v63, v115
    v_fma_f32 v64, v107, v111, v64
    v_mfma_f32_16x16x32_bf16 a[4:7], a[84:87], v[124:127], a[4:7]
    v_mfma_f32_16x16x32_bf16 a[8:11], a[92:95], v[124:127], a[8:11]
    s_waitcnt lgkmcnt(9)
    v_mfma_f32_16x16x32_bf16 a[0:3], a[144:147], v[92:95], a[0:3]
    ds_read_b64_tr_b16 a[72:73], v36 offset:0
    ds_read_b64_tr_b16 a[74:75], v36 offset:6144
    v_mfma_f32_16x16x32_bf16 a[4:7], a[160:163], v[92:95], a[4:7]
    ds_read_b64_tr_b16 a[76:77], v36 offset:12288
    ds_read_b64_tr_b16 a[78:79], v36 offset:18432
    v_mfma_f32_16x16x32_bf16 a[8:11], a[176:179], v[92:95], a[8:11]
    ds_read_b64_tr_b16 a[80:81], v37 offset:0
    ds_read_b64_tr_b16 a[82:83], v37 offset:6144
    s_waitcnt lgkmcnt(14)
    v_mfma_f32_16x16x32_bf16 a[0:3], a[148:151], v[96:99], a[0:3]
    ds_read_b64_tr_b16 a[84:85], v37 offset:12288
    ds_read_b64_tr_b16 a[86:87], v37 offset:18432
    v_mfma_f32_16x16x32_bf16 a[4:7], a[164:167], v[96:99], a[4:7]
    ds_read_b64_tr_b16 a[88:89], v38 offset:0
    ds_read_b64_tr_b16 a[90:91], v38 offset:6144
    v_mfma_f32_16x16x32_bf16 a[8:11], a[180:183], v[96:99], a[8:11]
    ds_read_b64_tr_b16 a[92:93], v38 offset:12288
    ds_read_b64_tr_b16 a[94:95], v38 offset:18432
    s_waitcnt lgkmcnt(15)
    v_mfma_f32_16x16x32_bf16 a[0:3], a[152:155], v[100:103], a[0:3]
    s_cmp_eq_u32 s17, 0
    s_cbranch_scc0 L_g74
    s_waitcnt vmcnt(5)
L_g74:
    buffer_load_dwordx4 v23, s[24:27], s59 offen offset:1024 nt lds
    v_mfma_f32_16x16x32_bf16 a[4:7], a[168:171], v[100:103], a[4:7]
    v_mfma_f32_16x16x32_bf16 a[8:11], a[184:187], v[100:103], a[8:11]
    v_mfma_f32_16x16x32_bf16 a[0:3], a[156:159], v[116:119], a[0:3]
    v_mfma_f32_16x16x32_bf16 a[4:7], a[172:175], v[116:119], a[4:7]
    v_mfma_f32_16x16x32_bf16 a[8:11], a[188:191], v[116:119], a[8:11]
    v_mfma_f32_16x16x32_bf16 v[84:87], a[48:51], a[48:51], 0
    v_mfma_f32_16x16x32_bf16 v[80:83], a[48:51], v[52:55], 0
    v_mfma_f32_16x16x32_bf16 v[84:87], a[52:55], a[52:55], v[84:87]
    v_mfma_f32_16x16x32_bf16 v[80:83], a[52:55], v[52:55], v[80:83]
    v_mfma_f32_16x16x32_bf16 v[84:87], a[56:59], a[56:59], v[84:87]
    v_mfma_f32_16x16x32_bf16 v[80:83], a[56:59], v[52:55], v[80:83]
    s_waitcnt lgkmcnt(14)
    v_mfma_f32_16x16x32_bf16 v[84:87], a[60:63], a[60:63], v[84:87]
    v_mfma_f32_16x16x32_bf16 v[80:83], a[60:63], v[52:55], v[80:83]
    s_waitcnt lgkmcnt(13)
    v_mfma_f32_16x16x32_bf16 v[84:87], a[64:67], a[64:67], v[84:87]
    s_add_u32 s61, s60, 3145728
    buffer_load_dwordx4 v[160:163], v65, s[72:75], s61 offen offset:0 sc1
    v_mfma_f32_16x16x32_bf16 v[80:83], a[64:67], v[52:55], v[80:83]
    s_waitcnt lgkmcnt(12)
    v_mfma_f32_16x16x32_bf16 v[84:87], a[68:71], a[68:71], v[84:87]
    v_mfma_f32_16x16x32_bf16 v[80:83], a[68:71], v[52:55], v[80:83]
    s_waitcnt lgkmcnt(0)
    v_mfma_f32_16x16x32_bf16 v[76:79], a[48:51], v[136:139], 0
    v_mfma_f32_16x16x32_bf16 v[76:79], a[52:55], v[140:143], v[76:79]
    v_mfma_f32_16x16x32_bf16 v[76:79], a[56:59], v[144:147], v[76:79]
    v_mfma_f32_16x16x32_bf16 v[76:79], a[60:63], v[148:151], v[76:79]
    v_mfma_f32_16x16x32_bf16 v[76:79], a[64:67], v[152:155], v[76:79]
    v_mfma_f32_16x16x32_bf16 v[76:79], a[68:71], v[156:159], v[76:79]
    s_cmp_eq_u32 s17, 0
    s_cbranch_scc0 L_g75
    s_waitcnt vmcnt(6)
L_g75:
    buffer_load_dwordx4 v24, s[24:27], s59 offen offset:2048 nt lds
    s_cmp_eq_u32 s17, 0
    s_cbranch_scc0 L_g76
    s_waitcnt vmcnt(6)
L_g76:
    buffer_load_dwordx4 v25, s[24:27], s59 offen offset:3072 nt lds
    buffer_load_dwordx4 v[164:167], v65, s[72:75], s61 offen offset:1024 sc1
    s_cmp_eq_u32 s17, 0
    s_cbranch_scc0 L_g77
    s_waitcnt vmcnt(7)
L_g77:
    s_add_u32 m0, s42, 4096
    s_nop 0
    buffer_load_dwordx4 v26, s[24:27], s59 offen offset:0 nt lds
    s_cmp_eq_u32 s17, 0
    s_cbranch_scc0 L_g78
    s_waitcnt vmcnt(7)
L_g78:
    buffer_load_dwordx4 v27, s[24:27], s59 offen offset:1024 nt lds
    s_cmp_eq_u32 s17, 0
    s_cbranch_scc0 L_g79
    s_waitcnt vmcnt(7)
L_g79:
    buffer_load_dwordx4 v28, s[24:27], s59 offen offset:2048 nt lds
    buffer_load_dwordx4 v[168:171], v65, s[72:75], s61 offen offset:2048 sc1
    buffer_load_dwordx4 v29, s[24:27], s59 offen offset:3072 nt lds
    s_waitcnt vmcnt(11)
    s_barrier
    ds_read_b128 a[96:99], v40 offset:0
    ds_read_b128 a[100:103], v41 offset:0
    ds_read_b128 a[104:107], v42 offset:0
    ds_read_b128 a[108:111], v43 offset:0
    ds_read_b128 a[112:115], v40 offset:256
    ds_read_b128 a[116:119], v41 offset:256
    ds_read_b128 a[120:123], v42 offset:256
    ds_read_b128 a[124:127], v43 offset:256
    ds_read_b128 a[128:131], v40 offset:512
    ds_read_b128 a[132:135], v41 offset:512
    ds_read_b128 a[136:139], v42 offset:512
    ds_read_b128 a[140:143], v43 offset:512
    s_waitcnt lgkmcnt(11)
    v_mfma_f32_16x16x32_bf16 v[96:99], a[96:99], a[96:99], v[84:87]
    ds_read_b64_tr_b16 a[144:145], v44 offset:0
    ds_read_b64_tr_b16 a[146:147], v45 offset:0
    v_mfma_f32_16x16x32_bf16 v[100:103], a[96:99], a[48:51], 0
    ds_read_b64_tr_b16 a[148:149], v44 offset:12288
    ds_read_b64_tr_b16 a[150:151], v45 offset:12288
    s_waitcnt lgkmcnt(14)
    v_mfma_f32_16x16x32_bf16 v[96:99], a[100:103], a[100:103], v[96:99]
    ds_read_b64_tr_b16 a[152:153], v44 offset:24576
    ds_read_b64_tr_b16 a[154:155], v45 offset:24576
    v_mfma_f32_16x16x32_bf16 v[100:103], a[100:103], a[52:55], v[100:103]
    ds_read_b64_tr_b16 a[156:157], v44 offset:36864
    ds_read_b64_tr_b16 a[158:159], v45 offset:36864
    s_waitcnt lgkmcnt(15)
    v_mfma_f32_16x16x32_bf16 v[96:99], a[104:107], a[104:107], v[96:99]
    ds_read_b64_tr_b16 a[160:161], v46 offset:0
    ds_read_b64_tr_b16 a[162:163], v47 offset:0
    v_mfma_f32_16x16x32_bf16 v[100:103], a[104:107], a[56:59], v[100:103]
    ds_read_b64_tr_b16 a[164:165], v46 offset:12288
    ds_read_b64_tr_b16 a[166:167], v47 offset:12288
    v_mfma_f32_16x16x32_bf16 v[96:99], a[108:111], a[108:111], v[96:99]
    s_add_u32 m0, s42, 8192
    s_nop 0
    buffer_load_dwordx4 v30, s[24:27], s59 offen offset:0 nt lds
    ds_read_b64_tr_b16 a[168:169], v46 offset:24576
    ds_read_b64_tr_b16 a[170:171], v47 offset:24576
    v_mfma_f32_16x16x32_bf16 v[100:103], a[108:111], a[60:63], v[100:103]
    ds_read_b64_tr_b16 a[172:173], v46 offset:36864
    ds_read_b64_tr_b16 a[174:175], v47 offset:36864
    v_mfma_f32_16x16x32_bf16 v[96:99], a[112:115], a[112:115], v[96:99]
    ds_read_b64_tr_b16 a[176:177], v48 offset:0
    ds_read_b64_tr_b16 a[178:179], v49 offset:0
    v_mfma_f32_16x16x32_bf16 v[100:103], a[112:115], a[64:67], v[100:103]
    ds_read_b64_tr_b16 a[180:181], v48 offset:12288
    ds_read_b64_tr_b16 a[182:183], v49 offset:12288
    s_waitcnt lgkmcnt(15)
    v_mfma_f32_16x16x32_bf16 v[96:99], a[116:119], a[116:119], v[96:99]
    ds_read_b64_tr_b16 a[184:185], v48 offset:24576
    ds_read_b64_tr_b16 a[186:187], v49 offset:24576
    v_mfma_f32_16x16x32_bf16 v[100:103], a[116:119], a[68:71], v[100:103]
    ds_read_b64_tr_b16 a[188:189], v48 offset:36864
    ds_read_b64_tr_b16 a[190:191], v49 offset:36864
    v_mfma_f32_16x16x32_bf16 v[92:95], a[96:99], v[52:55], v[80:83]
    v_mfma_f32_16x16x32_bf16 v[92:95], a[100:103], v[52:55], v[92:95]
    v_mfma_f32_16x16x32_bf16 v[92:95], a[104:107], v[52:55], v[92:95]
    v_mfma_f32_16x16x32_bf16 v[92:95], a[108:111], v[52:55], v[92:95]
    s_nop 1
    v_fma_f32 v96, v100, 2.0, v96
    v_fma_f32 v97, v101, 2.0, v97
    v_mfma_f32_16x16x32_bf16 v[92:95], a[112:115], v[52:55], v[92:95]
    v_fma_f32 v98, v102, 2.0, v98
    v_fma_f32 v99, v103, 2.0, v99
    v_mfma_f32_16x16x32_bf16 v[92:95], a[116:119], v[52:55], v[92:95]
    buffer_load_dwordx4 v[172:175], v65, s[72:75], s61 offen offset:3072 sc1
    v_cndmask_b32 v3, 0, v96, s[44:45]
    v_cndmask_b32 v3, v3, v97, s[46:47]
    v_mfma_f32_16x16x32_bf16 v[88:91], a[96:99], v[136:139], v[76:79]
    buffer_load_dwordx4 v31, s[24:27], s59 offen offset:1024 nt lds
    v_cndmask_b32 v3, v3, v98, s[48:49]
    v_cndmask_b32 v3, v3, v99, s[50:51]
    v_mfma_f32_16x16x32_bf16 v[88:91], a[100:103], v[140:143], v[88:91]
    s_nop 0
    s_nop 0
    v_mfma_f32_16x16x32_bf16 v[88:91], a[104:107], v[144:147], v[88:91]
    v_mfma_f32_16x16x4_f32 v[120:123], v3, v60, v[56:59]
    v_mfma_f32_16x16x32_bf16 v[88:91], a[108:111], v[148:151], v[88:91]
    v_mfma_f32_16x16x32_bf16 v[88:91], a[112:115], v[152:155], v[88:91]
    v_mfma_f32_16x16x32_bf16 v[88:91], a[116:119], v[156:159], v[88:91]
    v_mfma_f32_16x16x32_bf16 v[112:115], a[120:123], a[120:123], v[84:87]
    v_mfma_f32_16x16x32_bf16 v[116:119], a[120:123], a[48:51], 0
    v_mfma_f32_16x16x32_bf16 v[112:115], a[124:127], a[124:127], v[112:115]
    buffer_load_dwordx4 v32, s[24:27], s59 offen offset:2048 nt lds
    v_mfma_f32_16x16x32_bf16 v[116:119], a[124:127], a[52:55], v[116:119]
    s_nop 1
    v_fma_f32 v128, -v92, v92, v120
    v_fma_f32 v129, -v93, v93, v121
    v_mfma_f32_16x16x32_bf16 v[112:115], a[128:131], a[128:131], v[112:115]
    v_fma_f32 v130, -v94, v94, v122
    v_fma_f32 v131, -v95, v95, v123
    v_mfma_f32_16x16x32_bf16 v[116:119], a[128:131], a[56:59], v[116:119]
    v_max_f32 v128, v128, v56
    v_max_f32 v129, v129, v56
    v_mfma_f32_16x16x32_bf16 v[112:115], a[132:135], a[132:135], v[112:115]
    v_max_f32 v130, v130, v56
    v_max_f32 v131, v131, v56
    v_mfma_f32_16x16x32_bf16 v[116:119], a[132:135], a[60:63], v[116:119]
    v_rsq_f32 v128, v128
    v_mfma_f32_16x16x32_bf16 v[112:115], a[136:139], a[136:139], v[112:115]
    v_rsq_f32 v129, v129
    v_mfma_f32_16x16x32_bf16 v[116:119], a[136:139], a[64:67], v[116:119]
    v_rsq_f32 v130, v130
    v_mfma_f32_16x16x32_bf16 v[112:115], a[140:143], a[140:143], v[112:115]
    v_rsq_f32 v131, v131
    v_mfma_f32_16x16x32_bf16 v[116:119], a[140:143], a[68:71], v[116:119]
    v_fma_f32 v88, -v92, v61, v88
    v_fma_f32 v89, -v93, v61, v89
    v_mfma_f32_16x16x32_bf16 v[108:111], a[120:123], v[52:55], v[80:83]
    v_fma_f32 v90, -v94, v61, v90
    v_fma_f32 v91, -v95, v61, v91
    v_mfma_f32_16x16x32_bf16 v[108:111], a[124:127], v[52:55], v[108:111]
    v_fma_f32 v88, v88, v128, v62
    v_fma_f32 v89, v89, v129, v62
    v_mfma_f32_16x16x32_bf16 v[108:111], a[128:131], v[52:55], v[108:111]
    v_fma_f32 v90, v90, v130, v62
    v_fma_f32 v91, v91, v131, v62
    v_mfma_f32_16x16x32_bf16 v[108:111], a[132:135], v[52:55], v[108:111]
    buffer_load_dwordx4 v33, s[24:27], s59 offen offset:3072 nt lds
    v_max3_f32 v1, v88, v89, v90
    v_max_f32 v1, v1, v91
    v_mfma_f32_16x16x32_bf16 v[108:111], a[136:139], v[52:55], v[108:111]
    s_add_u32 s61, s60, 3149824
    buffer_load_dwordx4 v[176:179], v65, s[72:75], s61 offen offset:0 sc1
    v_cmp_lt_f32 vcc, s52, v1
    s_cbranch_vccnz L_site6
L_back6:
    v_mfma_f32_16x16x32_bf16 v[108:111], a[140:143], v[52:55], v[108:111]
    v_exp_f32 v96, v88
    v_mfma_f32_16x16x32_bf16 v[104:107], a[120:123], v[136:139], v[76:79]
    v_exp_f32 v97, v89
    v_mfma_f32_16x16x32_bf16 v[104:107], a[124:127], v[140:143], v[104:107]
    v_exp_f32 v98, v90
    v_mfma_f32_16x16x32_bf16 v[104:107], a[128:131], v[144:147], v[104:107]
    v_exp_f32 v99, v91
    v_mfma_f32_16x16x32_bf16 v[104:107], a[132:135], v[148:151], v[104:107]
    v_mul_f32 v88, v96, v128
    v_mul_f32 v89, v97, v129
    v_mfma_f32_16x16x32_bf16 v[104:107], a[136:139], v[152:155], v[104:107]
    v_mul_f32 v90, v98, v130
    v_mul_f32 v91, v99, v131
    v_mfma_f32_16x16x32_bf16 v[104:107], a[140:143], v[156:159], v[104:107]
    v_fma_f32 v112, v116, 2.0, v112
    v_fma_f32 v113, v117, 2.0, v113
    v_fma_f32 v114, v118, 2.0, v114
    v_fma_f32 v115, v119, 2.0, v115
    v_cndmask_b32 v4, 0, v112, s[44:45]
    v_cndmask_b32 v4, v4, v113, s[46:47]
    v_cndmask_b32 v4, v4, v114, s[48:49]
    v_cndmask_b32 v4, v4, v115, s[50:51]
    v_add_f32 v63, v63, v96
    v_fmac_f32 v64, v88, v92
    v_mfma_f32_16x16x4_f32 v[124:127], v4, v60, v[56:59]
    v_add_f32 v63, v63, v97
    v_fmac_f32 v64, v89, v93
    v_add_f32 v63, v63, v98
    v_fmac_f32 v64, v90, v94
    v_add_f32 v63, v63, v99
    v_fmac_f32 v64, v91, v95
    v_mov_b32 v68, v88
    v_mov_b32 v69, v89
    v_mov_b32 v70, v90
    v_mov_b32 v71, v91
    v_add_u32 v44, 49152, v44
    v_add_u32 v45, 49152, v45
    v_add_u32 v46, 49152, v46
    v_add_u32 v47, 49152, v47
    v_add_u32 v48, 49152, v48
    v_add_u32 v49, 49152, v49
    v_fma_f32 v132, -v108, v108, v124
    v_fma_f32 v133, -v109, v109, v125
    v_fma_f32 v134, -v110, v110, v126
    v_fma_f32 v135, -v111, v111, v127
    v_max_f32 v132, v132, v56
    v_max_f32 v133, v133, v56
    v_max_f32 v134, v134, v56
    v_max_f32 v135, v135, v56
    v_rsq_f32 v132, v132
    v_rsq_f32 v133, v133
    v_rsq_f32 v134, v134
    v_rsq_f32 v135, v135
    s_add_u32 m0, s40, 0
    s_add_u32 s57, s36, 18874368
    buffer_load_dwordx4 v16, s[28:31], s57 offen offset:0 nt lds
    v_fma_f32 v104, -v108, v61, v104
    v_fma_f32 v105, -v109, v61, v105
    v_fma_f32 v106, -v110, v61, v106
    v_fma_f32 v107, -v111, v61, v107
    v_fma_f32 v104, v104, v132, v62
    v_fma_f32 v105, v105, v133, v62
    v_fma_f32 v106, v106, v134, v62
    v_fma_f32 v107, v107, v135, v62
    v_max3_f32 v1, v104, v105, v106
    v_max_f32 v1, v1, v107
    v_cmp_lt_f32 vcc, s52, v1
    s_cbranch_vccnz L_site7
L_back7:
    buffer_load_dwordx4 v17, s[28:31], s57 offen offset:1024 nt lds
    v_exp_f32 v112, v104
    v_exp_f32 v113, v105
    v_exp_f32 v114, v106
    v_exp_f32 v115, v107
    v_cvt_pk_bf16_f32 v72, v88, v89
    v_cvt_pk_bf16_f32 v73, v90, v91
    v_mul_f32 v104, v112, v132
    v_mul_f32 v105, v113, v133
    v_mul_f32 v106, v114, v134
    v_mul_f32 v107, v115, v135
    v_cvt_pk_bf16_f32 v74, v104, v105
    v_cvt_pk_bf16_f32 v75, v106, v107
    ds_write_b128 v237, v[72:75] offset:0
    s_waitcnt lgkmcnt(0)
    s_barrier
L_post27:
    ds_read_b32 v9, v254 offset:4096
    ds_read_b128 v[92:95], v253 offset:0
    ds_read_b128 v[96:99], v253 offset:1024
    ds_read_b128 v[100:103], v253 offset:2048
    ds_read_b128 v[116:119], v253 offset:3072
    s_waitcnt lgkmcnt(4)
    v_cmp_ne_u32 vcc, 0, v9
    s_cbranch_vccnz L_xt27
    s_waitcnt lgkmcnt(3)
    v_mfma_f32_16x16x32_bf16 a[0:3], a[144:147], v[92:95], a[0:3]
    buffer_load_dwordx4 v[180:183], v65, s[72:75], s61 offen offset:1024 sc1
    v_add_f32 v68, v68, v104
    v_add_f32 v69, v69, v105
    v_mfma_f32_16x16x32_bf16 a[4:7], a[160:163], v[92:95], a[4:7]
    buffer_load_dwordx4 v18, s[28:31], s57 offen offset:2048 nt lds
    v_add_f32 v70, v70, v106
    v_add_f32 v71, v71, v107
    v_mfma_f32_16x16x32_bf16 a[8:11], a[176:179], v[92:95], a[8:11]
    buffer_load_dwordx4 v19, s[28:31], s57 offen offset:3072 nt lds
    v_add_f32 v63, v63, v112
    v_fma_f32 v64, v104, v108, v64
    s_waitcnt lgkmcnt(2)
    v_mfma_f32_16x16x32_bf16 a[0:3], a[148:151], v[96:99], a[0:3]
    v_add_f32 v63, v63, v113
    v_fma_f32 v64, v105, v109, v64
    v_mfma_f32_16x16x32_bf16 a[4:7], a[164:167], v[96:99], a[4:7]
    v_add_f32 v63, v63, v114
    v_fma_f32 v64, v106, v110, v64
    v_mfma_f32_16x16x32_bf16 a[8:11], a[180:183], v[96:99], a[8:11]
    v_add_f32 v63, v63, v115
    v_fma_f32 v64, v107, v111, v64
    s_waitcnt lgkmcnt(1)
    v_mfma_f32_16x16x32_bf16 a[0:3], a[152:155], v[100:103], a[0:3]
    v_mfma_f32_16x16x32_bf16 a[4:7], a[168:171], v[100:103], a[4:7]
    v_mfma_f32_16x16x32_bf16 a[8:11], a[184:187], v[100:103], a[8:11]
    s_waitcnt lgkmcnt(0)
    v_mfma_f32_16x16x32_bf16 a[0:3], a[156:159], v[116:119], a[0:3]
    v_mfma_f32_16x16x32_bf16 a[4:7], a[172:175], v[116:119], a[4:7]
    v_mfma_f32_16x16x32_bf16 a[8:11], a[188:191], v[116:119], a[8:11]
    s_add_u32 m0, s40, 4096
    s_nop 0
    buffer_load_dwordx4 v20, s[28:31], s57 offen offset:0 nt lds
    buffer_load_dwordx4 v[184:187], v65, s[72:75], s61 offen offset:2048 sc1
    buffer_load_dwordx4 v21, s[28:31], s57 offen offset:1024 nt lds
    s_add_u32 m0, s41, 0
    s_add_u32 s58, s37, 75497472
    buffer_load_dwordx4 v224, s[24:27], s58 offen offset:0 nt lds
    buffer_load_dwordx4 v[188:191], v65, s[72:75], s61 offen offset:3072 sc1
    s_waitcnt vmcnt(11)
    s_barrier
    ds_read_b128 a[96:99], v40 offset:49152
    ds_read_b128 a[100:103], v41 offset:49152
    ds_read_b128 a[104:107], v42 offset:49152
    ds_read_b128 a[108:111], v43 offset:49152
    ds_read_b128 a[112:115], v40 offset:49408
    ds_read_b128 a[116:119], v41 offset:49408
    ds_read_b128 a[120:123], v42 offset:49408
    ds_read_b128 a[124:127], v43 offset:49408
    ds_read_b128 a[128:131], v40 offset:49664
    ds_read_b128 a[132:135], v41 offset:49664
    ds_read_b128 a[136:139], v42 offset:49664
    ds_read_b128 a[140:143], v43 offset:49664
    s_waitcnt lgkmcnt(11)
    v_mfma_f32_16x16x32_bf16 v[96:99], a[96:99], a[96:99], v[84:87]
    buffer_load_dwordx4 v225, s[24:27], s58 offen offset:1024 nt lds
    ds_read_b64_tr_b16 a[144:145], v44 offset:0
    ds_read_b64_tr_b16 a[146:147], v45 offset:0
    v_mfma_f32_16x16x32_bf16 v[100:103], a[96:99], a[48:51], 0
    ds_read_b64_tr_b16 a[148:149], v44 offset:12288
    ds_read_b64_tr_b16 a[150:151], v45 offset:12288
    s_waitcnt lgkmcnt(14)
    v_mfma_f32_16x16x32_bf16 v[96:99], a[100:103], a[100:103], v[96:99]
    ds_read_b64_tr_b16 a[152:153], v44 offset:24576
    ds_read_b64_tr_b16 a[154:155], v45 offset:24576
    v_mfma_f32_16x16x32_bf16 v[100:103], a[100:103], a[52:55], v[100:103]
    ds_read_b64_tr_b16 a[156:157], v44 offset:36864
    ds_read_b64_tr_b16 a[158:159], v45 offset:36864
    s_waitcnt lgkmcnt(15)
    v_mfma_f32_16x16x32_bf16 v[96:99], a[104:107], a[104:107], v[96:99]
    ds_read_b64_tr_b16 a[160:161], v46 offset:0
    ds_read_b64_tr_b16 a[162:163], v47 offset:0
    v_mfma_f32_16x16x32_bf16 v[100:103], a[104:107], a[56:59], v[100:103]
    s_add_u32 m0, s41, 2048
    s_add_u32 s58, s37, 75497600
    buffer_load_dwordx4 v224, s[24:27], s58 offen offset:0 nt lds
    ds_read_b64_tr_b16 a[164:165], v46 offset:12288
    ds_read_b64_tr_b16 a[166:167], v47 offset:12288
    v_mfma_f32_16x16x32_bf16 v[96:99], a[108:111], a[108:111], v[96:99]
    ds_read_b64_tr_b16 a[168:169], v46 offset:24576
    ds_read_b64_tr_b16 a[170:171], v47 offset:24576
    v_mfma_f32_16x16x32_bf16 v[100:103], a[108:111], a[60:63], v[100:103]
    ds_read_b64_tr_b16 a[172:173], v46 offset:36864
    ds_read_b64_tr_b16 a[174:175], v47 offset:36864
    v_mfma_f32_16x16x32_bf16 v[96:99], a[112:115], a[112:115], v[96:99]
    ds_read_b64_tr_b16 a[176:177], v48 offset:0
    ds_read_b64_tr_b16 a[178:179], v49 offset:0
    v_mfma_f32_16x16x32_bf16 v[100:103], a[112:115], a[64:67], v[100:103]
    ds_read_b64_tr_b16 a[180:181], v48 offset:12288
    ds_read_b64_tr_b16 a[182:183], v49 offset:12288
    s_waitcnt lgkmcnt(15)
    v_mfma_f32_16x16x32_bf16 v[96:99], a[116:119], a[116:119], v[96:99]
    ds_read_b64_tr_b16 a[184:185], v48 offset:24576
    ds_read_b64_tr_b16 a[186:187], v49 offset:24576
    v_mfma_f32_16x16x32_bf16 v[100:103], a[116:119], a[68:71], v[100:103]
    ds_read_b64_tr_b16 a[188:189], v48 offset:36864
    ds_read_b64_tr_b16 a[190:191], v49 offset:36864
    v_mfma_f32_16x16x32_bf16 v[92:95], a[96:99], v[52:55], v[80:83]
    v_mfma_f32_16x16x32_bf16 v[92:95], a[100:103], v[52:55], v[92:95]
    v_mfma_f32_16x16x32_bf16 v[92:95], a[104:107], v[52:55], v[92:95]
    v_mfma_f32_16x16x32_bf16 v[92:95], a[108:111], v[52:55], v[92:95]
    buffer_load_dwordx4 v225, s[24:27], s58 offen offset:1024 nt lds
    s_nop 0
    v_fma_f32 v96, v100, 2.0, v96
    v_fma_f32 v97, v101, 2.0, v97
    v_mfma_f32_16x16x32_bf16 v[92:95], a[112:115], v[52:55], v[92:95]
    s_add_u32 s61, s60, 3153920
    buffer_load_dwordx4 v[192:195], v65, s[72:75], s61 offen offset:0 sc1
    v_fma_f32 v98, v102, 2.0, v98
    v_fma_f32 v99, v103, 2.0, v99
    v_mfma_f32_16x16x32_bf16 v[92:95], a[116:119], v[52:55], v[92:95]
    v_cndmask_b32 v3, 0, v96, s[44:45]
    v_cndmask_b32 v3, v3, v97, s[46:47]
    v_mfma_f32_16x16x32_bf16 v[88:91], a[96:99], v[136:139], v[76:79]
    v_cndmask_b32 v3, v3, v98, s[48:49]
    v_cndmask_b32 v3, v3, v99, s[50:51]
    v_mfma_f32_16x16x32_bf16 v[88:91], a[100:103], v[140:143], v[88:91]
    s_nop 0
    s_nop 0
    v_mfma_f32_16x16x32_bf16 v[88:91], a[104:107], v[144:147], v[88:91]
    v_mfma_f32_16x16x4_f32 v[120:123], v3, v60, v[56:59]
    v_mfma_f32_16x16x32_bf16 v[88:91], a[108:111], v[148:151], v[88:91]
    v_mfma_f32_16x16x32_bf16 v[88:91], a[112:115], v[152:155], v[88:91]
    v_mfma_f32_16x16x32_bf16 v[88:91], a[116:119], v[156:159], v[88:91]
    v_mfma_f32_16x16x32_bf16 v[112:115], a[120:123], a[120:123], v[84:87]
    s_add_u32 m0, s41, 4096
    s_add_u32 s58, s37, 75497728
    buffer_load_dwordx4 v224, s[24:27], s58 offen offset:0 nt lds
    v_mfma_f32_16x16x32_bf16 v[116:119], a[120:123], a[48:51], 0
    v_mfma_f32_16x16x32_bf16 v[112:115], a[124:127], a[124:127], v[112:115]
    v_mfma_f32_16x16x32_bf16 v[116:119], a[124:127], a[52:55], v[116:119]
    v_fma_f32 v128, -v92, v92, v120
    v_fma_f32 v129, -v93, v93, v121
    v_mfma_f32_16x16x32_bf16 v[112:115], a[128:131], a[128:131], v[112:115]
    v_fma_f32 v130, -v94, v94, v122
    v_fma_f32 v131, -v95, v95, v123
    v_mfma_f32_16x16x32_bf16 v[116:119], a[128:131], a[56:59], v[116:119]
    v_max_f32 v128, v128, v56
    v_max_f32 v129, v129, v56
    v_mfma_f32_16x16x32_bf16 v[112:115], a[132:135], a[132:135], v[112:115]
    v_max_f32 v130, v130, v56
    v_max_f32 v131, v131, v56
    v_mfma_f32_16x16x32_bf16 v[116:119], a[132:135], a[60:63], v[116:119]
    v_rsq_f32 v128, v128
    v_mfma_f32_16x16x32_bf16 v[112:115], a[136:139], a[136:139], v[112:115]
    v_rsq_f32 v129, v129
    v_mfma_f32_16x16x32_bf16 v[116:119], a[136:139], a[64:67], v[116:119]
    v_rsq_f32 v130, v130
    v_mfma_f32_16x16x32_bf16 v[112:115], a[140:143], a[140:143], v[112:115]
    v_rsq_f32 v131, v131
    v_mfma_f32_16x16x32_bf16 v[116:119], a[140:143], a[68:71], v[116:119]
    v_fma_f32 v88, -v92, v61, v88
    v_fma_f32 v89, -v93, v61, v89
    v_mfma_f32_16x16x32_bf16 v[108:111], a[120:123], v[52:55], v[80:83]
    buffer_load_dwordx4 v225, s[24:27], s58 offen offset:1024 nt lds
    v_fma_f32 v90, -v94, v61, v90
    v_fma_f32 v91, -v95, v61, v91
    v_mfma_f32_16x16x32_bf16 v[108:111], a[124:127], v[52:55], v[108:111]
    v_fma_f32 v88, v88, v128, v62
    v_fma_f32 v89, v89, v129, v62
    v_mfma_f32_16x16x32_bf16 v[108:111], a[128:131], v[52:55], v[108:111]
    v_fma_f32 v90, v90, v130, v62
    v_fma_f32 v91, v91, v131, v62
    v_mfma_f32_16x16x32_bf16 v[108:111], a[132:135], v[52:55], v[108:111]
    v_max3_f32 v1, v88, v89, v90
    v_max_f32 v1, v1, v91
    v_mfma_f32_16x16x32_bf16 v[108:111], a[136:139], v[52:55], v[108:111]
    v_cmp_lt_f32 vcc, s52, v1
    s_cbranch_vccnz L_site8
L_back8:
    v_mfma_f32_16x16x32_bf16 v[108:111], a[140:143], v[52:55], v[108:111]
    v_exp_f32 v96, v88
    v_mfma_f32_16x16x32_bf16 v[104:107], a[120:123], v[136:139], v[76:79]
    v_exp_f32 v97, v89
    v_mfma_f32_16x16x32_bf16 v[104:107], a[124:127], v[140:143], v[104:107]
    v_exp_f32 v98, v90
    v_mfma_f32_16x16x32_bf16 v[104:107], a[128:131], v[144:147], v[104:107]
    v_exp_f32 v99, v91
    v_mfma_f32_16x16x32_bf16 v[104:107], a[132:135], v[148:151], v[104:107]
    v_mul_f32 v88, v96, v128
    v_mul_f32 v89, v97, v129
    v_mfma_f32_16x16x32_bf16 v[104:107], a[136:139], v[152:155], v[104:107]
    v_mul_f32 v90, v98, v130
    v_mul_f32 v91, v99, v131
    v_mfma_f32_16x16x32_bf16 v[104:107], a[140:143], v[156:159], v[104:107]
    v_fma_f32 v112, v116, 2.0, v112
    v_fma_f32 v113, v117, 2.0, v113
    v_fma_f32 v114, v118, 2.0, v114
    v_fma_f32 v115, v119, 2.0, v115
    v_cndmask_b32 v4, 0, v112, s[44:45]
    v_cndmask_b32 v4, v4, v113, s[46:47]
    v_cndmask_b32 v4, v4, v114, s[48:49]
    v_cndmask_b32 v4, v4, v115, s[50:51]
    v_add_f32 v63, v63, v96
    v_fmac_f32 v64, v88, v92
    v_mfma_f32_16x16x4_f32 v[124:127], v4, v60, v[56:59]
    v_add_f32 v63, v63, v97
    v_fmac_f32 v64, v89, v93
    v_add_f32 v63, v63, v98
    v_fmac_f32 v64, v90, v94
    v_add_f32 v63, v63, v99
    v_fmac_f32 v64, v91, v95
    v_add_f32 v68, v68, v88
    v_add_f32 v69, v69, v89
    v_add_f32 v70, v70, v90
    v_add_f32 v71, v71, v91
    v_add_u32 v44, -49152, v44
    v_add_u32 v45, -49152, v45
    v_add_u32 v46, -49152, v46
    v_add_u32 v47, -49152, v47
    v_add_u32 v48, -49152, v48
    v_add_u32 v49, -49152, v49
    v_fma_f32 v132, -v108, v108, v124
    v_fma_f32 v133, -v109, v109, v125
    v_fma_f32 v134, -v110, v110, v126
    v_fma_f32 v135, -v111, v111, v127
    v_max_f32 v132, v132, v56
    v_max_f32 v133, v133, v56
    v_max_f32 v134, v134, v56
    v_max_f32 v135, v135, v56
    v_rsq_f32 v132, v132
    v_rsq_f32 v133, v133
    v_rsq_f32 v134, v134
    v_rsq_f32 v135, v135
    buffer_load_dwordx4 v[196:199], v65, s[72:75], s61 offen offset:1024 sc1
    v_fma_f32 v104, -v108, v61, v104
    v_fma_f32 v105, -v109, v61, v105
    v_fma_f32 v106, -v110, v61, v106
    v_fma_f32 v107, -v111, v61, v107
    v_fma_f32 v104, v104, v132, v62
    v_fma_f32 v105, v105, v133, v62
    v_fma_f32 v106, v106, v134, v62
    v_fma_f32 v107, v107, v135, v62
    v_max3_f32 v1, v104, v105, v106
    v_max_f32 v1, v1, v107
    v_cmp_lt_f32 vcc, s52, v1
    s_cbranch_vccnz L_site9
L_back9:
    s_add_u32 m0, s41, 6144
    s_add_u32 s58, s37, 75497856
    buffer_load_dwordx4 v224, s[24:27], s58 offen offset:0 nt lds
    v_exp_f32 v112, v104
    v_exp_f32 v113, v105
    v_exp_f32 v114, v106
    v_exp_f32 v115, v107
    v_cvt_pk_bf16_f32 v72, v88, v89
    v_cvt_pk_bf16_f32 v73, v90, v91
    v_mul_f32 v104, v112, v132
    v_mul_f32 v105, v113, v133
    v_mul_f32 v106, v114, v134
    v_mul_f32 v107, v115, v135
    v_cvt_pk_bf16_f32 v74, v104, v105
    v_cvt_pk_bf16_f32 v75, v106, v107
    ds_write_b128 v237, v[72:75] offset:0
    v_add_f32 v68, v68, v104
    v_add_f32 v69, v69, v105
    v_add_f32 v70, v70, v106
    v_add_f32 v71, v71, v107
    v_cvt_pk_bf16_f32 v66, v68, v69
    v_cvt_pk_bf16_f32 v67, v70, v71
    ds_write_b64 v238, v[66:67]
    s_lshl_b32 s56, s3, 13
    v_lshl_add_u32 v233, v0, 7, s56
    v_min_u32 v233, L_hot - L_tail, v233
    v_add_u32 v233, L_tail - L_pc_main, v233
    global_load_dword v234, v233, s[100:101]
    buffer_load_dwordx4 v225, s[24:27], s58 offen offset:1024 nt lds
    s_add_u32 m0, s41, 8192
    s_add_u32 s58, s37, 75497984
    buffer_load_dwordx4 v224, s[24:27], s58 offen offset:0 nt lds
    s_waitcnt vmcnt(13)
    s_waitcnt lgkmcnt(0)
    s_barrier
L_post9:
    ds_read_b32 v9, v254 offset:4096
    ds_read_b64 v[120:121], v254 offset:0
    ds_read_b64 v[122:123], v254 offset:512
    ds_read_b64 v[124:125], v254 offset:1024
    ds_read_b64 v[126:127], v254 offset:1536
    ds_read_b128 v[92:95], v253 offset:0
    ds_read_b128 v[96:99], v253 offset:1024
    ds_read_b128 v[100:103], v253 offset:2048
    ds_read_b128 v[116:119], v253 offset:3072
    ds_read_b128 a[48:51], v34 offset:0
    ds_read_b128 a[52:55], v35 offset:0
    ds_read_b128 a[56:59], v34 offset:128
    ds_read_b128 a[60:63], v35 offset:128
    ds_read_b128 a[64:67], v34 offset:256
    ds_read_b128 a[68:71], v35 offset:256
    s_waitcnt lgkmcnt(14)
    v_cmp_ne_u32 vcc, 0, v9
    s_cbranch_vccnz L_xt9
    s_waitcnt lgkmcnt(12)
    v_mfma_f32_16x16x32_bf16 a[0:3], a[72:75], v[120:123], a[0:3]
    buffer_load_dwordx4 v[200:203], v65, s[72:75], s61 offen offset:2048 sc1
    v_add_f32 v63, v63, v112
    v_fma_f32 v64, v104, v108, v64
    v_mfma_f32_16x16x32_bf16 a[4:7], a[80:83], v[120:123], a[4:7]
    v_add_f32 v63, v63, v113
    v_fma_f32 v64, v105, v109, v64
    v_mfma_f32_16x16x32_bf16 a[8:11], a[88:91], v[120:123], a[8:11]
    v_add_f32 v63, v63, v114
    v_fma_f32 v64, v106, v110, v64
    s_waitcnt lgkmcnt(10)
    v_mfma_f32_16x16x32_bf16 a[0:3], a[76:79], v[124:127], a[0:3]
    v_add_f32 v63, v63, v115
    v_fma_f32 v64, v107, v111, v64
    v_mfma_f32_16x16x32_bf16 a[4:7], a[84:87], v[124:127], a[4:7]
    v_mfma_f32_16x16x32_bf16 a[8:11], a[92:95], v[124:127], a[8:11]
    s_waitcnt lgkmcnt(9)
    v_mfma_f32_16x16x32_bf16 a[0:3], a[144:147], v[92:95], a[0:3]
    ds_read_b64_tr_b16 a[72:73], v36 offset:0
    ds_read_b64_tr_b16 a[74:75], v36 offset:6144
    v_mfma_f32_16x16x32_bf16 a[4:7], a[160:163], v[92:95], a[4:7]
    ds_read_b64_tr_b16 a[76:77], v36 offset:12288
    ds_read_b64_tr_b16 a[78:79], v36 offset:18432
    v_mfma_f32_16x16x32_bf16 a[8:11], a[176:179], v[92:95], a[8:11]
    ds_read_b64_tr_b16 a[80:81], v37 offset:0
    ds_read_b64_tr_b16 a[82:83], v37 offset:6144
    s_waitcnt lgkmcnt(14)
    v_mfma_f32_16x16x32_bf16 a[0:3], a[148:151], v[96:99], a[0:3]
    ds_read_b64_tr_b16 a[84:85], v37 offset:12288
    ds_read_b64_tr_b16 a[86:87], v37 offset:18432
    v_mfma_f32_16x16x32_bf16 a[4:7], a[164:167], v[96:99], a[4:7]
    ds_read_b64_tr_b16 a[88:89], v38 offset:0
    ds_read_b64_tr_b16 a[90:91], v38 offset:6144
    v_mfma_f32_16x16x32_bf16 a[8:11], a[180:183], v[96:99], a[8:11]
    buffer_load_dwordx4 v225, s[24:27], s58 offen offset:1024 nt lds
    ds_read_b64_tr_b16 a[92:93], v38 offset:12288
    ds_read_b64_tr_b16 a[94:95], v38 offset:18432
    s_waitcnt lgkmcnt(15)
    v_mfma_f32_16x16x32_bf16 a[0:3], a[152:155], v[100:103], a[0:3]
    v_mfma_f32_16x16x32_bf16 a[4:7], a[168:171], v[100:103], a[4:7]
    v_mfma_f32_16x16x32_bf16 a[8:11], a[184:187], v[100:103], a[8:11]
    v_mfma_f32_16x16x32_bf16 a[0:3], a[156:159], v[116:119], a[0:3]
    v_mfma_f32_16x16x32_bf16 a[4:7], a[172:175], v[116:119], a[4:7]
    v_mfma_f32_16x16x32_bf16 a[8:11], a[188:191], v[116:119], a[8:11]
    v_mfma_f32_16x16x32_bf16 v[84:87], a[48:51], a[48:51], 0
    v_mfma_f32_16x16x32_bf16 v[80:83], a[48:51], v[52:55], 0
    v_mfma_f32_16x16x32_bf16 v[84:87], a[52:55], a[52:55], v[84:87]
    v_mfma_f32_16x16x32_bf16 v[80:83], a[52:55], v[52:55], v[80:83]
    v_mfma_f32_16x16x32_bf16 v[84:87], a[56:59], a[56:59], v[84:87]
    v_mfma_f32_16x16x32_bf16 v[80:83], a[56:59], v[52:55], v[80:83]
    s_waitcnt lgkmcnt(14)
    v_mfma_f32_16x16x32_bf16 v[84:87], a[60:63], a[60:63], v[84:87]
    s_add_u32 m0, s41, 10240
    s_add_u32 s58, s37, 75498112
    buffer_load_dwordx4 v224, s[24:27], s58 offen offset:0 nt lds
    v_mfma_f32_16x16x32_bf16 v[80:83], a[60:63], v[52:55], v[80:83]
    buffer_load_dwordx4 v[204:207], v65, s[72:75], s61 offen offset:3072 sc1
    s_waitcnt lgkmcnt(13)
    v_mfma_f32_16x16x32_bf16 v[84:87], a[64:67], a[64:67], v[84:87]
    v_mfma_f32_16x16x32_bf16 v[80:83], a[64:67], v[52:55], v[80:83]
    s_waitcnt lgkmcnt(12)
    v_mfma_f32_16x16x32_bf16 v[84:87], a[68:71], a[68:71], v[84:87]
    v_mfma_f32_16x16x32_bf16 v[80:83], a[68:71], v[52:55], v[80:83]
    s_waitcnt lgkmcnt(0)
    v_mfma_f32_16x16x32_bf16 v[76:79], a[48:51], v[136:139], 0
    v_mfma_f32_16x16x32_bf16 v[76:79], a[52:55], v[140:143], v[76:79]
    v_mfma_f32_16x16x32_bf16 v[76:79], a[56:59], v[144:147], v[76:79]
    v_mfma_f32_16x16x32_bf16 v[76:79], a[60:63], v[148:151], v[76:79]
    v_mfma_f32_16x16x32_bf16 v[76:79], a[64:67], v[152:155], v[76:79]
    v_mfma_f32_16x16x32_bf16 v[76:79], a[68:71], v[156:159], v[76:79]
    buffer_load_dwordx4 v225, s[24:27], s58 offen offset:1024 nt lds
    s_mul_i32 s28, s3, 262144
    s_and_b32 s56, s2, 7
    s_lshl_b32 s56, s56, 10
    s_add_u32 s28, s28, s56
    s_bfe_u32 s56, s2, 0x30003
    s_lshl_b32 s56, s56, 7
    s_add_u32 s28, s28, s56
    s_lshr_b32 s56, s2, 6
    s_lshl_b32 s56, s56, 14
    s_add_u32 s28, s28, s56
    s_add_u32 s28, s28, 8388608
    v_lshrrev_b32 v1, 3, v0
    s_xor_b32 s56, s1, s3
    v_xor_b32 v1, s56, v1
    v_and_b32 v1, 1, v1
    v_lshl_or_b32 v242, v1, 13, v242
    s_sub_u32 s29, s2, 64
    s_lshr_b32 s29, s29, 4
    s_and_b32 s56, s2, 7
    s_lshl3_add_u32 s29, s29, s56
    s_mul_i32 s30, s29, 65536
    s_lshl_b32 s56, s3, 14
    s_add_u32 s30, s30, s56
    s_add_u32 s30, s30, 8388608
    s_lshr_b32 s56, s29, 5
    s_xor_b32 s56, s56, s1
    s_lshr_b32 s57, s29, 2
    s_xor_b32 s56, s56, s57
    s_and_b32 s56, s56, 1
    s_lshl_b32 s56, s56, 13
    s_add_u32 s30, s30, s56
    s_add_u32 s31, s30, 4096
    v_mov_b32 v28, v242
    v_bfe_u32 v1, v0, 4, 1
    v_mul_u32_u24 v2, 65536, v1
    v_mul_u32_u24 v1, 0x10, v1
    v_xor_b32 v242, v242, v1
    v_sub_u32 v242, v242, v2
    v_add_u32 v243, 65536, v242
    s_bfe_u32 s56, s2, 0x10003
    s_lshl_b32 s56, s56, 6
    v_lshrrev_b32 v1, 2, v0
    v_and_b32 v2, 48, v65
    v_lshl_add_u32 v1, v1, 7, v2
    v_add_u32 v29, s56, v1
    v_mov_b32 v232, 0x53800000
    s_mov_b32 s43, 1
    s_mov_b32 s68, s18
    s_mov_b32 s69, s19
    s_mov_b32 s70, 6144
    s_mov_b32 s71, 0x20000
L_tail:
    v_and_b32 v1, 15, v0
    v_lshlrev_b32 v1, 8, v1
    v_sub_u32 v1, v34, v1
    v_lshrrev_b32 v2, 2, v0
    v_lshlrev_b32 v2, 8, v2
    s_sub_u32 s56, s41, s40
    v_add_u32 v40, s56, v1
    v_xor_b32 v41, 64, v40
    s_sub_u32 s56, s42, s40
    v_add_u32 v42, s56, v1
    v_xor_b32 v43, 64, v42
    s_mul_i32 s56, s3, 3
    s_add_u32 s57, s56, 0
    s_lshr_b32 s57, s57, 2
    s_mul_i32 s57, s57, 1920
    s_add_u32 s57, s57, 24576
    v_sub_u32 v44, v36, v2
    v_add_u32 v44, s57, v44
    v_add_u32 v47, 49152, v44
    s_add_u32 s57, s56, 1
    s_lshr_b32 s57, s57, 2
    s_mul_i32 s57, s57, 1920
    s_add_u32 s57, s57, 24576
    v_sub_u32 v45, v37, v2
    v_add_u32 v45, s57, v45
    v_add_u32 v48, 49152, v45
    s_add_u32 s57, s56, 2
    s_lshr_b32 s57, s57, 2
    s_mul_i32 s57, s57, 1920
    s_add_u32 s57, s57, 24576
    v_sub_u32 v46, v38, v2
    v_add_u32 v46, s57, v46
    v_add_u32 v49, 49152, v46
    v_accvgpr_read_b32 v16, a0
    v_accvgpr_read_b32 v17, a1
    v_accvgpr_read_b32 v18, a2
    v_accvgpr_read_b32 v19, a3
    v_accvgpr_read_b32 v20, a4
    v_accvgpr_read_b32 v21, a5
    v_accvgpr_read_b32 v22, a6
    v_accvgpr_read_b32 v23, a7
    v_accvgpr_read_b32 v24, a8
    v_accvgpr_read_b32 v25, a9
    v_accvgpr_read_b32 v26, a10
    v_accvgpr_read_b32 v27, a11
    s_add_u32 m0, s42, 0
    s_add_u32 s59, s37, 75694080
    buffer_load_dwordx4 v224, s[24:27], s59 offen offset:0 nt lds
    buffer_load_dwordx4 v225, s[24:27], s59 offen offset:1024 nt lds
    s_add_u32 m0, s42, 2048
    s_add_u32 s59, s37, 75694208
    buffer_load_dwordx4 v224, s[24:27], s59 offen offset:0 nt lds
    buffer_load_dwordx4 v225, s[24:27], s59 offen offset:1024 nt lds
    s_waitcnt vmcnt(14)
    s_barrier
    ds_read_b128 a[96:99], v40 offset:0
    ds_read_b128 a[100:103], v41 offset:0
    ds_read_b128 a[104:107], v40 offset:2048
    ds_read_b128 a[108:111], v41 offset:2048
    ds_read_b128 a[112:115], v40 offset:4096
    ds_read_b128 a[116:119], v41 offset:4096
    s_waitcnt lgkmcnt(5)
    v_mfma_f32_16x16x32_bf16 v[96:99], a[96:99], a[96:99], v[84:87]
    s_add_u32 m0, s42, 4096
    s_add_u32 s59, s37, 75694336
    buffer_load_dwordx4 v224, s[24:27], s59 offen offset:0 nt lds
    ds_read_b64_tr_b16 a[144:145], v44 offset:0
    ds_read_b64_tr_b16 a[148:149], v44 offset:12288
    v_mfma_f32_16x16x32_bf16 v[100:103], a[96:99], a[48:51], 0
    ds_read_b64_tr_b16 a[152:153], v44 offset:24576
    ds_read_b64_tr_b16 a[156:157], v44 offset:36864
    s_waitcnt lgkmcnt(8)
    v_mfma_f32_16x16x32_bf16 v[96:99], a[100:103], a[100:103], v[96:99]
    ds_read_b64_tr_b16 a[160:161], v45 offset:0
    ds_read_b64_tr_b16 a[164:165], v45 offset:12288
    v_mfma_f32_16x16x32_bf16 v[100:103], a[100:103], a[52:55], v[100:103]
    ds_read_b64_tr_b16 a[168:169], v45 offset:24576
    ds_read_b64_tr_b16 a[172:173], v45 offset:36864
    s_waitcnt lgkmcnt(11)
    v_mfma_f32_16x16x32_bf16 v[96:99], a[104:107], a[104:107], v[96:99]
    ds_read_b64_tr_b16 a[176:177], v46 offset:0
    ds_read_b64_tr_b16 a[180:181], v46 offset:12288
    v_mfma_f32_16x16x32_bf16 v[100:103], a[104:107], a[56:59], v[100:103]
    ds_read_b64_tr_b16 a[184:185], v46 offset:24576
    ds_read_b64_tr_b16 a[188:189], v46 offset:36864
    s_waitcnt lgkmcnt(14)
    v_mfma_f32_16x16x32_bf16 v[96:99], a[108:111], a[108:111], v[96:99]
    v_mfma_f32_16x16x32_bf16 v[100:103], a[108:111], a[60:63], v[100:103]
    s_waitcnt lgkmcnt(13)
    v_mfma_f32_16x16x32_bf16 v[96:99], a[112:115], a[112:115], v[96:99]
    v_mfma_f32_16x16x32_bf16 v[100:103], a[112:115], a[64:67], v[100:103]
    buffer_load_dwordx4 v225, s[24:27], s59 offen offset:1024 nt lds
    s_waitcnt lgkmcnt(12)
    v_mfma_f32_16x16x32_bf16 v[96:99], a[116:119], a[116:119], v[96:99]
    s_add_u32 m0, s42, 6144
    s_add_u32 s59, s37, 75694464
    buffer_load_dwordx4 v224, s[24:27], s59 offen offset:0 nt lds
    v_mfma_f32_16x16x32_bf16 v[100:103], a[116:119], a[68:71], v[100:103]
    v_mfma_f32_16x16x32_bf16 v[92:95], a[96:99], v[52:55], v[80:83]
    v_mfma_f32_16x16x32_bf16 v[92:95], a[100:103], v[52:55], v[92:95]
    v_mfma_f32_16x16x32_bf16 v[92:95], a[104:107], v[52:55], v[92:95]
    v_mfma_f32_16x16x32_bf16 v[92:95], a[108:111], v[52:55], v[92:95]
    s_nop 3
    v_fma_f32 v96, v100, 2.0, v96
    v_fma_f32 v97, v101, 2.0, v97
    v_mfma_f32_16x16x32_bf16 v[92:95], a[112:115], v[52:55], v[92:95]
    v_fma_f32 v98, v102, 2.0, v98
    v_fma_f32 v99, v103, 2.0, v99
    v_mfma_f32_16x16x32_bf16 v[92:95], a[116:119], v[52:55], v[92:95]
    v_cndmask_b32 v3, 0, v96, s[44:45]
    v_cndmask_b32 v3, v3, v97, s[46:47]
    v_mfma_f32_16x16x32_bf16 v[88:91], a[96:99], v[136:139], v[76:79]
    v_cndmask_b32 v3, v3, v98, s[48:49]
    v_cndmask_b32 v3, v3, v99, s[50:51]
    v_mfma_f32_16x16x32_bf16 v[88:91], a[100:103], v[140:143], v[88:91]
    s_nop 0
    s_nop 0
    v_mfma_f32_16x16x32_bf16 v[88:91], a[104:107], v[144:147], v[88:91]
    buffer_load_dwordx4 v225, s[24:27], s59 offen offset:1024 nt lds
    v_mfma_f32_16x16x4_f32 v[120:123], v3, v60, v[56:59]
    v_mfma_f32_16x16x32_bf16 v[88:91], a[108:111], v[148:151], v[88:91]
    v_mfma_f32_16x16x32_bf16 v[88:91], a[112:115], v[152:155], v[88:91]
    v_mfma_f32_16x16x32_bf16 v[88:91], a[116:119], v[156:159], v[88:91]
    s_nop 6
    v_fma_f32 v128, -v92, v92, v120
    v_fma_f32 v129, -v93, v93, v121
    v_fma_f32 v130, -v94, v94, v122
    v_fma_f32 v131, -v95, v95, v123
    v_max_f32 v128, v128, v56
    v_max_f32 v129, v129, v56
    v_max_f32 v130, v130, v56
    v_max_f32 v131, v131, v56
    v_rsq_f32 v128, v128
    v_rsq_f32 v129, v129
    v_rsq_f32 v130, v130
    v_rsq_f32 v131, v131
    v_fma_f32 v88, -v92, v61, v88
    v_fma_f32 v89, -v93, v61, v89
    v_fma_f32 v90, -v94, v61, v90
    v_fma_f32 v91, -v95, v61, v91
    v_fma_f32 v88, v88, v128, v62
    v_fma_f32 v89, v89, v129, v62
    v_fma_f32 v90, v90, v130, v62
    v_fma_f32 v91, v91, v131, v62
    v_max3_f32 v1, v88, v89, v90
    v_max_f32 v1, v1, v91
    v_cmp_lt_f32 vcc, s52, v1
    s_cbranch_vccnz L_site10
L_back10:
    v_exp_f32 v96, v88
    s_add_u32 m0, s42, 8192
    s_add_u32 s59, s37, 75694592
    buffer_load_dwordx4 v224, s[24:27], s59 offen offset:0 nt lds
    v_exp_f32 v97, v89
    v_exp_f32 v98, v90
    v_exp_f32 v99, v91
    v_mul_f32 v88, v96, v128
    v_mul_f32 v89, v97, v129
    v_mul_f32 v90, v98, v130
    buffer_load_dwordx4 v225, s[24:27], s59 offen offset:1024 nt lds
    v_mul_f32 v91, v99, v131
    v_add_f32 v63, v63, v96
    v_fmac_f32 v64, v88, v92
    v_add_f32 v63, v63, v97
    v_fmac_f32 v64, v89, v93
    v_add_f32 v63, v63, v98
    v_fmac_f32 v64, v90, v94
    v_add_f32 v63, v63, v99
    v_fmac_f32 v64, v91, v95
    v_mov_b32 v68, v88
    v_mov_b32 v69, v89
    v_mov_b32 v70, v90
    v_mov_b32 v71, v91
    s_waitcnt vmcnt(16)
    ds_read_b128 a[120:123], v40 offset:6144
    ds_read_b128 a[124:127], v41 offset:6144
    s_waitcnt lgkmcnt(1)
    v_mfma_f32_16x16x32_bf16 v[112:115], a[120:123], a[120:123], v[84:87]
    s_add_u32 m0, s42, 10240
    s_add_u32 s59, s37, 75694720
    buffer_load_dwordx4 v224, s[24:27], s59 offen offset:0 nt lds
    v_mfma_f32_16x16x32_bf16 v[116:119], a[120:123], a[48:51], 0
    s_waitcnt lgkmcnt(0)
    v_mfma_f32_16x16x32_bf16 v[112:115], a[124:127], a[124:127], v[112:115]
    v_mfma_f32_16x16x32_bf16 v[116:119], a[124:127], a[52:55], v[116:119]
    v_mfma_f32_16x16x32_bf16 v[108:111], a[120:123], v[52:55], v[80:83]
    v_mfma_f32_16x16x32_bf16 v[104:107], a[120:123], v[136:139], v[76:79]
    s_waitcnt vmcnt(14)
    ds_read_b128 a[128:131], v40 offset:8192
    ds_read_b128 a[132:135], v41 offset:8192
    v_mfma_f32_16x16x32_bf16 v[108:111], a[124:127], v[52:55], v[108:111]
    v_mfma_f32_16x16x32_bf16 v[104:107], a[124:127], v[140:143], v[104:107]
    s_waitcnt lgkmcnt(1)
    v_mfma_f32_16x16x32_bf16 v[112:115], a[128:131], a[128:131], v[112:115]
    v_mfma_f32_16x16x32_bf16 v[116:119], a[128:131], a[56:59], v[116:119]
    s_waitcnt lgkmcnt(0)
    v_mfma_f32_16x16x32_bf16 v[112:115], a[132:135], a[132:135], v[112:115]
    v_mfma_f32_16x16x32_bf16 v[116:119], a[132:135], a[60:63], v[116:119]
    v_mfma_f32_16x16x32_bf16 v[108:111], a[128:131], v[52:55], v[108:111]
    buffer_load_dwordx4 v225, s[24:27], s59 offen offset:1024 nt lds
    v_mfma_f32_16x16x32_bf16 v[104:107], a[128:131], v[144:147], v[104:107]
    s_waitcnt vmcnt(12)
    ds_read_b128 a[136:139], v40 offset:10240
    ds_read_b128 a[140:143], v41 offset:10240
    s_barrier
    s_add_u32 s61, s60, 3158016
    buffer_load_dwordx4 v[208:211], v65, s[32:35], s61 offen offset:0 sc1
    v_mfma_f32_16x16x32_bf16 v[108:111], a[132:135], v[52:55], v[108:111]
    ds_read_b64_tr_b16 a[146:147], v44 offset:6144
    v_mfma_f32_16x16x32_bf16 v[104:107], a[132:135], v[148:151], v[104:107]
    ds_read_b64_tr_b16 a[150:151], v44 offset:18432
    s_waitcnt lgkmcnt(3)
    v_mfma_f32_16x16x32_bf16 v[112:115], a[136:139], a[136:139], v[112:115]
    ds_read_b64_tr_b16 a[154:155], v44 offset:30720
    v_mfma_f32_16x16x32_bf16 v[116:119], a[136:139], a[64:67], v[116:119]
    ds_read_b64_tr_b16 a[158:159], v44 offset:43008
    s_waitcnt lgkmcnt(4)
    v_mfma_f32_16x16x32_bf16 v[112:115], a[140:143], a[140:143], v[112:115]
    ds_read_b64_tr_b16 a[162:163], v45 offset:6144
    v_mfma_f32_16x16x32_bf16 v[116:119], a[140:143], a[68:71], v[116:119]
    ds_read_b64_tr_b16 a[166:167], v45 offset:18432
    v_mfma_f32_16x16x32_bf16 v[108:111], a[136:139], v[52:55], v[108:111]
    ds_read_b64_tr_b16 a[170:171], v45 offset:30720
    v_mfma_f32_16x16x32_bf16 v[108:111], a[140:143], v[52:55], v[108:111]
    ds_read_b64_tr_b16 a[174:175], v45 offset:43008
    s_nop 2
    v_fma_f32 v112, v116, 2.0, v112
    v_fma_f32 v113, v117, 2.0, v113
    v_fma_f32 v114, v118, 2.0, v114
    v_fma_f32 v115, v119, 2.0, v115
    v_cndmask_b32 v4, 0, v112, s[44:45]
    v_cndmask_b32 v4, v4, v113, s[46:47]
    v_cndmask_b32 v4, v4, v114, s[48:49]
    v_cndmask_b32 v4, v4, v115, s[50:51]
    ds_read_b64_tr_b16 a[178:179], v46 offset:6144
    ds_read_b64_tr_b16 a[182:183], v46 offset:18432
    v_mfma_f32_16x16x4_f32 v[124:127], v4, v60, v[56:59]
    ds_read_b64_tr_b16 a[186:187], v46 offset:30720
    ds_read_b64_tr_b16 a[190:191], v46 offset:43008
    buffer_load_dwordx4 v[212:215], v65, s[32:35], s61 offen offset:1024 sc1
    s_nop 5
    v_mfma_f32_16x16x32_bf16 v[104:107], a[136:139], v[152:155], v[104:107]
    v_fma_f32 v132, -v108, v108, v124
    v_fma_f32 v133, -v109, v109, v125
    v_mfma_f32_16x16x32_bf16 v[104:107], a[140:143], v[156:159], v[104:107]
    v_fma_f32 v134, -v110, v110, v126
    v_fma_f32 v135, -v111, v111, v127
    v_max_f32 v132, v132, v56
    v_max_f32 v133, v133, v56
    v_max_f32 v134, v134, v56
    v_max_f32 v135, v135, v56
    v_rsq_f32 v132, v132
    v_rsq_f32 v133, v133
    v_rsq_f32 v134, v134
    v_rsq_f32 v135, v135
    v_pk_fma_f32 v[104:105], v[108:109], v[60:61], v[104:105] op_sel:[0,1,0] neg_lo:[1,0,0] neg_hi:[1,0,0]
    v_pk_fma_f32 v[106:107], v[110:111], v[60:61], v[106:107] op_sel:[0,1,0] neg_lo:[1,0,0] neg_hi:[1,0,0]
    v_pk_fma_f32 v[104:105], v[104:105], v[132:133], v[62:63] op_sel_hi:[1,1,0]
    v_pk_fma_f32 v[106:107], v[106:107], v[134:135], v[62:63] op_sel_hi:[1,1,0]
L_back11:
    v_max3_f32 v1, v104, v105, v106
    v_max_f32 v1, v1, v107
    v_cmp_lt_f32 vcc, s52, v1
    v_exp_f32 v112, v104
    v_exp_f32 v113, v105
    v_exp_f32 v114, v106
    v_exp_f32 v115, v107
    s_cbranch_vccnz L_site11
    v_cvt_pk_bf16_f32 v72, v88, v89
    v_cvt_pk_bf16_f32 v73, v90, v91
    v_pk_mul_f32 v[104:105], v[112:113], v[132:133]
    v_pk_mul_f32 v[106:107], v[114:115], v[134:135]
    v_cvt_pk_bf16_f32 v74, v104, v105
    v_cvt_pk_bf16_f32 v75, v106, v107
    ds_write_b128 v237, v[72:75] offset:12288
    s_waitcnt lgkmcnt(0)
    s_barrier
    ds_read_b32 v9, v254 offset:4100
    ds_read_b128 a[192:195], v253 offset:12288
    ds_read_b128 a[196:199], v253 offset:13312
    ds_read_b128 a[200:203], v253 offset:14336
    ds_read_b128 a[204:207], v253 offset:15360
    buffer_load_dwordx4 v[216:219], v65, s[32:35], s61 offen offset:2048 sc1
    s_waitcnt lgkmcnt(4)
    v_cmp_ne_u32 vcc, 0, v9
    s_cbranch_vccnz L_xt11
L_post11:
    s_waitcnt lgkmcnt(3)
    v_mfma_f32_16x16x32_bf16 v[16:19], a[144:147], a[192:195], v[16:19]
    v_add_f32 v68, v68, v104
    v_add_f32 v69, v69, v105
    v_mfma_f32_16x16x32_bf16 v[20:23], a[160:163], a[192:195], v[20:23]
    v_add_f32 v70, v70, v106
    v_add_f32 v71, v71, v107
    v_mfma_f32_16x16x32_bf16 v[24:27], a[176:179], a[192:195], v[24:27]
    v_add_f32 v63, v63, v112
    v_fma_f32 v64, v104, v108, v64
    s_waitcnt lgkmcnt(2)
    v_mfma_f32_16x16x32_bf16 v[16:19], a[148:151], a[196:199], v[16:19]
    s_waitcnt vmcnt(13)
    ds_read_b128 a[96:99], v42 offset:0
    ds_read_b128 a[100:103], v43 offset:0
    v_mfma_f32_16x16x32_bf16 v[20:23], a[164:167], a[196:199], v[20:23]
    v_add_f32 v63, v63, v113
    v_fma_f32 v64, v105, v109, v64
    v_mfma_f32_16x16x32_bf16 v[24:27], a[180:183], a[196:199], v[24:27]
    v_add_f32 v63, v63, v114
    v_fma_f32 v64, v106, v110, v64
    s_waitcnt lgkmcnt(3)
    v_mfma_f32_16x16x32_bf16 v[16:19], a[152:155], a[200:203], v[16:19]
    v_add_f32 v63, v63, v115
    v_fma_f32 v64, v107, v111, v64
    v_mfma_f32_16x16x32_bf16 v[20:23], a[168:171], a[200:203], v[20:23]
    s_waitcnt vmcnt(11)
    ds_read_b128 a[104:107], v42 offset:2048
    ds_read_b128 a[108:111], v43 offset:2048
    v_mfma_f32_16x16x32_bf16 v[24:27], a[184:187], a[200:203], v[24:27]
    s_waitcnt lgkmcnt(4)
    v_mfma_f32_16x16x32_bf16 v[16:19], a[156:159], a[204:207], v[16:19]
    v_mfma_f32_16x16x32_bf16 v[20:23], a[172:175], a[204:207], v[20:23]
    v_mfma_f32_16x16x32_bf16 v[24:27], a[188:191], a[204:207], v[24:27]
    s_waitcnt lgkmcnt(3)
    v_mfma_f32_16x16x32_bf16 v[96:99], a[96:99], a[96:99], v[84:87]
    v_mfma_f32_16x16x32_bf16 v[100:103], a[96:99], a[48:51], 0
    s_waitcnt lgkmcnt(2)
    v_mfma_f32_16x16x32_bf16 v[96:99], a[100:103], a[100:103], v[96:99]
    v_mfma_f32_16x16x32_bf16 v[100:103], a[100:103], a[52:55], v[100:103]
    s_waitcnt vmcnt(9)
    ds_read_b128 a[112:115], v42 offset:4096
    ds_read_b128 a[116:119], v43 offset:4096
    s_barrier
    v_mfma_f32_16x16x32_bf16 v[92:95], a[96:99], v[52:55], v[80:83]
    buffer_load_dwordx4 v[220:223], v65, s[32:35], s61 offen offset:3072 sc1
    ds_read_b64_tr_b16 a[0:1], v47 offset:0
    v_mfma_f32_16x16x32_bf16 v[88:91], a[96:99], v[136:139], v[76:79]
    ds_read_b64_tr_b16 a[4:5], v47 offset:12288
    v_mfma_f32_16x16x32_bf16 v[92:95], a[100:103], v[52:55], v[92:95]
    ds_read_b64_tr_b16 a[8:9], v47 offset:24576
    v_mfma_f32_16x16x32_bf16 v[88:91], a[100:103], v[140:143], v[88:91]
    ds_read_b64_tr_b16 a[12:13], v47 offset:36864
    s_waitcnt lgkmcnt(7)
    v_mfma_f32_16x16x32_bf16 v[96:99], a[104:107], a[104:107], v[96:99]
    ds_read_b64_tr_b16 a[16:17], v48 offset:0
    v_mfma_f32_16x16x32_bf16 v[100:103], a[104:107], a[56:59], v[100:103]
    ds_read_b64_tr_b16 a[20:21], v48 offset:12288
    s_waitcnt lgkmcnt(8)
    v_mfma_f32_16x16x32_bf16 v[96:99], a[108:111], a[108:111], v[96:99]
    ds_read_b64_tr_b16 a[24:25], v48 offset:24576
    v_mfma_f32_16x16x32_bf16 v[100:103], a[108:111], a[60:63], v[100:103]
    ds_read_b64_tr_b16 a[28:29], v48 offset:36864
    v_mfma_f32_16x16x32_bf16 v[92:95], a[104:107], v[52:55], v[92:95]
    ds_read_b64_tr_b16 a[32:33], v49 offset:0
    v_mfma_f32_16x16x32_bf16 v[88:91], a[104:107], v[144:147], v[88:91]
    ds_read_b64_tr_b16 a[36:37], v49 offset:12288
    v_mfma_f32_16x16x32_bf16 v[92:95], a[108:111], v[52:55], v[92:95]
    ds_read_b64_tr_b16 a[40:41], v49 offset:24576
    v_mfma_f32_16x16x32_bf16 v[88:91], a[108:111], v[148:151], v[88:91]
    ds_read_b64_tr_b16 a[44:45], v49 offset:36864
    s_waitcnt lgkmcnt(13)
    v_mfma_f32_16x16x32_bf16 v[96:99], a[112:115], a[112:115], v[96:99]
    v_mfma_f32_16x16x32_bf16 v[100:103], a[112:115], a[64:67], v[100:103]
    s_waitcnt lgkmcnt(12)
    v_mfma_f32_16x16x32_bf16 v[96:99], a[116:119], a[116:119], v[96:99]
    v_mfma_f32_16x16x32_bf16 v[100:103], a[116:119], a[68:71], v[100:103]
    s_waitcnt vmcnt(8)
    ds_read_b128 a[120:123], v42 offset:6144
    ds_read_b128 a[124:127], v43 offset:6144
    v_mfma_f32_16x16x32_bf16 v[92:95], a[112:115], v[52:55], v[92:95]
    v_mfma_f32_16x16x32_bf16 v[92:95], a[116:119], v[52:55], v[92:95]
    s_nop 2
    v_fma_f32 v96, v100, 2.0, v96
    v_fma_f32 v97, v101, 2.0, v97
    v_mfma_f32_16x16x32_bf16 v[88:91], a[112:115], v[152:155], v[88:91]
    v_fma_f32 v98, v102, 2.0, v98
    v_fma_f32 v99, v103, 2.0, v99
    v_mfma_f32_16x16x32_bf16 v[88:91], a[116:119], v[156:159], v[88:91]
    v_cndmask_b32 v3, 0, v96, s[44:45]
    v_cndmask_b32 v3, v3, v97, s[46:47]
    v_cndmask_b32 v3, v3, v98, s[48:49]
    v_cndmask_b32 v3, v3, v99, s[50:51]
    s_nop 0
    s_nop 0
    v_mfma_f32_16x16x4_f32 v[120:123], v3, v60, v[56:59]
    s_waitcnt lgkmcnt(1)
    v_mfma_f32_16x16x32_bf16 v[112:115], a[120:123], a[120:123], v[84:87]
    v_mfma_f32_16x16x32_bf16 v[116:119], a[120:123], a[48:51], 0
    s_waitcnt vmcnt(6)
    ds_read_b128 a[128:131], v42 offset:8192
    ds_read_b128 a[132:135], v43 offset:8192
    s_add_u32 s61, s60, 3162112
    buffer_load_dwordx4 v[224:227], v65, s[32:35], s61 offen offset:0 sc1
    s_waitcnt lgkmcnt(2)
    v_mfma_f32_16x16x32_bf16 v[112:115], a[124:127], a[124:127], v[112:115]
    v_fma_f32 v128, -v92, v92, v120
    v_fma_f32 v129, -v93, v93, v121
    v_fma_f32 v130, -v94, v94, v122
    v_mfma_f32_16x16x32_bf16 v[116:119], a[124:127], a[52:55], v[116:119]
    v_fma_f32 v131, -v95, v95, v123
    v_max_f32 v128, v128, v56
    v_max_f32 v129, v129, v56
    v_mfma_f32_16x16x32_bf16 v[108:111], a[120:123], v[52:55], v[80:83]
    v_max_f32 v130, v130, v56
    v_max_f32 v131, v131, v56
    v_mfma_f32_16x16x32_bf16 v[104:107], a[120:123], v[136:139], v[76:79]
    v_rsq_f32 v128, v128
    v_mfma_f32_16x16x32_bf16 v[108:111], a[124:127], v[52:55], v[108:111]
    v_rsq_f32 v129, v129
    v_mfma_f32_16x16x32_bf16 v[104:107], a[124:127], v[140:143], v[104:107]
    v_rsq_f32 v130, v130
    s_waitcnt lgkmcnt(1)
    v_mfma_f32_16x16x32_bf16 v[112:115], a[128:131], a[128:131], v[112:115]
    v_rsq_f32 v131, v131
    v_fma_f32 v88, -v92, v61, v88
    v_mfma_f32_16x16x32_bf16 v[116:119], a[128:131], a[56:59], v[116:119]
    v_fma_f32 v89, -v93, v61, v89
    v_fma_f32 v90, -v94, v61, v90
    v_fma_f32 v91, -v95, v61, v91
    s_waitcnt lgkmcnt(0)
    v_mfma_f32_16x16x32_bf16 v[112:115], a[132:135], a[132:135], v[112:115]
    v_fma_f32 v88, v88, v128, v62
    v_fma_f32 v89, v89, v129, v62
    v_fma_f32 v90, v90, v130, v62
    v_mfma_f32_16x16x32_bf16 v[116:119], a[132:135], a[60:63], v[116:119]
    v_fma_f32 v91, v91, v131, v62
    v_max3_f32 v1, v88, v89, v90
    v_max_f32 v1, v1, v91
    v_mfma_f32_16x16x32_bf16 v[108:111], a[128:131], v[52:55], v[108:111]
    v_cmp_lt_f32 vcc, s52, v1
    s_cbranch_vccnz L_site12
L_back12:
    v_mfma_f32_16x16x32_bf16 v[104:107], a[128:131], v[144:147], v[104:107]
    s_waitcnt vmcnt(5)
    ds_read_b128 a[136:139], v42 offset:10240
    ds_read_b128 a[140:143], v43 offset:10240
    s_barrier
    buffer_load_dwordx4 v[228:231], v65, s[32:35], s61 offen offset:1024 sc1
    s_cmp_eq_u32 s0, 1
    s_cbranch_scc0 L_nolate
    s_add_u32 s56, s60, 3145728
    buffer_load_dwordx4 v[160:163], v65, s[32:35], s56 offen offset:0 sc1
    buffer_load_dwordx4 v[164:167], v65, s[32:35], s56 offen offset:1024 sc1
    buffer_load_dwordx4 v[168:171], v65, s[32:35], s56 offen offset:2048 sc1
    buffer_load_dwordx4 v[172:175], v65, s[32:35], s56 offen offset:3072 sc1
    s_add_u32 s56, s60, 3149824
    buffer_load_dwordx4 v[176:179], v65, s[32:35], s56 offen offset:0 sc1
    buffer_load_dwordx4 v[180:183], v65, s[32:35], s56 offen offset:1024 sc1
    buffer_load_dwordx4 v[184:187], v65, s[32:35], s56 offen offset:2048 sc1
    buffer_load_dwordx4 v[188:191], v65, s[32:35], s56 offen offset:3072 sc1
    s_add_u32 s56, s60, 3153920
    buffer_load_dwordx4 v[192:195], v65, s[32:35], s56 offen offset:0 sc1
    buffer_load_dwordx4 v[196:199], v65, s[32:35], s56 offen offset:1024 sc1
    buffer_load_dwordx4 v[200:203], v65, s[32:35], s56 offen offset:2048 sc1
    buffer_load_dwordx4 v[204:207], v65, s[32:35], s56 offen offset:3072 sc1
L_nolate:
    buffer_load_dword v244, v28, s[32:35], s28 offen
    v_mfma_f32_16x16x32_bf16 v[108:111], a[132:135], v[52:55], v[108:111]
    ds_read_b64_tr_b16 a[2:3], v47 offset:6144
    v_exp_f32 v96, v88
    v_mfma_f32_16x16x32_bf16 v[104:107], a[132:135], v[148:151], v[104:107]
    ds_read_b64_tr_b16 a[6:7], v47 offset:18432
    v_exp_f32 v97, v89
    s_waitcnt lgkmcnt(3)
    v_mfma_f32_16x16x32_bf16 v[112:115], a[136:139], a[136:139], v[112:115]
    ds_read_b64_tr_b16 a[10:11], v47 offset:30720
    v_exp_f32 v98, v90
    v_mfma_f32_16x16x32_bf16 v[116:119], a[136:139], a[64:67], v[116:119]
    ds_read_b64_tr_b16 a[14:15], v47 offset:43008
    v_exp_f32 v99, v91
    s_waitcnt lgkmcnt(4)
    v_mfma_f32_16x16x32_bf16 v[112:115], a[140:143], a[140:143], v[112:115]
    ds_read_b64_tr_b16 a[18:19], v48 offset:6144
    v_mul_f32 v88, v96, v128
    v_mul_f32 v89, v97, v129
    v_mfma_f32_16x16x32_bf16 v[116:119], a[140:143], a[68:71], v[116:119]
    ds_read_b64_tr_b16 a[22:23], v48 offset:18432
    v_mul_f32 v90, v98, v130
    v_mul_f32 v91, v99, v131
    v_mfma_f32_16x16x32_bf16 v[108:111], a[136:139], v[52:55], v[108:111]
    ds_read_b64_tr_b16 a[26:27], v48 offset:30720
    v_add_f32 v63, v63, v96
    v_fmac_f32 v64, v88, v92
    v_mfma_f32_16x16x32_bf16 v[108:111], a[140:143], v[52:55], v[108:111]
    ds_read_b64_tr_b16 a[30:31], v48 offset:43008
    v_add_f32 v63, v63, v97
    v_fmac_f32 v64, v89, v93
    v_add_f32 v63, v63, v98
    v_fma_f32 v112, v116, 2.0, v112
    v_fma_f32 v113, v117, 2.0, v113
    v_fma_f32 v114, v118, 2.0, v114
    v_fma_f32 v115, v119, 2.0, v115
    v_cndmask_b32 v4, 0, v112, s[44:45]
    v_cndmask_b32 v4, v4, v113, s[46:47]
    v_cndmask_b32 v4, v4, v114, s[48:49]
    v_cndmask_b32 v4, v4, v115, s[50:51]
    ds_read_b64_tr_b16 a[34:35], v49 offset:6144
    ds_read_b64_tr_b16 a[38:39], v49 offset:18432
    v_mfma_f32_16x16x4_f32 v[124:127], v4, v60, v[56:59]
    ds_read_b64_tr_b16 a[42:43], v49 offset:30720
    ds_read_b64_tr_b16 a[46:47], v49 offset:43008
    v_fmac_f32 v64, v90, v94
    v_add_f32 v63, v63, v99
    v_fmac_f32 v64, v91, v95
    v_add_f32 v68, v68, v88
    v_add_f32 v69, v69, v89
    v_add_f32 v70, v70, v90
    v_add_f32 v71, v71, v91
    v_mfma_f32_16x16x32_bf16 v[104:107], a[136:139], v[152:155], v[104:107]
    v_cvt_pk_bf16_f32 v72, v88, v89
    v_cvt_pk_bf16_f32 v73, v90, v91
    v_mfma_f32_16x16x32_bf16 v[104:107], a[140:143], v[156:159], v[104:107]
    v_fma_f32 v132, -v108, v108, v124
    v_fma_f32 v133, -v109, v109, v125
    v_fma_f32 v134, -v110, v110, v126
    v_fma_f32 v135, -v111, v111, v127
    v_max_f32 v132, v132, v56
    v_max_f32 v133, v133, v56
    v_max_f32 v134, v134, v56
    v_max_f32 v135, v135, v56
    v_rsq_f32 v132, v132
    v_rsq_f32 v133, v133
    v_rsq_f32 v134, v134
    v_rsq_f32 v135, v135
    v_pk_fma_f32 v[104:105], v[108:109], v[60:61], v[104:105] op_sel:[0,1,0] neg_lo:[1,0,0] neg_hi:[1,0,0]
    v_pk_fma_f32 v[106:107], v[110:111], v[60:61], v[106:107] op_sel:[0,1,0] neg_lo:[1,0,0] neg_hi:[1,0,0]
    v_pk_fma_f32 v[104:105], v[104:105], v[132:133], v[62:63] op_sel_hi:[1,1,0]
    v_pk_fma_f32 v[106:107], v[106:107], v[134:135], v[62:63] op_sel_hi:[1,1,0]
L_back13:
    v_max3_f32 v1, v104, v105, v106
    v_max_f32 v1, v1, v107
    v_cmp_lt_f32 vcc, s52, v1
    v_exp_f32 v112, v104
    v_exp_f32 v113, v105
    v_exp_f32 v114, v106
    v_exp_f32 v115, v107
    s_cbranch_vccnz L_site13
    v_pk_mul_f32 v[104:105], v[112:113], v[132:133]
    v_pk_mul_f32 v[106:107], v[114:115], v[134:135]
    v_cvt_pk_bf16_f32 v74, v104, v105
    v_cvt_pk_bf16_f32 v75, v106, v107
    ds_write_b128 v237, v[72:75] offset:0
    v_pk_add_f32 v[68:69], v[68:69], v[104:105]
    v_pk_add_f32 v[70:71], v[70:71], v[106:107]
    v_pk_add_f32 v[112:113], v[112:113], v[114:115]
    v_cvt_pk_bf16_f32 v66, v68, v69
    v_cvt_pk_bf16_f32 v67, v70, v71
    ds_write_b64 v238, v[66:67]
    v_pk_mul_f32 v[114:115], v[104:105], v[108:109]
    v_add_f32 v63, v63, v112
    v_pk_fma_f32 v[114:115], v[106:107], v[110:111], v[114:115]
    v_add_f32 v10, v63, v113
    v_add_f32 v64, v64, v114
    v_add_f32 v11, v64, v115
    ds_write_b64 v238, v[10:11] offset:2048
L_merge:
    s_waitcnt lgkmcnt(0)
    s_barrier
L_postx:
    ds_read_b32 v9, v254 offset:4096
    ds_read_b128 v[92:95], v253 offset:0
    ds_read_b128 v[96:99], v253 offset:1024
    ds_read_b128 v[100:103], v253 offset:2048
    ds_read_b64 v[136:137], v254 offset:2048
    ds_read_b64 v[138:139], v254 offset:2560
    ds_read_b64 v[140:141], v254 offset:3072
    ds_read_b64 v[142:143], v254 offset:3584
    ds_read_b128 v[116:119], v253 offset:3072
    ds_read_b64 v[120:121], v254 offset:0
    ds_read_b64 v[122:123], v254 offset:512
    s_waitcnt lgkmcnt(10)
    v_cmp_ne_u32 vcc, 0, v9
    s_cbranch_vccnz L_xlast
    s_waitcnt lgkmcnt(9)
    v_mfma_f32_16x16x32_bf16 v[16:19], a[0:3], v[92:95], v[16:19]
    ds_read_b64 v[124:125], v254 offset:1024
    v_mfma_f32_16x16x32_bf16 v[20:23], a[16:19], v[92:95], v[20:23]
    ds_read_b64 v[126:127], v254 offset:1536
    v_mfma_f32_16x16x32_bf16 v[24:27], a[32:35], v[92:95], v[24:27]
    s_waitcnt lgkmcnt(10)
    v_mfma_f32_16x16x32_bf16 v[16:19], a[4:7], v[96:99], v[16:19]
    v_mfma_f32_16x16x32_bf16 v[20:23], a[20:23], v[96:99], v[20:23]
    v_mfma_f32_16x16x32_bf16 v[24:27], a[36:39], v[96:99], v[24:27]
    s_waitcnt lgkmcnt(9)
    v_mfma_f32_16x16x32_bf16 v[16:19], a[8:11], v[100:103], v[16:19]
    s_waitcnt lgkmcnt(5)
    v_add_f32 v1, v136, v138
    v_add_f32 v2, v137, v139
    v_add_f32 v140, v140, v142
    v_mfma_f32_16x16x32_bf16 v[20:23], a[24:27], v[100:103], v[20:23]
    v_add_f32 v141, v141, v143
    v_add_f32 v1, v1, v140
    v_add_f32 v2, v2, v141
    v_mfma_f32_16x16x32_bf16 v[24:27], a[40:43], v[100:103], v[24:27]
    s_nop 0
    v_permlane32_swap_b32 v1, v2
    v_add_f32 v1, v1, v2
    v_mov_b32 v2, v1
    s_waitcnt lgkmcnt(4)
    v_mfma_f32_16x16x32_bf16 v[16:19], a[12:15], v[116:119], v[16:19]
    v_permlane16_swap_b32 v1, v2
    v_add_f32 v1, v1, v2
    v_mov_b32 v2, v1
    s_waitcnt lgkmcnt(2)
    v_mfma_f32_16x16x32_bf16 v[16:19], a[72:75], v[120:123], v[16:19]
    v_permlane32_swap_b32 v1, v2
    v_rcp_f32 v3, v1
    s_waitcnt lgkmcnt(0)
    v_mfma_f32_16x16x32_bf16 v[16:19], a[76:79], v[124:127], v[16:19]
    v_log_f32 v4, v1
    v_mul_f32 v5, v60, v3
    v_mfma_f32_16x16x32_bf16 v[20:23], a[28:31], v[116:119], v[20:23]
    v_mul_f32 v6, v2, v3
    v_sub_f32 v4, v4, v255
    v_mfma_f32_16x16x32_bf16 v[20:23], a[80:83], v[120:123], v[20:23]
    v_mfma_f32_16x16x32_bf16 v[20:23], a[84:87], v[124:127], v[20:23]
    v_mfma_f32_16x16x32_bf16 v[24:27], a[44:47], v[116:119], v[24:27]
    v_fma_f32 v16, v16, v5, -v6
    v_fma_f32 v17, v17, v5, -v6
    v_mfma_f32_16x16x32_bf16 v[24:27], a[88:91], v[120:123], v[24:27]
    v_fma_f32 v18, v18, v5, -v6
    v_fma_f32 v19, v19, v5, -v6
    v_mfma_f32_16x16x32_bf16 v[24:27], a[92:95], v[124:127], v[24:27]
    v_cvt_pk_bf16_f32 v66, v16, v17
    v_cvt_pk_bf16_f32 v67, v18, v19
    ds_write_b64 v236, v[66:67] offset:0
    v_pk_fma_f32 v[20:21], v[20:21], v[4:5], v[6:7] op_sel:[0,1,0] op_sel_hi:[1,1,0] neg_lo:[0,0,1] neg_hi:[0,0,1]
    v_pk_fma_f32 v[22:23], v[22:23], v[4:5], v[6:7] op_sel:[0,1,0] op_sel_hi:[1,1,0] neg_lo:[0,0,1] neg_hi:[0,0,1]
    v_cvt_pk_bf16_f32 v68, v20, v21
    v_cvt_pk_bf16_f32 v69, v22, v23
    ds_write_b64 v236, v[68:69] offset:512
    v_pk_fma_f32 v[24:25], v[24:25], v[4:5], v[6:7] op_sel:[0,1,0] op_sel_hi:[1,1,0] neg_lo:[0,0,1] neg_hi:[0,0,1]
    v_pk_fma_f32 v[26:27], v[26:27], v[4:5], v[6:7] op_sel:[0,1,0] op_sel_hi:[1,1,0] neg_lo:[0,0,1] neg_hi:[0,0,1]
    v_cvt_pk_bf16_f32 v70, v24, v25
    v_cvt_pk_bf16_f32 v71, v26, v27
    ds_write_b64 v236, v[70:71] offset:1024
    s_waitcnt lgkmcnt(0)
    s_barrier
    ds_read_b128 v[136:139], v241 offset:0
    ds_read_b128 v[140:143], v241 offset:1024
    ds_read_b128 v[144:147], v241 offset:2048
    ds_read_b128 v[148:151], v241 offset:3072
    ds_read_b128 v[152:155], v241 offset:4096
    ds_read_b128 v[156:159], v241 offset:5120
    s_waitcnt vmcnt(1)
    v_subrev_u32 v35, s39, v4
    v_add_u32 v39, s39, v4
    s_waitcnt lgkmcnt(5)
    v_mfma_f32_16x16x32_bf16 v[16:19], v[160:163], v[136:139], 0
    v_mfma_f32_16x16x32_bf16 v[20:23], v[184:187], v[136:139], 0
    v_mfma_f32_16x16x32_bf16 v[24:27], v[208:211], v[136:139], 0
    s_waitcnt lgkmcnt(4)
    v_mfma_f32_16x16x32_bf16 v[16:19], v[164:167], v[140:143], v[16:19]
    v_mfma_f32_16x16x32_bf16 v[20:23], v[188:191], v[140:143], v[20:23]
    v_mfma_f32_16x16x32_bf16 v[24:27], v[212:215], v[140:143], v[24:27]
    s_waitcnt lgkmcnt(3)
    v_mfma_f32_16x16x32_bf16 v[16:19], v[168:171], v[144:147], v[16:19]
    v_mfma_f32_16x16x32_bf16 v[20:23], v[192:195], v[144:147], v[20:23]
    v_mfma_f32_16x16x32_bf16 v[24:27], v[216:219], v[144:147], v[24:27]
    s_waitcnt lgkmcnt(2)
    v_mfma_f32_16x16x32_bf16 v[16:19], v[172:175], v[148:151], v[16:19]
    s_waitcnt lgkmcnt(1)
    v_mfma_f32_16x16x32_bf16 v[16:19], v[176:179], v[152:155], v[16:19]
    s_waitcnt lgkmcnt(0)
    v_mfma_f32_16x16x32_bf16 v[16:19], v[180:183], v[156:159], v[16:19]
    v_mfma_f32_16x16x32_bf16 v[20:23], v[196:199], v[148:151], v[20:23]
    v_mfma_f32_16x16x32_bf16 v[20:23], v[200:203], v[152:155], v[20:23]
    v_mfma_f32_16x16x32_bf16 v[20:23], v[204:207], v[156:159], v[20:23]
    v_mfma_f32_16x16x32_bf16 v[24:27], v[220:223], v[148:151], v[24:27]
    v_mfma_f32_16x16x32_bf16 v[24:27], v[224:227], v[152:155], v[24:27]
    s_nop 2
    v_cvt_pk_bf16_f32 v32, v16, v17
    v_mfma_f32_16x16x32_bf16 v[24:27], v[228:231], v[156:159], v[24:27]
    v_cvt_pk_bf16_f32 v33, v18, v19
    v_cvt_pk_bf16_f32 v34, v20, v21
    v_cvt_pk_bf16_f32 v36, v22, v23
    v_permlane16_swap_b32 v35, v39
    s_nop 0
    v_permlane16_swap_b32 v32, v36
    s_nop 1
    v_cvt_pk_bf16_f32 v37, v24, v25
    v_cvt_pk_bf16_f32 v38, v26, v27
    s_nop 0
    v_permlane16_swap_b32 v33, v37
    v_permlane16_swap_b32 v34, v38
    buffer_store_dwordx4 v[32:35], v242, s[32:35], s28 offen sc1
    buffer_store_dwordx4 v[36:39], v243, s[32:35], s28 offen sc1
    s_cmp_lt_u32 s29, 64
    s_cbranch_scc0 L_fin
    buffer_load_dwordx4 v[76:79], v29, s[32:35], s30 offen offset:0 sc1
    buffer_load_dwordx4 v[80:83], v29, s[32:35], s30 offen offset:2048 sc1
    buffer_load_dwordx4 v[84:87], v29, s[32:35], s31 offen offset:0 sc1
    buffer_load_dwordx4 v[108:111], v29, s[32:35], s31 offen offset:2048 sc1
    ds_bpermute_b32 v42, v252, v4
    v_bfe_u32 v48, v0, 0, 1
    v_cmp_eq_u32 vcc, 1, v48
    v_mov_b32 v246, s39
    s_movk_i32 s26, 0x11
    v_sub_u32 v247, 0, v246
    v_cndmask_b32 v247, v247, v246, vcc
    v_mul_lo_u32 v246, v247, -2
    v_mov_b32 v16, 0
    v_mov_b32 v17, 0
    v_mov_b32 v18, 0
    v_mov_b32 v19, 0
    v_mov_b32 v20, 0
    v_mov_b32 v21, 0
    v_mov_b32 v22, 0
    v_mov_b32 v97, 0
    s_mov_b32 s53, 0
    v_mov_b32 v160, 0x11
    v_mov_b32 v161, 0x22
    v_mov_b32 v162, 0x44
    v_mov_b32 v163, 0x88
    s_waitcnt vmcnt(0)
    v_sub_u32_dpp v136, v79, v79 quad_perm:[1,0,3,2] row_mask:0xf bank_mask:0xf
    v_sub_u32_dpp v137, v83, v83 quad_perm:[1,0,3,2] row_mask:0xf bank_mask:0xf
    v_sub_u32_dpp v138, v87, v87 quad_perm:[1,0,3,2] row_mask:0xf bank_mask:0xf
    v_sub_u32_dpp v139, v111, v111 quad_perm:[1,0,3,2] row_mask:0xf bank_mask:0xf
    v_cmp_eq_u32 s[6:7], v136, v246
    v_cmp_eq_u32 s[8:9], v137, v246
    v_cmp_eq_u32 s[10:11], v138, v246
    v_cmp_eq_u32 s[12:13], v139, v246
    v_cndmask_b32 v136, v160, 0, s[6:7]
    v_cndmask_b32 v137, v161, 0, s[8:9]
    v_cndmask_b32 v138, v162, 0, s[10:11]
    v_cndmask_b32 v139, v163, 0, s[12:13]
    v_or3_b32 v96, v136, v137, v138
    v_or_b32 v96, v96, v139
    v_cmp_ne_u32 vcc, 0, v96
    v_sub_u32 v168, v79, v247
    v_sub_u32 v169, v83, v247
    s_cbranch_vccz L_c_all
    v_lshrrev_b32 v48, v97, v96
    v_ffbl_b32 v48, v48
    v_add_u32 v48, v48, v97
    v_and_b32 v48, 3, v48
    v_lshl_add_u32 v51, v48, 11, v29
    v_lshlrev_b32 v88, v48, s26
    v_add_u32 v97, 1, v48
    s_mov_b64 exec, vcc
    buffer_load_dwordx4 v[136:139], v51, s[32:35], s30 offen sc1
    s_mov_b64 exec, -1
    v_lshrrev_b32 v48, v97, v96
    v_ffbl_b32 v48, v48
    v_add_u32 v48, v48, v97
    v_and_b32 v48, 3, v48
    v_lshl_add_u32 v51, v48, 11, v29
    v_lshlrev_b32 v89, v48, s26
    v_add_u32 v97, 1, v48
    s_mov_b64 exec, vcc
    buffer_load_dwordx4 v[140:143], v51, s[32:35], s30 offen sc1
    s_mov_b64 exec, -1
L_c_all:
    v_sub_u32 v170, v87, v247
    v_sub_u32 v171, v111, v247
    s_waitcnt lgkmcnt(0)
    v_sub_f32 v168, v168, v42
    v_sub_f32 v169, v169, v42
    v_sub_f32 v170, v170, v42
    v_sub_f32 v171, v171, v42
    v_exp_f32 v168, v168
    v_exp_f32 v169, v169
    v_exp_f32 v170, v170
    v_exp_f32 v171, v171
    v_cvt_pk_bf16_f32 v168, v168, 0
    v_cvt_pk_bf16_f32 v169, v169, 0
    v_cvt_pk_bf16_f32 v170, v170, 0
    v_cvt_pk_bf16_f32 v171, v171, 0
    v_lshlrev_b32 v176, 16, v168
    v_lshlrev_b32 v177, 16, v169
    v_lshlrev_b32 v178, 16, v170
    v_lshlrev_b32 v179, 16, v171
    s_mov_b64 exec, s[6:7]
    v_dot2c_f32_bf16 v16, v76, v168
    v_dot2c_f32_bf16 v18, v77, v168
    v_dot2c_f32_bf16 v20, v78, v168
    v_add_f32 v22, v22, v176
    v_dot2c_f32_bf16 v17, v76, v176
    v_dot2c_f32_bf16 v19, v77, v176
    v_dot2c_f32_bf16 v21, v78, v176
    s_mov_b64 exec, s[8:9]
    v_dot2c_f32_bf16 v16, v80, v169
    v_dot2c_f32_bf16 v18, v81, v169
    v_dot2c_f32_bf16 v20, v82, v169
    v_add_f32 v22, v22, v177
    v_dot2c_f32_bf16 v17, v80, v177
    v_dot2c_f32_bf16 v19, v81, v177
    v_dot2c_f32_bf16 v21, v82, v177
    s_mov_b64 exec, s[10:11]
    v_dot2c_f32_bf16 v16, v84, v170
    v_dot2c_f32_bf16 v18, v85, v170
    v_dot2c_f32_bf16 v20, v86, v170
    v_add_f32 v22, v22, v178
    v_dot2c_f32_bf16 v17, v84, v178
    v_dot2c_f32_bf16 v19, v85, v178
    v_dot2c_f32_bf16 v21, v86, v178
    s_mov_b64 exec, s[12:13]
    v_dot2c_f32_bf16 v16, v108, v171
    v_dot2c_f32_bf16 v18, v109, v171
    v_dot2c_f32_bf16 v20, v110, v171
    v_add_f32 v22, v22, v179
    v_dot2c_f32_bf16 v17, v108, v179
    v_dot2c_f32_bf16 v19, v109, v179
    v_dot2c_f32_bf16 v21, v110, v179
    s_mov_b64 exec, -1
    s_cbranch_vccz L_c_red
L_c_loop:
    s_waitcnt vmcnt(1)
    v_sub_u32_dpp v48, v139, v139 quad_perm:[1,0,3,2] row_mask:0xf bank_mask:0xf
    v_and_b32 v49, v88, v96
    v_cmpx_eq_u32 vcc, v48, v246
    v_cmpx_ne_u32 vcc, 0, v49
    v_xor_b32 v96, v96, v88
    v_sub_u32 v49, v139, v247
    v_sub_f32 v49, v49, v42
    v_exp_f32 v49, v49
    s_cbranch_execz L_c_s0
    v_cvt_pk_bf16_f32 v49, v49, 0
    v_lshlrev_b32 v50, 16, v49
    v_dot2c_f32_bf16 v16, v136, v49
    v_dot2c_f32_bf16 v18, v137, v49
    v_dot2c_f32_bf16 v20, v138, v49
    v_add_f32 v22, v22, v50
    v_dot2c_f32_bf16 v17, v136, v50
    v_dot2c_f32_bf16 v19, v137, v50
    v_dot2c_f32_bf16 v21, v138, v50
L_c_s0:
    s_mov_b64 exec, -1
    v_cmp_ne_u32 vcc, 0, v96
    v_lshrrev_b32 v48, v97, v96
    v_ffbl_b32 v48, v48
    s_cbranch_vccz L_c_red
    v_add_u32 v48, v48, v97
    v_and_b32 v48, 3, v48
    v_lshl_add_u32 v51, v48, 11, v29
    v_lshlrev_b32 v88, v48, s26
    v_add_u32 v97, 1, v48
    s_mov_b64 exec, vcc
    buffer_load_dwordx4 v[136:139], v51, s[32:35], s30 offen sc1
    s_mov_b64 exec, -1
    s_waitcnt vmcnt(1)
    v_sub_u32_dpp v48, v143, v143 quad_perm:[1,0,3,2] row_mask:0xf bank_mask:0xf
    v_and_b32 v49, v89, v96
    v_cmpx_eq_u32 vcc, v48, v246
    v_cmpx_ne_u32 vcc, 0, v49
    v_xor_b32 v96, v96, v89
    v_sub_u32 v49, v143, v247
    v_sub_f32 v49, v49, v42
    v_exp_f32 v49, v49
    s_cbranch_execz L_c_s1
    v_cvt_pk_bf16_f32 v49, v49, 0
    v_lshlrev_b32 v50, 16, v49
    v_dot2c_f32_bf16 v16, v140, v49
    v_dot2c_f32_bf16 v18, v141, v49
    v_dot2c_f32_bf16 v20, v142, v49
    v_add_f32 v22, v22, v50
    v_dot2c_f32_bf16 v17, v140, v50
    v_dot2c_f32_bf16 v19, v141, v50
    v_dot2c_f32_bf16 v21, v142, v50
L_c_s1:
    s_mov_b64 exec, -1
    v_cmp_ne_u32 vcc, 0, v96
    v_lshrrev_b32 v48, v97, v96
    v_ffbl_b32 v48, v48
    s_cbranch_vccz L_c_red
    v_add_u32 v48, v48, v97
    v_and_b32 v48, 3, v48
    v_lshl_add_u32 v51, v48, 11, v29
    v_lshlrev_b32 v89, v48, s26
    v_add_u32 v97, 1, v48
    s_mov_b64 exec, vcc
    buffer_load_dwordx4 v[140:143], v51, s[32:35], s30 offen sc1
    s_mov_b64 exec, -1
    s_add_u32 s53, s53, 1
    s_cmp_lt_u32 s53, 65536
    s_cbranch_scc1 L_c_loop
L_c_red:
    v_mov_b32 v23, v22
    v_permlane32_swap_b32 v16, v20
    v_permlane32_swap_b32 v17, v21
    v_permlane32_swap_b32 v18, v22
    v_permlane32_swap_b32 v19, v23
    v_add_f32 v16, v16, v20
    v_add_f32 v17, v17, v21
    v_add_f32 v18, v18, v22
    v_add_f32 v19, v19, v23
    s_nop 0
    v_permlane16_swap_b32 v16, v18
    v_permlane16_swap_b32 v17, v19
    v_add_f32 v16, v16, v18
    v_add_f32 v17, v17, v19
    s_nop 0
    v_add_f32_dpp v48, v16, v16 row_ror:8 row_mask:0xf bank_mask:0x3
    s_nop 1
    v_add_f32_dpp v48, v17, v17 row_ror:8 row_mask:0xf bank_mask:0xc
    s_nop 1
    v_add_f32_dpp v48, v48, v48 row_shr:4 row_mask:0xf bank_mask:0xa
    ds_write_b32 v250, v48
    s_waitcnt lgkmcnt(0)
    s_barrier
    ds_read_b128 v[48:51], v251 offset:768
    ds_read_b128 v[52:55], v65
    v_lshlrev_b32 v18, 16, v249
    s_waitcnt lgkmcnt(1)
    v_add_f32 v48, v48, v49
    v_add_f32 v50, v50, v51
    v_add_f32 v48, v48, v50
    v_cmp_nlt_f32 vcc, v48, v232
    v_rcp_f32 v48, v48
    s_waitcnt lgkmcnt(0)
    s_cbranch_vccnz L_c_slow
L_c_out:
    s_cmp_lg_u32 s3, 0
    s_cbranch_scc1 L_fin
    v_add_f32 v52, v52, v53
    v_add_f32 v54, v54, v55
    v_add_f32 v52, v52, v54
    v_fmac_f32 v18, v52, v48
    v_cvt_pk_bf16_f32 v18, v18, v18
    buffer_store_short v18, v248, s[68:71], 0 offen sc1
    s_cmp_lg_u32 s2, 64
    s_cbranch_scc1 L_fin
    v_mov_b32 v48, s39
    v_mov_b32 v49, 0
    s_mov_b64 exec, 1
    buffer_store_dword v48, v49, s[32:35], 0 offen offset:0 sc1
    s_mov_b64 exec, -1
L_fin:
L_end:
    s_endpgm
L_hot:
L_prod:
    s_cmp_lg_u32 s3, 0
    s_cbranch_scc1 L_p_noq
    s_mov_b32 m0, 147456
    s_nop 0
    buffer_load_dwordx4 v16, s[72:75], 0 offen offset:0  lds
    buffer_load_dwordx4 v17, s[72:75], 0 offen offset:1024  lds
    buffer_load_dwordx4 v18, s[72:75], 0 offen offset:2048  lds
    buffer_load_dwordx4 v19, s[72:75], 0 offen offset:3072  lds
    s_mov_b32 m0, 151552
    s_nop 0
    buffer_load_dwordx4 v20, s[72:75], 0 offen offset:0  lds
    buffer_load_dwordx4 v21, s[72:75], 0 offen offset:1024  lds
L_p_noq:
    s_mul_i32 s60, s3, 18432
    s_add_u32 m0, s60, 73728
    s_nop 0
    buffer_load_dwordx4 v16, s[64:67], s60 offen offset:0  lds
    buffer_load_dwordx4 v17, s[64:67], s60 offen offset:1024  lds
    buffer_load_dwordx4 v18, s[64:67], s60 offen offset:2048  lds
    buffer_load_dwordx4 v19, s[64:67], s60 offen offset:3072  lds
    s_add_u32 m0, s60, 77824
    s_nop 0
    buffer_load_dwordx4 v20, s[64:67], s60 offen offset:0  lds
    buffer_load_dwordx4 v21, s[64:67], s60 offen offset:1024  lds
    s_add_u32 s60, s60, 6144
    s_add_u32 m0, s60, 73728
    s_nop 0
    buffer_load_dwordx4 v16, s[64:67], s60 offen offset:0  lds
    buffer_load_dwordx4 v17, s[64:67], s60 offen offset:1024  lds
    buffer_load_dwordx4 v18, s[64:67], s60 offen offset:2048  lds
    buffer_load_dwordx4 v19, s[64:67], s60 offen offset:3072  lds
    s_add_u32 m0, s60, 77824
    s_nop 0
    buffer_load_dwordx4 v20, s[64:67], s60 offen offset:0  lds
    buffer_load_dwordx4 v21, s[64:67], s60 offen offset:1024  lds
    s_add_u32 s60, s60, 6144
    s_add_u32 m0, s60, 73728
    s_nop 0
    buffer_load_dwordx4 v16, s[64:67], s60 offen offset:0  lds
    v_mov_b32 v52, 0x3f803f80
    v_mov_b32 v56, 0x3ebcbe62
    s_mov_b32 s44, 0x100001
    s_mov_b32 s45, 0x10000100
    v_mov_b32 v53, 0x3f803f80
    v_mov_b32 v57, 0x3ebcbe62
    s_mov_b32 s46, 0x200002
    buffer_load_dwordx4 v17, s[64:67], s60 offen offset:1024  lds
    s_mov_b32 s47, 0x20000200
    v_mov_b32 v54, 0x3f803f80
    v_mov_b32 v58, 0x3ebcbe62
    s_mov_b32 s48, 0x400004
    s_mov_b32 s49, 0x40000400
    v_mov_b32 v55, 0x3f803f80
    v_mov_b32 v59, 0x3ebcbe62
    buffer_load_dwordx4 v18, s[64:67], s60 offen offset:2048  lds
    s_mov_b32 s50, 0x800008
    s_mov_b32 s51, 0x80000800
    v_mov_b32 v60, 0x43400000
    v_lshrrev_b32 v1, 5, v0
    v_lshlrev_b32 v1, 8, v1
    v_and_b32 v2, 15, v0
    v_lshl_add_u32 v1, v2, 4, v1
    buffer_load_dwordx4 v19, s[64:67], s60 offen offset:3072  lds
    v_bfe_u32 v2, v0, 4, 1
    v_lshl_add_u32 v1, v2, 3, v1
    s_mul_i32 s56, s3, 1536
    s_add_u32 s56, s56, 153600
    v_add_u32 v134, s56, v1
    v_bfe_u32 v1, v0, 4, 1
    v_lshrrev_b32 v5, 5, v0
    s_add_u32 m0, s60, 77824
    s_nop 0
    buffer_load_dwordx4 v20, s[64:67], s60 offen offset:0  lds
    v_lshl_or_b32 v1, v1, 1, v5
    v_bfe_u32 v2, v0, 2, 2
    v_lshl_add_u32 v3, v1, 3, v2
    v_mul_u32_u24 v3, 384, v3
    v_and_b32 v4, 1, v0
    v_lshl_add_u32 v3, v4, 3, v3
    v_add_u32 v3, 73728, v3
    buffer_load_dwordx4 v21, s[64:67], s60 offen offset:1024  lds
    v_and_or_b32 v2, v2, 2, v5
    v_bfe_u32 v4, v0, 1, 1
    v_xor_b32 v2, v2, v4
    s_mul_i32 s56, s3, 6
    s_add_u32 s57, s56, 0
    v_xor_b32 v4, s57, v2
    v_lshl_add_u32 v124, v4, 4, v3
    s_lshl_b32 s61, s43, 2
    s_add_u32 s61, s61, s3
    s_mul_i32 s60, s61, 6144
    s_add_u32 m0, s41, 6144
    s_nop 0
    buffer_load_dwordx4 v16, s[68:71], s60 offen offset:0  lds
    v_xor_b32 v125, 64, v124
    s_add_u32 s57, s56, 2
    v_xor_b32 v4, s57, v2
    v_lshl_add_u32 v126, v4, 4, v3
    v_xor_b32 v127, 64, v126
    s_add_u32 s57, s56, 4
    v_xor_b32 v4, s57, v2
    buffer_load_dwordx4 v17, s[68:71], s60 offen offset:1024  lds
    v_lshl_add_u32 v128, v4, 4, v3
    v_xor_b32 v129, 64, v128
    v_and_b32 v2, 15, v0
    v_bfe_u32 v3, v0, 3, 1
    v_and_or_b32 v4, v0, 6, v3
    v_xor_b32 v4, v4, v1
    v_mul_u32_u24 v2, 384, v2
    buffer_load_dwordx4 v18, s[68:71], s60 offen offset:2048  lds
    v_lshl_add_u32 v2, v4, 4, v2
    v_add_u32 v132, 147456, v2
    v_xor_b32 v133, 64, v132
    s_and_b32 s56, s3, 1
    s_lshl_b32 s56, s56, 2
    s_lshr_b32 s57, s3, 1
    s_mul_i32 s57, s57, 24576
    buffer_load_dwordx4 v19, s[68:71], s60 offen offset:3072  lds
    s_add_u32 s57, s57, 30720
    v_and_b32 v1, 11, v0
    v_or_b32 v1, s56, v1
    v_and_or_b32 v2, v1, 6, v3
    v_lshrrev_b32 v3, 4, v0
    v_xor_b32 v2, v2, v3
    v_mul_u32_u24 v1, 384, v1
    s_add_u32 m0, s41, 10240
    s_nop 0
    buffer_load_dwordx4 v20, s[68:71], s60 offen offset:0  lds
    v_lshl_add_u32 v1, v2, 4, v1
    v_bfe_u32 v2, v0, 2, 1
    v_mul_u32_u24 v2, 12288, v2
    v_add3_u32 v130, s57, v1, v2
    v_xor_b32 v131, 64, v130
    v_add_u32 v135, 153600, v65
    buffer_load_dwordx4 v21, s[68:71], s60 offen offset:1024  lds
    s_waitcnt vmcnt(24)
    s_barrier
    s_load_dword s38, s[22:23], 0
    ds_read_b128 v[136:139], v132 offset:0
    ds_read_b128 v[140:143], v133 offset:0
    ds_read_b128 v[144:147], v132 offset:128
    ds_read_b128 v[148:151], v133 offset:128
    ds_read_b128 v[152:155], v132 offset:256
    ds_read_b128 v[156:159], v133 offset:256
    s_add_u32 m0, s40, 0
    s_add_u32 s57, s36, 0
    buffer_load_dwordx4 v16, s[28:31], s57 offen offset:0 nt lds
    buffer_load_dwordx4 v17, s[28:31], s57 offen offset:1024 nt lds
    buffer_load_dwordx4 v18, s[28:31], s57 offen offset:2048 nt lds
    buffer_load_dwordx4 v19, s[28:31], s57 offen offset:3072 nt lds
    s_add_u32 m0, s40, 4096
    s_nop 0
    buffer_load_dwordx4 v20, s[28:31], s57 offen offset:0 nt lds
    buffer_load_dwordx4 v21, s[28:31], s57 offen offset:1024 nt lds
    s_waitcnt lgkmcnt(0)
    v_mfma_f32_16x16x32_bf16 v[112:115], v[136:139], v[136:139], 0
    v_mfma_f32_16x16x32_bf16 v[116:119], v[52:55], v[136:139], 0
    s_add_u32 m0, s41, 0
    s_add_u32 s58, s37, 0
    buffer_load_dwordx4 v22, s[24:27], s58 offen offset:0 nt lds
    v_mfma_f32_16x16x32_bf16 v[112:115], v[140:143], v[140:143], v[112:115]
    v_mfma_f32_16x16x32_bf16 v[116:119], v[52:55], v[140:143], v[116:119]
    buffer_load_dwordx4 v23, s[24:27], s58 offen offset:1024 nt lds
    v_mfma_f32_16x16x32_bf16 v[112:115], v[144:147], v[144:147], v[112:115]
    v_mfma_f32_16x16x32_bf16 v[116:119], v[52:55], v[144:147], v[116:119]
    buffer_load_dwordx4 v24, s[24:27], s58 offen offset:2048 nt lds
    v_mfma_f32_16x16x32_bf16 v[112:115], v[148:151], v[148:151], v[112:115]
    v_mfma_f32_16x16x32_bf16 v[116:119], v[52:55], v[148:151], v[116:119]
    v_mfma_f32_16x16x32_bf16 v[112:115], v[152:155], v[152:155], v[112:115]
    v_mfma_f32_16x16x32_bf16 v[116:119], v[52:55], v[152:155], v[116:119]
    v_mfma_f32_16x16x32_bf16 v[112:115], v[156:159], v[156:159], v[112:115]
    v_mfma_f32_16x16x32_bf16 v[116:119], v[52:55], v[156:159], v[116:119]
    s_mul_i32 s39, s38, 0x9e3779b1
    s_add_u32 s39, s39, 0x7f4a7c16
    s_or_b32 s39, s39, 1
    s_lshl_b32 s61, s61, 10
    s_add_u32 s61, s61, 16384
    s_waitcnt vmcnt(15)
    s_barrier
    ds_read_b64_tr_b16 v[160:161], v124 offset:0
    ds_read_b64_tr_b16 v[162:163], v125 offset:1536
    ds_read_b64_tr_b16 v[184:185], v126 offset:0
    ds_read_b64_tr_b16 v[186:187], v127 offset:1536
    ds_read_b64_tr_b16 v[208:209], v128 offset:0
    ds_read_b64_tr_b16 v[210:211], v129 offset:1536
    ds_read_b64_tr_b16 v[164:165], v124 offset:12288
    ds_read_b64_tr_b16 v[166:167], v125 offset:13824
    ds_read_b64_tr_b16 v[188:189], v126 offset:12288
    ds_read_b64_tr_b16 v[190:191], v127 offset:13824
    ds_read_b64_tr_b16 v[212:213], v128 offset:12288
    ds_read_b64_tr_b16 v[214:215], v129 offset:13824
    v_cndmask_b32 v3, 0, v112, s[44:45]
    v_cndmask_b32 v3, v3, v113, s[46:47]
    v_cndmask_b32 v3, v3, v114, s[48:49]
    v_cndmask_b32 v3, v3, v115, s[50:51]
    v_mul_f32 v6, 0x3baaaaab, v116
    ds_read_b64_tr_b16 v[168:169], v124 offset:24576
    ds_read_b64_tr_b16 v[170:171], v125 offset:26112
    v_mfma_f32_16x16x4_f32 v[120:123], v60, v3, v[56:59]
    s_waitcnt lgkmcnt(12)
    v_mfma_f32_16x16x32_bf16 v[88:91], v[160:163], v[136:139], 0
    ds_read_b64_tr_b16 v[192:193], v126 offset:24576
    v_mfma_f32_16x16x32_bf16 v[100:103], v[160:163], v[52:55], 0
    ds_read_b64_tr_b16 v[194:195], v127 offset:26112
    s_waitcnt lgkmcnt(12)
    v_mfma_f32_16x16x32_bf16 v[92:95], v[184:187], v[136:139], 0
    ds_read_b64_tr_b16 v[216:217], v128 offset:24576
    v_mfma_f32_16x16x32_bf16 v[104:107], v[184:187], v[52:55], 0
    ds_read_b64_tr_b16 v[218:219], v129 offset:26112
    s_waitcnt lgkmcnt(12)
    v_mfma_f32_16x16x32_bf16 v[96:99], v[208:211], v[136:139], 0
    ds_read_b64_tr_b16 v[172:173], v124 offset:36864
    v_mfma_f32_16x16x32_bf16 v[108:111], v[208:211], v[52:55], 0
    ds_read_b64_tr_b16 v[174:175], v125 offset:38400
    s_waitcnt lgkmcnt(12)
    v_mfma_f32_16x16x32_bf16 v[88:91], v[164:167], v[140:143], v[88:91]
    ds_read_b64_tr_b16 v[196:197], v126 offset:36864
    v_mfma_f32_16x16x32_bf16 v[100:103], v[164:167], v[52:55], v[100:103]
    ds_read_b64_tr_b16 v[198:199], v127 offset:38400
    s_waitcnt lgkmcnt(12)
    v_mfma_f32_16x16x32_bf16 v[92:95], v[188:191], v[140:143], v[92:95]
    ds_read_b64_tr_b16 v[220:221], v128 offset:36864
    v_mfma_f32_16x16x32_bf16 v[104:107], v[188:191], v[52:55], v[104:107]
    ds_read_b64_tr_b16 v[222:223], v129 offset:38400
    s_waitcnt lgkmcnt(12)
    v_mfma_f32_16x16x32_bf16 v[96:99], v[212:215], v[140:143], v[96:99]
    ds_read_b64_tr_b16 v[176:177], v124 offset:49152
    v_mfma_f32_16x16x32_bf16 v[108:111], v[212:215], v[52:55], v[108:111]
    ds_read_b64_tr_b16 v[178:179], v125 offset:50688
    s_waitcnt lgkmcnt(12)
    v_mfma_f32_16x16x32_bf16 v[88:91], v[168:171], v[144:147], v[88:91]
    ds_read_b64_tr_b16 v[200:201], v126 offset:49152
    v_mfma_f32_16x16x32_bf16 v[100:103], v[168:171], v[52:55], v[100:103]
    ds_read_b64_tr_b16 v[202:203], v127 offset:50688
    s_waitcnt lgkmcnt(12)
    v_mfma_f32_16x16x32_bf16 v[92:95], v[192:195], v[144:147], v[92:95]
    ds_read_b64_tr_b16 v[224:225], v128 offset:49152
    v_mfma_f32_16x16x32_bf16 v[104:107], v[192:195], v[52:55], v[104:107]
    ds_read_b64_tr_b16 v[226:227], v129 offset:50688
    s_waitcnt lgkmcnt(12)
    v_mfma_f32_16x16x32_bf16 v[96:99], v[216:219], v[144:147], v[96:99]
    ds_read_b64_tr_b16 v[180:181], v124 offset:61440
    v_mfma_f32_16x16x32_bf16 v[108:111], v[216:219], v[52:55], v[108:111]
    ds_read_b64_tr_b16 v[182:183], v125 offset:62976
    s_waitcnt lgkmcnt(12)
    v_mfma_f32_16x16x32_bf16 v[88:91], v[172:175], v[148:151], v[88:91]
    ds_read_b64_tr_b16 v[204:205], v126 offset:61440
    v_mfma_f32_16x16x32_bf16 v[100:103], v[172:175], v[52:55], v[100:103]
    ds_read_b64_tr_b16 v[206:207], v127 offset:62976
    s_waitcnt lgkmcnt(12)
    v_mfma_f32_16x16x32_bf16 v[92:95], v[196:199], v[148:151], v[92:95]
    ds_read_b64_tr_b16 v[228:229], v128 offset:61440
    v_mfma_f32_16x16x32_bf16 v[104:107], v[196:199], v[52:55], v[104:107]
    ds_read_b64_tr_b16 v[230:231], v129 offset:62976
    s_waitcnt lgkmcnt(12)
    v_mfma_f32_16x16x32_bf16 v[96:99], v[220:223], v[148:151], v[96:99]
    v_fma_f32 v5, -v116, v116, v120
    v_mfma_f32_16x16x32_bf16 v[108:111], v[220:223], v[52:55], v[108:111]
    v_max_f32 v5, v5, v56
    s_waitcnt lgkmcnt(10)
    v_mfma_f32_16x16x32_bf16 v[88:91], v[176:179], v[152:155], v[88:91]
    v_rsq_f32 v5, v5
    v_mfma_f32_16x16x32_bf16 v[100:103], v[176:179], v[52:55], v[100:103]
    v_mov_b32 v122, s39
    s_waitcnt lgkmcnt(8)
    v_mfma_f32_16x16x32_bf16 v[92:95], v[200:203], v[152:155], v[92:95]
    v_mul_f32 v5, v60, v5
    v_mfma_f32_16x16x32_bf16 v[104:107], v[200:203], v[52:55], v[104:107]
    v_mov_b32 v123, s39
    s_waitcnt lgkmcnt(6)
    v_mfma_f32_16x16x32_bf16 v[96:99], v[224:227], v[152:155], v[96:99]
    v_mfma_f32_16x16x32_bf16 v[108:111], v[224:227], v[52:55], v[108:111]
    s_waitcnt lgkmcnt(4)
    v_mfma_f32_16x16x32_bf16 v[88:91], v[180:183], v[156:159], v[88:91]
    v_mfma_f32_16x16x32_bf16 v[100:103], v[180:183], v[52:55], v[100:103]
    s_waitcnt lgkmcnt(2)
    v_mfma_f32_16x16x32_bf16 v[92:95], v[204:207], v[156:159], v[92:95]
    v_mfma_f32_16x16x32_bf16 v[104:107], v[204:207], v[52:55], v[104:107]
    s_waitcnt lgkmcnt(0)
    v_mfma_f32_16x16x32_bf16 v[96:99], v[228:231], v[156:159], v[96:99]
    v_mfma_f32_16x16x32_bf16 v[108:111], v[228:231], v[52:55], v[108:111]
    s_nop 1
    v_fma_f32 v88, -v6, v100, v88
    v_fma_f32 v89, -v6, v101, v89
    v_fma_f32 v90, -v6, v102, v90
    v_fma_f32 v91, -v6, v103, v91
    v_mul_f32 v88, v88, v5
    v_mul_f32 v89, v89, v5
    v_mul_f32 v90, v90, v5
    v_mul_f32 v91, v91, v5
    v_cvt_pk_bf16_f32 v112, v88, v89
    v_cvt_pk_bf16_f32 v113, v90, v91
    ds_write_b64 v134, v[112:113] offset:0
    v_fma_f32 v92, -v6, v104, v92
    v_fma_f32 v93, -v6, v105, v93
    v_fma_f32 v94, -v6, v106, v94
    v_fma_f32 v95, -v6, v107, v95
    v_mul_f32 v92, v92, v5
    v_mul_f32 v93, v93, v5
    v_mul_f32 v94, v94, v5
    v_mul_f32 v95, v95, v5
    v_cvt_pk_bf16_f32 v114, v92, v93
    v_cvt_pk_bf16_f32 v115, v94, v95
    ds_write_b64 v134, v[114:115] offset:512
    v_fma_f32 v96, -v6, v108, v96
    v_fma_f32 v97, -v6, v109, v97
    v_fma_f32 v98, -v6, v110, v98
    v_fma_f32 v99, -v6, v111, v99
    v_mul_f32 v96, v96, v5
    v_mul_f32 v97, v97, v5
    v_mul_f32 v98, v98, v5
    v_mul_f32 v99, v99, v5
    v_cvt_pk_bf16_f32 v116, v96, v97
    v_cvt_pk_bf16_f32 v117, v98, v99
    ds_write_b64 v134, v[116:117] offset:1024
    s_waitcnt vmcnt(9)
    s_waitcnt lgkmcnt(0)
    s_barrier
    ds_read_b128 v[136:139], v135 offset:0
    ds_read_b128 a[96:99], v130 offset:0
    ds_read_b128 v[140:143], v135 offset:1024
    ds_read_b128 a[100:103], v131 offset:0
    ds_read_b128 v[144:147], v135 offset:2048
    ds_read_b128 a[104:107], v130 offset:128
    ds_read_b128 v[148:151], v135 offset:3072
    ds_read_b128 a[108:111], v131 offset:128
    ds_read_b128 v[152:155], v135 offset:4096
    ds_read_b128 a[112:115], v130 offset:256
    ds_read_b128 v[156:159], v135 offset:5120
    ds_read_b128 a[116:119], v131 offset:256
    s_waitcnt lgkmcnt(10)
    v_mfma_f32_16x16x32_bf16 v[88:91], a[96:99], v[136:139], 0
    s_waitcnt lgkmcnt(8)
    v_mfma_f32_16x16x32_bf16 v[92:95], a[100:103], v[140:143], 0
    s_waitcnt lgkmcnt(6)
    v_mfma_f32_16x16x32_bf16 v[88:91], a[104:107], v[144:147], v[88:91]
    s_waitcnt lgkmcnt(4)
    v_mfma_f32_16x16x32_bf16 v[92:95], a[108:111], v[148:151], v[92:95]
    s_waitcnt lgkmcnt(2)
    v_mfma_f32_16x16x32_bf16 v[88:91], a[112:115], v[152:155], v[88:91]
    s_waitcnt lgkmcnt(0)
    v_mfma_f32_16x16x32_bf16 v[92:95], a[116:119], v[156:159], v[92:95]
    s_nop 7
    v_add_f32 v88, v88, v92
    v_add_f32 v89, v89, v93
    v_add_f32 v90, v90, v94
    v_add_f32 v91, v91, v95
    v_mul_f32 v88, 0x419fecaf, v88
    v_mul_f32 v89, 0x419fecaf, v89
    v_mul_f32 v90, 0x419fecaf, v90
    v_mul_f32 v91, 0x419fecaf, v91
    v_cvt_pk_bf16_f32 v120, v88, v89
    v_cvt_pk_bf16_f32 v121, v90, v91
    buffer_store_dwordx4 v[120:123], v65, s[32:35], s61 offen sc1
    buffer_load_dwordx4 v25, s[24:27], s58 offen offset:3072 nt lds
    s_add_u32 m0, s41, 4096
    s_nop 0
    buffer_load_dwordx4 v26, s[24:27], s58 offen offset:0 nt lds
    buffer_load_dwordx4 v27, s[24:27], s58 offen offset:1024 nt lds
    s_barrier
    buffer_load_dwordx4 v28, s[24:27], s58 offen offset:2048 nt lds
    buffer_load_dwordx4 v29, s[24:27], s58 offen offset:3072 nt lds
    s_add_u32 m0, s41, 8192
    s_nop 0
    buffer_load_dwordx4 v30, s[24:27], s58 offen offset:0 nt lds
    buffer_load_dwordx4 v31, s[24:27], s58 offen offset:1024 nt lds
    buffer_load_dwordx4 v32, s[24:27], s58 offen offset:2048 nt lds
    buffer_load_dwordx4 v33, s[24:27], s58 offen offset:3072 nt lds
    v_and_b32 v1, 15, v0
    v_lshrrev_b32 v6, 5, v0
    v_bfe_u32 v3, v0, 4, 1
    v_lshl_or_b32 v3, v3, 1, v6
    v_lshrrev_b32 v4, 2, v0
    v_bfe_u32 v5, v0, 1, 1
    v_lshrrev_b32 v6, 3, v1
    v_and_or_b32 v6, v1, 6, v6
    v_xor_b32 v6, v6, v3
    v_mul_u32_u24 v7, 384, v1
    v_lshl_add_u32 v6, v6, 4, v7
    v_add_u32 v34, s40, v6
    v_xor_b32 v35, 64, v34
    v_lshrrev_b32 v6, 3, v1
    v_and_b32 v7, 7, v1
    v_lshl_or_b32 v6, v7, 1, v6
    v_xor_b32 v6, v6, v3
    v_mul_u32_u24 v7, 768, v1
    v_lshl_add_u32 v6, v6, 4, v7
    v_add_u32 v40, s41, v6
    v_xor_b32 v41, 0x40, v40
    v_xor_b32 v42, 0x80, v40
    v_xor_b32 v43, 0xc0, v40
    v_and_b32 v2, 1, v0
    v_lshlrev_b32 v2, 3, v2
    s_mul_i32 s56, s3, 96
    v_lshrrev_b32 v6, 3, v4
    v_and_or_b32 v6, v4, 6, v6
    v_xor_b32 v6, v6, v5
    v_lshl_add_u32 v6, v6, 4, v2
    v_mul_u32_u24 v7, 384, v4
    s_add_u32 s57, s56, 0
    v_xad_u32 v36, v6, s57, v7
    s_add_u32 s57, s56, 32
    v_xad_u32 v37, v6, s57, v7
    s_add_u32 s57, s56, 64
    v_xad_u32 v38, v6, s57, v7
    v_lshrrev_b32 v6, 3, v4
    v_and_b32 v3, 7, v4
    v_lshl_or_b32 v6, v3, 1, v6
    v_xor_b32 v6, v6, v5
    v_lshl_add_u32 v6, v6, 4, v2
    v_lshlrev_b32 v7, 1, v7
    v_add_u32 v7, 24576, v7
    s_add_u32 s57, s56, 0
    v_xad_u32 v44, v6, s57, v7
    s_add_u32 s57, s56, 384
    v_xad_u32 v45, v6, s57, v7
    s_add_u32 s57, s56, 32
    v_xad_u32 v46, v6, s57, v7
    s_add_u32 s57, s56, 416
    v_xad_u32 v47, v6, s57, v7
    s_add_u32 s57, s56, 64
    v_xad_u32 v48, v6, s57, v7
    s_add_u32 s57, s56, 448
    v_xad_u32 v49, v6, s57, v7
    v_lshrrev_b32 v1, 5, v0
    v_lshlrev_b32 v1, 8, v1
    v_and_b32 v2, 15, v0
    v_lshl_add_u32 v1, v2, 4, v1
    v_bfe_u32 v2, v0, 4, 1
    v_lshl_add_u32 v1, v2, 3, v1
    s_mul_i32 s56, s3, 1536
    s_add_u32 s56, s56, 147456
    v_add_u32 v236, s56, v1
    s_mul_i32 s56, s3, 3072
    s_add_u32 s56, s56, 24576
    v_add_u32 v237, s56, v65
    v_add_u32 v238, s41, v65
    s_lshl_b32 s56, s3, 10
    v_add_u32 v240, 159744, v65
    v_add_u32 v239, s56, v240
    v_add_u32 v241, 147456, v65
    v_bfe_u32 v1, v0, 2, 2
    v_lshrrev_b32 v2, 4, v0
    v_lshl_or_b32 v1, v1, 4, v2
    v_mul_u32_u24 v1, 65536, v1
    v_and_b32 v2, 3, v0
    v_lshl_or_b32 v242, v2, 5, v1
    v_xor_b32 v243, 0x70, v242
    s_mul_i32 s56, s3, 3
    v_min_u32 v1, 2, v0
    v_add_u32 v1, s56, v1
    v_min_u32 v2, 8, v0
    v_add_u32 v2, 9, v2
    v_cmp_gt_u32 vcc, 3, v0
    s_nop 1
    v_cndmask_b32 v1, v2, v1, vcc
    v_lshlrev_b32 v245, 7, v1
    v_lshlrev_b32 v1, 3, v0
    v_add_u32 v254, 126976, v1
    s_lshl_b32 s56, s3, 9
    v_add_u32 v238, s56, v254
    v_add_u32 v253, 122880, v65
    s_lshl_b32 s56, s3, 10
    v_add_u32 v237, s56, v253
    s_mov_b32 s52, 0x41c00000
    s_add_u32 m0, s42, 0
    s_add_u32 s59, s37, 196608
    buffer_load_dwordx4 v22, s[24:27], s59 offen offset:0 nt lds
    s_waitcnt vmcnt(14)
    s_barrier
    ds_read_b128 a[48:51], v34 offset:0
    ds_read_b128 a[52:55], v35 offset:0
    ds_read_b128 a[56:59], v34 offset:128
    ds_read_b128 a[60:63], v35 offset:128
    ds_read_b128 a[64:67], v34 offset:256
    ds_read_b128 a[68:71], v35 offset:256
    s_waitcnt lgkmcnt(5)
    v_mfma_f32_16x16x32_bf16 v[84:87], a[48:51], a[48:51], 0
    buffer_load_dwordx4 v23, s[24:27], s59 offen offset:1024 nt lds
    ds_read_b64_tr_b16 a[72:73], v36 offset:0
    ds_read_b64_tr_b16 a[74:75], v36 offset:6144
    v_mfma_f32_16x16x32_bf16 v[80:83], a[48:51], v[52:55], 0
    ds_read_b64_tr_b16 a[76:77], v36 offset:12288
    ds_read_b64_tr_b16 a[78:79], v36 offset:18432
    s_waitcnt lgkmcnt(8)
    v_mfma_f32_16x16x32_bf16 v[84:87], a[52:55], a[52:55], v[84:87]
    ds_read_b64_tr_b16 a[80:81], v37 offset:0
    ds_read_b64_tr_b16 a[82:83], v37 offset:6144
    v_mfma_f32_16x16x32_bf16 v[80:83], a[52:55], v[52:55], v[80:83]
    ds_read_b64_tr_b16 a[84:85], v37 offset:12288
    ds_read_b64_tr_b16 a[86:87], v37 offset:18432
    s_waitcnt lgkmcnt(11)
    v_mfma_f32_16x16x32_bf16 v[84:87], a[56:59], a[56:59], v[84:87]
    buffer_load_dwordx4 v24, s[24:27], s59 offen offset:2048 nt lds
    ds_read_b64_tr_b16 a[88:89], v38 offset:0
    ds_read_b64_tr_b16 a[90:91], v38 offset:6144
    v_mfma_f32_16x16x32_bf16 v[80:83], a[56:59], v[52:55], v[80:83]
    buffer_load_dwordx4 v25, s[24:27], s59 offen offset:3072 nt lds
    ds_read_b64_tr_b16 a[92:93], v38 offset:12288
    ds_read_b64_tr_b16 a[94:95], v38 offset:18432
    s_waitcnt lgkmcnt(14)
    v_mfma_f32_16x16x32_bf16 v[84:87], a[60:63], a[60:63], v[84:87]
    v_mfma_f32_16x16x32_bf16 v[80:83], a[60:63], v[52:55], v[80:83]
    s_waitcnt lgkmcnt(13)
    v_mfma_f32_16x16x32_bf16 v[84:87], a[64:67], a[64:67], v[84:87]
    v_mfma_f32_16x16x32_bf16 v[80:83], a[64:67], v[52:55], v[80:83]
    s_waitcnt lgkmcnt(12)
    v_mfma_f32_16x16x32_bf16 v[84:87], a[68:71], a[68:71], v[84:87]
    v_mfma_f32_16x16x32_bf16 v[80:83], a[68:71], v[52:55], v[80:83]
    s_waitcnt lgkmcnt(0)
    s_mul_i32 s39, s38, 0x9e3779b1
    s_add_u32 s39, s39, 0x7f4a7c16
    s_or_b32 s39, s39, 1
    s_add_u32 m0, s42, 4096
    s_nop 0
    buffer_load_dwordx4 v26, s[24:27], s59 offen offset:0 nt lds
    buffer_load_dwordx4 v27, s[24:27], s59 offen offset:1024 nt lds
    buffer_load_dwordx4 v28, s[24:27], s59 offen offset:2048 nt lds
    buffer_load_dwordx4 v29, s[24:27], s59 offen offset:3072 nt lds
    s_add_u32 m0, s42, 8192
    s_nop 0
    buffer_load_dwordx4 v30, s[24:27], s59 offen offset:0 nt lds
    buffer_load_dwordx4 v31, s[24:27], s59 offen offset:1024 nt lds
    buffer_load_dwordx4 v32, s[24:27], s59 offen offset:2048 nt lds
    s_mul_i32 s56, s3, 3072
    s_add_u32 s56, s56, 16384
    buffer_load_dwordx4 v[136:139], v65, s[32:35], s56 offen offset:0 sc1
    buffer_load_dwordx4 v[140:143], v65, s[32:35], s56 offen offset:1024 sc1
    buffer_load_dwordx4 v[144:147], v65, s[32:35], s56 offen offset:2048 sc1
    s_mov_b32 s43, -1
    s_branch L_join
L_vprod:
    s_mul_i32 s60, s3, 18432
    s_add_u32 m0, s60, 73728
    s_nop 0
    buffer_load_dwordx4 v16, s[64:67], s60 offen offset:0  lds
    buffer_load_dwordx4 v17, s[64:67], s60 offen offset:1024  lds
    buffer_load_dwordx4 v18, s[64:67], s60 offen offset:2048  lds
    buffer_load_dwordx4 v19, s[64:67], s60 offen offset:3072  lds
    s_add_u32 m0, s60, 77824
    s_nop 0
    buffer_load_dwordx4 v20, s[64:67], s60 offen offset:0  lds
    buffer_load_dwordx4 v21, s[64:67], s60 offen offset:1024  lds
    s_add_u32 s60, s60, 6144
    s_add_u32 m0, s60, 73728
    s_nop 0
    buffer_load_dwordx4 v16, s[64:67], s60 offen offset:0  lds
    buffer_load_dwordx4 v17, s[64:67], s60 offen offset:1024  lds
    buffer_load_dwordx4 v18, s[64:67], s60 offen offset:2048  lds
    buffer_load_dwordx4 v19, s[64:67], s60 offen offset:3072  lds
    s_add_u32 m0, s60, 77824
    s_nop 0
    buffer_load_dwordx4 v20, s[64:67], s60 offen offset:0  lds
    buffer_load_dwordx4 v21, s[64:67], s60 offen offset:1024  lds
    s_add_u32 s60, s60, 6144
    s_add_u32 m0, s60, 73728
    s_nop 0
    buffer_load_dwordx4 v16, s[64:67], s60 offen offset:0  lds
    v_lshrrev_b32 v1, 4, v0
    v_and_b32 v5, 1, v1
    v_bfe_u32 v2, v0, 2, 2
    v_lshl_add_u32 v3, v1, 3, v2
    buffer_load_dwordx4 v17, s[64:67], s60 offen offset:1024  lds
    v_mul_u32_u24 v3, 384, v3
    v_and_b32 v4, 1, v0
    v_lshl_add_u32 v3, v4, 3, v3
    v_add_u32 v3, 73728, v3
    buffer_load_dwordx4 v18, s[64:67], s60 offen offset:2048  lds
    v_and_or_b32 v2, v2, 2, v5
    v_bfe_u32 v4, v0, 1, 1
    v_xor_b32 v2, v2, v4
    s_mul_i32 s56, s3, 6
    buffer_load_dwordx4 v19, s[64:67], s60 offen offset:3072  lds
    s_add_u32 s57, s56, 0
    v_xor_b32 v4, s57, v2
    v_lshl_add_u32 v136, v4, 4, v3
    v_xor_b32 v137, 64, v136
    s_add_u32 m0, s60, 77824
    s_nop 0
    buffer_load_dwordx4 v20, s[64:67], s60 offen offset:0  lds
    s_add_u32 s57, s56, 2
    v_xor_b32 v4, s57, v2
    v_lshl_add_u32 v138, v4, 4, v3
    v_xor_b32 v139, 64, v138
    buffer_load_dwordx4 v21, s[64:67], s60 offen offset:1024  lds
    s_add_u32 s57, s56, 4
    v_xor_b32 v4, s57, v2
    v_lshl_add_u32 v140, v4, 4, v3
    v_xor_b32 v141, 64, v140
    s_lshl_b32 s61, s43, 2
    s_add_u32 s61, s61, s3
    s_mul_i32 s60, s61, 6144
    s_add_u32 m0, s41, 6144
    s_nop 0
    buffer_load_dwordx4 v16, s[68:71], s60 offen offset:0  lds
    v_bfe_u32 v1, v0, 2, 1
    v_and_b32 v2, 3, v0
    v_lshl_or_b32 v2, v1, 3, v2
    v_and_or_b32 v1, v0, 2, v1
    buffer_load_dwordx4 v17, s[68:71], s60 offen offset:1024  lds
    v_lshrrev_b32 v3, 4, v0
    v_xor_b32 v1, v1, v3
    v_mul_u32_u24 v2, 384, v2
    v_lshl_add_u32 v1, v1, 4, v2
    buffer_load_dwordx4 v18, s[68:71], s60 offen offset:2048  lds
    v_bfe_u32 v2, v0, 3, 1
    v_mul_u32_u24 v2, 12288, v2
    s_mov_b32 s56, 30720
    v_add3_u32 v142, s56, v1, v2
    buffer_load_dwordx4 v19, s[68:71], s60 offen offset:3072  lds
    v_xor_b32 v143, 64, v142
    s_add_u32 m0, s41, 10240
    s_nop 0
    buffer_load_dwordx4 v20, s[68:71], s60 offen offset:0  lds
    buffer_load_dwordx4 v21, s[68:71], s60 offen offset:1024  lds
    s_load_dword s38, s[22:23], 0
    s_barrier
    s_add_u32 m0, s40, 0
    s_add_u32 s57, s36, 0
    buffer_load_dwordx4 v16, s[28:31], s57 offen offset:0 nt lds
    buffer_load_dwordx4 v17, s[28:31], s57 offen offset:1024 nt lds
    buffer_load_dwordx4 v18, s[28:31], s57 offen offset:2048 nt lds
    buffer_load_dwordx4 v19, s[28:31], s57 offen offset:3072 nt lds
    s_add_u32 m0, s40, 4096
    s_nop 0
    buffer_load_dwordx4 v20, s[28:31], s57 offen offset:0 nt lds
    buffer_load_dwordx4 v21, s[28:31], s57 offen offset:1024 nt lds
    s_add_u32 m0, s41, 0
    s_add_u32 s58, s37, 0
    buffer_load_dwordx4 v22, s[24:27], s58 offen offset:0 nt lds
    buffer_load_dwordx4 v23, s[24:27], s58 offen offset:1024 nt lds
    buffer_load_dwordx4 v24, s[24:27], s58 offen offset:2048 nt lds
    s_waitcnt vmcnt(9)
    s_barrier
    ds_read_b128 a[96:99], v142 offset:0
    ds_read_b128 a[100:103], v143 offset:0
    ds_read_b128 a[104:107], v142 offset:128
    ds_read_b128 a[108:111], v143 offset:128
    ds_read_b128 a[112:115], v142 offset:256
    ds_read_b128 a[116:119], v143 offset:256
    ds_read_b128 a[120:123], v143 offset:1536
    ds_read_b128 a[124:127], v142 offset:1536
    ds_read_b128 a[128:131], v143 offset:1664
    ds_read_b128 a[132:135], v142 offset:1664
    ds_read_b128 a[136:139], v143 offset:1792
    ds_read_b128 a[140:143], v142 offset:1792
    ds_read_b128 a[144:147], v142 offset:24576
    ds_read_b128 a[148:151], v143 offset:24576
    ds_read_b128 a[152:155], v142 offset:24704
    ds_read_b128 a[156:159], v143 offset:24704
    ds_read_b128 a[160:163], v142 offset:24832
    ds_read_b128 a[164:167], v143 offset:24832
    ds_read_b128 a[168:171], v143 offset:26112
    ds_read_b128 a[172:175], v142 offset:26112
    ds_read_b128 a[176:179], v143 offset:26240
    ds_read_b128 a[180:183], v142 offset:26240
    ds_read_b128 a[184:187], v143 offset:26368
    ds_read_b128 a[188:191], v142 offset:26368
    ds_read_b64_tr_b16 v[160:161], v136 offset:0
    ds_read_b64_tr_b16 v[162:163], v137 offset:1536
    ds_read_b64_tr_b16 v[164:165], v136 offset:12288
    ds_read_b64_tr_b16 v[166:167], v137 offset:13824
    ds_read_b64_tr_b16 v[168:169], v136 offset:24576
    ds_read_b64_tr_b16 v[170:171], v137 offset:26112
    ds_read_b64_tr_b16 v[172:173], v136 offset:36864
    ds_read_b64_tr_b16 v[174:175], v137 offset:38400
    ds_read_b64_tr_b16 v[176:177], v136 offset:49152
    ds_read_b64_tr_b16 v[178:179], v137 offset:50688
    ds_read_b64_tr_b16 v[180:181], v136 offset:61440
    ds_read_b64_tr_b16 v[182:183], v137 offset:62976
    ds_read_b64_tr_b16 v[184:185], v138 offset:0
    ds_read_b64_tr_b16 v[186:187], v139 offset:1536
    ds_read_b64_tr_b16 v[188:189], v138 offset:12288
    ds_read_b64_tr_b16 v[190:191], v139 offset:13824
    ds_read_b64_tr_b16 v[192:193], v138 offset:24576
    ds_read_b64_tr_b16 v[194:195], v139 offset:26112
    ds_read_b64_tr_b16 v[196:197], v138 offset:36864
    ds_read_b64_tr_b16 v[198:199], v139 offset:38400
    ds_read_b64_tr_b16 v[200:201], v138 offset:49152
    ds_read_b64_tr_b16 v[202:203], v139 offset:50688
    ds_read_b64_tr_b16 v[204:205], v138 offset:61440
    ds_read_b64_tr_b16 v[206:207], v139 offset:62976
    ds_read_b64_tr_b16 v[208:209], v140 offset:0
    ds_read_b64_tr_b16 v[210:211], v141 offset:1536
    ds_read_b64_tr_b16 v[212:213], v140 offset:12288
    ds_read_b64_tr_b16 v[214:215], v141 offset:13824
    ds_read_b64_tr_b16 v[216:217], v140 offset:24576
    ds_read_b64_tr_b16 v[218:219], v141 offset:26112
    ds_read_b64_tr_b16 v[220:221], v140 offset:36864
    ds_read_b64_tr_b16 v[222:223], v141 offset:38400
    ds_read_b64_tr_b16 v[224:225], v140 offset:49152
    ds_read_b64_tr_b16 v[226:227], v141 offset:50688
    ds_read_b64_tr_b16 v[228:229], v140 offset:61440
    ds_read_b64_tr_b16 v[230:231], v141 offset:62976
    s_waitcnt lgkmcnt(0)
    s_barrier
    s_mul_i32 s60, s3, 18432
    s_lshl_b32 s61, s43, 11
    s_add_u32 s60, s60, s61
    s_add_u32 s60, s60, 3145728
    v_mfma_f32_16x16x32_bf16 v[88:91], a[96:99], v[160:163], 0
    v_mfma_f32_16x16x32_bf16 v[92:95], a[120:123], v[160:163], 0
    v_mfma_f32_16x16x32_bf16 v[96:99], a[144:147], v[160:163], 0
    v_mfma_f32_16x16x32_bf16 v[100:103], a[168:171], v[160:163], 0
    buffer_load_dwordx4 v25, s[24:27], s58 offen offset:3072 nt lds
    v_mfma_f32_16x16x32_bf16 v[88:91], a[100:103], v[164:167], v[88:91]
    v_mfma_f32_16x16x32_bf16 v[92:95], a[124:127], v[164:167], v[92:95]
    v_mfma_f32_16x16x32_bf16 v[96:99], a[148:151], v[164:167], v[96:99]
    v_mfma_f32_16x16x32_bf16 v[100:103], a[172:175], v[164:167], v[100:103]
    s_add_u32 m0, s41, 4096
    s_nop 0
    buffer_load_dwordx4 v26, s[24:27], s58 offen offset:0 nt lds
    v_mfma_f32_16x16x32_bf16 v[88:91], a[104:107], v[168:171], v[88:91]
    v_mfma_f32_16x16x32_bf16 v[92:95], a[128:131], v[168:171], v[92:95]
    v_mfma_f32_16x16x32_bf16 v[96:99], a[152:155], v[168:171], v[96:99]
    v_mfma_f32_16x16x32_bf16 v[100:103], a[176:179], v[168:171], v[100:103]
    buffer_load_dwordx4 v27, s[24:27], s58 offen offset:1024 nt lds
    v_mfma_f32_16x16x32_bf16 v[88:91], a[108:111], v[172:175], v[88:91]
    v_mfma_f32_16x16x32_bf16 v[92:95], a[132:135], v[172:175], v[92:95]
    v_mfma_f32_16x16x32_bf16 v[96:99], a[156:159], v[172:175], v[96:99]
    v_mfma_f32_16x16x32_bf16 v[100:103], a[180:183], v[172:175], v[100:103]
    buffer_load_dwordx4 v28, s[24:27], s58 offen offset:2048 nt lds
    v_mfma_f32_16x16x32_bf16 v[88:91], a[112:115], v[176:179], v[88:91]
    v_mfma_f32_16x16x32_bf16 v[92:95], a[136:139], v[176:179], v[92:95]
    v_mfma_f32_16x16x32_bf16 v[96:99], a[160:163], v[176:179], v[96:99]
    v_mfma_f32_16x16x32_bf16 v[100:103], a[184:187], v[176:179], v[100:103]
    buffer_load_dwordx4 v29, s[24:27], s58 offen offset:3072 nt lds
    v_mfma_f32_16x16x32_bf16 v[88:91], a[116:119], v[180:183], v[88:91]
    v_mfma_f32_16x16x32_bf16 v[92:95], a[140:143], v[180:183], v[92:95]
    v_mfma_f32_16x16x32_bf16 v[96:99], a[164:167], v[180:183], v[96:99]
    v_mfma_f32_16x16x32_bf16 v[100:103], a[188:191], v[180:183], v[100:103]
    v_mfma_f32_16x16x32_bf16 v[104:107], a[96:99], v[184:187], 0
    v_mfma_f32_16x16x32_bf16 v[108:111], a[120:123], v[184:187], 0
    v_mfma_f32_16x16x32_bf16 v[112:115], a[144:147], v[184:187], 0
    v_mfma_f32_16x16x32_bf16 v[116:119], a[168:171], v[184:187], 0
    s_add_u32 m0, s41, 8192
    s_nop 0
    buffer_load_dwordx4 v30, s[24:27], s58 offen offset:0 nt lds
    v_mfma_f32_16x16x32_bf16 v[104:107], a[100:103], v[188:191], v[104:107]
    v_mfma_f32_16x16x32_bf16 v[108:111], a[124:127], v[188:191], v[108:111]
    v_mfma_f32_16x16x32_bf16 v[112:115], a[148:151], v[188:191], v[112:115]
    v_mfma_f32_16x16x32_bf16 v[116:119], a[172:175], v[188:191], v[116:119]
    buffer_load_dwordx4 v31, s[24:27], s58 offen offset:1024 nt lds
    v_mfma_f32_16x16x32_bf16 v[104:107], a[104:107], v[192:195], v[104:107]
    v_mfma_f32_16x16x32_bf16 v[108:111], a[128:131], v[192:195], v[108:111]
    v_mfma_f32_16x16x32_bf16 v[112:115], a[152:155], v[192:195], v[112:115]
    v_mfma_f32_16x16x32_bf16 v[116:119], a[176:179], v[192:195], v[116:119]
    buffer_load_dwordx4 v32, s[24:27], s58 offen offset:2048 nt lds
    v_cvt_pk_bf16_f32 v144, v88, v89
    v_cvt_pk_bf16_f32 v145, v90, v91
    v_cvt_pk_bf16_f32 v146, v92, v93
    v_cvt_pk_bf16_f32 v147, v94, v95
    buffer_store_dwordx4 v[144:147], v65, s[32:35], s60 offen offset:0 sc1
    v_cvt_pk_bf16_f32 v148, v96, v97
    v_cvt_pk_bf16_f32 v149, v98, v99
    v_cvt_pk_bf16_f32 v150, v100, v101
    v_cvt_pk_bf16_f32 v151, v102, v103
    buffer_store_dwordx4 v[148:151], v65, s[32:35], s60 offen offset:1024 sc1
    s_add_u32 s60, s60, 6144
    v_mfma_f32_16x16x32_bf16 v[104:107], a[108:111], v[196:199], v[104:107]
    v_mfma_f32_16x16x32_bf16 v[108:111], a[132:135], v[196:199], v[108:111]
    v_mfma_f32_16x16x32_bf16 v[112:115], a[156:159], v[196:199], v[112:115]
    v_mfma_f32_16x16x32_bf16 v[116:119], a[180:183], v[196:199], v[116:119]
    buffer_load_dwordx4 v33, s[24:27], s58 offen offset:3072 nt lds
    v_mfma_f32_16x16x32_bf16 v[104:107], a[112:115], v[200:203], v[104:107]
    v_mfma_f32_16x16x32_bf16 v[108:111], a[136:139], v[200:203], v[108:111]
    v_mfma_f32_16x16x32_bf16 v[112:115], a[160:163], v[200:203], v[112:115]
    v_mfma_f32_16x16x32_bf16 v[116:119], a[184:187], v[200:203], v[116:119]
    s_add_u32 m0, s42, 0
    s_add_u32 s59, s37, 196608
    buffer_load_dwordx4 v22, s[24:27], s59 offen offset:0 nt lds
    v_mfma_f32_16x16x32_bf16 v[104:107], a[116:119], v[204:207], v[104:107]
    v_mfma_f32_16x16x32_bf16 v[108:111], a[140:143], v[204:207], v[108:111]
    v_mfma_f32_16x16x32_bf16 v[112:115], a[164:167], v[204:207], v[112:115]
    v_mfma_f32_16x16x32_bf16 v[116:119], a[188:191], v[204:207], v[116:119]
    v_mfma_f32_16x16x32_bf16 v[120:123], a[96:99], v[208:211], 0
    v_mfma_f32_16x16x32_bf16 v[124:127], a[120:123], v[208:211], 0
    v_mfma_f32_16x16x32_bf16 v[128:131], a[144:147], v[208:211], 0
    v_mfma_f32_16x16x32_bf16 v[132:135], a[168:171], v[208:211], 0
    buffer_load_dwordx4 v23, s[24:27], s59 offen offset:1024 nt lds
    v_mfma_f32_16x16x32_bf16 v[120:123], a[100:103], v[212:215], v[120:123]
    v_mfma_f32_16x16x32_bf16 v[124:127], a[124:127], v[212:215], v[124:127]
    v_mfma_f32_16x16x32_bf16 v[128:131], a[148:151], v[212:215], v[128:131]
    v_mfma_f32_16x16x32_bf16 v[132:135], a[172:175], v[212:215], v[132:135]
    buffer_load_dwordx4 v24, s[24:27], s59 offen offset:2048 nt lds
    v_mfma_f32_16x16x32_bf16 v[120:123], a[104:107], v[216:219], v[120:123]
    v_mfma_f32_16x16x32_bf16 v[124:127], a[128:131], v[216:219], v[124:127]
    v_mfma_f32_16x16x32_bf16 v[128:131], a[152:155], v[216:219], v[128:131]
    v_mfma_f32_16x16x32_bf16 v[132:135], a[176:179], v[216:219], v[132:135]
    buffer_load_dwordx4 v25, s[24:27], s59 offen offset:3072 nt lds
    v_cvt_pk_bf16_f32 v152, v104, v105
    v_cvt_pk_bf16_f32 v153, v106, v107
    v_cvt_pk_bf16_f32 v154, v108, v109
    v_cvt_pk_bf16_f32 v155, v110, v111
    buffer_store_dwordx4 v[152:155], v65, s[32:35], s60 offen offset:0 sc1
    v_cvt_pk_bf16_f32 v156, v112, v113
    v_cvt_pk_bf16_f32 v157, v114, v115
    v_cvt_pk_bf16_f32 v158, v116, v117
    v_cvt_pk_bf16_f32 v159, v118, v119
    buffer_store_dwordx4 v[156:159], v65, s[32:35], s60 offen offset:1024 sc1
    s_add_u32 s60, s60, 6144
    v_mfma_f32_16x16x32_bf16 v[120:123], a[108:111], v[220:223], v[120:123]
    v_mfma_f32_16x16x32_bf16 v[124:127], a[132:135], v[220:223], v[124:127]
    v_mfma_f32_16x16x32_bf16 v[128:131], a[156:159], v[220:223], v[128:131]
    v_mfma_f32_16x16x32_bf16 v[132:135], a[180:183], v[220:223], v[132:135]
    s_add_u32 m0, s42, 4096
    s_nop 0
    buffer_load_dwordx4 v26, s[24:27], s59 offen offset:0 nt lds
    v_mfma_f32_16x16x32_bf16 v[120:123], a[112:115], v[224:227], v[120:123]
    v_mfma_f32_16x16x32_bf16 v[124:127], a[136:139], v[224:227], v[124:127]
    v_mfma_f32_16x16x32_bf16 v[128:131], a[160:163], v[224:227], v[128:131]
    v_mfma_f32_16x16x32_bf16 v[132:135], a[184:187], v[224:227], v[132:135]
    buffer_load_dwordx4 v27, s[24:27], s59 offen offset:1024 nt lds
    v_mfma_f32_16x16x32_bf16 v[120:123], a[116:119], v[228:231], v[120:123]
    v_mfma_f32_16x16x32_bf16 v[124:127], a[140:143], v[228:231], v[124:127]
    v_mfma_f32_16x16x32_bf16 v[128:131], a[164:167], v[228:231], v[128:131]
    v_mfma_f32_16x16x32_bf16 v[132:135], a[188:191], v[228:231], v[132:135]
    s_nop 4
    v_cvt_pk_bf16_f32 v144, v120, v121
    v_cvt_pk_bf16_f32 v145, v122, v123
    v_cvt_pk_bf16_f32 v146, v124, v125
    v_cvt_pk_bf16_f32 v147, v126, v127
    buffer_store_dwordx4 v[144:147], v65, s[32:35], s60 offen offset:0 sc1
    v_cvt_pk_bf16_f32 v148, v128, v129
    v_cvt_pk_bf16_f32 v149, v130, v131
    v_cvt_pk_bf16_f32 v150, v132, v133
    v_cvt_pk_bf16_f32 v151, v134, v135
    buffer_store_dwordx4 v[148:151], v65, s[32:35], s60 offen offset:1024 sc1
    v_and_b32 v1, 15, v0
    v_lshrrev_b32 v6, 5, v0
    v_bfe_u32 v3, v0, 4, 1
    v_lshl_or_b32 v3, v3, 1, v6
    v_lshrrev_b32 v4, 2, v0
    v_bfe_u32 v5, v0, 1, 1
    v_lshrrev_b32 v6, 3, v1
    v_and_or_b32 v6, v1, 6, v6
    v_xor_b32 v6, v6, v3
    v_mul_u32_u24 v7, 384, v1
    v_lshl_add_u32 v6, v6, 4, v7
    v_add_u32 v34, s40, v6
    v_xor_b32 v35, 64, v34
    v_lshrrev_b32 v6, 3, v1
    v_and_b32 v7, 7, v1
    v_lshl_or_b32 v6, v7, 1, v6
    v_xor_b32 v6, v6, v3
    v_mul_u32_u24 v7, 768, v1
    v_lshl_add_u32 v6, v6, 4, v7
    v_add_u32 v40, s41, v6
    v_xor_b32 v41, 0x40, v40
    v_xor_b32 v42, 0x80, v40
    v_xor_b32 v43, 0xc0, v40
    v_and_b32 v2, 1, v0
    v_lshlrev_b32 v2, 3, v2
    s_mul_i32 s56, s3, 96
    v_lshrrev_b32 v6, 3, v4
    v_and_or_b32 v6, v4, 6, v6
    v_xor_b32 v6, v6, v5
    v_lshl_add_u32 v6, v6, 4, v2
    v_mul_u32_u24 v7, 384, v4
    s_add_u32 s57, s56, 0
    v_xad_u32 v36, v6, s57, v7
    s_add_u32 s57, s56, 32
    v_xad_u32 v37, v6, s57, v7
    s_add_u32 s57, s56, 64
    v_xad_u32 v38, v6, s57, v7
    v_lshrrev_b32 v6, 3, v4
    v_and_b32 v3, 7, v4
    v_lshl_or_b32 v6, v3, 1, v6
    v_xor_b32 v6, v6, v5
    v_lshl_add_u32 v6, v6, 4, v2
    v_lshlrev_b32 v7, 1, v7
    v_add_u32 v7, 24576, v7
    s_add_u32 s57, s56, 0
    v_xad_u32 v44, v6, s57, v7
    s_add_u32 s57, s56, 384
    v_xad_u32 v45, v6, s57, v7
    s_add_u32 s57, s56, 32
    v_xad_u32 v46, v6, s57, v7
    s_add_u32 s57, s56, 416
    v_xad_u32 v47, v6, s57, v7
    s_add_u32 s57, s56, 64
    v_xad_u32 v48, v6, s57, v7
    s_add_u32 s57, s56, 448
    v_xad_u32 v49, v6, s57, v7
    v_mov_b32 v52, 0x3f803f80
    v_mov_b32 v56, 0x3ebcbe62
    s_mov_b32 s44, 0x100001
    s_mov_b32 s45, 0x10000100
    v_mov_b32 v53, 0x3f803f80
    v_mov_b32 v57, 0x3ebcbe62
    s_mov_b32 s46, 0x200002
    s_mov_b32 s47, 0x20000200
    v_mov_b32 v54, 0x3f803f80
    v_mov_b32 v58, 0x3ebcbe62
    s_mov_b32 s48, 0x400004
    s_mov_b32 s49, 0x40000400
    v_mov_b32 v55, 0x3f803f80
    v_mov_b32 v59, 0x3ebcbe62
    s_mov_b32 s50, 0x800008
    s_mov_b32 s51, 0x80000800
    v_mov_b32 v60, 0x43400000
    v_lshrrev_b32 v1, 5, v0
    v_lshlrev_b32 v1, 8, v1
    v_and_b32 v2, 15, v0
    v_lshl_add_u32 v1, v2, 4, v1
    v_bfe_u32 v2, v0, 4, 1
    v_lshl_add_u32 v1, v2, 3, v1
    s_mul_i32 s56, s3, 1536
    s_add_u32 s56, s56, 147456
    v_add_u32 v236, s56, v1
    s_mul_i32 s56, s3, 3072
    s_add_u32 s56, s56, 24576
    v_add_u32 v237, s56, v65
    v_add_u32 v238, s41, v65
    s_lshl_b32 s56, s3, 10
    v_add_u32 v240, 159744, v65
    v_add_u32 v239, s56, v240
    v_add_u32 v241, 147456, v65
    v_bfe_u32 v1, v0, 2, 2
    v_lshrrev_b32 v2, 4, v0
    v_lshl_or_b32 v1, v1, 4, v2
    v_mul_u32_u24 v1, 65536, v1
    v_and_b32 v2, 3, v0
    v_lshl_or_b32 v242, v2, 5, v1
    v_xor_b32 v243, 0x70, v242
    s_mul_i32 s56, s3, 3
    v_min_u32 v1, 2, v0
    v_add_u32 v1, s56, v1
    v_min_u32 v2, 8, v0
    v_add_u32 v2, 9, v2
    v_cmp_gt_u32 vcc, 3, v0
    s_nop 1
    v_cndmask_b32 v1, v2, v1, vcc
    v_lshlrev_b32 v245, 7, v1
    v_lshlrev_b32 v1, 3, v0
    v_add_u32 v254, 126976, v1
    s_lshl_b32 s56, s3, 9
    v_add_u32 v238, s56, v254
    v_add_u32 v253, 122880, v65
    s_lshl_b32 s56, s3, 10
    v_add_u32 v237, s56, v253
    s_mov_b32 s52, 0x41c00000
    buffer_load_dwordx4 v28, s[24:27], s59 offen offset:2048 nt lds
    buffer_load_dwordx4 v29, s[24:27], s59 offen offset:3072 nt lds
    s_add_u32 m0, s42, 8192
    s_nop 0
    buffer_load_dwordx4 v30, s[24:27], s59 offen offset:0 nt lds
    buffer_load_dwordx4 v31, s[24:27], s59 offen offset:1024 nt lds
    s_waitcnt vmcnt(28)
    s_barrier
    ds_read_b128 a[48:51], v34 offset:0
    ds_read_b128 a[52:55], v35 offset:0
    ds_read_b128 a[56:59], v34 offset:128
    ds_read_b128 a[60:63], v35 offset:128
    ds_read_b128 a[64:67], v34 offset:256
    ds_read_b128 a[68:71], v35 offset:256
    s_waitcnt lgkmcnt(5)
    v_mfma_f32_16x16x32_bf16 v[84:87], a[48:51], a[48:51], 0
    buffer_load_dwordx4 v32, s[24:27], s59 offen offset:2048 nt lds
    ds_read_b64_tr_b16 a[72:73], v36 offset:0
    ds_read_b64_tr_b16 a[74:75], v36 offset:6144
    v_mfma_f32_16x16x32_bf16 v[80:83], a[48:51], v[52:55], 0
    ds_read_b64_tr_b16 a[76:77], v36 offset:12288
    ds_read_b64_tr_b16 a[78:79], v36 offset:18432
    s_waitcnt lgkmcnt(8)
    v_mfma_f32_16x16x32_bf16 v[84:87], a[52:55], a[52:55], v[84:87]
    ds_read_b64_tr_b16 a[80:81], v37 offset:0
    ds_read_b64_tr_b16 a[82:83], v37 offset:6144
    v_mfma_f32_16x16x32_bf16 v[80:83], a[52:55], v[52:55], v[80:83]
    ds_read_b64_tr_b16 a[84:85], v37 offset:12288
    ds_read_b64_tr_b16 a[86:87], v37 offset:18432
    s_waitcnt lgkmcnt(11)
    v_mfma_f32_16x16x32_bf16 v[84:87], a[56:59], a[56:59], v[84:87]
    ds_read_b64_tr_b16 a[88:89], v38 offset:0
    ds_read_b64_tr_b16 a[90:91], v38 offset:6144
    v_mfma_f32_16x16x32_bf16 v[80:83], a[56:59], v[52:55], v[80:83]
    ds_read_b64_tr_b16 a[92:93], v38 offset:12288
    ds_read_b64_tr_b16 a[94:95], v38 offset:18432
    s_waitcnt lgkmcnt(14)
    v_mfma_f32_16x16x32_bf16 v[84:87], a[60:63], a[60:63], v[84:87]
    v_mfma_f32_16x16x32_bf16 v[80:83], a[60:63], v[52:55], v[80:83]
    s_waitcnt lgkmcnt(13)
    v_mfma_f32_16x16x32_bf16 v[84:87], a[64:67], a[64:67], v[84:87]
    v_mfma_f32_16x16x32_bf16 v[80:83], a[64:67], v[52:55], v[80:83]
    s_mul_i32 s56, s3, 3072
    s_add_u32 s56, s56, 16384
    buffer_load_dwordx4 v[136:139], v65, s[32:35], s56 offen offset:0 sc1
    buffer_load_dwordx4 v[140:143], v65, s[32:35], s56 offen offset:1024 sc1
    buffer_load_dwordx4 v[144:147], v65, s[32:35], s56 offen offset:2048 sc1
    s_waitcnt lgkmcnt(12)
    v_mfma_f32_16x16x32_bf16 v[84:87], a[68:71], a[68:71], v[84:87]
    v_mfma_f32_16x16x32_bf16 v[80:83], a[68:71], v[52:55], v[80:83]
    s_waitcnt lgkmcnt(0)
    s_mul_i32 s39, s38, 0x9e3779b1
    s_add_u32 s39, s39, 0x7f4a7c16
    s_or_b32 s39, s39, 1
    s_branch L_join
L_xt3:
    s_call_b64 s[54:55], L_xslow
    s_branch L_post3
L_xt24:
    s_call_b64 s[54:55], L_xslow
    s_branch L_post24
L_xt6:
    s_call_b64 s[54:55], L_xslow
    s_branch L_post6
L_xt27:
    s_call_b64 s[54:55], L_xslow
    s_branch L_post27
L_xt9:
    s_call_b64 s[54:55], L_xslow
    s_branch L_post9
L_xt11:
    s_call_b64 s[54:55], L_xalt
    ds_read_b128 a[192:195], v253 offset:12288
    ds_read_b128 a[196:199], v253 offset:13312
    ds_read_b128 a[200:203], v253 offset:14336
    ds_read_b128 a[204:207], v253 offset:15360
    s_waitcnt lgkmcnt(0)
    s_branch L_post11
L_xslow:
    s_waitcnt lgkmcnt(0)
    ds_write_b32 v239, v62
    s_waitcnt lgkmcnt(0)
    s_barrier
    ds_read_b32 v12, v240 offset:0
    ds_read_b32 v13, v240 offset:1024
    ds_read_b32 v14, v240 offset:2048
    ds_read_b32 v15, v240 offset:3072
    v_mov_b32 v9, 0
    ds_write_b32 v254, v9 offset:4096
    s_waitcnt lgkmcnt(0)
    v_min3_f32 v1, v12, v13, v14
    v_min_f32 v1, v1, v15
    v_sub_f32 v2, v1, v255
    v_sub_f32 v12, v1, v62
    v_exp_f32 v2, v2
    v_exp_f32 v12, v12
    v_mov_b32 v62, v1
    v_mov_b32 v255, v1
    v_mul_f32 v88, v88, v12
    v_mul_f32 v89, v89, v12
    v_mul_f32 v90, v90, v12
    v_mul_f32 v91, v91, v12
    v_mul_f32 v104, v104, v12
    v_mul_f32 v105, v105, v12
    v_mul_f32 v106, v106, v12
    v_mul_f32 v107, v107, v12
    v_mul_f32 v68, v68, v12
    v_mul_f32 v69, v69, v12
    v_mul_f32 v70, v70, v12
    v_mul_f32 v71, v71, v12
    v_mul_f32 v112, v112, v12
    v_mul_f32 v113, v113, v12
    v_mul_f32 v114, v114, v12
    v_mul_f32 v115, v115, v12
    v_mul_f32 v63, v63, v12
    v_mul_f32 v64, v64, v12
    v_accvgpr_read_b32 v1, a0
    v_mul_f32 v1, v1, v2
    v_accvgpr_write_b32 a0, v1
    v_accvgpr_read_b32 v1, a1
    v_mul_f32 v1, v1, v2
    v_accvgpr_write_b32 a1, v1
    v_accvgpr_read_b32 v1, a2
    v_mul_f32 v1, v1, v2
    v_accvgpr_write_b32 a2, v1
    v_accvgpr_read_b32 v1, a3
    v_mul_f32 v1, v1, v2
    v_accvgpr_write_b32 a3, v1
    v_accvgpr_read_b32 v1, a4
    v_mul_f32 v1, v1, v2
    v_accvgpr_write_b32 a4, v1
    v_accvgpr_read_b32 v1, a5
    v_mul_f32 v1, v1, v2
    v_accvgpr_write_b32 a5, v1
    v_accvgpr_read_b32 v1, a6
    v_mul_f32 v1, v1, v2
    v_accvgpr_write_b32 a6, v1
    v_accvgpr_read_b32 v1, a7
    v_mul_f32 v1, v1, v2
    v_accvgpr_write_b32 a7, v1
    v_accvgpr_read_b32 v1, a8
    v_mul_f32 v1, v1, v2
    v_accvgpr_write_b32 a8, v1
    v_accvgpr_read_b32 v1, a9
    v_mul_f32 v1, v1, v2
    v_accvgpr_write_b32 a9, v1
    v_accvgpr_read_b32 v1, a10
    v_mul_f32 v1, v1, v2
    v_accvgpr_write_b32 a10, v1
    v_accvgpr_read_b32 v1, a11
    v_mul_f32 v1, v1, v2
    v_accvgpr_write_b32 a11, v1
    v_cvt_pk_bf16_f32 v72, v88, v89
    v_cvt_pk_bf16_f32 v73, v90, v91
    v_cvt_pk_bf16_f32 v74, v104, v105
    v_cvt_pk_bf16_f32 v75, v106, v107
    ds_write_b128 v237, v[72:75] offset:0
    v_cvt_pk_bf16_f32 v66, v68, v69
    v_cvt_pk_bf16_f32 v67, v70, v71
    ds_write_b64 v238, v[66:67]
    s_waitcnt lgkmcnt(0)
    s_barrier
    s_setpc_b64 s[54:55]
L_xlast:
    s_waitcnt lgkmcnt(0)
    ds_write_b32 v239, v62
    s_waitcnt lgkmcnt(0)
    s_barrier
    ds_read_b32 v12, v240 offset:0
    ds_read_b32 v13, v240 offset:1024
    ds_read_b32 v14, v240 offset:2048
    ds_read_b32 v15, v240 offset:3072
    v_mov_b32 v9, 0
    ds_write_b32 v254, v9 offset:4096
    s_waitcnt lgkmcnt(0)
    v_min3_f32 v1, v12, v13, v14
    v_min_f32 v1, v1, v15
    v_sub_f32 v2, v1, v255
    v_sub_f32 v12, v1, v62
    v_exp_f32 v2, v2
    v_exp_f32 v12, v12
    v_mov_b32 v62, v1
    v_mov_b32 v255, v1
    v_mul_f32 v88, v88, v12
    v_mul_f32 v89, v89, v12
    v_mul_f32 v90, v90, v12
    v_mul_f32 v91, v91, v12
    v_mul_f32 v104, v104, v12
    v_mul_f32 v105, v105, v12
    v_mul_f32 v106, v106, v12
    v_mul_f32 v107, v107, v12
    v_mul_f32 v68, v68, v12
    v_mul_f32 v69, v69, v12
    v_mul_f32 v70, v70, v12
    v_mul_f32 v71, v71, v12
    v_mul_f32 v10, v10, v12
    v_mul_f32 v11, v11, v12
    v_mul_f32 v16, v16, v2
    v_mul_f32 v17, v17, v2
    v_mul_f32 v18, v18, v2
    v_mul_f32 v19, v19, v2
    v_mul_f32 v20, v20, v2
    v_mul_f32 v21, v21, v2
    v_mul_f32 v22, v22, v2
    v_mul_f32 v23, v23, v2
    v_mul_f32 v24, v24, v2
    v_mul_f32 v25, v25, v2
    v_mul_f32 v26, v26, v2
    v_mul_f32 v27, v27, v2
    v_cvt_pk_bf16_f32 v72, v88, v89
    v_cvt_pk_bf16_f32 v73, v90, v91
    v_cvt_pk_bf16_f32 v74, v104, v105
    v_cvt_pk_bf16_f32 v75, v106, v107
    ds_write_b128 v237, v[72:75] offset:0
    v_cvt_pk_bf16_f32 v66, v68, v69
    v_cvt_pk_bf16_f32 v67, v70, v71
    ds_write_b64 v238, v[66:67]
    ds_write_b64 v238, v[10:11] offset:2048
    s_waitcnt lgkmcnt(0)
    s_barrier
    s_branch L_postx
L_xalt:
    s_waitcnt lgkmcnt(0)
    ds_write_b32 v239, v62
    s_waitcnt lgkmcnt(0)
    s_barrier
    ds_read_b32 v12, v240 offset:0
    ds_read_b32 v13, v240 offset:1024
    ds_read_b32 v14, v240 offset:2048
    ds_read_b32 v15, v240 offset:3072
    v_mov_b32 v9, 0
    ds_write_b32 v254, v9 offset:4100
    s_waitcnt lgkmcnt(0)
    v_min3_f32 v1, v12, v13, v14
    v_min_f32 v1, v1, v15
    v_sub_f32 v2, v1, v255
    v_sub_f32 v12, v1, v62
    v_exp_f32 v2, v2
    v_exp_f32 v12, v12
    v_mov_b32 v62, v1
    v_mov_b32 v255, v1
    v_mul_f32 v88, v88, v12
    v_mul_f32 v89, v89, v12
    v_mul_f32 v90, v90, v12
    v_mul_f32 v91, v91, v12
    v_mul_f32 v104, v104, v12
    v_mul_f32 v105, v105, v12
    v_mul_f32 v106, v106, v12
    v_mul_f32 v107, v107, v12
    v_mul_f32 v68, v68, v12
    v_mul_f32 v69, v69, v12
    v_mul_f32 v70, v70, v12
    v_mul_f32 v71, v71, v12
    v_mul_f32 v112, v112, v12
    v_mul_f32 v113, v113, v12
    v_mul_f32 v114, v114, v12
    v_mul_f32 v115, v115, v12
    v_mul_f32 v63, v63, v12
    v_mul_f32 v64, v64, v12
    v_mul_f32 v16, v16, v2
    v_mul_f32 v17, v17, v2
    v_mul_f32 v18, v18, v2
    v_mul_f32 v19, v19, v2
    v_mul_f32 v20, v20, v2
    v_mul_f32 v21, v21, v2
    v_mul_f32 v22, v22, v2
    v_mul_f32 v23, v23, v2
    v_mul_f32 v24, v24, v2
    v_mul_f32 v25, v25, v2
    v_mul_f32 v26, v26, v2
    v_mul_f32 v27, v27, v2
    v_cvt_pk_bf16_f32 v72, v88, v89
    v_cvt_pk_bf16_f32 v73, v90, v91
    v_cvt_pk_bf16_f32 v74, v104, v105
    v_cvt_pk_bf16_f32 v75, v106, v107
    ds_write_b128 v237, v[72:75] offset:12288
    s_waitcnt lgkmcnt(0)
    s_barrier
    s_setpc_b64 s[54:55]
L_c_slow:
    s_cmp_eq_u32 s43, 0
    s_cbranch_scc1 L_c_out
    s_mov_b32 s43, 0
    buffer_load_dwordx4 v[76:79], v29, s[32:35], s30 offen offset:0 sc1
    buffer_load_dwordx4 v[80:83], v29, s[32:35], s30 offen offset:2048 sc1
    buffer_load_dwordx4 v[84:87], v29, s[32:35], s31 offen offset:0 sc1
    buffer_load_dwordx4 v[108:111], v29, s[32:35], s31 offen offset:2048 sc1
    s_waitcnt vmcnt(0)
    v_sub_u32 v49, v79, v247
    v_max_f32 v42, v42, v49
    v_sub_u32 v49, v83, v247
    v_max_f32 v42, v42, v49
    v_sub_u32 v49, v87, v247
    v_max_f32 v42, v42, v49
    v_sub_u32 v49, v111, v247
    v_max_f32 v42, v42, v49
    s_nop 1
    v_max_f32_dpp v42, v42, v42 row_ror:8 row_mask:0xf bank_mask:0xf
    v_mov_b32 v48, v42
    s_nop 1
    v_max_f32_dpp v42, v48, v48 row_shr:4 row_mask:0xf bank_mask:0xa
    s_nop 1
    v_max_f32_dpp v42, v48, v48 row_shl:4 row_mask:0xf bank_mask:0x5
    v_mov_b32 v48, v42
    s_nop 1
    v_permlane32_swap_b32 v42, v48
    v_max_f32 v42, v42, v48
    v_mov_b32 v48, v42
    s_nop 1
    v_permlane16_swap_b32 v42, v48
    v_max_f32 v42, v42, v48
    s_lshl_b32 s56, s3, 2
    v_add_u32 v48, s56, v251
    ds_write_b32 v48, v42 offset:1024
    s_waitcnt lgkmcnt(0)
    s_barrier
    ds_read_b128 v[48:51], v251 offset:1024
    v_mov_b32 v16, 0
    v_mov_b32 v17, 0
    v_mov_b32 v18, 0
    v_mov_b32 v19, 0
    v_mov_b32 v20, 0
    v_mov_b32 v21, 0
    v_mov_b32 v22, 0
    s_waitcnt lgkmcnt(0)
    v_max3_f32 v42, v48, v49, v50
    v_max_f32 v42, v42, v51
    v_sub_u32 v49, v79, v247
    v_sub_f32 v49, v49, v42
    v_exp_f32 v49, v49
    s_nop 0
    v_cvt_pk_bf16_f32 v49, v49, 0
    v_lshlrev_b32 v50, 16, v49
    v_dot2_f32_bf16 v16, v76, v49, v16
    v_dot2_f32_bf16 v18, v77, v49, v18
    v_dot2_f32_bf16 v20, v78, v49, v20
    v_add_f32 v22, v22, v50
    v_dot2_f32_bf16 v17, v76, v50, v17
    v_dot2_f32_bf16 v19, v77, v50, v19
    v_dot2_f32_bf16 v21, v78, v50, v21
    v_sub_u32 v49, v83, v247
    v_sub_f32 v49, v49, v42
    v_exp_f32 v49, v49
    s_nop 0
    v_cvt_pk_bf16_f32 v49, v49, 0
    v_lshlrev_b32 v50, 16, v49
    v_dot2_f32_bf16 v16, v80, v49, v16
    v_dot2_f32_bf16 v18, v81, v49, v18
    v_dot2_f32_bf16 v20, v82, v49, v20
    v_add_f32 v22, v22, v50
    v_dot2_f32_bf16 v17, v80, v50, v17
    v_dot2_f32_bf16 v19, v81, v50, v19
    v_dot2_f32_bf16 v21, v82, v50, v21
    v_sub_u32 v49, v87, v247
    v_sub_f32 v49, v49, v42
    v_exp_f32 v49, v49
    s_nop 0
    v_cvt_pk_bf16_f32 v49, v49, 0
    v_lshlrev_b32 v50, 16, v49
    v_dot2_f32_bf16 v16, v84, v49, v16
    v_dot2_f32_bf16 v18, v85, v49, v18
    v_dot2_f32_bf16 v20, v86, v49, v20
    v_add_f32 v22, v22, v50
    v_dot2_f32_bf16 v17, v84, v50, v17
    v_dot2_f32_bf16 v19, v85, v50, v19
    v_dot2_f32_bf16 v21, v86, v50, v21
    v_sub_u32 v49, v111, v247
    v_sub_f32 v49, v49, v42
    v_exp_f32 v49, v49
    s_nop 0
    v_cvt_pk_bf16_f32 v49, v49, 0
    v_lshlrev_b32 v50, 16, v49
    v_dot2_f32_bf16 v16, v108, v49, v16
    v_dot2_f32_bf16 v18, v109, v49, v18
    v_dot2_f32_bf16 v20, v110, v49, v20
    v_add_f32 v22, v22, v50
    v_dot2_f32_bf16 v17, v108, v50, v17
    v_dot2_f32_bf16 v19, v109, v50, v19
    v_dot2_f32_bf16 v21, v110, v50, v21
    s_nop 2
    s_branch L_c_red
L_qk_retry:
    s_mov_b32 s53, 0
L_qk_again:
    s_mul_i32 s56, s3, 3072
    s_add_u32 s56, s56, 16384
    buffer_load_dwordx4 v[136:139], v65, s[32:35], s56 offen offset:0 sc1
    buffer_load_dwordx4 v[140:143], v65, s[32:35], s56 offen offset:1024 sc1
    buffer_load_dwordx4 v[144:147], v65, s[32:35], s56 offen offset:2048 sc1
    s_add_u32 s53, s53, 1
    s_waitcnt vmcnt(0)
    v_xor_b32 v1, s39, v138
    v_xor_b32 v2, s39, v142
    v_xor_b32 v3, s39, v146
    v_or3_b32 v1, v1, v2, v3
    v_cmp_ne_u32 vcc, 0, v1
    s_cbranch_vccz L_qk_ok
    s_cmp_lt_u32 s53, 65536
    s_cbranch_scc1 L_qk_again
    s_branch L_qk_ok
L_fl_retry:
    s_mov_b32 s53, 0
L_fl_again:
    buffer_load_dwordx2 v[234:235], v245, s[32:35], 0 offen offset:128 sc1
    s_add_u32 s53, s53, 1
    s_waitcnt vmcnt(0)
    v_cmp_ne_u32 vcc, s39, v234
    s_cbranch_vccz L_fl_ok
    s_cmp_lt_u32 s53, 65536
    s_cbranch_scc1 L_fl_again
    s_branch L_fl_ok
L_site0:
    s_call_b64 s[54:55], L_rare2
    s_branch L_back0
L_site1:
    s_call_b64 s[54:55], L_rare3
    s_branch L_back1
L_site2:
    s_call_b64 s[54:55], L_rare2
    s_branch L_back2
L_site3:
    s_call_b64 s[54:55], L_rare3
    s_branch L_back3
L_site4:
    s_call_b64 s[54:55], L_rare2
    s_branch L_back4
L_site5:
    s_call_b64 s[54:55], L_rare3
    s_branch L_back5
L_site6:
    s_call_b64 s[54:55], L_rare2
    s_branch L_back6
L_site7:
    s_call_b64 s[54:55], L_rare3
    s_branch L_back7
L_site8:
    s_call_b64 s[54:55], L_rare2
    s_branch L_back8
L_site9:
    s_call_b64 s[54:55], L_rare3
    s_branch L_back9
L_site10:
    s_call_b64 s[54:55], L_rare6
    s_branch L_back10
L_site11:
    s_call_b64 s[54:55], L_rare7
    s_branch L_back11
L_site12:
    s_call_b64 s[54:55], L_rare2
    s_branch L_back12
L_site13:
    s_call_b64 s[54:55], L_rare5
    s_branch L_back13
L_rare2:
    s_nop 7
    s_nop 7
    v_mov_b32 v2, v1
    s_nop 1
    v_permlane32_swap_b32 v1, v2
    v_max_f32 v1, v1, v2
    v_mov_b32 v2, v1
    s_nop 1
    v_permlane16_swap_b32 v1, v2
    v_max_f32 v1, v1, v2
    v_max_f32 v1, 0, v1
    v_sub_f32 v62, v62, v1
    v_sub_f32 v88, v88, v1
    v_sub_f32 v89, v89, v1
    v_sub_f32 v90, v90, v1
    v_sub_f32 v91, v91, v1
    v_sub_f32 v1, 0, v1
    v_exp_f32 v1, v1
    s_nop 0
    v_mul_f32 v63, v63, v1
    v_mul_f32 v64, v64, v1
    v_mul_f32 v68, v68, v1
    v_mul_f32 v69, v69, v1
    v_mul_f32 v70, v70, v1
    v_mul_f32 v71, v71, v1
    v_mov_b32 v2, 1
    ds_write_b32 v254, v2 offset:4096
    s_waitcnt lgkmcnt(0)
    s_nop 3
    s_setpc_b64 s[54:55]
L_rare3:
    s_nop 7
    s_nop 7
    v_mov_b32 v2, v1
    s_nop 1
    v_permlane32_swap_b32 v1, v2
    v_max_f32 v1, v1, v2
    v_mov_b32 v2, v1
    s_nop 1
    v_permlane16_swap_b32 v1, v2
    v_max_f32 v1, v1, v2
    v_max_f32 v1, 0, v1
    v_sub_f32 v62, v62, v1
    v_sub_f32 v104, v104, v1
    v_sub_f32 v105, v105, v1
    v_sub_f32 v106, v106, v1
    v_sub_f32 v107, v107, v1
    v_sub_f32 v1, 0, v1
    v_exp_f32 v1, v1
    s_nop 0
    v_mul_f32 v63, v63, v1
    v_mul_f32 v64, v64, v1
    v_mul_f32 v68, v68, v1
    v_mul_f32 v69, v69, v1
    v_mul_f32 v70, v70, v1
    v_mul_f32 v71, v71, v1
    v_mul_f32 v88, v88, v1
    v_mul_f32 v89, v89, v1
    v_mul_f32 v90, v90, v1
    v_mul_f32 v91, v91, v1
    v_mov_b32 v2, 1
    ds_write_b32 v254, v2 offset:4096
    s_waitcnt lgkmcnt(0)
    s_nop 3
    s_setpc_b64 s[54:55]
L_rare5:
    s_nop 7
    s_nop 7
    v_mov_b32 v2, v1
    s_nop 1
    v_permlane32_swap_b32 v1, v2
    v_max_f32 v1, v1, v2
    v_mov_b32 v2, v1
    s_nop 1
    v_permlane16_swap_b32 v1, v2
    v_max_f32 v1, v1, v2
    v_max_f32 v1, 0, v1
    v_sub_f32 v62, v62, v1
    v_sub_f32 v104, v104, v1
    v_sub_f32 v105, v105, v1
    v_sub_f32 v106, v106, v1
    v_sub_f32 v107, v107, v1
    v_sub_f32 v1, 0, v1
    v_exp_f32 v1, v1
    s_nop 0
    v_mul_f32 v63, v63, v1
    v_mul_f32 v64, v64, v1
    v_mul_f32 v68, v68, v1
    v_mul_f32 v69, v69, v1
    v_mul_f32 v70, v70, v1
    v_mul_f32 v71, v71, v1
    v_mul_f32 v88, v88, v1
    v_mul_f32 v89, v89, v1
    v_mul_f32 v90, v90, v1
    v_mul_f32 v91, v91, v1
    v_cvt_pk_bf16_f32 v72, v88, v89
    v_cvt_pk_bf16_f32 v73, v90, v91
    v_mov_b32 v2, 1
    ds_write_b32 v254, v2 offset:4096
    s_waitcnt lgkmcnt(0)
    s_nop 3
    s_setpc_b64 s[54:55]
L_rare6:
    s_nop 7
    s_nop 7
    v_mov_b32 v2, v1
    s_nop 1
    v_permlane32_swap_b32 v1, v2
    v_max_f32 v1, v1, v2
    v_mov_b32 v2, v1
    s_nop 1
    v_permlane16_swap_b32 v1, v2
    v_max_f32 v1, v1, v2
    v_max_f32 v1, 0, v1
    v_sub_f32 v62, v62, v1
    v_sub_f32 v88, v88, v1
    v_sub_f32 v89, v89, v1
    v_sub_f32 v90, v90, v1
    v_sub_f32 v91, v91, v1
    v_sub_f32 v1, 0, v1
    v_exp_f32 v1, v1
    s_nop 0
    v_mul_f32 v63, v63, v1
    v_mul_f32 v64, v64, v1
    v_mul_f32 v68, v68, v1
    v_mul_f32 v69, v69, v1
    v_mul_f32 v70, v70, v1
    v_mul_f32 v71, v71, v1
    v_mov_b32 v2, 1
    ds_write_b32 v254, v2 offset:4100
    s_waitcnt lgkmcnt(0)
    s_nop 3
    s_setpc_b64 s[54:55]
L_rare7:
    s_nop 7
    s_nop 7
    v_mov_b32 v2, v1
    s_nop 1
    v_permlane32_swap_b32 v1, v2
    v_max_f32 v1, v1, v2
    v_mov_b32 v2, v1
    s_nop 1
    v_permlane16_swap_b32 v1, v2
    v_max_f32 v1, v1, v2
    v_max_f32 v1, 0, v1
    v_sub_f32 v62, v62, v1
    v_sub_f32 v104, v104, v1
    v_sub_f32 v105, v105, v1
    v_sub_f32 v106, v106, v1
    v_sub_f32 v107, v107, v1
    v_sub_f32 v1, 0, v1
    v_exp_f32 v1, v1
    s_nop 0
    v_mul_f32 v63, v63, v1
    v_mul_f32 v64, v64, v1
    v_mul_f32 v68, v68, v1
    v_mul_f32 v69, v69, v1
    v_mul_f32 v70, v70, v1
    v_mul_f32 v71, v71, v1
    v_mul_f32 v88, v88, v1
    v_mul_f32 v89, v89, v1
    v_mul_f32 v90, v90, v1
    v_mul_f32 v91, v91, v1
    v_mov_b32 v2, 1
    ds_write_b32 v254, v2 offset:4100
    s_waitcnt lgkmcnt(0)
    s_nop 3
    s_setpc_b64 s[54:55]
L_codeend:
.section .rodata,"a"
.p2align 6
.amdhsa_kernel standalone__detection_seg_dino__vision_kernel
  .amdhsa_next_free_vgpr 464
  .amdhsa_next_free_sgpr 102
  .amdhsa_accum_offset 256
  .amdhsa_group_segment_fixed_size 0
  .amdhsa_kernarg_size 80
  .amdhsa_user_sgpr_count 2
  .amdhsa_user_sgpr_kernarg_segment_ptr 1
  .amdhsa_system_sgpr_workgroup_id_x 1
  .amdhsa_float_denorm_mode_32 3
.end_amdhsa_kernel
```

```asm
; @launch grid=(256,1,1) block=(256,1,1) lds=163840
.amdgcn_target "amdgcn-amd-amdhsa--gfx950"
.text
.globl standalone__detection_seg_dino__vision_kernel
.p2align 8
.type standalone__detection_seg_dino__vision_kernel,@function
standalone__detection_seg_dino__vision_kernel:
    s_cmp_ge_u32 s2, 256
    s_cbranch_scc1 L_end
    s_load_dwordx16 s[4:19], s[0:1], 0
    s_load_dwordx4 s[20:23], s[0:1], 64
    s_memrealtime s[44:45]
    s_getpc_b64 s[54:55]
L_pc_main:
    v_lshlrev_b32 v233, 7, v0
    v_min_u32 v233, L_codeend - L_pc_main - 4, v233
    global_load_dword v232, v233, s[54:55]
    s_mov_b64 s[100:101], s[54:55]
    v_lshrrev_b32 v1, 6, v0
    v_and_b32 v0, 63, v0
    v_readfirstlane_b32 s3, v1
    v_lshlrev_b32 v65, 4, v0
    v_lshrrev_b32 v1, 2, v0
    v_and_b32 v1, 14, v1
    s_mov_b32 s56, 0x5000
    v_bfe_u32 v2, s56, v1, 2
    v_lshlrev_b32 v2, 5, v2
    v_xor_b32 v16, v65, v2
    s_mov_b32 s56, 0xaa55
    v_bfe_u32 v2, s56, v1, 2
    v_lshlrev_b32 v2, 5, v2
    v_xor_b32 v17, v65, v2
    s_mov_b32 s56, 0xfffa
    v_bfe_u32 v2, s56, v1, 2
    v_lshlrev_b32 v2, 5, v2
    v_xor_b32 v18, v65, v2
    v_xor_b32 v19, 16, v16
    v_xor_b32 v20, 0x1010, v17
    v_xor_b32 v21, 0x1010, v18
    v_lshrrev_b32 v1, 3, v0
    v_and_b32 v1, 6, v1
    s_mov_b32 s56, 0x40
    v_bfe_u32 v2, s56, v1, 2
    v_lshlrev_b32 v2, 5, v2
    v_xor_b32 v22, v65, v2
    s_mov_b32 s56, 0xa5
    v_bfe_u32 v2, s56, v1, 2
    v_lshlrev_b32 v2, 5, v2
    v_xor_b32 v23, v65, v2
    s_mov_b32 s56, 0xfe
    v_bfe_u32 v2, s56, v1, 2
    v_lshlrev_b32 v2, 5, v2
    v_xor_b32 v24, v65, v2
    v_xor_b32 v25, 0x80, v22
    v_xor_b32 v26, 0x1080, v23
    v_xor_b32 v27, 0x1080, v24
    v_xor_b32 v28, 0x1010, v22
    v_xor_b32 v29, 0x1010, v23
    v_xor_b32 v30, 0x2010, v24
    v_xor_b32 v31, 0x2090, v22
    v_xor_b32 v32, 0x2090, v23
    v_xor_b32 v33, 0x2090, v24
    v_mov_b32 v248, 0x10000
    s_mul_i32 s36, s3, 6144
    s_mul_i32 s37, s3, 12288
    s_add_u32 s40, s36, 0
    s_add_u32 s41, s37, 24576
    s_add_u32 s42, s37, 73728
    s_and_b32 s58, s2, 7
    s_lshr_b32 s57, s2, 3
    s_lshl_b32 s58, s58, 5
    s_add_u32 s58, s58, s57
    s_lshr_b32 s56, s58, 2
    s_mul_i32 s56, s56, 196608
    s_mul_i32 s57, s58, 24576
    s_lshl1_add_u32 s56, s57, s56
    s_mov_b64 s[60:61], s[56:57]
    s_and_b32 s98, s2, 7
    s_cmp_lt_u32 s2, 48
    s_cselect_b32 s98, s98, 0
    s_mov_b32 s30, 18898944
    s_mov_b32 s31, 0x20000
    s_mov_b32 s26, 75743232
    s_mov_b32 s27, 0x20000
    s_mov_b32 s34, 16777216
    s_mov_b32 s35, 0x20000
    s_mov_b32 m0, s40
    s_and_b32 s56, s2, 7
    s_cmp_eq_u32 s56, 2
    s_cbranch_scc1 L_spec
    s_and_b32 s56, s2, 7
    s_cbranch_scc1 L_plain
L_spec:
    s_waitcnt lgkmcnt(0)
    s_add_u32 s28, s8, s61
    s_addc_u32 s29, s9, 0
    s_add_u32 s24, s6, s60
    s_addc_u32 s25, s7, 0
    s_mov_b64 s[32:33], s[22:23]
    s_lshr_b32 s43, s2, 3
    s_mul_i32 s57, s43, 2304
    v_min_u32 v1, 17, v0
    v_lshlrev_b32 v1, 7, v1
    s_mov_b32 s66, 73728
    s_mov_b32 s67, 0x20000
    s_mov_b32 s70, 73728
    s_mov_b32 s71, 0x20000
    s_mov_b32 s72, s4
    s_mov_b32 s73, s5
    s_mov_b32 s74, 6144
    s_mov_b32 s75, 0x20000
    s_bitcmp1_b32 s2, 1
    s_cselect_b64 s[64:65], s[16:17], s[10:11]
    s_cselect_b64 s[68:69], s[14:15], s[12:13]
    s_cmp_eq_u32 s3, 0
    s_cbranch_scc1 L_pf0
    s_cmp_eq_u32 s3, 1
    s_cbranch_scc0 L_pfdone
    s_lshl_b32 s58, s43, 8
    buffer_load_dword v234, v1, s[68:71], s57 offen
    v_min_u32 v2, 128, v1
    buffer_load_dword v235, v2, s[72:75], s58 offen
    s_branch L_pfdone
L_pf0:
    buffer_load_dword v234, v1, s[64:67], s57 offen
L_pfdone:
    s_cmp_ge_u32 s43, 3
    s_cbranch_scc1 L_nopf
    s_mov_b32 s0, 1
    s_bitcmp1_b32 s2, 1
    s_cbranch_scc0 L_prod
    s_branch L_vprod
L_plain:
    s_waitcnt lgkmcnt(0)
    s_cmp_eq_u32 s98, 1
    s_cbranch_scc0 L_nopf
    s_lshl2_add_u32 s20, s2, s3
    s_lshl4_add_u32 s20, s20, s44
    s_mul_i32 s20, s20, 0x9e3779b1
    s_lshr_b32 s20, s20, 11
    s_and_b32 s20, s20, 0x1fdf80
    s_bfe_u32 s56, s2, 0x10003
    s_lshl_b32 s56, s56, 13
    s_add_u32 s56, s56, 6291456
    s_add_u32 s56, s56, s20
    s_load_dword s38, s[22:23], s56
    s_memtime s[20:21]
L_nopf:
    s_add_u32 s28, s8, s61
    s_addc_u32 s29, s9, 0
    buffer_load_dwordx4 v16, s[28:31], s36 offen offset:0 nt lds
    s_add_u32 s24, s6, s60
    s_addc_u32 s25, s7, 0
    s_mov_b64 s[32:33], s[22:23]
    s_mov_b32 s0, 0
    buffer_load_dwordx4 v17, s[28:31], s36 offen offset:1024 nt lds
    buffer_load_dwordx4 v18, s[28:31], s36 offen offset:2048 nt lds
    buffer_load_dwordx4 v19, s[28:31], s36 offen offset:3072 nt lds
    s_add_u32 m0, s40, 4096
    s_nop 0
    buffer_load_dwordx4 v20, s[28:31], s36 offen offset:0 nt lds
    buffer_load_dwordx4 v21, s[28:31], s36 offen offset:1024 nt lds
    s_mov_b32 s43, -1
    s_sub_u32 s59, s2, 64
    s_lshr_b32 s59, s59, 4
    s_and_b32 s56, s2, 7
    s_lshl3_add_u32 s59, s59, s56
    s_cmp_ge_u32 s59, 64
    s_cbranch_scc1 L_nocs
    s_mov_b32 s64, s4
    s_mov_b32 s65, s5
    s_mov_b32 s66, 6144
    s_mov_b32 s67, 0x20000
    s_mov_b32 s68, s18
    s_mov_b32 s69, s19
    s_mov_b32 s70, 6144
    s_mov_b32 s71, 0x20000
    v_and_b32 v1, 1, v0
    v_bfe_u32 v2, v0, 1, 1
    s_bfe_u32 s57, s2, 0x10003
    s_lshr_b32 s56, s59, 4
    s_lshl2_add_u32 s56, s56, s57
    s_add_u32 s56, s56, s57
    v_add_u32 v2, s56, v2
    v_lshlrev_b32 v252, 2, v2
    v_lshrrev_b32 v3, 4, v0
    v_mad_u32_u24 v3, v1, 3, v3
    v_lshrrev_b32 v4, 1, v3
    v_and_b32 v3, 1, v3
    v_lshlrev_b32 v3, 2, v3
    v_lshl_add_u32 v3, v4, 5, v3
    v_bfe_u32 v4, v0, 3, 1
    v_lshl_add_u32 v3, v4, 1, v3
    v_mul_u32_u24 v2, 384, v2
    s_bfe_u32 s56, s59, 0x20002
    s_mul_i32 s56, s56, 96
    s_and_b32 s57, s59, 3
    s_lshl_b32 s57, s57, 3
    s_add_u32 s56, s56, s57
    v_add3_u32 v248, s56, v2, v3
    v_and_b32 v3, 4, v0
    v_cmp_eq_u32 vcc, 4, v3
    s_nop 1
    v_cndmask_b32 v3, 63, v0, vcc
    v_cmp_gt_u32 vcc, 48, v3
    v_mov_b32 v4, 0x10000
    s_lshl_b32 s56, s3, 2
    v_cndmask_b32 v248, v4, v248, vcc
    buffer_load_ushort v249, v248, s[64:67], 0 offen
    s_xor_b32 s59, s2, 64
    s_or_b32 s57, s59, s3
    s_cselect_b32 s70, 0, 6144
    v_lshlrev_b32 v4, 7, v0
    buffer_load_ushort v246, v4, s[68:71], 0 offen
    v_add_u32 v250, s56, v65
    v_and_b32 v251, 0x70, v65
L_nocs:
    s_cmp_eq_u32 s98, 1
    s_cbranch_scc0 L_noprobe
    s_waitcnt lgkmcnt(0)
    s_memtime s[54:55]
    s_waitcnt lgkmcnt(0)
    s_sub_u32 s20, s54, s20
    s_add_u32 s98, s3, 1
L_noprobe:
    s_load_dword s38, s[22:23], 0
    v_and_b32 v1, 15, v0
    v_lshrrev_b32 v6, 5, v0
    v_bfe_u32 v3, v0, 4, 1
    v_lshl_or_b32 v3, v3, 1, v6
    v_lshrrev_b32 v4, 2, v0
    v_bfe_u32 v5, v0, 1, 1
    v_lshrrev_b32 v6, 3, v1
    v_and_or_b32 v6, v1, 6, v6
    v_xor_b32 v6, v6, v3
    v_mul_u32_u24 v7, 384, v1
    v_lshl_add_u32 v6, v6, 4, v7
    v_add_u32 v34, s40, v6
    v_xor_b32 v35, 64, v34
    v_lshrrev_b32 v6, 3, v1
    v_and_b32 v7, 7, v1
    v_lshl_or_b32 v6, v7, 1, v6
    v_xor_b32 v6, v6, v3
    v_mul_u32_u24 v7, 768, v1
    v_lshl_add_u32 v6, v6, 4, v7
    v_add_u32 v40, s41, v6
    v_xor_b32 v41, 0x40, v40
    v_xor_b32 v42, 0x80, v40
    v_xor_b32 v43, 0xc0, v40
    v_and_b32 v2, 1, v0
    v_lshlrev_b32 v2, 3, v2
    s_mul_i32 s56, s3, 96
    v_lshrrev_b32 v6, 3, v4
    v_and_or_b32 v6, v4, 6, v6
    v_xor_b32 v6, v6, v5
    v_lshl_add_u32 v6, v6, 4, v2
    v_mul_u32_u24 v7, 384, v4
    s_add_u32 s57, s56, 0
    v_xad_u32 v36, v6, s57, v7
    s_add_u32 s57, s56, 32
    v_xad_u32 v37, v6, s57, v7
    s_add_u32 s57, s56, 64
    v_xad_u32 v38, v6, s57, v7
    v_lshrrev_b32 v6, 3, v4
    v_and_b32 v3, 7, v4
    v_lshl_or_b32 v6, v3, 1, v6
    v_xor_b32 v6, v6, v5
    v_lshl_add_u32 v6, v6, 4, v2
    v_lshlrev_b32 v7, 1, v7
    v_add_u32 v7, 24576, v7
    s_add_u32 s57, s56, 0
    v_xad_u32 v44, v6, s57, v7
    s_add_u32 s57, s56, 384
    v_xad_u32 v45, v6, s57, v7
    s_add_u32 s57, s56, 32
    v_xad_u32 v46, v6, s57, v7
    s_add_u32 s57, s56, 416
    v_xad_u32 v47, v6, s57, v7
    s_add_u32 s57, s56, 64
    v_xad_u32 v48, v6, s57, v7
    s_add_u32 s57, s56, 448
    v_xad_u32 v49, v6, s57, v7
    v_mov_b32 v52, 0x3f803f80
    v_mov_b32 v56, 0x3ebcbe62
    s_mov_b32 s44, 0x100001
    s_mov_b32 s45, 0x10000100
    v_mov_b32 v53, 0x3f803f80
    v_mov_b32 v57, 0x3ebcbe62
    s_mov_b32 s46, 0x200002
    s_mov_b32 s47, 0x20000200
    v_mov_b32 v54, 0x3f803f80
    v_mov_b32 v58, 0x3ebcbe62
    s_mov_b32 s48, 0x400004
    s_mov_b32 s49, 0x40000400
    v_mov_b32 v55, 0x3f803f80
    v_mov_b32 v59, 0x3ebcbe62
    s_mov_b32 s50, 0x800008
    s_mov_b32 s51, 0x80000800
    v_mov_b32 v60, 0x43400000
    v_lshrrev_b32 v1, 5, v0
    v_lshlrev_b32 v1, 8, v1
    v_and_b32 v2, 15, v0
    v_lshl_add_u32 v1, v2, 4, v1
    v_bfe_u32 v2, v0, 4, 1
    v_lshl_add_u32 v1, v2, 3, v1
    s_mul_i32 s56, s3, 1536
    s_add_u32 s56, s56, 147456
    v_add_u32 v236, s56, v1
    s_mul_i32 s56, s3, 3072
    s_add_u32 s56, s56, 24576
    v_add_u32 v237, s56, v65
    v_add_u32 v238, s41, v65
    s_lshl_b32 s56, s3, 10
    v_add_u32 v240, 159744, v65
    v_add_u32 v239, s56, v240
    v_add_u32 v241, 147456, v65
    v_bfe_u32 v1, v0, 2, 2
    v_lshrrev_b32 v2, 4, v0
    v_lshl_or_b32 v1, v1, 4, v2
    v_mul_u32_u24 v1, 65536, v1
    v_and_b32 v2, 3, v0
    v_lshl_or_b32 v242, v2, 5, v1
    v_xor_b32 v243, 0x70, v242
    s_mul_i32 s56, s3, 3
    v_min_u32 v1, 2, v0
    v_add_u32 v1, s56, v1
    v_min_u32 v2, 8, v0
    v_add_u32 v2, 9, v2
    v_cmp_gt_u32 vcc, 3, v0
    s_nop 1
    v_cndmask_b32 v1, v2, v1, vcc
    v_lshlrev_b32 v245, 7, v1
    v_lshlrev_b32 v1, 3, v0
    v_add_u32 v254, 126976, v1
    s_lshl_b32 s56, s3, 9
    v_add_u32 v238, s56, v254
    v_add_u32 v253, 122880, v65
    s_lshl_b32 s56, s3, 10
    v_add_u32 v237, s56, v253
    s_mov_b32 s52, 0x41c00000
    s_waitcnt vmcnt(5)
    s_add_u32 m0, s41, 0
    s_add_u32 s58, s37, 0
    buffer_load_dwordx4 v22, s[24:27], s58 offen offset:0 nt lds
    s_waitcnt vmcnt(5)
    buffer_load_dwordx4 v23, s[24:27], s58 offen offset:1024 nt lds
    s_waitcnt vmcnt(5)
    buffer_load_dwordx4 v24, s[24:27], s58 offen offset:2048 nt lds
    s_waitcnt vmcnt(5)
    buffer_load_dwordx4 v25, s[24:27], s58 offen offset:3072 nt lds
    s_waitcnt vmcnt(5)
    s_add_u32 m0, s41, 4096
    s_nop 0
    buffer_load_dwordx4 v26, s[24:27], s58 offen offset:0 nt lds
    s_waitcnt vmcnt(5)
    buffer_load_dwordx4 v27, s[24:27], s58 offen offset:1024 nt lds
    s_waitcnt vmcnt(5)
    buffer_load_dwordx4 v28, s[24:27], s58 offen offset:2048 nt lds
    s_waitcnt vmcnt(5)
    buffer_load_dwordx4 v29, s[24:27], s58 offen offset:3072 nt lds
    s_waitcnt vmcnt(5)
    s_add_u32 m0, s41, 8192
    s_nop 0
    buffer_load_dwordx4 v30, s[24:27], s58 offen offset:0 nt lds
    s_waitcnt vmcnt(9)
    s_waitcnt lgkmcnt(0)
    s_barrier
    ds_read_b128 a[48:51], v34 offset:0
    ds_read_b128 a[52:55], v35 offset:0
    ds_read_b128 a[56:59], v34 offset:128
    ds_read_b128 a[60:63], v35 offset:128
    ds_read_b128 a[64:67], v34 offset:256
    ds_read_b128 a[68:71], v35 offset:256
    s_waitcnt lgkmcnt(5)
    v_mfma_f32_16x16x32_bf16 v[84:87], a[48:51], a[48:51], 0
    s_waitcnt vmcnt(5)
    buffer_load_dwordx4 v31, s[24:27], s58 offen offset:1024 nt lds
    ds_read_b64_tr_b16 a[72:73], v36 offset:0
    ds_read_b64_tr_b16 a[74:75], v36 offset:6144
    v_mfma_f32_16x16x32_bf16 v[80:83], a[48:51], v[52:55], 0
    s_waitcnt vmcnt(5)
    buffer_load_dwordx4 v32, s[24:27], s58 offen offset:2048 nt lds
    ds_read_b64_tr_b16 a[76:77], v36 offset:12288
    ds_read_b64_tr_b16 a[78:79], v36 offset:18432
    s_waitcnt lgkmcnt(8)
    v_mfma_f32_16x16x32_bf16 v[84:87], a[52:55], a[52:55], v[84:87]
    s_waitcnt vmcnt(5)
    buffer_load_dwordx4 v33, s[24:27], s58 offen offset:3072 nt lds
    ds_read_b64_tr_b16 a[80:81], v37 offset:0
    ds_read_b64_tr_b16 a[82:83], v37 offset:6144
    v_mfma_f32_16x16x32_bf16 v[80:83], a[52:55], v[52:55], v[80:83]
    ds_read_b64_tr_b16 a[84:85], v37 offset:12288
    ds_read_b64_tr_b16 a[86:87], v37 offset:18432
    s_waitcnt lgkmcnt(11)
    v_mfma_f32_16x16x32_bf16 v[84:87], a[56:59], a[56:59], v[84:87]
    ds_read_b64_tr_b16 a[88:89], v38 offset:0
    ds_read_b64_tr_b16 a[90:91], v38 offset:6144
    v_mfma_f32_16x16x32_bf16 v[80:83], a[56:59], v[52:55], v[80:83]
    ds_read_b64_tr_b16 a[92:93], v38 offset:12288
    ds_read_b64_tr_b16 a[94:95], v38 offset:18432
    s_waitcnt lgkmcnt(14)
    v_mfma_f32_16x16x32_bf16 v[84:87], a[60:63], a[60:63], v[84:87]
    v_mfma_f32_16x16x32_bf16 v[80:83], a[60:63], v[52:55], v[80:83]
    s_waitcnt lgkmcnt(13)
    v_mfma_f32_16x16x32_bf16 v[84:87], a[64:67], a[64:67], v[84:87]
    v_mfma_f32_16x16x32_bf16 v[80:83], a[64:67], v[52:55], v[80:83]
    s_waitcnt lgkmcnt(12)
    v_mfma_f32_16x16x32_bf16 v[84:87], a[68:71], a[68:71], v[84:87]
    s_waitcnt vmcnt(5)
    s_add_u32 m0, s42, 0
    s_add_u32 s59, s37, 196608
    buffer_load_dwordx4 v22, s[24:27], s59 offen offset:0 nt lds
    v_mfma_f32_16x16x32_bf16 v[80:83], a[68:71], v[52:55], v[80:83]
    s_waitcnt lgkmcnt(0)
    s_mul_i32 s39, s38, 0x9e3779b1
    s_add_u32 s39, s39, 0x7f4a7c16
    s_or_b32 s39, s39, 1
    s_waitcnt vmcnt(5)
    buffer_load_dwordx4 v23, s[24:27], s59 offen offset:1024 nt lds
    s_waitcnt vmcnt(5)
    buffer_load_dwordx4 v24, s[24:27], s59 offen offset:2048 nt lds
    s_waitcnt vmcnt(5)
    buffer_load_dwordx4 v25, s[24:27], s59 offen offset:3072 nt lds
    s_waitcnt vmcnt(5)
    s_add_u32 m0, s42, 4096
    s_nop 0
    buffer_load_dwordx4 v26, s[24:27], s59 offen offset:0 nt lds
    s_waitcnt vmcnt(5)
    buffer_load_dwordx4 v27, s[24:27], s59 offen offset:1024 nt lds
    s_waitcnt vmcnt(5)
    buffer_load_dwordx4 v28, s[24:27], s59 offen offset:2048 nt lds
    s_waitcnt vmcnt(5)
    buffer_load_dwordx4 v29, s[24:27], s59 offen offset:3072 nt lds
    s_waitcnt vmcnt(5)
    s_add_u32 m0, s42, 8192
    s_nop 0
    buffer_load_dwordx4 v30, s[24:27], s59 offen offset:0 nt lds
    s_waitcnt vmcnt(5)
    buffer_load_dwordx4 v31, s[24:27], s59 offen offset:1024 nt lds
    s_waitcnt vmcnt(5)
    buffer_load_dwordx4 v32, s[24:27], s59 offen offset:2048 nt lds
    s_mul_i32 s56, s3, 3072
    s_add_u32 s56, s56, 16384
    buffer_load_dwordx4 v[136:139], v65, s[32:35], s56 offen offset:0 sc1
    buffer_load_dwordx4 v[140:143], v65, s[32:35], s56 offen offset:1024 sc1
    buffer_load_dwordx4 v[144:147], v65, s[32:35], s56 offen offset:2048 sc1
L_join:
    s_mul_i32 s60, s3, 18432
    s_mov_b32 s72, s22
    s_mov_b32 s73, s23
    s_mov_b32 s74, 16777216
    s_mov_b32 s75, 0x20000
    s_cmp_eq_u32 s0, 1
    s_cselect_b32 s74, 0, s74
    s_waitcnt vmcnt(14)
    s_barrier
    ds_read_b128 a[96:99], v40 offset:0
    ds_read_b128 a[100:103], v41 offset:0
    ds_read_b128 a[104:107], v42 offset:0
    ds_read_b128 a[108:111], v43 offset:0
    ds_read_b128 a[112:115], v40 offset:256
    ds_read_b128 a[116:119], v41 offset:256
    ds_read_b128 a[120:123], v42 offset:256
    ds_read_b128 a[124:127], v43 offset:256
    ds_read_b128 a[128:131], v40 offset:512
    ds_read_b128 a[132:135], v41 offset:512
    ds_read_b128 a[136:139], v42 offset:512
    ds_read_b128 a[140:143], v43 offset:512
    ds_read_b64_tr_b16 a[144:145], v44 offset:0
    ds_read_b64_tr_b16 a[146:147], v45 offset:0
    ds_read_b64_tr_b16 a[148:149], v44 offset:12288
    ds_read_b64_tr_b16 a[150:151], v45 offset:12288
    ds_read_b64_tr_b16 a[152:153], v44 offset:24576
    ds_read_b64_tr_b16 a[154:155], v45 offset:24576
    ds_read_b64_tr_b16 a[156:157], v44 offset:36864
    ds_read_b64_tr_b16 a[158:159], v45 offset:36864
    ds_read_b64_tr_b16 a[160:161], v46 offset:0
    ds_read_b64_tr_b16 a[162:163], v47 offset:0
    ds_read_b64_tr_b16 a[164:165], v46 offset:12288
    ds_read_b64_tr_b16 a[166:167], v47 offset:12288
    ds_read_b64_tr_b16 a[168:169], v46 offset:24576
    ds_read_b64_tr_b16 a[170:171], v47 offset:24576
    ds_read_b64_tr_b16 a[172:173], v46 offset:36864
    ds_read_b64_tr_b16 a[174:175], v47 offset:36864
    ds_read_b64_tr_b16 a[176:177], v48 offset:0
    ds_read_b64_tr_b16 a[178:179], v49 offset:0
    ds_read_b64_tr_b16 a[180:181], v48 offset:12288
    ds_read_b64_tr_b16 a[182:183], v49 offset:12288
    ds_read_b64_tr_b16 a[184:185], v48 offset:24576
    ds_read_b64_tr_b16 a[186:187], v49 offset:24576
    ds_read_b64_tr_b16 a[188:189], v48 offset:36864
    ds_read_b64_tr_b16 a[190:191], v49 offset:36864
    s_waitcnt lgkmcnt(0)
    s_barrier
    s_cmp_ge_u32 s43, 3
    s_cbranch_scc1 L_v_nofl
    s_mul_i32 s56, s3, 3
    s_add_u32 s56, s56, s43
    s_lshl_b32 s56, s56, 7
    v_mov_b32 v1, s39
    v_mov_b32 v2, 0
    s_mov_b64 exec, 1
    s_waitcnt vmcnt(8)
    buffer_store_dword v1, v2, s[32:35], s56 offen offset:128 sc1
    s_mov_b64 exec, -1
L_v_nofl:
    s_cmp_eq_u32 s98, 1
    s_cbranch_scc0 L_nopub
    s_lshl_b32 s56, s2, 4
    v_mov_b32 v2, s39
    v_mov_b32 v3, s20
    v_mov_b32 v1, 0
    s_mov_b64 exec, 1
    buffer_store_dwordx2 v[2:3], v1, s[32:35], s56 offen offset:1648 sc1
    s_mov_b64 exec, -1
L_nopub:
    v_mfma_f32_16x16x32_bf16 v[96:99], a[96:99], a[96:99], v[84:87]
    s_cmp_eq_u32 s0, 0
    s_cbranch_scc0 L_g24
    s_waitcnt vmcnt(9)
L_g24:
    s_add_u32 m0, s42, 8192
    s_add_u32 s59, s37, 196608
    buffer_load_dwordx4 v33, s[24:27], s59 offen offset:3072 nt lds
    v_add_u32 v44, 49152, v44
    v_add_u32 v45, 49152, v45
    v_mfma_f32_16x16x32_bf16 v[100:103], a[96:99], a[48:51], 0
    s_cmp_eq_u32 s0, 0
    s_cbranch_scc0 L_g25
    s_waitcnt vmcnt(9)
L_g25:
    s_add_u32 m0, s40, 0
    s_add_u32 s57, s36, 6291456
    buffer_load_dwordx4 v16, s[28:31], s57 offen offset:0 nt lds
    v_add_u32 v46, 49152, v46
    v_add_u32 v47, 49152, v47
    v_mfma_f32_16x16x32_bf16 v[96:99], a[100:103], a[100:103], v[96:99]
    v_add_u32 v48, 49152, v48
    v_add_u32 v49, 49152, v49
    v_mfma_f32_16x16x32_bf16 v[100:103], a[100:103], a[52:55], v[100:103]
    v_mfma_f32_16x16x32_bf16 v[96:99], a[104:107], a[104:107], v[96:99]
    v_mfma_f32_16x16x32_bf16 v[100:103], a[104:107], a[56:59], v[100:103]
    v_mfma_f32_16x16x32_bf16 v[96:99], a[108:111], a[108:111], v[96:99]
    v_mfma_f32_16x16x32_bf16 v[100:103], a[108:111], a[60:63], v[100:103]
    v_mfma_f32_16x16x32_bf16 v[96:99], a[112:115], a[112:115], v[96:99]
    v_mfma_f32_16x16x32_bf16 v[100:103], a[112:115], a[64:67], v[100:103]
    v_mfma_f32_16x16x32_bf16 v[96:99], a[116:119], a[116:119], v[96:99]
    v_mfma_f32_16x16x32_bf16 v[100:103], a[116:119], a[68:71], v[100:103]
    v_mfma_f32_16x16x32_bf16 v[92:95], a[96:99], v[52:55], v[80:83]
    v_mfma_f32_16x16x32_bf16 v[92:95], a[100:103], v[52:55], v[92:95]
    s_cmp_eq_u32 s0, 0
    s_cbranch_scc0 L_g26
    s_waitcnt vmcnt(9)
L_g26:
    buffer_load_dwordx4 v17, s[28:31], s57 offen offset:1024 nt lds
    v_mfma_f32_16x16x32_bf16 v[92:95], a[104:107], v[52:55], v[92:95]
    v_mfma_f32_16x16x32_bf16 v[92:95], a[108:111], v[52:55], v[92:95]
    v_fma_f32 v96, v100, 2.0, v96
    v_fma_f32 v97, v101, 2.0, v97
    v_mfma_f32_16x16x32_bf16 v[92:95], a[112:115], v[52:55], v[92:95]
    v_fma_f32 v98, v102, 2.0, v98
    v_fma_f32 v99, v103, 2.0, v99
    v_mfma_f32_16x16x32_bf16 v[92:95], a[116:119], v[52:55], v[92:95]
    v_cndmask_b32 v3, 0, v96, s[44:45]
    v_cndmask_b32 v3, v3, v97, s[46:47]
    v_mfma_f32_16x16x32_bf16 v[112:115], a[120:123], a[120:123], v[84:87]
    v_cndmask_b32 v3, v3, v98, s[48:49]
    v_cndmask_b32 v3, v3, v99, s[50:51]
    v_mfma_f32_16x16x32_bf16 v[116:119], a[120:123], a[48:51], 0
    s_nop 0
    s_nop 0
    v_mfma_f32_16x16x32_bf16 v[112:115], a[124:127], a[124:127], v[112:115]
    v_mfma_f32_16x16x4_f32 v[120:123], v3, v60, v[56:59]
    v_mfma_f32_16x16x32_bf16 v[116:119], a[124:127], a[52:55], v[116:119]
    v_mfma_f32_16x16x32_bf16 v[112:115], a[128:131], a[128:131], v[112:115]
    v_mfma_f32_16x16x32_bf16 v[116:119], a[128:131], a[56:59], v[116:119]
    v_mfma_f32_16x16x32_bf16 v[112:115], a[132:135], a[132:135], v[112:115]
    s_cmp_eq_u32 s0, 0
    s_cbranch_scc0 L_g27
    s_waitcnt vmcnt(9)
L_g27:
    buffer_load_dwordx4 v18, s[28:31], s57 offen offset:2048 nt lds
    s_nop 1
    v_fma_f32 v128, -v92, v92, v120
    v_fma_f32 v129, -v93, v93, v121
    v_mfma_f32_16x16x32_bf16 v[116:119], a[132:135], a[60:63], v[116:119]
    v_fma_f32 v130, -v94, v94, v122
    v_fma_f32 v131, -v95, v95, v123
    v_mfma_f32_16x16x32_bf16 v[112:115], a[136:139], a[136:139], v[112:115]
    v_max_f32 v128, v128, v56
    v_max_f32 v129, v129, v56
    v_mfma_f32_16x16x32_bf16 v[116:119], a[136:139], a[64:67], v[116:119]
    v_max_f32 v130, v130, v56
    v_max_f32 v131, v131, v56
    v_mfma_f32_16x16x32_bf16 v[112:115], a[140:143], a[140:143], v[112:115]
    v_rsq_f32 v128, v128
    v_mfma_f32_16x16x32_bf16 v[116:119], a[140:143], a[68:71], v[116:119]
    v_rsq_f32 v129, v129
    v_mfma_f32_16x16x32_bf16 v[108:111], a[120:123], v[52:55], v[80:83]
    v_rsq_f32 v130, v130
    v_mfma_f32_16x16x32_bf16 v[108:111], a[124:127], v[52:55], v[108:111]
    v_rsq_f32 v131, v131
    v_mfma_f32_16x16x32_bf16 v[108:111], a[128:131], v[52:55], v[108:111]
    v_mfma_f32_16x16x32_bf16 v[108:111], a[132:135], v[52:55], v[108:111]
    v_mfma_f32_16x16x32_bf16 v[108:111], a[136:139], v[52:55], v[108:111]
    v_fma_f32 v112, v116, 2.0, v112
    v_fma_f32 v113, v117, 2.0, v113
    v_mfma_f32_16x16x32_bf16 v[108:111], a[140:143], v[52:55], v[108:111]
    v_fma_f32 v114, v118, 2.0, v114
    v_fma_f32 v115, v119, 2.0, v115
    v_cndmask_b32 v4, 0, v112, s[44:45]
    v_cndmask_b32 v4, v4, v113, s[46:47]
    v_cndmask_b32 v4, v4, v114, s[48:49]
    v_cndmask_b32 v4, v4, v115, s[50:51]
    s_nop 0
    s_nop 0
    v_mfma_f32_16x16x4_f32 v[124:127], v4, v60, v[56:59]
    s_nop 9
    v_fma_f32 v132, -v108, v108, v124
    v_fma_f32 v133, -v109, v109, v125
    v_fma_f32 v134, -v110, v110, v126
    v_fma_f32 v135, -v111, v111, v127
    v_max_f32 v132, v132, v56
    v_max_f32 v133, v133, v56
    v_max_f32 v134, v134, v56
    v_max_f32 v135, v135, v56
    v_rsq_f32 v132, v132
    v_rsq_f32 v133, v133
    v_rsq_f32 v134, v134
    v_rsq_f32 v135, v135
    s_mul_i32 s56, s3, 1536
    v_lshlrev_b32 v5, 3, v0
    v_add_u32 v5, 153600, v5
    v_add_u32 v4, s56, v5
    s_cmp_eq_u32 s0, 0
    s_cbranch_scc0 L_g28
    s_waitcnt vmcnt(9)
L_g28:
    buffer_load_dwordx4 v19, s[28:31], s57 offen offset:3072 nt lds
    s_cmp_eq_u32 s0, 0
    s_cbranch_scc0 L_g29
    s_waitcnt vmcnt(9)
L_g29:
    s_add_u32 m0, s40, 4096
    s_nop 0
    buffer_load_dwordx4 v20, s[28:31], s57 offen offset:0 nt lds
    s_cmp_eq_u32 s0, 0
    s_cbranch_scc0 L_g30
    s_waitcnt vmcnt(5)
L_g30:
    buffer_load_dwordx4 v21, s[28:31], s57 offen offset:1024 nt lds
    s_cmp_eq_u32 s0, 0
    s_cbranch_scc0 L_g31
    s_waitcnt vmcnt(5)
L_g31:
    s_add_u32 m0, s41, 0
    s_add_u32 s58, s37, 25165824
    buffer_load_dwordx4 v22, s[24:27], s58 offen offset:0 nt lds
    s_cmp_eq_u32 s0, 0
    s_cbranch_scc0 L_g32
    s_waitcnt vmcnt(5)
L_g32:
    buffer_load_dwordx4 v23, s[24:27], s58 offen offset:1024 nt lds
    s_cmp_eq_u32 s0, 0
    s_cbranch_scc0 L_g33
    s_waitcnt vmcnt(5)
L_g33:
    buffer_load_dwordx4 v24, s[24:27], s58 offen offset:2048 nt lds
    s_cmp_eq_u32 s0, 0
    s_cbranch_scc0 L_g34
    s_waitcnt vmcnt(5)
L_g34:
    buffer_load_dwordx4 v25, s[24:27], s58 offen offset:3072 nt lds
    s_waitcnt vmcnt(11)
    v_xor_b32 v1, s39, v138
    v_xor_b32 v2, s39, v142
    v_xor_b32 v3, s39, v146
    v_or3_b32 v1, v1, v2, v3
    v_cmp_ne_u32 vcc, 0, v1
    s_cbranch_vccnz L_qk_retry
L_qk_ok:
    ds_write_b64 v4, v[136:137] offset:0
    ds_write_b64 v4, v[140:141] offset:512
    ds_write_b64 v4, v[144:145] offset:1024
    s_waitcnt lgkmcnt(0)
    s_barrier
    ds_read2st64_b64 v[136:139], v5 offset0:0 offset1:1
    ds_read2st64_b64 v[140:143], v5 offset0:2 offset1:3
    ds_read2st64_b64 v[144:147], v5 offset0:4 offset1:5
    ds_read2st64_b64 v[148:151], v5 offset0:6 offset1:7
    ds_read2st64_b64 v[152:155], v5 offset0:8 offset1:9
    ds_read2st64_b64 v[156:159], v5 offset0:10 offset1:11
    s_waitcnt lgkmcnt(5)
    v_mfma_f32_16x16x32_bf16 v[120:123], v[52:55], v[136:139], 0
    v_mfma_f32_16x16x32_bf16 v[76:79], a[48:51], v[136:139], 0
    s_waitcnt lgkmcnt(4)
    v_mfma_f32_16x16x32_bf16 v[120:123], v[52:55], v[140:143], v[120:123]
    v_mfma_f32_16x16x32_bf16 v[76:79], a[52:55], v[140:143], v[76:79]
    s_waitcnt lgkmcnt(3)
    v_mfma_f32_16x16x32_bf16 v[120:123], v[52:55], v[144:147], v[120:123]
    v_mfma_f32_16x16x32_bf16 v[76:79], a[56:59], v[144:147], v[76:79]
    s_waitcnt lgkmcnt(2)
    v_mfma_f32_16x16x32_bf16 v[120:123], v[52:55], v[148:151], v[120:123]
    v_mfma_f32_16x16x32_bf16 v[76:79], a[60:63], v[148:151], v[76:79]
    s_cmp_eq_u32 s0, 0
    s_cbranch_scc0 L_g35
    s_waitcnt vmcnt(5)
L_g35:
    s_add_u32 m0, s41, 4096
    s_nop 0
    buffer_load_dwordx4 v26, s[24:27], s58 offen offset:0 nt lds
    s_waitcnt lgkmcnt(1)
    v_mfma_f32_16x16x32_bf16 v[120:123], v[52:55], v[152:155], v[120:123]
    v_mfma_f32_16x16x32_bf16 v[76:79], a[64:67], v[152:155], v[76:79]
    s_waitcnt lgkmcnt(0)
    v_mfma_f32_16x16x32_bf16 v[120:123], v[52:55], v[156:159], v[120:123]
    v_mfma_f32_16x16x32_bf16 v[76:79], a[68:71], v[156:159], v[76:79]
    s_nop 6
    v_mul_f32 v61, 0x3baaaaab, v120
    v_mfma_f32_16x16x32_bf16 v[88:91], a[96:99], v[136:139], v[76:79]
    v_mov_b32 v9, 0
    v_mfma_f32_16x16x32_bf16 v[88:91], a[100:103], v[140:143], v[88:91]
    v_mfma_f32_16x16x32_bf16 v[88:91], a[104:107], v[144:147], v[88:91]
    v_mfma_f32_16x16x32_bf16 v[88:91], a[108:111], v[148:151], v[88:91]
    v_mfma_f32_16x16x32_bf16 v[88:91], a[112:115], v[152:155], v[88:91]
    v_mfma_f32_16x16x32_bf16 v[88:91], a[116:119], v[156:159], v[88:91]
    ds_write_b32 v254, v9 offset:4096
    ds_write_b32 v254, v9 offset:4100
    v_mfma_f32_16x16x32_bf16 v[104:107], a[120:123], v[136:139], v[76:79]
    v_mfma_f32_16x16x32_bf16 v[104:107], a[124:127], v[140:143], v[104:107]
    v_mfma_f32_16x16x32_bf16 v[104:107], a[128:131], v[144:147], v[104:107]
    s_cmp_eq_u32 s0, 0
    s_cbranch_scc0 L_g36
    s_waitcnt vmcnt(5)
L_g36:
    buffer_load_dwordx4 v27, s[24:27], s58 offen offset:1024 nt lds
    v_mfma_f32_16x16x32_bf16 v[104:107], a[132:135], v[148:151], v[104:107]
    v_fma_f32 v88, -v92, v61, v88
    v_fma_f32 v89, -v93, v61, v89
    v_mfma_f32_16x16x32_bf16 v[104:107], a[136:139], v[152:155], v[104:107]
    v_fma_f32 v90, -v94, v61, v90
    v_fma_f32 v91, -v95, v61, v91
    v_mfma_f32_16x16x32_bf16 v[104:107], a[140:143], v[156:159], v[104:107]
    v_mul_f32 v88, v88, v128
    v_mul_f32 v89, v89, v129
    v_mul_f32 v90, v90, v130
    v_mul_f32 v91, v91, v131
    v_max3_f32 v1, v88, v89, v90
    v_max_f32 v1, v1, v91
    s_nop 1
    v_fma_f32 v104, -v108, v61, v104
    v_fma_f32 v105, -v109, v61, v105
    v_fma_f32 v106, -v110, v61, v106
    v_fma_f32 v107, -v111, v61, v107
    v_mul_f32 v104, v104, v132
    v_mul_f32 v105, v105, v133
    v_mul_f32 v106, v106, v134
    v_mul_f32 v107, v107, v135
    v_max3_f32 v1, v1, v104, v105
    v_max3_f32 v1, v1, v106, v107
    v_mov_b32 v2, v1
    s_nop 1
    v_permlane32_swap_b32 v1, v2
    v_max_f32 v1, v1, v2
    v_mov_b32 v2, v1
    s_nop 1
    v_permlane16_swap_b32 v1, v2
    v_max_f32 v1, v1, v2
    ds_write_b32 v239, v1
    s_waitcnt lgkmcnt(0)
    s_barrier
    ds_read_b32 v12, v240 offset:0
    ds_read_b32 v13, v240 offset:1024
    ds_read_b32 v14, v240 offset:2048
    ds_read_b32 v15, v240 offset:3072
    s_cmp_eq_u32 s0, 0
    s_cbranch_scc0 L_g37
    s_waitcnt vmcnt(5)
L_g37:
    buffer_load_dwordx4 v28, s[24:27], s58 offen offset:2048 nt lds
    s_waitcnt lgkmcnt(0)
    v_max3_f32 v1, v12, v13, v14
    v_max_f32 v1, v1, v15
    v_sub_f32 v88, v88, v1
    v_sub_f32 v89, v89, v1
    v_sub_f32 v90, v90, v1
    v_sub_f32 v91, v91, v1
    v_sub_f32 v104, v104, v1
    v_sub_f32 v105, v105, v1
    v_sub_f32 v106, v106, v1
    v_sub_f32 v107, v107, v1
    v_sub_f32 v62, 0, v1
    v_sub_f32 v255, 0, v1
    v_exp_f32 v96, v88
    v_exp_f32 v97, v89
    v_exp_f32 v98, v90
    v_exp_f32 v99, v91
    v_mul_f32 v88, v96, v128
    v_mul_f32 v89, v97, v129
    v_mul_f32 v90, v98, v130
    v_mul_f32 v91, v99, v131
    s_cmp_eq_u32 s0, 0
    s_cbranch_scc0 L_g38
    s_waitcnt vmcnt(5)
L_g38:
    buffer_load_dwordx4 v29, s[24:27], s58 offen offset:3072 nt lds
    v_exp_f32 v112, v104
    v_exp_f32 v113, v105
    v_exp_f32 v114, v106
    v_exp_f32 v115, v107
    v_cvt_pk_bf16_f32 v72, v88, v89
    v_cvt_pk_bf16_f32 v73, v90, v91
    v_mul_f32 v104, v112, v132
    v_mul_f32 v105, v113, v133
    v_mul_f32 v106, v114, v134
    v_mul_f32 v107, v115, v135
    v_cvt_pk_bf16_f32 v74, v104, v105
    v_cvt_pk_bf16_f32 v75, v106, v107
    ds_write_b128 v237, v[72:75] offset:0
    v_mov_b32 v63, v96
    v_mul_f32 v64, v88, v92
    v_add_f32 v63, v63, v97
    v_fmac_f32 v64, v89, v93
    v_add_f32 v63, v63, v98
    v_fmac_f32 v64, v90, v94
    v_add_f32 v63, v63, v99
    v_fmac_f32 v64, v91, v95
    v_mov_b32 v68, v88
    v_mov_b32 v69, v89
    v_mov_b32 v70, v90
    v_mov_b32 v71, v91
    s_waitcnt lgkmcnt(0)
    s_barrier
    ds_read_b128 v[92:95], v253 offset:0
    ds_read_b128 v[96:99], v253 offset:1024
    ds_read_b128 v[100:103], v253 offset:2048
    ds_read_b128 v[116:119], v253 offset:3072
    s_waitcnt lgkmcnt(3)
    v_mfma_f32_16x16x32_bf16 a[0:3], a[144:147], v[92:95], 0
    s_cmp_eq_u32 s0, 0
    s_cbranch_scc0 L_g39
    s_waitcnt vmcnt(5)
L_g39:
    s_add_u32 m0, s41, 8192
    s_nop 0
    buffer_load_dwordx4 v30, s[24:27], s58 offen offset:0 nt lds
    v_add_f32 v68, v68, v104
    v_add_f32 v69, v69, v105
    v_mfma_f32_16x16x32_bf16 a[4:7], a[160:163], v[92:95], 0
    v_add_f32 v70, v70, v106
    v_add_f32 v71, v71, v107
    v_mfma_f32_16x16x32_bf16 a[8:11], a[176:179], v[92:95], 0
    v_add_f32 v63, v63, v112
    v_fma_f32 v64, v104, v108, v64
    s_waitcnt lgkmcnt(2)
    v_mfma_f32_16x16x32_bf16 a[0:3], a[148:151], v[96:99], a[0:3]
    v_add_f32 v63, v63, v113
    v_fma_f32 v64, v105, v109, v64
    v_mfma_f32_16x16x32_bf16 a[4:7], a[164:167], v[96:99], a[4:7]
    v_add_f32 v63, v63, v114
    v_fma_f32 v64, v106, v110, v64
    v_mfma_f32_16x16x32_bf16 a[8:11], a[180:183], v[96:99], a[8:11]
    s_cmp_eq_u32 s0, 0
    s_cbranch_scc0 L_g40
    s_waitcnt vmcnt(5)
L_g40:
    buffer_load_dwordx4 v31, s[24:27], s58 offen offset:1024 nt lds
    v_add_f32 v63, v63, v115
    v_fma_f32 v64, v107, v111, v64
    s_waitcnt lgkmcnt(1)
    v_mfma_f32_16x16x32_bf16 a[0:3], a[152:155], v[100:103], a[0:3]
    v_mfma_f32_16x16x32_bf16 a[4:7], a[168:171], v[100:103], a[4:7]
    v_mfma_f32_16x16x32_bf16 a[8:11], a[184:187], v[100:103], a[8:11]
    s_waitcnt lgkmcnt(0)
    v_mfma_f32_16x16x32_bf16 a[0:3], a[156:159], v[116:119], a[0:3]
    v_mfma_f32_16x16x32_bf16 a[4:7], a[172:175], v[116:119], a[4:7]
    v_mfma_f32_16x16x32_bf16 a[8:11], a[188:191], v[116:119], a[8:11]
    s_waitcnt vmcnt(16)
    s_barrier
    ds_read_b128 a[96:99], v40 offset:49152
    ds_read_b128 a[100:103], v41 offset:49152
    ds_read_b128 a[104:107], v42 offset:49152
    ds_read_b128 a[108:111], v43 offset:49152
    ds_read_b128 a[112:115], v40 offset:49408
    ds_read_b128 a[116:119], v41 offset:49408
    ds_read_b128 a[120:123], v42 offset:49408
    ds_read_b128 a[124:127], v43 offset:49408
    ds_read_b128 a[128:131], v40 offset:49664
    ds_read_b128 a[132:135], v41 offset:49664
    ds_read_b128 a[136:139], v42 offset:49664
    ds_read_b128 a[140:143], v43 offset:49664
    s_waitcnt lgkmcnt(11)
    v_mfma_f32_16x16x32_bf16 v[96:99], a[96:99], a[96:99], v[84:87]
    s_cmp_eq_u32 s0, 0
    s_cbranch_scc0 L_g41
    s_waitcnt vmcnt(5)
L_g41:
    buffer_load_dwordx4 v32, s[24:27], s58 offen offset:2048 nt lds
    ds_read_b64_tr_b16 a[144:145], v44 offset:0
    ds_read_b64_tr_b16 a[146:147], v45 offset:0
    v_mfma_f32_16x16x32_bf16 v[100:103], a[96:99], a[48:51], 0
    ds_read_b64_tr_b16 a[148:149], v44 offset:12288
    ds_read_b64_tr_b16 a[150:151], v45 offset:12288
    s_waitcnt lgkmcnt(14)
    v_mfma_f32_16x16x32_bf16 v[96:99], a[100:103], a[100:103], v[96:99]
    ds_read_b64_tr_b16 a[152:153], v44 offset:24576
    ds_read_b64_tr_b16 a[154:155], v45 offset:24576
    v_mfma_f32_16x16x32_bf16 v[100:103], a[100:103], a[52:55], v[100:103]
    ds_read_b64_tr_b16 a[156:157], v44 offset:36864
    ds_read_b64_tr_b16 a[158:159], v45 offset:36864
    s_waitcnt lgkmcnt(15)
    v_mfma_f32_16x16x32_bf16 v[96:99], a[104:107], a[104:107], v[96:99]
    ds_read_b64_tr_b16 a[160:161], v46 offset:0
    ds_read_b64_tr_b16 a[162:163], v47 offset:0
    v_mfma_f32_16x16x32_bf16 v[100:103], a[104:107], a[56:59], v[100:103]
    ds_read_b64_tr_b16 a[164:165], v46 offset:12288
    ds_read_b64_tr_b16 a[166:167], v47 offset:12288
    v_mfma_f32_16x16x32_bf16 v[96:99], a[108:111], a[108:111], v[96:99]
    ds_read_b64_tr_b16 a[168:169], v46 offset:24576
    ds_read_b64_tr_b16 a[170:171], v47 offset:24576
    v_mfma_f32_16x16x32_bf16 v[100:103], a[108:111], a[60:63], v[100:103]
    ds_read_b64_tr_b16 a[172:173], v46 offset:36864
    ds_read_b64_tr_b16 a[174:175], v47 offset:36864
    v_mfma_f32_16x16x32_bf16 v[96:99], a[112:115], a[112:115], v[96:99]
    s_cmp_eq_u32 s0, 0
    s_cbranch_scc0 L_g42
    s_waitcnt vmcnt(5)
L_g42:
    buffer_load_dwordx4 v33, s[24:27], s58 offen offset:3072 nt lds
    ds_read_b64_tr_b16 a[176:177], v48 offset:0
    ds_read_b64_tr_b16 a[178:179], v49 offset:0
    v_mfma_f32_16x16x32_bf16 v[100:103], a[112:115], a[64:67], v[100:103]
    ds_read_b64_tr_b16 a[180:181], v48 offset:12288
    ds_read_b64_tr_b16 a[182:183], v49 offset:12288
    s_waitcnt lgkmcnt(15)
    v_mfma_f32_16x16x32_bf16 v[96:99], a[116:119], a[116:119], v[96:99]
    ds_read_b64_tr_b16 a[184:185], v48 offset:24576
    ds_read_b64_tr_b16 a[186:187], v49 offset:24576
    v_mfma_f32_16x16x32_bf16 v[100:103], a[116:119], a[68:71], v[100:103]
    ds_read_b64_tr_b16 a[188:189], v48 offset:36864
    ds_read_b64_tr_b16 a[190:191], v49 offset:36864
    v_mfma_f32_16x16x32_bf16 v[92:95], a[96:99], v[52:55], v[80:83]
    v_mfma_f32_16x16x32_bf16 v[92:95], a[100:103], v[52:55], v[92:95]
    v_mfma_f32_16x16x32_bf16 v[92:95], a[104:107], v[52:55], v[92:95]
    v_mfma_f32_16x16x32_bf16 v[92:95], a[108:111], v[52:55], v[92:95]
    s_nop 1
    v_fma_f32 v96, v100, 2.0, v96
    v_fma_f32 v97, v101, 2.0, v97
    v_mfma_f32_16x16x32_bf16 v[92:95], a[112:115], v[52:55], v[92:95]
    v_fma_f32 v98, v102, 2.0, v98
    v_fma_f32 v99, v103, 2.0, v99
    v_mfma_f32_16x16x32_bf16 v[92:95], a[116:119], v[52:55], v[92:95]
    v_cndmask_b32 v3, 0, v96, s[44:45]
    v_cndmask_b32 v3, v3, v97, s[46:47]
    v_mfma_f32_16x16x32_bf16 v[88:91], a[96:99], v[136:139], v[76:79]
    v_cndmask_b32 v3, v3, v98, s[48:49]
    v_cndmask_b32 v3, v3, v99, s[50:51]
    v_mfma_f32_16x16x32_bf16 v[88:91], a[100:103], v[140:143], v[88:91]
    s_nop 0
    s_nop 0
    v_mfma_f32_16x16x32_bf16 v[88:91], a[104:107], v[144:147], v[88:91]
    v_mfma_f32_16x16x4_f32 v[120:123], v3, v60, v[56:59]
    v_mfma_f32_16x16x32_bf16 v[88:91], a[108:111], v[148:151], v[88:91]
    v_mfma_f32_16x16x32_bf16 v[88:91], a[112:115], v[152:155], v[88:91]
    v_mfma_f32_16x16x32_bf16 v[88:91], a[116:119], v[156:159], v[88:91]
    s_waitcnt lgkmcnt(0)
    s_barrier
    v_mfma_f32_16x16x32_bf16 v[112:115], a[120:123], a[120:123], v[84:87]
    s_cmp_eq_u32 s0, 0
    s_cbranch_scc0 L_g43
    s_waitcnt vmcnt(5)
L_g43:
    s_add_u32 m0, s42, 0
    s_add_u32 s59, s37, 25362432
    buffer_load_dwordx4 v22, s[24:27], s59 offen offset:0 nt lds
    v_mfma_f32_16x16x32_bf16 v[116:119], a[120:123], a[48:51], 0
    v_mfma_f32_16x16x32_bf16 v[112:115], a[124:127], a[124:127], v[112:115]
    v_mfma_f32_16x16x32_bf16 v[116:119], a[124:127], a[52:55], v[116:119]
    v_fma_f32 v128, -v92, v92, v120
    v_fma_f32 v129, -v93, v93, v121
    v_mfma_f32_16x16x32_bf16 v[112:115], a[128:131], a[128:131], v[112:115]
    v_fma_f32 v130, -v94, v94, v122
    v_fma_f32 v131, -v95, v95, v123
    v_mfma_f32_16x16x32_bf16 v[116:119], a[128:131], a[56:59], v[116:119]
    s_cmp_eq_u32 s0, 0
    s_cbranch_scc0 L_g44
    s_waitcnt vmcnt(5)
L_g44:
    buffer_load_dwordx4 v23, s[24:27], s59 offen offset:1024 nt lds
    v_max_f32 v128, v128, v56
    v_max_f32 v129, v129, v56
    v_mfma_f32_16x16x32_bf16 v[112:115], a[132:135], a[132:135], v[112:115]
    v_max_f32 v130, v130, v56
    v_max_f32 v131, v131, v56
    v_mfma_f32_16x16x32_bf16 v[116:119], a[132:135], a[60:63], v[116:119]
    v_rsq_f32 v128, v128
    v_mfma_f32_16x16x32_bf16 v[112:115], a[136:139], a[136:139], v[112:115]
    v_rsq_f32 v129, v129
    v_mfma_f32_16x16x32_bf16 v[116:119], a[136:139], a[64:67], v[116:119]
    v_rsq_f32 v130, v130
    v_mfma_f32_16x16x32_bf16 v[112:115], a[140:143], a[140:143], v[112:115]
    v_rsq_f32 v131, v131
    v_mfma_f32_16x16x32_bf16 v[116:119], a[140:143], a[68:71], v[116:119]
    v_fma_f32 v88, -v92, v61, v88
    v_fma_f32 v89, -v93, v61, v89
    v_mfma_f32_16x16x32_bf16 v[108:111], a[120:123], v[52:55], v[80:83]
    v_fma_f32 v90, -v94, v61, v90
    v_fma_f32 v91, -v95, v61, v91
    v_mfma_f32_16x16x32_bf16 v[108:111], a[124:127], v[52:55], v[108:111]
    v_fma_f32 v88, v88, v128, v62
    v_fma_f32 v89, v89, v129, v62
    v_mfma_f32_16x16x32_bf16 v[108:111], a[128:131], v[52:55], v[108:111]
    v_fma_f32 v90, v90, v130, v62
    v_fma_f32 v91, v91, v131, v62
    v_mfma_f32_16x16x32_bf16 v[108:111], a[132:135], v[52:55], v[108:111]
    v_max3_f32 v1, v88, v89, v90
    v_max_f32 v1, v1, v91
    v_mfma_f32_16x16x32_bf16 v[108:111], a[136:139], v[52:55], v[108:111]
    v_cmp_lt_f32 vcc, s52, v1
    s_cbranch_vccnz L_site0
L_back0:
    v_mfma_f32_16x16x32_bf16 v[108:111], a[140:143], v[52:55], v[108:111]
    v_exp_f32 v96, v88
    v_mfma_f32_16x16x32_bf16 v[104:107], a[120:123], v[136:139], v[76:79]
    s_cmp_eq_u32 s0, 0
    s_cbranch_scc0 L_g45
    s_waitcnt vmcnt(5)
L_g45:
    buffer_load_dwordx4 v24, s[24:27], s59 offen offset:2048 nt lds
    v_exp_f32 v97, v89
    v_mfma_f32_16x16x32_bf16 v[104:107], a[124:127], v[140:143], v[104:107]
    v_exp_f32 v98, v90
    v_mfma_f32_16x16x32_bf16 v[104:107], a[128:131], v[144:147], v[104:107]
    v_exp_f32 v99, v91
    v_mfma_f32_16x16x32_bf16 v[104:107], a[132:135], v[148:151], v[104:107]
    v_mul_f32 v88, v96, v128
    v_mul_f32 v89, v97, v129
    v_mfma_f32_16x16x32_bf16 v[104:107], a[136:139], v[152:155], v[104:107]
    v_mul_f32 v90, v98, v130
    v_mul_f32 v91, v99, v131
    v_mfma_f32_16x16x32_bf16 v[104:107], a[140:143], v[156:159], v[104:107]
    v_fma_f32 v112, v116, 2.0, v112
    v_fma_f32 v113, v117, 2.0, v113
    v_fma_f32 v114, v118, 2.0, v114
    v_fma_f32 v115, v119, 2.0, v115
    v_cndmask_b32 v4, 0, v112, s[44:45]
    v_cndmask_b32 v4, v4, v113, s[46:47]
    v_cndmask_b32 v4, v4, v114, s[48:49]
    v_cndmask_b32 v4, v4, v115, s[50:51]
    v_add_f32 v63, v63, v96
    v_fmac_f32 v64, v88, v92
    v_mfma_f32_16x16x4_f32 v[124:127], v4, v60, v[56:59]
    v_add_f32 v63, v63, v97
    v_fmac_f32 v64, v89, v93
    v_add_f32 v63, v63, v98
    v_fmac_f32 v64, v90, v94
    v_add_f32 v63, v63, v99
    v_fmac_f32 v64, v91, v95
    v_add_f32 v68, v68, v88
    v_add_f32 v69, v69, v89
    v_add_f32 v70, v70, v90
    v_add_f32 v71, v71, v91
    v_add_u32 v44, -49152, v44
    v_add_u32 v45, -49152, v45
    v_add_u32 v46, -49152, v46
    v_add_u32 v47, -49152, v47
    v_add_u32 v48, -49152, v48
    v_add_u32 v49, -49152, v49
    v_fma_f32 v132, -v108, v108, v124
    v_fma_f32 v133, -v109, v109, v125
    v_fma_f32 v134, -v110, v110, v126
    v_fma_f32 v135, -v111, v111, v127
    v_max_f32 v132, v132, v56
    v_max_f32 v133, v133, v56
    v_max_f32 v134, v134, v56
    v_max_f32 v135, v135, v56
    v_rsq_f32 v132, v132
    v_rsq_f32 v133, v133
    v_rsq_f32 v134, v134
    v_rsq_f32 v135, v135
    s_cmp_eq_u32 s0, 0
    s_cbranch_scc0 L_g46
    s_waitcnt vmcnt(5)
L_g46:
    buffer_load_dwordx4 v25, s[24:27], s59 offen offset:3072 nt lds
    v_fma_f32 v104, -v108, v61, v104
    v_fma_f32 v105, -v109, v61, v105
    v_fma_f32 v106, -v110, v61, v106
    v_fma_f32 v107, -v111, v61, v107
    v_fma_f32 v104, v104, v132, v62
    v_fma_f32 v105, v105, v133, v62
    v_fma_f32 v106, v106, v134, v62
    v_fma_f32 v107, v107, v135, v62
    v_max3_f32 v1, v104, v105, v106
    v_max_f32 v1, v1, v107
    v_cmp_lt_f32 vcc, s52, v1
    s_cbranch_vccnz L_site1
L_back1:
    v_exp_f32 v112, v104
    v_exp_f32 v113, v105
    v_exp_f32 v114, v106
    v_exp_f32 v115, v107
    v_cvt_pk_bf16_f32 v72, v88, v89
    v_cvt_pk_bf16_f32 v73, v90, v91
    v_mul_f32 v104, v112, v132
    v_mul_f32 v105, v113, v133
    v_mul_f32 v106, v114, v134
    v_mul_f32 v107, v115, v135
    v_cvt_pk_bf16_f32 v74, v104, v105
    v_cvt_pk_bf16_f32 v75, v106, v107
    ds_write_b128 v237, v[72:75] offset:0
    v_add_f32 v68, v68, v104
    v_add_f32 v69, v69, v105
    v_add_f32 v70, v70, v106
    v_add_f32 v71, v71, v107
    v_cvt_pk_bf16_f32 v66, v68, v69
    v_cvt_pk_bf16_f32 v67, v70, v71
    ds_write_b64 v238, v[66:67]
    s_cmp_eq_u32 s0, 0
    s_cbranch_scc0 L_g47
    s_waitcnt vmcnt(5)
L_g47:
    s_add_u32 m0, s42, 4096
    s_nop 0
    buffer_load_dwordx4 v26, s[24:27], s59 offen offset:0 nt lds
    s_waitcnt vmcnt(17)
    s_waitcnt lgkmcnt(0)
    s_barrier
L_post3:
    ds_read_b32 v9, v254 offset:4096
    ds_read_b64 v[120:121], v254 offset:0
    ds_read_b64 v[122:123], v254 offset:512
    ds_read_b64 v[124:125], v254 offset:1024
    ds_read_b64 v[126:127], v254 offset:1536
    ds_read_b128 v[92:95], v253 offset:0
    ds_read_b128 v[96:99], v253 offset:1024
    ds_read_b128 v[100:103], v253 offset:2048
    ds_read_b128 v[116:119], v253 offset:3072
    ds_read_b128 a[48:51], v34 offset:0
    ds_read_b128 a[52:55], v35 offset:0
    ds_read_b128 a[56:59], v34 offset:128
    ds_read_b128 a[60:63], v35 offset:128
    ds_read_b128 a[64:67], v34 offset:256
    ds_read_b128 a[68:71], v35 offset:256
    s_waitcnt lgkmcnt(14)
    v_cmp_ne_u32 vcc, 0, v9
    s_cbranch_vccnz L_xt3
    s_waitcnt lgkmcnt(12)
    v_mfma_f32_16x16x32_bf16 a[0:3], a[72:75], v[120:123], a[0:3]
    s_cmp_eq_u32 s0, 0
    s_cbranch_scc0 L_g48
    s_waitcnt vmcnt(5)
L_g48:
    buffer_load_dwordx4 v27, s[24:27], s59 offen offset:1024 nt lds
    v_add_f32 v63, v63, v112
    v_fma_f32 v64, v104, v108, v64
    v_mfma_f32_16x16x32_bf16 a[4:7], a[80:83], v[120:123], a[4:7]
    v_add_f32 v63, v63, v113
    v_fma_f32 v64, v105, v109, v64
    v_mfma_f32_16x16x32_bf16 a[8:11], a[88:91], v[120:123], a[8:11]
    v_add_f32 v63, v63, v114
    v_fma_f32 v64, v106, v110, v64
    s_waitcnt lgkmcnt(10)
    v_mfma_f32_16x16x32_bf16 a[0:3], a[76:79], v[124:127], a[0:3]
    v_add_f32 v63, v63, v115
    v_fma_f32 v64, v107, v111, v64
    v_mfma_f32_16x16x32_bf16 a[4:7], a[84:87], v[124:127], a[4:7]
    v_mfma_f32_16x16x32_bf16 a[8:11], a[92:95], v[124:127], a[8:11]
    s_waitcnt lgkmcnt(9)
    v_mfma_f32_16x16x32_bf16 a[0:3], a[144:147], v[92:95], a[0:3]
    ds_read_b64_tr_b16 a[72:73], v36 offset:0
    ds_read_b64_tr_b16 a[74:75], v36 offset:6144
    v_mfma_f32_16x16x32_bf16 a[4:7], a[160:163], v[92:95], a[4:7]
    ds_read_b64_tr_b16 a[76:77], v36 offset:12288
    ds_read_b64_tr_b16 a[78:79], v36 offset:18432
    v_mfma_f32_16x16x32_bf16 a[8:11], a[176:179], v[92:95], a[8:11]
    ds_read_b64_tr_b16 a[80:81], v37 offset:0
    ds_read_b64_tr_b16 a[82:83], v37 offset:6144
    s_waitcnt lgkmcnt(14)
    v_mfma_f32_16x16x32_bf16 a[0:3], a[148:151], v[96:99], a[0:3]
    ds_read_b64_tr_b16 a[84:85], v37 offset:12288
    ds_read_b64_tr_b16 a[86:87], v37 offset:18432
    v_mfma_f32_16x16x32_bf16 a[4:7], a[164:167], v[96:99], a[4:7]
    ds_read_b64_tr_b16 a[88:89], v38 offset:0
    ds_read_b64_tr_b16 a[90:91], v38 offset:6144
    v_mfma_f32_16x16x32_bf16 a[8:11], a[180:183], v[96:99], a[8:11]
    s_cmp_eq_u32 s0, 0
    s_cbranch_scc0 L_g49
    s_waitcnt vmcnt(5)
L_g49:
    buffer_load_dwordx4 v28, s[24:27], s59 offen offset:2048 nt lds
    ds_read_b64_tr_b16 a[92:93], v38 offset:12288
    ds_read_b64_tr_b16 a[94:95], v38 offset:18432
    s_waitcnt lgkmcnt(15)
    v_mfma_f32_16x16x32_bf16 a[0:3], a[152:155], v[100:103], a[0:3]
    v_mfma_f32_16x16x32_bf16 a[4:7], a[168:171], v[100:103], a[4:7]
    v_mfma_f32_16x16x32_bf16 a[8:11], a[184:187], v[100:103], a[8:11]
    v_mfma_f32_16x16x32_bf16 a[0:3], a[156:159], v[116:119], a[0:3]
    v_mfma_f32_16x16x32_bf16 a[4:7], a[172:175], v[116:119], a[4:7]
    v_mfma_f32_16x16x32_bf16 a[8:11], a[188:191], v[116:119], a[8:11]
    v_mfma_f32_16x16x32_bf16 v[84:87], a[48:51], a[48:51], 0
    v_mfma_f32_16x16x32_bf16 v[80:83], a[48:51], v[52:55], 0
    v_mfma_f32_16x16x32_bf16 v[84:87], a[52:55], a[52:55], v[84:87]
    v_mfma_f32_16x16x32_bf16 v[80:83], a[52:55], v[52:55], v[80:83]
    v_mfma_f32_16x16x32_bf16 v[84:87], a[56:59], a[56:59], v[84:87]
    v_mfma_f32_16x16x32_bf16 v[80:83], a[56:59], v[52:55], v[80:83]
    s_waitcnt lgkmcnt(14)
    v_mfma_f32_16x16x32_bf16 v[84:87], a[60:63], a[60:63], v[84:87]
    s_cmp_eq_u32 s0, 0
    s_cbranch_scc0 L_g50
    s_waitcnt vmcnt(5)
L_g50:
    buffer_load_dwordx4 v29, s[24:27], s59 offen offset:3072 nt lds
    v_mfma_f32_16x16x32_bf16 v[80:83], a[60:63], v[52:55], v[80:83]
    s_waitcnt lgkmcnt(13)
    v_mfma_f32_16x16x32_bf16 v[84:87], a[64:67], a[64:67], v[84:87]
    v_mfma_f32_16x16x32_bf16 v[80:83], a[64:67], v[52:55], v[80:83]
    s_waitcnt lgkmcnt(12)
    v_mfma_f32_16x16x32_bf16 v[84:87], a[68:71], a[68:71], v[84:87]
    v_mfma_f32_16x16x32_bf16 v[80:83], a[68:71], v[52:55], v[80:83]
    s_waitcnt lgkmcnt(0)
    v_mfma_f32_16x16x32_bf16 v[76:79], a[48:51], v[136:139], 0
    v_mfma_f32_16x16x32_bf16 v[76:79], a[52:55], v[140:143], v[76:79]
    v_mfma_f32_16x16x32_bf16 v[76:79], a[56:59], v[144:147], v[76:79]
    v_mfma_f32_16x16x32_bf16 v[76:79], a[60:63], v[148:151], v[76:79]
    v_mfma_f32_16x16x32_bf16 v[76:79], a[64:67], v[152:155], v[76:79]
    v_mfma_f32_16x16x32_bf16 v[76:79], a[68:71], v[156:159], v[76:79]
    v_lshrrev_b32 v1, 3, v0
    v_and_b32 v2, 6, v1
    v_xor_b32 v2, v0, v2
    v_and_b32 v2, 7, v2
    v_mul_u32_u24 v1, 768, v1
    v_lshl_add_u32 v224, v2, 4, v1
    v_xor_b32 v225, 16, v224
    v_add_u32 v225, 5120, v225
    s_cmp_eq_u32 s0, 0
    s_cbranch_scc0 L_g51
    s_waitcnt vmcnt(5)
L_g51:
    s_add_u32 m0, s42, 8192
    s_nop 0
    buffer_load_dwordx4 v30, s[24:27], s59 offen offset:0 nt lds
    s_cmp_eq_u32 s0, 0
    s_cbranch_scc0 L_g52
    s_waitcnt vmcnt(5)
L_g52:
    buffer_load_dwordx4 v31, s[24:27], s59 offen offset:1024 nt lds
    s_cmp_eq_u32 s0, 0
    s_cbranch_scc0 L_g53
    s_waitcnt vmcnt(5)
L_g53:
    buffer_load_dwordx4 v32, s[24:27], s59 offen offset:2048 nt lds
    s_waitcnt vmcnt(11)
    s_barrier
    ds_read_b128 a[96:99], v40 offset:0
    ds_read_b128 a[100:103], v41 offset:0
    ds_read_b128 a[104:107], v42 offset:0
    ds_read_b128 a[108:111], v43 offset:0
    ds_read_b128 a[112:115], v40 offset:256
    ds_read_b128 a[116:119], v41 offset:256
    ds_read_b128 a[120:123], v42 offset:256
    ds_read_b128 a[124:127], v43 offset:256
    ds_read_b128 a[128:131], v40 offset:512
    ds_read_b128 a[132:135], v41 offset:512
    ds_read_b128 a[136:139], v42 offset:512
    ds_read_b128 a[140:143], v43 offset:512
    s_waitcnt lgkmcnt(11)
    v_mfma_f32_16x16x32_bf16 v[96:99], a[96:99], a[96:99], v[84:87]
    ds_read_b64_tr_b16 a[144:145], v44 offset:0
    ds_read_b64_tr_b16 a[146:147], v45 offset:0
    v_mfma_f32_16x16x32_bf16 v[100:103], a[96:99], a[48:51], 0
    ds_read_b64_tr_b16 a[148:149], v44 offset:12288
    ds_read_b64_tr_b16 a[150:151], v45 offset:12288
    s_waitcnt lgkmcnt(14)
    v_mfma_f32_16x16x32_bf16 v[96:99], a[100:103], a[100:103], v[96:99]
    ds_read_b64_tr_b16 a[152:153], v44 offset:24576
    ds_read_b64_tr_b16 a[154:155], v45 offset:24576
    v_mfma_f32_16x16x32_bf16 v[100:103], a[100:103], a[52:55], v[100:103]
    ds_read_b64_tr_b16 a[156:157], v44 offset:36864
    ds_read_b64_tr_b16 a[158:159], v45 offset:36864
    s_waitcnt lgkmcnt(15)
    v_mfma_f32_16x16x32_bf16 v[96:99], a[104:107], a[104:107], v[96:99]
    ds_read_b64_tr_b16 a[160:161], v46 offset:0
    ds_read_b64_tr_b16 a[162:163], v47 offset:0
    v_mfma_f32_16x16x32_bf16 v[100:103], a[104:107], a[56:59], v[100:103]
    ds_read_b64_tr_b16 a[164:165], v46 offset:12288
    ds_read_b64_tr_b16 a[166:167], v47 offset:12288
    v_mfma_f32_16x16x32_bf16 v[96:99], a[108:111], a[108:111], v[96:99]
    s_cmp_eq_u32 s0, 0
    s_cbranch_scc0 L_g54
    s_waitcnt vmcnt(5)
L_g54:
    buffer_load_dwordx4 v33, s[24:27], s59 offen offset:3072 nt lds
    ds_read_b64_tr_b16 a[168:169], v46 offset:24576
    ds_read_b64_tr_b16 a[170:171], v47 offset:24576
    v_mfma_f32_16x16x32_bf16 v[100:103], a[108:111], a[60:63], v[100:103]
    ds_read_b64_tr_b16 a[172:173], v46 offset:36864
    ds_read_b64_tr_b16 a[174:175], v47 offset:36864
    v_mfma_f32_16x16x32_bf16 v[96:99], a[112:115], a[112:115], v[96:99]
    ds_read_b64_tr_b16 a[176:177], v48 offset:0
    ds_read_b64_tr_b16 a[178:179], v49 offset:0
    v_mfma_f32_16x16x32_bf16 v[100:103], a[112:115], a[64:67], v[100:103]
    ds_read_b64_tr_b16 a[180:181], v48 offset:12288
    ds_read_b64_tr_b16 a[182:183], v49 offset:12288
    s_waitcnt lgkmcnt(15)
    v_mfma_f32_16x16x32_bf16 v[96:99], a[116:119], a[116:119], v[96:99]
    ds_read_b64_tr_b16 a[184:185], v48 offset:24576
    ds_read_b64_tr_b16 a[186:187], v49 offset:24576
    v_mfma_f32_16x16x32_bf16 v[100:103], a[116:119], a[68:71], v[100:103]
    ds_read_b64_tr_b16 a[188:189], v48 offset:36864
    ds_read_b64_tr_b16 a[190:191], v49 offset:36864
    v_mfma_f32_16x16x32_bf16 v[92:95], a[96:99], v[52:55], v[80:83]
    v_mfma_f32_16x16x32_bf16 v[92:95], a[100:103], v[52:55], v[92:95]
    v_mfma_f32_16x16x32_bf16 v[92:95], a[104:107], v[52:55], v[92:95]
    v_mfma_f32_16x16x32_bf16 v[92:95], a[108:111], v[52:55], v[92:95]
    s_nop 1
    v_fma_f32 v96, v100, 2.0, v96
    v_fma_f32 v97, v101, 2.0, v97
    v_mfma_f32_16x16x32_bf16 v[92:95], a[112:115], v[52:55], v[92:95]
    v_fma_f32 v98, v102, 2.0, v98
    v_fma_f32 v99, v103, 2.0, v99
    v_mfma_f32_16x16x32_bf16 v[92:95], a[116:119], v[52:55], v[92:95]
    v_cndmask_b32 v3, 0, v96, s[44:45]
    v_cndmask_b32 v3, v3, v97, s[46:47]
    v_mfma_f32_16x16x32_bf16 v[88:91], a[96:99], v[136:139], v[76:79]
    s_cmp_eq_u32 s0, 0
    s_cbranch_scc0 L_g55
    s_waitcnt vmcnt(5)
L_g55:
    s_add_u32 m0, s40, 0
    s_add_u32 s57, s36, 12582912
    buffer_load_dwordx4 v16, s[28:31], s57 offen offset:0 nt lds
    v_cndmask_b32 v3, v3, v98, s[48:49]
    v_cndmask_b32 v3, v3, v99, s[50:51]
    v_mfma_f32_16x16x32_bf16 v[88:91], a[100:103], v[140:143], v[88:91]
    s_nop 0
    s_nop 0
    v_mfma_f32_16x16x32_bf16 v[88:91], a[104:107], v[144:147], v[88:91]
    v_mfma_f32_16x16x4_f32 v[120:123], v3, v60, v[56:59]
    v_mfma_f32_16x16x32_bf16 v[88:91], a[108:111], v[148:151], v[88:91]
    v_mfma_f32_16x16x32_bf16 v[88:91], a[112:115], v[152:155], v[88:91]
    v_mfma_f32_16x16x32_bf16 v[88:91], a[116:119], v[156:159], v[88:91]
    v_mfma_f32_16x16x32_bf16 v[112:115], a[120:123], a[120:123], v[84:87]
    v_mfma_f32_16x16x32_bf16 v[116:119], a[120:123], a[48:51], 0
    v_mfma_f32_16x16x32_bf16 v[112:115], a[124:127], a[124:127], v[112:115]
    v_mfma_f32_16x16x32_bf16 v[116:119], a[124:127], a[52:55], v[116:119]
    s_nop 2
    v_fma_f32 v128, -v92, v92, v120
    v_fma_f32 v129, -v93, v93, v121
    v_mfma_f32_16x16x32_bf16 v[112:115], a[128:131], a[128:131], v[112:115]
    v_fma_f32 v130, -v94, v94, v122
    v_fma_f32 v131, -v95, v95, v123
    v_mfma_f32_16x16x32_bf16 v[116:119], a[128:131], a[56:59], v[116:119]
    s_cmp_eq_u32 s0, 0
    s_cbranch_scc0 L_g56
    s_waitcnt vmcnt(5)
L_g56:
    buffer_load_dwordx4 v17, s[28:31], s57 offen offset:1024 nt lds
    v_max_f32 v128, v128, v56
    v_max_f32 v129, v129, v56
    v_mfma_f32_16x16x32_bf16 v[112:115], a[132:135], a[132:135], v[112:115]
    v_max_f32 v130, v130, v56
    v_max_f32 v131, v131, v56
    v_mfma_f32_16x16x32_bf16 v[116:119], a[132:135], a[60:63], v[116:119]
    v_rsq_f32 v128, v128
    v_mfma_f32_16x16x32_bf16 v[112:115], a[136:139], a[136:139], v[112:115]
    v_rsq_f32 v129, v129
    v_mfma_f32_16x16x32_bf16 v[116:119], a[136:139], a[64:67], v[116:119]
    v_rsq_f32 v130, v130
    v_mfma_f32_16x16x32_bf16 v[112:115], a[140:143], a[140:143], v[112:115]
    v_rsq_f32 v131, v131
    v_mfma_f32_16x16x32_bf16 v[116:119], a[140:143], a[68:71], v[116:119]
    v_fma_f32 v88, -v92, v61, v88
    v_fma_f32 v89, -v93, v61, v89
    v_mfma_f32_16x16x32_bf16 v[108:111], a[120:123], v[52:55], v[80:83]
    v_fma_f32 v90, -v94, v61, v90
    v_fma_f32 v91, -v95, v61, v91
    v_mfma_f32_16x16x32_bf16 v[108:111], a[124:127], v[52:55], v[108:111]
    v_fma_f32 v88, v88, v128, v62
    v_fma_f32 v89, v89, v129, v62
    v_mfma_f32_16x16x32_bf16 v[108:111], a[128:131], v[52:55], v[108:111]
    v_fma_f32 v90, v90, v130, v62
    v_fma_f32 v91, v91, v131, v62
    v_mfma_f32_16x16x32_bf16 v[108:111], a[132:135], v[52:55], v[108:111]
    v_max3_f32 v1, v88, v89, v90
    v_max_f32 v1, v1, v91
    v_mfma_f32_16x16x32_bf16 v[108:111], a[136:139], v[52:55], v[108:111]
    v_cmp_lt_f32 vcc, s52, v1
    s_cbranch_vccnz L_site2
L_back2:
    v_mfma_f32_16x16x32_bf16 v[108:111], a[140:143], v[52:55], v[108:111]
    s_cmp_eq_u32 s0, 0
    s_cbranch_scc0 L_g57
    s_waitcnt vmcnt(5)
L_g57:
    buffer_load_dwordx4 v18, s[28:31], s57 offen offset:2048 nt lds
    v_exp_f32 v96, v88
    v_mfma_f32_16x16x32_bf16 v[104:107], a[120:123], v[136:139], v[76:79]
    v_exp_f32 v97, v89
    v_mfma_f32_16x16x32_bf16 v[104:107], a[124:127], v[140:143], v[104:107]
    v_exp_f32 v98, v90
    v_mfma_f32_16x16x32_bf16 v[104:107], a[128:131], v[144:147], v[104:107]
    v_exp_f32 v99, v91
    v_mfma_f32_16x16x32_bf16 v[104:107], a[132:135], v[148:151], v[104:107]
    v_mul_f32 v88, v96, v128
    v_mul_f32 v89, v97, v129
    v_mfma_f32_16x16x32_bf16 v[104:107], a[136:139], v[152:155], v[104:107]
    v_mul_f32 v90, v98, v130
    v_mul_f32 v91, v99, v131
    v_mfma_f32_16x16x32_bf16 v[104:107], a[140:143], v[156:159], v[104:107]
    v_fma_f32 v112, v116, 2.0, v112
    v_fma_f32 v113, v117, 2.0, v113
    v_fma_f32 v114, v118, 2.0, v114
    v_fma_f32 v115, v119, 2.0, v115
    v_cndmask_b32 v4, 0, v112, s[44:45]
    v_cndmask_b32 v4, v4, v113, s[46:47]
    v_cndmask_b32 v4, v4, v114, s[48:49]
    v_cndmask_b32 v4, v4, v115, s[50:51]
    v_add_f32 v63, v63, v96
    v_fmac_f32 v64, v88, v92
    v_mfma_f32_16x16x4_f32 v[124:127], v4, v60, v[56:59]
    v_add_f32 v63, v63, v97
    v_fmac_f32 v64, v89, v93
    v_add_f32 v63, v63, v98
    v_fmac_f32 v64, v90, v94
    v_add_f32 v63, v63, v99
    v_fmac_f32 v64, v91, v95
    v_mov_b32 v68, v88
    v_mov_b32 v69, v89
    v_mov_b32 v70, v90
    v_mov_b32 v71, v91
    v_add_u32 v44, 49152, v44
    v_add_u32 v45, 49152, v45
    v_add_u32 v46, 49152, v46
    v_add_u32 v47, 49152, v47
    v_add_u32 v48, 49152, v48
    v_add_u32 v49, 49152, v49
    v_fma_f32 v132, -v108, v108, v124
    v_fma_f32 v133, -v109, v109, v125
    v_fma_f32 v134, -v110, v110, v126
    v_fma_f32 v135, -v111, v111, v127
    v_max_f32 v132, v132, v56
    v_max_f32 v133, v133, v56
    v_max_f32 v134, v134, v56
    v_max_f32 v135, v135, v56
    v_rsq_f32 v132, v132
    v_rsq_f32 v133, v133
    v_rsq_f32 v134, v134
    v_rsq_f32 v135, v135
    s_cmp_eq_u32 s0, 0
    s_cbranch_scc0 L_g58
    s_waitcnt vmcnt(5)
L_g58:
    buffer_load_dwordx4 v19, s[28:31], s57 offen offset:3072 nt lds
    v_fma_f32 v104, -v108, v61, v104
    v_fma_f32 v105, -v109, v61, v105
    v_fma_f32 v106, -v110, v61, v106
    v_fma_f32 v107, -v111, v61, v107
    v_fma_f32 v104, v104, v132, v62
    v_fma_f32 v105, v105, v133, v62
    v_fma_f32 v106, v106, v134, v62
    v_fma_f32 v107, v107, v135, v62
    v_max3_f32 v1, v104, v105, v106
    v_max_f32 v1, v1, v107
    v_cmp_lt_f32 vcc, s52, v1
    s_cbranch_vccnz L_site3
L_back3:
    v_exp_f32 v112, v104
    v_exp_f32 v113, v105
    v_exp_f32 v114, v106
    v_exp_f32 v115, v107
    v_cvt_pk_bf16_f32 v72, v88, v89
    v_cvt_pk_bf16_f32 v73, v90, v91
    v_mul_f32 v104, v112, v132
    v_mul_f32 v105, v113, v133
    v_mul_f32 v106, v114, v134
    v_mul_f32 v107, v115, v135
    v_cvt_pk_bf16_f32 v74, v104, v105
    v_cvt_pk_bf16_f32 v75, v106, v107
    ds_write_b128 v237, v[72:75] offset:0
    s_waitcnt lgkmcnt(0)
    s_barrier
L_post24:
    ds_read_b32 v9, v254 offset:4096
    ds_read_b128 v[92:95], v253 offset:0
    ds_read_b128 v[96:99], v253 offset:1024
    ds_read_b128 v[100:103], v253 offset:2048
    ds_read_b128 v[116:119], v253 offset:3072
    s_waitcnt lgkmcnt(4)
    v_cmp_ne_u32 vcc, 0, v9
    s_cbranch_vccnz L_xt24
    s_waitcnt lgkmcnt(3)
    v_mfma_f32_16x16x32_bf16 a[0:3], a[144:147], v[92:95], a[0:3]
    s_cmp_eq_u32 s0, 0
    s_cbranch_scc0 L_g59
    s_waitcnt vmcnt(5)
L_g59:
    s_add_u32 m0, s40, 4096
    s_nop 0
    buffer_load_dwordx4 v20, s[28:31], s57 offen offset:0 nt lds
    v_add_f32 v68, v68, v104
    v_add_f32 v69, v69, v105
    v_mfma_f32_16x16x32_bf16 a[4:7], a[160:163], v[92:95], a[4:7]
    s_cmp_eq_u32 s0, 0
    s_cbranch_scc0 L_g60
    s_waitcnt vmcnt(5)
L_g60:
    buffer_load_dwordx4 v21, s[28:31], s57 offen offset:1024 nt lds
    v_add_f32 v70, v70, v106
    v_add_f32 v71, v71, v107
    v_mfma_f32_16x16x32_bf16 a[8:11], a[176:179], v[92:95], a[8:11]
    v_add_f32 v63, v63, v112
    v_fma_f32 v64, v104, v108, v64
    s_waitcnt lgkmcnt(2)
    v_mfma_f32_16x16x32_bf16 a[0:3], a[148:151], v[96:99], a[0:3]
    v_add_f32 v63, v63, v113
    v_fma_f32 v64, v105, v109, v64
    v_mfma_f32_16x16x32_bf16 a[4:7], a[164:167], v[96:99], a[4:7]
    v_add_f32 v63, v63, v114
    v_fma_f32 v64, v106, v110, v64
    v_mfma_f32_16x16x32_bf16 a[8:11], a[180:183], v[96:99], a[8:11]
    v_add_f32 v63, v63, v115
    v_fma_f32 v64, v107, v111, v64
    s_waitcnt lgkmcnt(1)
    v_mfma_f32_16x16x32_bf16 a[0:3], a[152:155], v[100:103], a[0:3]
    v_mfma_f32_16x16x32_bf16 a[4:7], a[168:171], v[100:103], a[4:7]
    v_mfma_f32_16x16x32_bf16 a[8:11], a[184:187], v[100:103], a[8:11]
    s_waitcnt lgkmcnt(0)
    v_mfma_f32_16x16x32_bf16 a[0:3], a[156:159], v[116:119], a[0:3]
    buffer_load_dwordx2 v[234:235], v245, s[32:35], 0 offen offset:128 sc1
    v_mfma_f32_16x16x32_bf16 a[4:7], a[172:175], v[116:119], a[4:7]
    v_mfma_f32_16x16x32_bf16 a[8:11], a[188:191], v[116:119], a[8:11]
    s_cmp_eq_u32 s0, 0
    s_cbranch_scc0 L_g61
    s_waitcnt vmcnt(6)
L_g61:
    s_add_u32 m0, s41, 0
    s_add_u32 s58, s37, 50331648
    buffer_load_dwordx4 v22, s[24:27], s58 offen offset:0 nt lds
    s_cmp_eq_u32 s0, 0
    s_cbranch_scc0 L_g62
    s_waitcnt vmcnt(6)
L_g62:
    buffer_load_dwordx4 v23, s[24:27], s58 offen offset:1024 nt lds
    s_cmp_eq_u32 s0, 0
    s_cbranch_scc0 L_g63
    s_waitcnt vmcnt(6)
L_g63:
    buffer_load_dwordx4 v24, s[24:27], s58 offen offset:2048 nt lds
    s_cmp_eq_u32 s0, 0
    s_cbranch_scc0 L_g64
    s_waitcnt vmcnt(6)
L_g64:
    buffer_load_dwordx4 v25, s[24:27], s58 offen offset:3072 nt lds
    s_waitcnt vmcnt(11)
    s_barrier
    ds_read_b128 a[96:99], v40 offset:49152
    ds_read_b128 a[100:103], v41 offset:49152
    ds_read_b128 a[104:107], v42 offset:49152
    ds_read_b128 a[108:111], v43 offset:49152
    ds_read_b128 a[112:115], v40 offset:49408
    ds_read_b128 a[116:119], v41 offset:49408
    ds_read_b128 a[120:123], v42 offset:49408
    ds_read_b128 a[124:127], v43 offset:49408
    ds_read_b128 a[128:131], v40 offset:49664
    ds_read_b128 a[132:135], v41 offset:49664
    ds_read_b128 a[136:139], v42 offset:49664
    ds_read_b128 a[140:143], v43 offset:49664
    s_waitcnt lgkmcnt(11)
    v_mfma_f32_16x16x32_bf16 v[96:99], a[96:99], a[96:99], v[84:87]
    ds_read_b64_tr_b16 a[144:145], v44 offset:0
    ds_read_b64_tr_b16 a[146:147], v45 offset:0
    v_mfma_f32_16x16x32_bf16 v[100:103], a[96:99], a[48:51], 0
    ds_read_b64_tr_b16 a[148:149], v44 offset:12288
    ds_read_b64_tr_b16 a[150:151], v45 offset:12288
    s_waitcnt lgkmcnt(14)
    v_mfma_f32_16x16x32_bf16 v[96:99], a[100:103], a[100:103], v[96:99]
    ds_read_b64_tr_b16 a[152:153], v44 offset:24576
    ds_read_b64_tr_b16 a[154:155], v45 offset:24576
    v_mfma_f32_16x16x32_bf16 v[100:103], a[100:103], a[52:55], v[100:103]
    ds_read_b64_tr_b16 a[156:157], v44 offset:36864
    ds_read_b64_tr_b16 a[158:159], v45 offset:36864
    s_waitcnt lgkmcnt(15)
    v_mfma_f32_16x16x32_bf16 v[96:99], a[104:107], a[104:107], v[96:99]
    ds_read_b64_tr_b16 a[160:161], v46 offset:0
    ds_read_b64_tr_b16 a[162:163], v47 offset:0
    v_mfma_f32_16x16x32_bf16 v[100:103], a[104:107], a[56:59], v[100:103]
    ds_read_b64_tr_b16 a[164:165], v46 offset:12288
    ds_read_b64_tr_b16 a[166:167], v47 offset:12288
    v_mfma_f32_16x16x32_bf16 v[96:99], a[108:111], a[108:111], v[96:99]
    s_cmp_eq_u32 s0, 0
    s_cbranch_scc0 L_g65
    s_waitcnt vmcnt(6)
L_g65:
    s_add_u32 m0, s41, 4096
    s_nop 0
    buffer_load_dwordx4 v26, s[24:27], s58 offen offset:0 nt lds
    ds_read_b64_tr_b16 a[168:169], v46 offset:24576
    ds_read_b64_tr_b16 a[170:171], v47 offset:24576
    v_mfma_f32_16x16x32_bf16 v[100:103], a[108:111], a[60:63], v[100:103]
    ds_read_b64_tr_b16 a[172:173], v46 offset:36864
    ds_read_b64_tr_b16 a[174:175], v47 offset:36864
    v_mfma_f32_16x16x32_bf16 v[96:99], a[112:115], a[112:115], v[96:99]
    ds_read_b64_tr_b16 a[176:177], v48 offset:0
    ds_read_b64_tr_b16 a[178:179], v49 offset:0
    v_mfma_f32_16x16x32_bf16 v[100:103], a[112:115], a[64:67], v[100:103]
    ds_read_b64_tr_b16 a[180:181], v48 offset:12288
    ds_read_b64_tr_b16 a[182:183], v49 offset:12288
    s_waitcnt lgkmcnt(15)
    v_mfma_f32_16x16x32_bf16 v[96:99], a[116:119], a[116:119], v[96:99]
    ds_read_b64_tr_b16 a[184:185], v48 offset:24576
    ds_read_b64_tr_b16 a[186:187], v49 offset:24576
    v_mfma_f32_16x16x32_bf16 v[100:103], a[116:119], a[68:71], v[100:103]
    ds_read_b64_tr_b16 a[188:189], v48 offset:36864
    ds_read_b64_tr_b16 a[190:191], v49 offset:36864
    v_mfma_f32_16x16x32_bf16 v[92:95], a[96:99], v[52:55], v[80:83]
    v_mfma_f32_16x16x32_bf16 v[92:95], a[100:103], v[52:55], v[92:95]
    v_mfma_f32_16x16x32_bf16 v[92:95], a[104:107], v[52:55], v[92:95]
    v_mfma_f32_16x16x32_bf16 v[92:95], a[108:111], v[52:55], v[92:95]
    s_nop 1
    v_fma_f32 v96, v100, 2.0, v96
    v_fma_f32 v97, v101, 2.0, v97
    v_mfma_f32_16x16x32_bf16 v[92:95], a[112:115], v[52:55], v[92:95]
    v_fma_f32 v98, v102, 2.0, v98
    v_fma_f32 v99, v103, 2.0, v99
    v_mfma_f32_16x16x32_bf16 v[92:95], a[116:119], v[52:55], v[92:95]
    v_cndmask_b32 v3, 0, v96, s[44:45]
    v_cndmask_b32 v3, v3, v97, s[46:47]
    v_mfma_f32_16x16x32_bf16 v[88:91], a[96:99], v[136:139], v[76:79]
    s_cmp_eq_u32 s0, 0
    s_cbranch_scc0 L_g66
    s_waitcnt vmcnt(6)
L_g66:
    buffer_load_dwordx4 v27, s[24:27], s58 offen offset:1024 nt lds
    v_cndmask_b32 v3, v3, v98, s[48:49]
    v_cndmask_b32 v3, v3, v99, s[50:51]
    v_mfma_f32_16x16x32_bf16 v[88:91], a[100:103], v[140:143], v[88:91]
    s_nop 0
    s_nop 0
    v_mfma_f32_16x16x32_bf16 v[88:91], a[104:107], v[144:147], v[88:91]
    v_mfma_f32_16x16x4_f32 v[120:123], v3, v60, v[56:59]
    v_mfma_f32_16x16x32_bf16 v[88:91], a[108:111], v[148:151], v[88:91]
    v_mfma_f32_16x16x32_bf16 v[88:91], a[112:115], v[152:155], v[88:91]
    v_mfma_f32_16x16x32_bf16 v[88:91], a[116:119], v[156:159], v[88:91]
    v_mfma_f32_16x16x32_bf16 v[112:115], a[120:123], a[120:123], v[84:87]
    v_mfma_f32_16x16x32_bf16 v[116:119], a[120:123], a[48:51], 0
    v_mfma_f32_16x16x32_bf16 v[112:115], a[124:127], a[124:127], v[112:115]
    v_mfma_f32_16x16x32_bf16 v[116:119], a[124:127], a[52:55], v[116:119]
    s_nop 2
    v_fma_f32 v128, -v92, v92, v120
    v_fma_f32 v129, -v93, v93, v121
    v_mfma_f32_16x16x32_bf16 v[112:115], a[128:131], a[128:131], v[112:115]
    v_fma_f32 v130, -v94, v94, v122
    v_fma_f32 v131, -v95, v95, v123
    v_mfma_f32_16x16x32_bf16 v[116:119], a[128:131], a[56:59], v[116:119]
    s_cmp_eq_u32 s0, 0
    s_cbranch_scc0 L_g67
    s_waitcnt vmcnt(5)
L_g67:
    buffer_load_dwordx4 v28, s[24:27], s58 offen offset:2048 nt lds
    v_max_f32 v128, v128, v56
    v_max_f32 v129, v129, v56
    v_mfma_f32_16x16x32_bf16 v[112:115], a[132:135], a[132:135], v[112:115]
    v_max_f32 v130, v130, v56
    v_max_f32 v131, v131, v56
    v_mfma_f32_16x16x32_bf16 v[116:119], a[132:135], a[60:63], v[116:119]
    v_rsq_f32 v128, v128
    v_mfma_f32_16x16x32_bf16 v[112:115], a[136:139], a[136:139], v[112:115]
    v_rsq_f32 v129, v129
    v_mfma_f32_16x16x32_bf16 v[116:119], a[136:139], a[64:67], v[116:119]
    v_rsq_f32 v130, v130
    v_mfma_f32_16x16x32_bf16 v[112:115], a[140:143], a[140:143], v[112:115]
    v_rsq_f32 v131, v131
    v_mfma_f32_16x16x32_bf16 v[116:119], a[140:143], a[68:71], v[116:119]
    v_fma_f32 v88, -v92, v61, v88
    v_fma_f32 v89, -v93, v61, v89
    v_mfma_f32_16x16x32_bf16 v[108:111], a[120:123], v[52:55], v[80:83]
    v_fma_f32 v90, -v94, v61, v90
    v_fma_f32 v91, -v95, v61, v91
    v_mfma_f32_16x16x32_bf16 v[108:111], a[124:127], v[52:55], v[108:111]
    v_fma_f32 v88, v88, v128, v62
    v_fma_f32 v89, v89, v129, v62
    v_mfma_f32_16x16x32_bf16 v[108:111], a[128:131], v[52:55], v[108:111]
    v_fma_f32 v90, v90, v130, v62
    v_fma_f32 v91, v91, v131, v62
    v_mfma_f32_16x16x32_bf16 v[108:111], a[132:135], v[52:55], v[108:111]
    v_max3_f32 v1, v88, v89, v90
    v_max_f32 v1, v1, v91
    v_mfma_f32_16x16x32_bf16 v[108:111], a[136:139], v[52:55], v[108:111]
    v_cmp_lt_f32 vcc, s52, v1
    s_cbranch_vccnz L_site4
L_back4:
    v_mfma_f32_16x16x32_bf16 v[108:111], a[140:143], v[52:55], v[108:111]
    v_exp_f32 v96, v88
    v_mfma_f32_16x16x32_bf16 v[104:107], a[120:123], v[136:139], v[76:79]
    s_cmp_eq_u32 s0, 0
    s_cbranch_scc0 L_g68
    s_waitcnt vmcnt(5)
L_g68:
    buffer_load_dwordx4 v29, s[24:27], s58 offen offset:3072 nt lds
    v_exp_f32 v97, v89
    v_mfma_f32_16x16x32_bf16 v[104:107], a[124:127], v[140:143], v[104:107]
    v_exp_f32 v98, v90
    v_mfma_f32_16x16x32_bf16 v[104:107], a[128:131], v[144:147], v[104:107]
    v_exp_f32 v99, v91
    v_mfma_f32_16x16x32_bf16 v[104:107], a[132:135], v[148:151], v[104:107]
    v_mul_f32 v88, v96, v128
    v_mul_f32 v89, v97, v129
    v_mfma_f32_16x16x32_bf16 v[104:107], a[136:139], v[152:155], v[104:107]
    v_mul_f32 v90, v98, v130
    v_mul_f32 v91, v99, v131
    v_mfma_f32_16x16x32_bf16 v[104:107], a[140:143], v[156:159], v[104:107]
    v_fma_f32 v112, v116, 2.0, v112
    v_fma_f32 v113, v117, 2.0, v113
    v_fma_f32 v114, v118, 2.0, v114
    v_fma_f32 v115, v119, 2.0, v115
    v_cndmask_b32 v4, 0, v112, s[44:45]
    v_cndmask_b32 v4, v4, v113, s[46:47]
    v_cndmask_b32 v4, v4, v114, s[48:49]
    v_cndmask_b32 v4, v4, v115, s[50:51]
    v_add_f32 v63, v63, v96
    v_fmac_f32 v64, v88, v92
    v_mfma_f32_16x16x4_f32 v[124:127], v4, v60, v[56:59]
    v_add_f32 v63, v63, v97
    v_fmac_f32 v64, v89, v93
    v_add_f32 v63, v63, v98
    v_fmac_f32 v64, v90, v94
    v_add_f32 v63, v63, v99
    v_fmac_f32 v64, v91, v95
    v_add_f32 v68, v68, v88
    v_add_f32 v69, v69, v89
    v_add_f32 v70, v70, v90
    v_add_f32 v71, v71, v91
    v_add_u32 v44, -49152, v44
    v_add_u32 v45, -49152, v45
    v_add_u32 v46, -49152, v46
    v_add_u32 v47, -49152, v47
    v_add_u32 v48, -49152, v48
    v_add_u32 v49, -49152, v49
    v_fma_f32 v132, -v108, v108, v124
    v_fma_f32 v133, -v109, v109, v125
    v_fma_f32 v134, -v110, v110, v126
    v_fma_f32 v135, -v111, v111, v127
    v_max_f32 v132, v132, v56
    v_max_f32 v133, v133, v56
    v_max_f32 v134, v134, v56
    v_max_f32 v135, v135, v56
    v_rsq_f32 v132, v132
    v_rsq_f32 v133, v133
    v_rsq_f32 v134, v134
    v_rsq_f32 v135, v135
    s_cmp_eq_u32 s0, 0
    s_cbranch_scc0 L_g69
    s_waitcnt vmcnt(5)
L_g69:
    s_add_u32 m0, s41, 8192
    s_nop 0
    buffer_load_dwordx4 v30, s[24:27], s58 offen offset:0 nt lds
    v_fma_f32 v104, -v108, v61, v104
    v_fma_f32 v105, -v109, v61, v105
    v_fma_f32 v106, -v110, v61, v106
    v_fma_f32 v107, -v111, v61, v107
    v_fma_f32 v104, v104, v132, v62
    v_fma_f32 v105, v105, v133, v62
    v_fma_f32 v106, v106, v134, v62
    v_fma_f32 v107, v107, v135, v62
    v_max3_f32 v1, v104, v105, v106
    v_max_f32 v1, v1, v107
    v_cmp_lt_f32 vcc, s52, v1
    s_cbranch_vccnz L_site5
L_back5:
    v_exp_f32 v112, v104
    v_exp_f32 v113, v105
    v_exp_f32 v114, v106
    v_exp_f32 v115, v107
    v_cvt_pk_bf16_f32 v72, v88, v89
    v_cvt_pk_bf16_f32 v73, v90, v91
    v_mul_f32 v104, v112, v132
    v_mul_f32 v105, v113, v133
    v_mul_f32 v106, v114, v134
    v_mul_f32 v107, v115, v135
    v_cvt_pk_bf16_f32 v74, v104, v105
    v_cvt_pk_bf16_f32 v75, v106, v107
    ds_write_b128 v237, v[72:75] offset:0
    v_add_f32 v68, v68, v104
    v_add_f32 v69, v69, v105
    v_add_f32 v70, v70, v106
    v_add_f32 v71, v71, v107
    v_cvt_pk_bf16_f32 v66, v68, v69
    v_cvt_pk_bf16_f32 v67, v70, v71
    ds_write_b64 v238, v[66:67]
    s_cmp_eq_u32 s0, 0
    s_cbranch_scc0 L_g70
    s_waitcnt vmcnt(5)
L_g70:
    buffer_load_dwordx4 v31, s[24:27], s58 offen offset:1024 nt lds
    s_cmp_eq_u32 s0, 0
    s_cbranch_scc0 L_g71
    s_waitcnt vmcnt(5)
L_g71:
    buffer_load_dwordx4 v32, s[24:27], s58 offen offset:2048 nt lds
    s_waitcnt vmcnt(12)
    s_waitcnt vmcnt(11)
    v_cmp_ne_u32 vcc, s39, v234
    s_cbranch_vccnz L_fl_retry
L_fl_ok:
    v_readlane_b32 s20, v235, 3
    v_readlane_b32 s21, v235, 4
    s_sub_u32 s20, s20, s21
    v_readlane_b32 s21, v235, 5
    s_add_u32 s20, s20, s21
    v_readlane_b32 s21, v235, 6
    s_sub_u32 s20, s20, s21
    v_readlane_b32 s21, v235, 7
    s_add_u32 s20, s20, s21
    v_readlane_b32 s21, v235, 8
    s_sub_u32 s20, s20, s21
    s_lshr_b32 s1, s20, 31
    s_waitcnt lgkmcnt(0)
    s_barrier
L_post6:
    ds_read_b32 v9, v254 offset:4096
    ds_read_b64 v[120:121], v254 offset:0
    ds_read_b64 v[122:123], v254 offset:512
    ds_read_b64 v[124:125], v254 offset:1024
    ds_read_b64 v[126:127], v254 offset:1536
    ds_read_b128 v[92:95], v253 offset:0
    ds_read_b128 v[96:99], v253 offset:1024
    ds_read_b128 v[100:103], v253 offset:2048
    ds_read_b128 v[116:119], v253 offset:3072
    ds_read_b128 a[48:51], v34 offset:0
    ds_read_b128 a[52:55], v35 offset:0
    ds_read_b128 a[56:59], v34 offset:128
    ds_read_b128 a[60:63], v35 offset:128
    ds_read_b128 a[64:67], v34 offset:256
    ds_read_b128 a[68:71], v35 offset:256
    s_waitcnt lgkmcnt(14)
    v_cmp_ne_u32 vcc, 0, v9
    s_cbranch_vccnz L_xt6
    s_waitcnt lgkmcnt(12)
    v_mfma_f32_16x16x32_bf16 a[0:3], a[72:75], v[120:123], a[0:3]
    s_cmp_eq_u32 s0, 0
    s_cbranch_scc0 L_g72
    s_waitcnt vmcnt(5)
L_g72:
    buffer_load_dwordx4 v33, s[24:27], s58 offen offset:3072 nt lds
    v_add_f32 v63, v63, v112
    v_fma_f32 v64, v104, v108, v64
    v_mfma_f32_16x16x32_bf16 a[4:7], a[80:83], v[120:123], a[4:7]
    v_add_f32 v63, v63, v113
    v_fma_f32 v64, v105, v109, v64
    v_mfma_f32_16x16x32_bf16 a[8:11], a[88:91], v[120:123], a[8:11]
    v_add_f32 v63, v63, v114
    v_fma_f32 v64, v106, v110, v64
    s_waitcnt lgkmcnt(10)
    v_mfma_f32_16x16x32_bf16 a[0:3], a[76:79], v[124:127], a[0:3]
    v_add_f32 v63, v63, v115
    v_fma_f32 v64, v107, v111, v64
    v_mfma_f32_16x16x32_bf16 a[4:7], a[84:87], v[124:127], a[4:7]
    v_mfma_f32_16x16x32_bf16 a[8:11], a[92:95], v[124:127], a[8:11]
    s_waitcnt lgkmcnt(9)
    v_mfma_f32_16x16x32_bf16 a[0:3], a[144:147], v[92:95], a[0:3]
    ds_read_b64_tr_b16 a[72:73], v36 offset:0
    ds_read_b64_tr_b16 a[74:75], v36 offset:6144
    v_mfma_f32_16x16x32_bf16 a[4:7], a[160:163], v[92:95], a[4:7]
    s_cmp_eq_u32 s0, 0
    s_cbranch_scc0 L_g73
    s_waitcnt vmcnt(5)
L_g73:
    s_add_u32 m0, s42, 0
    s_add_u32 s59, s37, 50528256
    buffer_load_dwordx4 v22, s[24:27], s59 offen offset:0 nt lds
    ds_read_b64_tr_b16 a[76:77], v36 offset:12288
    ds_read_b64_tr_b16 a[78:79], v36 offset:18432
    v_mfma_f32_16x16x32_bf16 a[8:11], a[176:179], v[92:95], a[8:11]
    ds_read_b64_tr_b16 a[80:81], v37 offset:0
    ds_read_b64_tr_b16 a[82:83], v37 offset:6144
    s_waitcnt lgkmcnt(14)
    v_mfma_f32_16x16x32_bf16 a[0:3], a[148:151], v[96:99], a[0:3]
    ds_read_b64_tr_b16 a[84:85], v37 offset:12288
    ds_read_b64_tr_b16 a[86:87], v37 offset:18432
    v_mfma_f32_16x16x32_bf16 a[4:7], a[164:167], v[96:99], a[4:7]
    ds_read_b64_tr_b16 a[88:89], v38 offset:0
    ds_read_b64_tr_b16 a[90:91], v38 offset:6144
    v_mfma_f32_16x16x32_bf16 a[8:11], a[180:183], v[96:99], a[8:11]
    ds_read_b64_tr_b16 a[92:93], v38 offset:12288
    ds_read_b64_tr_b16 a[94:95], v38 offset:18432
    s_waitcnt lgkmcnt(15)
    v_mfma_f32_16x16x32_bf16 a[0:3], a[152:155], v[100:103], a[0:3]
    v_mfma_f32_16x16x32_bf16 a[4:7], a[168:171], v[100:103], a[4:7]
    v_mfma_f32_16x16x32_bf16 a[8:11], a[184:187], v[100:103], a[8:11]
    v_mfma_f32_16x16x32_bf16 a[0:3], a[156:159], v[116:119], a[0:3]
    v_mfma_f32_16x16x32_bf16 a[4:7], a[172:175], v[116:119], a[4:7]
    v_mfma_f32_16x16x32_bf16 a[8:11], a[188:191], v[116:119], a[8:11]
    v_mfma_f32_16x16x32_bf16 v[84:87], a[48:51], a[48:51], 0
    s_cmp_eq_u32 s0, 0
    s_cbranch_scc0 L_g74
    s_waitcnt vmcnt(5)
L_g74:
    buffer_load_dwordx4 v23, s[24:27], s59 offen offset:1024 nt lds
    v_mfma_f32_16x16x32_bf16 v[80:83], a[48:51], v[52:55], 0
    v_mfma_f32_16x16x32_bf16 v[84:87], a[52:55], a[52:55], v[84:87]
    v_mfma_f32_16x16x32_bf16 v[80:83], a[52:55], v[52:55], v[80:83]
    v_mfma_f32_16x16x32_bf16 v[84:87], a[56:59], a[56:59], v[84:87]
    v_mfma_f32_16x16x32_bf16 v[80:83], a[56:59], v[52:55], v[80:83]
    s_waitcnt lgkmcnt(14)
    v_mfma_f32_16x16x32_bf16 v[84:87], a[60:63], a[60:63], v[84:87]
    v_mfma_f32_16x16x32_bf16 v[80:83], a[60:63], v[52:55], v[80:83]
    s_waitcnt lgkmcnt(13)
    v_mfma_f32_16x16x32_bf16 v[84:87], a[64:67], a[64:67], v[84:87]
    v_mfma_f32_16x16x32_bf16 v[80:83], a[64:67], v[52:55], v[80:83]
    s_waitcnt lgkmcnt(12)
    v_mfma_f32_16x16x32_bf16 v[84:87], a[68:71], a[68:71], v[84:87]
    v_mfma_f32_16x16x32_bf16 v[80:83], a[68:71], v[52:55], v[80:83]
    s_waitcnt lgkmcnt(0)
    v_mfma_f32_16x16x32_bf16 v[76:79], a[48:51], v[136:139], 0
    v_mfma_f32_16x16x32_bf16 v[76:79], a[52:55], v[140:143], v[76:79]
    v_mfma_f32_16x16x32_bf16 v[76:79], a[56:59], v[144:147], v[76:79]
    s_add_u32 s61, s60, 3145728
    buffer_load_dwordx4 v[160:163], v65, s[72:75], s61 offen offset:0 sc1
    v_mfma_f32_16x16x32_bf16 v[76:79], a[60:63], v[148:151], v[76:79]
    v_mfma_f32_16x16x32_bf16 v[76:79], a[64:67], v[152:155], v[76:79]
    v_mfma_f32_16x16x32_bf16 v[76:79], a[68:71], v[156:159], v[76:79]
    s_cmp_eq_u32 s0, 0
    s_cbranch_scc0 L_g75
    s_waitcnt vmcnt(6)
L_g75:
    buffer_load_dwordx4 v24, s[24:27], s59 offen offset:2048 nt lds
    s_cmp_eq_u32 s0, 0
    s_cbranch_scc0 L_g76
    s_waitcnt vmcnt(6)
L_g76:
    buffer_load_dwordx4 v25, s[24:27], s59 offen offset:3072 nt lds
    buffer_load_dwordx4 v[164:167], v65, s[72:75], s61 offen offset:1024 sc1
    s_cmp_eq_u32 s0, 0
    s_cbranch_scc0 L_g77
    s_waitcnt vmcnt(7)
L_g77:
    s_add_u32 m0, s42, 4096
    s_nop 0
    buffer_load_dwordx4 v26, s[24:27], s59 offen offset:0 nt lds
    s_cmp_eq_u32 s0, 0
    s_cbranch_scc0 L_g78
    s_waitcnt vmcnt(7)
L_g78:
    buffer_load_dwordx4 v27, s[24:27], s59 offen offset:1024 nt lds
    s_cmp_eq_u32 s0, 0
    s_cbranch_scc0 L_g79
    s_waitcnt vmcnt(7)
L_g79:
    buffer_load_dwordx4 v28, s[24:27], s59 offen offset:2048 nt lds
    buffer_load_dwordx4 v[168:171], v65, s[72:75], s61 offen offset:2048 sc1
    s_cmp_eq_u32 s0, 0
    s_cbranch_scc0 L_g80
    s_waitcnt vmcnt(8)
L_g80:
    buffer_load_dwordx4 v29, s[24:27], s59 offen offset:3072 nt lds
    s_waitcnt vmcnt(11)
    s_barrier
    ds_read_b128 a[96:99], v40 offset:0
    ds_read_b128 a[100:103], v41 offset:0
    ds_read_b128 a[104:107], v42 offset:0
    ds_read_b128 a[108:111], v43 offset:0
    ds_read_b128 a[112:115], v40 offset:256
    ds_read_b128 a[116:119], v41 offset:256
    ds_read_b128 a[120:123], v42 offset:256
    ds_read_b128 a[124:127], v43 offset:256
    ds_read_b128 a[128:131], v40 offset:512
    ds_read_b128 a[132:135], v41 offset:512
    ds_read_b128 a[136:139], v42 offset:512
    ds_read_b128 a[140:143], v43 offset:512
    s_waitcnt lgkmcnt(11)
    v_mfma_f32_16x16x32_bf16 v[96:99], a[96:99], a[96:99], v[84:87]
    ds_read_b64_tr_b16 a[144:145], v44 offset:0
    ds_read_b64_tr_b16 a[146:147], v45 offset:0
    v_mfma_f32_16x16x32_bf16 v[100:103], a[96:99], a[48:51], 0
    ds_read_b64_tr_b16 a[148:149], v44 offset:12288
    ds_read_b64_tr_b16 a[150:151], v45 offset:12288
    s_waitcnt lgkmcnt(14)
    v_mfma_f32_16x16x32_bf16 v[96:99], a[100:103], a[100:103], v[96:99]
    ds_read_b64_tr_b16 a[152:153], v44 offset:24576
    ds_read_b64_tr_b16 a[154:155], v45 offset:24576
    v_mfma_f32_16x16x32_bf16 v[100:103], a[100:103], a[52:55], v[100:103]
    ds_read_b64_tr_b16 a[156:157], v44 offset:36864
    ds_read_b64_tr_b16 a[158:159], v45 offset:36864
    s_waitcnt lgkmcnt(15)
    v_mfma_f32_16x16x32_bf16 v[96:99], a[104:107], a[104:107], v[96:99]
    ds_read_b64_tr_b16 a[160:161], v46 offset:0
    ds_read_b64_tr_b16 a[162:163], v47 offset:0
    v_mfma_f32_16x16x32_bf16 v[100:103], a[104:107], a[56:59], v[100:103]
    ds_read_b64_tr_b16 a[164:165], v46 offset:12288
    ds_read_b64_tr_b16 a[166:167], v47 offset:12288
    v_mfma_f32_16x16x32_bf16 v[96:99], a[108:111], a[108:111], v[96:99]
    s_cmp_eq_u32 s0, 0
    s_cbranch_scc0 L_g81
    s_waitcnt vmcnt(7)
L_g81:
    s_add_u32 m0, s42, 8192
    s_nop 0
    buffer_load_dwordx4 v30, s[24:27], s59 offen offset:0 nt lds
    ds_read_b64_tr_b16 a[168:169], v46 offset:24576
    ds_read_b64_tr_b16 a[170:171], v47 offset:24576
    v_mfma_f32_16x16x32_bf16 v[100:103], a[108:111], a[60:63], v[100:103]
    ds_read_b64_tr_b16 a[172:173], v46 offset:36864
    ds_read_b64_tr_b16 a[174:175], v47 offset:36864
    v_mfma_f32_16x16x32_bf16 v[96:99], a[112:115], a[112:115], v[96:99]
    ds_read_b64_tr_b16 a[176:177], v48 offset:0
    ds_read_b64_tr_b16 a[178:179], v49 offset:0
    v_mfma_f32_16x16x32_bf16 v[100:103], a[112:115], a[64:67], v[100:103]
    ds_read_b64_tr_b16 a[180:181], v48 offset:12288
    ds_read_b64_tr_b16 a[182:183], v49 offset:12288
    s_waitcnt lgkmcnt(15)
    v_mfma_f32_16x16x32_bf16 v[96:99], a[116:119], a[116:119], v[96:99]
    ds_read_b64_tr_b16 a[184:185], v48 offset:24576
    ds_read_b64_tr_b16 a[186:187], v49 offset:24576
    v_mfma_f32_16x16x32_bf16 v[100:103], a[116:119], a[68:71], v[100:103]
    ds_read_b64_tr_b16 a[188:189], v48 offset:36864
    ds_read_b64_tr_b16 a[190:191], v49 offset:36864
    v_mfma_f32_16x16x32_bf16 v[92:95], a[96:99], v[52:55], v[80:83]
    v_mfma_f32_16x16x32_bf16 v[92:95], a[100:103], v[52:55], v[92:95]
    v_mfma_f32_16x16x32_bf16 v[92:95], a[104:107], v[52:55], v[92:95]
    v_mfma_f32_16x16x32_bf16 v[92:95], a[108:111], v[52:55], v[92:95]
    s_nop 1
    v_fma_f32 v96, v100, 2.0, v96
    v_fma_f32 v97, v101, 2.0, v97
    v_mfma_f32_16x16x32_bf16 v[92:95], a[112:115], v[52:55], v[92:95]
    v_fma_f32 v98, v102, 2.0, v98
    v_fma_f32 v99, v103, 2.0, v99
    v_mfma_f32_16x16x32_bf16 v[92:95], a[116:119], v[52:55], v[92:95]
    v_cndmask_b32 v3, 0, v96, s[44:45]
    v_cndmask_b32 v3, v3, v97, s[46:47]
    v_mfma_f32_16x16x32_bf16 v[88:91], a[96:99], v[136:139], v[76:79]
    buffer_load_dwordx4 v[172:175], v65, s[72:75], s61 offen offset:3072 sc1
    v_cndmask_b32 v3, v3, v98, s[48:49]
    v_cndmask_b32 v3, v3, v99, s[50:51]
    v_mfma_f32_16x16x32_bf16 v[88:91], a[100:103], v[140:143], v[88:91]
    s_cmp_eq_u32 s0, 0
    s_cbranch_scc0 L_g82
    s_waitcnt vmcnt(8)
L_g82:
    buffer_load_dwordx4 v31, s[24:27], s59 offen offset:1024 nt lds
    s_nop 0
    s_nop 0
    v_mfma_f32_16x16x32_bf16 v[88:91], a[104:107], v[144:147], v[88:91]
    v_mfma_f32_16x16x4_f32 v[120:123], v3, v60, v[56:59]
    v_mfma_f32_16x16x32_bf16 v[88:91], a[108:111], v[148:151], v[88:91]
    v_mfma_f32_16x16x32_bf16 v[88:91], a[112:115], v[152:155], v[88:91]
    v_mfma_f32_16x16x32_bf16 v[88:91], a[116:119], v[156:159], v[88:91]
    v_mfma_f32_16x16x32_bf16 v[112:115], a[120:123], a[120:123], v[84:87]
    v_mfma_f32_16x16x32_bf16 v[116:119], a[120:123], a[48:51], 0
    v_mfma_f32_16x16x32_bf16 v[112:115], a[124:127], a[124:127], v[112:115]
    v_mfma_f32_16x16x32_bf16 v[116:119], a[124:127], a[52:55], v[116:119]
    s_nop 2
    v_fma_f32 v128, -v92, v92, v120
    v_fma_f32 v129, -v93, v93, v121
    v_mfma_f32_16x16x32_bf16 v[112:115], a[128:131], a[128:131], v[112:115]
    s_cmp_eq_u32 s0, 0
    s_cbranch_scc0 L_g83
    s_waitcnt vmcnt(7)
L_g83:
    buffer_load_dwordx4 v32, s[24:27], s59 offen offset:2048 nt lds
    v_fma_f32 v130, -v94, v94, v122
    v_fma_f32 v131, -v95, v95, v123
    v_mfma_f32_16x16x32_bf16 v[116:119], a[128:131], a[56:59], v[116:119]
    v_max_f32 v128, v128, v56
    v_max_f32 v129, v129, v56
    v_mfma_f32_16x16x32_bf16 v[112:115], a[132:135], a[132:135], v[112:115]
    v_max_f32 v130, v130, v56
    v_max_f32 v131, v131, v56
    v_mfma_f32_16x16x32_bf16 v[116:119], a[132:135], a[60:63], v[116:119]
    v_rsq_f32 v128, v128
    v_mfma_f32_16x16x32_bf16 v[112:115], a[136:139], a[136:139], v[112:115]
    v_rsq_f32 v129, v129
    v_mfma_f32_16x16x32_bf16 v[116:119], a[136:139], a[64:67], v[116:119]
    v_rsq_f32 v130, v130
    v_mfma_f32_16x16x32_bf16 v[112:115], a[140:143], a[140:143], v[112:115]
    v_rsq_f32 v131, v131
    v_mfma_f32_16x16x32_bf16 v[116:119], a[140:143], a[68:71], v[116:119]
    v_fma_f32 v88, -v92, v61, v88
    v_fma_f32 v89, -v93, v61, v89
    v_mfma_f32_16x16x32_bf16 v[108:111], a[120:123], v[52:55], v[80:83]
    v_fma_f32 v90, -v94, v61, v90
    v_fma_f32 v91, -v95, v61, v91
    v_mfma_f32_16x16x32_bf16 v[108:111], a[124:127], v[52:55], v[108:111]
    v_fma_f32 v88, v88, v128, v62
    v_fma_f32 v89, v89, v129, v62
    v_mfma_f32_16x16x32_bf16 v[108:111], a[128:131], v[52:55], v[108:111]
    v_fma_f32 v90, v90, v130, v62
    v_fma_f32 v91, v91, v131, v62
    v_mfma_f32_16x16x32_bf16 v[108:111], a[132:135], v[52:55], v[108:111]
    v_max3_f32 v1, v88, v89, v90
    v_max_f32 v1, v1, v91
    v_mfma_f32_16x16x32_bf16 v[108:111], a[136:139], v[52:55], v[108:111]
    s_cmp_eq_u32 s0, 0
    s_cbranch_scc0 L_g84
    s_waitcnt vmcnt(7)
L_g84:
    buffer_load_dwordx4 v33, s[24:27], s59 offen offset:3072 nt lds
    v_cmp_lt_f32 vcc, s52, v1
    s_cbranch_vccnz L_site6
L_back6:
    v_mfma_f32_16x16x32_bf16 v[108:111], a[140:143], v[52:55], v[108:111]
    s_add_u32 s61, s60, 3149824
    buffer_load_dwordx4 v[176:179], v65, s[72:75], s61 offen offset:0 sc1
    v_exp_f32 v96, v88
    v_mfma_f32_16x16x32_bf16 v[104:107], a[120:123], v[136:139], v[76:79]
    v_exp_f32 v97, v89
    v_mfma_f32_16x16x32_bf16 v[104:107], a[124:127], v[140:143], v[104:107]
    v_exp_f32 v98, v90
    v_mfma_f32_16x16x32_bf16 v[104:107], a[128:131], v[144:147], v[104:107]
    v_exp_f32 v99, v91
    v_mfma_f32_16x16x32_bf16 v[104:107], a[132:135], v[148:151], v[104:107]
    v_mul_f32 v88, v96, v128
    v_mul_f32 v89, v97, v129
    v_mfma_f32_16x16x32_bf16 v[104:107], a[136:139], v[152:155], v[104:107]
    v_mul_f32 v90, v98, v130
    v_mul_f32 v91, v99, v131
    v_mfma_f32_16x16x32_bf16 v[104:107], a[140:143], v[156:159], v[104:107]
    v_fma_f32 v112, v116, 2.0, v112
    v_fma_f32 v113, v117, 2.0, v113
    v_fma_f32 v114, v118, 2.0, v114
    v_fma_f32 v115, v119, 2.0, v115
    v_cndmask_b32 v4, 0, v112, s[44:45]
    v_cndmask_b32 v4, v4, v113, s[46:47]
    v_cndmask_b32 v4, v4, v114, s[48:49]
    v_cndmask_b32 v4, v4, v115, s[50:51]
    v_add_f32 v63, v63, v96
    v_fmac_f32 v64, v88, v92
    v_mfma_f32_16x16x4_f32 v[124:127], v4, v60, v[56:59]
    v_add_f32 v63, v63, v97
    v_fmac_f32 v64, v89, v93
    v_add_f32 v63, v63, v98
    v_fmac_f32 v64, v90, v94
    v_add_f32 v63, v63, v99
    v_fmac_f32 v64, v91, v95
    v_mov_b32 v68, v88
    v_mov_b32 v69, v89
    v_mov_b32 v70, v90
    v_mov_b32 v71, v91
    v_add_u32 v44, 49152, v44
    v_add_u32 v45, 49152, v45
    v_add_u32 v46, 49152, v46
    v_add_u32 v47, 49152, v47
    v_add_u32 v48, 49152, v48
    v_add_u32 v49, 49152, v49
    v_fma_f32 v132, -v108, v108, v124
    v_fma_f32 v133, -v109, v109, v125
    v_fma_f32 v134, -v110, v110, v126
    v_fma_f32 v135, -v111, v111, v127
    v_max_f32 v132, v132, v56
    v_max_f32 v133, v133, v56
    v_max_f32 v134, v134, v56
    v_max_f32 v135, v135, v56
    v_rsq_f32 v132, v132
    v_rsq_f32 v133, v133
    v_rsq_f32 v134, v134
    v_rsq_f32 v135, v135
    s_cmp_eq_u32 s0, 0
    s_cbranch_scc0 L_g85
    s_waitcnt vmcnt(8)
L_g85:
    s_add_u32 m0, s40, 0
    s_add_u32 s57, s36, 18874368
    buffer_load_dwordx4 v16, s[28:31], s57 offen offset:0 nt lds
    v_fma_f32 v104, -v108, v61, v104
    v_fma_f32 v105, -v109, v61, v105
    v_fma_f32 v106, -v110, v61, v106
    v_fma_f32 v107, -v111, v61, v107
    v_fma_f32 v104, v104, v132, v62
    v_fma_f32 v105, v105, v133, v62
    v_fma_f32 v106, v106, v134, v62
    v_fma_f32 v107, v107, v135, v62
    v_max3_f32 v1, v104, v105, v106
    v_max_f32 v1, v1, v107
    v_cmp_lt_f32 vcc, s52, v1
    s_cbranch_vccnz L_site7
L_back7:
    v_exp_f32 v112, v104
    v_exp_f32 v113, v105
    v_exp_f32 v114, v106
    v_exp_f32 v115, v107
    v_cvt_pk_bf16_f32 v72, v88, v89
    v_cvt_pk_bf16_f32 v73, v90, v91
    v_mul_f32 v104, v112, v132
    v_mul_f32 v105, v113, v133
    v_mul_f32 v106, v114, v134
    v_mul_f32 v107, v115, v135
    v_cvt_pk_bf16_f32 v74, v104, v105
    v_cvt_pk_bf16_f32 v75, v106, v107
    ds_write_b128 v237, v[72:75] offset:0
    s_waitcnt lgkmcnt(0)
    s_barrier
L_post27:
    ds_read_b32 v9, v254 offset:4096
    ds_read_b128 v[92:95], v253 offset:0
    ds_read_b128 v[96:99], v253 offset:1024
    ds_read_b128 v[100:103], v253 offset:2048
    ds_read_b128 v[116:119], v253 offset:3072
    s_waitcnt lgkmcnt(4)
    v_cmp_ne_u32 vcc, 0, v9
    s_cbranch_vccnz L_xt27
    s_waitcnt lgkmcnt(3)
    v_mfma_f32_16x16x32_bf16 a[0:3], a[144:147], v[92:95], a[0:3]
    buffer_load_dwordx4 v17, s[28:31], s57 offen offset:1024 nt lds
    v_add_f32 v68, v68, v104
    v_add_f32 v69, v69, v105
    v_mfma_f32_16x16x32_bf16 a[4:7], a[160:163], v[92:95], a[4:7]
    buffer_load_dwordx4 v[180:183], v65, s[72:75], s61 offen offset:1024 sc1
    v_add_f32 v70, v70, v106
    v_add_f32 v71, v71, v107
    v_mfma_f32_16x16x32_bf16 a[8:11], a[176:179], v[92:95], a[8:11]
    buffer_load_dwordx4 v18, s[28:31], s57 offen offset:2048 nt lds
    v_add_f32 v63, v63, v112
    v_fma_f32 v64, v104, v108, v64
    s_waitcnt lgkmcnt(2)
    v_mfma_f32_16x16x32_bf16 a[0:3], a[148:151], v[96:99], a[0:3]
    v_add_f32 v63, v63, v113
    v_fma_f32 v64, v105, v109, v64
    v_mfma_f32_16x16x32_bf16 a[4:7], a[164:167], v[96:99], a[4:7]
    v_add_f32 v63, v63, v114
    v_fma_f32 v64, v106, v110, v64
    v_mfma_f32_16x16x32_bf16 a[8:11], a[180:183], v[96:99], a[8:11]
    buffer_load_dwordx4 v19, s[28:31], s57 offen offset:3072 nt lds
    v_add_f32 v63, v63, v115
    v_fma_f32 v64, v107, v111, v64
    s_waitcnt lgkmcnt(1)
    v_mfma_f32_16x16x32_bf16 a[0:3], a[152:155], v[100:103], a[0:3]
    v_mfma_f32_16x16x32_bf16 a[4:7], a[168:171], v[100:103], a[4:7]
    v_mfma_f32_16x16x32_bf16 a[8:11], a[184:187], v[100:103], a[8:11]
    s_waitcnt lgkmcnt(0)
    v_mfma_f32_16x16x32_bf16 a[0:3], a[156:159], v[116:119], a[0:3]
    v_mfma_f32_16x16x32_bf16 a[4:7], a[172:175], v[116:119], a[4:7]
    v_mfma_f32_16x16x32_bf16 a[8:11], a[188:191], v[116:119], a[8:11]
    s_add_u32 m0, s40, 4096
    s_nop 0
    buffer_load_dwordx4 v20, s[28:31], s57 offen offset:0 nt lds
    buffer_load_dwordx4 v[184:187], v65, s[72:75], s61 offen offset:2048 sc1
    buffer_load_dwordx4 v21, s[28:31], s57 offen offset:1024 nt lds
    s_add_u32 m0, s41, 0
    s_add_u32 s58, s37, 75497472
    buffer_load_dwordx4 v224, s[24:27], s58 offen offset:0 nt lds
    buffer_load_dwordx4 v[188:191], v65, s[72:75], s61 offen offset:3072 sc1
    s_waitcnt vmcnt(11)
    s_barrier
    ds_read_b128 a[96:99], v40 offset:49152
    ds_read_b128 a[100:103], v41 offset:49152
    ds_read_b128 a[104:107], v42 offset:49152
    ds_read_b128 a[108:111], v43 offset:49152
    ds_read_b128 a[112:115], v40 offset:49408
    ds_read_b128 a[116:119], v41 offset:49408
    ds_read_b128 a[120:123], v42 offset:49408
    ds_read_b128 a[124:127], v43 offset:49408
    ds_read_b128 a[128:131], v40 offset:49664
    ds_read_b128 a[132:135], v41 offset:49664
    ds_read_b128 a[136:139], v42 offset:49664
    ds_read_b128 a[140:143], v43 offset:49664
    s_waitcnt lgkmcnt(11)
    v_mfma_f32_16x16x32_bf16 v[96:99], a[96:99], a[96:99], v[84:87]
    buffer_load_dwordx4 v225, s[24:27], s58 offen offset:1024 nt lds
    ds_read_b64_tr_b16 a[144:145], v44 offset:0
    ds_read_b64_tr_b16 a[146:147], v45 offset:0
    v_mfma_f32_16x16x32_bf16 v[100:103], a[96:99], a[48:51], 0
    ds_read_b64_tr_b16 a[148:149], v44 offset:12288
    ds_read_b64_tr_b16 a[150:151], v45 offset:12288
    s_waitcnt lgkmcnt(14)
    v_mfma_f32_16x16x32_bf16 v[96:99], a[100:103], a[100:103], v[96:99]
    ds_read_b64_tr_b16 a[152:153], v44 offset:24576
    ds_read_b64_tr_b16 a[154:155], v45 offset:24576
    v_mfma_f32_16x16x32_bf16 v[100:103], a[100:103], a[52:55], v[100:103]
    ds_read_b64_tr_b16 a[156:157], v44 offset:36864
    ds_read_b64_tr_b16 a[158:159], v45 offset:36864
    s_waitcnt lgkmcnt(15)
    v_mfma_f32_16x16x32_bf16 v[96:99], a[104:107], a[104:107], v[96:99]
    ds_read_b64_tr_b16 a[160:161], v46 offset:0
    ds_read_b64_tr_b16 a[162:163], v47 offset:0
    v_mfma_f32_16x16x32_bf16 v[100:103], a[104:107], a[56:59], v[100:103]
    s_add_u32 m0, s41, 2048
    s_add_u32 s58, s37, 75497600
    buffer_load_dwordx4 v224, s[24:27], s58 offen offset:0 nt lds
    ds_read_b64_tr_b16 a[164:165], v46 offset:12288
    ds_read_b64_tr_b16 a[166:167], v47 offset:12288
    v_mfma_f32_16x16x32_bf16 v[96:99], a[108:111], a[108:111], v[96:99]
    ds_read_b64_tr_b16 a[168:169], v46 offset:24576
    ds_read_b64_tr_b16 a[170:171], v47 offset:24576
    v_mfma_f32_16x16x32_bf16 v[100:103], a[108:111], a[60:63], v[100:103]
    ds_read_b64_tr_b16 a[172:173], v46 offset:36864
    ds_read_b64_tr_b16 a[174:175], v47 offset:36864
    v_mfma_f32_16x16x32_bf16 v[96:99], a[112:115], a[112:115], v[96:99]
    ds_read_b64_tr_b16 a[176:177], v48 offset:0
    ds_read_b64_tr_b16 a[178:179], v49 offset:0
    v_mfma_f32_16x16x32_bf16 v[100:103], a[112:115], a[64:67], v[100:103]
    ds_read_b64_tr_b16 a[180:181], v48 offset:12288
    ds_read_b64_tr_b16 a[182:183], v49 offset:12288
    s_waitcnt lgkmcnt(15)
    v_mfma_f32_16x16x32_bf16 v[96:99], a[116:119], a[116:119], v[96:99]
    ds_read_b64_tr_b16 a[184:185], v48 offset:24576
    ds_read_b64_tr_b16 a[186:187], v49 offset:24576
    v_mfma_f32_16x16x32_bf16 v[100:103], a[116:119], a[68:71], v[100:103]
    ds_read_b64_tr_b16 a[188:189], v48 offset:36864
    ds_read_b64_tr_b16 a[190:191], v49 offset:36864
    v_mfma_f32_16x16x32_bf16 v[92:95], a[96:99], v[52:55], v[80:83]
    v_mfma_f32_16x16x32_bf16 v[92:95], a[100:103], v[52:55], v[92:95]
    v_mfma_f32_16x16x32_bf16 v[92:95], a[104:107], v[52:55], v[92:95]
    v_mfma_f32_16x16x32_bf16 v[92:95], a[108:111], v[52:55], v[92:95]
    s_nop 1
    v_fma_f32 v96, v100, 2.0, v96
    v_fma_f32 v97, v101, 2.0, v97
    v_mfma_f32_16x16x32_bf16 v[92:95], a[112:115], v[52:55], v[92:95]
    buffer_load_dwordx4 v225, s[24:27], s58 offen offset:1024 nt lds
    v_fma_f32 v98, v102, 2.0, v98
    v_fma_f32 v99, v103, 2.0, v99
    v_mfma_f32_16x16x32_bf16 v[92:95], a[116:119], v[52:55], v[92:95]
    s_add_u32 s61, s60, 3153920
    buffer_load_dwordx4 v[192:195], v65, s[72:75], s61 offen offset:0 sc1
    v_cndmask_b32 v3, 0, v96, s[44:45]
    v_cndmask_b32 v3, v3, v97, s[46:47]
    v_mfma_f32_16x16x32_bf16 v[88:91], a[96:99], v[136:139], v[76:79]
    v_cndmask_b32 v3, v3, v98, s[48:49]
    v_cndmask_b32 v3, v3, v99, s[50:51]
    v_mfma_f32_16x16x32_bf16 v[88:91], a[100:103], v[140:143], v[88:91]
    s_nop 0
    s_nop 0
    v_mfma_f32_16x16x32_bf16 v[88:91], a[104:107], v[144:147], v[88:91]
    v_mfma_f32_16x16x4_f32 v[120:123], v3, v60, v[56:59]
    v_mfma_f32_16x16x32_bf16 v[88:91], a[108:111], v[148:151], v[88:91]
    v_mfma_f32_16x16x32_bf16 v[88:91], a[112:115], v[152:155], v[88:91]
    v_mfma_f32_16x16x32_bf16 v[88:91], a[116:119], v[156:159], v[88:91]
    v_mfma_f32_16x16x32_bf16 v[112:115], a[120:123], a[120:123], v[84:87]
    v_mfma_f32_16x16x32_bf16 v[116:119], a[120:123], a[48:51], 0
    v_mfma_f32_16x16x32_bf16 v[112:115], a[124:127], a[124:127], v[112:115]
    s_add_u32 m0, s41, 4096
    s_add_u32 s58, s37, 75497728
    buffer_load_dwordx4 v224, s[24:27], s58 offen offset:0 nt lds
    v_mfma_f32_16x16x32_bf16 v[116:119], a[124:127], a[52:55], v[116:119]
    v_fma_f32 v128, -v92, v92, v120
    v_fma_f32 v129, -v93, v93, v121
    v_mfma_f32_16x16x32_bf16 v[112:115], a[128:131], a[128:131], v[112:115]
    v_fma_f32 v130, -v94, v94, v122
    v_fma_f32 v131, -v95, v95, v123
    v_mfma_f32_16x16x32_bf16 v[116:119], a[128:131], a[56:59], v[116:119]
    v_max_f32 v128, v128, v56
    v_max_f32 v129, v129, v56
    v_mfma_f32_16x16x32_bf16 v[112:115], a[132:135], a[132:135], v[112:115]
    v_max_f32 v130, v130, v56
    v_max_f32 v131, v131, v56
    v_mfma_f32_16x16x32_bf16 v[116:119], a[132:135], a[60:63], v[116:119]
    v_rsq_f32 v128, v128
    v_mfma_f32_16x16x32_bf16 v[112:115], a[136:139], a[136:139], v[112:115]
    v_rsq_f32 v129, v129
    v_mfma_f32_16x16x32_bf16 v[116:119], a[136:139], a[64:67], v[116:119]
    v_rsq_f32 v130, v130
    v_mfma_f32_16x16x32_bf16 v[112:115], a[140:143], a[140:143], v[112:115]
    v_rsq_f32 v131, v131
    v_mfma_f32_16x16x32_bf16 v[116:119], a[140:143], a[68:71], v[116:119]
    v_fma_f32 v88, -v92, v61, v88
    v_fma_f32 v89, -v93, v61, v89
    v_mfma_f32_16x16x32_bf16 v[108:111], a[120:123], v[52:55], v[80:83]
    v_fma_f32 v90, -v94, v61, v90
    v_fma_f32 v91, -v95, v61, v91
    v_mfma_f32_16x16x32_bf16 v[108:111], a[124:127], v[52:55], v[108:111]
    v_fma_f32 v88, v88, v128, v62
    v_fma_f32 v89, v89, v129, v62
    v_mfma_f32_16x16x32_bf16 v[108:111], a[128:131], v[52:55], v[108:111]
    v_fma_f32 v90, v90, v130, v62
    v_fma_f32 v91, v91, v131, v62
    v_mfma_f32_16x16x32_bf16 v[108:111], a[132:135], v[52:55], v[108:111]
    buffer_load_dwordx4 v225, s[24:27], s58 offen offset:1024 nt lds
    v_max3_f32 v1, v88, v89, v90
    v_max_f32 v1, v1, v91
    v_mfma_f32_16x16x32_bf16 v[108:111], a[136:139], v[52:55], v[108:111]
    v_cmp_lt_f32 vcc, s52, v1
    s_cbranch_vccnz L_site8
L_back8:
    v_mfma_f32_16x16x32_bf16 v[108:111], a[140:143], v[52:55], v[108:111]
    v_exp_f32 v96, v88
    v_mfma_f32_16x16x32_bf16 v[104:107], a[120:123], v[136:139], v[76:79]
    v_exp_f32 v97, v89
    v_mfma_f32_16x16x32_bf16 v[104:107], a[124:127], v[140:143], v[104:107]
    v_exp_f32 v98, v90
    v_mfma_f32_16x16x32_bf16 v[104:107], a[128:131], v[144:147], v[104:107]
    v_exp_f32 v99, v91
    v_mfma_f32_16x16x32_bf16 v[104:107], a[132:135], v[148:151], v[104:107]
    v_mul_f32 v88, v96, v128
    v_mul_f32 v89, v97, v129
    v_mfma_f32_16x16x32_bf16 v[104:107], a[136:139], v[152:155], v[104:107]
    v_mul_f32 v90, v98, v130
    v_mul_f32 v91, v99, v131
    v_mfma_f32_16x16x32_bf16 v[104:107], a[140:143], v[156:159], v[104:107]
    v_fma_f32 v112, v116, 2.0, v112
    v_fma_f32 v113, v117, 2.0, v113
    v_fma_f32 v114, v118, 2.0, v114
    v_fma_f32 v115, v119, 2.0, v115
    v_cndmask_b32 v4, 0, v112, s[44:45]
    v_cndmask_b32 v4, v4, v113, s[46:47]
    v_cndmask_b32 v4, v4, v114, s[48:49]
    v_cndmask_b32 v4, v4, v115, s[50:51]
    v_add_f32 v63, v63, v96
    v_fmac_f32 v64, v88, v92
    v_mfma_f32_16x16x4_f32 v[124:127], v4, v60, v[56:59]
    v_add_f32 v63, v63, v97
    v_fmac_f32 v64, v89, v93
    v_add_f32 v63, v63, v98
    v_fmac_f32 v64, v90, v94
    v_add_f32 v63, v63, v99
    v_fmac_f32 v64, v91, v95
    v_add_f32 v68, v68, v88
    v_add_f32 v69, v69, v89
    v_add_f32 v70, v70, v90
    v_add_f32 v71, v71, v91
    v_add_u32 v44, -49152, v44
    v_add_u32 v45, -49152, v45
    v_add_u32 v46, -49152, v46
    v_add_u32 v47, -49152, v47
    v_add_u32 v48, -49152, v48
    v_add_u32 v49, -49152, v49
    v_fma_f32 v132, -v108, v108, v124
    v_fma_f32 v133, -v109, v109, v125
    v_fma_f32 v134, -v110, v110, v126
    v_fma_f32 v135, -v111, v111, v127
    v_max_f32 v132, v132, v56
    v_max_f32 v133, v133, v56
    v_max_f32 v134, v134, v56
    v_max_f32 v135, v135, v56
    v_rsq_f32 v132, v132
    v_rsq_f32 v133, v133
    v_rsq_f32 v134, v134
    v_rsq_f32 v135, v135
    buffer_load_dwordx4 v[196:199], v65, s[72:75], s61 offen offset:1024 sc1
    v_fma_f32 v104, -v108, v61, v104
    v_fma_f32 v105, -v109, v61, v105
    v_fma_f32 v106, -v110, v61, v106
    v_fma_f32 v107, -v111, v61, v107
    v_fma_f32 v104, v104, v132, v62
    v_fma_f32 v105, v105, v133, v62
    v_fma_f32 v106, v106, v134, v62
    v_fma_f32 v107, v107, v135, v62
    v_max3_f32 v1, v104, v105, v106
    v_max_f32 v1, v1, v107
    v_cmp_lt_f32 vcc, s52, v1
    s_cbranch_vccnz L_site9
L_back9:
    s_add_u32 m0, s41, 6144
    s_add_u32 s58, s37, 75497856
    buffer_load_dwordx4 v224, s[24:27], s58 offen offset:0 nt lds
    v_exp_f32 v112, v104
    v_exp_f32 v113, v105
    v_exp_f32 v114, v106
    v_exp_f32 v115, v107
    v_cvt_pk_bf16_f32 v72, v88, v89
    v_cvt_pk_bf16_f32 v73, v90, v91
    v_mul_f32 v104, v112, v132
    v_mul_f32 v105, v113, v133
    v_mul_f32 v106, v114, v134
    v_mul_f32 v107, v115, v135
    v_cvt_pk_bf16_f32 v74, v104, v105
    v_cvt_pk_bf16_f32 v75, v106, v107
    ds_write_b128 v237, v[72:75] offset:0
    v_add_f32 v68, v68, v104
    v_add_f32 v69, v69, v105
    v_add_f32 v70, v70, v106
    v_add_f32 v71, v71, v107
    v_cvt_pk_bf16_f32 v66, v68, v69
    v_cvt_pk_bf16_f32 v67, v70, v71
    ds_write_b64 v238, v[66:67]
    s_lshl_b32 s56, s3, 13
    v_lshl_add_u32 v233, v0, 7, s56
    v_min_u32 v233, L_hot - L_tail, v233
    v_add_u32 v233, L_tail - L_pc_main, v233
    global_load_dword v234, v233, s[100:101]
    s_waitcnt vmcnt(11)
    s_waitcnt lgkmcnt(0)
    s_barrier
L_post9:
    ds_read_b32 v9, v254 offset:4096
    ds_read_b64 v[120:121], v254 offset:0
    ds_read_b64 v[122:123], v254 offset:512
    ds_read_b64 v[124:125], v254 offset:1024
    ds_read_b64 v[126:127], v254 offset:1536
    ds_read_b128 v[92:95], v253 offset:0
    ds_read_b128 v[96:99], v253 offset:1024
    ds_read_b128 v[100:103], v253 offset:2048
    ds_read_b128 v[116:119], v253 offset:3072
    ds_read_b128 a[48:51], v34 offset:0
    ds_read_b128 a[52:55], v35 offset:0
    ds_read_b128 a[56:59], v34 offset:128
    ds_read_b128 a[60:63], v35 offset:128
    ds_read_b128 a[64:67], v34 offset:256
    ds_read_b128 a[68:71], v35 offset:256
    s_waitcnt lgkmcnt(14)
    v_cmp_ne_u32 vcc, 0, v9
    s_cbranch_vccnz L_xt9
    s_waitcnt lgkmcnt(12)
    v_mfma_f32_16x16x32_bf16 a[0:3], a[72:75], v[120:123], a[0:3]
    buffer_load_dwordx4 v225, s[24:27], s58 offen offset:1024 nt lds
    v_add_f32 v63, v63, v112
    v_fma_f32 v64, v104, v108, v64
    v_mfma_f32_16x16x32_bf16 a[4:7], a[80:83], v[120:123], a[4:7]
    s_add_u32 m0, s41, 8192
    s_add_u32 s58, s37, 75497984
    buffer_load_dwordx4 v224, s[24:27], s58 offen offset:0 nt lds
    v_add_f32 v63, v63, v113
    v_fma_f32 v64, v105, v109, v64
    v_mfma_f32_16x16x32_bf16 a[8:11], a[88:91], v[120:123], a[8:11]
    v_add_f32 v63, v63, v114
    v_fma_f32 v64, v106, v110, v64
    s_waitcnt lgkmcnt(10)
    v_mfma_f32_16x16x32_bf16 a[0:3], a[76:79], v[124:127], a[0:3]
    v_add_f32 v63, v63, v115
    v_fma_f32 v64, v107, v111, v64
    v_mfma_f32_16x16x32_bf16 a[4:7], a[84:87], v[124:127], a[4:7]
    v_mfma_f32_16x16x32_bf16 a[8:11], a[92:95], v[124:127], a[8:11]
    buffer_load_dwordx4 v[200:203], v65, s[72:75], s61 offen offset:2048 sc1
    s_waitcnt lgkmcnt(9)
    v_mfma_f32_16x16x32_bf16 a[0:3], a[144:147], v[92:95], a[0:3]
    ds_read_b64_tr_b16 a[72:73], v36 offset:0
    ds_read_b64_tr_b16 a[74:75], v36 offset:6144
    v_mfma_f32_16x16x32_bf16 a[4:7], a[160:163], v[92:95], a[4:7]
    ds_read_b64_tr_b16 a[76:77], v36 offset:12288
    ds_read_b64_tr_b16 a[78:79], v36 offset:18432
    v_mfma_f32_16x16x32_bf16 a[8:11], a[176:179], v[92:95], a[8:11]
    ds_read_b64_tr_b16 a[80:81], v37 offset:0
    ds_read_b64_tr_b16 a[82:83], v37 offset:6144
    s_waitcnt lgkmcnt(14)
    v_mfma_f32_16x16x32_bf16 a[0:3], a[148:151], v[96:99], a[0:3]
    ds_read_b64_tr_b16 a[84:85], v37 offset:12288
    ds_read_b64_tr_b16 a[86:87], v37 offset:18432
    v_mfma_f32_16x16x32_bf16 a[4:7], a[164:167], v[96:99], a[4:7]
    ds_read_b64_tr_b16 a[88:89], v38 offset:0
    ds_read_b64_tr_b16 a[90:91], v38 offset:6144
    v_mfma_f32_16x16x32_bf16 a[8:11], a[180:183], v[96:99], a[8:11]
    ds_read_b64_tr_b16 a[92:93], v38 offset:12288
    ds_read_b64_tr_b16 a[94:95], v38 offset:18432
    s_waitcnt lgkmcnt(15)
    v_mfma_f32_16x16x32_bf16 a[0:3], a[152:155], v[100:103], a[0:3]
    v_mfma_f32_16x16x32_bf16 a[4:7], a[168:171], v[100:103], a[4:7]
    v_mfma_f32_16x16x32_bf16 a[8:11], a[184:187], v[100:103], a[8:11]
    v_mfma_f32_16x16x32_bf16 a[0:3], a[156:159], v[116:119], a[0:3]
    v_mfma_f32_16x16x32_bf16 a[4:7], a[172:175], v[116:119], a[4:7]
    v_mfma_f32_16x16x32_bf16 a[8:11], a[188:191], v[116:119], a[8:11]
    buffer_load_dwordx4 v225, s[24:27], s58 offen offset:1024 nt lds
    v_mfma_f32_16x16x32_bf16 v[84:87], a[48:51], a[48:51], 0
    v_mfma_f32_16x16x32_bf16 v[80:83], a[48:51], v[52:55], 0
    v_mfma_f32_16x16x32_bf16 v[84:87], a[52:55], a[52:55], v[84:87]
    v_mfma_f32_16x16x32_bf16 v[80:83], a[52:55], v[52:55], v[80:83]
    v_mfma_f32_16x16x32_bf16 v[84:87], a[56:59], a[56:59], v[84:87]
    v_mfma_f32_16x16x32_bf16 v[80:83], a[56:59], v[52:55], v[80:83]
    s_waitcnt lgkmcnt(14)
    v_mfma_f32_16x16x32_bf16 v[84:87], a[60:63], a[60:63], v[84:87]
    v_mfma_f32_16x16x32_bf16 v[80:83], a[60:63], v[52:55], v[80:83]
    s_waitcnt lgkmcnt(13)
    v_mfma_f32_16x16x32_bf16 v[84:87], a[64:67], a[64:67], v[84:87]
    v_mfma_f32_16x16x32_bf16 v[80:83], a[64:67], v[52:55], v[80:83]
    s_waitcnt lgkmcnt(12)
    v_mfma_f32_16x16x32_bf16 v[84:87], a[68:71], a[68:71], v[84:87]
    v_mfma_f32_16x16x32_bf16 v[80:83], a[68:71], v[52:55], v[80:83]
    s_waitcnt lgkmcnt(0)
    v_mfma_f32_16x16x32_bf16 v[76:79], a[48:51], v[136:139], 0
    v_mfma_f32_16x16x32_bf16 v[76:79], a[52:55], v[140:143], v[76:79]
    s_add_u32 m0, s41, 10240
    s_add_u32 s58, s37, 75498112
    buffer_load_dwordx4 v224, s[24:27], s58 offen offset:0 nt lds
    v_mfma_f32_16x16x32_bf16 v[76:79], a[56:59], v[144:147], v[76:79]
    buffer_load_dwordx4 v[204:207], v65, s[72:75], s61 offen offset:3072 sc1
    v_mfma_f32_16x16x32_bf16 v[76:79], a[60:63], v[148:151], v[76:79]
    v_mfma_f32_16x16x32_bf16 v[76:79], a[64:67], v[152:155], v[76:79]
    v_mfma_f32_16x16x32_bf16 v[76:79], a[68:71], v[156:159], v[76:79]
    s_mul_i32 s28, s3, 262144
    s_and_b32 s56, s2, 7
    s_lshl_b32 s56, s56, 10
    s_add_u32 s28, s28, s56
    s_bfe_u32 s56, s2, 0x30003
    s_lshl_b32 s56, s56, 7
    s_add_u32 s28, s28, s56
    s_lshr_b32 s56, s2, 6
    s_lshl_b32 s56, s56, 14
    s_add_u32 s28, s28, s56
    s_add_u32 s28, s28, 8388608
    v_lshrrev_b32 v1, 3, v0
    s_xor_b32 s56, s1, s3
    v_xor_b32 v1, s56, v1
    v_and_b32 v1, 1, v1
    v_lshl_or_b32 v242, v1, 13, v242
    s_sub_u32 s29, s2, 64
    s_lshr_b32 s29, s29, 4
    s_and_b32 s56, s2, 7
    s_lshl3_add_u32 s29, s29, s56
    s_mul_i32 s30, s29, 65536
    s_lshl_b32 s56, s3, 14
    s_add_u32 s30, s30, s56
    s_add_u32 s30, s30, 8388608
    s_lshr_b32 s56, s29, 5
    s_xor_b32 s56, s56, s1
    s_lshr_b32 s57, s29, 2
    s_xor_b32 s56, s56, s57
    s_and_b32 s56, s56, 1
    s_lshl_b32 s56, s56, 13
    s_add_u32 s30, s30, s56
    s_add_u32 s31, s30, 4096
    v_mov_b32 v28, v242
    v_bfe_u32 v1, v0, 4, 1
    v_mul_u32_u24 v2, 65536, v1
    v_mul_u32_u24 v1, 0x10, v1
    v_xor_b32 v242, v242, v1
    v_sub_u32 v242, v242, v2
    v_add_u32 v243, 65536, v242
    s_bfe_u32 s56, s2, 0x10003
    s_lshl_b32 s56, s56, 6
    v_lshrrev_b32 v1, 2, v0
    v_and_b32 v2, 48, v65
    v_lshl_add_u32 v1, v1, 7, v2
    v_add_u32 v29, s56, v1
    v_mov_b32 v232, 0x53800000
    s_mov_b32 s43, 1
    s_mov_b32 s68, s18
    s_mov_b32 s69, s19
    s_mov_b32 s70, 6144
    s_mov_b32 s71, 0x20000
L_tail:
    v_and_b32 v1, 15, v0
    v_lshlrev_b32 v1, 8, v1
    v_sub_u32 v1, v34, v1
    v_lshrrev_b32 v2, 2, v0
    v_lshlrev_b32 v2, 8, v2
    s_sub_u32 s56, s41, s40
    v_add_u32 v40, s56, v1
    v_xor_b32 v41, 64, v40
    s_sub_u32 s56, s42, s40
    v_add_u32 v42, s56, v1
    v_xor_b32 v43, 64, v42
    s_mul_i32 s56, s3, 3
    s_add_u32 s57, s56, 0
    s_lshr_b32 s57, s57, 2
    s_mul_i32 s57, s57, 1920
    s_add_u32 s57, s57, 24576
    v_sub_u32 v44, v36, v2
    v_add_u32 v44, s57, v44
    v_add_u32 v47, 49152, v44
    s_add_u32 s57, s56, 1
    s_lshr_b32 s57, s57, 2
    s_mul_i32 s57, s57, 1920
    s_add_u32 s57, s57, 24576
    v_sub_u32 v45, v37, v2
    v_add_u32 v45, s57, v45
    v_add_u32 v48, 49152, v45
    s_add_u32 s57, s56, 2
    s_lshr_b32 s57, s57, 2
    s_mul_i32 s57, s57, 1920
    s_add_u32 s57, s57, 24576
    v_sub_u32 v46, v38, v2
    v_add_u32 v46, s57, v46
    v_add_u32 v49, 49152, v46
    v_accvgpr_read_b32 v16, a0
    v_accvgpr_read_b32 v17, a1
    v_accvgpr_read_b32 v18, a2
    v_accvgpr_read_b32 v19, a3
    v_accvgpr_read_b32 v20, a4
    v_accvgpr_read_b32 v21, a5
    v_accvgpr_read_b32 v22, a6
    v_accvgpr_read_b32 v23, a7
    v_accvgpr_read_b32 v24, a8
    v_accvgpr_read_b32 v25, a9
    v_accvgpr_read_b32 v26, a10
    v_accvgpr_read_b32 v27, a11
    buffer_load_dwordx4 v225, s[24:27], s58 offen offset:1024 nt lds
    s_add_u32 m0, s42, 0
    s_add_u32 s59, s37, 75694080
    buffer_load_dwordx4 v224, s[24:27], s59 offen offset:0 nt lds
    buffer_load_dwordx4 v225, s[24:27], s59 offen offset:1024 nt lds
    s_waitcnt vmcnt(12)
    s_barrier
    ds_read_b128 a[96:99], v40 offset:0
    ds_read_b128 a[100:103], v41 offset:0
    ds_read_b128 a[104:107], v40 offset:2048
    ds_read_b128 a[108:111], v41 offset:2048
    ds_read_b128 a[112:115], v40 offset:4096
    ds_read_b128 a[116:119], v41 offset:4096
    s_waitcnt lgkmcnt(5)
    v_mfma_f32_16x16x32_bf16 v[96:99], a[96:99], a[96:99], v[84:87]
    s_add_u32 m0, s42, 2048
    s_add_u32 s59, s37, 75694208
    buffer_load_dwordx4 v224, s[24:27], s59 offen offset:0 nt lds
    ds_read_b64_tr_b16 a[144:145], v44 offset:0
    ds_read_b64_tr_b16 a[148:149], v44 offset:12288
    v_mfma_f32_16x16x32_bf16 v[100:103], a[96:99], a[48:51], 0
    buffer_load_dwordx4 v225, s[24:27], s59 offen offset:1024 nt lds
    ds_read_b64_tr_b16 a[152:153], v44 offset:24576
    ds_read_b64_tr_b16 a[156:157], v44 offset:36864
    s_waitcnt lgkmcnt(8)
    v_mfma_f32_16x16x32_bf16 v[96:99], a[100:103], a[100:103], v[96:99]
    ds_read_b64_tr_b16 a[160:161], v45 offset:0
    ds_read_b64_tr_b16 a[164:165], v45 offset:12288
    v_mfma_f32_16x16x32_bf16 v[100:103], a[100:103], a[52:55], v[100:103]
    ds_read_b64_tr_b16 a[168:169], v45 offset:24576
    ds_read_b64_tr_b16 a[172:173], v45 offset:36864
    s_waitcnt lgkmcnt(11)
    v_mfma_f32_16x16x32_bf16 v[96:99], a[104:107], a[104:107], v[96:99]
    ds_read_b64_tr_b16 a[176:177], v46 offset:0
    ds_read_b64_tr_b16 a[180:181], v46 offset:12288
    v_mfma_f32_16x16x32_bf16 v[100:103], a[104:107], a[56:59], v[100:103]
    ds_read_b64_tr_b16 a[184:185], v46 offset:24576
    ds_read_b64_tr_b16 a[188:189], v46 offset:36864
    s_waitcnt lgkmcnt(14)
    v_mfma_f32_16x16x32_bf16 v[96:99], a[108:111], a[108:111], v[96:99]
    s_add_u32 m0, s42, 4096
    s_add_u32 s59, s37, 75694336
    buffer_load_dwordx4 v224, s[24:27], s59 offen offset:0 nt lds
    v_mfma_f32_16x16x32_bf16 v[100:103], a[108:111], a[60:63], v[100:103]
    s_waitcnt lgkmcnt(13)
    v_mfma_f32_16x16x32_bf16 v[96:99], a[112:115], a[112:115], v[96:99]
    v_mfma_f32_16x16x32_bf16 v[100:103], a[112:115], a[64:67], v[100:103]
    s_waitcnt lgkmcnt(12)
    v_mfma_f32_16x16x32_bf16 v[96:99], a[116:119], a[116:119], v[96:99]
    v_mfma_f32_16x16x32_bf16 v[100:103], a[116:119], a[68:71], v[100:103]
    v_mfma_f32_16x16x32_bf16 v[92:95], a[96:99], v[52:55], v[80:83]
    v_mfma_f32_16x16x32_bf16 v[92:95], a[100:103], v[52:55], v[92:95]
    v_mfma_f32_16x16x32_bf16 v[92:95], a[104:107], v[52:55], v[92:95]
    v_mfma_f32_16x16x32_bf16 v[92:95], a[108:111], v[52:55], v[92:95]
    s_nop 3
    v_fma_f32 v96, v100, 2.0, v96
    v_fma_f32 v97, v101, 2.0, v97
    v_mfma_f32_16x16x32_bf16 v[92:95], a[112:115], v[52:55], v[92:95]
    v_fma_f32 v98, v102, 2.0, v98
    v_fma_f32 v99, v103, 2.0, v99
    v_mfma_f32_16x16x32_bf16 v[92:95], a[116:119], v[52:55], v[92:95]
    v_cndmask_b32 v3, 0, v96, s[44:45]
    v_cndmask_b32 v3, v3, v97, s[46:47]
    v_mfma_f32_16x16x32_bf16 v[88:91], a[96:99], v[136:139], v[76:79]
    v_cndmask_b32 v3, v3, v98, s[48:49]
    v_cndmask_b32 v3, v3, v99, s[50:51]
    v_mfma_f32_16x16x32_bf16 v[88:91], a[100:103], v[140:143], v[88:91]
    buffer_load_dwordx4 v225, s[24:27], s59 offen offset:1024 nt lds
    s_nop 0
    s_nop 0
    v_mfma_f32_16x16x32_bf16 v[88:91], a[104:107], v[144:147], v[88:91]
    s_add_u32 m0, s42, 6144
    s_add_u32 s59, s37, 75694464
    buffer_load_dwordx4 v224, s[24:27], s59 offen offset:0 nt lds
    v_mfma_f32_16x16x4_f32 v[120:123], v3, v60, v[56:59]
    v_mfma_f32_16x16x32_bf16 v[88:91], a[108:111], v[148:151], v[88:91]
    v_mfma_f32_16x16x32_bf16 v[88:91], a[112:115], v[152:155], v[88:91]
    v_mfma_f32_16x16x32_bf16 v[88:91], a[116:119], v[156:159], v[88:91]
    s_nop 6
    v_fma_f32 v128, -v92, v92, v120
    v_fma_f32 v129, -v93, v93, v121
    v_fma_f32 v130, -v94, v94, v122
    v_fma_f32 v131, -v95, v95, v123
    v_max_f32 v128, v128, v56
    v_max_f32 v129, v129, v56
    v_max_f32 v130, v130, v56
    v_max_f32 v131, v131, v56
    v_rsq_f32 v128, v128
    v_rsq_f32 v129, v129
    v_rsq_f32 v130, v130
    v_rsq_f32 v131, v131
    v_fma_f32 v88, -v92, v61, v88
    v_fma_f32 v89, -v93, v61, v89
    v_fma_f32 v90, -v94, v61, v90
    v_fma_f32 v91, -v95, v61, v91
    v_fma_f32 v88, v88, v128, v62
    v_fma_f32 v89, v89, v129, v62
    buffer_load_dwordx4 v225, s[24:27], s59 offen offset:1024 nt lds
    v_fma_f32 v90, v90, v130, v62
    v_fma_f32 v91, v91, v131, v62
    v_max3_f32 v1, v88, v89, v90
    v_max_f32 v1, v1, v91
    v_cmp_lt_f32 vcc, s52, v1
    s_cbranch_vccnz L_site10
L_back10:
    v_exp_f32 v96, v88
    v_exp_f32 v97, v89
    v_exp_f32 v98, v90
    v_exp_f32 v99, v91
    v_mul_f32 v88, v96, v128
    v_mul_f32 v89, v97, v129
    v_mul_f32 v90, v98, v130
    v_mul_f32 v91, v99, v131
    v_add_f32 v63, v63, v96
    v_fmac_f32 v64, v88, v92
    v_add_f32 v63, v63, v97
    v_fmac_f32 v64, v89, v93
    v_add_f32 v63, v63, v98
    v_fmac_f32 v64, v90, v94
    v_add_f32 v63, v63, v99
    v_fmac_f32 v64, v91, v95
    v_mov_b32 v68, v88
    v_mov_b32 v69, v89
    v_mov_b32 v70, v90
    v_mov_b32 v71, v91
    s_waitcnt vmcnt(14)
    ds_read_b128 a[120:123], v40 offset:6144
    ds_read_b128 a[124:127], v41 offset:6144
    s_waitcnt lgkmcnt(1)
    v_mfma_f32_16x16x32_bf16 v[112:115], a[120:123], a[120:123], v[84:87]
    s_add_u32 m0, s42, 8192
    s_add_u32 s59, s37, 75694592
    buffer_load_dwordx4 v224, s[24:27], s59 offen offset:0 nt lds
    v_mfma_f32_16x16x32_bf16 v[116:119], a[120:123], a[48:51], 0
    buffer_load_dwordx4 v225, s[24:27], s59 offen offset:1024 nt lds
    s_waitcnt lgkmcnt(0)
    v_mfma_f32_16x16x32_bf16 v[112:115], a[124:127], a[124:127], v[112:115]
    v_mfma_f32_16x16x32_bf16 v[116:119], a[124:127], a[52:55], v[116:119]
    v_mfma_f32_16x16x32_bf16 v[108:111], a[120:123], v[52:55], v[80:83]
    v_mfma_f32_16x16x32_bf16 v[104:107], a[120:123], v[136:139], v[76:79]
    s_waitcnt vmcnt(13)
    ds_read_b128 a[128:131], v40 offset:8192
    ds_read_b128 a[132:135], v41 offset:8192
    v_mfma_f32_16x16x32_bf16 v[108:111], a[124:127], v[52:55], v[108:111]
    v_mfma_f32_16x16x32_bf16 v[104:107], a[124:127], v[140:143], v[104:107]
    s_waitcnt lgkmcnt(1)
    v_mfma_f32_16x16x32_bf16 v[112:115], a[128:131], a[128:131], v[112:115]
    v_mfma_f32_16x16x32_bf16 v[116:119], a[128:131], a[56:59], v[116:119]
    s_waitcnt lgkmcnt(0)
    v_mfma_f32_16x16x32_bf16 v[112:115], a[132:135], a[132:135], v[112:115]
    v_mfma_f32_16x16x32_bf16 v[116:119], a[132:135], a[60:63], v[116:119]
    v_mfma_f32_16x16x32_bf16 v[108:111], a[128:131], v[52:55], v[108:111]
    s_add_u32 m0, s42, 10240
    s_add_u32 s59, s37, 75694720
    buffer_load_dwordx4 v224, s[24:27], s59 offen offset:0 nt lds
    v_mfma_f32_16x16x32_bf16 v[104:107], a[128:131], v[144:147], v[104:107]
    buffer_load_dwordx4 v225, s[24:27], s59 offen offset:1024 nt lds
    s_waitcnt vmcnt(12)
    ds_read_b128 a[136:139], v40 offset:10240
    ds_read_b128 a[140:143], v41 offset:10240
    s_barrier
    s_add_u32 s61, s60, 3158016
    buffer_load_dwordx4 v[208:211], v65, s[32:35], s61 offen offset:0 sc1
    v_mfma_f32_16x16x32_bf16 v[108:111], a[132:135], v[52:55], v[108:111]
    ds_read_b64_tr_b16 a[146:147], v44 offset:6144
    v_mfma_f32_16x16x32_bf16 v[104:107], a[132:135], v[148:151], v[104:107]
    ds_read_b64_tr_b16 a[150:151], v44 offset:18432
    s_waitcnt lgkmcnt(3)
    v_mfma_f32_16x16x32_bf16 v[112:115], a[136:139], a[136:139], v[112:115]
    ds_read_b64_tr_b16 a[154:155], v44 offset:30720
    v_mfma_f32_16x16x32_bf16 v[116:119], a[136:139], a[64:67], v[116:119]
    ds_read_b64_tr_b16 a[158:159], v44 offset:43008
    s_waitcnt lgkmcnt(4)
    v_mfma_f32_16x16x32_bf16 v[112:115], a[140:143], a[140:143], v[112:115]
    ds_read_b64_tr_b16 a[162:163], v45 offset:6144
    v_mfma_f32_16x16x32_bf16 v[116:119], a[140:143], a[68:71], v[116:119]
    ds_read_b64_tr_b16 a[166:167], v45 offset:18432
    v_mfma_f32_16x16x32_bf16 v[108:111], a[136:139], v[52:55], v[108:111]
    ds_read_b64_tr_b16 a[170:171], v45 offset:30720
    v_mfma_f32_16x16x32_bf16 v[108:111], a[140:143], v[52:55], v[108:111]
    ds_read_b64_tr_b16 a[174:175], v45 offset:43008
    s_nop 2
    v_fma_f32 v112, v116, 2.0, v112
    v_fma_f32 v113, v117, 2.0, v113
    v_fma_f32 v114, v118, 2.0, v114
    v_fma_f32 v115, v119, 2.0, v115
    v_cndmask_b32 v4, 0, v112, s[44:45]
    v_cndmask_b32 v4, v4, v113, s[46:47]
    v_cndmask_b32 v4, v4, v114, s[48:49]
    v_cndmask_b32 v4, v4, v115, s[50:51]
    ds_read_b64_tr_b16 a[178:179], v46 offset:6144
    ds_read_b64_tr_b16 a[182:183], v46 offset:18432
    v_mfma_f32_16x16x4_f32 v[124:127], v4, v60, v[56:59]
    ds_read_b64_tr_b16 a[186:187], v46 offset:30720
    ds_read_b64_tr_b16 a[190:191], v46 offset:43008
    buffer_load_dwordx4 v[212:215], v65, s[32:35], s61 offen offset:1024 sc1
    s_nop 5
    v_mfma_f32_16x16x32_bf16 v[104:107], a[136:139], v[152:155], v[104:107]
    v_fma_f32 v132, -v108, v108, v124
    v_fma_f32 v133, -v109, v109, v125
    v_mfma_f32_16x16x32_bf16 v[104:107], a[140:143], v[156:159], v[104:107]
    v_fma_f32 v134, -v110, v110, v126
    v_fma_f32 v135, -v111, v111, v127
    v_max_f32 v132, v132, v56
    v_max_f32 v133, v133, v56
    v_max_f32 v134, v134, v56
    v_max_f32 v135, v135, v56
    v_rsq_f32 v132, v132
    v_rsq_f32 v133, v133
    v_rsq_f32 v134, v134
    v_rsq_f32 v135, v135
    v_pk_fma_f32 v[104:105], v[108:109], v[60:61], v[104:105] op_sel:[0,1,0] neg_lo:[1,0,0] neg_hi:[1,0,0]
    v_pk_fma_f32 v[106:107], v[110:111], v[60:61], v[106:107] op_sel:[0,1,0] neg_lo:[1,0,0] neg_hi:[1,0,0]
    v_pk_fma_f32 v[104:105], v[104:105], v[132:133], v[62:63] op_sel_hi:[1,1,0]
    v_pk_fma_f32 v[106:107], v[106:107], v[134:135], v[62:63] op_sel_hi:[1,1,0]
L_back11:
    v_max3_f32 v1, v104, v105, v106
    v_max_f32 v1, v1, v107
    v_cmp_lt_f32 vcc, s52, v1
    v_exp_f32 v112, v104
    v_exp_f32 v113, v105
    v_exp_f32 v114, v106
    v_exp_f32 v115, v107
    s_cbranch_vccnz L_site11
    v_cvt_pk_bf16_f32 v72, v88, v89
    v_cvt_pk_bf16_f32 v73, v90, v91
    v_pk_mul_f32 v[104:105], v[112:113], v[132:133]
    v_pk_mul_f32 v[106:107], v[114:115], v[134:135]
    v_cvt_pk_bf16_f32 v74, v104, v105
    v_cvt_pk_bf16_f32 v75, v106, v107
    ds_write_b128 v237, v[72:75] offset:12288
    s_waitcnt lgkmcnt(0)
    s_barrier
    ds_read_b32 v9, v254 offset:4100
    ds_read_b128 a[192:195], v253 offset:12288
    ds_read_b128 a[196:199], v253 offset:13312
    ds_read_b128 a[200:203], v253 offset:14336
    ds_read_b128 a[204:207], v253 offset:15360
    buffer_load_dwordx4 v[216:219], v65, s[32:35], s61 offen offset:2048 sc1
    s_waitcnt lgkmcnt(4)
    v_cmp_ne_u32 vcc, 0, v9
    s_cbranch_vccnz L_xt11
L_post11:
    s_waitcnt lgkmcnt(3)
    v_mfma_f32_16x16x32_bf16 v[16:19], a[144:147], a[192:195], v[16:19]
    v_add_f32 v68, v68, v104
    v_add_f32 v69, v69, v105
    v_mfma_f32_16x16x32_bf16 v[20:23], a[160:163], a[192:195], v[20:23]
    v_add_f32 v70, v70, v106
    v_add_f32 v71, v71, v107
    v_mfma_f32_16x16x32_bf16 v[24:27], a[176:179], a[192:195], v[24:27]
    v_add_f32 v63, v63, v112
    v_fma_f32 v64, v104, v108, v64
    s_waitcnt lgkmcnt(2)
    v_mfma_f32_16x16x32_bf16 v[16:19], a[148:151], a[196:199], v[16:19]
    s_waitcnt vmcnt(13)
    ds_read_b128 a[96:99], v42 offset:0
    ds_read_b128 a[100:103], v43 offset:0
    v_mfma_f32_16x16x32_bf16 v[20:23], a[164:167], a[196:199], v[20:23]
    v_add_f32 v63, v63, v113
    v_fma_f32 v64, v105, v109, v64
    v_mfma_f32_16x16x32_bf16 v[24:27], a[180:183], a[196:199], v[24:27]
    v_add_f32 v63, v63, v114
    v_fma_f32 v64, v106, v110, v64
    s_waitcnt lgkmcnt(3)
    v_mfma_f32_16x16x32_bf16 v[16:19], a[152:155], a[200:203], v[16:19]
    v_add_f32 v63, v63, v115
    v_fma_f32 v64, v107, v111, v64
    v_mfma_f32_16x16x32_bf16 v[20:23], a[168:171], a[200:203], v[20:23]
    s_waitcnt vmcnt(11)
    ds_read_b128 a[104:107], v42 offset:2048
    ds_read_b128 a[108:111], v43 offset:2048
    v_mfma_f32_16x16x32_bf16 v[24:27], a[184:187], a[200:203], v[24:27]
    s_waitcnt lgkmcnt(4)
    v_mfma_f32_16x16x32_bf16 v[16:19], a[156:159], a[204:207], v[16:19]
    v_mfma_f32_16x16x32_bf16 v[20:23], a[172:175], a[204:207], v[20:23]
    v_mfma_f32_16x16x32_bf16 v[24:27], a[188:191], a[204:207], v[24:27]
    s_waitcnt lgkmcnt(3)
    v_mfma_f32_16x16x32_bf16 v[96:99], a[96:99], a[96:99], v[84:87]
    v_mfma_f32_16x16x32_bf16 v[100:103], a[96:99], a[48:51], 0
    s_waitcnt lgkmcnt(2)
    v_mfma_f32_16x16x32_bf16 v[96:99], a[100:103], a[100:103], v[96:99]
    v_mfma_f32_16x16x32_bf16 v[100:103], a[100:103], a[52:55], v[100:103]
    s_waitcnt vmcnt(9)
    ds_read_b128 a[112:115], v42 offset:4096
    ds_read_b128 a[116:119], v43 offset:4096
    s_barrier
    v_mfma_f32_16x16x32_bf16 v[92:95], a[96:99], v[52:55], v[80:83]
    buffer_load_dwordx4 v[220:223], v65, s[32:35], s61 offen offset:3072 sc1
    ds_read_b64_tr_b16 a[0:1], v47 offset:0
    v_mfma_f32_16x16x32_bf16 v[88:91], a[96:99], v[136:139], v[76:79]
    ds_read_b64_tr_b16 a[4:5], v47 offset:12288
    v_mfma_f32_16x16x32_bf16 v[92:95], a[100:103], v[52:55], v[92:95]
    ds_read_b64_tr_b16 a[8:9], v47 offset:24576
    v_mfma_f32_16x16x32_bf16 v[88:91], a[100:103], v[140:143], v[88:91]
    ds_read_b64_tr_b16 a[12:13], v47 offset:36864
    s_waitcnt lgkmcnt(7)
    v_mfma_f32_16x16x32_bf16 v[96:99], a[104:107], a[104:107], v[96:99]
    ds_read_b64_tr_b16 a[16:17], v48 offset:0
    v_mfma_f32_16x16x32_bf16 v[100:103], a[104:107], a[56:59], v[100:103]
    ds_read_b64_tr_b16 a[20:21], v48 offset:12288
    s_waitcnt lgkmcnt(8)
    v_mfma_f32_16x16x32_bf16 v[96:99], a[108:111], a[108:111], v[96:99]
    ds_read_b64_tr_b16 a[24:25], v48 offset:24576
    v_mfma_f32_16x16x32_bf16 v[100:103], a[108:111], a[60:63], v[100:103]
    ds_read_b64_tr_b16 a[28:29], v48 offset:36864
    v_mfma_f32_16x16x32_bf16 v[92:95], a[104:107], v[52:55], v[92:95]
    ds_read_b64_tr_b16 a[32:33], v49 offset:0
    v_mfma_f32_16x16x32_bf16 v[88:91], a[104:107], v[144:147], v[88:91]
    ds_read_b64_tr_b16 a[36:37], v49 offset:12288
    v_mfma_f32_16x16x32_bf16 v[92:95], a[108:111], v[52:55], v[92:95]
    ds_read_b64_tr_b16 a[40:41], v49 offset:24576
    v_mfma_f32_16x16x32_bf16 v[88:91], a[108:111], v[148:151], v[88:91]
    ds_read_b64_tr_b16 a[44:45], v49 offset:36864
    s_waitcnt lgkmcnt(13)
    v_mfma_f32_16x16x32_bf16 v[96:99], a[112:115], a[112:115], v[96:99]
    v_mfma_f32_16x16x32_bf16 v[100:103], a[112:115], a[64:67], v[100:103]
    s_waitcnt lgkmcnt(12)
    v_mfma_f32_16x16x32_bf16 v[96:99], a[116:119], a[116:119], v[96:99]
    v_mfma_f32_16x16x32_bf16 v[100:103], a[116:119], a[68:71], v[100:103]
    s_waitcnt vmcnt(8)
    ds_read_b128 a[120:123], v42 offset:6144
    ds_read_b128 a[124:127], v43 offset:6144
    v_mfma_f32_16x16x32_bf16 v[92:95], a[112:115], v[52:55], v[92:95]
    v_mfma_f32_16x16x32_bf16 v[92:95], a[116:119], v[52:55], v[92:95]
    s_nop 2
    v_fma_f32 v96, v100, 2.0, v96
    v_fma_f32 v97, v101, 2.0, v97
    v_mfma_f32_16x16x32_bf16 v[88:91], a[112:115], v[152:155], v[88:91]
    v_fma_f32 v98, v102, 2.0, v98
    v_fma_f32 v99, v103, 2.0, v99
    v_mfma_f32_16x16x32_bf16 v[88:91], a[116:119], v[156:159], v[88:91]
    v_cndmask_b32 v3, 0, v96, s[44:45]
    v_cndmask_b32 v3, v3, v97, s[46:47]
    v_cndmask_b32 v3, v3, v98, s[48:49]
    v_cndmask_b32 v3, v3, v99, s[50:51]
    s_nop 0
    s_nop 0
    v_mfma_f32_16x16x4_f32 v[120:123], v3, v60, v[56:59]
    s_waitcnt lgkmcnt(1)
    v_mfma_f32_16x16x32_bf16 v[112:115], a[120:123], a[120:123], v[84:87]
    v_mfma_f32_16x16x32_bf16 v[116:119], a[120:123], a[48:51], 0
    s_waitcnt vmcnt(6)
    ds_read_b128 a[128:131], v42 offset:8192
    ds_read_b128 a[132:135], v43 offset:8192
    s_add_u32 s61, s60, 3162112
    buffer_load_dwordx4 v[224:227], v65, s[32:35], s61 offen offset:0 sc1
    s_waitcnt lgkmcnt(2)
    v_mfma_f32_16x16x32_bf16 v[112:115], a[124:127], a[124:127], v[112:115]
    v_fma_f32 v128, -v92, v92, v120
    v_fma_f32 v129, -v93, v93, v121
    v_fma_f32 v130, -v94, v94, v122
    v_mfma_f32_16x16x32_bf16 v[116:119], a[124:127], a[52:55], v[116:119]
    v_fma_f32 v131, -v95, v95, v123
    v_max_f32 v128, v128, v56
    v_max_f32 v129, v129, v56
    v_mfma_f32_16x16x32_bf16 v[108:111], a[120:123], v[52:55], v[80:83]
    v_max_f32 v130, v130, v56
    v_max_f32 v131, v131, v56
    v_mfma_f32_16x16x32_bf16 v[104:107], a[120:123], v[136:139], v[76:79]
    v_rsq_f32 v128, v128
    v_mfma_f32_16x16x32_bf16 v[108:111], a[124:127], v[52:55], v[108:111]
    v_rsq_f32 v129, v129
    v_mfma_f32_16x16x32_bf16 v[104:107], a[124:127], v[140:143], v[104:107]
    v_rsq_f32 v130, v130
    s_waitcnt lgkmcnt(1)
    v_mfma_f32_16x16x32_bf16 v[112:115], a[128:131], a[128:131], v[112:115]
    v_rsq_f32 v131, v131
    v_fma_f32 v88, -v92, v61, v88
    v_mfma_f32_16x16x32_bf16 v[116:119], a[128:131], a[56:59], v[116:119]
    v_fma_f32 v89, -v93, v61, v89
    v_fma_f32 v90, -v94, v61, v90
    v_fma_f32 v91, -v95, v61, v91
    s_waitcnt lgkmcnt(0)
    v_mfma_f32_16x16x32_bf16 v[112:115], a[132:135], a[132:135], v[112:115]
    v_fma_f32 v88, v88, v128, v62
    v_fma_f32 v89, v89, v129, v62
    v_fma_f32 v90, v90, v130, v62
    v_mfma_f32_16x16x32_bf16 v[116:119], a[132:135], a[60:63], v[116:119]
    v_fma_f32 v91, v91, v131, v62
    v_max3_f32 v1, v88, v89, v90
    v_max_f32 v1, v1, v91
    v_mfma_f32_16x16x32_bf16 v[108:111], a[128:131], v[52:55], v[108:111]
    v_cmp_lt_f32 vcc, s52, v1
    s_cbranch_vccnz L_site12
L_back12:
    v_mfma_f32_16x16x32_bf16 v[104:107], a[128:131], v[144:147], v[104:107]
    s_waitcnt vmcnt(5)
    ds_read_b128 a[136:139], v42 offset:10240
    ds_read_b128 a[140:143], v43 offset:10240
    s_barrier
    buffer_load_dwordx4 v[228:231], v65, s[32:35], s61 offen offset:1024 sc1
    s_cmp_eq_u32 s0, 1
    s_cbranch_scc0 L_nolate
    s_add_u32 s56, s60, 3145728
    buffer_load_dwordx4 v[160:163], v65, s[32:35], s56 offen offset:0 sc1
    buffer_load_dwordx4 v[164:167], v65, s[32:35], s56 offen offset:1024 sc1
    buffer_load_dwordx4 v[168:171], v65, s[32:35], s56 offen offset:2048 sc1
    buffer_load_dwordx4 v[172:175], v65, s[32:35], s56 offen offset:3072 sc1
    s_add_u32 s56, s60, 3149824
    buffer_load_dwordx4 v[176:179], v65, s[32:35], s56 offen offset:0 sc1
    buffer_load_dwordx4 v[180:183], v65, s[32:35], s56 offen offset:1024 sc1
    buffer_load_dwordx4 v[184:187], v65, s[32:35], s56 offen offset:2048 sc1
    buffer_load_dwordx4 v[188:191], v65, s[32:35], s56 offen offset:3072 sc1
    s_add_u32 s56, s60, 3153920
    buffer_load_dwordx4 v[192:195], v65, s[32:35], s56 offen offset:0 sc1
    buffer_load_dwordx4 v[196:199], v65, s[32:35], s56 offen offset:1024 sc1
    buffer_load_dwordx4 v[200:203], v65, s[32:35], s56 offen offset:2048 sc1
    buffer_load_dwordx4 v[204:207], v65, s[32:35], s56 offen offset:3072 sc1
L_nolate:
    buffer_load_dword v244, v28, s[32:35], s28 offen
    v_mfma_f32_16x16x32_bf16 v[108:111], a[132:135], v[52:55], v[108:111]
    ds_read_b64_tr_b16 a[2:3], v47 offset:6144
    v_exp_f32 v96, v88
    v_mfma_f32_16x16x32_bf16 v[104:107], a[132:135], v[148:151], v[104:107]
    ds_read_b64_tr_b16 a[6:7], v47 offset:18432
    v_exp_f32 v97, v89
    s_waitcnt lgkmcnt(3)
    v_mfma_f32_16x16x32_bf16 v[112:115], a[136:139], a[136:139], v[112:115]
    ds_read_b64_tr_b16 a[10:11], v47 offset:30720
    v_exp_f32 v98, v90
    v_mfma_f32_16x16x32_bf16 v[116:119], a[136:139], a[64:67], v[116:119]
    ds_read_b64_tr_b16 a[14:15], v47 offset:43008
    v_exp_f32 v99, v91
    s_waitcnt lgkmcnt(4)
    v_mfma_f32_16x16x32_bf16 v[112:115], a[140:143], a[140:143], v[112:115]
    ds_read_b64_tr_b16 a[18:19], v48 offset:6144
    v_mul_f32 v88, v96, v128
    v_mul_f32 v89, v97, v129
    v_mfma_f32_16x16x32_bf16 v[116:119], a[140:143], a[68:71], v[116:119]
    ds_read_b64_tr_b16 a[22:23], v48 offset:18432
    v_mul_f32 v90, v98, v130
    v_mul_f32 v91, v99, v131
    v_mfma_f32_16x16x32_bf16 v[108:111], a[136:139], v[52:55], v[108:111]
    ds_read_b64_tr_b16 a[26:27], v48 offset:30720
    v_add_f32 v63, v63, v96
    v_fmac_f32 v64, v88, v92
    v_mfma_f32_16x16x32_bf16 v[108:111], a[140:143], v[52:55], v[108:111]
    ds_read_b64_tr_b16 a[30:31], v48 offset:43008
    v_add_f32 v63, v63, v97
    v_fmac_f32 v64, v89, v93
    v_add_f32 v63, v63, v98
    v_fma_f32 v112, v116, 2.0, v112
    v_fma_f32 v113, v117, 2.0, v113
    v_fma_f32 v114, v118, 2.0, v114
    v_fma_f32 v115, v119, 2.0, v115
    v_cndmask_b32 v4, 0, v112, s[44:45]
    v_cndmask_b32 v4, v4, v113, s[46:47]
    v_cndmask_b32 v4, v4, v114, s[48:49]
    v_cndmask_b32 v4, v4, v115, s[50:51]
    ds_read_b64_tr_b16 a[34:35], v49 offset:6144
    ds_read_b64_tr_b16 a[38:39], v49 offset:18432
    v_mfma_f32_16x16x4_f32 v[124:127], v4, v60, v[56:59]
    ds_read_b64_tr_b16 a[42:43], v49 offset:30720
    ds_read_b64_tr_b16 a[46:47], v49 offset:43008
    v_fmac_f32 v64, v90, v94
    v_add_f32 v63, v63, v99
    v_fmac_f32 v64, v91, v95
    v_add_f32 v68, v68, v88
    v_add_f32 v69, v69, v89
    v_add_f32 v70, v70, v90
    v_add_f32 v71, v71, v91
    v_mfma_f32_16x16x32_bf16 v[104:107], a[136:139], v[152:155], v[104:107]
    v_cvt_pk_bf16_f32 v72, v88, v89
    v_cvt_pk_bf16_f32 v73, v90, v91
    v_mfma_f32_16x16x32_bf16 v[104:107], a[140:143], v[156:159], v[104:107]
    v_fma_f32 v132, -v108, v108, v124
    v_fma_f32 v133, -v109, v109, v125
    v_fma_f32 v134, -v110, v110, v126
    v_fma_f32 v135, -v111, v111, v127
    v_max_f32 v132, v132, v56
    v_max_f32 v133, v133, v56
    v_max_f32 v134, v134, v56
    v_max_f32 v135, v135, v56
    v_rsq_f32 v132, v132
    v_rsq_f32 v133, v133
    v_rsq_f32 v134, v134
    v_rsq_f32 v135, v135
    v_pk_fma_f32 v[104:105], v[108:109], v[60:61], v[104:105] op_sel:[0,1,0] neg_lo:[1,0,0] neg_hi:[1,0,0]
    v_pk_fma_f32 v[106:107], v[110:111], v[60:61], v[106:107] op_sel:[0,1,0] neg_lo:[1,0,0] neg_hi:[1,0,0]
    v_pk_fma_f32 v[104:105], v[104:105], v[132:133], v[62:63] op_sel_hi:[1,1,0]
    v_pk_fma_f32 v[106:107], v[106:107], v[134:135], v[62:63] op_sel_hi:[1,1,0]
L_back13:
    v_max3_f32 v1, v104, v105, v106
    v_max_f32 v1, v1, v107
    v_cmp_lt_f32 vcc, s52, v1
    v_exp_f32 v112, v104
    v_exp_f32 v113, v105
    v_exp_f32 v114, v106
    v_exp_f32 v115, v107
    s_cbranch_vccnz L_site13
    v_pk_mul_f32 v[104:105], v[112:113], v[132:133]
    v_pk_mul_f32 v[106:107], v[114:115], v[134:135]
    v_cvt_pk_bf16_f32 v74, v104, v105
    v_cvt_pk_bf16_f32 v75, v106, v107
    ds_write_b128 v237, v[72:75] offset:0
    v_pk_add_f32 v[68:69], v[68:69], v[104:105]
    v_pk_add_f32 v[70:71], v[70:71], v[106:107]
    v_pk_add_f32 v[112:113], v[112:113], v[114:115]
    v_cvt_pk_bf16_f32 v66, v68, v69
    v_cvt_pk_bf16_f32 v67, v70, v71
    ds_write_b64 v238, v[66:67]
    v_pk_mul_f32 v[114:115], v[104:105], v[108:109]
    v_add_f32 v63, v63, v112
    v_pk_fma_f32 v[114:115], v[106:107], v[110:111], v[114:115]
    v_add_f32 v10, v63, v113
    v_add_f32 v64, v64, v114
    v_add_f32 v11, v64, v115
    ds_write_b64 v238, v[10:11] offset:2048
L_merge:
    s_waitcnt lgkmcnt(0)
    s_barrier
L_postx:
    ds_read_b32 v9, v254 offset:4096
    ds_read_b128 v[92:95], v253 offset:0
    ds_read_b128 v[96:99], v253 offset:1024
    ds_read_b128 v[100:103], v253 offset:2048
    ds_read_b64 v[136:137], v254 offset:2048
    ds_read_b64 v[138:139], v254 offset:2560
    ds_read_b64 v[140:141], v254 offset:3072
    ds_read_b64 v[142:143], v254 offset:3584
    ds_read_b128 v[116:119], v253 offset:3072
    ds_read_b64 v[120:121], v254 offset:0
    ds_read_b64 v[122:123], v254 offset:512
    s_waitcnt lgkmcnt(10)
    v_cmp_ne_u32 vcc, 0, v9
    s_cbranch_vccnz L_xlast
    s_waitcnt lgkmcnt(9)
    v_mfma_f32_16x16x32_bf16 v[16:19], a[0:3], v[92:95], v[16:19]
    ds_read_b64 v[124:125], v254 offset:1024
    v_mfma_f32_16x16x32_bf16 v[20:23], a[16:19], v[92:95], v[20:23]
    ds_read_b64 v[126:127], v254 offset:1536
    v_mfma_f32_16x16x32_bf16 v[24:27], a[32:35], v[92:95], v[24:27]
    s_waitcnt lgkmcnt(10)
    v_mfma_f32_16x16x32_bf16 v[16:19], a[4:7], v[96:99], v[16:19]
    v_mfma_f32_16x16x32_bf16 v[20:23], a[20:23], v[96:99], v[20:23]
    v_mfma_f32_16x16x32_bf16 v[24:27], a[36:39], v[96:99], v[24:27]
    s_waitcnt lgkmcnt(9)
    v_mfma_f32_16x16x32_bf16 v[16:19], a[8:11], v[100:103], v[16:19]
    s_waitcnt lgkmcnt(5)
    v_add_f32 v1, v136, v138
    v_add_f32 v2, v137, v139
    v_add_f32 v140, v140, v142
    v_mfma_f32_16x16x32_bf16 v[20:23], a[24:27], v[100:103], v[20:23]
    v_add_f32 v141, v141, v143
    v_add_f32 v1, v1, v140
    v_add_f32 v2, v2, v141
    v_mfma_f32_16x16x32_bf16 v[24:27], a[40:43], v[100:103], v[24:27]
    s_nop 0
    v_permlane32_swap_b32 v1, v2
    v_add_f32 v1, v1, v2
    v_mov_b32 v2, v1
    s_waitcnt lgkmcnt(4)
    v_mfma_f32_16x16x32_bf16 v[16:19], a[12:15], v[116:119], v[16:19]
    v_permlane16_swap_b32 v1, v2
    v_add_f32 v1, v1, v2
    v_mov_b32 v2, v1
    s_waitcnt lgkmcnt(2)
    v_mfma_f32_16x16x32_bf16 v[16:19], a[72:75], v[120:123], v[16:19]
    v_permlane32_swap_b32 v1, v2
    v_rcp_f32 v3, v1
    s_waitcnt lgkmcnt(0)
    v_mfma_f32_16x16x32_bf16 v[16:19], a[76:79], v[124:127], v[16:19]
    v_log_f32 v4, v1
    v_mul_f32 v5, v60, v3
    v_mfma_f32_16x16x32_bf16 v[20:23], a[28:31], v[116:119], v[20:23]
    v_mul_f32 v6, v2, v3
    v_sub_f32 v4, v4, v255
    v_mfma_f32_16x16x32_bf16 v[20:23], a[80:83], v[120:123], v[20:23]
    v_mfma_f32_16x16x32_bf16 v[20:23], a[84:87], v[124:127], v[20:23]
    v_mfma_f32_16x16x32_bf16 v[24:27], a[44:47], v[116:119], v[24:27]
    v_fma_f32 v16, v16, v5, -v6
    v_fma_f32 v17, v17, v5, -v6
    v_mfma_f32_16x16x32_bf16 v[24:27], a[88:91], v[120:123], v[24:27]
    v_fma_f32 v18, v18, v5, -v6
    v_fma_f32 v19, v19, v5, -v6
    v_mfma_f32_16x16x32_bf16 v[24:27], a[92:95], v[124:127], v[24:27]
    v_cvt_pk_bf16_f32 v66, v16, v17
    v_cvt_pk_bf16_f32 v67, v18, v19
    ds_write_b64 v236, v[66:67] offset:0
    v_pk_fma_f32 v[20:21], v[20:21], v[4:5], v[6:7] op_sel:[0,1,0] op_sel_hi:[1,1,0] neg_lo:[0,0,1] neg_hi:[0,0,1]
    v_pk_fma_f32 v[22:23], v[22:23], v[4:5], v[6:7] op_sel:[0,1,0] op_sel_hi:[1,1,0] neg_lo:[0,0,1] neg_hi:[0,0,1]
    v_cvt_pk_bf16_f32 v68, v20, v21
    v_cvt_pk_bf16_f32 v69, v22, v23
    ds_write_b64 v236, v[68:69] offset:512
    v_pk_fma_f32 v[24:25], v[24:25], v[4:5], v[6:7] op_sel:[0,1,0] op_sel_hi:[1,1,0] neg_lo:[0,0,1] neg_hi:[0,0,1]
    v_pk_fma_f32 v[26:27], v[26:27], v[4:5], v[6:7] op_sel:[0,1,0] op_sel_hi:[1,1,0] neg_lo:[0,0,1] neg_hi:[0,0,1]
    v_cvt_pk_bf16_f32 v70, v24, v25
    v_cvt_pk_bf16_f32 v71, v26, v27
    ds_write_b64 v236, v[70:71] offset:1024
    s_waitcnt lgkmcnt(0)
    s_barrier
    ds_read_b128 v[136:139], v241 offset:0
    ds_read_b128 v[140:143], v241 offset:1024
    ds_read_b128 v[144:147], v241 offset:2048
    ds_read_b128 v[148:151], v241 offset:3072
    ds_read_b128 v[152:155], v241 offset:4096
    ds_read_b128 v[156:159], v241 offset:5120
    s_waitcnt vmcnt(1)
    v_subrev_u32 v35, s39, v4
    v_add_u32 v39, s39, v4
    s_waitcnt lgkmcnt(5)
    v_mfma_f32_16x16x32_bf16 v[16:19], v[160:163], v[136:139], 0
    v_mfma_f32_16x16x32_bf16 v[20:23], v[184:187], v[136:139], 0
    v_mfma_f32_16x16x32_bf16 v[24:27], v[208:211], v[136:139], 0
    s_waitcnt lgkmcnt(4)
    v_mfma_f32_16x16x32_bf16 v[16:19], v[164:167], v[140:143], v[16:19]
    v_mfma_f32_16x16x32_bf16 v[20:23], v[188:191], v[140:143], v[20:23]
    v_mfma_f32_16x16x32_bf16 v[24:27], v[212:215], v[140:143], v[24:27]
    s_waitcnt lgkmcnt(3)
    v_mfma_f32_16x16x32_bf16 v[16:19], v[168:171], v[144:147], v[16:19]
    v_mfma_f32_16x16x32_bf16 v[20:23], v[192:195], v[144:147], v[20:23]
    v_mfma_f32_16x16x32_bf16 v[24:27], v[216:219], v[144:147], v[24:27]
    s_waitcnt lgkmcnt(2)
    v_mfma_f32_16x16x32_bf16 v[16:19], v[172:175], v[148:151], v[16:19]
    s_waitcnt lgkmcnt(1)
    v_mfma_f32_16x16x32_bf16 v[16:19], v[176:179], v[152:155], v[16:19]
    s_waitcnt lgkmcnt(0)
    v_mfma_f32_16x16x32_bf16 v[16:19], v[180:183], v[156:159], v[16:19]
    v_mfma_f32_16x16x32_bf16 v[20:23], v[196:199], v[148:151], v[20:23]
    v_mfma_f32_16x16x32_bf16 v[20:23], v[200:203], v[152:155], v[20:23]
    v_mfma_f32_16x16x32_bf16 v[20:23], v[204:207], v[156:159], v[20:23]
    v_mfma_f32_16x16x32_bf16 v[24:27], v[220:223], v[148:151], v[24:27]
    v_mfma_f32_16x16x32_bf16 v[24:27], v[224:227], v[152:155], v[24:27]
    s_nop 2
    v_cvt_pk_bf16_f32 v32, v16, v17
    v_mfma_f32_16x16x32_bf16 v[24:27], v[228:231], v[156:159], v[24:27]
    v_cvt_pk_bf16_f32 v33, v18, v19
    v_cvt_pk_bf16_f32 v34, v20, v21
    v_cvt_pk_bf16_f32 v36, v22, v23
    v_permlane16_swap_b32 v35, v39
    s_nop 0
    v_permlane16_swap_b32 v32, v36
    s_nop 1
    v_cvt_pk_bf16_f32 v37, v24, v25
    v_cvt_pk_bf16_f32 v38, v26, v27
    s_nop 0
    v_permlane16_swap_b32 v33, v37
    v_permlane16_swap_b32 v34, v38
    buffer_store_dwordx4 v[32:35], v242, s[32:35], s28 offen sc1
    buffer_store_dwordx4 v[36:39], v243, s[32:35], s28 offen sc1
    s_cmp_lt_u32 s29, 64
    s_cbranch_scc0 L_fin
    buffer_load_dwordx4 v[76:79], v29, s[32:35], s30 offen offset:0 sc1
    buffer_load_dwordx4 v[80:83], v29, s[32:35], s30 offen offset:2048 sc1
    buffer_load_dwordx4 v[84:87], v29, s[32:35], s31 offen offset:0 sc1
    buffer_load_dwordx4 v[108:111], v29, s[32:35], s31 offen offset:2048 sc1
    ds_bpermute_b32 v42, v252, v4
    v_bfe_u32 v48, v0, 0, 1
    v_cmp_eq_u32 vcc, 1, v48
    v_mov_b32 v246, s39
    s_movk_i32 s26, 0x11
    v_sub_u32 v247, 0, v246
    v_cndmask_b32 v247, v247, v246, vcc
    v_mul_lo_u32 v246, v247, -2
    v_mov_b32 v16, 0
    v_mov_b32 v17, 0
    v_mov_b32 v18, 0
    v_mov_b32 v19, 0
    v_mov_b32 v20, 0
    v_mov_b32 v21, 0
    v_mov_b32 v22, 0
    v_mov_b32 v97, 0
    s_mov_b32 s53, 0
    v_mov_b32 v160, 0x11
    v_mov_b32 v161, 0x22
    v_mov_b32 v162, 0x44
    v_mov_b32 v163, 0x88
    s_waitcnt vmcnt(0)
    v_sub_u32_dpp v136, v79, v79 quad_perm:[1,0,3,2] row_mask:0xf bank_mask:0xf
    v_sub_u32_dpp v137, v83, v83 quad_perm:[1,0,3,2] row_mask:0xf bank_mask:0xf
    v_sub_u32_dpp v138, v87, v87 quad_perm:[1,0,3,2] row_mask:0xf bank_mask:0xf
    v_sub_u32_dpp v139, v111, v111 quad_perm:[1,0,3,2] row_mask:0xf bank_mask:0xf
    v_cmp_eq_u32 s[6:7], v136, v246
    v_cmp_eq_u32 s[8:9], v137, v246
    v_cmp_eq_u32 s[10:11], v138, v246
    v_cmp_eq_u32 s[12:13], v139, v246
    v_cndmask_b32 v136, v160, 0, s[6:7]
    v_cndmask_b32 v137, v161, 0, s[8:9]
    v_cndmask_b32 v138, v162, 0, s[10:11]
    v_cndmask_b32 v139, v163, 0, s[12:13]
    v_or3_b32 v96, v136, v137, v138
    v_or_b32 v96, v96, v139
    v_cmp_ne_u32 vcc, 0, v96
    v_sub_u32 v168, v79, v247
    v_sub_u32 v169, v83, v247
    s_cbranch_vccz L_c_all
    v_lshrrev_b32 v48, v97, v96
    v_ffbl_b32 v48, v48
    v_add_u32 v48, v48, v97
    v_and_b32 v48, 3, v48
    v_lshl_add_u32 v51, v48, 11, v29
    v_lshlrev_b32 v88, v48, s26
    v_add_u32 v97, 1, v48
    s_mov_b64 exec, vcc
    buffer_load_dwordx4 v[136:139], v51, s[32:35], s30 offen sc1
    s_mov_b64 exec, -1
    v_lshrrev_b32 v48, v97, v96
    v_ffbl_b32 v48, v48
    v_add_u32 v48, v48, v97
    v_and_b32 v48, 3, v48
    v_lshl_add_u32 v51, v48, 11, v29
    v_lshlrev_b32 v89, v48, s26
    v_add_u32 v97, 1, v48
    s_mov_b64 exec, vcc
    buffer_load_dwordx4 v[140:143], v51, s[32:35], s30 offen sc1
    s_mov_b64 exec, -1
L_c_all:
    v_sub_u32 v170, v87, v247
    v_sub_u32 v171, v111, v247
    s_waitcnt lgkmcnt(0)
    v_sub_f32 v168, v168, v42
    v_sub_f32 v169, v169, v42
    v_sub_f32 v170, v170, v42
    v_sub_f32 v171, v171, v42
    v_exp_f32 v168, v168
    v_exp_f32 v169, v169
    v_exp_f32 v170, v170
    v_exp_f32 v171, v171
    v_cvt_pk_bf16_f32 v168, v168, 0
    v_cvt_pk_bf16_f32 v169, v169, 0
    v_cvt_pk_bf16_f32 v170, v170, 0
    v_cvt_pk_bf16_f32 v171, v171, 0
    v_lshlrev_b32 v176, 16, v168
    v_lshlrev_b32 v177, 16, v169
    v_lshlrev_b32 v178, 16, v170
    v_lshlrev_b32 v179, 16, v171
    s_mov_b64 exec, s[6:7]
    v_dot2c_f32_bf16 v16, v76, v168
    v_dot2c_f32_bf16 v18, v77, v168
    v_dot2c_f32_bf16 v20, v78, v168
    v_add_f32 v22, v22, v176
    v_dot2c_f32_bf16 v17, v76, v176
    v_dot2c_f32_bf16 v19, v77, v176
    v_dot2c_f32_bf16 v21, v78, v176
    s_mov_b64 exec, s[8:9]
    v_dot2c_f32_bf16 v16, v80, v169
    v_dot2c_f32_bf16 v18, v81, v169
    v_dot2c_f32_bf16 v20, v82, v169
    v_add_f32 v22, v22, v177
    v_dot2c_f32_bf16 v17, v80, v177
    v_dot2c_f32_bf16 v19, v81, v177
    v_dot2c_f32_bf16 v21, v82, v177
    s_mov_b64 exec, s[10:11]
    v_dot2c_f32_bf16 v16, v84, v170
    v_dot2c_f32_bf16 v18, v85, v170
    v_dot2c_f32_bf16 v20, v86, v170
    v_add_f32 v22, v22, v178
    v_dot2c_f32_bf16 v17, v84, v178
    v_dot2c_f32_bf16 v19, v85, v178
    v_dot2c_f32_bf16 v21, v86, v178
    s_mov_b64 exec, s[12:13]
    v_dot2c_f32_bf16 v16, v108, v171
    v_dot2c_f32_bf16 v18, v109, v171
    v_dot2c_f32_bf16 v20, v110, v171
    v_add_f32 v22, v22, v179
    v_dot2c_f32_bf16 v17, v108, v179
    v_dot2c_f32_bf16 v19, v109, v179
    v_dot2c_f32_bf16 v21, v110, v179
    s_mov_b64 exec, -1
    s_cbranch_vccz L_c_red
L_c_loop:
    s_waitcnt vmcnt(1)
    v_sub_u32_dpp v48, v139, v139 quad_perm:[1,0,3,2] row_mask:0xf bank_mask:0xf
    v_and_b32 v49, v88, v96
    v_cmpx_eq_u32 vcc, v48, v246
    v_cmpx_ne_u32 vcc, 0, v49
    v_xor_b32 v96, v96, v88
    v_sub_u32 v49, v139, v247
    v_sub_f32 v49, v49, v42
    v_exp_f32 v49, v49
    s_cbranch_execz L_c_s0
    v_cvt_pk_bf16_f32 v49, v49, 0
    v_lshlrev_b32 v50, 16, v49
    v_dot2c_f32_bf16 v16, v136, v49
    v_dot2c_f32_bf16 v18, v137, v49
    v_dot2c_f32_bf16 v20, v138, v49
    v_add_f32 v22, v22, v50
    v_dot2c_f32_bf16 v17, v136, v50
    v_dot2c_f32_bf16 v19, v137, v50
    v_dot2c_f32_bf16 v21, v138, v50
L_c_s0:
    s_mov_b64 exec, -1
    v_cmp_ne_u32 vcc, 0, v96
    v_lshrrev_b32 v48, v97, v96
    v_ffbl_b32 v48, v48
    s_cbranch_vccz L_c_red
    v_add_u32 v48, v48, v97
    v_and_b32 v48, 3, v48
    v_lshl_add_u32 v51, v48, 11, v29
    v_lshlrev_b32 v88, v48, s26
    v_add_u32 v97, 1, v48
    s_mov_b64 exec, vcc
    buffer_load_dwordx4 v[136:139], v51, s[32:35], s30 offen sc1
    s_mov_b64 exec, -1
    s_waitcnt vmcnt(1)
    v_sub_u32_dpp v48, v143, v143 quad_perm:[1,0,3,2] row_mask:0xf bank_mask:0xf
    v_and_b32 v49, v89, v96
    v_cmpx_eq_u32 vcc, v48, v246
    v_cmpx_ne_u32 vcc, 0, v49
    v_xor_b32 v96, v96, v89
    v_sub_u32 v49, v143, v247
    v_sub_f32 v49, v49, v42
    v_exp_f32 v49, v49
    s_cbranch_execz L_c_s1
    v_cvt_pk_bf16_f32 v49, v49, 0
    v_lshlrev_b32 v50, 16, v49
    v_dot2c_f32_bf16 v16, v140, v49
    v_dot2c_f32_bf16 v18, v141, v49
    v_dot2c_f32_bf16 v20, v142, v49
    v_add_f32 v22, v22, v50
    v_dot2c_f32_bf16 v17, v140, v50
    v_dot2c_f32_bf16 v19, v141, v50
    v_dot2c_f32_bf16 v21, v142, v50
L_c_s1:
    s_mov_b64 exec, -1
    v_cmp_ne_u32 vcc, 0, v96
    v_lshrrev_b32 v48, v97, v96
    v_ffbl_b32 v48, v48
    s_cbranch_vccz L_c_red
    v_add_u32 v48, v48, v97
    v_and_b32 v48, 3, v48
    v_lshl_add_u32 v51, v48, 11, v29
    v_lshlrev_b32 v89, v48, s26
    v_add_u32 v97, 1, v48
    s_mov_b64 exec, vcc
    buffer_load_dwordx4 v[140:143], v51, s[32:35], s30 offen sc1
    s_mov_b64 exec, -1
    s_add_u32 s53, s53, 1
    s_cmp_lt_u32 s53, 65536
    s_cbranch_scc1 L_c_loop
L_c_red:
    v_mov_b32 v23, v22
    v_permlane32_swap_b32 v16, v20
    v_permlane32_swap_b32 v17, v21
    v_permlane32_swap_b32 v18, v22
    v_permlane32_swap_b32 v19, v23
    v_add_f32 v16, v16, v20
    v_add_f32 v17, v17, v21
    v_add_f32 v18, v18, v22
    v_add_f32 v19, v19, v23
    s_nop 0
    v_permlane16_swap_b32 v16, v18
    v_permlane16_swap_b32 v17, v19
    v_add_f32 v16, v16, v18
    v_add_f32 v17, v17, v19
    s_nop 0
    v_add_f32_dpp v48, v16, v16 row_ror:8 row_mask:0xf bank_mask:0x3
    s_nop 1
    v_add_f32_dpp v48, v17, v17 row_ror:8 row_mask:0xf bank_mask:0xc
    s_nop 1
    v_add_f32_dpp v48, v48, v48 row_shr:4 row_mask:0xf bank_mask:0xa
    ds_write_b32 v250, v48
    s_waitcnt lgkmcnt(0)
    s_barrier
    ds_read_b128 v[48:51], v251 offset:768
    ds_read_b128 v[52:55], v65
    v_lshlrev_b32 v18, 16, v249
    s_waitcnt lgkmcnt(1)
    v_add_f32 v48, v48, v49
    v_add_f32 v50, v50, v51
    v_add_f32 v48, v48, v50
    v_cmp_nlt_f32 vcc, v48, v232
    v_rcp_f32 v48, v48
    s_waitcnt lgkmcnt(0)
    s_cbranch_vccnz L_c_slow
L_c_out:
    s_cmp_lg_u32 s3, 0
    s_cbranch_scc1 L_fin
    v_add_f32 v52, v52, v53
    v_add_f32 v54, v54, v55
    v_add_f32 v52, v52, v54
    v_fmac_f32 v18, v52, v48
    v_cvt_pk_bf16_f32 v18, v18, v18
    buffer_store_short v18, v248, s[68:71], 0 offen sc1
    s_cmp_lg_u32 s2, 64
    s_cbranch_scc1 L_fin
    v_mov_b32 v48, s39
    v_mov_b32 v49, 0
    s_mov_b64 exec, 1
    buffer_store_dword v48, v49, s[32:35], 0 offen offset:0 sc1
    s_mov_b64 exec, -1
L_fin:
L_end:
    s_endpgm
L_hot:
L_prod:
    s_cmp_lg_u32 s3, 0
    s_cbranch_scc1 L_p_noq
    s_mov_b32 m0, 147456
    s_nop 0
    buffer_load_dwordx4 v16, s[72:75], 0 offen offset:0  lds
    buffer_load_dwordx4 v17, s[72:75], 0 offen offset:1024  lds
    buffer_load_dwordx4 v18, s[72:75], 0 offen offset:2048  lds
    buffer_load_dwordx4 v19, s[72:75], 0 offen offset:3072  lds
    s_mov_b32 m0, 151552
    s_nop 0
    buffer_load_dwordx4 v20, s[72:75], 0 offen offset:0  lds
    buffer_load_dwordx4 v21, s[72:75], 0 offen offset:1024  lds
L_p_noq:
    s_mul_i32 s60, s3, 18432
    s_add_u32 m0, s60, 73728
    s_nop 0
    buffer_load_dwordx4 v16, s[64:67], s60 offen offset:0  lds
    buffer_load_dwordx4 v17, s[64:67], s60 offen offset:1024  lds
    buffer_load_dwordx4 v18, s[64:67], s60 offen offset:2048  lds
    buffer_load_dwordx4 v19, s[64:67], s60 offen offset:3072  lds
    s_add_u32 m0, s60, 77824
    s_nop 0
    buffer_load_dwordx4 v20, s[64:67], s60 offen offset:0  lds
    buffer_load_dwordx4 v21, s[64:67], s60 offen offset:1024  lds
    s_add_u32 s60, s60, 6144
    s_add_u32 m0, s60, 73728
    s_nop 0
    buffer_load_dwordx4 v16, s[64:67], s60 offen offset:0  lds
    buffer_load_dwordx4 v17, s[64:67], s60 offen offset:1024  lds
    buffer_load_dwordx4 v18, s[64:67], s60 offen offset:2048  lds
    buffer_load_dwordx4 v19, s[64:67], s60 offen offset:3072  lds
    s_add_u32 m0, s60, 77824
    s_nop 0
    buffer_load_dwordx4 v20, s[64:67], s60 offen offset:0  lds
    buffer_load_dwordx4 v21, s[64:67], s60 offen offset:1024  lds
    s_add_u32 s60, s60, 6144
    s_add_u32 m0, s60, 73728
    s_nop 0
    buffer_load_dwordx4 v16, s[64:67], s60 offen offset:0  lds
    v_mov_b32 v52, 0x3f803f80
    v_mov_b32 v56, 0x3ebcbe62
    s_mov_b32 s44, 0x100001
    s_mov_b32 s45, 0x10000100
    v_mov_b32 v53, 0x3f803f80
    v_mov_b32 v57, 0x3ebcbe62
    s_mov_b32 s46, 0x200002
    buffer_load_dwordx4 v17, s[64:67], s60 offen offset:1024  lds
    s_mov_b32 s47, 0x20000200
    v_mov_b32 v54, 0x3f803f80
    v_mov_b32 v58, 0x3ebcbe62
    s_mov_b32 s48, 0x400004
    s_mov_b32 s49, 0x40000400
    v_mov_b32 v55, 0x3f803f80
    v_mov_b32 v59, 0x3ebcbe62
    buffer_load_dwordx4 v18, s[64:67], s60 offen offset:2048  lds
    s_mov_b32 s50, 0x800008
    s_mov_b32 s51, 0x80000800
    v_mov_b32 v60, 0x43400000
    v_lshrrev_b32 v1, 5, v0
    v_lshlrev_b32 v1, 8, v1
    v_and_b32 v2, 15, v0
    v_lshl_add_u32 v1, v2, 4, v1
    buffer_load_dwordx4 v19, s[64:67], s60 offen offset:3072  lds
    v_bfe_u32 v2, v0, 4, 1
    v_lshl_add_u32 v1, v2, 3, v1
    s_mul_i32 s56, s3, 1536
    s_add_u32 s56, s56, 153600
    v_add_u32 v134, s56, v1
    v_bfe_u32 v1, v0, 4, 1
    v_lshrrev_b32 v5, 5, v0
    s_add_u32 m0, s60, 77824
    s_nop 0
    buffer_load_dwordx4 v20, s[64:67], s60 offen offset:0  lds
    v_lshl_or_b32 v1, v1, 1, v5
    v_bfe_u32 v2, v0, 2, 2
    v_lshl_add_u32 v3, v1, 3, v2
    v_mul_u32_u24 v3, 384, v3
    v_and_b32 v4, 1, v0
    v_lshl_add_u32 v3, v4, 3, v3
    v_add_u32 v3, 73728, v3
    buffer_load_dwordx4 v21, s[64:67], s60 offen offset:1024  lds
    v_and_or_b32 v2, v2, 2, v5
    v_bfe_u32 v4, v0, 1, 1
    v_xor_b32 v2, v2, v4
    s_mul_i32 s56, s3, 6
    s_add_u32 s57, s56, 0
    v_xor_b32 v4, s57, v2
    v_lshl_add_u32 v124, v4, 4, v3
    s_lshl_b32 s61, s43, 2
    s_add_u32 s61, s61, s3
    s_mul_i32 s60, s61, 6144
    s_add_u32 m0, s41, 6144
    s_nop 0
    buffer_load_dwordx4 v16, s[68:71], s60 offen offset:0  lds
    v_xor_b32 v125, 64, v124
    s_add_u32 s57, s56, 2
    v_xor_b32 v4, s57, v2
    v_lshl_add_u32 v126, v4, 4, v3
    v_xor_b32 v127, 64, v126
    s_add_u32 s57, s56, 4
    v_xor_b32 v4, s57, v2
    buffer_load_dwordx4 v17, s[68:71], s60 offen offset:1024  lds
    v_lshl_add_u32 v128, v4, 4, v3
    v_xor_b32 v129, 64, v128
    v_and_b32 v2, 15, v0
    v_bfe_u32 v3, v0, 3, 1
    v_and_or_b32 v4, v0, 6, v3
    v_xor_b32 v4, v4, v1
    v_mul_u32_u24 v2, 384, v2
    buffer_load_dwordx4 v18, s[68:71], s60 offen offset:2048  lds
    v_lshl_add_u32 v2, v4, 4, v2
    v_add_u32 v132, 147456, v2
    v_xor_b32 v133, 64, v132
    s_and_b32 s56, s3, 1
    s_lshl_b32 s56, s56, 2
    s_lshr_b32 s57, s3, 1
    s_mul_i32 s57, s57, 24576
    buffer_load_dwordx4 v19, s[68:71], s60 offen offset:3072  lds
    s_add_u32 s57, s57, 30720
    v_and_b32 v1, 11, v0
    v_or_b32 v1, s56, v1
    v_and_or_b32 v2, v1, 6, v3
    v_lshrrev_b32 v3, 4, v0
    v_xor_b32 v2, v2, v3
    v_mul_u32_u24 v1, 384, v1
    s_add_u32 m0, s41, 10240
    s_nop 0
    buffer_load_dwordx4 v20, s[68:71], s60 offen offset:0  lds
    v_lshl_add_u32 v1, v2, 4, v1
    v_bfe_u32 v2, v0, 2, 1
    v_mul_u32_u24 v2, 12288, v2
    v_add3_u32 v130, s57, v1, v2
    v_xor_b32 v131, 64, v130
    v_add_u32 v135, 153600, v65
    buffer_load_dwordx4 v21, s[68:71], s60 offen offset:1024  lds
    s_waitcnt vmcnt(24)
    s_barrier
    s_load_dword s38, s[22:23], 0
    ds_read_b128 v[136:139], v132 offset:0
    ds_read_b128 v[140:143], v133 offset:0
    ds_read_b128 v[144:147], v132 offset:128
    ds_read_b128 v[148:151], v133 offset:128
    ds_read_b128 v[152:155], v132 offset:256
    ds_read_b128 v[156:159], v133 offset:256
    s_add_u32 m0, s40, 0
    s_add_u32 s57, s36, 0
    buffer_load_dwordx4 v16, s[28:31], s57 offen offset:0 nt lds
    buffer_load_dwordx4 v17, s[28:31], s57 offen offset:1024 nt lds
    buffer_load_dwordx4 v18, s[28:31], s57 offen offset:2048 nt lds
    buffer_load_dwordx4 v19, s[28:31], s57 offen offset:3072 nt lds
    s_add_u32 m0, s40, 4096
    s_nop 0
    buffer_load_dwordx4 v20, s[28:31], s57 offen offset:0 nt lds
    buffer_load_dwordx4 v21, s[28:31], s57 offen offset:1024 nt lds
    s_waitcnt lgkmcnt(0)
    v_mfma_f32_16x16x32_bf16 v[112:115], v[136:139], v[136:139], 0
    v_mfma_f32_16x16x32_bf16 v[116:119], v[52:55], v[136:139], 0
    s_add_u32 m0, s41, 0
    s_add_u32 s58, s37, 0
    buffer_load_dwordx4 v22, s[24:27], s58 offen offset:0 nt lds
    v_mfma_f32_16x16x32_bf16 v[112:115], v[140:143], v[140:143], v[112:115]
    v_mfma_f32_16x16x32_bf16 v[116:119], v[52:55], v[140:143], v[116:119]
    buffer_load_dwordx4 v23, s[24:27], s58 offen offset:1024 nt lds
    v_mfma_f32_16x16x32_bf16 v[112:115], v[144:147], v[144:147], v[112:115]
    v_mfma_f32_16x16x32_bf16 v[116:119], v[52:55], v[144:147], v[116:119]
    buffer_load_dwordx4 v24, s[24:27], s58 offen offset:2048 nt lds
    v_mfma_f32_16x16x32_bf16 v[112:115], v[148:151], v[148:151], v[112:115]
    v_mfma_f32_16x16x32_bf16 v[116:119], v[52:55], v[148:151], v[116:119]
    v_mfma_f32_16x16x32_bf16 v[112:115], v[152:155], v[152:155], v[112:115]
    v_mfma_f32_16x16x32_bf16 v[116:119], v[52:55], v[152:155], v[116:119]
    v_mfma_f32_16x16x32_bf16 v[112:115], v[156:159], v[156:159], v[112:115]
    v_mfma_f32_16x16x32_bf16 v[116:119], v[52:55], v[156:159], v[116:119]
    s_mul_i32 s39, s38, 0x9e3779b1
    s_add_u32 s39, s39, 0x7f4a7c16
    s_or_b32 s39, s39, 1
    s_lshl_b32 s61, s61, 10
    s_add_u32 s61, s61, 16384
    s_waitcnt vmcnt(15)
    s_barrier
    ds_read_b64_tr_b16 v[160:161], v124 offset:0
    ds_read_b64_tr_b16 v[162:163], v125 offset:1536
    ds_read_b64_tr_b16 v[184:185], v126 offset:0
    ds_read_b64_tr_b16 v[186:187], v127 offset:1536
    ds_read_b64_tr_b16 v[208:209], v128 offset:0
    ds_read_b64_tr_b16 v[210:211], v129 offset:1536
    ds_read_b64_tr_b16 v[164:165], v124 offset:12288
    ds_read_b64_tr_b16 v[166:167], v125 offset:13824
    ds_read_b64_tr_b16 v[188:189], v126 offset:12288
    ds_read_b64_tr_b16 v[190:191], v127 offset:13824
    ds_read_b64_tr_b16 v[212:213], v128 offset:12288
    ds_read_b64_tr_b16 v[214:215], v129 offset:13824
    v_cndmask_b32 v3, 0, v112, s[44:45]
    v_cndmask_b32 v3, v3, v113, s[46:47]
    v_cndmask_b32 v3, v3, v114, s[48:49]
    v_cndmask_b32 v3, v3, v115, s[50:51]
    v_mul_f32 v6, 0x3baaaaab, v116
    ds_read_b64_tr_b16 v[168:169], v124 offset:24576
    ds_read_b64_tr_b16 v[170:171], v125 offset:26112
    v_mfma_f32_16x16x4_f32 v[120:123], v60, v3, v[56:59]
    s_waitcnt lgkmcnt(12)
    v_mfma_f32_16x16x32_bf16 v[88:91], v[160:163], v[136:139], 0
    ds_read_b64_tr_b16 v[192:193], v126 offset:24576
    v_mfma_f32_16x16x32_bf16 v[100:103], v[160:163], v[52:55], 0
    ds_read_b64_tr_b16 v[194:195], v127 offset:26112
    s_waitcnt lgkmcnt(12)
    v_mfma_f32_16x16x32_bf16 v[92:95], v[184:187], v[136:139], 0
    ds_read_b64_tr_b16 v[216:217], v128 offset:24576
    v_mfma_f32_16x16x32_bf16 v[104:107], v[184:187], v[52:55], 0
    ds_read_b64_tr_b16 v[218:219], v129 offset:26112
    s_waitcnt lgkmcnt(12)
    v_mfma_f32_16x16x32_bf16 v[96:99], v[208:211], v[136:139], 0
    ds_read_b64_tr_b16 v[172:173], v124 offset:36864
    v_mfma_f32_16x16x32_bf16 v[108:111], v[208:211], v[52:55], 0
    ds_read_b64_tr_b16 v[174:175], v125 offset:38400
    s_waitcnt lgkmcnt(12)
    v_mfma_f32_16x16x32_bf16 v[88:91], v[164:167], v[140:143], v[88:91]
    ds_read_b64_tr_b16 v[196:197], v126 offset:36864
    v_mfma_f32_16x16x32_bf16 v[100:103], v[164:167], v[52:55], v[100:103]
    ds_read_b64_tr_b16 v[198:199], v127 offset:38400
    s_waitcnt lgkmcnt(12)
    v_mfma_f32_16x16x32_bf16 v[92:95], v[188:191], v[140:143], v[92:95]
    ds_read_b64_tr_b16 v[220:221], v128 offset:36864
    v_mfma_f32_16x16x32_bf16 v[104:107], v[188:191], v[52:55], v[104:107]
    ds_read_b64_tr_b16 v[222:223], v129 offset:38400
    s_waitcnt lgkmcnt(12)
    v_mfma_f32_16x16x32_bf16 v[96:99], v[212:215], v[140:143], v[96:99]
    ds_read_b64_tr_b16 v[176:177], v124 offset:49152
    v_mfma_f32_16x16x32_bf16 v[108:111], v[212:215], v[52:55], v[108:111]
    ds_read_b64_tr_b16 v[178:179], v125 offset:50688
    s_waitcnt lgkmcnt(12)
    v_mfma_f32_16x16x32_bf16 v[88:91], v[168:171], v[144:147], v[88:91]
    ds_read_b64_tr_b16 v[200:201], v126 offset:49152
    v_mfma_f32_16x16x32_bf16 v[100:103], v[168:171], v[52:55], v[100:103]
    ds_read_b64_tr_b16 v[202:203], v127 offset:50688
    s_waitcnt lgkmcnt(12)
    v_mfma_f32_16x16x32_bf16 v[92:95], v[192:195], v[144:147], v[92:95]
    ds_read_b64_tr_b16 v[224:225], v128 offset:49152
    v_mfma_f32_16x16x32_bf16 v[104:107], v[192:195], v[52:55], v[104:107]
    ds_read_b64_tr_b16 v[226:227], v129 offset:50688
    s_waitcnt lgkmcnt(12)
    v_mfma_f32_16x16x32_bf16 v[96:99], v[216:219], v[144:147], v[96:99]
    ds_read_b64_tr_b16 v[180:181], v124 offset:61440
    v_mfma_f32_16x16x32_bf16 v[108:111], v[216:219], v[52:55], v[108:111]
    ds_read_b64_tr_b16 v[182:183], v125 offset:62976
    s_waitcnt lgkmcnt(12)
    v_mfma_f32_16x16x32_bf16 v[88:91], v[172:175], v[148:151], v[88:91]
    ds_read_b64_tr_b16 v[204:205], v126 offset:61440
    v_mfma_f32_16x16x32_bf16 v[100:103], v[172:175], v[52:55], v[100:103]
    ds_read_b64_tr_b16 v[206:207], v127 offset:62976
    s_waitcnt lgkmcnt(12)
    v_mfma_f32_16x16x32_bf16 v[92:95], v[196:199], v[148:151], v[92:95]
    ds_read_b64_tr_b16 v[228:229], v128 offset:61440
    v_mfma_f32_16x16x32_bf16 v[104:107], v[196:199], v[52:55], v[104:107]
    ds_read_b64_tr_b16 v[230:231], v129 offset:62976
    s_waitcnt lgkmcnt(12)
    v_mfma_f32_16x16x32_bf16 v[96:99], v[220:223], v[148:151], v[96:99]
    v_fma_f32 v5, -v116, v116, v120
    v_mfma_f32_16x16x32_bf16 v[108:111], v[220:223], v[52:55], v[108:111]
    v_max_f32 v5, v5, v56
    s_waitcnt lgkmcnt(10)
    v_mfma_f32_16x16x32_bf16 v[88:91], v[176:179], v[152:155], v[88:91]
    v_rsq_f32 v5, v5
    v_mfma_f32_16x16x32_bf16 v[100:103], v[176:179], v[52:55], v[100:103]
    v_mov_b32 v122, s39
    s_waitcnt lgkmcnt(8)
    v_mfma_f32_16x16x32_bf16 v[92:95], v[200:203], v[152:155], v[92:95]
    v_mul_f32 v5, v60, v5
    v_mfma_f32_16x16x32_bf16 v[104:107], v[200:203], v[52:55], v[104:107]
    v_mov_b32 v123, s39
    s_waitcnt lgkmcnt(6)
    v_mfma_f32_16x16x32_bf16 v[96:99], v[224:227], v[152:155], v[96:99]
    v_mfma_f32_16x16x32_bf16 v[108:111], v[224:227], v[52:55], v[108:111]
    s_waitcnt lgkmcnt(4)
    v_mfma_f32_16x16x32_bf16 v[88:91], v[180:183], v[156:159], v[88:91]
    v_mfma_f32_16x16x32_bf16 v[100:103], v[180:183], v[52:55], v[100:103]
    s_waitcnt lgkmcnt(2)
    v_mfma_f32_16x16x32_bf16 v[92:95], v[204:207], v[156:159], v[92:95]
    v_mfma_f32_16x16x32_bf16 v[104:107], v[204:207], v[52:55], v[104:107]
    s_waitcnt lgkmcnt(0)
    v_mfma_f32_16x16x32_bf16 v[96:99], v[228:231], v[156:159], v[96:99]
    v_mfma_f32_16x16x32_bf16 v[108:111], v[228:231], v[52:55], v[108:111]
    s_nop 1
    v_fma_f32 v88, -v6, v100, v88
    v_fma_f32 v89, -v6, v101, v89
    v_fma_f32 v90, -v6, v102, v90
    v_fma_f32 v91, -v6, v103, v91
    v_mul_f32 v88, v88, v5
    v_mul_f32 v89, v89, v5
    v_mul_f32 v90, v90, v5
    v_mul_f32 v91, v91, v5
    v_cvt_pk_bf16_f32 v112, v88, v89
    v_cvt_pk_bf16_f32 v113, v90, v91
    ds_write_b64 v134, v[112:113] offset:0
    v_fma_f32 v92, -v6, v104, v92
    v_fma_f32 v93, -v6, v105, v93
    v_fma_f32 v94, -v6, v106, v94
    v_fma_f32 v95, -v6, v107, v95
    v_mul_f32 v92, v92, v5
    v_mul_f32 v93, v93, v5
    v_mul_f32 v94, v94, v5
    v_mul_f32 v95, v95, v5
    v_cvt_pk_bf16_f32 v114, v92, v93
    v_cvt_pk_bf16_f32 v115, v94, v95
    ds_write_b64 v134, v[114:115] offset:512
    v_fma_f32 v96, -v6, v108, v96
    v_fma_f32 v97, -v6, v109, v97
    v_fma_f32 v98, -v6, v110, v98
    v_fma_f32 v99, -v6, v111, v99
    v_mul_f32 v96, v96, v5
    v_mul_f32 v97, v97, v5
    v_mul_f32 v98, v98, v5
    v_mul_f32 v99, v99, v5
    v_cvt_pk_bf16_f32 v116, v96, v97
    v_cvt_pk_bf16_f32 v117, v98, v99
    ds_write_b64 v134, v[116:117] offset:1024
    s_waitcnt vmcnt(9)
    s_waitcnt lgkmcnt(0)
    s_barrier
    ds_read_b128 v[136:139], v135 offset:0
    ds_read_b128 a[96:99], v130 offset:0
    ds_read_b128 v[140:143], v135 offset:1024
    ds_read_b128 a[100:103], v131 offset:0
    ds_read_b128 v[144:147], v135 offset:2048
    ds_read_b128 a[104:107], v130 offset:128
    ds_read_b128 v[148:151], v135 offset:3072
    ds_read_b128 a[108:111], v131 offset:128
    ds_read_b128 v[152:155], v135 offset:4096
    ds_read_b128 a[112:115], v130 offset:256
    ds_read_b128 v[156:159], v135 offset:5120
    ds_read_b128 a[116:119], v131 offset:256
    s_waitcnt lgkmcnt(10)
    v_mfma_f32_16x16x32_bf16 v[88:91], a[96:99], v[136:139], 0
    s_waitcnt lgkmcnt(8)
    v_mfma_f32_16x16x32_bf16 v[92:95], a[100:103], v[140:143], 0
    s_waitcnt lgkmcnt(6)
    v_mfma_f32_16x16x32_bf16 v[88:91], a[104:107], v[144:147], v[88:91]
    s_waitcnt lgkmcnt(4)
    v_mfma_f32_16x16x32_bf16 v[92:95], a[108:111], v[148:151], v[92:95]
    s_waitcnt lgkmcnt(2)
    v_mfma_f32_16x16x32_bf16 v[88:91], a[112:115], v[152:155], v[88:91]
    s_waitcnt lgkmcnt(0)
    v_mfma_f32_16x16x32_bf16 v[92:95], a[116:119], v[156:159], v[92:95]
    s_nop 7
    v_add_f32 v88, v88, v92
    v_add_f32 v89, v89, v93
    v_add_f32 v90, v90, v94
    v_add_f32 v91, v91, v95
    v_mul_f32 v88, 0x419fecaf, v88
    v_mul_f32 v89, 0x419fecaf, v89
    v_mul_f32 v90, 0x419fecaf, v90
    v_mul_f32 v91, 0x419fecaf, v91
    v_cvt_pk_bf16_f32 v120, v88, v89
    v_cvt_pk_bf16_f32 v121, v90, v91
    buffer_store_dwordx4 v[120:123], v65, s[32:35], s61 offen sc1
    buffer_load_dwordx4 v25, s[24:27], s58 offen offset:3072 nt lds
    s_add_u32 m0, s41, 4096
    s_nop 0
    buffer_load_dwordx4 v26, s[24:27], s58 offen offset:0 nt lds
    buffer_load_dwordx4 v27, s[24:27], s58 offen offset:1024 nt lds
    s_barrier
    buffer_load_dwordx4 v28, s[24:27], s58 offen offset:2048 nt lds
    buffer_load_dwordx4 v29, s[24:27], s58 offen offset:3072 nt lds
    s_add_u32 m0, s41, 8192
    s_nop 0
    buffer_load_dwordx4 v30, s[24:27], s58 offen offset:0 nt lds
    buffer_load_dwordx4 v31, s[24:27], s58 offen offset:1024 nt lds
    buffer_load_dwordx4 v32, s[24:27], s58 offen offset:2048 nt lds
    buffer_load_dwordx4 v33, s[24:27], s58 offen offset:3072 nt lds
    v_and_b32 v1, 15, v0
    v_lshrrev_b32 v6, 5, v0
    v_bfe_u32 v3, v0, 4, 1
    v_lshl_or_b32 v3, v3, 1, v6
    v_lshrrev_b32 v4, 2, v0
    v_bfe_u32 v5, v0, 1, 1
    v_lshrrev_b32 v6, 3, v1
    v_and_or_b32 v6, v1, 6, v6
    v_xor_b32 v6, v6, v3
    v_mul_u32_u24 v7, 384, v1
    v_lshl_add_u32 v6, v6, 4, v7
    v_add_u32 v34, s40, v6
    v_xor_b32 v35, 64, v34
    v_lshrrev_b32 v6, 3, v1
    v_and_b32 v7, 7, v1
    v_lshl_or_b32 v6, v7, 1, v6
    v_xor_b32 v6, v6, v3
    v_mul_u32_u24 v7, 768, v1
    v_lshl_add_u32 v6, v6, 4, v7
    v_add_u32 v40, s41, v6
    v_xor_b32 v41, 0x40, v40
    v_xor_b32 v42, 0x80, v40
    v_xor_b32 v43, 0xc0, v40
    v_and_b32 v2, 1, v0
    v_lshlrev_b32 v2, 3, v2
    s_mul_i32 s56, s3, 96
    v_lshrrev_b32 v6, 3, v4
    v_and_or_b32 v6, v4, 6, v6
    v_xor_b32 v6, v6, v5
    v_lshl_add_u32 v6, v6, 4, v2
    v_mul_u32_u24 v7, 384, v4
    s_add_u32 s57, s56, 0
    v_xad_u32 v36, v6, s57, v7
    s_add_u32 s57, s56, 32
    v_xad_u32 v37, v6, s57, v7
    s_add_u32 s57, s56, 64
    v_xad_u32 v38, v6, s57, v7
    v_lshrrev_b32 v6, 3, v4
    v_and_b32 v3, 7, v4
    v_lshl_or_b32 v6, v3, 1, v6
    v_xor_b32 v6, v6, v5
    v_lshl_add_u32 v6, v6, 4, v2
    v_lshlrev_b32 v7, 1, v7
    v_add_u32 v7, 24576, v7
    s_add_u32 s57, s56, 0
    v_xad_u32 v44, v6, s57, v7
    s_add_u32 s57, s56, 384
    v_xad_u32 v45, v6, s57, v7
    s_add_u32 s57, s56, 32
    v_xad_u32 v46, v6, s57, v7
    s_add_u32 s57, s56, 416
    v_xad_u32 v47, v6, s57, v7
    s_add_u32 s57, s56, 64
    v_xad_u32 v48, v6, s57, v7
    s_add_u32 s57, s56, 448
    v_xad_u32 v49, v6, s57, v7
    v_lshrrev_b32 v1, 5, v0
    v_lshlrev_b32 v1, 8, v1
    v_and_b32 v2, 15, v0
    v_lshl_add_u32 v1, v2, 4, v1
    v_bfe_u32 v2, v0, 4, 1
    v_lshl_add_u32 v1, v2, 3, v1
    s_mul_i32 s56, s3, 1536
    s_add_u32 s56, s56, 147456
    v_add_u32 v236, s56, v1
    s_mul_i32 s56, s3, 3072
    s_add_u32 s56, s56, 24576
    v_add_u32 v237, s56, v65
    v_add_u32 v238, s41, v65
    s_lshl_b32 s56, s3, 10
    v_add_u32 v240, 159744, v65
    v_add_u32 v239, s56, v240
    v_add_u32 v241, 147456, v65
    v_bfe_u32 v1, v0, 2, 2
    v_lshrrev_b32 v2, 4, v0
    v_lshl_or_b32 v1, v1, 4, v2
    v_mul_u32_u24 v1, 65536, v1
    v_and_b32 v2, 3, v0
    v_lshl_or_b32 v242, v2, 5, v1
    v_xor_b32 v243, 0x70, v242
    s_mul_i32 s56, s3, 3
    v_min_u32 v1, 2, v0
    v_add_u32 v1, s56, v1
    v_min_u32 v2, 8, v0
    v_add_u32 v2, 9, v2
    v_cmp_gt_u32 vcc, 3, v0
    s_nop 1
    v_cndmask_b32 v1, v2, v1, vcc
    v_lshlrev_b32 v245, 7, v1
    v_lshlrev_b32 v1, 3, v0
    v_add_u32 v254, 126976, v1
    s_lshl_b32 s56, s3, 9
    v_add_u32 v238, s56, v254
    v_add_u32 v253, 122880, v65
    s_lshl_b32 s56, s3, 10
    v_add_u32 v237, s56, v253
    s_mov_b32 s52, 0x41c00000
    s_add_u32 m0, s42, 0
    s_add_u32 s59, s37, 196608
    buffer_load_dwordx4 v22, s[24:27], s59 offen offset:0 nt lds
    s_waitcnt vmcnt(14)
    s_barrier
    ds_read_b128 a[48:51], v34 offset:0
    ds_read_b128 a[52:55], v35 offset:0
    ds_read_b128 a[56:59], v34 offset:128
    ds_read_b128 a[60:63], v35 offset:128
    ds_read_b128 a[64:67], v34 offset:256
    ds_read_b128 a[68:71], v35 offset:256
    s_waitcnt lgkmcnt(5)
    v_mfma_f32_16x16x32_bf16 v[84:87], a[48:51], a[48:51], 0
    buffer_load_dwordx4 v23, s[24:27], s59 offen offset:1024 nt lds
    ds_read_b64_tr_b16 a[72:73], v36 offset:0
    ds_read_b64_tr_b16 a[74:75], v36 offset:6144
    v_mfma_f32_16x16x32_bf16 v[80:83], a[48:51], v[52:55], 0
    ds_read_b64_tr_b16 a[76:77], v36 offset:12288
    ds_read_b64_tr_b16 a[78:79], v36 offset:18432
    s_waitcnt lgkmcnt(8)
    v_mfma_f32_16x16x32_bf16 v[84:87], a[52:55], a[52:55], v[84:87]
    ds_read_b64_tr_b16 a[80:81], v37 offset:0
    ds_read_b64_tr_b16 a[82:83], v37 offset:6144
    v_mfma_f32_16x16x32_bf16 v[80:83], a[52:55], v[52:55], v[80:83]
    ds_read_b64_tr_b16 a[84:85], v37 offset:12288
    ds_read_b64_tr_b16 a[86:87], v37 offset:18432
    s_waitcnt lgkmcnt(11)
    v_mfma_f32_16x16x32_bf16 v[84:87], a[56:59], a[56:59], v[84:87]
    ds_read_b64_tr_b16 a[88:89], v38 offset:0
    ds_read_b64_tr_b16 a[90:91], v38 offset:6144
    v_mfma_f32_16x16x32_bf16 v[80:83], a[56:59], v[52:55], v[80:83]
    ds_read_b64_tr_b16 a[92:93], v38 offset:12288
    ds_read_b64_tr_b16 a[94:95], v38 offset:18432
    s_waitcnt lgkmcnt(14)
    v_mfma_f32_16x16x32_bf16 v[84:87], a[60:63], a[60:63], v[84:87]
    buffer_load_dwordx4 v24, s[24:27], s59 offen offset:2048 nt lds
    v_mfma_f32_16x16x32_bf16 v[80:83], a[60:63], v[52:55], v[80:83]
    buffer_load_dwordx4 v25, s[24:27], s59 offen offset:3072 nt lds
    s_waitcnt lgkmcnt(13)
    v_mfma_f32_16x16x32_bf16 v[84:87], a[64:67], a[64:67], v[84:87]
    v_mfma_f32_16x16x32_bf16 v[80:83], a[64:67], v[52:55], v[80:83]
    s_waitcnt lgkmcnt(12)
    v_mfma_f32_16x16x32_bf16 v[84:87], a[68:71], a[68:71], v[84:87]
    v_mfma_f32_16x16x32_bf16 v[80:83], a[68:71], v[52:55], v[80:83]
    s_waitcnt lgkmcnt(0)
    s_mul_i32 s39, s38, 0x9e3779b1
    s_add_u32 s39, s39, 0x7f4a7c16
    s_or_b32 s39, s39, 1
    s_add_u32 m0, s42, 4096
    s_nop 0
    buffer_load_dwordx4 v26, s[24:27], s59 offen offset:0 nt lds
    buffer_load_dwordx4 v27, s[24:27], s59 offen offset:1024 nt lds
    buffer_load_dwordx4 v28, s[24:27], s59 offen offset:2048 nt lds
    buffer_load_dwordx4 v29, s[24:27], s59 offen offset:3072 nt lds
    s_add_u32 m0, s42, 8192
    s_nop 0
    buffer_load_dwordx4 v30, s[24:27], s59 offen offset:0 nt lds
    buffer_load_dwordx4 v31, s[24:27], s59 offen offset:1024 nt lds
    buffer_load_dwordx4 v32, s[24:27], s59 offen offset:2048 nt lds
    s_mul_i32 s56, s3, 3072
    s_add_u32 s56, s56, 16384
    buffer_load_dwordx4 v[136:139], v65, s[32:35], s56 offen offset:0 sc1
    buffer_load_dwordx4 v[140:143], v65, s[32:35], s56 offen offset:1024 sc1
    buffer_load_dwordx4 v[144:147], v65, s[32:35], s56 offen offset:2048 sc1
    s_mov_b32 s43, -1
    s_branch L_join
L_vprod:
    s_mul_i32 s60, s3, 18432
    s_add_u32 m0, s60, 73728
    s_nop 0
    buffer_load_dwordx4 v16, s[64:67], s60 offen offset:0  lds
    buffer_load_dwordx4 v17, s[64:67], s60 offen offset:1024  lds
    buffer_load_dwordx4 v18, s[64:67], s60 offen offset:2048  lds
    buffer_load_dwordx4 v19, s[64:67], s60 offen offset:3072  lds
    s_add_u32 m0, s60, 77824
    s_nop 0
    buffer_load_dwordx4 v20, s[64:67], s60 offen offset:0  lds
    buffer_load_dwordx4 v21, s[64:67], s60 offen offset:1024  lds
    s_add_u32 s60, s60, 6144
    s_add_u32 m0, s60, 73728
    s_nop 0
    buffer_load_dwordx4 v16, s[64:67], s60 offen offset:0  lds
    buffer_load_dwordx4 v17, s[64:67], s60 offen offset:1024  lds
    buffer_load_dwordx4 v18, s[64:67], s60 offen offset:2048  lds
    buffer_load_dwordx4 v19, s[64:67], s60 offen offset:3072  lds
    s_add_u32 m0, s60, 77824
    s_nop 0
    buffer_load_dwordx4 v20, s[64:67], s60 offen offset:0  lds
    buffer_load_dwordx4 v21, s[64:67], s60 offen offset:1024  lds
    s_add_u32 s60, s60, 6144
    s_add_u32 m0, s60, 73728
    s_nop 0
    buffer_load_dwordx4 v16, s[64:67], s60 offen offset:0  lds
    v_lshrrev_b32 v1, 4, v0
    v_and_b32 v5, 1, v1
    v_bfe_u32 v2, v0, 2, 2
    v_lshl_add_u32 v3, v1, 3, v2
    buffer_load_dwordx4 v17, s[64:67], s60 offen offset:1024  lds
    v_mul_u32_u24 v3, 384, v3
    v_and_b32 v4, 1, v0
    v_lshl_add_u32 v3, v4, 3, v3
    v_add_u32 v3, 73728, v3
    buffer_load_dwordx4 v18, s[64:67], s60 offen offset:2048  lds
    v_and_or_b32 v2, v2, 2, v5
    v_bfe_u32 v4, v0, 1, 1
    v_xor_b32 v2, v2, v4
    s_mul_i32 s56, s3, 6
    buffer_load_dwordx4 v19, s[64:67], s60 offen offset:3072  lds
    s_add_u32 s57, s56, 0
    v_xor_b32 v4, s57, v2
    v_lshl_add_u32 v136, v4, 4, v3
    v_xor_b32 v137, 64, v136
    s_add_u32 m0, s60, 77824
    s_nop 0
    buffer_load_dwordx4 v20, s[64:67], s60 offen offset:0  lds
    s_add_u32 s57, s56, 2
    v_xor_b32 v4, s57, v2
    v_lshl_add_u32 v138, v4, 4, v3
    v_xor_b32 v139, 64, v138
    buffer_load_dwordx4 v21, s[64:67], s60 offen offset:1024  lds
    s_add_u32 s57, s56, 4
    v_xor_b32 v4, s57, v2
    v_lshl_add_u32 v140, v4, 4, v3
    v_xor_b32 v141, 64, v140
    s_lshl_b32 s61, s43, 2
    s_add_u32 s61, s61, s3
    s_mul_i32 s60, s61, 6144
    s_add_u32 m0, s41, 6144
    s_nop 0
    buffer_load_dwordx4 v16, s[68:71], s60 offen offset:0  lds
    v_bfe_u32 v1, v0, 2, 1
    v_and_b32 v2, 3, v0
    v_lshl_or_b32 v2, v1, 3, v2
    v_and_or_b32 v1, v0, 2, v1
    buffer_load_dwordx4 v17, s[68:71], s60 offen offset:1024  lds
    v_lshrrev_b32 v3, 4, v0
    v_xor_b32 v1, v1, v3
    v_mul_u32_u24 v2, 384, v2
    v_lshl_add_u32 v1, v1, 4, v2
    buffer_load_dwordx4 v18, s[68:71], s60 offen offset:2048  lds
    v_bfe_u32 v2, v0, 3, 1
    v_mul_u32_u24 v2, 12288, v2
    s_mov_b32 s56, 30720
    v_add3_u32 v142, s56, v1, v2
    buffer_load_dwordx4 v19, s[68:71], s60 offen offset:3072  lds
    v_xor_b32 v143, 64, v142
    s_add_u32 m0, s41, 10240
    s_nop 0
    buffer_load_dwordx4 v20, s[68:71], s60 offen offset:0  lds
    buffer_load_dwordx4 v21, s[68:71], s60 offen offset:1024  lds
    s_load_dword s38, s[22:23], 0
    s_barrier
    s_add_u32 m0, s40, 0
    s_add_u32 s57, s36, 0
    buffer_load_dwordx4 v16, s[28:31], s57 offen offset:0 nt lds
    buffer_load_dwordx4 v17, s[28:31], s57 offen offset:1024 nt lds
    buffer_load_dwordx4 v18, s[28:31], s57 offen offset:2048 nt lds
    buffer_load_dwordx4 v19, s[28:31], s57 offen offset:3072 nt lds
    s_add_u32 m0, s40, 4096
    s_nop 0
    buffer_load_dwordx4 v20, s[28:31], s57 offen offset:0 nt lds
    buffer_load_dwordx4 v21, s[28:31], s57 offen offset:1024 nt lds
    s_add_u32 m0, s41, 0
    s_add_u32 s58, s37, 0
    buffer_load_dwordx4 v22, s[24:27], s58 offen offset:0 nt lds
    buffer_load_dwordx4 v23, s[24:27], s58 offen offset:1024 nt lds
    buffer_load_dwordx4 v24, s[24:27], s58 offen offset:2048 nt lds
    s_waitcnt vmcnt(9)
    s_barrier
    ds_read_b128 a[96:99], v142 offset:0
    ds_read_b128 a[100:103], v143 offset:0
    ds_read_b128 a[104:107], v142 offset:128
    ds_read_b128 a[108:111], v143 offset:128
    ds_read_b128 a[112:115], v142 offset:256
    ds_read_b128 a[116:119], v143 offset:256
    ds_read_b128 a[120:123], v143 offset:1536
    ds_read_b128 a[124:127], v142 offset:1536
    ds_read_b128 a[128:131], v143 offset:1664
    ds_read_b128 a[132:135], v142 offset:1664
    ds_read_b128 a[136:139], v143 offset:1792
    ds_read_b128 a[140:143], v142 offset:1792
    ds_read_b128 a[144:147], v142 offset:24576
    ds_read_b128 a[148:151], v143 offset:24576
    ds_read_b128 a[152:155], v142 offset:24704
    ds_read_b128 a[156:159], v143 offset:24704
    ds_read_b128 a[160:163], v142 offset:24832
    ds_read_b128 a[164:167], v143 offset:24832
    ds_read_b128 a[168:171], v143 offset:26112
    ds_read_b128 a[172:175], v142 offset:26112
    ds_read_b128 a[176:179], v143 offset:26240
    ds_read_b128 a[180:183], v142 offset:26240
    ds_read_b128 a[184:187], v143 offset:26368
    ds_read_b128 a[188:191], v142 offset:26368
    ds_read_b64_tr_b16 v[160:161], v136 offset:0
    ds_read_b64_tr_b16 v[162:163], v137 offset:1536
    ds_read_b64_tr_b16 v[164:165], v136 offset:12288
    ds_read_b64_tr_b16 v[166:167], v137 offset:13824
    ds_read_b64_tr_b16 v[168:169], v136 offset:24576
    ds_read_b64_tr_b16 v[170:171], v137 offset:26112
    ds_read_b64_tr_b16 v[172:173], v136 offset:36864
    ds_read_b64_tr_b16 v[174:175], v137 offset:38400
    ds_read_b64_tr_b16 v[176:177], v136 offset:49152
    ds_read_b64_tr_b16 v[178:179], v137 offset:50688
    ds_read_b64_tr_b16 v[180:181], v136 offset:61440
    ds_read_b64_tr_b16 v[182:183], v137 offset:62976
    ds_read_b64_tr_b16 v[184:185], v138 offset:0
    ds_read_b64_tr_b16 v[186:187], v139 offset:1536
    ds_read_b64_tr_b16 v[188:189], v138 offset:12288
    ds_read_b64_tr_b16 v[190:191], v139 offset:13824
    ds_read_b64_tr_b16 v[192:193], v138 offset:24576
    ds_read_b64_tr_b16 v[194:195], v139 offset:26112
    ds_read_b64_tr_b16 v[196:197], v138 offset:36864
    ds_read_b64_tr_b16 v[198:199], v139 offset:38400
    ds_read_b64_tr_b16 v[200:201], v138 offset:49152
    ds_read_b64_tr_b16 v[202:203], v139 offset:50688
    ds_read_b64_tr_b16 v[204:205], v138 offset:61440
    ds_read_b64_tr_b16 v[206:207], v139 offset:62976
    ds_read_b64_tr_b16 v[208:209], v140 offset:0
    ds_read_b64_tr_b16 v[210:211], v141 offset:1536
    ds_read_b64_tr_b16 v[212:213], v140 offset:12288
    ds_read_b64_tr_b16 v[214:215], v141 offset:13824
    ds_read_b64_tr_b16 v[216:217], v140 offset:24576
    ds_read_b64_tr_b16 v[218:219], v141 offset:26112
    ds_read_b64_tr_b16 v[220:221], v140 offset:36864
    ds_read_b64_tr_b16 v[222:223], v141 offset:38400
    ds_read_b64_tr_b16 v[224:225], v140 offset:49152
    ds_read_b64_tr_b16 v[226:227], v141 offset:50688
    ds_read_b64_tr_b16 v[228:229], v140 offset:61440
    ds_read_b64_tr_b16 v[230:231], v141 offset:62976
    s_waitcnt lgkmcnt(0)
    s_barrier
    s_mul_i32 s60, s3, 18432
    s_lshl_b32 s61, s43, 11
    s_add_u32 s60, s60, s61
    s_add_u32 s60, s60, 3145728
    v_mfma_f32_16x16x32_bf16 v[88:91], a[96:99], v[160:163], 0
    v_mfma_f32_16x16x32_bf16 v[92:95], a[120:123], v[160:163], 0
    v_mfma_f32_16x16x32_bf16 v[96:99], a[144:147], v[160:163], 0
    v_mfma_f32_16x16x32_bf16 v[100:103], a[168:171], v[160:163], 0
    buffer_load_dwordx4 v25, s[24:27], s58 offen offset:3072 nt lds
    v_mfma_f32_16x16x32_bf16 v[88:91], a[100:103], v[164:167], v[88:91]
    v_mfma_f32_16x16x32_bf16 v[92:95], a[124:127], v[164:167], v[92:95]
    v_mfma_f32_16x16x32_bf16 v[96:99], a[148:151], v[164:167], v[96:99]
    v_mfma_f32_16x16x32_bf16 v[100:103], a[172:175], v[164:167], v[100:103]
    s_add_u32 m0, s41, 4096
    s_nop 0
    buffer_load_dwordx4 v26, s[24:27], s58 offen offset:0 nt lds
    v_mfma_f32_16x16x32_bf16 v[88:91], a[104:107], v[168:171], v[88:91]
    v_mfma_f32_16x16x32_bf16 v[92:95], a[128:131], v[168:171], v[92:95]
    v_mfma_f32_16x16x32_bf16 v[96:99], a[152:155], v[168:171], v[96:99]
    v_mfma_f32_16x16x32_bf16 v[100:103], a[176:179], v[168:171], v[100:103]
    buffer_load_dwordx4 v27, s[24:27], s58 offen offset:1024 nt lds
    v_mfma_f32_16x16x32_bf16 v[88:91], a[108:111], v[172:175], v[88:91]
    v_mfma_f32_16x16x32_bf16 v[92:95], a[132:135], v[172:175], v[92:95]
    v_mfma_f32_16x16x32_bf16 v[96:99], a[156:159], v[172:175], v[96:99]
    v_mfma_f32_16x16x32_bf16 v[100:103], a[180:183], v[172:175], v[100:103]
    buffer_load_dwordx4 v28, s[24:27], s58 offen offset:2048 nt lds
    v_mfma_f32_16x16x32_bf16 v[88:91], a[112:115], v[176:179], v[88:91]
    v_mfma_f32_16x16x32_bf16 v[92:95], a[136:139], v[176:179], v[92:95]
    v_mfma_f32_16x16x32_bf16 v[96:99], a[160:163], v[176:179], v[96:99]
    v_mfma_f32_16x16x32_bf16 v[100:103], a[184:187], v[176:179], v[100:103]
    buffer_load_dwordx4 v29, s[24:27], s58 offen offset:3072 nt lds
    v_mfma_f32_16x16x32_bf16 v[88:91], a[116:119], v[180:183], v[88:91]
    v_mfma_f32_16x16x32_bf16 v[92:95], a[140:143], v[180:183], v[92:95]
    v_mfma_f32_16x16x32_bf16 v[96:99], a[164:167], v[180:183], v[96:99]
    v_mfma_f32_16x16x32_bf16 v[100:103], a[188:191], v[180:183], v[100:103]
    v_mfma_f32_16x16x32_bf16 v[104:107], a[96:99], v[184:187], 0
    v_mfma_f32_16x16x32_bf16 v[108:111], a[120:123], v[184:187], 0
    v_mfma_f32_16x16x32_bf16 v[112:115], a[144:147], v[184:187], 0
    v_mfma_f32_16x16x32_bf16 v[116:119], a[168:171], v[184:187], 0
    s_add_u32 m0, s41, 8192
    s_nop 0
    buffer_load_dwordx4 v30, s[24:27], s58 offen offset:0 nt lds
    v_mfma_f32_16x16x32_bf16 v[104:107], a[100:103], v[188:191], v[104:107]
    v_mfma_f32_16x16x32_bf16 v[108:111], a[124:127], v[188:191], v[108:111]
    v_mfma_f32_16x16x32_bf16 v[112:115], a[148:151], v[188:191], v[112:115]
    v_mfma_f32_16x16x32_bf16 v[116:119], a[172:175], v[188:191], v[116:119]
    buffer_load_dwordx4 v31, s[24:27], s58 offen offset:1024 nt lds
    v_mfma_f32_16x16x32_bf16 v[104:107], a[104:107], v[192:195], v[104:107]
    v_mfma_f32_16x16x32_bf16 v[108:111], a[128:131], v[192:195], v[108:111]
    v_mfma_f32_16x16x32_bf16 v[112:115], a[152:155], v[192:195], v[112:115]
    v_mfma_f32_16x16x32_bf16 v[116:119], a[176:179], v[192:195], v[116:119]
    buffer_load_dwordx4 v32, s[24:27], s58 offen offset:2048 nt lds
    v_cvt_pk_bf16_f32 v144, v88, v89
    v_cvt_pk_bf16_f32 v145, v90, v91
    v_cvt_pk_bf16_f32 v146, v92, v93
    v_cvt_pk_bf16_f32 v147, v94, v95
    buffer_store_dwordx4 v[144:147], v65, s[32:35], s60 offen offset:0 sc1
    v_cvt_pk_bf16_f32 v148, v96, v97
    v_cvt_pk_bf16_f32 v149, v98, v99
    v_cvt_pk_bf16_f32 v150, v100, v101
    v_cvt_pk_bf16_f32 v151, v102, v103
    buffer_store_dwordx4 v[148:151], v65, s[32:35], s60 offen offset:1024 sc1
    s_add_u32 s60, s60, 6144
    v_mfma_f32_16x16x32_bf16 v[104:107], a[108:111], v[196:199], v[104:107]
    v_mfma_f32_16x16x32_bf16 v[108:111], a[132:135], v[196:199], v[108:111]
    v_mfma_f32_16x16x32_bf16 v[112:115], a[156:159], v[196:199], v[112:115]
    v_mfma_f32_16x16x32_bf16 v[116:119], a[180:183], v[196:199], v[116:119]
    buffer_load_dwordx4 v33, s[24:27], s58 offen offset:3072 nt lds
    v_mfma_f32_16x16x32_bf16 v[104:107], a[112:115], v[200:203], v[104:107]
    v_mfma_f32_16x16x32_bf16 v[108:111], a[136:139], v[200:203], v[108:111]
    v_mfma_f32_16x16x32_bf16 v[112:115], a[160:163], v[200:203], v[112:115]
    v_mfma_f32_16x16x32_bf16 v[116:119], a[184:187], v[200:203], v[116:119]
    s_add_u32 m0, s42, 0
    s_add_u32 s59, s37, 196608
    buffer_load_dwordx4 v22, s[24:27], s59 offen offset:0 nt lds
    v_mfma_f32_16x16x32_bf16 v[104:107], a[116:119], v[204:207], v[104:107]
    v_mfma_f32_16x16x32_bf16 v[108:111], a[140:143], v[204:207], v[108:111]
    v_mfma_f32_16x16x32_bf16 v[112:115], a[164:167], v[204:207], v[112:115]
    v_mfma_f32_16x16x32_bf16 v[116:119], a[188:191], v[204:207], v[116:119]
    v_mfma_f32_16x16x32_bf16 v[120:123], a[96:99], v[208:211], 0
    v_mfma_f32_16x16x32_bf16 v[124:127], a[120:123], v[208:211], 0
    v_mfma_f32_16x16x32_bf16 v[128:131], a[144:147], v[208:211], 0
    v_mfma_f32_16x16x32_bf16 v[132:135], a[168:171], v[208:211], 0
    buffer_load_dwordx4 v23, s[24:27], s59 offen offset:1024 nt lds
    v_mfma_f32_16x16x32_bf16 v[120:123], a[100:103], v[212:215], v[120:123]
    v_mfma_f32_16x16x32_bf16 v[124:127], a[124:127], v[212:215], v[124:127]
    v_mfma_f32_16x16x32_bf16 v[128:131], a[148:151], v[212:215], v[128:131]
    v_mfma_f32_16x16x32_bf16 v[132:135], a[172:175], v[212:215], v[132:135]
    buffer_load_dwordx4 v24, s[24:27], s59 offen offset:2048 nt lds
    v_mfma_f32_16x16x32_bf16 v[120:123], a[104:107], v[216:219], v[120:123]
    v_mfma_f32_16x16x32_bf16 v[124:127], a[128:131], v[216:219], v[124:127]
    v_mfma_f32_16x16x32_bf16 v[128:131], a[152:155], v[216:219], v[128:131]
    v_mfma_f32_16x16x32_bf16 v[132:135], a[176:179], v[216:219], v[132:135]
    buffer_load_dwordx4 v25, s[24:27], s59 offen offset:3072 nt lds
    v_cvt_pk_bf16_f32 v152, v104, v105
    v_cvt_pk_bf16_f32 v153, v106, v107
    v_cvt_pk_bf16_f32 v154, v108, v109
    v_cvt_pk_bf16_f32 v155, v110, v111
    buffer_store_dwordx4 v[152:155], v65, s[32:35], s60 offen offset:0 sc1
    v_cvt_pk_bf16_f32 v156, v112, v113
    v_cvt_pk_bf16_f32 v157, v114, v115
    v_cvt_pk_bf16_f32 v158, v116, v117
    v_cvt_pk_bf16_f32 v159, v118, v119
    buffer_store_dwordx4 v[156:159], v65, s[32:35], s60 offen offset:1024 sc1
    s_add_u32 s60, s60, 6144
    v_mfma_f32_16x16x32_bf16 v[120:123], a[108:111], v[220:223], v[120:123]
    v_mfma_f32_16x16x32_bf16 v[124:127], a[132:135], v[220:223], v[124:127]
    v_mfma_f32_16x16x32_bf16 v[128:131], a[156:159], v[220:223], v[128:131]
    v_mfma_f32_16x16x32_bf16 v[132:135], a[180:183], v[220:223], v[132:135]
    s_add_u32 m0, s42, 4096
    s_nop 0
    buffer_load_dwordx4 v26, s[24:27], s59 offen offset:0 nt lds
    v_mfma_f32_16x16x32_bf16 v[120:123], a[112:115], v[224:227], v[120:123]
    v_mfma_f32_16x16x32_bf16 v[124:127], a[136:139], v[224:227], v[124:127]
    v_mfma_f32_16x16x32_bf16 v[128:131], a[160:163], v[224:227], v[128:131]
    v_mfma_f32_16x16x32_bf16 v[132:135], a[184:187], v[224:227], v[132:135]
    buffer_load_dwordx4 v27, s[24:27], s59 offen offset:1024 nt lds
    v_mfma_f32_16x16x32_bf16 v[120:123], a[116:119], v[228:231], v[120:123]
    v_mfma_f32_16x16x32_bf16 v[124:127], a[140:143], v[228:231], v[124:127]
    v_mfma_f32_16x16x32_bf16 v[128:131], a[164:167], v[228:231], v[128:131]
    v_mfma_f32_16x16x32_bf16 v[132:135], a[188:191], v[228:231], v[132:135]
    s_nop 4
    v_cvt_pk_bf16_f32 v144, v120, v121
    v_cvt_pk_bf16_f32 v145, v122, v123
    v_cvt_pk_bf16_f32 v146, v124, v125
    v_cvt_pk_bf16_f32 v147, v126, v127
    buffer_store_dwordx4 v[144:147], v65, s[32:35], s60 offen offset:0 sc1
    v_cvt_pk_bf16_f32 v148, v128, v129
    v_cvt_pk_bf16_f32 v149, v130, v131
    v_cvt_pk_bf16_f32 v150, v132, v133
    v_cvt_pk_bf16_f32 v151, v134, v135
    buffer_store_dwordx4 v[148:151], v65, s[32:35], s60 offen offset:1024 sc1
    v_and_b32 v1, 15, v0
    v_lshrrev_b32 v6, 5, v0
    v_bfe_u32 v3, v0, 4, 1
    v_lshl_or_b32 v3, v3, 1, v6
    v_lshrrev_b32 v4, 2, v0
    v_bfe_u32 v5, v0, 1, 1
    v_lshrrev_b32 v6, 3, v1
    v_and_or_b32 v6, v1, 6, v6
    v_xor_b32 v6, v6, v3
    v_mul_u32_u24 v7, 384, v1
    v_lshl_add_u32 v6, v6, 4, v7
    v_add_u32 v34, s40, v6
    v_xor_b32 v35, 64, v34
    v_lshrrev_b32 v6, 3, v1
    v_and_b32 v7, 7, v1
    v_lshl_or_b32 v6, v7, 1, v6
    v_xor_b32 v6, v6, v3
    v_mul_u32_u24 v7, 768, v1
    v_lshl_add_u32 v6, v6, 4, v7
    v_add_u32 v40, s41, v6
    v_xor_b32 v41, 0x40, v40
    v_xor_b32 v42, 0x80, v40
    v_xor_b32 v43, 0xc0, v40
    v_and_b32 v2, 1, v0
    v_lshlrev_b32 v2, 3, v2
    s_mul_i32 s56, s3, 96
    v_lshrrev_b32 v6, 3, v4
    v_and_or_b32 v6, v4, 6, v6
    v_xor_b32 v6, v6, v5
    v_lshl_add_u32 v6, v6, 4, v2
    v_mul_u32_u24 v7, 384, v4
    s_add_u32 s57, s56, 0
    v_xad_u32 v36, v6, s57, v7
    s_add_u32 s57, s56, 32
    v_xad_u32 v37, v6, s57, v7
    s_add_u32 s57, s56, 64
    v_xad_u32 v38, v6, s57, v7
    v_lshrrev_b32 v6, 3, v4
    v_and_b32 v3, 7, v4
    v_lshl_or_b32 v6, v3, 1, v6
    v_xor_b32 v6, v6, v5
    v_lshl_add_u32 v6, v6, 4, v2
    v_lshlrev_b32 v7, 1, v7
    v_add_u32 v7, 24576, v7
    s_add_u32 s57, s56, 0
    v_xad_u32 v44, v6, s57, v7
    s_add_u32 s57, s56, 384
    v_xad_u32 v45, v6, s57, v7
    s_add_u32 s57, s56, 32
    v_xad_u32 v46, v6, s57, v7
    s_add_u32 s57, s56, 416
    v_xad_u32 v47, v6, s57, v7
    s_add_u32 s57, s56, 64
    v_xad_u32 v48, v6, s57, v7
    s_add_u32 s57, s56, 448
    v_xad_u32 v49, v6, s57, v7
    v_mov_b32 v52, 0x3f803f80
    v_mov_b32 v56, 0x3ebcbe62
    s_mov_b32 s44, 0x100001
    s_mov_b32 s45, 0x10000100
    v_mov_b32 v53, 0x3f803f80
    v_mov_b32 v57, 0x3ebcbe62
    s_mov_b32 s46, 0x200002
    s_mov_b32 s47, 0x20000200
    v_mov_b32 v54, 0x3f803f80
    v_mov_b32 v58, 0x3ebcbe62
    s_mov_b32 s48, 0x400004
    s_mov_b32 s49, 0x40000400
    v_mov_b32 v55, 0x3f803f80
    v_mov_b32 v59, 0x3ebcbe62
    s_mov_b32 s50, 0x800008
    s_mov_b32 s51, 0x80000800
    v_mov_b32 v60, 0x43400000
    v_lshrrev_b32 v1, 5, v0
    v_lshlrev_b32 v1, 8, v1
    v_and_b32 v2, 15, v0
    v_lshl_add_u32 v1, v2, 4, v1
    v_bfe_u32 v2, v0, 4, 1
    v_lshl_add_u32 v1, v2, 3, v1
    s_mul_i32 s56, s3, 1536
    s_add_u32 s56, s56, 147456
    v_add_u32 v236, s56, v1
    s_mul_i32 s56, s3, 3072
    s_add_u32 s56, s56, 24576
    v_add_u32 v237, s56, v65
    v_add_u32 v238, s41, v65
    s_lshl_b32 s56, s3, 10
    v_add_u32 v240, 159744, v65
    v_add_u32 v239, s56, v240
    v_add_u32 v241, 147456, v65
    v_bfe_u32 v1, v0, 2, 2
    v_lshrrev_b32 v2, 4, v0
    v_lshl_or_b32 v1, v1, 4, v2
    v_mul_u32_u24 v1, 65536, v1
    v_and_b32 v2, 3, v0
    v_lshl_or_b32 v242, v2, 5, v1
    v_xor_b32 v243, 0x70, v242
    s_mul_i32 s56, s3, 3
    v_min_u32 v1, 2, v0
    v_add_u32 v1, s56, v1
    v_min_u32 v2, 8, v0
    v_add_u32 v2, 9, v2
    v_cmp_gt_u32 vcc, 3, v0
    s_nop 1
    v_cndmask_b32 v1, v2, v1, vcc
    v_lshlrev_b32 v245, 7, v1
    v_lshlrev_b32 v1, 3, v0
    v_add_u32 v254, 126976, v1
    s_lshl_b32 s56, s3, 9
    v_add_u32 v238, s56, v254
    v_add_u32 v253, 122880, v65
    s_lshl_b32 s56, s3, 10
    v_add_u32 v237, s56, v253
    s_mov_b32 s52, 0x41c00000
    buffer_load_dwordx4 v28, s[24:27], s59 offen offset:2048 nt lds
    buffer_load_dwordx4 v29, s[24:27], s59 offen offset:3072 nt lds
    s_add_u32 m0, s42, 8192
    s_nop 0
    buffer_load_dwordx4 v30, s[24:27], s59 offen offset:0 nt lds
    buffer_load_dwordx4 v31, s[24:27], s59 offen offset:1024 nt lds
    s_waitcnt vmcnt(28)
    s_barrier
    ds_read_b128 a[48:51], v34 offset:0
    ds_read_b128 a[52:55], v35 offset:0
    ds_read_b128 a[56:59], v34 offset:128
    ds_read_b128 a[60:63], v35 offset:128
    ds_read_b128 a[64:67], v34 offset:256
    ds_read_b128 a[68:71], v35 offset:256
    s_waitcnt lgkmcnt(5)
    v_mfma_f32_16x16x32_bf16 v[84:87], a[48:51], a[48:51], 0
    ds_read_b64_tr_b16 a[72:73], v36 offset:0
    ds_read_b64_tr_b16 a[74:75], v36 offset:6144
    v_mfma_f32_16x16x32_bf16 v[80:83], a[48:51], v[52:55], 0
    buffer_load_dwordx4 v32, s[24:27], s59 offen offset:2048 nt lds
    ds_read_b64_tr_b16 a[76:77], v36 offset:12288
    ds_read_b64_tr_b16 a[78:79], v36 offset:18432
    s_waitcnt lgkmcnt(8)
    v_mfma_f32_16x16x32_bf16 v[84:87], a[52:55], a[52:55], v[84:87]
    ds_read_b64_tr_b16 a[80:81], v37 offset:0
    ds_read_b64_tr_b16 a[82:83], v37 offset:6144
    v_mfma_f32_16x16x32_bf16 v[80:83], a[52:55], v[52:55], v[80:83]
    ds_read_b64_tr_b16 a[84:85], v37 offset:12288
    ds_read_b64_tr_b16 a[86:87], v37 offset:18432
    s_waitcnt lgkmcnt(11)
    v_mfma_f32_16x16x32_bf16 v[84:87], a[56:59], a[56:59], v[84:87]
    ds_read_b64_tr_b16 a[88:89], v38 offset:0
    ds_read_b64_tr_b16 a[90:91], v38 offset:6144
    v_mfma_f32_16x16x32_bf16 v[80:83], a[56:59], v[52:55], v[80:83]
    ds_read_b64_tr_b16 a[92:93], v38 offset:12288
    ds_read_b64_tr_b16 a[94:95], v38 offset:18432
    s_waitcnt lgkmcnt(14)
    v_mfma_f32_16x16x32_bf16 v[84:87], a[60:63], a[60:63], v[84:87]
    v_mfma_f32_16x16x32_bf16 v[80:83], a[60:63], v[52:55], v[80:83]
    s_waitcnt lgkmcnt(13)
    v_mfma_f32_16x16x32_bf16 v[84:87], a[64:67], a[64:67], v[84:87]
    v_mfma_f32_16x16x32_bf16 v[80:83], a[64:67], v[52:55], v[80:83]
    s_waitcnt lgkmcnt(12)
    v_mfma_f32_16x16x32_bf16 v[84:87], a[68:71], a[68:71], v[84:87]
    v_mfma_f32_16x16x32_bf16 v[80:83], a[68:71], v[52:55], v[80:83]
    s_waitcnt lgkmcnt(0)
    s_mul_i32 s39, s38, 0x9e3779b1
    s_add_u32 s39, s39, 0x7f4a7c16
    s_or_b32 s39, s39, 1
    s_mul_i32 s56, s3, 3072
    s_add_u32 s56, s56, 16384
    buffer_load_dwordx4 v[136:139], v65, s[32:35], s56 offen offset:0 sc1
    buffer_load_dwordx4 v[140:143], v65, s[32:35], s56 offen offset:1024 sc1
    buffer_load_dwordx4 v[144:147], v65, s[32:35], s56 offen offset:2048 sc1
    s_branch L_join
L_xt3:
    s_call_b64 s[54:55], L_xslow
    s_branch L_post3
L_xt24:
    s_call_b64 s[54:55], L_xslow
    s_branch L_post24
L_xt6:
    s_call_b64 s[54:55], L_xslow
    s_branch L_post6
L_xt27:
    s_call_b64 s[54:55], L_xslow
    s_branch L_post27
L_xt9:
    s_call_b64 s[54:55], L_xslow
    s_branch L_post9
L_xt11:
    s_call_b64 s[54:55], L_xalt
    ds_read_b128 a[192:195], v253 offset:12288
    ds_read_b128 a[196:199], v253 offset:13312
    ds_read_b128 a[200:203], v253 offset:14336
    ds_read_b128 a[204:207], v253 offset:15360
    s_waitcnt lgkmcnt(0)
    s_branch L_post11
L_xslow:
    s_waitcnt lgkmcnt(0)
    ds_write_b32 v239, v62
    s_waitcnt lgkmcnt(0)
    s_barrier
    ds_read_b32 v12, v240 offset:0
    ds_read_b32 v13, v240 offset:1024
    ds_read_b32 v14, v240 offset:2048
    ds_read_b32 v15, v240 offset:3072
    v_mov_b32 v9, 0
    ds_write_b32 v254, v9 offset:4096
    s_waitcnt lgkmcnt(0)
    v_min3_f32 v1, v12, v13, v14
    v_min_f32 v1, v1, v15
    v_sub_f32 v2, v1, v255
    v_sub_f32 v12, v1, v62
    v_exp_f32 v2, v2
    v_exp_f32 v12, v12
    v_mov_b32 v62, v1
    v_mov_b32 v255, v1
    v_mul_f32 v88, v88, v12
    v_mul_f32 v89, v89, v12
    v_mul_f32 v90, v90, v12
    v_mul_f32 v91, v91, v12
    v_mul_f32 v104, v104, v12
    v_mul_f32 v105, v105, v12
    v_mul_f32 v106, v106, v12
    v_mul_f32 v107, v107, v12
    v_mul_f32 v68, v68, v12
    v_mul_f32 v69, v69, v12
    v_mul_f32 v70, v70, v12
    v_mul_f32 v71, v71, v12
    v_mul_f32 v112, v112, v12
    v_mul_f32 v113, v113, v12
    v_mul_f32 v114, v114, v12
    v_mul_f32 v115, v115, v12
    v_mul_f32 v63, v63, v12
    v_mul_f32 v64, v64, v12
    v_accvgpr_read_b32 v1, a0
    v_mul_f32 v1, v1, v2
    v_accvgpr_write_b32 a0, v1
    v_accvgpr_read_b32 v1, a1
    v_mul_f32 v1, v1, v2
    v_accvgpr_write_b32 a1, v1
    v_accvgpr_read_b32 v1, a2
    v_mul_f32 v1, v1, v2
    v_accvgpr_write_b32 a2, v1
    v_accvgpr_read_b32 v1, a3
    v_mul_f32 v1, v1, v2
    v_accvgpr_write_b32 a3, v1
    v_accvgpr_read_b32 v1, a4
    v_mul_f32 v1, v1, v2
    v_accvgpr_write_b32 a4, v1
    v_accvgpr_read_b32 v1, a5
    v_mul_f32 v1, v1, v2
    v_accvgpr_write_b32 a5, v1
    v_accvgpr_read_b32 v1, a6
    v_mul_f32 v1, v1, v2
    v_accvgpr_write_b32 a6, v1
    v_accvgpr_read_b32 v1, a7
    v_mul_f32 v1, v1, v2
    v_accvgpr_write_b32 a7, v1
    v_accvgpr_read_b32 v1, a8
    v_mul_f32 v1, v1, v2
    v_accvgpr_write_b32 a8, v1
    v_accvgpr_read_b32 v1, a9
    v_mul_f32 v1, v1, v2
    v_accvgpr_write_b32 a9, v1
    v_accvgpr_read_b32 v1, a10
    v_mul_f32 v1, v1, v2
    v_accvgpr_write_b32 a10, v1
    v_accvgpr_read_b32 v1, a11
    v_mul_f32 v1, v1, v2
    v_accvgpr_write_b32 a11, v1
    v_cvt_pk_bf16_f32 v72, v88, v89
    v_cvt_pk_bf16_f32 v73, v90, v91
    v_cvt_pk_bf16_f32 v74, v104, v105
    v_cvt_pk_bf16_f32 v75, v106, v107
    ds_write_b128 v237, v[72:75] offset:0
    v_cvt_pk_bf16_f32 v66, v68, v69
    v_cvt_pk_bf16_f32 v67, v70, v71
    ds_write_b64 v238, v[66:67]
    s_waitcnt lgkmcnt(0)
    s_barrier
    s_setpc_b64 s[54:55]
L_xlast:
    s_waitcnt lgkmcnt(0)
    ds_write_b32 v239, v62
    s_waitcnt lgkmcnt(0)
    s_barrier
    ds_read_b32 v12, v240 offset:0
    ds_read_b32 v13, v240 offset:1024
    ds_read_b32 v14, v240 offset:2048
    ds_read_b32 v15, v240 offset:3072
    v_mov_b32 v9, 0
    ds_write_b32 v254, v9 offset:4096
    s_waitcnt lgkmcnt(0)
    v_min3_f32 v1, v12, v13, v14
    v_min_f32 v1, v1, v15
    v_sub_f32 v2, v1, v255
    v_sub_f32 v12, v1, v62
    v_exp_f32 v2, v2
    v_exp_f32 v12, v12
    v_mov_b32 v62, v1
    v_mov_b32 v255, v1
    v_mul_f32 v88, v88, v12
    v_mul_f32 v89, v89, v12
    v_mul_f32 v90, v90, v12
    v_mul_f32 v91, v91, v12
    v_mul_f32 v104, v104, v12
    v_mul_f32 v105, v105, v12
    v_mul_f32 v106, v106, v12
    v_mul_f32 v107, v107, v12
    v_mul_f32 v68, v68, v12
    v_mul_f32 v69, v69, v12
    v_mul_f32 v70, v70, v12
    v_mul_f32 v71, v71, v12
    v_mul_f32 v10, v10, v12
    v_mul_f32 v11, v11, v12
    v_mul_f32 v16, v16, v2
    v_mul_f32 v17, v17, v2
    v_mul_f32 v18, v18, v2
    v_mul_f32 v19, v19, v2
    v_mul_f32 v20, v20, v2
    v_mul_f32 v21, v21, v2
    v_mul_f32 v22, v22, v2
    v_mul_f32 v23, v23, v2
    v_mul_f32 v24, v24, v2
    v_mul_f32 v25, v25, v2
    v_mul_f32 v26, v26, v2
    v_mul_f32 v27, v27, v2
    v_cvt_pk_bf16_f32 v72, v88, v89
    v_cvt_pk_bf16_f32 v73, v90, v91
    v_cvt_pk_bf16_f32 v74, v104, v105
    v_cvt_pk_bf16_f32 v75, v106, v107
    ds_write_b128 v237, v[72:75] offset:0
    v_cvt_pk_bf16_f32 v66, v68, v69
    v_cvt_pk_bf16_f32 v67, v70, v71
    ds_write_b64 v238, v[66:67]
    ds_write_b64 v238, v[10:11] offset:2048
    s_waitcnt lgkmcnt(0)
    s_barrier
    s_branch L_postx
L_xalt:
    s_waitcnt lgkmcnt(0)
    ds_write_b32 v239, v62
    s_waitcnt lgkmcnt(0)
    s_barrier
    ds_read_b32 v12, v240 offset:0
    ds_read_b32 v13, v240 offset:1024
    ds_read_b32 v14, v240 offset:2048
    ds_read_b32 v15, v240 offset:3072
    v_mov_b32 v9, 0
    ds_write_b32 v254, v9 offset:4100
    s_waitcnt lgkmcnt(0)
    v_min3_f32 v1, v12, v13, v14
    v_min_f32 v1, v1, v15
    v_sub_f32 v2, v1, v255
    v_sub_f32 v12, v1, v62
    v_exp_f32 v2, v2
    v_exp_f32 v12, v12
    v_mov_b32 v62, v1
    v_mov_b32 v255, v1
    v_mul_f32 v88, v88, v12
    v_mul_f32 v89, v89, v12
    v_mul_f32 v90, v90, v12
    v_mul_f32 v91, v91, v12
    v_mul_f32 v104, v104, v12
    v_mul_f32 v105, v105, v12
    v_mul_f32 v106, v106, v12
    v_mul_f32 v107, v107, v12
    v_mul_f32 v68, v68, v12
    v_mul_f32 v69, v69, v12
    v_mul_f32 v70, v70, v12
    v_mul_f32 v71, v71, v12
    v_mul_f32 v112, v112, v12
    v_mul_f32 v113, v113, v12
    v_mul_f32 v114, v114, v12
    v_mul_f32 v115, v115, v12
    v_mul_f32 v63, v63, v12
    v_mul_f32 v64, v64, v12
    v_mul_f32 v16, v16, v2
    v_mul_f32 v17, v17, v2
    v_mul_f32 v18, v18, v2
    v_mul_f32 v19, v19, v2
    v_mul_f32 v20, v20, v2
    v_mul_f32 v21, v21, v2
    v_mul_f32 v22, v22, v2
    v_mul_f32 v23, v23, v2
    v_mul_f32 v24, v24, v2
    v_mul_f32 v25, v25, v2
    v_mul_f32 v26, v26, v2
    v_mul_f32 v27, v27, v2
    v_cvt_pk_bf16_f32 v72, v88, v89
    v_cvt_pk_bf16_f32 v73, v90, v91
    v_cvt_pk_bf16_f32 v74, v104, v105
    v_cvt_pk_bf16_f32 v75, v106, v107
    ds_write_b128 v237, v[72:75] offset:12288
    s_waitcnt lgkmcnt(0)
    s_barrier
    s_setpc_b64 s[54:55]
L_c_slow:
    s_cmp_eq_u32 s43, 0
    s_cbranch_scc1 L_c_out
    s_mov_b32 s43, 0
    buffer_load_dwordx4 v[76:79], v29, s[32:35], s30 offen offset:0 sc1
    buffer_load_dwordx4 v[80:83], v29, s[32:35], s30 offen offset:2048 sc1
    buffer_load_dwordx4 v[84:87], v29, s[32:35], s31 offen offset:0 sc1
    buffer_load_dwordx4 v[108:111], v29, s[32:35], s31 offen offset:2048 sc1
    s_waitcnt vmcnt(0)
    v_sub_u32 v49, v79, v247
    v_max_f32 v42, v42, v49
    v_sub_u32 v49, v83, v247
    v_max_f32 v42, v42, v49
    v_sub_u32 v49, v87, v247
    v_max_f32 v42, v42, v49
    v_sub_u32 v49, v111, v247
    v_max_f32 v42, v42, v49
    s_nop 1
    v_max_f32_dpp v42, v42, v42 row_ror:8 row_mask:0xf bank_mask:0xf
    v_mov_b32 v48, v42
    s_nop 1
    v_max_f32_dpp v42, v48, v48 row_shr:4 row_mask:0xf bank_mask:0xa
    s_nop 1
    v_max_f32_dpp v42, v48, v48 row_shl:4 row_mask:0xf bank_mask:0x5
    v_mov_b32 v48, v42
    s_nop 1
    v_permlane32_swap_b32 v42, v48
    v_max_f32 v42, v42, v48
    v_mov_b32 v48, v42
    s_nop 1
    v_permlane16_swap_b32 v42, v48
    v_max_f32 v42, v42, v48
    s_lshl_b32 s56, s3, 2
    v_add_u32 v48, s56, v251
    ds_write_b32 v48, v42 offset:1024
    s_waitcnt lgkmcnt(0)
    s_barrier
    ds_read_b128 v[48:51], v251 offset:1024
    v_mov_b32 v16, 0
    v_mov_b32 v17, 0
    v_mov_b32 v18, 0
    v_mov_b32 v19, 0
    v_mov_b32 v20, 0
    v_mov_b32 v21, 0
    v_mov_b32 v22, 0
    s_waitcnt lgkmcnt(0)
    v_max3_f32 v42, v48, v49, v50
    v_max_f32 v42, v42, v51
    v_sub_u32 v49, v79, v247
    v_sub_f32 v49, v49, v42
    v_exp_f32 v49, v49
    s_nop 0
    v_cvt_pk_bf16_f32 v49, v49, 0
    v_lshlrev_b32 v50, 16, v49
    v_dot2_f32_bf16 v16, v76, v49, v16
    v_dot2_f32_bf16 v18, v77, v49, v18
    v_dot2_f32_bf16 v20, v78, v49, v20
    v_add_f32 v22, v22, v50
    v_dot2_f32_bf16 v17, v76, v50, v17
    v_dot2_f32_bf16 v19, v77, v50, v19
    v_dot2_f32_bf16 v21, v78, v50, v21
    v_sub_u32 v49, v83, v247
    v_sub_f32 v49, v49, v42
    v_exp_f32 v49, v49
    s_nop 0
    v_cvt_pk_bf16_f32 v49, v49, 0
    v_lshlrev_b32 v50, 16, v49
    v_dot2_f32_bf16 v16, v80, v49, v16
    v_dot2_f32_bf16 v18, v81, v49, v18
    v_dot2_f32_bf16 v20, v82, v49, v20
    v_add_f32 v22, v22, v50
    v_dot2_f32_bf16 v17, v80, v50, v17
    v_dot2_f32_bf16 v19, v81, v50, v19
    v_dot2_f32_bf16 v21, v82, v50, v21
    v_sub_u32 v49, v87, v247
    v_sub_f32 v49, v49, v42
    v_exp_f32 v49, v49
    s_nop 0
    v_cvt_pk_bf16_f32 v49, v49, 0
    v_lshlrev_b32 v50, 16, v49
    v_dot2_f32_bf16 v16, v84, v49, v16
    v_dot2_f32_bf16 v18, v85, v49, v18
    v_dot2_f32_bf16 v20, v86, v49, v20
    v_add_f32 v22, v22, v50
    v_dot2_f32_bf16 v17, v84, v50, v17
    v_dot2_f32_bf16 v19, v85, v50, v19
    v_dot2_f32_bf16 v21, v86, v50, v21
    v_sub_u32 v49, v111, v247
    v_sub_f32 v49, v49, v42
    v_exp_f32 v49, v49
    s_nop 0
    v_cvt_pk_bf16_f32 v49, v49, 0
    v_lshlrev_b32 v50, 16, v49
    v_dot2_f32_bf16 v16, v108, v49, v16
    v_dot2_f32_bf16 v18, v109, v49, v18
    v_dot2_f32_bf16 v20, v110, v49, v20
    v_add_f32 v22, v22, v50
    v_dot2_f32_bf16 v17, v108, v50, v17
    v_dot2_f32_bf16 v19, v109, v50, v19
    v_dot2_f32_bf16 v21, v110, v50, v21
    s_nop 2
    s_branch L_c_red
L_qk_retry:
    s_mov_b32 s53, 0
L_qk_again:
    s_mul_i32 s56, s3, 3072
    s_add_u32 s56, s56, 16384
    buffer_load_dwordx4 v[136:139], v65, s[32:35], s56 offen offset:0 sc1
    buffer_load_dwordx4 v[140:143], v65, s[32:35], s56 offen offset:1024 sc1
    buffer_load_dwordx4 v[144:147], v65, s[32:35], s56 offen offset:2048 sc1
    s_add_u32 s53, s53, 1
    s_waitcnt vmcnt(0)
    v_xor_b32 v1, s39, v138
    v_xor_b32 v2, s39, v142
    v_xor_b32 v3, s39, v146
    v_or3_b32 v1, v1, v2, v3
    v_cmp_ne_u32 vcc, 0, v1
    s_cbranch_vccz L_qk_ok
    s_cmp_lt_u32 s53, 65536
    s_cbranch_scc1 L_qk_again
    s_branch L_qk_ok
L_fl_retry:
    s_mov_b32 s53, 0
L_fl_again:
    buffer_load_dwordx2 v[234:235], v245, s[32:35], 0 offen offset:128 sc1
    s_add_u32 s53, s53, 1
    s_waitcnt vmcnt(0)
    v_cmp_ne_u32 vcc, s39, v234
    s_cbranch_vccz L_fl_ok
    s_cmp_lt_u32 s53, 65536
    s_cbranch_scc1 L_fl_again
    s_branch L_fl_ok
L_site0:
    s_call_b64 s[54:55], L_rare2
    s_branch L_back0
L_site1:
    s_call_b64 s[54:55], L_rare3
    s_branch L_back1
L_site2:
    s_call_b64 s[54:55], L_rare2
    s_branch L_back2
L_site3:
    s_call_b64 s[54:55], L_rare3
    s_branch L_back3
L_site4:
    s_call_b64 s[54:55], L_rare2
    s_branch L_back4
L_site5:
    s_call_b64 s[54:55], L_rare3
    s_branch L_back5
L_site6:
    s_call_b64 s[54:55], L_rare2
    s_branch L_back6
L_site7:
    s_call_b64 s[54:55], L_rare3
    s_branch L_back7
L_site8:
    s_call_b64 s[54:55], L_rare2
    s_branch L_back8
L_site9:
    s_call_b64 s[54:55], L_rare3
    s_branch L_back9
L_site10:
    s_call_b64 s[54:55], L_rare6
    s_branch L_back10
L_site11:
    s_call_b64 s[54:55], L_rare7
    s_branch L_back11
L_site12:
    s_call_b64 s[54:55], L_rare2
    s_branch L_back12
L_site13:
    s_call_b64 s[54:55], L_rare5
    s_branch L_back13
L_rare2:
    s_nop 7
    s_nop 7
    v_mov_b32 v2, v1
    s_nop 1
    v_permlane32_swap_b32 v1, v2
    v_max_f32 v1, v1, v2
    v_mov_b32 v2, v1
    s_nop 1
    v_permlane16_swap_b32 v1, v2
    v_max_f32 v1, v1, v2
    v_max_f32 v1, 0, v1
    v_sub_f32 v62, v62, v1
    v_sub_f32 v88, v88, v1
    v_sub_f32 v89, v89, v1
    v_sub_f32 v90, v90, v1
    v_sub_f32 v91, v91, v1
    v_sub_f32 v1, 0, v1
    v_exp_f32 v1, v1
    s_nop 0
    v_mul_f32 v63, v63, v1
    v_mul_f32 v64, v64, v1
    v_mul_f32 v68, v68, v1
    v_mul_f32 v69, v69, v1
    v_mul_f32 v70, v70, v1
    v_mul_f32 v71, v71, v1
    v_mov_b32 v2, 1
    ds_write_b32 v254, v2 offset:4096
    s_waitcnt lgkmcnt(0)
    s_nop 3
    s_setpc_b64 s[54:55]
L_rare3:
    s_nop 7
    s_nop 7
    v_mov_b32 v2, v1
    s_nop 1
    v_permlane32_swap_b32 v1, v2
    v_max_f32 v1, v1, v2
    v_mov_b32 v2, v1
    s_nop 1
    v_permlane16_swap_b32 v1, v2
    v_max_f32 v1, v1, v2
    v_max_f32 v1, 0, v1
    v_sub_f32 v62, v62, v1
    v_sub_f32 v104, v104, v1
    v_sub_f32 v105, v105, v1
    v_sub_f32 v106, v106, v1
    v_sub_f32 v107, v107, v1
    v_sub_f32 v1, 0, v1
    v_exp_f32 v1, v1
    s_nop 0
    v_mul_f32 v63, v63, v1
    v_mul_f32 v64, v64, v1
    v_mul_f32 v68, v68, v1
    v_mul_f32 v69, v69, v1
    v_mul_f32 v70, v70, v1
    v_mul_f32 v71, v71, v1
    v_mul_f32 v88, v88, v1
    v_mul_f32 v89, v89, v1
    v_mul_f32 v90, v90, v1
    v_mul_f32 v91, v91, v1
    v_mov_b32 v2, 1
    ds_write_b32 v254, v2 offset:4096
    s_waitcnt lgkmcnt(0)
    s_nop 3
    s_setpc_b64 s[54:55]
L_rare5:
    s_nop 7
    s_nop 7
    v_mov_b32 v2, v1
    s_nop 1
    v_permlane32_swap_b32 v1, v2
    v_max_f32 v1, v1, v2
    v_mov_b32 v2, v1
    s_nop 1
    v_permlane16_swap_b32 v1, v2
    v_max_f32 v1, v1, v2
    v_max_f32 v1, 0, v1
    v_sub_f32 v62, v62, v1
    v_sub_f32 v104, v104, v1
    v_sub_f32 v105, v105, v1
    v_sub_f32 v106, v106, v1
    v_sub_f32 v107, v107, v1
    v_sub_f32 v1, 0, v1
    v_exp_f32 v1, v1
    s_nop 0
    v_mul_f32 v63, v63, v1
    v_mul_f32 v64, v64, v1
    v_mul_f32 v68, v68, v1
    v_mul_f32 v69, v69, v1
    v_mul_f32 v70, v70, v1
    v_mul_f32 v71, v71, v1
    v_mul_f32 v88, v88, v1
    v_mul_f32 v89, v89, v1
    v_mul_f32 v90, v90, v1
    v_mul_f32 v91, v91, v1
    v_cvt_pk_bf16_f32 v72, v88, v89
    v_cvt_pk_bf16_f32 v73, v90, v91
    v_mov_b32 v2, 1
    ds_write_b32 v254, v2 offset:4096
    s_waitcnt lgkmcnt(0)
    s_nop 3
    s_setpc_b64 s[54:55]
L_rare6:
    s_nop 7
    s_nop 7
    v_mov_b32 v2, v1
    s_nop 1
    v_permlane32_swap_b32 v1, v2
    v_max_f32 v1, v1, v2
    v_mov_b32 v2, v1
    s_nop 1
    v_permlane16_swap_b32 v1, v2
    v_max_f32 v1, v1, v2
    v_max_f32 v1, 0, v1
    v_sub_f32 v62, v62, v1
    v_sub_f32 v88, v88, v1
    v_sub_f32 v89, v89, v1
    v_sub_f32 v90, v90, v1
    v_sub_f32 v91, v91, v1
    v_sub_f32 v1, 0, v1
    v_exp_f32 v1, v1
    s_nop 0
    v_mul_f32 v63, v63, v1
    v_mul_f32 v64, v64, v1
    v_mul_f32 v68, v68, v1
    v_mul_f32 v69, v69, v1
    v_mul_f32 v70, v70, v1
    v_mul_f32 v71, v71, v1
    v_mov_b32 v2, 1
    ds_write_b32 v254, v2 offset:4100
    s_waitcnt lgkmcnt(0)
    s_nop 3
    s_setpc_b64 s[54:55]
L_rare7:
    s_nop 7
    s_nop 7
    v_mov_b32 v2, v1
    s_nop 1
    v_permlane32_swap_b32 v1, v2
    v_max_f32 v1, v1, v2
    v_mov_b32 v2, v1
    s_nop 1
    v_permlane16_swap_b32 v1, v2
    v_max_f32 v1, v1, v2
    v_max_f32 v1, 0, v1
    v_sub_f32 v62, v62, v1
    v_sub_f32 v104, v104, v1
    v_sub_f32 v105, v105, v1
    v_sub_f32 v106, v106, v1
    v_sub_f32 v107, v107, v1
    v_sub_f32 v1, 0, v1
    v_exp_f32 v1, v1
    s_nop 0
    v_mul_f32 v63, v63, v1
    v_mul_f32 v64, v64, v1
    v_mul_f32 v68, v68, v1
    v_mul_f32 v69, v69, v1
    v_mul_f32 v70, v70, v1
    v_mul_f32 v71, v71, v1
    v_mul_f32 v88, v88, v1
    v_mul_f32 v89, v89, v1
    v_mul_f32 v90, v90, v1
    v_mul_f32 v91, v91, v1
    v_mov_b32 v2, 1
    ds_write_b32 v254, v2 offset:4100
    s_waitcnt lgkmcnt(0)
    s_nop 3
    s_setpc_b64 s[54:55]
L_codeend:
.section .rodata,"a"
.p2align 6
.amdhsa_kernel standalone__detection_seg_dino__vision_kernel
  .amdhsa_next_free_vgpr 464
  .amdhsa_next_free_sgpr 102
  .amdhsa_accum_offset 256
  .amdhsa_group_segment_fixed_size 0
  .amdhsa_kernarg_size 80
  .amdhsa_user_sgpr_count 2
  .amdhsa_user_sgpr_kernarg_segment_ptr 1
  .amdhsa_system_sgpr_workgroup_id_x 1
  .amdhsa_float_denorm_mode_32 3
.end_amdhsa_kernel
```
